```python
import torch

def _softmax(x, axis=-1):
    return torch.softmax(x, dim=axis)
def _gelu(x):
    return torch.nn.functional.gelu(x, approximate="tanh")
def _silu(x):
    return torch.nn.functional.silu(x)
def _sigmoid(x):
    return torch.sigmoid(x)
def _layernorm(x, axis=-1, eps=1e-5):
    m = x.mean(dim=axis, keepdim=True)
    v = x.var(dim=axis, keepdim=True, unbiased=False)
    return (x - m) / torch.sqrt(v + eps)
def _scatter_add(tgt, idx, src, axis=0):
    return tgt.clone().index_add_(axis, idx, src)
def _segment_sum(src, seg, n):
    out = torch.zeros((n,) + src.shape[1:], dtype=src.dtype)
    return out.index_add_(0, seg, src)
def _pad(x, pw):
    flat = tuple(v for pair in reversed(pw) for v in pair)
    return torch.nn.functional.pad(x, flat)

kernel_name = 'sequential_preLN__compressed_kv_cla__glu_gated_swiglu__prompt'

def setup_inputs():

    _w = (lambda a: (lambda t: t.to(torch.bfloat16) if t.is_floating_point() else t)(torch.as_tensor(a)))
    def _A_setup():
        B, H, Sq, Sk, D, M = 1, 32, 2048, 2048, 128, 512
        Dc = 4 * D
        return {
            "x": _w((lambda *s: torch.randn(*s, dtype=torch.bfloat16) * 0.05)(B, Sq, M)),
            "c_kv": _w((lambda *s: torch.randn(*s, dtype=torch.bfloat16) * 0.2)(B, Sk, Dc)),
            "w_q": _w((lambda *s: torch.randn(*s, dtype=torch.bfloat16) * 6.4)(M, H, D) * (M ** -0.5)),
            "w_uk": _w((lambda *s: torch.randn(*s, dtype=torch.bfloat16) * 6.4)(Dc, H, D) * (Dc ** -0.5)),
            "w_uv": _w((lambda *s: torch.randn(*s, dtype=torch.bfloat16) * 0.2)(Dc, H, D) * (Dc ** -0.5)),
            "w_o": _w((lambda *s: torch.randn(*s, dtype=torch.bfloat16) * 0.2)(H, D, M) * ((H * D) ** -0.5)),
        }
    _A_in = _A_setup()

    def _B_setup():
        B, S, D, F = 1, 2048, 512, 1376
        return {
            "x": _w((lambda *s: torch.randn(*s, dtype=torch.bfloat16) * 0.05)(B, S, D)),
            "w1": _w((lambda *s: torch.randn(*s, dtype=torch.bfloat16) * 0.2)(D, F) * (2.0 / D) ** 0.5),
            "w3": _w((lambda *s: torch.randn(*s, dtype=torch.bfloat16) * 0.2)(D, F) * (2.0 / D) ** 0.5),
            "w2": _w((lambda *s: torch.randn(*s, dtype=torch.bfloat16) * 0.2)(F, D) * (2.0 / F) ** 0.5),
        }
    _B_in = _B_setup()

    return {
        "A_x": _A_in["x"],
        "A_c_kv": _A_in["c_kv"],
        "A_w_q": _A_in["w_q"],
        "A_w_uk": _A_in["w_uk"],
        "A_w_uv": _A_in["w_uv"],
        "A_w_o": _A_in["w_o"],
        "B_x": _B_in["x"],
        "B_w1": _B_in["w1"],
        "B_w3": _B_in["w3"],
        "B_w2": _B_in["w2"],
    }

def reference(A_x, A_c_kv, A_w_q, A_w_uk, A_w_uv, A_w_o, B_x, B_w1, B_w3, B_w2):
    def _A_ref(x, c_kv, w_q, w_uk, w_uv, w_o):
        B, Sq, M = x.shape[0], x.shape[1], x.shape[2]
        Sk = c_kv.shape[1]
        H, D = w_q.shape[1], w_q.shape[2]
        q = torch.einsum("bqm,mhd->bhqd", x, w_q)
        k = torch.einsum("bkc,chd->bhkd", c_kv, w_uk)
        v = torch.einsum("bkc,chd->bhkd", c_kv, w_uv)
        scores = torch.einsum("bhqd,bhkd->bhqk", q, k) * (D ** -0.5)
        off = Sk - Sq
        qi = torch.arange(Sq)[:, None]
        kj = torch.arange(Sk)[None, :]
        cmask = kj <= (qi + off)
        scores = torch.where(cmask[None, None], scores, -1e9)
        p = _softmax(scores, axis=-1)
        ctx = torch.einsum("bhqk,bhkd->bhqd", p, v)
        return torch.einsum("bhqd,hdm->bqm", ctx, w_o)

    def _B_ref(x, w1, w3, w2):
        gate = torch.einsum("bsd,df->bsf", x, w1)
        up = torch.einsum("bsd,df->bsf", x, w3)
        h = _silu(gate) * up
        out = torch.einsum("bsf,fd->bsd", h, w2)
        return out

    x = A_x
    h = x + _A_ref(_layernorm(x, axis=-1), A_c_kv, A_w_q, A_w_uk, A_w_uv, A_w_o)
    h2 = h + _B_ref(_layernorm(h, axis=-1), B_w1, B_w3, B_w2)
    return h2
```

```asm
; @launch grid=(256,1,1) block=(256,1,1) lds=163840
.amdgcn_target "amdgcn-amd-amdhsa--gfx950"
.text
.globl sequential_preLN__compressed_kv_cla__glu_gated_swiglu__prompt_kernel
.p2align 8
.type sequential_preLN__compressed_kv_cla__glu_gated_swiglu__prompt_kernel,@function
sequential_preLN__compressed_kv_cla__glu_gated_swiglu__prompt_kernel:
 s_cmp_ge_u32 s2, 256
 s_cbranch_scc0 sequential_preLN__compressed_kv_cla__glu_gated_swiglu__prompt_kernel_go
 s_endpgm
sequential_preLN__compressed_kv_cla__glu_gated_swiglu__prompt_kernel_go:
 s_getpc_b64 s[6:7]
 v_and_b32 v2, 63, v0
 v_lshlrev_b32 v2, 7, v2
 global_load_dword v29, v2, s[6:7]
 s_load_dwordx16 s[36:51], s[0:1], 0
 s_load_dwordx8 s[52:59], s[0:1], 64
 s_load_dwordx2 s[60:61], s[0:1], 96
 v_lshrrev_b32 v1, 6, v0
 v_and_b32 v0, 63, v0
 v_readfirstlane_b32 s3, v1
 v_lshrrev_b32 v2, 3, v0
 v_mov_b32 v3, 8192
 v_mul_lo_u32 v2, v2, v3
 v_lshrrev_b32 v3, 4, v0
 v_and_b32 v3, 1, v3
 v_lshlrev_b32 v3, 1, v3
 v_and_b32 v12, 7, v0
 v_xor_b32 v3, v3, v12
 v_lshl_add_u32 v2, v3, 4, v2
 s_mul_i32 s4, s3, 262144
 v_add_u32 v4, s4, v2
 v_xor_b32 v5, 64, v4
 v_add_u32 v6, 129024, v4
 v_add_u32 v7, 193536, v5
 v_add_u32 v5, 64512, v5
 s_and_b32 s70, s2, 7
 s_lshl_b32 s70, s70, 2
 s_bfe_u32 s71, s2, 0x20003
 s_add_u32 s70, s70, s71
 s_lshr_b32 s71, s2, 5
 s_mul_i32 s5, s3, 24576
 s_add_u32 s5, s5, 65536
 v_lshrrev_b32 v2, 4, v0
 v_and_b32 v3, 15, v0
 v_xor_b32 v21, v2, v3
 v_lshlrev_b32 v21, 4, v21
 v_lshl_add_u32 v2, v2, 10, v21
 s_lshl_b32 s4, s3, 16
 v_add_u32 v12, s4, v2
 v_xor_b32 v13, 64, v12
 v_add_u32 v13, 3072, v13
 v_xor_b32 v14, 128, v12
 v_add_u32 v14, 6144, v14
 v_xor_b32 v15, 192, v12
 v_add_u32 v15, 9216, v15
 s_lshl_b32 s6, s70, 8
 s_sub_u32 s68, 0x400000, s6
 s_lshl_b32 s4, s71, 18
 s_waitcnt lgkmcnt(0)
 s_lshl_b32 s58, s3, 12
 s_add_u32 s8, s38, s4
 s_addc_u32 s9, s39, 0
 s_mov_b32 s10, 262144
 s_mov_b32 s11, 0x20000
 s_add_u32 s12, s42, s6
 s_addc_u32 s13, s43, 0
 s_mov_b32 s14, s68
 s_mov_b32 s15, 0x20000
 s_add_u32 m0, s58, 0
 s_mov_b32 s4, 0
 buffer_load_dwordx4 v4, s[12:15], s4 offen offset:0 lds
 buffer_load_dwordx4 v5, s[12:15], s4 offen offset:1024 lds
 buffer_load_dwordx4 v6, s[12:15], s4 offen offset:2048 lds
 buffer_load_dwordx4 v7, s[12:15], s4 offen offset:3072 lds
 s_add_u32 m0, s5, 0
 s_mov_b32 s4, 0
 buffer_load_dwordx4 v12, s[8:11], s4 offen offset:0 lds
 buffer_load_dwordx4 v13, s[8:11], s4 offen offset:1024 lds
 buffer_load_dwordx4 v14, s[8:11], s4 offen offset:2048 lds
 buffer_load_dwordx4 v15, s[8:11], s4 offen offset:3072 lds
 s_add_u32 m0, s5, 4096
 s_mov_b32 s4, 16384
 buffer_load_dwordx4 v12, s[8:11], s4 offen offset:0 lds
 buffer_load_dwordx4 v13, s[8:11], s4 offen offset:1024 lds
 buffer_load_dwordx4 v14, s[8:11], s4 offen offset:2048 lds
 buffer_load_dwordx4 v15, s[8:11], s4 offen offset:3072 lds
 s_add_u32 m0, s5, 8192
 s_mov_b32 s4, 32768
 buffer_load_dwordx4 v12, s[8:11], s4 offen offset:0 lds
 buffer_load_dwordx4 v13, s[8:11], s4 offen offset:1024 lds
 buffer_load_dwordx4 v14, s[8:11], s4 offen offset:2048 lds
 buffer_load_dwordx4 v15, s[8:11], s4 offen offset:3072 lds
 s_add_u32 m0, s5, 12288
 s_mov_b32 s4, 49152
 buffer_load_dwordx4 v12, s[8:11], s4 offen offset:0 lds
 buffer_load_dwordx4 v13, s[8:11], s4 offen offset:1024 lds
 buffer_load_dwordx4 v14, s[8:11], s4 offen offset:2048 lds
 buffer_load_dwordx4 v15, s[8:11], s4 offen offset:3072 lds
 s_add_u32 s16, s44, s6
 s_addc_u32 s17, s45, 0
 s_mov_b32 s18, s68
 s_mov_b32 s19, 0x20000
 s_getpc_b64 s[6:7]
L_cw_1:
 s_add_u32 s6, s6, sequential_preLN__compressed_kv_cla__glu_gated_swiglu__prompt_kernel_c0 - L_cw_1
 s_addc_u32 s7, s7, 0
 s_lshr_b32 s4, s2, 3
 s_lshl_b32 s4, s4, 2
 s_add_u32 s4, s4, s3
 s_lshl_b32 s4, s4, 7
 v_lshlrev_b32 v28, 14, v0
 v_add_u32 v28, s4, v28
 v_cmp_gt_u32 vcc, sequential_preLN__compressed_kv_cla__glu_gated_swiglu__prompt_kernel_cend - sequential_preLN__compressed_kv_cla__glu_gated_swiglu__prompt_kernel_c0, v28
 s_and_saveexec_b64 s[92:93], vcc
 s_cbranch_execz L_cs_2
 global_load_dword v29, v28, s[6:7]
L_cs_2:
 s_mov_b64 exec, s[92:93]
 v_lshrrev_b32 v2, 4, v0
 v_bfe_u32 v3, v0, 2, 2
 v_lshl_add_u32 v22, v2, 3, v3
 v_lshlrev_b32 v22, 7, v22
 v_and_b32 v23, 3, v0
 v_lshl_add_u32 v22, v23, 3, v22
 v_and_b32 v2, 1, v2
 v_lshrrev_b32 v3, 1, v3
 v_lshl_add_u32 v2, v2, 1, v3
 v_lshl_add_u32 v8, v2, 5, v22
 v_xor_b32 v9, 32, v8
 v_xor_b32 v10, 64, v8
 v_xor_b32 v11, 96, v8
 s_lshl_b32 s69, s2, 2
 s_add_u32 s69, s69, s3
 v_and_b32 v3, 15, v0
 v_lshl_add_u32 v16, v3, 8, v21
 s_mul_i32 s4, s3, 16384
 v_lshlrev_b32 v2, 4, v0
 v_add_u32 v20, s4, v2
 v_xor_b32 v17, 64, v16
 v_xor_b32 v18, 128, v16
 v_xor_b32 v19, 192, v16
 v_add_u32 v16, s5, v16
 v_add_u32 v17, s5, v17
 v_add_u32 v18, s5, v18
 v_add_u32 v19, s5, v19
 s_lshr_b32 s4, s2, 3
 s_lshl_b32 s4, s4, 2
 s_add_u32 s4, s4, s3
 s_lshl_b32 s4, s4, 15
 s_and_b32 s68, s2, 7
 s_lshl_b32 s68, s68, 10
 s_add_u32 s4, s4, s68
 v_lshrrev_b32 v2, 3, v0
 v_and_b32 v3, 7, v0
 v_lshlrev_b32 v3, 7, v3
 v_lshl_add_u32 v25, v2, 13, v3
 s_add_u32 s32, s44, s4
 s_addc_u32 s33, s45, 0
 s_mov_b32 s34, 25600
 s_mov_b32 s35, 0x20000
 s_add_u32 s80, s40, s4
 s_addc_u32 s81, s41, 0
 s_mov_b32 s82, 25600
 s_mov_b32 s83, 0x20000
 s_add_u32 s96, s60, 72351744
 s_addc_u32 s97, s61, 0
 s_mov_b32 s98, 262144
 s_mov_b32 s99, 0x20000
 v_mov_b32 v30, 196608
 buffer_load_dword v31, v30, s[96:99], 0 offen sc1
 s_mul_i32 s4, s70, 524288
 s_mul_i32 s68, s71, 65536
 s_add_u32 s4, s4, s68
 s_add_u32 s4, s4, 16777216
 s_add_u32 s20, s60, s4
 s_addc_u32 s21, s61, 0
 s_mov_b32 s22, 65536
 s_mov_b32 s23, 0x20000
 s_sub_u32 s4, s4, 16777216
 s_add_u32 s24, s60, s4
 s_addc_u32 s25, s61, 0
 s_mov_b32 s26, 65536
 s_mov_b32 s27, 0x20000
 s_lshr_b32 s4, s69, 3
 s_lshl_b32 s4, s4, 14
 s_add_u32 s4, s4, 33554432
 s_add_u32 s88, s60, s4
 s_addc_u32 s89, s61, 0
 s_mov_b32 s90, 16384
 s_mov_b32 s91, 0x20000
 s_lshl_b32 s4, s69, 11
 s_add_u32 s84, s36, s4
 s_addc_u32 s85, s37, 0
 s_mov_b32 s86, 2048
 s_mov_b32 s87, 0x20000
 s_lshr_b32 s64, s2, 3
 s_add_u32 s64, s64, 40
 s_and_b32 s65, s2, 7
 s_lshl_b32 s66, s64, 15
 s_lshl_b32 s67, s65, 7
 s_add_u32 s66, s66, s67
 s_min_u32 s66, s66, 1409024
 s_sub_u32 s68, 1409024, s66
 s_add_u32 s28, s54, s66
 s_addc_u32 s29, s55, 0
 s_mov_b32 s30, s68
 s_mov_b32 s31, 0x20000
 s_mul_i32 s67, s65, 176128
 s_lshl_b32 s64, s64, 10
 s_add_u32 s67, s67, s64
 s_add_u32 s67, s67, 60817408
 s_add_u32 s76, s60, s67
 s_addc_u32 s77, s61, 0
 s_mov_b32 s78, 133120
 s_mov_b32 s79, 0x20000
 s_lshl_b32 s62, s3, 8
 s_add_u32 s62, s62, s2
 v_lshrrev_b32 v2, 3, v0
 v_and_b32 v3, 7, v0
 v_lshlrev_b32 v3, 4, v3
 v_lshl_add_u32 v21, v2, 10, v3
 v_bfe_u32 v2, v0, 2, 4
 v_lshlrev_b32 v2, 7, v2
 v_and_b32 v3, 3, v0
 v_lshl_add_u32 v23, v3, 3, v2
 v_add_u32 v23, 147456, v23
 v_lshlrev_b32 v24, 4, v0
 v_and_b32 v26, 1, v0
 v_lshlrev_b32 v26, 10, v26
 v_lshrrev_b32 v3, 1, v0
 v_lshl_add_u32 v26, v3, 4, v26
 s_mov_b32 s64, 4096
 s_mov_b32 s65, 8192
 s_mov_b32 s66, 12288
 s_waitcnt vmcnt(13)
 ds_read_b128 a[0:3], v16 offset:0
 ds_read_b128 a[4:7], v17 offset:0
 ds_read_b128 a[8:11], v18 offset:0
 ds_read_b128 a[12:15], v19 offset:0
 s_add_u32 m0, s5, 16384
 s_mov_b32 s4, 256
 buffer_load_dwordx4 v12, s[8:11], s4 offen offset:0 lds
 buffer_load_dwordx4 v13, s[8:11], s4 offen offset:1024 lds
 buffer_load_dwordx4 v14, s[8:11], s4 offen offset:2048 lds
 buffer_load_dwordx4 v15, s[8:11], s4 offen offset:3072 lds
 s_waitcnt vmcnt(13)
 ds_read_b128 a[64:67], v16 offset:4096
 ds_read_b128 a[68:71], v17 offset:4096
 ds_read_b128 a[72:75], v18 offset:4096
 ds_read_b128 a[76:79], v19 offset:4096
 s_add_u32 m0, s5, 20480
 s_mov_b32 s4, 16640
 buffer_load_dwordx4 v12, s[8:11], s4 offen offset:0 lds
 buffer_load_dwordx4 v13, s[8:11], s4 offen offset:1024 lds
 buffer_load_dwordx4 v14, s[8:11], s4 offen offset:2048 lds
 buffer_load_dwordx4 v15, s[8:11], s4 offen offset:3072 lds
 s_waitcnt vmcnt(13)
 ds_read_b128 a[128:131], v16 offset:8192
 ds_read_b128 a[132:135], v17 offset:8192
 ds_read_b128 a[136:139], v18 offset:8192
 ds_read_b128 a[140:143], v19 offset:8192
 s_add_u32 m0, s58, 16384
 s_mov_b32 s4, 128
 buffer_load_dwordx4 v4, s[12:15], s4 offen offset:0 lds
 buffer_load_dwordx4 v5, s[12:15], s4 offen offset:1024 lds
 buffer_load_dwordx4 v6, s[12:15], s4 offen offset:2048 lds
 buffer_load_dwordx4 v7, s[12:15], s4 offen offset:3072 lds
 s_waitcnt vmcnt(13)
 ds_read_b128 a[192:195], v16 offset:12288
 ds_read_b128 a[196:199], v17 offset:12288
 ds_read_b128 a[200:203], v18 offset:12288
 ds_read_b128 a[204:207], v19 offset:12288
 buffer_load_dwordx4 v[192:195], v26, s[84:87], 0 offen offset:0
 buffer_load_dwordx4 v[196:199], v26, s[84:87], 0 offen offset:512
 s_barrier
sequential_preLN__compressed_kv_cla__glu_gated_swiglu__prompt_kernel_c0:
 ds_read_b64_tr_b16 v[32:33], v8 offset:0
 ds_read_b64_tr_b16 v[34:35], v8 offset:512
 ds_read_b64_tr_b16 v[36:37], v8 offset:4096
 ds_read_b64_tr_b16 v[38:39], v8 offset:4608
 ds_read_b64_tr_b16 v[40:41], v8 offset:8192
 ds_read_b64_tr_b16 v[42:43], v8 offset:8704
 ds_read_b64_tr_b16 v[44:45], v8 offset:12288
 ds_read_b64_tr_b16 v[46:47], v8 offset:12800
 s_waitcnt lgkmcnt(6)
 v_mfma_f32_16x16x32_bf16 v[64:67], v[32:35], a[0:3], 0
 s_waitcnt lgkmcnt(4)
 ds_read_b64_tr_b16 v[48:49], v9 offset:0
 v_mfma_f32_16x16x32_bf16 v[64:67], v[36:39], a[4:7], v[64:67]
 s_waitcnt lgkmcnt(3)
 ds_read_b64_tr_b16 v[50:51], v9 offset:512
 v_mfma_f32_16x16x32_bf16 v[64:67], v[40:43], a[8:11], v[64:67]
 s_waitcnt lgkmcnt(2)
 ds_read_b64_tr_b16 v[52:53], v9 offset:4096
 v_mfma_f32_16x16x32_bf16 v[64:67], v[44:47], a[12:15], v[64:67]
 ds_read_b64_tr_b16 v[54:55], v9 offset:4608
 v_mfma_f32_16x16x32_bf16 v[68:71], v[44:47], a[76:79], 0
 s_add_u32 m0, s5, 0
 v_mfma_f32_16x16x32_bf16 v[68:71], v[40:43], a[72:75], v[68:71]
 s_mov_b32 s4, 33024
 ds_read_b64_tr_b16 v[56:57], v9 offset:8192
 v_mfma_f32_16x16x32_bf16 v[68:71], v[36:39], a[68:71], v[68:71]
 ds_read_b64_tr_b16 v[58:59], v9 offset:8704
 v_mfma_f32_16x16x32_bf16 v[68:71], v[32:35], a[64:67], v[68:71]
 buffer_load_dwordx4 v12, s[8:11], s4 offen offset:0 lds
 v_mfma_f32_16x16x32_bf16 v[72:75], v[32:35], a[128:131], 0
 ds_read_b64_tr_b16 v[60:61], v9 offset:12288
 ds_read_b64_tr_b16 v[62:63], v9 offset:12800
 v_mfma_f32_16x16x32_bf16 v[72:75], v[36:39], a[132:135], v[72:75]
 v_mfma_f32_16x16x32_bf16 v[72:75], v[40:43], a[136:139], v[72:75]
 buffer_load_dwordx4 v13, s[8:11], s4 offen offset:1024 lds
 v_mfma_f32_16x16x32_bf16 v[72:75], v[44:47], a[140:143], v[72:75]
 v_mfma_f32_16x16x32_bf16 v[76:79], v[44:47], a[204:207], 0
 buffer_load_dwordx4 v14, s[8:11], s4 offen offset:2048 lds
 v_mfma_f32_16x16x32_bf16 v[76:79], v[40:43], a[200:203], v[76:79]
 v_mfma_f32_16x16x32_bf16 v[76:79], v[36:39], a[196:199], v[76:79]
 v_mfma_f32_16x16x32_bf16 v[76:79], v[32:35], a[192:195], v[76:79]
 s_waitcnt lgkmcnt(4)
 buffer_load_dwordx4 v15, s[8:11], s4 offen offset:3072 lds
 v_mfma_f32_16x16x32_bf16 v[80:83], v[48:51], a[0:3], 0
 ds_read_b64_tr_b16 v[32:33], v10 offset:0
 ds_read_b64_tr_b16 v[34:35], v10 offset:512
 v_mfma_f32_16x16x32_bf16 v[80:83], v[52:55], a[4:7], v[80:83]
 s_waitcnt lgkmcnt(4)
 v_mfma_f32_16x16x32_bf16 v[80:83], v[56:59], a[8:11], v[80:83]
 s_waitcnt lgkmcnt(2)
 ds_read_b64_tr_b16 v[36:37], v10 offset:4096
 v_mfma_f32_16x16x32_bf16 v[80:83], v[60:63], a[12:15], v[80:83]
 ds_read_b64_tr_b16 v[38:39], v10 offset:4608
 v_mfma_f32_16x16x32_bf16 v[84:87], v[60:63], a[76:79], 0
 s_add_u32 m0, s5, 4096
 v_mfma_f32_16x16x32_bf16 v[84:87], v[56:59], a[72:75], v[84:87]
 ds_read_b64_tr_b16 v[40:41], v10 offset:8192
 ds_read_b64_tr_b16 v[42:43], v10 offset:8704
 v_mfma_f32_16x16x32_bf16 v[84:87], v[52:55], a[68:71], v[84:87]
 s_mov_b32 s4, 49408
 v_mfma_f32_16x16x32_bf16 v[84:87], v[48:51], a[64:67], v[84:87]
 v_mfma_f32_16x16x32_bf16 v[88:91], v[48:51], a[128:131], 0
 ds_read_b64_tr_b16 v[44:45], v10 offset:12288
 ds_read_b64_tr_b16 v[46:47], v10 offset:12800
 v_mfma_f32_16x16x32_bf16 v[88:91], v[52:55], a[132:135], v[88:91]
 buffer_load_dwordx4 v12, s[8:11], s4 offen offset:0 lds
 v_mfma_f32_16x16x32_bf16 v[88:91], v[56:59], a[136:139], v[88:91]
 v_mfma_f32_16x16x32_bf16 v[88:91], v[60:63], a[140:143], v[88:91]
 buffer_load_dwordx4 v13, s[8:11], s4 offen offset:1024 lds
 v_mfma_f32_16x16x32_bf16 v[92:95], v[60:63], a[204:207], 0
 v_mfma_f32_16x16x32_bf16 v[92:95], v[56:59], a[200:203], v[92:95]
 v_mfma_f32_16x16x32_bf16 v[92:95], v[52:55], a[196:199], v[92:95]
 buffer_load_dwordx4 v14, s[8:11], s4 offen offset:2048 lds
 v_mfma_f32_16x16x32_bf16 v[92:95], v[48:51], a[192:195], v[92:95]
 s_waitcnt lgkmcnt(2)
 v_mfma_f32_16x16x32_bf16 v[96:99], v[32:35], a[0:3], 0
 buffer_load_dwordx4 v15, s[8:11], s4 offen offset:3072 lds
 v_mfma_f32_16x16x32_bf16 v[96:99], v[36:39], a[4:7], v[96:99]
 ds_read_b64_tr_b16 v[48:49], v11 offset:0
 ds_read_b64_tr_b16 v[50:51], v11 offset:512
 v_mfma_f32_16x16x32_bf16 v[96:99], v[40:43], a[8:11], v[96:99]
 s_waitcnt lgkmcnt(2)
 ds_read_b64_tr_b16 v[52:53], v11 offset:4096
 v_mfma_f32_16x16x32_bf16 v[96:99], v[44:47], a[12:15], v[96:99]
 s_add_u32 m0, s58, 32768
 ds_read_b64_tr_b16 v[54:55], v11 offset:4608
 v_mfma_f32_16x16x32_bf16 v[100:103], v[44:47], a[76:79], 0
 v_mfma_f32_16x16x32_bf16 v[100:103], v[40:43], a[72:75], v[100:103]
 s_mov_b32 s4, 1048576
 ds_read_b64_tr_b16 v[56:57], v11 offset:8192
 v_mfma_f32_16x16x32_bf16 v[100:103], v[36:39], a[68:71], v[100:103]
 ds_read_b64_tr_b16 v[58:59], v11 offset:8704
 v_mfma_f32_16x16x32_bf16 v[100:103], v[32:35], a[64:67], v[100:103]
 v_mfma_f32_16x16x32_bf16 v[104:107], v[32:35], a[128:131], 0
 buffer_load_dwordx4 v4, s[12:15], s4 offen offset:0 lds
 v_mfma_f32_16x16x32_bf16 v[104:107], v[36:39], a[132:135], v[104:107]
 ds_read_b64_tr_b16 v[60:61], v11 offset:12288
 ds_read_b64_tr_b16 v[62:63], v11 offset:12800
 v_mfma_f32_16x16x32_bf16 v[104:107], v[40:43], a[136:139], v[104:107]
 buffer_load_dwordx4 v5, s[12:15], s4 offen offset:1024 lds
 v_mfma_f32_16x16x32_bf16 v[104:107], v[44:47], a[140:143], v[104:107]
 v_mfma_f32_16x16x32_bf16 v[108:111], v[44:47], a[204:207], 0
 v_mfma_f32_16x16x32_bf16 v[108:111], v[40:43], a[200:203], v[108:111]
 buffer_load_dwordx4 v6, s[12:15], s4 offen offset:2048 lds
 v_mfma_f32_16x16x32_bf16 v[108:111], v[36:39], a[196:199], v[108:111]
 v_mfma_f32_16x16x32_bf16 v[108:111], v[32:35], a[192:195], v[108:111]
 s_waitcnt lgkmcnt(4)
 s_waitcnt vmcnt(13)
 s_barrier
 v_mfma_f32_16x16x32_bf16 v[112:115], v[48:51], a[0:3], 0
 buffer_load_dwordx4 v7, s[12:15], s4 offen offset:3072 lds
 v_mfma_f32_16x16x32_bf16 v[112:115], v[52:55], a[4:7], v[112:115]
 s_waitcnt lgkmcnt(2)
 ds_read_b64_tr_b16 v[32:33], v8 offset:16384
 v_mfma_f32_16x16x32_bf16 v[112:115], v[56:59], a[8:11], v[112:115]
 s_waitcnt lgkmcnt(1)
 v_readfirstlane_b32 s100, v31
 s_nop 0
 s_add_u32 s100, s100, 1
 v_mfma_f32_16x16x32_bf16 v[112:115], v[60:63], a[12:15], v[112:115]
 ds_read_b64_tr_b16 v[34:35], v8 offset:16896
 v_mfma_f32_16x16x32_bf16 v[116:119], v[60:63], a[76:79], 0
 ds_read_b64_tr_b16 v[36:37], v8 offset:20480
 ds_read_b64_tr_b16 v[38:39], v8 offset:20992
 v_mfma_f32_16x16x32_bf16 v[116:119], v[56:59], a[72:75], v[116:119]
 ds_read_b128 a[16:19], v16 offset:16384
 ds_read_b64_tr_b16 v[40:41], v8 offset:24576
 v_mfma_f32_16x16x32_bf16 v[116:119], v[52:55], a[68:71], v[116:119]
 ds_read_b64_tr_b16 v[42:43], v8 offset:25088
 ds_read_b128 a[20:23], v17 offset:16384
 v_mfma_f32_16x16x32_bf16 v[116:119], v[48:51], a[64:67], v[116:119]
 v_mfma_f32_16x16x32_bf16 v[120:123], v[48:51], a[128:131], 0
 ds_read_b64_tr_b16 v[44:45], v8 offset:28672
 ds_read_b128 a[24:27], v18 offset:16384
 v_mfma_f32_16x16x32_bf16 v[120:123], v[52:55], a[132:135], v[120:123]
 ds_read_b64_tr_b16 v[46:47], v8 offset:29184
 v_mfma_f32_16x16x32_bf16 v[120:123], v[56:59], a[136:139], v[120:123]
 v_mfma_f32_16x16x32_bf16 v[120:123], v[60:63], a[140:143], v[120:123]
 ds_read_b128 a[28:31], v19 offset:16384
 v_mfma_f32_16x16x32_bf16 v[124:127], v[60:63], a[204:207], 0
 v_mfma_f32_16x16x32_bf16 v[124:127], v[56:59], a[200:203], v[124:127]
 v_mfma_f32_16x16x32_bf16 v[124:127], v[52:55], a[196:199], v[124:127]
 v_mfma_f32_16x16x32_bf16 v[124:127], v[48:51], a[192:195], v[124:127]
 s_waitcnt lgkmcnt(8)
 v_mfma_f32_16x16x32_bf16 v[128:131], v[32:35], a[0:3], 0
 ds_read_b64_tr_b16 v[48:49], v9 offset:16384
 v_mfma_f32_16x16x32_bf16 v[128:131], v[36:39], a[4:7], v[128:131]
 s_waitcnt lgkmcnt(6)
 ds_read_b64_tr_b16 v[50:51], v9 offset:16896
 v_mfma_f32_16x16x32_bf16 v[128:131], v[40:43], a[8:11], v[128:131]
 s_waitcnt lgkmcnt(3)
 ds_read_b64_tr_b16 v[52:53], v9 offset:20480
 v_mfma_f32_16x16x32_bf16 v[128:131], v[44:47], a[12:15], v[128:131]
 s_add_u32 m0, s5, 8192
 ds_read_b64_tr_b16 v[54:55], v9 offset:20992
 v_mfma_f32_16x16x32_bf16 v[132:135], v[44:47], a[76:79], 0
 s_mov_b32 s4, 512
 buffer_load_dwordx4 v12, s[8:11], s4 offen offset:0 lds
 v_mfma_f32_16x16x32_bf16 v[132:135], v[40:43], a[72:75], v[132:135]
 buffer_load_dwordx4 v13, s[8:11], s4 offen offset:1024 lds
 v_mfma_f32_16x16x32_bf16 v[132:135], v[36:39], a[68:71], v[132:135]
 buffer_load_dwordx4 v14, s[8:11], s4 offen offset:2048 lds
 v_mfma_f32_16x16x32_bf16 v[132:135], v[32:35], a[64:67], v[132:135]
 ds_read_b64_tr_b16 v[56:57], v9 offset:24576
 ds_read_b64_tr_b16 v[58:59], v9 offset:25088
 v_mfma_f32_16x16x32_bf16 v[136:139], v[32:35], a[128:131], 0
 s_waitcnt vmcnt(15)
 buffer_load_dwordx4 v15, s[8:11], s4 offen offset:3072 lds
 v_mfma_f32_16x16x32_bf16 v[136:139], v[36:39], a[132:135], v[136:139]
 v_lshlrev_b32 v200, 16, v192
 v_and_b32 v201, 0xffff0000, v192
 v_mfma_f32_16x16x32_bf16 v[136:139], v[40:43], a[136:139], v[136:139]
 s_add_u32 m0, s5, 12288
 v_lshlrev_b32 v202, 16, v193
 v_and_b32 v203, 0xffff0000, v193
 v_mfma_f32_16x16x32_bf16 v[136:139], v[44:47], a[140:143], v[136:139]
 ds_read_b64_tr_b16 v[60:61], v9 offset:28672
 v_lshlrev_b32 v204, 16, v194
 ds_read_b64_tr_b16 v[62:63], v9 offset:29184
 v_mfma_f32_16x16x32_bf16 v[140:143], v[44:47], a[204:207], 0
 s_mov_b32 s4, 16896
 v_and_b32 v205, 0xffff0000, v194
 v_lshlrev_b32 v206, 16, v195
 v_mfma_f32_16x16x32_bf16 v[140:143], v[40:43], a[200:203], v[140:143]
 buffer_load_dwordx4 v12, s[8:11], s4 offen offset:0 lds
 v_mfma_f32_16x16x32_bf16 v[140:143], v[36:39], a[196:199], v[140:143]
 buffer_load_dwordx4 v13, s[8:11], s4 offen offset:1024 lds
 v_mfma_f32_16x16x32_bf16 v[140:143], v[32:35], a[192:195], v[140:143]
 s_waitcnt lgkmcnt(4)
 v_and_b32 v207, 0xffff0000, v195
 v_lshlrev_b32 v208, 16, v196
 v_mfma_f32_16x16x32_bf16 v[144:147], v[48:51], a[0:3], 0
 buffer_load_dwordx4 v14, s[8:11], s4 offen offset:2048 lds
 v_mfma_f32_16x16x32_bf16 v[144:147], v[52:55], a[4:7], v[144:147]
 s_waitcnt lgkmcnt(2)
 buffer_load_dwordx4 v15, s[8:11], s4 offen offset:3072 lds
 v_mfma_f32_16x16x32_bf16 v[144:147], v[56:59], a[8:11], v[144:147]
 s_waitcnt lgkmcnt(0)
 ds_read_b64_tr_b16 v[32:33], v10 offset:16384
 v_mfma_f32_16x16x32_bf16 v[144:147], v[60:63], a[12:15], v[144:147]
 s_add_u32 m0, s58, 49152
 ds_read_b64_tr_b16 v[34:35], v10 offset:16896
 v_mfma_f32_16x16x32_bf16 v[148:151], v[60:63], a[76:79], 0
 s_mov_b32 s4, 1048704
 v_and_b32 v209, 0xffff0000, v196
 v_lshlrev_b32 v210, 16, v197
 v_mfma_f32_16x16x32_bf16 v[148:151], v[56:59], a[72:75], v[148:151]
 buffer_load_dwordx4 v4, s[12:15], s4 offen offset:0 lds
 v_mfma_f32_16x16x32_bf16 v[148:151], v[52:55], a[68:71], v[148:151]
 buffer_load_dwordx4 v5, s[12:15], s4 offen offset:1024 lds
 v_mfma_f32_16x16x32_bf16 v[148:151], v[48:51], a[64:67], v[148:151]
 ds_read_b64_tr_b16 v[36:37], v10 offset:20480
 ds_read_b64_tr_b16 v[38:39], v10 offset:20992
 v_mfma_f32_16x16x32_bf16 v[152:155], v[48:51], a[128:131], 0
 buffer_load_dwordx4 v6, s[12:15], s4 offen offset:2048 lds
 v_mfma_f32_16x16x32_bf16 v[152:155], v[52:55], a[132:135], v[152:155]
 buffer_load_dwordx4 v7, s[12:15], s4 offen offset:3072 lds
 v_mfma_f32_16x16x32_bf16 v[152:155], v[56:59], a[136:139], v[152:155]
 ds_read_b64_tr_b16 v[40:41], v10 offset:24576
 v_mfma_f32_16x16x32_bf16 v[152:155], v[60:63], a[140:143], v[152:155]
 ds_read_b64_tr_b16 v[42:43], v10 offset:25088
 v_and_b32 v211, 0xffff0000, v197
 ds_read_b64_tr_b16 v[44:45], v10 offset:28672
 ds_read_b64_tr_b16 v[46:47], v10 offset:29184
 v_mfma_f32_16x16x32_bf16 v[156:159], v[60:63], a[204:207], 0
 ds_read_b128 a[80:83], v16 offset:20480
 v_lshlrev_b32 v212, 16, v198
 v_mfma_f32_16x16x32_bf16 v[156:159], v[56:59], a[200:203], v[156:159]
 ds_read_b128 a[84:87], v17 offset:20480
 v_and_b32 v213, 0xffff0000, v198
 v_mfma_f32_16x16x32_bf16 v[156:159], v[52:55], a[196:199], v[156:159]
 ds_read_b128 a[88:91], v18 offset:20480
 v_lshlrev_b32 v214, 16, v199
 v_mfma_f32_16x16x32_bf16 v[156:159], v[48:51], a[192:195], v[156:159]
 s_waitcnt lgkmcnt(9)
 v_and_b32 v215, 0xffff0000, v199
 v_add_f32 v2, v200, v201
 v_mfma_f32_16x16x32_bf16 v[160:163], v[32:35], a[0:3], 0
 s_waitcnt lgkmcnt(7)
 v_add_f32 v2, v2, v202
 v_add_f32 v2, v2, v203
 v_mfma_f32_16x16x32_bf16 v[160:163], v[36:39], a[4:7], v[160:163]
 s_waitcnt lgkmcnt(5)
 v_add_f32 v2, v2, v204
 v_add_f32 v2, v2, v205
 v_mfma_f32_16x16x32_bf16 v[160:163], v[40:43], a[8:11], v[160:163]
 s_waitcnt lgkmcnt(3)
 ds_read_b64_tr_b16 v[48:49], v11 offset:16384
 v_mfma_f32_16x16x32_bf16 v[160:163], v[44:47], a[12:15], v[160:163]
 ds_read_b128 a[92:95], v19 offset:20480
 v_add_f32 v2, v2, v206
 v_mfma_f32_16x16x32_bf16 v[164:167], v[44:47], a[76:79], 0
 s_waitcnt vmcnt(20)
 ds_read_b64_tr_b16 v[50:51], v11 offset:16896
 v_mfma_f32_16x16x32_bf16 v[164:167], v[40:43], a[72:75], v[164:167]
 ds_read_b128 a[144:147], v16 offset:0
 v_add_f32 v2, v2, v207
 v_mfma_f32_16x16x32_bf16 v[164:167], v[36:39], a[68:71], v[164:167]
 ds_read_b64_tr_b16 v[52:53], v11 offset:20480
 v_add_f32 v2, v2, v208
 v_mfma_f32_16x16x32_bf16 v[164:167], v[32:35], a[64:67], v[164:167]
 ds_read_b64_tr_b16 v[54:55], v11 offset:20992
 ds_read_b128 a[148:151], v17 offset:0
 v_mfma_f32_16x16x32_bf16 v[168:171], v[32:35], a[128:131], 0
 ds_read_b128 a[152:155], v18 offset:0
 v_add_f32 v2, v2, v209
 v_mfma_f32_16x16x32_bf16 v[168:171], v[36:39], a[132:135], v[168:171]
 ds_read_b64_tr_b16 v[56:57], v11 offset:24576
 ds_read_b128 a[156:159], v19 offset:0
 v_mfma_f32_16x16x32_bf16 v[168:171], v[40:43], a[136:139], v[168:171]
 s_waitcnt vmcnt(16)
 ds_read_b64_tr_b16 v[58:59], v11 offset:25088
 v_mfma_f32_16x16x32_bf16 v[168:171], v[44:47], a[140:143], v[168:171]
 ds_read_b64_tr_b16 v[60:61], v11 offset:28672
 v_add_f32 v2, v2, v210
 ds_read_b64_tr_b16 v[62:63], v11 offset:29184
 v_mfma_f32_16x16x32_bf16 v[172:175], v[44:47], a[204:207], 0
 ds_read_b128 a[208:211], v16 offset:4096
 v_add_f32 v2, v2, v211
 v_mfma_f32_16x16x32_bf16 v[172:175], v[40:43], a[200:203], v[172:175]
 ds_read_b128 a[212:215], v17 offset:4096
 v_add_f32 v2, v2, v212
 v_mfma_f32_16x16x32_bf16 v[172:175], v[36:39], a[196:199], v[172:175]
 ds_read_b128 a[216:219], v18 offset:4096
 v_add_f32 v2, v2, v213
 ds_read_b128 a[220:223], v19 offset:4096
 v_mfma_f32_16x16x32_bf16 v[172:175], v[32:35], a[192:195], v[172:175]
 s_waitcnt lgkmcnt(14)
 s_waitcnt vmcnt(12)
 s_barrier
 v_mfma_f32_16x16x32_bf16 v[176:179], v[48:51], a[0:3], 0
 s_waitcnt lgkmcnt(11)
 v_add_f32 v2, v2, v214
 v_add_f32 v2, v2, v215
 v_mfma_f32_16x16x32_bf16 v[176:179], v[52:55], a[4:7], v[176:179]
 s_waitcnt lgkmcnt(6)
 v_add_f32_dpp v2, v2, v2 quad_perm:[2,3,0,1] row_mask:0xf bank_mask:0xf
 s_nop 1
 v_add_f32_dpp v2, v2, v2 row_ror:4 row_mask:0xf bank_mask:0xf
 v_mfma_f32_16x16x32_bf16 v[176:179], v[56:59], a[8:11], v[176:179]
 s_waitcnt lgkmcnt(4)
 ds_read_b64_tr_b16 v[32:33], v8 offset:32768
 v_mfma_f32_16x16x32_bf16 v[176:179], v[60:63], a[12:15], v[176:179]
 s_add_u32 m0, s58, 0
 ds_read_b64_tr_b16 v[34:35], v8 offset:33280
 v_mfma_f32_16x16x32_bf16 v[180:183], v[60:63], a[76:79], 0
 s_mov_b32 s4, 2097152
 v_add_f32_dpp v2, v2, v2 row_ror:8 row_mask:0xf bank_mask:0xf
 v_mov_b32 v3, v2
 v_mfma_f32_16x16x32_bf16 v[180:183], v[56:59], a[72:75], v[180:183]
 buffer_load_dwordx4 v4, s[12:15], s4 offen offset:0 lds
 v_mfma_f32_16x16x32_bf16 v[180:183], v[52:55], a[68:71], v[180:183]
 ds_read_b64_tr_b16 v[36:37], v8 offset:36864
 v_permlane16_swap_b32 v2, v3
 v_mfma_f32_16x16x32_bf16 v[180:183], v[48:51], a[64:67], v[180:183]
 buffer_load_dwordx4 v5, s[12:15], s4 offen offset:1024 lds
 v_mfma_f32_16x16x32_bf16 v[184:187], v[48:51], a[128:131], 0
 ds_read_b64_tr_b16 v[38:39], v8 offset:37376
 v_add_f32 v2, v2, v3
 v_mfma_f32_16x16x32_bf16 v[184:187], v[52:55], a[132:135], v[184:187]
 ds_read_b64_tr_b16 v[40:41], v8 offset:40960
 v_mov_b32 v3, v2
 v_mfma_f32_16x16x32_bf16 v[184:187], v[56:59], a[136:139], v[184:187]
 buffer_load_dwordx4 v6, s[12:15], s4 offen offset:2048 lds
 v_mfma_f32_16x16x32_bf16 v[184:187], v[60:63], a[140:143], v[184:187]
 ds_read_b64_tr_b16 v[42:43], v8 offset:41472
 v_permlane32_swap_b32 v2, v3
 ds_read_b64_tr_b16 v[44:45], v8 offset:45056
 ds_read_b64_tr_b16 v[46:47], v8 offset:45568
 v_mfma_f32_16x16x32_bf16 v[188:191], v[60:63], a[204:207], 0
 buffer_load_dwordx4 v7, s[12:15], s4 offen offset:3072 lds
 v_mfma_f32_16x16x32_bf16 v[188:191], v[56:59], a[200:203], v[188:191]
 v_add_f32 v2, v2, v3
 v_mul_f32 v2, 0x3b000000, v2
 v_mfma_f32_16x16x32_bf16 v[188:191], v[52:55], a[196:199], v[188:191]
 v_sub_f32 v3, v200, v2
 v_mul_f32 v27, v3, v3
 v_mfma_f32_16x16x32_bf16 v[188:191], v[48:51], a[192:195], v[188:191]
 v_sub_f32 v3, v201, v2
 v_fmac_f32 v27, v3, v3
 v_sub_f32 v3, v202, v2
 v_fmac_f32 v27, v3, v3
 v_sub_f32 v3, v203, v2
 v_fmac_f32 v27, v3, v3
 v_sub_f32 v3, v204, v2
 v_fmac_f32 v27, v3, v3
 v_sub_f32 v3, v205, v2
 v_fmac_f32 v27, v3, v3
 v_sub_f32 v3, v206, v2
 v_fmac_f32 v27, v3, v3
 v_sub_f32 v3, v207, v2
 v_fmac_f32 v27, v3, v3
 v_sub_f32 v3, v208, v2
 v_fmac_f32 v27, v3, v3
 v_sub_f32 v3, v209, v2
 v_fmac_f32 v27, v3, v3
 s_waitcnt lgkmcnt(6)
 v_mfma_f32_16x16x32_bf16 v[64:67], v[32:35], a[16:19], v[64:67]
 s_waitcnt lgkmcnt(4)
 v_sub_f32 v3, v210, v2
 v_fmac_f32 v27, v3, v3
 v_mfma_f32_16x16x32_bf16 v[64:67], v[36:39], a[20:23], v[64:67]
 s_waitcnt lgkmcnt(2)
 v_sub_f32 v3, v211, v2
 v_fmac_f32 v27, v3, v3
 v_mfma_f32_16x16x32_bf16 v[64:67], v[40:43], a[24:27], v[64:67]
 s_waitcnt lgkmcnt(0)
 ds_read_b64_tr_b16 v[48:49], v9 offset:32768
 v_mfma_f32_16x16x32_bf16 v[64:67], v[44:47], a[28:31], v[64:67]
 ds_read_b64_tr_b16 v[50:51], v9 offset:33280
 v_mfma_f32_16x16x32_bf16 v[68:71], v[44:47], a[92:95], v[68:71]
 s_add_u32 m0, s5, 16384
 v_sub_f32 v3, v212, v2
 v_fmac_f32 v27, v3, v3
 v_mfma_f32_16x16x32_bf16 v[68:71], v[40:43], a[88:91], v[68:71]
 s_mov_b32 s4, 33280
 ds_read_b64_tr_b16 v[52:53], v9 offset:36864
 v_mfma_f32_16x16x32_bf16 v[68:71], v[36:39], a[84:87], v[68:71]
 ds_read_b64_tr_b16 v[54:55], v9 offset:37376
 v_sub_f32 v3, v213, v2
 v_mfma_f32_16x16x32_bf16 v[68:71], v[32:35], a[80:83], v[68:71]
 buffer_load_dwordx4 v12, s[8:11], s4 offen offset:0 lds
 v_mfma_f32_16x16x32_bf16 v[72:75], v[32:35], a[144:147], v[72:75]
 buffer_load_dwordx4 v13, s[8:11], s4 offen offset:1024 lds
 v_mfma_f32_16x16x32_bf16 v[72:75], v[36:39], a[148:151], v[72:75]
 ds_read_b64_tr_b16 v[56:57], v9 offset:40960
 v_fmac_f32 v27, v3, v3
 v_mfma_f32_16x16x32_bf16 v[72:75], v[40:43], a[152:155], v[72:75]
 buffer_load_dwordx4 v14, s[8:11], s4 offen offset:2048 lds
 v_mfma_f32_16x16x32_bf16 v[72:75], v[44:47], a[156:159], v[72:75]
 ds_read_b64_tr_b16 v[58:59], v9 offset:41472
 v_sub_f32 v3, v214, v2
 ds_read_b64_tr_b16 v[60:61], v9 offset:45056
 ds_read_b64_tr_b16 v[62:63], v9 offset:45568
 v_mfma_f32_16x16x32_bf16 v[76:79], v[44:47], a[220:223], v[76:79]
 buffer_load_dwordx4 v15, s[8:11], s4 offen offset:3072 lds
 v_mfma_f32_16x16x32_bf16 v[76:79], v[40:43], a[216:219], v[76:79]
 v_fmac_f32 v27, v3, v3
 v_sub_f32 v3, v215, v2
 v_mfma_f32_16x16x32_bf16 v[76:79], v[36:39], a[212:215], v[76:79]
 v_fmac_f32 v27, v3, v3
 s_nop 1
 v_add_f32_dpp v27, v27, v27 quad_perm:[2,3,0,1] row_mask:0xf bank_mask:0xf
 v_mfma_f32_16x16x32_bf16 v[76:79], v[32:35], a[208:211], v[76:79]
 s_waitcnt lgkmcnt(6)
 v_add_f32_dpp v27, v27, v27 row_ror:4 row_mask:0xf bank_mask:0xf
 s_nop 1
 v_add_f32_dpp v27, v27, v27 row_ror:8 row_mask:0xf bank_mask:0xf
 v_mfma_f32_16x16x32_bf16 v[80:83], v[48:51], a[16:19], v[80:83]
 s_waitcnt lgkmcnt(4)
 v_mov_b32 v3, v27
 s_nop 1
 v_permlane16_swap_b32 v27, v3
 v_mfma_f32_16x16x32_bf16 v[80:83], v[52:55], a[20:23], v[80:83]
 s_waitcnt lgkmcnt(2)
 v_add_f32 v27, v27, v3
 v_mov_b32 v3, v27
 v_mfma_f32_16x16x32_bf16 v[80:83], v[56:59], a[24:27], v[80:83]
 s_waitcnt lgkmcnt(0)
 ds_read_b64_tr_b16 v[32:33], v10 offset:32768
 v_mfma_f32_16x16x32_bf16 v[80:83], v[60:63], a[28:31], v[80:83]
 s_add_u32 m0, s5, 20480
 ds_read_b64_tr_b16 v[34:35], v10 offset:33280
 v_mfma_f32_16x16x32_bf16 v[84:87], v[60:63], a[92:95], v[84:87]
 s_mov_b32 s4, 49664
 buffer_load_dwordx4 v12, s[8:11], s4 offen offset:0 lds
 v_mfma_f32_16x16x32_bf16 v[84:87], v[56:59], a[88:91], v[84:87]
 buffer_load_dwordx4 v13, s[8:11], s4 offen offset:1024 lds
 v_mfma_f32_16x16x32_bf16 v[84:87], v[52:55], a[84:87], v[84:87]
 buffer_load_dwordx4 v14, s[8:11], s4 offen offset:2048 lds
 v_mfma_f32_16x16x32_bf16 v[84:87], v[48:51], a[80:83], v[84:87]
 ds_read_b64_tr_b16 v[36:37], v10 offset:36864
 ds_read_b64_tr_b16 v[38:39], v10 offset:37376
 v_mfma_f32_16x16x32_bf16 v[88:91], v[48:51], a[144:147], v[88:91]
 buffer_load_dwordx4 v15, s[8:11], s4 offen offset:3072 lds
 v_mfma_f32_16x16x32_bf16 v[88:91], v[52:55], a[148:151], v[88:91]
 ds_read_b64_tr_b16 v[40:41], v10 offset:40960
 v_permlane32_swap_b32 v27, v3
 v_mfma_f32_16x16x32_bf16 v[88:91], v[56:59], a[152:155], v[88:91]
 ds_read_b64_tr_b16 v[42:43], v10 offset:41472
 v_mfma_f32_16x16x32_bf16 v[88:91], v[60:63], a[156:159], v[88:91]
 s_add_u32 m0, s5, 0
 ds_read_b64_tr_b16 v[44:45], v10 offset:45056
 ds_read_b64_tr_b16 v[46:47], v10 offset:45568
 v_mfma_f32_16x16x32_bf16 v[92:95], v[60:63], a[220:223], v[92:95]
 v_add_f32 v27, v27, v3
 v_mul_f32 v27, 0x3b000000, v27
 v_mfma_f32_16x16x32_bf16 v[92:95], v[56:59], a[216:219], v[92:95]
 s_mov_b32 s4, 768
 v_cvt_pk_bf16_f32 v2, v2, v27
 v_and_b32 v27, 0xffff0000, v2
 v_mfma_f32_16x16x32_bf16 v[92:95], v[52:55], a[212:215], v[92:95]
 v_lshlrev_b32 v2, 16, v2
 v_add_f32 v27, 0x3727c5ac, v27
 v_mfma_f32_16x16x32_bf16 v[92:95], v[48:51], a[208:211], v[92:95]
 s_waitcnt lgkmcnt(6)
 buffer_load_dwordx4 v12, s[8:11], s4 offen offset:0 lds
 v_mfma_f32_16x16x32_bf16 v[96:99], v[32:35], a[16:19], v[96:99]
 s_waitcnt lgkmcnt(4)
 v_cvt_pk_bf16_f32 v27, v27, v27
 v_lshlrev_b32 v27, 16, v27
 v_mfma_f32_16x16x32_bf16 v[96:99], v[36:39], a[20:23], v[96:99]
 s_waitcnt lgkmcnt(2)
 buffer_load_dwordx4 v13, s[8:11], s4 offen offset:1024 lds
 v_mfma_f32_16x16x32_bf16 v[96:99], v[40:43], a[24:27], v[96:99]
 s_waitcnt lgkmcnt(0)
 buffer_load_dwordx4 v14, s[8:11], s4 offen offset:2048 lds
 v_mfma_f32_16x16x32_bf16 v[96:99], v[44:47], a[28:31], v[96:99]
 ds_read_b64_tr_b16 v[48:49], v11 offset:32768
 v_sqrt_f32 v27, v27
 v_mfma_f32_16x16x32_bf16 v[100:103], v[44:47], a[92:95], v[100:103]
 buffer_load_dwordx4 v15, s[8:11], s4 offen offset:3072 lds
 v_mfma_f32_16x16x32_bf16 v[100:103], v[40:43], a[88:91], v[100:103]
 ds_read_b64_tr_b16 v[50:51], v11 offset:33280
 v_cvt_pk_bf16_f32 v27, v27, v27
 v_mfma_f32_16x16x32_bf16 v[100:103], v[36:39], a[84:87], v[100:103]
 s_waitcnt vmcnt(24)
 ds_read_b64_tr_b16 v[52:53], v11 offset:36864
 v_mfma_f32_16x16x32_bf16 v[100:103], v[32:35], a[80:83], v[100:103]
 ds_read_b64_tr_b16 v[54:55], v11 offset:37376
 v_lshlrev_b32 v27, 16, v27
 v_mfma_f32_16x16x32_bf16 v[104:107], v[32:35], a[144:147], v[104:107]
 ds_read_b64_tr_b16 v[56:57], v11 offset:40960
 v_rcp_f32 v27, v27
 v_mfma_f32_16x16x32_bf16 v[104:107], v[36:39], a[148:151], v[104:107]
 ds_read_b64_tr_b16 v[58:59], v11 offset:41472
 v_sub_f32 v200, v200, v2
 v_mfma_f32_16x16x32_bf16 v[104:107], v[40:43], a[152:155], v[104:107]
 ds_read_b128 a[32:35], v16 offset:8192
 v_sub_f32 v201, v201, v2
 v_mfma_f32_16x16x32_bf16 v[104:107], v[44:47], a[156:159], v[104:107]
 ds_read_b64_tr_b16 v[60:61], v11 offset:45056
 v_cvt_pk_bf16_f32 v192, v200, v201
 ds_read_b64_tr_b16 v[62:63], v11 offset:45568
 v_mfma_f32_16x16x32_bf16 v[108:111], v[44:47], a[220:223], v[108:111]
 ds_read_b128 a[36:39], v17 offset:8192
 v_lshlrev_b32 v200, 16, v192
 v_mfma_f32_16x16x32_bf16 v[108:111], v[40:43], a[216:219], v[108:111]
 ds_read_b128 a[40:43], v18 offset:8192
 v_and_b32 v201, 0xffff0000, v192
 v_mfma_f32_16x16x32_bf16 v[108:111], v[36:39], a[212:215], v[108:111]
 ds_read_b128 a[44:47], v19 offset:8192
 v_mul_f32 v200, v200, v27
 v_mfma_f32_16x16x32_bf16 v[108:111], v[32:35], a[208:211], v[108:111]
 s_waitcnt lgkmcnt(10)
 s_waitcnt vmcnt(16)
 s_barrier
 v_mfma_f32_16x16x32_bf16 v[112:115], v[48:51], a[16:19], v[112:115]
 s_waitcnt lgkmcnt(8)
 v_mul_f32 v201, v201, v27
 v_cvt_pk_bf16_f32 v192, v200, v201
 v_mfma_f32_16x16x32_bf16 v[112:115], v[52:55], a[20:23], v[112:115]
 s_waitcnt lgkmcnt(6)
 v_sub_f32 v202, v202, v2
 v_sub_f32 v203, v203, v2
 v_mfma_f32_16x16x32_bf16 v[112:115], v[56:59], a[24:27], v[112:115]
 s_waitcnt lgkmcnt(3)
 ds_read_b64_tr_b16 v[32:33], v8 offset:49152
 v_mfma_f32_16x16x32_bf16 v[112:115], v[60:63], a[28:31], v[112:115]
 s_add_u32 m0, s58, 16384
 ds_read_b64_tr_b16 v[34:35], v8 offset:49664
 v_mfma_f32_16x16x32_bf16 v[116:119], v[60:63], a[92:95], v[116:119]
 s_mov_b32 s4, 2097280
 v_cvt_pk_bf16_f32 v193, v202, v203
 v_lshlrev_b32 v202, 16, v193
 v_mfma_f32_16x16x32_bf16 v[116:119], v[56:59], a[88:91], v[116:119]
 buffer_load_dwordx4 v4, s[12:15], s4 offen offset:0 lds
 v_mfma_f32_16x16x32_bf16 v[116:119], v[52:55], a[84:87], v[116:119]
 ds_read_b64_tr_b16 v[36:37], v8 offset:53248
 v_and_b32 v203, 0xffff0000, v193
 v_mfma_f32_16x16x32_bf16 v[116:119], v[48:51], a[80:83], v[116:119]
 buffer_load_dwordx4 v5, s[12:15], s4 offen offset:1024 lds
 v_mfma_f32_16x16x32_bf16 v[120:123], v[48:51], a[144:147], v[120:123]
 ds_read_b64_tr_b16 v[38:39], v8 offset:53760
 v_mul_f32 v202, v202, v27
 v_mfma_f32_16x16x32_bf16 v[120:123], v[52:55], a[148:151], v[120:123]
 ds_read_b64_tr_b16 v[40:41], v8 offset:57344
 v_mul_f32 v203, v203, v27
 v_mfma_f32_16x16x32_bf16 v[120:123], v[56:59], a[152:155], v[120:123]
 buffer_load_dwordx4 v6, s[12:15], s4 offen offset:2048 lds
 v_mfma_f32_16x16x32_bf16 v[120:123], v[60:63], a[156:159], v[120:123]
 ds_read_b64_tr_b16 v[42:43], v8 offset:57856
 v_cvt_pk_bf16_f32 v193, v202, v203
 ds_read_b64_tr_b16 v[44:45], v8 offset:61440
 ds_read_b64_tr_b16 v[46:47], v8 offset:61952
 v_mfma_f32_16x16x32_bf16 v[124:127], v[60:63], a[220:223], v[124:127]
 buffer_load_dwordx4 v7, s[12:15], s4 offen offset:3072 lds
 v_mfma_f32_16x16x32_bf16 v[124:127], v[56:59], a[216:219], v[124:127]
 v_sub_f32 v204, v204, v2
 v_sub_f32 v205, v205, v2
 v_mfma_f32_16x16x32_bf16 v[124:127], v[52:55], a[212:215], v[124:127]
 v_cvt_pk_bf16_f32 v194, v204, v205
 v_lshlrev_b32 v204, 16, v194
 v_mfma_f32_16x16x32_bf16 v[124:127], v[48:51], a[208:211], v[124:127]
 v_and_b32 v205, 0xffff0000, v194
 v_mul_f32 v204, v204, v27
 v_mul_f32 v205, v205, v27
 v_cvt_pk_bf16_f32 v194, v204, v205
 v_sub_f32 v206, v206, v2
 v_sub_f32 v207, v207, v2
 v_cvt_pk_bf16_f32 v195, v206, v207
 v_lshlrev_b32 v206, 16, v195
 v_and_b32 v207, 0xffff0000, v195
 v_mul_f32 v206, v206, v27
 s_waitcnt lgkmcnt(6)
 v_mfma_f32_16x16x32_bf16 v[128:131], v[32:35], a[16:19], v[128:131]
 s_waitcnt lgkmcnt(4)
 v_mul_f32 v207, v207, v27
 v_cvt_pk_bf16_f32 v195, v206, v207
 v_mfma_f32_16x16x32_bf16 v[128:131], v[36:39], a[20:23], v[128:131]
 s_waitcnt lgkmcnt(2)
 v_sub_f32 v208, v208, v2
 v_sub_f32 v209, v209, v2
 v_mfma_f32_16x16x32_bf16 v[128:131], v[40:43], a[24:27], v[128:131]
 s_waitcnt lgkmcnt(0)
 ds_read_b64_tr_b16 v[48:49], v9 offset:49152
 v_mfma_f32_16x16x32_bf16 v[128:131], v[44:47], a[28:31], v[128:131]
 ds_read_b64_tr_b16 v[50:51], v9 offset:49664
 v_mfma_f32_16x16x32_bf16 v[132:135], v[44:47], a[92:95], v[132:135]
 s_add_u32 m0, s5, 4096
 v_cvt_pk_bf16_f32 v196, v208, v209
 v_lshlrev_b32 v208, 16, v196
 v_mfma_f32_16x16x32_bf16 v[132:135], v[40:43], a[88:91], v[132:135]
 s_mov_b32 s4, 17152
 ds_read_b64_tr_b16 v[52:53], v9 offset:53248
 v_mfma_f32_16x16x32_bf16 v[132:135], v[36:39], a[84:87], v[132:135]
 buffer_load_dwordx4 v12, s[8:11], s4 offen offset:0 lds
 v_mfma_f32_16x16x32_bf16 v[132:135], v[32:35], a[80:83], v[132:135]
 buffer_load_dwordx4 v13, s[8:11], s4 offen offset:1024 lds
 v_mfma_f32_16x16x32_bf16 v[136:139], v[32:35], a[144:147], v[136:139]
 ds_read_b64_tr_b16 v[54:55], v9 offset:53760
 v_and_b32 v209, 0xffff0000, v196
 v_mfma_f32_16x16x32_bf16 v[136:139], v[36:39], a[148:151], v[136:139]
 buffer_load_dwordx4 v14, s[8:11], s4 offen offset:2048 lds
 v_mfma_f32_16x16x32_bf16 v[136:139], v[40:43], a[152:155], v[136:139]
 buffer_load_dwordx4 v15, s[8:11], s4 offen offset:3072 lds
 v_mfma_f32_16x16x32_bf16 v[136:139], v[44:47], a[156:159], v[136:139]
 ds_read_b64_tr_b16 v[56:57], v9 offset:57344
 ds_read_b64_tr_b16 v[58:59], v9 offset:57856
 ds_read_b64_tr_b16 v[60:61], v9 offset:61440
 ds_read_b64_tr_b16 v[62:63], v9 offset:61952
 v_mfma_f32_16x16x32_bf16 v[140:143], v[44:47], a[220:223], v[140:143]
 v_mul_f32 v208, v208, v27
 v_mul_f32 v209, v209, v27
 v_mfma_f32_16x16x32_bf16 v[140:143], v[40:43], a[216:219], v[140:143]
 ds_read_b128 a[96:99], v16 offset:12288
 v_cvt_pk_bf16_f32 v196, v208, v209
 v_mfma_f32_16x16x32_bf16 v[140:143], v[36:39], a[212:215], v[140:143]
 ds_read_b128 a[100:103], v17 offset:12288
 v_sub_f32 v210, v210, v2
 v_mfma_f32_16x16x32_bf16 v[140:143], v[32:35], a[208:211], v[140:143]
 s_waitcnt lgkmcnt(8)
 v_sub_f32 v211, v211, v2
 v_cvt_pk_bf16_f32 v197, v210, v211
 v_mfma_f32_16x16x32_bf16 v[144:147], v[48:51], a[16:19], v[144:147]
 s_waitcnt lgkmcnt(6)
 v_lshlrev_b32 v210, 16, v197
 v_and_b32 v211, 0xffff0000, v197
 v_mfma_f32_16x16x32_bf16 v[144:147], v[52:55], a[20:23], v[144:147]
 s_waitcnt lgkmcnt(4)
 v_mul_f32 v210, v210, v27
 v_mfma_f32_16x16x32_bf16 v[144:147], v[56:59], a[24:27], v[144:147]
 s_waitcnt lgkmcnt(2)
 ds_read_b64_tr_b16 v[32:33], v10 offset:49152
 v_mfma_f32_16x16x32_bf16 v[144:147], v[60:63], a[28:31], v[144:147]
 ds_read_b128 a[104:107], v18 offset:12288
 v_mul_f32 v211, v211, v27
 v_mfma_f32_16x16x32_bf16 v[148:151], v[60:63], a[92:95], v[148:151]
 ds_read_b64_tr_b16 v[34:35], v10 offset:49664
 v_cvt_pk_bf16_f32 v197, v210, v211
 v_mfma_f32_16x16x32_bf16 v[148:151], v[56:59], a[88:91], v[148:151]
 ds_read_b128 a[108:111], v19 offset:12288
 v_sub_f32 v212, v212, v2
 v_mfma_f32_16x16x32_bf16 v[148:151], v[52:55], a[84:87], v[148:151]
 ds_read_b64_tr_b16 v[36:37], v10 offset:53248
 v_mfma_f32_16x16x32_bf16 v[148:151], v[48:51], a[80:83], v[148:151]
 s_add_u32 m0, s5, 8192
 ds_read_b64_tr_b16 v[38:39], v10 offset:53760
 v_mfma_f32_16x16x32_bf16 v[152:155], v[48:51], a[144:147], v[152:155]
 s_mov_b32 s4, 33536
 buffer_load_dwordx4 v12, s[8:11], s4 offen offset:0 lds
 v_mfma_f32_16x16x32_bf16 v[152:155], v[52:55], a[148:151], v[152:155]
 buffer_load_dwordx4 v13, s[8:11], s4 offen offset:1024 lds
 v_mfma_f32_16x16x32_bf16 v[152:155], v[56:59], a[152:155], v[152:155]
 ds_read_b64_tr_b16 v[40:41], v10 offset:57344
 ds_read_b64_tr_b16 v[42:43], v10 offset:57856
 v_mfma_f32_16x16x32_bf16 v[152:155], v[60:63], a[156:159], v[152:155]
 buffer_load_dwordx4 v14, s[8:11], s4 offen offset:2048 lds
 ds_read_b64_tr_b16 v[44:45], v10 offset:61440
 ds_read_b64_tr_b16 v[46:47], v10 offset:61952
 v_mfma_f32_16x16x32_bf16 v[156:159], v[60:63], a[220:223], v[156:159]
 buffer_load_dwordx4 v15, s[8:11], s4 offen offset:3072 lds
 v_mfma_f32_16x16x32_bf16 v[156:159], v[56:59], a[216:219], v[156:159]
 v_sub_f32 v213, v213, v2
 v_cvt_pk_bf16_f32 v198, v212, v213
 v_mfma_f32_16x16x32_bf16 v[156:159], v[52:55], a[212:215], v[156:159]
 s_waitcnt vmcnt(20)
 v_lshlrev_b32 v212, 16, v198
 v_and_b32 v213, 0xffff0000, v198
 v_mfma_f32_16x16x32_bf16 v[156:159], v[48:51], a[208:211], v[156:159]
 s_waitcnt lgkmcnt(6)
 v_mul_f32 v212, v212, v27
 v_mul_f32 v213, v213, v27
 v_mfma_f32_16x16x32_bf16 v[160:163], v[32:35], a[16:19], v[160:163]
 s_waitcnt lgkmcnt(4)
 v_cvt_pk_bf16_f32 v198, v212, v213
 v_sub_f32 v214, v214, v2
 v_mfma_f32_16x16x32_bf16 v[160:163], v[36:39], a[20:23], v[160:163]
 s_waitcnt lgkmcnt(2)
 ds_read_b128 a[160:163], v16 offset:16384
 v_mfma_f32_16x16x32_bf16 v[160:163], v[40:43], a[24:27], v[160:163]
 s_waitcnt lgkmcnt(1)
 ds_read_b64_tr_b16 v[48:49], v11 offset:49152
 v_mfma_f32_16x16x32_bf16 v[160:163], v[44:47], a[28:31], v[160:163]
 ds_read_b64_tr_b16 v[50:51], v11 offset:49664
 v_sub_f32 v215, v215, v2
 v_mfma_f32_16x16x32_bf16 v[164:167], v[44:47], a[92:95], v[164:167]
 ds_read_b128 a[164:167], v17 offset:16384
 v_cvt_pk_bf16_f32 v199, v214, v215
 v_mfma_f32_16x16x32_bf16 v[164:167], v[40:43], a[88:91], v[164:167]
 ds_read_b128 a[168:171], v18 offset:16384
 v_lshlrev_b32 v214, 16, v199
 v_mfma_f32_16x16x32_bf16 v[164:167], v[36:39], a[84:87], v[164:167]
 ds_read_b64_tr_b16 v[52:53], v11 offset:53248
 v_and_b32 v215, 0xffff0000, v199
 v_mfma_f32_16x16x32_bf16 v[164:167], v[32:35], a[80:83], v[164:167]
 ds_read_b64_tr_b16 v[54:55], v11 offset:53760
 ds_read_b128 a[172:175], v19 offset:16384
 v_mfma_f32_16x16x32_bf16 v[168:171], v[32:35], a[144:147], v[168:171]
 s_waitcnt vmcnt(16)
 ds_read_b64_tr_b16 v[56:57], v11 offset:57344
 v_mfma_f32_16x16x32_bf16 v[168:171], v[36:39], a[148:151], v[168:171]
 ds_read_b64_tr_b16 v[58:59], v11 offset:57856
 v_mul_f32 v214, v214, v27
 v_mfma_f32_16x16x32_bf16 v[168:171], v[40:43], a[152:155], v[168:171]
 ds_read_b128 a[224:227], v16 offset:20480
 v_mul_f32 v215, v215, v27
 v_mfma_f32_16x16x32_bf16 v[168:171], v[44:47], a[156:159], v[168:171]
 ds_read_b128 a[228:231], v17 offset:20480
 v_cvt_pk_bf16_f32 v199, v214, v215
 ds_read_b64_tr_b16 v[60:61], v11 offset:61440
 ds_read_b64_tr_b16 v[62:63], v11 offset:61952
 v_mfma_f32_16x16x32_bf16 v[172:175], v[44:47], a[220:223], v[172:175]
 ds_read_b128 a[232:235], v18 offset:20480
 ds_read_b128 a[236:239], v19 offset:20480
 v_mfma_f32_16x16x32_bf16 v[172:175], v[40:43], a[216:219], v[172:175]
 v_mfma_f32_16x16x32_bf16 v[172:175], v[36:39], a[212:215], v[172:175]
 v_mfma_f32_16x16x32_bf16 v[172:175], v[32:35], a[208:211], v[172:175]
 s_waitcnt lgkmcnt(13)
 s_waitcnt lgkmcnt(0)
 s_barrier
 v_mfma_f32_16x16x32_bf16 v[176:179], v[48:51], a[16:19], v[176:179]
 s_lshl_b32 s68, s3, 5
 ds_read_b64_tr_b16 v[32:33], v8 offset:0
 v_mfma_f32_16x16x32_bf16 v[176:179], v[52:55], a[20:23], v[176:179]
 s_add_u32 m0, s58, 32768
 ds_read_b64_tr_b16 v[34:35], v8 offset:512
 v_mfma_f32_16x16x32_bf16 v[176:179], v[56:59], a[24:27], v[176:179]
 s_add_u32 s68, s68, 155648
 v_and_b32 v2, 1, v0
 v_lshlrev_b32 v2, 4, v2
 v_mfma_f32_16x16x32_bf16 v[176:179], v[60:63], a[28:31], v[176:179]
 s_mov_b32 s4, 3145728
 ds_read_b64_tr_b16 v[36:37], v8 offset:4096
 v_mfma_f32_16x16x32_bf16 v[180:183], v[60:63], a[92:95], v[180:183]
 ds_read_b64_tr_b16 v[38:39], v8 offset:4608
 v_lshrrev_b32 v3, 1, v0
 v_mfma_f32_16x16x32_bf16 v[180:183], v[56:59], a[88:91], v[180:183]
 buffer_load_dwordx4 v4, s[12:15], s4 offen offset:0 lds
 v_mfma_f32_16x16x32_bf16 v[180:183], v[52:55], a[84:87], v[180:183]
 ds_read_b64_tr_b16 v[40:41], v8 offset:8192
 v_lshl_add_u32 v2, v3, 7, v2
 v_mfma_f32_16x16x32_bf16 v[180:183], v[48:51], a[80:83], v[180:183]
 buffer_load_dwordx4 v5, s[12:15], s4 offen offset:1024 lds
 v_mfma_f32_16x16x32_bf16 v[184:187], v[48:51], a[144:147], v[184:187]
 ds_read_b64_tr_b16 v[42:43], v8 offset:8704
 v_add_u32 v2, s68, v2
 v_mfma_f32_16x16x32_bf16 v[184:187], v[52:55], a[148:151], v[184:187]
 ds_read_b64_tr_b16 v[44:45], v8 offset:12288
 ds_read_b64_tr_b16 v[46:47], v8 offset:12800
 v_mfma_f32_16x16x32_bf16 v[184:187], v[56:59], a[152:155], v[184:187]
 buffer_load_dwordx4 v6, s[12:15], s4 offen offset:2048 lds
 v_mfma_f32_16x16x32_bf16 v[184:187], v[60:63], a[156:159], v[184:187]
 ds_write_b128 v2, v[192:195] offset:0
 v_mfma_f32_16x16x32_bf16 v[188:191], v[60:63], a[220:223], v[188:191]
 buffer_load_dwordx4 v7, s[12:15], s4 offen offset:3072 lds
 v_mfma_f32_16x16x32_bf16 v[188:191], v[56:59], a[216:219], v[188:191]
 ds_write_b128 v2, v[196:199] offset:4096
 v_mfma_f32_16x16x32_bf16 v[188:191], v[52:55], a[212:215], v[188:191]
 v_mfma_f32_16x16x32_bf16 v[188:191], v[48:51], a[208:211], v[188:191]
 s_waitcnt lgkmcnt(6)
 v_mfma_f32_16x16x32_bf16 v[64:67], v[32:35], a[32:35], v[64:67]
 ds_read_b64_tr_b16 v[48:49], v9 offset:0
 ds_read_b64_tr_b16 v[50:51], v9 offset:512
 v_mfma_f32_16x16x32_bf16 v[64:67], v[36:39], a[36:39], v[64:67]
 s_waitcnt lgkmcnt(6)
 v_mfma_f32_16x16x32_bf16 v[64:67], v[40:43], a[40:43], v[64:67]
 s_waitcnt lgkmcnt(4)
 ds_read_b64_tr_b16 v[52:53], v9 offset:4096
 v_mfma_f32_16x16x32_bf16 v[64:67], v[44:47], a[44:47], v[64:67]
 ds_read_b64_tr_b16 v[54:55], v9 offset:4608
 v_mfma_f32_16x16x32_bf16 v[68:71], v[44:47], a[108:111], v[68:71]
 s_add_u32 m0, s5, 12288
 v_mfma_f32_16x16x32_bf16 v[68:71], v[40:43], a[104:107], v[68:71]
 ds_read_b64_tr_b16 v[56:57], v9 offset:8192
 ds_read_b64_tr_b16 v[58:59], v9 offset:8704
 v_mfma_f32_16x16x32_bf16 v[68:71], v[36:39], a[100:103], v[68:71]
 s_mov_b32 s4, 49920
 v_mfma_f32_16x16x32_bf16 v[68:71], v[32:35], a[96:99], v[68:71]
 v_mfma_f32_16x16x32_bf16 v[72:75], v[32:35], a[160:163], v[72:75]
 buffer_load_dwordx4 v12, s[8:11], s4 offen offset:0 lds
 v_mfma_f32_16x16x32_bf16 v[72:75], v[36:39], a[164:167], v[72:75]
 ds_read_b64_tr_b16 v[60:61], v9 offset:12288
 ds_read_b64_tr_b16 v[62:63], v9 offset:12800
 v_mfma_f32_16x16x32_bf16 v[72:75], v[40:43], a[168:171], v[72:75]
 v_mfma_f32_16x16x32_bf16 v[72:75], v[44:47], a[172:175], v[72:75]
 buffer_load_dwordx4 v13, s[8:11], s4 offen offset:1024 lds
 v_mfma_f32_16x16x32_bf16 v[76:79], v[44:47], a[236:239], v[76:79]
 v_mfma_f32_16x16x32_bf16 v[76:79], v[40:43], a[232:235], v[76:79]
 buffer_load_dwordx4 v14, s[8:11], s4 offen offset:2048 lds
 v_mfma_f32_16x16x32_bf16 v[76:79], v[36:39], a[228:231], v[76:79]
 v_mfma_f32_16x16x32_bf16 v[76:79], v[32:35], a[224:227], v[76:79]
 s_waitcnt lgkmcnt(2)
 buffer_load_dwordx4 v15, s[8:11], s4 offen offset:3072 lds
 v_mfma_f32_16x16x32_bf16 v[80:83], v[48:51], a[32:35], v[80:83]
 ds_read_b64_tr_b16 v[32:33], v10 offset:0
 ds_read_b64_tr_b16 v[34:35], v10 offset:512
 v_mfma_f32_16x16x32_bf16 v[80:83], v[52:55], a[36:39], v[80:83]
 s_waitcnt vmcnt(20)
 v_mfma_f32_16x16x32_bf16 v[80:83], v[56:59], a[40:43], v[80:83]
 s_waitcnt lgkmcnt(2)
 ds_read_b64_tr_b16 v[36:37], v10 offset:4096
 v_mfma_f32_16x16x32_bf16 v[80:83], v[60:63], a[44:47], v[80:83]
 ds_read_b64_tr_b16 v[38:39], v10 offset:4608
 ds_read_b128 a[48:51], v16 offset:0
 v_mfma_f32_16x16x32_bf16 v[84:87], v[60:63], a[108:111], v[84:87]
 v_mfma_f32_16x16x32_bf16 v[84:87], v[56:59], a[104:107], v[84:87]
 ds_read_b64_tr_b16 v[40:41], v10 offset:8192
 ds_read_b128 a[52:55], v17 offset:0
 v_mfma_f32_16x16x32_bf16 v[84:87], v[52:55], a[100:103], v[84:87]
 ds_read_b64_tr_b16 v[42:43], v10 offset:8704
 ds_read_b128 a[56:59], v18 offset:0
 v_mfma_f32_16x16x32_bf16 v[84:87], v[48:51], a[96:99], v[84:87]
 v_mfma_f32_16x16x32_bf16 v[88:91], v[48:51], a[160:163], v[88:91]
 ds_read_b64_tr_b16 v[44:45], v10 offset:12288
 ds_read_b64_tr_b16 v[46:47], v10 offset:12800
 v_mfma_f32_16x16x32_bf16 v[88:91], v[52:55], a[164:167], v[88:91]
 ds_read_b128 a[60:63], v19 offset:0
 v_mfma_f32_16x16x32_bf16 v[88:91], v[56:59], a[168:171], v[88:91]
 v_mfma_f32_16x16x32_bf16 v[88:91], v[60:63], a[172:175], v[88:91]
 v_mfma_f32_16x16x32_bf16 v[92:95], v[60:63], a[236:239], v[92:95]
 v_mfma_f32_16x16x32_bf16 v[92:95], v[56:59], a[232:235], v[92:95]
 s_waitcnt vmcnt(12)
 v_mfma_f32_16x16x32_bf16 v[92:95], v[52:55], a[228:231], v[92:95]
 ds_read_b128 a[112:115], v16 offset:4096
 v_mfma_f32_16x16x32_bf16 v[92:95], v[48:51], a[224:227], v[92:95]
 s_waitcnt lgkmcnt(9)
 v_mfma_f32_16x16x32_bf16 v[96:99], v[32:35], a[32:35], v[96:99]
 ds_read_b64_tr_b16 v[48:49], v11 offset:0
 ds_read_b64_tr_b16 v[50:51], v11 offset:512
 v_mfma_f32_16x16x32_bf16 v[96:99], v[36:39], a[36:39], v[96:99]
 s_waitcnt lgkmcnt(7)
 ds_read_b128 a[116:119], v17 offset:4096
 v_mfma_f32_16x16x32_bf16 v[96:99], v[40:43], a[40:43], v[96:99]
 s_waitcnt lgkmcnt(5)
 ds_read_b64_tr_b16 v[52:53], v11 offset:4096
 v_mfma_f32_16x16x32_bf16 v[96:99], v[44:47], a[44:47], v[96:99]
 ds_read_b128 a[120:123], v18 offset:4096
 ds_read_b64_tr_b16 v[54:55], v11 offset:4608
 v_mfma_f32_16x16x32_bf16 v[100:103], v[44:47], a[108:111], v[100:103]
 v_mfma_f32_16x16x32_bf16 v[100:103], v[40:43], a[104:107], v[100:103]
 ds_read_b64_tr_b16 v[56:57], v11 offset:8192
 ds_read_b128 a[124:127], v19 offset:4096
 v_mfma_f32_16x16x32_bf16 v[100:103], v[36:39], a[100:103], v[100:103]
 ds_read_b64_tr_b16 v[58:59], v11 offset:8704
 v_mfma_f32_16x16x32_bf16 v[100:103], v[32:35], a[96:99], v[100:103]
 v_mfma_f32_16x16x32_bf16 v[104:107], v[32:35], a[160:163], v[104:107]
 buffer_load_dword v22, v25, s[32:35], 0 offen
 v_mfma_f32_16x16x32_bf16 v[104:107], v[36:39], a[164:167], v[104:107]
 ds_read_b64_tr_b16 v[60:61], v11 offset:12288
 ds_read_b64_tr_b16 v[62:63], v11 offset:12800
 v_mfma_f32_16x16x32_bf16 v[104:107], v[40:43], a[168:171], v[104:107]
 buffer_load_dword v22, v25, s[80:83], 0 offen
 v_mfma_f32_16x16x32_bf16 v[104:107], v[44:47], a[172:175], v[104:107]
 v_mfma_f32_16x16x32_bf16 v[108:111], v[44:47], a[236:239], v[108:111]
 v_mfma_f32_16x16x32_bf16 v[108:111], v[40:43], a[232:235], v[108:111]
 v_mfma_f32_16x16x32_bf16 v[108:111], v[36:39], a[228:231], v[108:111]
 v_mfma_f32_16x16x32_bf16 v[108:111], v[32:35], a[224:227], v[108:111]
 s_waitcnt lgkmcnt(5)
 s_barrier
 v_mfma_f32_16x16x32_bf16 v[112:115], v[48:51], a[32:35], v[112:115]
 s_lshl_b32 s68, s3, 11
 ds_read_b64_tr_b16 v[32:33], v8 offset:16384
 v_mfma_f32_16x16x32_bf16 v[112:115], v[52:55], a[36:39], v[112:115]
 s_waitcnt lgkmcnt(3)
 ds_read_b64_tr_b16 v[34:35], v8 offset:16896
 v_mfma_f32_16x16x32_bf16 v[112:115], v[56:59], a[40:43], v[112:115]
 s_waitcnt lgkmcnt(2)
 ds_read_b64_tr_b16 v[36:37], v8 offset:20480
 v_mfma_f32_16x16x32_bf16 v[112:115], v[60:63], a[44:47], v[112:115]
 s_add_u32 m0, s58, 49152
 ds_read_b64_tr_b16 v[38:39], v8 offset:20992
 v_mfma_f32_16x16x32_bf16 v[116:119], v[60:63], a[108:111], v[116:119]
 s_add_u32 s68, s68, 155648
 v_add_u32 v2, s68, v24
 v_mfma_f32_16x16x32_bf16 v[116:119], v[56:59], a[104:107], v[116:119]
 s_mov_b32 s4, 3145856
 buffer_load_dwordx4 v4, s[12:15], s4 offen offset:0 lds
 v_mfma_f32_16x16x32_bf16 v[116:119], v[52:55], a[100:103], v[116:119]
 ds_read_b128 v[192:195], v2 offset:0
 ds_read_b128 v[196:199], v2 offset:1024
 v_mfma_f32_16x16x32_bf16 v[116:119], v[48:51], a[96:99], v[116:119]
 s_and_b32 s68, s2, 1
 buffer_load_dwordx4 v5, s[12:15], s4 offen offset:1024 lds
 v_mfma_f32_16x16x32_bf16 v[120:123], v[48:51], a[160:163], v[120:123]
 s_lshl_b32 s68, s68, 7
 ds_read_b64_tr_b16 v[40:41], v8 offset:24576
 v_mfma_f32_16x16x32_bf16 v[120:123], v[52:55], a[164:167], v[120:123]
 s_add_u32 s68, s68, s58
 ds_read_b64_tr_b16 v[42:43], v8 offset:25088
 v_mfma_f32_16x16x32_bf16 v[120:123], v[56:59], a[168:171], v[120:123]
 buffer_load_dwordx4 v6, s[12:15], s4 offen offset:2048 lds
 v_mfma_f32_16x16x32_bf16 v[120:123], v[60:63], a[172:175], v[120:123]
 ds_read_b64_tr_b16 v[44:45], v8 offset:28672
 v_lshrrev_b32 v2, 3, v0
 ds_read_b64_tr_b16 v[46:47], v8 offset:29184
 v_mfma_f32_16x16x32_bf16 v[124:127], v[60:63], a[236:239], v[124:127]
 buffer_load_dwordx4 v7, s[12:15], s4 offen offset:3072 lds
 v_mfma_f32_16x16x32_bf16 v[124:127], v[56:59], a[232:235], v[124:127]
 v_lshlrev_b32 v2, 8, v2
 v_and_b32 v3, 7, v0
 v_mfma_f32_16x16x32_bf16 v[124:127], v[52:55], a[228:231], v[124:127]
 v_lshl_add_u32 v2, v3, 4, v2
 v_add_u32 v2, s68, v2
 v_mfma_f32_16x16x32_bf16 v[124:127], v[48:51], a[224:227], v[124:127]
 s_waitcnt lgkmcnt(4)
 buffer_store_dwordx4 v[192:195], v2, s[88:91], 0 offen offset:0 sc1
 buffer_store_dwordx4 v[196:199], v2, s[88:91], 0 offen offset:2048 sc1
 v_mfma_f32_16x16x32_bf16 v[128:131], v[32:35], a[32:35], v[128:131]
 ds_read_b64_tr_b16 v[48:49], v9 offset:16384
 ds_read_b64_tr_b16 v[50:51], v9 offset:16896
 v_mfma_f32_16x16x32_bf16 v[128:131], v[36:39], a[36:39], v[128:131]
 s_waitcnt lgkmcnt(4)
 v_mfma_f32_16x16x32_bf16 v[128:131], v[40:43], a[40:43], v[128:131]
 s_waitcnt lgkmcnt(2)
 ds_read_b64_tr_b16 v[52:53], v9 offset:20480
 v_mfma_f32_16x16x32_bf16 v[128:131], v[44:47], a[44:47], v[128:131]
 ds_read_b64_tr_b16 v[54:55], v9 offset:20992
 v_mfma_f32_16x16x32_bf16 v[132:135], v[44:47], a[108:111], v[132:135]
 v_mfma_f32_16x16x32_bf16 v[132:135], v[40:43], a[104:107], v[132:135]
 ds_read_b64_tr_b16 v[56:57], v9 offset:24576
 ds_read_b64_tr_b16 v[58:59], v9 offset:25088
 v_mfma_f32_16x16x32_bf16 v[132:135], v[36:39], a[100:103], v[132:135]
 v_mfma_f32_16x16x32_bf16 v[132:135], v[32:35], a[96:99], v[132:135]
 v_mfma_f32_16x16x32_bf16 v[136:139], v[32:35], a[160:163], v[136:139]
 ds_read_b64_tr_b16 v[60:61], v9 offset:28672
 ds_read_b64_tr_b16 v[62:63], v9 offset:29184
 v_mfma_f32_16x16x32_bf16 v[136:139], v[36:39], a[164:167], v[136:139]
 v_mfma_f32_16x16x32_bf16 v[136:139], v[40:43], a[168:171], v[136:139]
 v_mfma_f32_16x16x32_bf16 v[136:139], v[44:47], a[172:175], v[136:139]
 v_mfma_f32_16x16x32_bf16 v[140:143], v[44:47], a[236:239], v[140:143]
 v_mfma_f32_16x16x32_bf16 v[140:143], v[40:43], a[232:235], v[140:143]
 v_mfma_f32_16x16x32_bf16 v[140:143], v[36:39], a[228:231], v[140:143]
 v_mfma_f32_16x16x32_bf16 v[140:143], v[32:35], a[224:227], v[140:143]
 s_waitcnt lgkmcnt(2)
 v_mfma_f32_16x16x32_bf16 v[144:147], v[48:51], a[32:35], v[144:147]
 ds_read_b64_tr_b16 v[32:33], v10 offset:16384
 ds_read_b64_tr_b16 v[34:35], v10 offset:16896
 v_mfma_f32_16x16x32_bf16 v[144:147], v[52:55], a[36:39], v[144:147]
 v_mfma_f32_16x16x32_bf16 v[144:147], v[56:59], a[40:43], v[144:147]
 s_waitcnt lgkmcnt(2)
 ds_read_b64_tr_b16 v[36:37], v10 offset:20480
 v_mfma_f32_16x16x32_bf16 v[144:147], v[60:63], a[44:47], v[144:147]
 ds_read_b64_tr_b16 v[38:39], v10 offset:20992
 v_mfma_f32_16x16x32_bf16 v[148:151], v[60:63], a[108:111], v[148:151]
 s_waitcnt vmcnt(16)
 v_mfma_f32_16x16x32_bf16 v[148:151], v[56:59], a[104:107], v[148:151]
 ds_read_b64_tr_b16 v[40:41], v10 offset:24576
 ds_read_b128 a[176:179], v16 offset:8192
 v_mfma_f32_16x16x32_bf16 v[148:151], v[52:55], a[100:103], v[148:151]
 ds_read_b64_tr_b16 v[42:43], v10 offset:25088
 ds_read_b128 a[180:183], v17 offset:8192
 v_mfma_f32_16x16x32_bf16 v[148:151], v[48:51], a[96:99], v[148:151]
 v_mfma_f32_16x16x32_bf16 v[152:155], v[48:51], a[160:163], v[152:155]
 ds_read_b64_tr_b16 v[44:45], v10 offset:28672
 ds_read_b64_tr_b16 v[46:47], v10 offset:29184
 v_mfma_f32_16x16x32_bf16 v[152:155], v[52:55], a[164:167], v[152:155]
 ds_read_b128 a[184:187], v18 offset:8192
 v_mfma_f32_16x16x32_bf16 v[152:155], v[56:59], a[168:171], v[152:155]
 v_mfma_f32_16x16x32_bf16 v[152:155], v[60:63], a[172:175], v[152:155]
 v_mfma_f32_16x16x32_bf16 v[156:159], v[60:63], a[236:239], v[156:159]
 ds_read_b128 a[188:191], v19 offset:8192
 v_mfma_f32_16x16x32_bf16 v[156:159], v[56:59], a[232:235], v[156:159]
 v_mfma_f32_16x16x32_bf16 v[156:159], v[52:55], a[228:231], v[156:159]
 v_mfma_f32_16x16x32_bf16 v[156:159], v[48:51], a[224:227], v[156:159]
 s_waitcnt lgkmcnt(8)
 v_mfma_f32_16x16x32_bf16 v[160:163], v[32:35], a[32:35], v[160:163]
 s_waitcnt vmcnt(8)
 ds_read_b64_tr_b16 v[48:49], v11 offset:16384
 v_mfma_f32_16x16x32_bf16 v[160:163], v[36:39], a[36:39], v[160:163]
 s_waitcnt lgkmcnt(6)
 ds_read_b64_tr_b16 v[50:51], v11 offset:16896
 v_mfma_f32_16x16x32_bf16 v[160:163], v[40:43], a[40:43], v[160:163]
 s_waitcnt lgkmcnt(4)
 ds_read_b128 a[240:243], v16 offset:12288
 v_mfma_f32_16x16x32_bf16 v[160:163], v[44:47], a[44:47], v[160:163]
 ds_read_b64_tr_b16 v[52:53], v11 offset:20480
 ds_read_b128 a[244:247], v17 offset:12288
 v_mfma_f32_16x16x32_bf16 v[164:167], v[44:47], a[108:111], v[164:167]
 ds_read_b64_tr_b16 v[54:55], v11 offset:20992
 ds_read_b64_tr_b16 v[56:57], v11 offset:24576
 v_mfma_f32_16x16x32_bf16 v[164:167], v[40:43], a[104:107], v[164:167]
 ds_read_b128 a[248:251], v18 offset:12288
 ds_read_b64_tr_b16 v[58:59], v11 offset:25088
 v_mfma_f32_16x16x32_bf16 v[164:167], v[36:39], a[100:103], v[164:167]
 v_mfma_f32_16x16x32_bf16 v[164:167], v[32:35], a[96:99], v[164:167]
 ds_read_b128 a[252:255], v19 offset:12288
 ds_read_b64_tr_b16 v[60:61], v11 offset:28672
 v_mfma_f32_16x16x32_bf16 v[168:171], v[32:35], a[160:163], v[168:171]
 v_mfma_f32_16x16x32_bf16 v[168:171], v[36:39], a[164:167], v[168:171]
 ds_read_b64_tr_b16 v[62:63], v11 offset:29184
 v_mfma_f32_16x16x32_bf16 v[168:171], v[40:43], a[168:171], v[168:171]
 s_waitcnt lgkmcnt(2)
 v_mfma_f32_16x16x32_bf16 v[168:171], v[44:47], a[172:175], v[168:171]
 v_mfma_f32_16x16x32_bf16 v[172:175], v[44:47], a[236:239], v[172:175]
 v_mfma_f32_16x16x32_bf16 v[172:175], v[40:43], a[232:235], v[172:175]
 v_mfma_f32_16x16x32_bf16 v[172:175], v[36:39], a[228:231], v[172:175]
 v_mfma_f32_16x16x32_bf16 v[172:175], v[32:35], a[224:227], v[172:175]
 s_barrier
 v_mfma_f32_16x16x32_bf16 v[176:179], v[48:51], a[32:35], v[176:179]
 s_add_u32 m0, s58, 0
 ds_read_b64_tr_b16 v[32:33], v8 offset:32768
 v_mfma_f32_16x16x32_bf16 v[176:179], v[52:55], a[36:39], v[176:179]
 s_mov_b32 s4, 0
 ds_read_b64_tr_b16 v[34:35], v8 offset:33280
 v_mfma_f32_16x16x32_bf16 v[176:179], v[56:59], a[40:43], v[176:179]
 s_waitcnt lgkmcnt(2)
 buffer_load_dwordx4 v4, s[16:19], s4 offen offset:0 lds
 v_mfma_f32_16x16x32_bf16 v[176:179], v[60:63], a[44:47], v[176:179]
 buffer_load_dwordx4 v5, s[16:19], s4 offen offset:1024 lds
 v_mfma_f32_16x16x32_bf16 v[180:183], v[60:63], a[108:111], v[180:183]
 ds_read_b64_tr_b16 v[36:37], v8 offset:36864
 ds_read_b64_tr_b16 v[38:39], v8 offset:37376
 v_mfma_f32_16x16x32_bf16 v[180:183], v[56:59], a[104:107], v[180:183]
 buffer_load_dwordx4 v6, s[16:19], s4 offen offset:2048 lds
 v_mfma_f32_16x16x32_bf16 v[180:183], v[52:55], a[100:103], v[180:183]
 buffer_load_dwordx4 v7, s[16:19], s4 offen offset:3072 lds
 v_mfma_f32_16x16x32_bf16 v[180:183], v[48:51], a[96:99], v[180:183]
 s_add_u32 m0, s58, 65536
 ds_read_b64_tr_b16 v[40:41], v8 offset:40960
 v_mfma_f32_16x16x32_bf16 v[184:187], v[48:51], a[160:163], v[184:187]
 s_mov_b32 s4, 128
 ds_read_b64_tr_b16 v[42:43], v8 offset:41472
 v_mfma_f32_16x16x32_bf16 v[184:187], v[52:55], a[164:167], v[184:187]
 ds_read_b64_tr_b16 v[44:45], v8 offset:45056
 ds_read_b64_tr_b16 v[46:47], v8 offset:45568
 v_mfma_f32_16x16x32_bf16 v[184:187], v[56:59], a[168:171], v[184:187]
 buffer_load_dwordx4 v4, s[16:19], s4 offen offset:0 lds
 v_mfma_f32_16x16x32_bf16 v[184:187], v[60:63], a[172:175], v[184:187]
 buffer_load_dwordx4 v5, s[16:19], s4 offen offset:1024 lds
 v_mfma_f32_16x16x32_bf16 v[188:191], v[60:63], a[236:239], v[188:191]
 buffer_load_dwordx4 v6, s[16:19], s4 offen offset:2048 lds
 v_mfma_f32_16x16x32_bf16 v[188:191], v[56:59], a[232:235], v[188:191]
 buffer_load_dwordx4 v7, s[16:19], s4 offen offset:3072 lds
 v_mfma_f32_16x16x32_bf16 v[188:191], v[52:55], a[228:231], v[188:191]
 v_mfma_f32_16x16x32_bf16 v[188:191], v[48:51], a[224:227], v[188:191]
 s_waitcnt lgkmcnt(4)
 v_mfma_f32_16x16x32_bf16 v[64:67], v[32:35], a[48:51], v[64:67]
 s_cmp_lt_u32 s62, 24
 s_cbranch_scc0 L_j0_7
 s_mov_b32 m0, 147456
 s_mov_b32 s68, 0
 buffer_load_dwordx4 v21, s[28:31], s68 offen offset:0 lds
 s_add_u32 s68, s68, 7168
 buffer_load_dwordx4 v21, s[28:31], s68 offen offset:1024 lds
 s_add_u32 s68, s68, 7168
 buffer_load_dwordx4 v21, s[28:31], s68 offen offset:2048 lds
 s_add_u32 s68, s68, 7168
 buffer_load_dwordx4 v21, s[28:31], s68 offen offset:3072 lds
 s_add_u32 s68, s68, 7168
L_j0_7:
 ds_read_b64_tr_b16 v[48:49], v9 offset:32768
 v_mfma_f32_16x16x32_bf16 v[64:67], v[36:39], a[52:55], v[64:67]
 s_waitcnt lgkmcnt(3)
 ds_read_b64_tr_b16 v[50:51], v9 offset:33280
 v_mfma_f32_16x16x32_bf16 v[64:67], v[40:43], a[56:59], v[64:67]
 s_waitcnt lgkmcnt(2)
 ds_read_b64_tr_b16 v[52:53], v9 offset:36864
 v_mfma_f32_16x16x32_bf16 v[64:67], v[44:47], a[60:63], v[64:67]
 ds_read_b64_tr_b16 v[54:55], v9 offset:37376
 v_mfma_f32_16x16x32_bf16 v[68:71], v[44:47], a[124:127], v[68:71]
 s_lshl_b32 s67, s71, 4
 v_mov_b32 v16, s67
 v_mfma_f32_16x16x32_bf16 v[68:71], v[40:43], a[120:123], v[68:71]
 s_add_u32 m0, s58, 81920
 ds_read_b64_tr_b16 v[56:57], v9 offset:40960
 v_mfma_f32_16x16x32_bf16 v[68:71], v[36:39], a[116:119], v[68:71]
 ds_read_b64_tr_b16 v[58:59], v9 offset:41472
 v_mfma_f32_16x16x32_bf16 v[68:71], v[32:35], a[112:115], v[68:71]
 s_mov_b32 s4, 1048576
 v_mfma_f32_16x16x32_bf16 v[72:75], v[32:35], a[176:179], v[72:75]
 s_sub_u32 s67, 240, s67
 v_mov_b32 v17, s67
 v_mfma_f32_16x16x32_bf16 v[72:75], v[36:39], a[180:183], v[72:75]
 ds_read_b64_tr_b16 v[60:61], v9 offset:45056
 ds_read_b64_tr_b16 v[62:63], v9 offset:45568
 v_mfma_f32_16x16x32_bf16 v[72:75], v[40:43], a[184:187], v[72:75]
 v_and_b32 v18, 16, v0
 v_mfma_f32_16x16x32_bf16 v[72:75], v[44:47], a[188:191], v[72:75]
 buffer_load_dwordx4 v4, s[16:19], s4 offen offset:0 lds
 v_mfma_f32_16x16x32_bf16 v[76:79], v[44:47], a[252:255], v[76:79]
 v_cmp_eq_u32 vcc, 0, v18
 v_mfma_f32_16x16x32_bf16 v[76:79], v[40:43], a[248:251], v[76:79]
 v_mfma_f32_16x16x32_bf16 v[76:79], v[36:39], a[244:247], v[76:79]
 buffer_load_dwordx4 v5, s[16:19], s4 offen offset:1024 lds
 v_mfma_f32_16x16x32_bf16 v[76:79], v[32:35], a[240:243], v[76:79]
 s_waitcnt lgkmcnt(4)
 v_cndmask_b32 v16, v17, v16, vcc
 v_mfma_f32_16x16x32_bf16 v[80:83], v[48:51], a[48:51], v[80:83]
 ds_read_b64_tr_b16 v[32:33], v10 offset:32768
 ds_read_b64_tr_b16 v[34:35], v10 offset:33280
 v_mfma_f32_16x16x32_bf16 v[80:83], v[52:55], a[52:55], v[80:83]
 s_waitcnt lgkmcnt(4)
 v_and_b32 v18, 15, v0
 v_mfma_f32_16x16x32_bf16 v[80:83], v[56:59], a[56:59], v[80:83]
 s_waitcnt lgkmcnt(2)
 buffer_load_dwordx4 v6, s[16:19], s4 offen offset:2048 lds
 v_mfma_f32_16x16x32_bf16 v[80:83], v[60:63], a[60:63], v[80:83]
 ds_read_b64_tr_b16 v[36:37], v10 offset:36864
 v_add_u32 v18, v16, v18
 v_mfma_f32_16x16x32_bf16 v[84:87], v[60:63], a[124:127], v[84:87]
 ds_read_b64_tr_b16 v[38:39], v10 offset:37376
 ds_read_b64_tr_b16 v[40:41], v10 offset:40960
 v_mfma_f32_16x16x32_bf16 v[84:87], v[56:59], a[120:123], v[84:87]
 buffer_load_dwordx4 v7, s[16:19], s4 offen offset:3072 lds
 v_mfma_f32_16x16x32_bf16 v[84:87], v[52:55], a[116:119], v[84:87]
 ds_read_b64_tr_b16 v[42:43], v10 offset:41472
 v_lshlrev_b32 v18, 7, v18
 v_mfma_f32_16x16x32_bf16 v[84:87], v[48:51], a[112:115], v[84:87]
 v_mfma_f32_16x16x32_bf16 v[88:91], v[48:51], a[176:179], v[88:91]
 ds_read_b64_tr_b16 v[44:45], v10 offset:45056
 ds_read_b64_tr_b16 v[46:47], v10 offset:45568
 v_mfma_f32_16x16x32_bf16 v[88:91], v[52:55], a[180:183], v[88:91]
 s_add_u32 m0, s58, 98304
 v_mfma_f32_16x16x32_bf16 v[88:91], v[56:59], a[184:187], v[88:91]
 v_mfma_f32_16x16x32_bf16 v[88:91], v[60:63], a[188:191], v[88:91]
 s_and_b32 s67, s2, 31
 v_mfma_f32_16x16x32_bf16 v[92:95], v[60:63], a[252:255], v[92:95]
 v_mfma_f32_16x16x32_bf16 v[92:95], v[56:59], a[248:251], v[92:95]
 s_lshl_b32 s67, s67, 7
 v_mfma_f32_16x16x32_bf16 v[92:95], v[52:55], a[244:247], v[92:95]
 s_mov_b32 s4, 1048704
 v_mfma_f32_16x16x32_bf16 v[92:95], v[48:51], a[240:243], v[92:95]
 s_waitcnt lgkmcnt(4)
 v_mfma_f32_16x16x32_bf16 v[96:99], v[32:35], a[48:51], v[96:99]
 s_add_u32 s67, s67, 32768
 buffer_load_dwordx4 v4, s[16:19], s4 offen offset:0 lds
 v_mfma_f32_16x16x32_bf16 v[96:99], v[36:39], a[52:55], v[96:99]
 s_waitcnt lgkmcnt(2)
 v_and_b32 v19, 7, v0
 v_lshlrev_b32 v19, 12, v19
 v_mfma_f32_16x16x32_bf16 v[96:99], v[40:43], a[56:59], v[96:99]
 s_waitcnt lgkmcnt(0)
 ds_read_b64_tr_b16 v[48:49], v11 offset:32768
 v_mfma_f32_16x16x32_bf16 v[96:99], v[44:47], a[60:63], v[96:99]
 ds_read_b64_tr_b16 v[50:51], v11 offset:33280
 v_add_u32 v19, s67, v19
 v_mfma_f32_16x16x32_bf16 v[100:103], v[44:47], a[124:127], v[100:103]
 buffer_load_dwordx4 v5, s[16:19], s4 offen offset:1024 lds
 v_mfma_f32_16x16x32_bf16 v[100:103], v[40:43], a[120:123], v[100:103]
 ds_read_b64_tr_b16 v[52:53], v11 offset:36864
 ds_read_b64_tr_b16 v[54:55], v11 offset:37376
 v_mfma_f32_16x16x32_bf16 v[100:103], v[36:39], a[116:119], v[100:103]
 ds_read_b64_tr_b16 v[56:57], v11 offset:40960
 ds_read_b64_tr_b16 v[58:59], v11 offset:41472
 v_mfma_f32_16x16x32_bf16 v[100:103], v[32:35], a[112:115], v[100:103]
 buffer_load_dwordx4 v6, s[16:19], s4 offen offset:2048 lds
 v_mfma_f32_16x16x32_bf16 v[104:107], v[32:35], a[176:179], v[104:107]
 s_bfe_u32 s6, s2, 0x20003
 ds_read_b64_tr_b16 v[60:61], v11 offset:45056
 v_mfma_f32_16x16x32_bf16 v[104:107], v[36:39], a[180:183], v[104:107]
 ds_read_b64_tr_b16 v[62:63], v11 offset:45568
 v_mfma_f32_16x16x32_bf16 v[104:107], v[40:43], a[184:187], v[104:107]
 v_mfma_f32_16x16x32_bf16 v[104:107], v[44:47], a[188:191], v[104:107]
 s_sub_u32 s7, 7, s6
 buffer_load_dwordx4 v7, s[16:19], s4 offen offset:3072 lds
 v_mfma_f32_16x16x32_bf16 v[108:111], v[44:47], a[252:255], v[108:111]
 v_mfma_f32_16x16x32_bf16 v[108:111], v[40:43], a[248:251], v[108:111]
 s_bitcmp1_b32 s3, 0
 s_cselect_b32 s6, s7, s6
 v_mfma_f32_16x16x32_bf16 v[108:111], v[36:39], a[244:247], v[108:111]
 v_mfma_f32_16x16x32_bf16 v[108:111], v[32:35], a[240:243], v[108:111]
 s_waitcnt lgkmcnt(4)
 s_waitcnt vmcnt(18)
 s_waitcnt vmcnt(16)
 s_barrier
 s_cmp_eq_u32 s3, 0
 s_cbranch_scc0 L_pub_8
 s_mul_i32 s4, s2, 128
 s_add_u32 s4, s4, 0
 v_lshl_add_u32 v2, v0, 2, s4
 v_mov_b32 v3, s100
 s_mov_b64 exec, 0xffffffff
 buffer_store_dword v3, v2, s[96:99], 0 offen sc1
 s_mov_b64 exec, -1
L_pub_8:
 v_mfma_f32_16x16x32_bf16 v[112:115], v[48:51], a[48:51], v[112:115]
 s_lshl_b32 s7, s71, 3
 ds_read_b64_tr_b16 v[32:33], v8 offset:49152
 v_mfma_f32_16x16x32_bf16 v[112:115], v[52:55], a[52:55], v[112:115]
 s_waitcnt lgkmcnt(3)
 ds_read_b64_tr_b16 v[34:35], v8 offset:49664
 v_mfma_f32_16x16x32_bf16 v[112:115], v[56:59], a[56:59], v[112:115]
 s_waitcnt lgkmcnt(2)
 ds_read_b64_tr_b16 v[36:37], v8 offset:53248
 v_mfma_f32_16x16x32_bf16 v[112:115], v[60:63], a[60:63], v[112:115]
 s_add_u32 m0, s58, 16384
 ds_read_b64_tr_b16 v[38:39], v8 offset:53760
 v_mfma_f32_16x16x32_bf16 v[116:119], v[60:63], a[124:127], v[116:119]
 s_sub_u32 s67, 120, s7
 v_mfma_f32_16x16x32_bf16 v[116:119], v[56:59], a[120:123], v[116:119]
 s_mov_b32 s4, 2097280
 buffer_load_dwordx4 v4, s[16:19], s4 offen offset:0 lds
 v_mfma_f32_16x16x32_bf16 v[116:119], v[52:55], a[116:119], v[116:119]
 s_bitcmp1_b32 s3, 1
 s_cselect_b32 s7, s67, s7
 v_mfma_f32_16x16x32_bf16 v[116:119], v[48:51], a[112:115], v[116:119]
 s_add_u32 s6, s6, s7
 buffer_load_dwordx4 v5, s[16:19], s4 offen offset:1024 lds
 v_mfma_f32_16x16x32_bf16 v[120:123], v[48:51], a[176:179], v[120:123]
 ds_read_b64_tr_b16 v[40:41], v8 offset:57344
 ds_read_b64_tr_b16 v[42:43], v8 offset:57856
 v_mfma_f32_16x16x32_bf16 v[120:123], v[52:55], a[180:183], v[120:123]
 s_lshl_b32 s6, s6, 14
 v_lshlrev_b32 v17, 6, v0
 v_mfma_f32_16x16x32_bf16 v[120:123], v[56:59], a[184:187], v[120:123]
 buffer_load_dwordx4 v6, s[16:19], s4 offen offset:2048 lds
 v_mfma_f32_16x16x32_bf16 v[120:123], v[60:63], a[188:191], v[120:123]
 ds_read_b64_tr_b16 v[44:45], v8 offset:61440
 v_add_u32 v17, s6, v17
 ds_read_b64_tr_b16 v[46:47], v8 offset:61952
 v_mfma_f32_16x16x32_bf16 v[124:127], v[60:63], a[252:255], v[124:127]
 buffer_load_dwordx4 v7, s[16:19], s4 offen offset:3072 lds
 v_mfma_f32_16x16x32_bf16 v[124:127], v[56:59], a[248:251], v[124:127]
 v_mfma_f32_16x16x32_bf16 v[124:127], v[52:55], a[244:247], v[124:127]
 v_mfma_f32_16x16x32_bf16 v[124:127], v[48:51], a[240:243], v[124:127]
 s_waitcnt lgkmcnt(4)
 v_mfma_f32_16x16x32_bf16 v[128:131], v[32:35], a[48:51], v[128:131]
 ds_read_b64_tr_b16 v[48:49], v9 offset:49152
 v_lshlrev_b32 v12, 4, v0
 v_mfma_f32_16x16x32_bf16 v[128:131], v[36:39], a[52:55], v[128:131]
 s_waitcnt lgkmcnt(3)
 v_add_u32 v13, s58, v12
 v_mfma_f32_16x16x32_bf16 v[128:131], v[40:43], a[56:59], v[128:131]
 s_waitcnt lgkmcnt(1)
 ds_read_b64_tr_b16 v[50:51], v9 offset:49664
 v_mfma_f32_16x16x32_bf16 v[128:131], v[44:47], a[60:63], v[128:131]
 ds_read_b64_tr_b16 v[52:53], v9 offset:53248
 ds_read_b64_tr_b16 v[54:55], v9 offset:53760
 v_mfma_f32_16x16x32_bf16 v[132:135], v[44:47], a[124:127], v[132:135]
 s_add_u32 m0, s58, 114688
 v_mfma_f32_16x16x32_bf16 v[132:135], v[40:43], a[120:123], v[132:135]
 ds_read_b64_tr_b16 v[56:57], v9 offset:57344
 ds_read_b64_tr_b16 v[58:59], v9 offset:57856
 v_mfma_f32_16x16x32_bf16 v[132:135], v[36:39], a[116:119], v[132:135]
 s_lshl_b32 s5, s71, 3
 v_mfma_f32_16x16x32_bf16 v[132:135], v[32:35], a[112:115], v[132:135]
 s_mov_b32 s4, 2097152
 v_mfma_f32_16x16x32_bf16 v[136:139], v[32:35], a[176:179], v[136:139]
 ds_read_b64_tr_b16 v[60:61], v9 offset:61440
 v_cvt_pk_bf16_f32 v64, v64, v65
 v_mfma_f32_16x16x32_bf16 v[136:139], v[36:39], a[180:183], v[136:139]
 s_sub_u32 s6, 120, s5
 v_cvt_pk_bf16_f32 v65, v66, v67
 v_cvt_pk_bf16_f32 v66, v80, v81
 v_mfma_f32_16x16x32_bf16 v[136:139], v[40:43], a[184:187], v[136:139]
 ds_read_b64_tr_b16 v[62:63], v9 offset:61952
 v_cvt_pk_bf16_f32 v67, v82, v83
 v_mfma_f32_16x16x32_bf16 v[136:139], v[44:47], a[188:191], v[136:139]
 buffer_load_dwordx4 v4, s[16:19], s4 offen offset:0 lds
 v_mfma_f32_16x16x32_bf16 v[140:143], v[44:47], a[252:255], v[140:143]
 s_sub_u32 s7, 7, s3
 v_cvt_pk_bf16_f32 v96, v96, v97
 v_mfma_f32_16x16x32_bf16 v[140:143], v[40:43], a[248:251], v[140:143]
 v_cvt_pk_bf16_f32 v97, v98, v99
 v_mfma_f32_16x16x32_bf16 v[140:143], v[36:39], a[244:247], v[140:143]
 buffer_load_dwordx4 v5, s[16:19], s4 offen offset:1024 lds
 v_mfma_f32_16x16x32_bf16 v[140:143], v[32:35], a[240:243], v[140:143]
 s_waitcnt lgkmcnt(2)
 v_cvt_pk_bf16_f32 v98, v112, v113
 v_mfma_f32_16x16x32_bf16 v[144:147], v[48:51], a[48:51], v[144:147]
 s_add_u32 s72, s5, s3
 ds_read_b64_tr_b16 v[32:33], v10 offset:49152
 v_mfma_f32_16x16x32_bf16 v[144:147], v[52:55], a[52:55], v[144:147]
 ds_read_b64_tr_b16 v[34:35], v10 offset:49664
 v_cvt_pk_bf16_f32 v99, v114, v115
 v_mfma_f32_16x16x32_bf16 v[144:147], v[56:59], a[56:59], v[144:147]
 s_waitcnt lgkmcnt(2)
 buffer_load_dwordx4 v6, s[16:19], s4 offen offset:2048 lds
 v_mfma_f32_16x16x32_bf16 v[144:147], v[60:63], a[60:63], v[144:147]
 s_add_u32 s73, s5, s7
 v_cvt_pk_bf16_f32 v68, v68, v69
 v_mfma_f32_16x16x32_bf16 v[148:151], v[60:63], a[124:127], v[148:151]
 ds_read_b64_tr_b16 v[36:37], v10 offset:53248
 v_cvt_pk_bf16_f32 v69, v70, v71
 v_mfma_f32_16x16x32_bf16 v[148:151], v[56:59], a[120:123], v[148:151]
 buffer_load_dwordx4 v7, s[16:19], s4 offen offset:3072 lds
 v_mfma_f32_16x16x32_bf16 v[148:151], v[52:55], a[116:119], v[148:151]
 s_add_u32 s74, s6, s3
 ds_read_b64_tr_b16 v[38:39], v10 offset:53760
 v_mfma_f32_16x16x32_bf16 v[148:151], v[48:51], a[112:115], v[148:151]
 ds_read_b64_tr_b16 v[40:41], v10 offset:57344
 v_cvt_pk_bf16_f32 v70, v84, v85
 v_mfma_f32_16x16x32_bf16 v[152:155], v[48:51], a[176:179], v[152:155]
 ds_read_b64_tr_b16 v[42:43], v10 offset:57856
 v_cvt_pk_bf16_f32 v71, v86, v87
 v_mfma_f32_16x16x32_bf16 v[152:155], v[52:55], a[180:183], v[152:155]
 s_add_u32 s75, s6, s7
 ds_read_b64_tr_b16 v[44:45], v10 offset:61440
 v_mfma_f32_16x16x32_bf16 v[152:155], v[56:59], a[184:187], v[152:155]
 s_add_u32 m0, s58, 131072
 v_cvt_pk_bf16_f32 v100, v100, v101
 v_mfma_f32_16x16x32_bf16 v[152:155], v[60:63], a[188:191], v[152:155]
 ds_read_b64_tr_b16 v[46:47], v10 offset:61952
 v_cvt_pk_bf16_f32 v101, v102, v103
 v_mfma_f32_16x16x32_bf16 v[156:159], v[60:63], a[252:255], v[156:159]
 s_lshl_b32 s72, s72, 14
 v_mfma_f32_16x16x32_bf16 v[156:159], v[56:59], a[248:251], v[156:159]
 s_mov_b32 s4, 3145728
 v_cvt_pk_bf16_f32 v102, v116, v117
 v_mfma_f32_16x16x32_bf16 v[156:159], v[52:55], a[244:247], v[156:159]
 v_mfma_f32_16x16x32_bf16 v[156:159], v[48:51], a[240:243], v[156:159]
 s_waitcnt lgkmcnt(6)
 v_cvt_pk_bf16_f32 v103, v118, v119
 v_mfma_f32_16x16x32_bf16 v[160:163], v[32:35], a[48:51], v[160:163]
 s_waitcnt lgkmcnt(4)
 buffer_load_dwordx4 v4, s[16:19], s4 offen offset:0 lds
 v_mfma_f32_16x16x32_bf16 v[160:163], v[36:39], a[52:55], v[160:163]
 s_waitcnt lgkmcnt(2)
 v_cvt_pk_bf16_f32 v72, v72, v73
 v_mfma_f32_16x16x32_bf16 v[160:163], v[40:43], a[56:59], v[160:163]
 s_waitcnt lgkmcnt(0)
 ds_read_b64_tr_b16 v[48:49], v11 offset:49152
 v_mfma_f32_16x16x32_bf16 v[160:163], v[44:47], a[60:63], v[160:163]
 s_lshl_b32 s73, s73, 14
 ds_read_b64_tr_b16 v[50:51], v11 offset:49664
 v_mfma_f32_16x16x32_bf16 v[164:167], v[44:47], a[124:127], v[164:167]
 s_lshl_b32 s74, s74, 14
 buffer_load_dwordx4 v5, s[16:19], s4 offen offset:1024 lds
 v_mfma_f32_16x16x32_bf16 v[164:167], v[40:43], a[120:123], v[164:167]
 ds_read_b64_tr_b16 v[52:53], v11 offset:53248
 v_cvt_pk_bf16_f32 v73, v74, v75
 v_mfma_f32_16x16x32_bf16 v[164:167], v[36:39], a[116:119], v[164:167]
 s_lshl_b32 s75, s75, 14
 ds_read_b64_tr_b16 v[54:55], v11 offset:53760
 v_mfma_f32_16x16x32_bf16 v[164:167], v[32:35], a[112:115], v[164:167]
 buffer_load_dwordx4 v6, s[16:19], s4 offen offset:2048 lds
 v_mfma_f32_16x16x32_bf16 v[168:171], v[32:35], a[176:179], v[168:171]
 ds_read_b64_tr_b16 v[56:57], v11 offset:57344
 v_cvt_pk_bf16_f32 v74, v88, v89
 v_mfma_f32_16x16x32_bf16 v[168:171], v[36:39], a[180:183], v[168:171]
 s_lshl_b32 s5, s70, 8
 s_sub_u32 s6, 0x400000, s5
 v_cvt_pk_bf16_f32 v75, v90, v91
 v_mfma_f32_16x16x32_bf16 v[168:171], v[40:43], a[184:187], v[168:171]
 ds_read_b64_tr_b16 v[58:59], v11 offset:57856
 v_cvt_pk_bf16_f32 v104, v104, v105
 v_mfma_f32_16x16x32_bf16 v[168:171], v[44:47], a[188:191], v[168:171]
 buffer_load_dwordx4 v7, s[16:19], s4 offen offset:3072 lds
 ds_read_b64_tr_b16 v[60:61], v11 offset:61440
 ds_read_b64_tr_b16 v[62:63], v11 offset:61952
 v_mfma_f32_16x16x32_bf16 v[172:175], v[44:47], a[252:255], v[172:175]
 s_add_u32 s8, s40, s5
 s_addc_u32 s9, s41, 0
 s_mov_b32 s10, s6
 s_mov_b32 s11, 0x20000
 v_mfma_f32_16x16x32_bf16 v[172:175], v[40:43], a[248:251], v[172:175]
 v_cvt_pk_bf16_f32 v105, v106, v107
 v_cvt_pk_bf16_f32 v106, v120, v121
 v_mfma_f32_16x16x32_bf16 v[172:175], v[36:39], a[244:247], v[172:175]
 v_cvt_pk_bf16_f32 v107, v122, v123
 v_mfma_f32_16x16x32_bf16 v[172:175], v[32:35], a[240:243], v[172:175]
 s_waitcnt lgkmcnt(6)
 s_waitcnt vmcnt(24)
 s_barrier
 v_mfma_f32_16x16x32_bf16 v[176:179], v[48:51], a[48:51], v[176:179]
 s_waitcnt lgkmcnt(4)
 v_cvt_pk_bf16_f32 v76, v76, v77
 v_cvt_pk_bf16_f32 v77, v78, v79
 v_mfma_f32_16x16x32_bf16 v[176:179], v[52:55], a[52:55], v[176:179]
 s_waitcnt lgkmcnt(2)
 ds_read_b64_tr_b16 v[32:33], v8 offset:0
 v_mfma_f32_16x16x32_bf16 v[176:179], v[56:59], a[56:59], v[176:179]
 s_waitcnt lgkmcnt(1)
 v_cvt_pk_bf16_f32 v78, v92, v93
 v_mfma_f32_16x16x32_bf16 v[176:179], v[60:63], a[60:63], v[176:179]
 s_add_u32 s28, s60, 33554432
 s_addc_u32 s29, s61, 0
 s_mov_b32 s30, 2097152
 s_mov_b32 s31, 0x20000
 v_mfma_f32_16x16x32_bf16 v[180:183], v[60:63], a[124:127], v[180:183]
 s_add_u32 m0, s58, 32768
 ds_read_b64_tr_b16 v[34:35], v8 offset:512
 v_mfma_f32_16x16x32_bf16 v[180:183], v[56:59], a[120:123], v[180:183]
 s_mov_b32 s4, 3145856
 buffer_load_dwordx4 v4, s[16:19], s4 offen offset:0 lds
 v_mfma_f32_16x16x32_bf16 v[180:183], v[52:55], a[116:119], v[180:183]
 s_mul_i32 s5, s70, 524288
 s_add_u32 s5, s5, 16777216
 s_sub_u32 s6, 16, s71
 s_mul_i32 s6, s6, 32768
 v_mfma_f32_16x16x32_bf16 v[180:183], v[48:51], a[112:115], v[180:183]
 s_add_u32 s12, s60, s5
 s_addc_u32 s13, s61, 0
 s_mov_b32 s14, s6
 s_mov_b32 s15, 0x20000
 v_mfma_f32_16x16x32_bf16 v[184:187], v[48:51], a[176:179], v[184:187]
 buffer_load_dwordx4 v5, s[16:19], s4 offen offset:1024 lds
 v_mfma_f32_16x16x32_bf16 v[184:187], v[52:55], a[180:183], v[184:187]
 s_sub_u32 s5, s5, 16777216
 ds_read_b64_tr_b16 v[36:37], v8 offset:4096
 v_mfma_f32_16x16x32_bf16 v[184:187], v[56:59], a[184:187], v[184:187]
 buffer_load_dwordx4 v6, s[16:19], s4 offen offset:2048 lds
 v_mfma_f32_16x16x32_bf16 v[184:187], v[60:63], a[188:191], v[184:187]
 ds_read_b64_tr_b16 v[38:39], v8 offset:4608
 ds_read_b64_tr_b16 v[40:41], v8 offset:8192
 ds_read_b64_tr_b16 v[42:43], v8 offset:8704
 ds_read_b64_tr_b16 v[44:45], v8 offset:12288
 ds_read_b64_tr_b16 v[46:47], v8 offset:12800
 v_mfma_f32_16x16x32_bf16 v[188:191], v[60:63], a[252:255], v[188:191]
 s_add_u32 s32, s60, s5
 s_addc_u32 s33, s61, 0
 s_mov_b32 s34, s6
 s_mov_b32 s35, 0x20000
 v_mfma_f32_16x16x32_bf16 v[188:191], v[56:59], a[248:251], v[188:191]
 buffer_load_dwordx4 v7, s[16:19], s4 offen offset:3072 lds
 v_mfma_f32_16x16x32_bf16 v[188:191], v[52:55], a[244:247], v[188:191]
 v_cvt_pk_bf16_f32 v79, v94, v95
 v_cvt_pk_bf16_f32 v108, v108, v109
 v_mfma_f32_16x16x32_bf16 v[188:191], v[48:51], a[240:243], v[188:191]
 v_cvt_pk_bf16_f32 v109, v110, v111
 v_cvt_pk_bf16_f32 v110, v124, v125
 v_cvt_pk_bf16_f32 v111, v126, v127
 s_waitcnt lgkmcnt(6)
 v_mfma_f32_16x16x32_bf16 v[192:195], a[0:3], v[32:35], 0
 s_waitcnt lgkmcnt(4)
 ds_read_b64_tr_b16 v[48:49], v9 offset:0
 v_mfma_f32_16x16x32_bf16 v[192:195], a[4:7], v[36:39], v[192:195]
 s_waitcnt lgkmcnt(3)
 ds_read_b64_tr_b16 v[50:51], v9 offset:512
 v_mfma_f32_16x16x32_bf16 v[192:195], a[8:11], v[40:43], v[192:195]
 s_waitcnt lgkmcnt(2)
 ds_read_b64_tr_b16 v[52:53], v9 offset:4096
 v_mfma_f32_16x16x32_bf16 v[192:195], a[12:15], v[44:47], v[192:195]
 ds_read_b64_tr_b16 v[54:55], v9 offset:4608
 v_mfma_f32_16x16x32_bf16 v[196:199], a[76:79], v[44:47], 0
 buffer_store_dwordx4 v[64:67], v20, s[20:23], 0 offen offset:0 sc1
 v_mfma_f32_16x16x32_bf16 v[196:199], a[72:75], v[40:43], v[196:199]
 ds_read_b64_tr_b16 v[56:57], v9 offset:8192
 ds_read_b64_tr_b16 v[58:59], v9 offset:8704
 v_mfma_f32_16x16x32_bf16 v[196:199], a[68:71], v[36:39], v[196:199]
 v_mfma_f32_16x16x32_bf16 v[196:199], a[64:67], v[32:35], v[196:199]
 v_mfma_f32_16x16x32_bf16 v[200:203], a[128:131], v[32:35], 0
 ds_read_b64_tr_b16 v[60:61], v9 offset:12288
 v_cvt_pk_bf16_f32 v128, v128, v129
 v_mfma_f32_16x16x32_bf16 v[200:203], a[132:135], v[36:39], v[200:203]
 ds_read_b64_tr_b16 v[62:63], v9 offset:12800
 v_cvt_pk_bf16_f32 v129, v130, v131
 v_mfma_f32_16x16x32_bf16 v[200:203], a[136:139], v[40:43], v[200:203]
 v_cvt_pk_bf16_f32 v130, v144, v145
 v_cvt_pk_bf16_f32 v131, v146, v147
 v_mfma_f32_16x16x32_bf16 v[200:203], a[140:143], v[44:47], v[200:203]
 v_mfma_f32_16x16x32_bf16 v[204:207], a[204:207], v[44:47], 0
 v_cvt_pk_bf16_f32 v160, v160, v161
 v_mfma_f32_16x16x32_bf16 v[204:207], a[200:203], v[40:43], v[204:207]
 v_cvt_pk_bf16_f32 v161, v162, v163
 v_mfma_f32_16x16x32_bf16 v[204:207], a[196:199], v[36:39], v[204:207]
 v_mfma_f32_16x16x32_bf16 v[204:207], a[192:195], v[32:35], v[204:207]
 s_waitcnt lgkmcnt(2)
 v_cvt_pk_bf16_f32 v162, v176, v177
 v_mfma_f32_16x16x32_bf16 v[208:211], a[0:3], v[48:51], 0
 ds_read_b64_tr_b16 v[32:33], v10 offset:0
 ds_read_b64_tr_b16 v[34:35], v10 offset:512
 v_mfma_f32_16x16x32_bf16 v[208:211], a[4:7], v[52:55], v[208:211]
 v_cvt_pk_bf16_f32 v163, v178, v179
 v_mfma_f32_16x16x32_bf16 v[208:211], a[8:11], v[56:59], v[208:211]
 s_waitcnt lgkmcnt(2)
 ds_read_b64_tr_b16 v[36:37], v10 offset:4096
 v_mfma_f32_16x16x32_bf16 v[208:211], a[12:15], v[60:63], v[208:211]
 ds_read_b64_tr_b16 v[38:39], v10 offset:4608
 v_cvt_pk_bf16_f32 v132, v132, v133
 v_mfma_f32_16x16x32_bf16 v[212:215], a[76:79], v[60:63], 0
 v_cvt_pk_bf16_f32 v133, v134, v135
 v_mfma_f32_16x16x32_bf16 v[212:215], a[72:75], v[56:59], v[212:215]
 ds_read_b64_tr_b16 v[40:41], v10 offset:8192
 ds_read_b64_tr_b16 v[42:43], v10 offset:8704
 v_mfma_f32_16x16x32_bf16 v[212:215], a[68:71], v[52:55], v[212:215]
 v_cvt_pk_bf16_f32 v134, v148, v149
 v_mfma_f32_16x16x32_bf16 v[212:215], a[64:67], v[48:51], v[212:215]
 buffer_store_dwordx4 v[96:99], v20, s[20:23], 0 offen offset:1024 sc1
 v_mfma_f32_16x16x32_bf16 v[216:219], a[128:131], v[48:51], 0
 ds_read_b64_tr_b16 v[44:45], v10 offset:12288
 v_cvt_pk_bf16_f32 v135, v150, v151
 v_mfma_f32_16x16x32_bf16 v[216:219], a[132:135], v[52:55], v[216:219]
 ds_read_b64_tr_b16 v[46:47], v10 offset:12800
 v_mfma_f32_16x16x32_bf16 v[216:219], a[136:139], v[56:59], v[216:219]
 v_cvt_pk_bf16_f32 v164, v164, v165
 v_mfma_f32_16x16x32_bf16 v[216:219], a[140:143], v[60:63], v[216:219]
 v_cvt_pk_bf16_f32 v165, v166, v167
 v_mfma_f32_16x16x32_bf16 v[220:223], a[204:207], v[60:63], 0
 v_mfma_f32_16x16x32_bf16 v[220:223], a[200:203], v[56:59], v[220:223]
 v_cvt_pk_bf16_f32 v166, v180, v181
 v_mfma_f32_16x16x32_bf16 v[220:223], a[196:199], v[52:55], v[220:223]
 v_mfma_f32_16x16x32_bf16 v[220:223], a[192:195], v[48:51], v[220:223]
 s_waitcnt lgkmcnt(2)
 v_cvt_pk_bf16_f32 v167, v182, v183
 v_mfma_f32_16x16x32_bf16 v[224:227], a[0:3], v[32:35], 0
 ds_read_b64_tr_b16 v[48:49], v11 offset:0
 ds_read_b64_tr_b16 v[50:51], v11 offset:512
 v_mfma_f32_16x16x32_bf16 v[224:227], a[4:7], v[36:39], v[224:227]
 v_cvt_pk_bf16_f32 v136, v136, v137
 v_mfma_f32_16x16x32_bf16 v[224:227], a[8:11], v[40:43], v[224:227]
 s_waitcnt lgkmcnt(2)
 v_cvt_pk_bf16_f32 v137, v138, v139
 v_mfma_f32_16x16x32_bf16 v[224:227], a[12:15], v[44:47], v[224:227]
 ds_read_b64_tr_b16 v[52:53], v11 offset:4096
 ds_read_b64_tr_b16 v[54:55], v11 offset:4608
 v_mfma_f32_16x16x32_bf16 v[228:231], a[76:79], v[44:47], 0
 v_cvt_pk_bf16_f32 v138, v152, v153
 v_mfma_f32_16x16x32_bf16 v[228:231], a[72:75], v[40:43], v[228:231]
 ds_read_b64_tr_b16 v[56:57], v11 offset:8192
 ds_read_b64_tr_b16 v[58:59], v11 offset:8704
 v_mfma_f32_16x16x32_bf16 v[228:231], a[68:71], v[36:39], v[228:231]
 v_cvt_pk_bf16_f32 v139, v154, v155
 v_mfma_f32_16x16x32_bf16 v[228:231], a[64:67], v[32:35], v[228:231]
 v_mfma_f32_16x16x32_bf16 v[232:235], a[128:131], v[32:35], 0
 ds_read_b64_tr_b16 v[60:61], v11 offset:12288
 v_cvt_pk_bf16_f32 v168, v168, v169
 v_mfma_f32_16x16x32_bf16 v[232:235], a[132:135], v[36:39], v[232:235]
 ds_read_b64_tr_b16 v[62:63], v11 offset:12800
 v_cvt_pk_bf16_f32 v169, v170, v171
 v_mfma_f32_16x16x32_bf16 v[232:235], a[136:139], v[40:43], v[232:235]
 buffer_store_dwordx4 v[68:71], v20, s[20:23], s64 offen offset:0 sc1
 v_mfma_f32_16x16x32_bf16 v[232:235], a[140:143], v[44:47], v[232:235]
 v_cvt_pk_bf16_f32 v170, v184, v185
 v_mfma_f32_16x16x32_bf16 v[236:239], a[204:207], v[44:47], 0
 v_mfma_f32_16x16x32_bf16 v[236:239], a[200:203], v[40:43], v[236:239]
 v_cvt_pk_bf16_f32 v171, v186, v187
 v_mfma_f32_16x16x32_bf16 v[236:239], a[196:199], v[36:39], v[236:239]
 v_mfma_f32_16x16x32_bf16 v[236:239], a[192:195], v[32:35], v[236:239]
 s_waitcnt lgkmcnt(2)
 s_waitcnt vmcnt(23)
 s_barrier
 v_mfma_f32_16x16x32_bf16 v[240:243], a[0:3], v[48:51], 0
 s_add_u32 m0, s58, 49152
 v_add_u32 v8, 0x10000, v8
 v_cvt_pk_bf16_f32 v140, v140, v141
 v_mfma_f32_16x16x32_bf16 v[240:243], a[4:7], v[52:55], v[240:243]
 ds_read_b64_tr_b16 v[32:33], v8 offset:0
 v_cvt_pk_bf16_f32 v141, v142, v143
 v_mfma_f32_16x16x32_bf16 v[240:243], a[8:11], v[56:59], v[240:243]
 s_waitcnt lgkmcnt(1)
 v_cvt_pk_bf16_f32 v142, v156, v157
 v_mfma_f32_16x16x32_bf16 v[240:243], a[12:15], v[60:63], v[240:243]
 s_mov_b32 s4, 0
 ds_read_b64_tr_b16 v[34:35], v8 offset:512
 v_mfma_f32_16x16x32_bf16 v[244:247], a[76:79], v[60:63], 0
 ds_read_b64_tr_b16 v[36:37], v8 offset:4096
 v_cvt_pk_bf16_f32 v143, v158, v159
 v_mfma_f32_16x16x32_bf16 v[244:247], a[72:75], v[56:59], v[244:247]
 buffer_load_dwordx4 v4, s[8:11], s4 offen offset:0 lds
 v_mfma_f32_16x16x32_bf16 v[244:247], a[68:71], v[52:55], v[244:247]
 ds_read_b64_tr_b16 v[38:39], v8 offset:4608
 v_cvt_pk_bf16_f32 v172, v172, v173
 v_mfma_f32_16x16x32_bf16 v[244:247], a[64:67], v[48:51], v[244:247]
 buffer_load_dwordx4 v5, s[8:11], s4 offen offset:1024 lds
 v_mfma_f32_16x16x32_bf16 v[248:251], a[128:131], v[48:51], 0
 ds_read_b64_tr_b16 v[40:41], v8 offset:8192
 v_cvt_pk_bf16_f32 v173, v174, v175
 v_mfma_f32_16x16x32_bf16 v[248:251], a[132:135], v[52:55], v[248:251]
 ds_read_b64_tr_b16 v[42:43], v8 offset:8704
 v_cvt_pk_bf16_f32 v174, v188, v189
 v_mfma_f32_16x16x32_bf16 v[248:251], a[136:139], v[56:59], v[248:251]
 buffer_load_dwordx4 v6, s[8:11], s4 offen offset:2048 lds
 v_mfma_f32_16x16x32_bf16 v[248:251], a[140:143], v[60:63], v[248:251]
 ds_read_b64_tr_b16 v[44:45], v8 offset:12288
 v_cvt_pk_bf16_f32 v175, v190, v191
 ds_read_b64_tr_b16 v[46:47], v8 offset:12800
 v_mfma_f32_16x16x32_bf16 v[252:255], a[204:207], v[60:63], 0
 buffer_load_dwordx4 v7, s[8:11], s4 offen offset:3072 lds
 v_mfma_f32_16x16x32_bf16 v[252:255], a[200:203], v[56:59], v[252:255]
 v_mfma_f32_16x16x32_bf16 v[252:255], a[196:199], v[52:55], v[252:255]
 v_mfma_f32_16x16x32_bf16 v[252:255], a[192:195], v[48:51], v[252:255]
 s_waitcnt lgkmcnt(6)
 v_mfma_f32_16x16x32_bf16 v[80:83], a[0:3], v[32:35], 0
 s_waitcnt lgkmcnt(4)
 buffer_load_dword v16, v18, s[96:99], 0 offen sc1
 v_mfma_f32_16x16x32_bf16 v[80:83], a[4:7], v[36:39], v[80:83]
 s_waitcnt lgkmcnt(2)
 v_add_u32 v9, 0x10000, v9
 v_mfma_f32_16x16x32_bf16 v[80:83], a[8:11], v[40:43], v[80:83]
 s_waitcnt lgkmcnt(0)
 ds_read_b64_tr_b16 v[48:49], v9 offset:0
 v_mfma_f32_16x16x32_bf16 v[80:83], a[12:15], v[44:47], v[80:83]
 ds_read_b64_tr_b16 v[50:51], v9 offset:512
 ds_read_b64_tr_b16 v[52:53], v9 offset:4096
 v_mfma_f32_16x16x32_bf16 v[84:87], a[76:79], v[44:47], 0
 buffer_store_dwordx4 v[100:103], v20, s[20:23], s64 offen offset:1024 sc1
 v_mfma_f32_16x16x32_bf16 v[84:87], a[72:75], v[40:43], v[84:87]
 ds_read_b64_tr_b16 v[54:55], v9 offset:4608
 ds_read_b64_tr_b16 v[56:57], v9 offset:8192
 v_mfma_f32_16x16x32_bf16 v[84:87], a[68:71], v[36:39], v[84:87]
 v_mfma_f32_16x16x32_bf16 v[84:87], a[64:67], v[32:35], v[84:87]
 ds_read_b64_tr_b16 v[58:59], v9 offset:8704
 ds_read_b64_tr_b16 v[60:61], v9 offset:12288
 v_mfma_f32_16x16x32_bf16 v[88:91], a[128:131], v[32:35], 0
 v_mfma_f32_16x16x32_bf16 v[88:91], a[132:135], v[36:39], v[88:91]
 ds_read_b64_tr_b16 v[62:63], v9 offset:12800
 v_mfma_f32_16x16x32_bf16 v[88:91], a[136:139], v[40:43], v[88:91]
 v_mfma_f32_16x16x32_bf16 v[88:91], a[140:143], v[44:47], v[88:91]
 v_mfma_f32_16x16x32_bf16 v[92:95], a[204:207], v[44:47], 0
 v_mfma_f32_16x16x32_bf16 v[92:95], a[200:203], v[40:43], v[92:95]
 v_mfma_f32_16x16x32_bf16 v[92:95], a[196:199], v[36:39], v[92:95]
 v_mfma_f32_16x16x32_bf16 v[92:95], a[192:195], v[32:35], v[92:95]
 s_waitcnt lgkmcnt(4)
 v_mfma_f32_16x16x32_bf16 v[112:115], a[0:3], v[48:51], 0
 v_add_u32 v10, 0x10000, v10
 v_mfma_f32_16x16x32_bf16 v[112:115], a[4:7], v[52:55], v[112:115]
 s_waitcnt lgkmcnt(2)
 ds_read_b64_tr_b16 v[32:33], v10 offset:0
 v_mfma_f32_16x16x32_bf16 v[112:115], a[8:11], v[56:59], v[112:115]
 s_waitcnt lgkmcnt(1)
 ds_read_b64_tr_b16 v[34:35], v10 offset:512
 v_mfma_f32_16x16x32_bf16 v[112:115], a[12:15], v[60:63], v[112:115]
 ds_read_b64_tr_b16 v[36:37], v10 offset:4096
 ds_read_b64_tr_b16 v[38:39], v10 offset:4608
 v_mfma_f32_16x16x32_bf16 v[116:119], a[76:79], v[60:63], 0
 v_mfma_f32_16x16x32_bf16 v[116:119], a[72:75], v[56:59], v[116:119]
 ds_read_b64_tr_b16 v[40:41], v10 offset:8192
 v_mfma_f32_16x16x32_bf16 v[116:119], a[68:71], v[52:55], v[116:119]
 v_mfma_f32_16x16x32_bf16 v[116:119], a[64:67], v[48:51], v[116:119]
 buffer_store_dwordx4 v[72:75], v20, s[20:23], s65 offen offset:0 sc1
 v_mfma_f32_16x16x32_bf16 v[120:123], a[128:131], v[48:51], 0
 ds_read_b64_tr_b16 v[42:43], v10 offset:8704
 ds_read_b64_tr_b16 v[44:45], v10 offset:12288
 v_mfma_f32_16x16x32_bf16 v[120:123], a[132:135], v[52:55], v[120:123]
 ds_read_b64_tr_b16 v[46:47], v10 offset:12800
 v_mfma_f32_16x16x32_bf16 v[120:123], a[136:139], v[56:59], v[120:123]
 v_mfma_f32_16x16x32_bf16 v[120:123], a[140:143], v[60:63], v[120:123]
 v_mfma_f32_16x16x32_bf16 v[124:127], a[204:207], v[60:63], 0
 v_mfma_f32_16x16x32_bf16 v[124:127], a[200:203], v[56:59], v[124:127]
 v_mfma_f32_16x16x32_bf16 v[124:127], a[196:199], v[52:55], v[124:127]
 v_mfma_f32_16x16x32_bf16 v[124:127], a[192:195], v[48:51], v[124:127]
 s_waitcnt lgkmcnt(4)
 v_mfma_f32_16x16x32_bf16 v[144:147], a[0:3], v[32:35], 0
 v_add_u32 v11, 0x10000, v11
 v_mfma_f32_16x16x32_bf16 v[144:147], a[4:7], v[36:39], v[144:147]
 s_waitcnt lgkmcnt(2)
 ds_read_b64_tr_b16 v[48:49], v11 offset:0
 v_mfma_f32_16x16x32_bf16 v[144:147], a[8:11], v[40:43], v[144:147]
 s_waitcnt lgkmcnt(1)
 ds_read_b64_tr_b16 v[50:51], v11 offset:512
 v_mfma_f32_16x16x32_bf16 v[144:147], a[12:15], v[44:47], v[144:147]
 ds_read_b64_tr_b16 v[52:53], v11 offset:4096
 ds_read_b64_tr_b16 v[54:55], v11 offset:4608
 v_mfma_f32_16x16x32_bf16 v[148:151], a[76:79], v[44:47], 0
 v_mfma_f32_16x16x32_bf16 v[148:151], a[72:75], v[40:43], v[148:151]
 ds_read_b64_tr_b16 v[56:57], v11 offset:8192
 v_mfma_f32_16x16x32_bf16 v[148:151], a[68:71], v[36:39], v[148:151]
 v_mfma_f32_16x16x32_bf16 v[148:151], a[64:67], v[32:35], v[148:151]
 ds_read_b64_tr_b16 v[58:59], v11 offset:8704
 ds_read_b64_tr_b16 v[60:61], v11 offset:12288
 v_mfma_f32_16x16x32_bf16 v[152:155], a[128:131], v[32:35], 0
 v_mfma_f32_16x16x32_bf16 v[152:155], a[132:135], v[36:39], v[152:155]
 ds_read_b64_tr_b16 v[62:63], v11 offset:12800
 v_mfma_f32_16x16x32_bf16 v[152:155], a[136:139], v[40:43], v[152:155]
 buffer_store_dwordx4 v[104:107], v20, s[20:23], s65 offen offset:1024 sc1
 v_mfma_f32_16x16x32_bf16 v[152:155], a[140:143], v[44:47], v[152:155]
 v_mfma_f32_16x16x32_bf16 v[156:159], a[204:207], v[44:47], 0
 s_waitcnt vmcnt(3)
 v_mfma_f32_16x16x32_bf16 v[156:159], a[200:203], v[40:43], v[156:159]
 v_cmp_ne_u32 vcc, s100, v16
 v_mfma_f32_16x16x32_bf16 v[156:159], a[196:199], v[36:39], v[156:159]
 v_mfma_f32_16x16x32_bf16 v[156:159], a[192:195], v[32:35], v[156:159]
 s_waitcnt lgkmcnt(4)
 v_mfma_f32_16x16x32_bf16 v[176:179], a[0:3], v[48:51], 0
 ds_read_b64_tr_b16 v[32:33], v8 offset:16384
 ds_read_b64_tr_b16 v[34:35], v8 offset:16896
 v_mfma_f32_16x16x32_bf16 v[176:179], a[4:7], v[52:55], v[176:179]
 s_waitcnt lgkmcnt(4)
 v_mfma_f32_16x16x32_bf16 v[176:179], a[8:11], v[56:59], v[176:179]
 s_waitcnt lgkmcnt(2)
 ds_read_b64_tr_b16 v[36:37], v8 offset:20480
 v_mfma_f32_16x16x32_bf16 v[176:179], a[12:15], v[60:63], v[176:179]
 ds_read_b64_tr_b16 v[38:39], v8 offset:20992
 v_mfma_f32_16x16x32_bf16 v[180:183], a[76:79], v[60:63], 0
 v_mfma_f32_16x16x32_bf16 v[180:183], a[72:75], v[56:59], v[180:183]
 s_nop 0
 ds_read_b64_tr_b16 v[40:41], v8 offset:24576
 v_mfma_f32_16x16x32_bf16 v[180:183], a[68:71], v[52:55], v[180:183]
 ds_read_b64_tr_b16 v[42:43], v8 offset:25088
 v_mfma_f32_16x16x32_bf16 v[180:183], a[64:67], v[48:51], v[180:183]
 v_mfma_f32_16x16x32_bf16 v[184:187], a[128:131], v[48:51], 0
 ds_read_b64_tr_b16 v[44:45], v8 offset:28672
 ds_read_b64_tr_b16 v[46:47], v8 offset:29184
 v_mfma_f32_16x16x32_bf16 v[184:187], a[132:135], v[52:55], v[184:187]
 v_mfma_f32_16x16x32_bf16 v[184:187], a[136:139], v[56:59], v[184:187]
 s_cbranch_vccnz L_po_3
L_pb_4:
 v_mfma_f32_16x16x32_bf16 v[184:187], a[140:143], v[60:63], v[184:187]
 v_mfma_f32_16x16x32_bf16 v[188:191], a[204:207], v[60:63], 0
 v_mfma_f32_16x16x32_bf16 v[188:191], a[200:203], v[56:59], v[188:191]
 v_mfma_f32_16x16x32_bf16 v[188:191], a[196:199], v[52:55], v[188:191]
 v_mfma_f32_16x16x32_bf16 v[188:191], a[192:195], v[48:51], v[188:191]
 s_waitcnt lgkmcnt(4)
 v_mfma_f32_16x16x32_bf16 v[192:195], a[16:19], v[32:35], v[192:195]
 ds_read_b64_tr_b16 v[48:49], v9 offset:16384
 ds_read_b64_tr_b16 v[50:51], v9 offset:16896
 v_mfma_f32_16x16x32_bf16 v[192:195], a[20:23], v[36:39], v[192:195]
 s_waitcnt lgkmcnt(4)
 v_mfma_f32_16x16x32_bf16 v[192:195], a[24:27], v[40:43], v[192:195]
 s_waitcnt lgkmcnt(2)
 ds_read_b64_tr_b16 v[52:53], v9 offset:20480
 v_mfma_f32_16x16x32_bf16 v[192:195], a[28:31], v[44:47], v[192:195]
 ds_read_b64_tr_b16 v[54:55], v9 offset:20992
 v_mfma_f32_16x16x32_bf16 v[196:199], a[92:95], v[44:47], v[196:199]
 s_add_u32 s5, s72, 0
 buffer_store_dwordx4 v[76:79], v20, s[20:23], s66 offen offset:0 sc1
 v_mfma_f32_16x16x32_bf16 v[196:199], a[88:91], v[40:43], v[196:199]
 ds_read_b64_tr_b16 v[56:57], v9 offset:24576
 ds_read_b64_tr_b16 v[58:59], v9 offset:25088
 v_mfma_f32_16x16x32_bf16 v[196:199], a[84:87], v[36:39], v[196:199]
 v_mfma_f32_16x16x32_bf16 v[196:199], a[80:83], v[32:35], v[196:199]
 v_mfma_f32_16x16x32_bf16 v[200:203], a[144:147], v[32:35], v[200:203]
 ds_read_b64_tr_b16 v[60:61], v9 offset:28672
 ds_read_b64_tr_b16 v[62:63], v9 offset:29184
 v_mfma_f32_16x16x32_bf16 v[200:203], a[148:151], v[36:39], v[200:203]
 v_mfma_f32_16x16x32_bf16 v[200:203], a[152:155], v[40:43], v[200:203]
 v_mfma_f32_16x16x32_bf16 v[200:203], a[156:159], v[44:47], v[200:203]
 v_mfma_f32_16x16x32_bf16 v[204:207], a[220:223], v[44:47], v[204:207]
 buffer_load_dwordx4 a[0:3], v12, s[28:31], s5 offen offset:0 sc1
 v_mfma_f32_16x16x32_bf16 v[204:207], a[216:219], v[40:43], v[204:207]
 v_mfma_f32_16x16x32_bf16 v[204:207], a[212:215], v[36:39], v[204:207]
 v_mfma_f32_16x16x32_bf16 v[204:207], a[208:211], v[32:35], v[204:207]
 s_waitcnt lgkmcnt(2)
 v_mfma_f32_16x16x32_bf16 v[208:211], a[16:19], v[48:51], v[208:211]
 ds_read_b64_tr_b16 v[32:33], v10 offset:16384
 ds_read_b64_tr_b16 v[34:35], v10 offset:16896
 v_mfma_f32_16x16x32_bf16 v[208:211], a[20:23], v[52:55], v[208:211]
 v_mfma_f32_16x16x32_bf16 v[208:211], a[24:27], v[56:59], v[208:211]
 s_waitcnt lgkmcnt(2)
 ds_read_b64_tr_b16 v[36:37], v10 offset:20480
 v_mfma_f32_16x16x32_bf16 v[208:211], a[28:31], v[60:63], v[208:211]
 ds_read_b64_tr_b16 v[38:39], v10 offset:20992
 v_mfma_f32_16x16x32_bf16 v[212:215], a[92:95], v[60:63], v[212:215]
 v_mfma_f32_16x16x32_bf16 v[212:215], a[88:91], v[56:59], v[212:215]
 buffer_load_dwordx4 a[4:7], v12, s[28:31], s5 offen offset:1024 sc1
 v_mfma_f32_16x16x32_bf16 v[212:215], a[84:87], v[52:55], v[212:215]
 ds_read_b64_tr_b16 v[40:41], v10 offset:24576
 ds_read_b64_tr_b16 v[42:43], v10 offset:25088
 v_mfma_f32_16x16x32_bf16 v[212:215], a[80:83], v[48:51], v[212:215]
 v_mfma_f32_16x16x32_bf16 v[216:219], a[144:147], v[48:51], v[216:219]
 ds_read_b64_tr_b16 v[44:45], v10 offset:28672
 ds_read_b64_tr_b16 v[46:47], v10 offset:29184
 v_mfma_f32_16x16x32_bf16 v[216:219], a[148:151], v[52:55], v[216:219]
 v_mfma_f32_16x16x32_bf16 v[216:219], a[152:155], v[56:59], v[216:219]
 v_mfma_f32_16x16x32_bf16 v[216:219], a[156:159], v[60:63], v[216:219]
 v_mfma_f32_16x16x32_bf16 v[220:223], a[220:223], v[60:63], v[220:223]
 v_mfma_f32_16x16x32_bf16 v[220:223], a[216:219], v[56:59], v[220:223]
 buffer_load_dwordx4 a[8:11], v12, s[28:31], s5 offen offset:2048 sc1
 v_mfma_f32_16x16x32_bf16 v[220:223], a[212:215], v[52:55], v[220:223]
 v_mfma_f32_16x16x32_bf16 v[220:223], a[208:211], v[48:51], v[220:223]
 s_waitcnt lgkmcnt(4)
 v_mfma_f32_16x16x32_bf16 v[224:227], a[16:19], v[32:35], v[224:227]
 buffer_store_dwordx4 v[108:111], v20, s[20:23], s66 offen offset:1024 sc1
 v_mfma_f32_16x16x32_bf16 v[224:227], a[20:23], v[36:39], v[224:227]
 s_waitcnt lgkmcnt(2)
 ds_read_b64_tr_b16 v[48:49], v11 offset:16384
 v_mfma_f32_16x16x32_bf16 v[224:227], a[24:27], v[40:43], v[224:227]
 s_waitcnt lgkmcnt(1)
 ds_read_b64_tr_b16 v[50:51], v11 offset:16896
 v_mfma_f32_16x16x32_bf16 v[224:227], a[28:31], v[44:47], v[224:227]
 ds_read_b64_tr_b16 v[52:53], v11 offset:20480
 ds_read_b64_tr_b16 v[54:55], v11 offset:20992
 v_mfma_f32_16x16x32_bf16 v[228:231], a[92:95], v[44:47], v[228:231]
 v_mfma_f32_16x16x32_bf16 v[228:231], a[88:91], v[40:43], v[228:231]
 ds_read_b64_tr_b16 v[56:57], v11 offset:24576
 ds_read_b64_tr_b16 v[58:59], v11 offset:25088
 v_mfma_f32_16x16x32_bf16 v[228:231], a[84:87], v[36:39], v[228:231]
 buffer_load_dwordx4 a[12:15], v12, s[28:31], s5 offen offset:3072 sc1
 v_mfma_f32_16x16x32_bf16 v[228:231], a[80:83], v[32:35], v[228:231]
 v_mfma_f32_16x16x32_bf16 v[232:235], a[144:147], v[32:35], v[232:235]
 ds_read_b64_tr_b16 v[60:61], v11 offset:28672
 ds_read_b64_tr_b16 v[62:63], v11 offset:29184
 v_mfma_f32_16x16x32_bf16 v[232:235], a[148:151], v[36:39], v[232:235]
 v_mfma_f32_16x16x32_bf16 v[232:235], a[152:155], v[40:43], v[232:235]
 v_mfma_f32_16x16x32_bf16 v[232:235], a[156:159], v[44:47], v[232:235]
 v_mfma_f32_16x16x32_bf16 v[236:239], a[220:223], v[44:47], v[236:239]
 v_mfma_f32_16x16x32_bf16 v[236:239], a[216:219], v[40:43], v[236:239]
 v_mfma_f32_16x16x32_bf16 v[236:239], a[212:215], v[36:39], v[236:239]
 v_mfma_f32_16x16x32_bf16 v[236:239], a[208:211], v[32:35], v[236:239]
 s_waitcnt lgkmcnt(2)
 s_barrier
 v_mfma_f32_16x16x32_bf16 v[240:243], a[16:19], v[48:51], v[240:243]
 s_add_u32 m0, s58, 0
 ds_read_b64_tr_b16 v[32:33], v8 offset:32768
 v_mfma_f32_16x16x32_bf16 v[240:243], a[20:23], v[52:55], v[240:243]
 ds_read_b64_tr_b16 v[34:35], v8 offset:33280
 ds_read_b64_tr_b16 v[36:37], v8 offset:36864
 v_mfma_f32_16x16x32_bf16 v[240:243], a[24:27], v[56:59], v[240:243]
 s_waitcnt lgkmcnt(3)
 v_mfma_f32_16x16x32_bf16 v[240:243], a[28:31], v[60:63], v[240:243]
 s_mov_b32 s4, 128
 ds_read_b64_tr_b16 v[38:39], v8 offset:37376
 v_mfma_f32_16x16x32_bf16 v[244:247], a[92:95], v[60:63], v[244:247]
 v_mfma_f32_16x16x32_bf16 v[244:247], a[88:91], v[56:59], v[244:247]
 buffer_load_dwordx4 v4, s[8:11], s4 offen offset:0 lds
 v_mfma_f32_16x16x32_bf16 v[244:247], a[84:87], v[52:55], v[244:247]
 ds_read_b64_tr_b16 v[40:41], v8 offset:40960
 ds_read_b64_tr_b16 v[42:43], v8 offset:41472
 v_mfma_f32_16x16x32_bf16 v[244:247], a[80:83], v[48:51], v[244:247]
 buffer_load_dwordx4 v5, s[8:11], s4 offen offset:1024 lds
 v_mfma_f32_16x16x32_bf16 v[248:251], a[144:147], v[48:51], v[248:251]
 ds_read_b64_tr_b16 v[44:45], v8 offset:45056
 ds_read_b64_tr_b16 v[46:47], v8 offset:45568
 v_mfma_f32_16x16x32_bf16 v[248:251], a[148:151], v[52:55], v[248:251]
 v_mfma_f32_16x16x32_bf16 v[248:251], a[152:155], v[56:59], v[248:251]
 buffer_load_dwordx4 v6, s[8:11], s4 offen offset:2048 lds
 v_mfma_f32_16x16x32_bf16 v[248:251], a[156:159], v[60:63], v[248:251]
 v_mfma_f32_16x16x32_bf16 v[252:255], a[220:223], v[60:63], v[252:255]
 buffer_load_dwordx4 v7, s[8:11], s4 offen offset:3072 lds
 v_mfma_f32_16x16x32_bf16 v[252:255], a[216:219], v[56:59], v[252:255]
 v_mfma_f32_16x16x32_bf16 v[252:255], a[212:215], v[52:55], v[252:255]
 v_mfma_f32_16x16x32_bf16 v[252:255], a[208:211], v[48:51], v[252:255]
 s_waitcnt lgkmcnt(4)
 v_mfma_f32_16x16x32_bf16 v[80:83], a[16:19], v[32:35], v[80:83]
 ds_read_b64_tr_b16 v[48:49], v9 offset:32768
 ds_read_b64_tr_b16 v[50:51], v9 offset:33280
 v_mfma_f32_16x16x32_bf16 v[80:83], a[20:23], v[36:39], v[80:83]
 s_waitcnt lgkmcnt(4)
 v_mfma_f32_16x16x32_bf16 v[80:83], a[24:27], v[40:43], v[80:83]
 s_waitcnt lgkmcnt(2)
 ds_read_b64_tr_b16 v[52:53], v9 offset:36864
 v_mfma_f32_16x16x32_bf16 v[80:83], a[28:31], v[44:47], v[80:83]
 ds_read_b64_tr_b16 v[54:55], v9 offset:37376
 v_mfma_f32_16x16x32_bf16 v[84:87], a[92:95], v[44:47], v[84:87]
 s_add_u32 s5, s73, 0
 buffer_store_dwordx4 v[128:131], v20, s[20:23], 0 offen offset:2048 sc1
 v_mfma_f32_16x16x32_bf16 v[84:87], a[88:91], v[40:43], v[84:87]
 ds_read_b64_tr_b16 v[56:57], v9 offset:40960
 ds_read_b64_tr_b16 v[58:59], v9 offset:41472
 v_mfma_f32_16x16x32_bf16 v[84:87], a[84:87], v[36:39], v[84:87]
 v_mfma_f32_16x16x32_bf16 v[84:87], a[80:83], v[32:35], v[84:87]
 v_mfma_f32_16x16x32_bf16 v[88:91], a[144:147], v[32:35], v[88:91]
 ds_read_b64_tr_b16 v[60:61], v9 offset:45056
 ds_read_b64_tr_b16 v[62:63], v9 offset:45568
 v_mfma_f32_16x16x32_bf16 v[88:91], a[148:151], v[36:39], v[88:91]
 v_mfma_f32_16x16x32_bf16 v[88:91], a[152:155], v[40:43], v[88:91]
 v_mfma_f32_16x16x32_bf16 v[88:91], a[156:159], v[44:47], v[88:91]
 v_mfma_f32_16x16x32_bf16 v[92:95], a[220:223], v[44:47], v[92:95]
 buffer_load_dwordx4 a[64:67], v12, s[28:31], s5 offen offset:0 sc1
 v_mfma_f32_16x16x32_bf16 v[92:95], a[216:219], v[40:43], v[92:95]
 v_mfma_f32_16x16x32_bf16 v[92:95], a[212:215], v[36:39], v[92:95]
 v_mfma_f32_16x16x32_bf16 v[92:95], a[208:211], v[32:35], v[92:95]
 s_waitcnt lgkmcnt(2)
 v_mfma_f32_16x16x32_bf16 v[112:115], a[16:19], v[48:51], v[112:115]
 ds_read_b64_tr_b16 v[32:33], v10 offset:32768
 ds_read_b64_tr_b16 v[34:35], v10 offset:33280
 v_mfma_f32_16x16x32_bf16 v[112:115], a[20:23], v[52:55], v[112:115]
 v_mfma_f32_16x16x32_bf16 v[112:115], a[24:27], v[56:59], v[112:115]
 s_waitcnt lgkmcnt(2)
 ds_read_b64_tr_b16 v[36:37], v10 offset:36864
 v_mfma_f32_16x16x32_bf16 v[112:115], a[28:31], v[60:63], v[112:115]
 ds_read_b64_tr_b16 v[38:39], v10 offset:37376
 v_mfma_f32_16x16x32_bf16 v[116:119], a[92:95], v[60:63], v[116:119]
 v_mfma_f32_16x16x32_bf16 v[116:119], a[88:91], v[56:59], v[116:119]
 buffer_load_dwordx4 a[68:71], v12, s[28:31], s5 offen offset:1024 sc1
 v_mfma_f32_16x16x32_bf16 v[116:119], a[84:87], v[52:55], v[116:119]
 ds_read_b64_tr_b16 v[40:41], v10 offset:40960
 ds_read_b64_tr_b16 v[42:43], v10 offset:41472
 v_mfma_f32_16x16x32_bf16 v[116:119], a[80:83], v[48:51], v[116:119]
 v_mfma_f32_16x16x32_bf16 v[120:123], a[144:147], v[48:51], v[120:123]
 ds_read_b64_tr_b16 v[44:45], v10 offset:45056
 ds_read_b64_tr_b16 v[46:47], v10 offset:45568
 v_mfma_f32_16x16x32_bf16 v[120:123], a[148:151], v[52:55], v[120:123]
 v_mfma_f32_16x16x32_bf16 v[120:123], a[152:155], v[56:59], v[120:123]
 v_mfma_f32_16x16x32_bf16 v[120:123], a[156:159], v[60:63], v[120:123]
 v_mfma_f32_16x16x32_bf16 v[124:127], a[220:223], v[60:63], v[124:127]
 v_mfma_f32_16x16x32_bf16 v[124:127], a[216:219], v[56:59], v[124:127]
 buffer_load_dwordx4 a[72:75], v12, s[28:31], s5 offen offset:2048 sc1
 v_mfma_f32_16x16x32_bf16 v[124:127], a[212:215], v[52:55], v[124:127]
 v_mfma_f32_16x16x32_bf16 v[124:127], a[208:211], v[48:51], v[124:127]
 s_waitcnt lgkmcnt(4)
 v_mfma_f32_16x16x32_bf16 v[144:147], a[16:19], v[32:35], v[144:147]
 buffer_store_dwordx4 v[160:163], v20, s[20:23], 0 offen offset:3072 sc1
 v_mfma_f32_16x16x32_bf16 v[144:147], a[20:23], v[36:39], v[144:147]
 s_waitcnt lgkmcnt(2)
 ds_read_b64_tr_b16 v[48:49], v11 offset:32768
 v_mfma_f32_16x16x32_bf16 v[144:147], a[24:27], v[40:43], v[144:147]
 s_waitcnt lgkmcnt(1)
 ds_read_b64_tr_b16 v[50:51], v11 offset:33280
 v_mfma_f32_16x16x32_bf16 v[144:147], a[28:31], v[44:47], v[144:147]
 ds_read_b64_tr_b16 v[52:53], v11 offset:36864
 ds_read_b64_tr_b16 v[54:55], v11 offset:37376
 v_mfma_f32_16x16x32_bf16 v[148:151], a[92:95], v[44:47], v[148:151]
 v_mfma_f32_16x16x32_bf16 v[148:151], a[88:91], v[40:43], v[148:151]
 ds_read_b64_tr_b16 v[56:57], v11 offset:40960
 ds_read_b64_tr_b16 v[58:59], v11 offset:41472
 v_mfma_f32_16x16x32_bf16 v[148:151], a[84:87], v[36:39], v[148:151]
 buffer_load_dwordx4 a[76:79], v12, s[28:31], s5 offen offset:3072 sc1
 v_mfma_f32_16x16x32_bf16 v[148:151], a[80:83], v[32:35], v[148:151]
 v_mfma_f32_16x16x32_bf16 v[152:155], a[144:147], v[32:35], v[152:155]
 ds_read_b64_tr_b16 v[60:61], v11 offset:45056
 ds_read_b64_tr_b16 v[62:63], v11 offset:45568
 v_mfma_f32_16x16x32_bf16 v[152:155], a[148:151], v[36:39], v[152:155]
 v_mfma_f32_16x16x32_bf16 v[152:155], a[152:155], v[40:43], v[152:155]
 v_mfma_f32_16x16x32_bf16 v[152:155], a[156:159], v[44:47], v[152:155]
 v_mfma_f32_16x16x32_bf16 v[156:159], a[220:223], v[44:47], v[156:159]
 v_mfma_f32_16x16x32_bf16 v[156:159], a[216:219], v[40:43], v[156:159]
 v_mfma_f32_16x16x32_bf16 v[156:159], a[212:215], v[36:39], v[156:159]
 v_mfma_f32_16x16x32_bf16 v[156:159], a[208:211], v[32:35], v[156:159]
 s_waitcnt lgkmcnt(2)
 v_mfma_f32_16x16x32_bf16 v[176:179], a[16:19], v[48:51], v[176:179]
 s_add_u32 m0, s58, 65536
 ds_read_b64_tr_b16 v[32:33], v8 offset:49152
 v_mfma_f32_16x16x32_bf16 v[176:179], a[20:23], v[52:55], v[176:179]
 ds_read_b64_tr_b16 v[34:35], v8 offset:49664
 ds_read_b64_tr_b16 v[36:37], v8 offset:53248
 v_mfma_f32_16x16x32_bf16 v[176:179], a[24:27], v[56:59], v[176:179]
 s_waitcnt lgkmcnt(3)
 v_mfma_f32_16x16x32_bf16 v[176:179], a[28:31], v[60:63], v[176:179]
 s_mov_b32 s4, 1048576
 ds_read_b64_tr_b16 v[38:39], v8 offset:53760
 v_mfma_f32_16x16x32_bf16 v[180:183], a[92:95], v[60:63], v[180:183]
 v_mfma_f32_16x16x32_bf16 v[180:183], a[88:91], v[56:59], v[180:183]
 buffer_load_dwordx4 v4, s[8:11], s4 offen offset:0 lds
 v_mfma_f32_16x16x32_bf16 v[180:183], a[84:87], v[52:55], v[180:183]
 ds_read_b64_tr_b16 v[40:41], v8 offset:57344
 ds_read_b64_tr_b16 v[42:43], v8 offset:57856
 v_mfma_f32_16x16x32_bf16 v[180:183], a[80:83], v[48:51], v[180:183]
 buffer_load_dwordx4 v5, s[8:11], s4 offen offset:1024 lds
 v_mfma_f32_16x16x32_bf16 v[184:187], a[144:147], v[48:51], v[184:187]
 ds_read_b64_tr_b16 v[44:45], v8 offset:61440
 ds_read_b64_tr_b16 v[46:47], v8 offset:61952
 v_mfma_f32_16x16x32_bf16 v[184:187], a[148:151], v[52:55], v[184:187]
 v_mfma_f32_16x16x32_bf16 v[184:187], a[152:155], v[56:59], v[184:187]
 buffer_load_dwordx4 v6, s[8:11], s4 offen offset:2048 lds
 v_mfma_f32_16x16x32_bf16 v[184:187], a[156:159], v[60:63], v[184:187]
 v_mfma_f32_16x16x32_bf16 v[188:191], a[220:223], v[60:63], v[188:191]
 buffer_load_dwordx4 v7, s[8:11], s4 offen offset:3072 lds
 v_mfma_f32_16x16x32_bf16 v[188:191], a[216:219], v[56:59], v[188:191]
 v_mfma_f32_16x16x32_bf16 v[188:191], a[212:215], v[52:55], v[188:191]
 v_mfma_f32_16x16x32_bf16 v[188:191], a[208:211], v[48:51], v[188:191]
 s_waitcnt lgkmcnt(4)
 v_mfma_f32_16x16x32_bf16 v[192:195], a[32:35], v[32:35], v[192:195]
 ds_read_b64_tr_b16 v[48:49], v9 offset:49152
 ds_read_b64_tr_b16 v[50:51], v9 offset:49664
 v_mfma_f32_16x16x32_bf16 v[192:195], a[36:39], v[36:39], v[192:195]
 s_waitcnt lgkmcnt(4)
 v_mfma_f32_16x16x32_bf16 v[192:195], a[40:43], v[40:43], v[192:195]
 s_waitcnt lgkmcnt(2)
 ds_read_b64_tr_b16 v[52:53], v9 offset:53248
 v_mfma_f32_16x16x32_bf16 v[192:195], a[44:47], v[44:47], v[192:195]
 ds_read_b64_tr_b16 v[54:55], v9 offset:53760
 v_mfma_f32_16x16x32_bf16 v[196:199], a[108:111], v[44:47], v[196:199]
 s_add_u32 s5, s74, 0
 buffer_store_dwordx4 v[132:135], v20, s[20:23], s64 offen offset:2048 sc1
 v_mfma_f32_16x16x32_bf16 v[196:199], a[104:107], v[40:43], v[196:199]
 ds_read_b64_tr_b16 v[56:57], v9 offset:57344
 ds_read_b64_tr_b16 v[58:59], v9 offset:57856
 v_mfma_f32_16x16x32_bf16 v[196:199], a[100:103], v[36:39], v[196:199]
 v_mfma_f32_16x16x32_bf16 v[196:199], a[96:99], v[32:35], v[196:199]
 v_mfma_f32_16x16x32_bf16 v[200:203], a[160:163], v[32:35], v[200:203]
 ds_read_b64_tr_b16 v[60:61], v9 offset:61440
 ds_read_b64_tr_b16 v[62:63], v9 offset:61952
 v_mfma_f32_16x16x32_bf16 v[200:203], a[164:167], v[36:39], v[200:203]
 v_mfma_f32_16x16x32_bf16 v[200:203], a[168:171], v[40:43], v[200:203]
 v_mfma_f32_16x16x32_bf16 v[200:203], a[172:175], v[44:47], v[200:203]
 v_mfma_f32_16x16x32_bf16 v[204:207], a[236:239], v[44:47], v[204:207]
 buffer_load_dwordx4 a[128:131], v12, s[28:31], s5 offen offset:0 sc1
 v_mfma_f32_16x16x32_bf16 v[204:207], a[232:235], v[40:43], v[204:207]
 v_mfma_f32_16x16x32_bf16 v[204:207], a[228:231], v[36:39], v[204:207]
 v_mfma_f32_16x16x32_bf16 v[204:207], a[224:227], v[32:35], v[204:207]
 s_waitcnt lgkmcnt(2)
 v_mfma_f32_16x16x32_bf16 v[208:211], a[32:35], v[48:51], v[208:211]
 ds_read_b64_tr_b16 v[32:33], v10 offset:49152
 ds_read_b64_tr_b16 v[34:35], v10 offset:49664
 v_mfma_f32_16x16x32_bf16 v[208:211], a[36:39], v[52:55], v[208:211]
 v_mfma_f32_16x16x32_bf16 v[208:211], a[40:43], v[56:59], v[208:211]
 s_waitcnt lgkmcnt(2)
 ds_read_b64_tr_b16 v[36:37], v10 offset:53248
 v_mfma_f32_16x16x32_bf16 v[208:211], a[44:47], v[60:63], v[208:211]
 ds_read_b64_tr_b16 v[38:39], v10 offset:53760
 v_mfma_f32_16x16x32_bf16 v[212:215], a[108:111], v[60:63], v[212:215]
 v_mfma_f32_16x16x32_bf16 v[212:215], a[104:107], v[56:59], v[212:215]
 buffer_load_dwordx4 a[132:135], v12, s[28:31], s5 offen offset:1024 sc1
 v_mfma_f32_16x16x32_bf16 v[212:215], a[100:103], v[52:55], v[212:215]
 ds_read_b64_tr_b16 v[40:41], v10 offset:57344
 ds_read_b64_tr_b16 v[42:43], v10 offset:57856
 v_mfma_f32_16x16x32_bf16 v[212:215], a[96:99], v[48:51], v[212:215]
 v_mfma_f32_16x16x32_bf16 v[216:219], a[160:163], v[48:51], v[216:219]
 ds_read_b64_tr_b16 v[44:45], v10 offset:61440
 ds_read_b64_tr_b16 v[46:47], v10 offset:61952
 v_mfma_f32_16x16x32_bf16 v[216:219], a[164:167], v[52:55], v[216:219]
 v_mfma_f32_16x16x32_bf16 v[216:219], a[168:171], v[56:59], v[216:219]
 v_mfma_f32_16x16x32_bf16 v[216:219], a[172:175], v[60:63], v[216:219]
 v_mfma_f32_16x16x32_bf16 v[220:223], a[236:239], v[60:63], v[220:223]
 v_mfma_f32_16x16x32_bf16 v[220:223], a[232:235], v[56:59], v[220:223]
 buffer_load_dwordx4 a[136:139], v12, s[28:31], s5 offen offset:2048 sc1
 v_mfma_f32_16x16x32_bf16 v[220:223], a[228:231], v[52:55], v[220:223]
 v_mfma_f32_16x16x32_bf16 v[220:223], a[224:227], v[48:51], v[220:223]
 s_waitcnt lgkmcnt(4)
 v_mfma_f32_16x16x32_bf16 v[224:227], a[32:35], v[32:35], v[224:227]
 buffer_store_dwordx4 v[164:167], v20, s[20:23], s64 offen offset:3072 sc1
 v_mfma_f32_16x16x32_bf16 v[224:227], a[36:39], v[36:39], v[224:227]
 s_waitcnt lgkmcnt(2)
 ds_read_b64_tr_b16 v[48:49], v11 offset:49152
 v_mfma_f32_16x16x32_bf16 v[224:227], a[40:43], v[40:43], v[224:227]
 s_waitcnt lgkmcnt(1)
 ds_read_b64_tr_b16 v[50:51], v11 offset:49664
 v_mfma_f32_16x16x32_bf16 v[224:227], a[44:47], v[44:47], v[224:227]
 ds_read_b64_tr_b16 v[52:53], v11 offset:53248
 ds_read_b64_tr_b16 v[54:55], v11 offset:53760
 v_mfma_f32_16x16x32_bf16 v[228:231], a[108:111], v[44:47], v[228:231]
 v_mfma_f32_16x16x32_bf16 v[228:231], a[104:107], v[40:43], v[228:231]
 ds_read_b64_tr_b16 v[56:57], v11 offset:57344
 ds_read_b64_tr_b16 v[58:59], v11 offset:57856
 v_mfma_f32_16x16x32_bf16 v[228:231], a[100:103], v[36:39], v[228:231]
 buffer_load_dwordx4 a[140:143], v12, s[28:31], s5 offen offset:3072 sc1
 v_mfma_f32_16x16x32_bf16 v[228:231], a[96:99], v[32:35], v[228:231]
 v_mfma_f32_16x16x32_bf16 v[232:235], a[160:163], v[32:35], v[232:235]
 ds_read_b64_tr_b16 v[60:61], v11 offset:61440
 ds_read_b64_tr_b16 v[62:63], v11 offset:61952
 v_mfma_f32_16x16x32_bf16 v[232:235], a[164:167], v[36:39], v[232:235]
 v_mfma_f32_16x16x32_bf16 v[232:235], a[168:171], v[40:43], v[232:235]
 v_mfma_f32_16x16x32_bf16 v[232:235], a[172:175], v[44:47], v[232:235]
 v_mfma_f32_16x16x32_bf16 v[236:239], a[236:239], v[44:47], v[236:239]
 v_mfma_f32_16x16x32_bf16 v[236:239], a[232:235], v[40:43], v[236:239]
 v_mfma_f32_16x16x32_bf16 v[236:239], a[228:231], v[36:39], v[236:239]
 v_mfma_f32_16x16x32_bf16 v[236:239], a[224:227], v[32:35], v[236:239]
 s_waitcnt lgkmcnt(2)
 s_barrier
 v_mfma_f32_16x16x32_bf16 v[240:243], a[32:35], v[48:51], v[240:243]
 s_add_u32 m0, s58, 81920
 v_add_u32 v8, 0x10000, v8
 v_mfma_f32_16x16x32_bf16 v[240:243], a[36:39], v[52:55], v[240:243]
 ds_read_b64_tr_b16 v[32:33], v8 offset:0
 ds_read_b64_tr_b16 v[34:35], v8 offset:512
 v_mfma_f32_16x16x32_bf16 v[240:243], a[40:43], v[56:59], v[240:243]
 s_waitcnt lgkmcnt(2)
 v_mfma_f32_16x16x32_bf16 v[240:243], a[44:47], v[60:63], v[240:243]
 s_mov_b32 s4, 1048704
 ds_read_b64_tr_b16 v[36:37], v8 offset:4096
 v_mfma_f32_16x16x32_bf16 v[244:247], a[108:111], v[60:63], v[244:247]
 ds_read_b64_tr_b16 v[38:39], v8 offset:4608
 ds_read_b64_tr_b16 v[40:41], v8 offset:8192
 v_mfma_f32_16x16x32_bf16 v[244:247], a[104:107], v[56:59], v[244:247]
 buffer_load_dwordx4 v4, s[8:11], s4 offen offset:0 lds
 v_mfma_f32_16x16x32_bf16 v[244:247], a[100:103], v[52:55], v[244:247]
 v_mfma_f32_16x16x32_bf16 v[244:247], a[96:99], v[48:51], v[244:247]
 buffer_load_dwordx4 v5, s[8:11], s4 offen offset:1024 lds
 v_mfma_f32_16x16x32_bf16 v[248:251], a[160:163], v[48:51], v[248:251]
 ds_read_b64_tr_b16 v[42:43], v8 offset:8704
 ds_read_b64_tr_b16 v[44:45], v8 offset:12288
 v_mfma_f32_16x16x32_bf16 v[248:251], a[164:167], v[52:55], v[248:251]
 ds_read_b64_tr_b16 v[46:47], v8 offset:12800
 v_mfma_f32_16x16x32_bf16 v[248:251], a[168:171], v[56:59], v[248:251]
 buffer_load_dwordx4 v6, s[8:11], s4 offen offset:2048 lds
 v_mfma_f32_16x16x32_bf16 v[248:251], a[172:175], v[60:63], v[248:251]
 v_mfma_f32_16x16x32_bf16 v[252:255], a[236:239], v[60:63], v[252:255]
 buffer_load_dwordx4 v7, s[8:11], s4 offen offset:3072 lds
 v_mfma_f32_16x16x32_bf16 v[252:255], a[232:235], v[56:59], v[252:255]
 v_mfma_f32_16x16x32_bf16 v[252:255], a[228:231], v[52:55], v[252:255]
 v_mfma_f32_16x16x32_bf16 v[252:255], a[224:227], v[48:51], v[252:255]
 s_waitcnt lgkmcnt(4)
 v_mfma_f32_16x16x32_bf16 v[192:195], a[48:51], v[32:35], v[192:195]
 v_add_u32 v9, 0x10000, v9
 v_mfma_f32_16x16x32_bf16 v[192:195], a[52:55], v[36:39], v[192:195]
 s_waitcnt lgkmcnt(2)
 ds_read_b64_tr_b16 v[48:49], v9 offset:0
 v_mfma_f32_16x16x32_bf16 v[192:195], a[56:59], v[40:43], v[192:195]
 s_waitcnt lgkmcnt(1)
 ds_read_b64_tr_b16 v[50:51], v9 offset:512
 v_mfma_f32_16x16x32_bf16 v[192:195], a[60:63], v[44:47], v[192:195]
 ds_read_b64_tr_b16 v[52:53], v9 offset:4096
 ds_read_b64_tr_b16 v[54:55], v9 offset:4608
 v_mfma_f32_16x16x32_bf16 v[196:199], a[124:127], v[44:47], v[196:199]
 s_add_u32 s5, s75, 0
 buffer_store_dwordx4 v[136:139], v20, s[20:23], s65 offen offset:2048 sc1
 v_mfma_f32_16x16x32_bf16 v[196:199], a[120:123], v[40:43], v[196:199]
 ds_read_b64_tr_b16 v[56:57], v9 offset:8192
 v_mfma_f32_16x16x32_bf16 v[196:199], a[116:119], v[36:39], v[196:199]
 v_mfma_f32_16x16x32_bf16 v[196:199], a[112:115], v[32:35], v[196:199]
 ds_read_b64_tr_b16 v[58:59], v9 offset:8704
 ds_read_b64_tr_b16 v[60:61], v9 offset:12288
 v_mfma_f32_16x16x32_bf16 v[200:203], a[176:179], v[32:35], v[200:203]
 buffer_load_dwordx4 a[192:195], v12, s[28:31], s5 offen offset:0 sc1
 v_mfma_f32_16x16x32_bf16 v[200:203], a[180:183], v[36:39], v[200:203]
 ds_read_b64_tr_b16 v[62:63], v9 offset:12800
 v_mfma_f32_16x16x32_bf16 v[200:203], a[184:187], v[40:43], v[200:203]
 v_mfma_f32_16x16x32_bf16 v[200:203], a[188:191], v[44:47], v[200:203]
 v_mfma_f32_16x16x32_bf16 v[204:207], a[252:255], v[44:47], v[204:207]
 buffer_load_dwordx4 a[196:199], v12, s[28:31], s5 offen offset:1024 sc1
 v_mfma_f32_16x16x32_bf16 v[204:207], a[248:251], v[40:43], v[204:207]
 v_mfma_f32_16x16x32_bf16 v[204:207], a[244:247], v[36:39], v[204:207]
 v_mfma_f32_16x16x32_bf16 v[204:207], a[240:243], v[32:35], v[204:207]
 s_waitcnt lgkmcnt(4)
 v_mfma_f32_16x16x32_bf16 v[208:211], a[48:51], v[48:51], v[208:211]
 buffer_load_dwordx4 a[200:203], v12, s[28:31], s5 offen offset:2048 sc1
 v_mfma_f32_16x16x32_bf16 v[208:211], a[52:55], v[52:55], v[208:211]
 s_waitcnt lgkmcnt(2)
 v_add_u32 v10, 0x10000, v10
 v_mfma_f32_16x16x32_bf16 v[208:211], a[56:59], v[56:59], v[208:211]
 s_waitcnt lgkmcnt(0)
 ds_read_b64_tr_b16 v[32:33], v10 offset:0
 v_mfma_f32_16x16x32_bf16 v[208:211], a[60:63], v[60:63], v[208:211]
 ds_read_b64_tr_b16 v[34:35], v10 offset:512
 ds_read_b64_tr_b16 v[36:37], v10 offset:4096
 v_mfma_f32_16x16x32_bf16 v[212:215], a[124:127], v[60:63], v[212:215]
 ds_read_b64_tr_b16 v[38:39], v10 offset:4608
 ds_read_b64_tr_b16 v[40:41], v10 offset:8192
 v_mfma_f32_16x16x32_bf16 v[212:215], a[120:123], v[56:59], v[212:215]
 buffer_load_dwordx4 a[204:207], v12, s[28:31], s5 offen offset:3072 sc1
 v_mfma_f32_16x16x32_bf16 v[212:215], a[116:119], v[52:55], v[212:215]
 v_mfma_f32_16x16x32_bf16 v[212:215], a[112:115], v[48:51], v[212:215]
 ds_read_b64_tr_b16 v[42:43], v10 offset:8704
 ds_read_b64_tr_b16 v[44:45], v10 offset:12288
 v_mfma_f32_16x16x32_bf16 v[216:219], a[176:179], v[48:51], v[216:219]
 v_mfma_f32_16x16x32_bf16 v[216:219], a[180:183], v[52:55], v[216:219]
 s_add_u32 s5, s72, 4096
 ds_read_b64_tr_b16 v[46:47], v10 offset:12800
 v_mfma_f32_16x16x32_bf16 v[216:219], a[184:187], v[56:59], v[216:219]
 v_mfma_f32_16x16x32_bf16 v[216:219], a[188:191], v[60:63], v[216:219]
 v_mfma_f32_16x16x32_bf16 v[220:223], a[252:255], v[60:63], v[220:223]
 v_mfma_f32_16x16x32_bf16 v[220:223], a[248:251], v[56:59], v[220:223]
 buffer_load_dwordx4 a[16:19], v12, s[28:31], s5 offen offset:0 sc1
 v_mfma_f32_16x16x32_bf16 v[220:223], a[244:247], v[52:55], v[220:223]
 v_mfma_f32_16x16x32_bf16 v[220:223], a[240:243], v[48:51], v[220:223]
 s_waitcnt lgkmcnt(4)
 v_mfma_f32_16x16x32_bf16 v[224:227], a[48:51], v[32:35], v[224:227]
 buffer_store_dwordx4 v[168:171], v20, s[20:23], s65 offen offset:3072 sc1
 v_mfma_f32_16x16x32_bf16 v[224:227], a[52:55], v[36:39], v[224:227]
 s_waitcnt lgkmcnt(2)
 v_add_u32 v11, 0x10000, v11
 v_mfma_f32_16x16x32_bf16 v[224:227], a[56:59], v[40:43], v[224:227]
 s_waitcnt lgkmcnt(0)
 buffer_load_dwordx4 a[20:23], v12, s[28:31], s5 offen offset:1024 sc1
 v_mfma_f32_16x16x32_bf16 v[224:227], a[60:63], v[44:47], v[224:227]
 ds_read_b64_tr_b16 v[48:49], v11 offset:0
 ds_read_b64_tr_b16 v[50:51], v11 offset:512
 v_mfma_f32_16x16x32_bf16 v[228:231], a[124:127], v[44:47], v[228:231]
 ds_read_b64_tr_b16 v[52:53], v11 offset:4096
 ds_read_b64_tr_b16 v[54:55], v11 offset:4608
 v_mfma_f32_16x16x32_bf16 v[228:231], a[120:123], v[40:43], v[228:231]
 ds_read_b64_tr_b16 v[56:57], v11 offset:8192
 v_mfma_f32_16x16x32_bf16 v[228:231], a[116:119], v[36:39], v[228:231]
 buffer_load_dwordx4 a[24:27], v12, s[28:31], s5 offen offset:2048 sc1
 v_mfma_f32_16x16x32_bf16 v[228:231], a[112:115], v[32:35], v[228:231]
 ds_read_b64_tr_b16 v[58:59], v11 offset:8704
 ds_read_b64_tr_b16 v[60:61], v11 offset:12288
 v_mfma_f32_16x16x32_bf16 v[232:235], a[176:179], v[32:35], v[232:235]
 v_mfma_f32_16x16x32_bf16 v[232:235], a[180:183], v[36:39], v[232:235]
 ds_read_b64_tr_b16 v[62:63], v11 offset:12800
 v_mfma_f32_16x16x32_bf16 v[232:235], a[184:187], v[40:43], v[232:235]
 buffer_load_dwordx4 a[28:31], v12, s[28:31], s5 offen offset:3072 sc1
 v_mfma_f32_16x16x32_bf16 v[232:235], a[188:191], v[44:47], v[232:235]
 v_mfma_f32_16x16x32_bf16 v[236:239], a[252:255], v[44:47], v[236:239]
 v_mfma_f32_16x16x32_bf16 v[236:239], a[248:251], v[40:43], v[236:239]
 v_mfma_f32_16x16x32_bf16 v[236:239], a[244:247], v[36:39], v[236:239]
 v_mfma_f32_16x16x32_bf16 v[236:239], a[240:243], v[32:35], v[236:239]
 s_waitcnt lgkmcnt(4)
 v_mfma_f32_16x16x32_bf16 v[240:243], a[48:51], v[48:51], v[240:243]
 s_add_u32 m0, s58, 98304
 v_add_u32 v8, 0xfffe0000, v8
 v_mfma_f32_16x16x32_bf16 v[240:243], a[52:55], v[52:55], v[240:243]
 s_waitcnt lgkmcnt(2)
 ds_read_b64_tr_b16 v[32:33], v8 offset:16384
 v_mfma_f32_16x16x32_bf16 v[240:243], a[56:59], v[56:59], v[240:243]
 s_waitcnt lgkmcnt(1)
 ds_read_b64_tr_b16 v[34:35], v8 offset:16896
 v_mfma_f32_16x16x32_bf16 v[240:243], a[60:63], v[60:63], v[240:243]
 s_mov_b32 s4, 2097152
 ds_read_b64_tr_b16 v[36:37], v8 offset:20480
 v_mfma_f32_16x16x32_bf16 v[244:247], a[124:127], v[60:63], v[244:247]
 ds_read_b64_tr_b16 v[38:39], v8 offset:20992
 ds_read_b64_tr_b16 v[40:41], v8 offset:24576
 v_mfma_f32_16x16x32_bf16 v[244:247], a[120:123], v[56:59], v[244:247]
 buffer_load_dwordx4 v4, s[8:11], s4 offen offset:0 lds
 v_mfma_f32_16x16x32_bf16 v[244:247], a[116:119], v[52:55], v[244:247]
 v_mfma_f32_16x16x32_bf16 v[244:247], a[112:115], v[48:51], v[244:247]
 buffer_load_dwordx4 v5, s[8:11], s4 offen offset:1024 lds
 v_mfma_f32_16x16x32_bf16 v[248:251], a[176:179], v[48:51], v[248:251]
 ds_read_b64_tr_b16 v[42:43], v8 offset:25088
 ds_read_b64_tr_b16 v[44:45], v8 offset:28672
 v_mfma_f32_16x16x32_bf16 v[248:251], a[180:183], v[52:55], v[248:251]
 ds_read_b64_tr_b16 v[46:47], v8 offset:29184
 v_mfma_f32_16x16x32_bf16 v[248:251], a[184:187], v[56:59], v[248:251]
 buffer_load_dwordx4 v6, s[8:11], s4 offen offset:2048 lds
 v_mfma_f32_16x16x32_bf16 v[248:251], a[188:191], v[60:63], v[248:251]
 v_mfma_f32_16x16x32_bf16 v[252:255], a[252:255], v[60:63], v[252:255]
 buffer_load_dwordx4 v7, s[8:11], s4 offen offset:3072 lds
 v_mfma_f32_16x16x32_bf16 v[252:255], a[248:251], v[56:59], v[252:255]
 v_mfma_f32_16x16x32_bf16 v[252:255], a[244:247], v[52:55], v[252:255]
 v_mfma_f32_16x16x32_bf16 v[252:255], a[240:243], v[48:51], v[252:255]
 s_waitcnt lgkmcnt(4)
 v_mfma_f32_16x16x32_bf16 v[80:83], a[32:35], v[32:35], v[80:83]
 v_add_u32 v9, 0xfffe0000, v9
 v_mfma_f32_16x16x32_bf16 v[80:83], a[36:39], v[36:39], v[80:83]
 s_waitcnt lgkmcnt(2)
 ds_read_b64_tr_b16 v[48:49], v9 offset:16384
 v_mfma_f32_16x16x32_bf16 v[80:83], a[40:43], v[40:43], v[80:83]
 s_waitcnt lgkmcnt(1)
 ds_read_b64_tr_b16 v[50:51], v9 offset:16896
 v_mfma_f32_16x16x32_bf16 v[80:83], a[44:47], v[44:47], v[80:83]
 ds_read_b64_tr_b16 v[52:53], v9 offset:20480
 ds_read_b64_tr_b16 v[54:55], v9 offset:20992
 v_mfma_f32_16x16x32_bf16 v[84:87], a[108:111], v[44:47], v[84:87]
 s_add_u32 s5, s73, 4096
 buffer_store_dwordx4 v[140:143], v20, s[20:23], s66 offen offset:2048 sc1
 v_mfma_f32_16x16x32_bf16 v[84:87], a[104:107], v[40:43], v[84:87]
 ds_read_b64_tr_b16 v[56:57], v9 offset:24576
 v_mfma_f32_16x16x32_bf16 v[84:87], a[100:103], v[36:39], v[84:87]
 v_mfma_f32_16x16x32_bf16 v[84:87], a[96:99], v[32:35], v[84:87]
 ds_read_b64_tr_b16 v[58:59], v9 offset:25088
 ds_read_b64_tr_b16 v[60:61], v9 offset:28672
 v_mfma_f32_16x16x32_bf16 v[88:91], a[160:163], v[32:35], v[88:91]
 buffer_load_dwordx4 a[80:83], v12, s[28:31], s5 offen offset:0 sc1
 v_mfma_f32_16x16x32_bf16 v[88:91], a[164:167], v[36:39], v[88:91]
 v_mul_f32 v192, 0x5f800000, v192
 v_mul_f32 v196, 0x5f800000, v196
 v_mfma_f32_16x16x32_bf16 v[88:91], a[168:171], v[40:43], v[88:91]
 v_mul_f32 v193, 0x5f800000, v193
 v_mul_f32 v197, 0x5f800000, v197
 v_mfma_f32_16x16x32_bf16 v[88:91], a[172:175], v[44:47], v[88:91]
 ds_read_b64_tr_b16 v[62:63], v9 offset:29184
 v_mfma_f32_16x16x32_bf16 v[92:95], a[236:239], v[44:47], v[92:95]
 buffer_load_dwordx4 a[84:87], v12, s[28:31], s5 offen offset:1024 sc1
 v_mfma_f32_16x16x32_bf16 v[92:95], a[232:235], v[40:43], v[92:95]
 v_mul_f32 v194, 0x5f800000, v194
 v_mul_f32 v198, 0x5f800000, v198
 v_mfma_f32_16x16x32_bf16 v[92:95], a[228:231], v[36:39], v[92:95]
 v_mul_f32 v195, 0x5f800000, v195
 v_mul_f32 v199, 0x5f800000, v199
 v_mfma_f32_16x16x32_bf16 v[92:95], a[224:227], v[32:35], v[92:95]
 s_waitcnt lgkmcnt(4)
 v_cvt_pk_bf16_f32 v192, v192, v193
 v_cvt_pk_bf16_f32 v193, v194, v195
 v_mfma_f32_16x16x32_bf16 v[112:115], a[32:35], v[48:51], v[112:115]
 buffer_load_dwordx4 a[88:91], v12, s[28:31], s5 offen offset:2048 sc1
 v_mfma_f32_16x16x32_bf16 v[112:115], a[36:39], v[52:55], v[112:115]
 s_waitcnt lgkmcnt(2)
 v_cvt_pk_bf16_f32 v194, v196, v197
 v_cvt_pk_bf16_f32 v195, v198, v199
 v_mfma_f32_16x16x32_bf16 v[112:115], a[40:43], v[56:59], v[112:115]
 s_waitcnt lgkmcnt(0)
 v_mul_f32 v200, 0x5f800000, v200
 v_mul_f32 v204, 0x5f800000, v204
 v_mfma_f32_16x16x32_bf16 v[112:115], a[44:47], v[60:63], v[112:115]
 v_mul_f32 v201, 0x5f800000, v201
 v_mul_f32 v205, 0x5f800000, v205
 v_mfma_f32_16x16x32_bf16 v[116:119], a[108:111], v[60:63], v[116:119]
 v_add_u32 v10, 0xfffe0000, v10
 v_mul_f32 v202, 0x5f800000, v202
 v_mul_f32 v206, 0x5f800000, v206
 v_mfma_f32_16x16x32_bf16 v[116:119], a[104:107], v[56:59], v[116:119]
 buffer_load_dwordx4 a[92:95], v12, s[28:31], s5 offen offset:3072 sc1
 v_mfma_f32_16x16x32_bf16 v[116:119], a[100:103], v[52:55], v[116:119]
 ds_read_b64_tr_b16 v[32:33], v10 offset:16384
 ds_read_b64_tr_b16 v[34:35], v10 offset:16896
 v_mfma_f32_16x16x32_bf16 v[116:119], a[96:99], v[48:51], v[116:119]
 ds_read_b64_tr_b16 v[36:37], v10 offset:20480
 v_mul_f32 v203, 0x5f800000, v203
 v_mul_f32 v207, 0x5f800000, v207
 v_mfma_f32_16x16x32_bf16 v[120:123], a[160:163], v[48:51], v[120:123]
 ds_read_b64_tr_b16 v[38:39], v10 offset:20992
 v_cvt_pk_bf16_f32 v200, v200, v201
 v_mfma_f32_16x16x32_bf16 v[120:123], a[164:167], v[52:55], v[120:123]
 s_add_u32 s5, s74, 4096
 ds_read_b64_tr_b16 v[40:41], v10 offset:24576
 v_mfma_f32_16x16x32_bf16 v[120:123], a[168:171], v[56:59], v[120:123]
 ds_read_b64_tr_b16 v[42:43], v10 offset:25088
 v_cvt_pk_bf16_f32 v201, v202, v203
 v_mfma_f32_16x16x32_bf16 v[120:123], a[172:175], v[60:63], v[120:123]
 ds_read_b64_tr_b16 v[44:45], v10 offset:28672
 v_cvt_pk_bf16_f32 v202, v204, v205
 ds_read_b64_tr_b16 v[46:47], v10 offset:29184
 v_mfma_f32_16x16x32_bf16 v[124:127], a[236:239], v[60:63], v[124:127]
 v_cvt_pk_bf16_f32 v203, v206, v207
 v_mul_f32 v208, 0x5f800000, v208
 v_mul_f32 v212, 0x5f800000, v212
 v_mfma_f32_16x16x32_bf16 v[124:127], a[232:235], v[56:59], v[124:127]
 buffer_load_dwordx4 a[144:147], v12, s[28:31], s5 offen offset:0 sc1
 v_mfma_f32_16x16x32_bf16 v[124:127], a[228:231], v[52:55], v[124:127]
 v_mul_f32 v209, 0x5f800000, v209
 v_mul_f32 v213, 0x5f800000, v213
 v_mfma_f32_16x16x32_bf16 v[124:127], a[224:227], v[48:51], v[124:127]
 s_waitcnt lgkmcnt(6)
 v_mul_f32 v210, 0x5f800000, v210
 v_mul_f32 v214, 0x5f800000, v214
 v_mfma_f32_16x16x32_bf16 v[144:147], a[32:35], v[32:35], v[144:147]
 s_waitcnt lgkmcnt(4)
 buffer_store_dwordx4 v[172:175], v20, s[20:23], s66 offen offset:3072 sc1
 v_mfma_f32_16x16x32_bf16 v[144:147], a[36:39], v[36:39], v[144:147]
 s_waitcnt lgkmcnt(2)
 v_mul_f32 v211, 0x5f800000, v211
 v_mul_f32 v215, 0x5f800000, v215
 v_mfma_f32_16x16x32_bf16 v[144:147], a[40:43], v[40:43], v[144:147]
 s_waitcnt lgkmcnt(0)
 buffer_load_dwordx4 a[148:151], v12, s[28:31], s5 offen offset:1024 sc1
 v_mfma_f32_16x16x32_bf16 v[144:147], a[44:47], v[44:47], v[144:147]
 v_cvt_pk_bf16_f32 v208, v208, v209
 v_cvt_pk_bf16_f32 v209, v210, v211
 v_mfma_f32_16x16x32_bf16 v[148:151], a[108:111], v[44:47], v[148:151]
 v_cvt_pk_bf16_f32 v210, v212, v213
 v_cvt_pk_bf16_f32 v211, v214, v215
 v_mfma_f32_16x16x32_bf16 v[148:151], a[104:107], v[40:43], v[148:151]
 v_mul_f32 v216, 0x5f800000, v216
 v_mul_f32 v220, 0x5f800000, v220
 v_mfma_f32_16x16x32_bf16 v[148:151], a[100:103], v[36:39], v[148:151]
 buffer_load_dwordx4 a[152:155], v12, s[28:31], s5 offen offset:2048 sc1
 v_mfma_f32_16x16x32_bf16 v[148:151], a[96:99], v[32:35], v[148:151]
 v_mul_f32 v217, 0x5f800000, v217
 v_mul_f32 v221, 0x5f800000, v221
 v_mfma_f32_16x16x32_bf16 v[152:155], a[160:163], v[32:35], v[152:155]
 v_mul_f32 v218, 0x5f800000, v218
 v_mul_f32 v222, 0x5f800000, v222
 v_mfma_f32_16x16x32_bf16 v[152:155], a[164:167], v[36:39], v[152:155]
 v_mul_f32 v219, 0x5f800000, v219
 v_mul_f32 v223, 0x5f800000, v223
 v_mfma_f32_16x16x32_bf16 v[152:155], a[168:171], v[40:43], v[152:155]
 buffer_load_dwordx4 a[156:159], v12, s[28:31], s5 offen offset:3072 sc1
 v_mfma_f32_16x16x32_bf16 v[152:155], a[172:175], v[44:47], v[152:155]
 v_add_u32 v11, 0xfffe0000, v11
 v_cvt_pk_bf16_f32 v216, v216, v217
 ds_read_b64_tr_b16 v[48:49], v11 offset:16384
 ds_read_b64_tr_b16 v[50:51], v11 offset:16896
 ds_read_b64_tr_b16 v[52:53], v11 offset:20480
 ds_read_b64_tr_b16 v[54:55], v11 offset:20992
 ds_read_b64_tr_b16 v[56:57], v11 offset:24576
 ds_read_b64_tr_b16 v[58:59], v11 offset:25088
 ds_read_b64_tr_b16 v[60:61], v11 offset:28672
 ds_read_b64_tr_b16 v[62:63], v11 offset:29184
 v_mfma_f32_16x16x32_bf16 v[156:159], a[236:239], v[44:47], v[156:159]
 v_cvt_pk_bf16_f32 v217, v218, v219
 v_cvt_pk_bf16_f32 v218, v220, v221
 v_mfma_f32_16x16x32_bf16 v[156:159], a[232:235], v[40:43], v[156:159]
 v_cvt_pk_bf16_f32 v219, v222, v223
 v_mul_f32 v224, 0x5f800000, v224
 v_mul_f32 v228, 0x5f800000, v228
 v_mfma_f32_16x16x32_bf16 v[156:159], a[228:231], v[36:39], v[156:159]
 v_mul_f32 v225, 0x5f800000, v225
 v_mul_f32 v229, 0x5f800000, v229
 v_mfma_f32_16x16x32_bf16 v[156:159], a[224:227], v[32:35], v[156:159]
 s_waitcnt lgkmcnt(6)
 s_barrier
 v_mfma_f32_16x16x32_bf16 v[176:179], a[32:35], v[48:51], v[176:179]
 s_waitcnt lgkmcnt(4)
 v_mul_f32 v226, 0x5f800000, v226
 v_mul_f32 v230, 0x5f800000, v230
 v_mfma_f32_16x16x32_bf16 v[176:179], a[36:39], v[52:55], v[176:179]
 s_waitcnt lgkmcnt(2)
 v_mul_f32 v227, 0x5f800000, v227
 v_mul_f32 v231, 0x5f800000, v231
 v_mfma_f32_16x16x32_bf16 v[176:179], a[40:43], v[56:59], v[176:179]
 s_waitcnt lgkmcnt(0)
 ds_read_b64_tr_b16 v[32:33], v8 offset:32768
 v_mfma_f32_16x16x32_bf16 v[176:179], a[44:47], v[60:63], v[176:179]
 s_add_u32 m0, s58, 114688
 ds_read_b64_tr_b16 v[34:35], v8 offset:33280
 v_mfma_f32_16x16x32_bf16 v[180:183], a[108:111], v[60:63], v[180:183]
 s_mov_b32 s4, 2097280
 v_cvt_pk_bf16_f32 v224, v224, v225
 v_cvt_pk_bf16_f32 v225, v226, v227
 v_mfma_f32_16x16x32_bf16 v[180:183], a[104:107], v[56:59], v[180:183]
 buffer_load_dwordx4 v4, s[8:11], s4 offen offset:0 lds
 v_mfma_f32_16x16x32_bf16 v[180:183], a[100:103], v[52:55], v[180:183]
 ds_read_b64_tr_b16 v[36:37], v8 offset:36864
 v_cvt_pk_bf16_f32 v226, v228, v229
 v_mfma_f32_16x16x32_bf16 v[180:183], a[96:99], v[48:51], v[180:183]
 buffer_load_dwordx4 v5, s[8:11], s4 offen offset:1024 lds
 v_mfma_f32_16x16x32_bf16 v[184:187], a[160:163], v[48:51], v[184:187]
 ds_read_b64_tr_b16 v[38:39], v8 offset:37376
 v_cvt_pk_bf16_f32 v227, v230, v231
 v_mfma_f32_16x16x32_bf16 v[184:187], a[164:167], v[52:55], v[184:187]
 ds_read_b64_tr_b16 v[40:41], v8 offset:40960
 v_mul_f32 v232, 0x5f800000, v232
 v_mul_f32 v236, 0x5f800000, v236
 v_mfma_f32_16x16x32_bf16 v[184:187], a[168:171], v[56:59], v[184:187]
 buffer_load_dwordx4 v6, s[8:11], s4 offen offset:2048 lds
 v_mfma_f32_16x16x32_bf16 v[184:187], a[172:175], v[60:63], v[184:187]
 ds_read_b64_tr_b16 v[42:43], v8 offset:41472
 v_mul_f32 v233, 0x5f800000, v233
 v_mul_f32 v237, 0x5f800000, v237
 ds_read_b64_tr_b16 v[44:45], v8 offset:45056
 ds_read_b64_tr_b16 v[46:47], v8 offset:45568
 v_mfma_f32_16x16x32_bf16 v[188:191], a[236:239], v[60:63], v[188:191]
 buffer_load_dwordx4 v7, s[8:11], s4 offen offset:3072 lds
 v_mfma_f32_16x16x32_bf16 v[188:191], a[232:235], v[56:59], v[188:191]
 v_mul_f32 v234, 0x5f800000, v234
 v_mul_f32 v238, 0x5f800000, v238
 v_mfma_f32_16x16x32_bf16 v[188:191], a[228:231], v[52:55], v[188:191]
 v_mul_f32 v235, 0x5f800000, v235
 v_mul_f32 v239, 0x5f800000, v239
 v_mfma_f32_16x16x32_bf16 v[188:191], a[224:227], v[48:51], v[188:191]
 v_cvt_pk_bf16_f32 v232, v232, v233
 v_cvt_pk_bf16_f32 v233, v234, v235
 v_cvt_pk_bf16_f32 v234, v236, v237
 v_cvt_pk_bf16_f32 v235, v238, v239
 v_mul_f32 v240, 0x5f800000, v240
 v_mul_f32 v244, 0x5f800000, v244
 v_mul_f32 v241, 0x5f800000, v241
 v_mul_f32 v245, 0x5f800000, v245
 v_mul_f32 v242, 0x5f800000, v242
 v_mul_f32 v246, 0x5f800000, v246
 v_mul_f32 v243, 0x5f800000, v243
 v_mul_f32 v247, 0x5f800000, v247
 v_cvt_pk_bf16_f32 v240, v240, v241
 v_cvt_pk_bf16_f32 v241, v242, v243
 v_cvt_pk_bf16_f32 v242, v244, v245
 v_cvt_pk_bf16_f32 v243, v246, v247
 v_mul_f32 v248, 0x5f800000, v248
 v_mul_f32 v252, 0x5f800000, v252
 v_mul_f32 v249, 0x5f800000, v249
 v_mul_f32 v253, 0x5f800000, v253
 v_mul_f32 v250, 0x5f800000, v250
 v_mul_f32 v254, 0x5f800000, v254
 v_mul_f32 v251, 0x5f800000, v251
 v_mul_f32 v255, 0x5f800000, v255
 v_cvt_pk_bf16_f32 v248, v248, v249
 v_cvt_pk_bf16_f32 v249, v250, v251
 v_cvt_pk_bf16_f32 v250, v252, v253
 v_cvt_pk_bf16_f32 v251, v254, v255
 s_waitcnt lgkmcnt(6)
 v_mfma_f32_16x16x32_bf16 v[80:83], a[48:51], v[32:35], v[80:83]
 s_waitcnt lgkmcnt(4)
 ds_read_b64_tr_b16 v[48:49], v9 offset:32768
 v_mfma_f32_16x16x32_bf16 v[80:83], a[52:55], v[36:39], v[80:83]
 s_waitcnt lgkmcnt(3)
 ds_read_b64_tr_b16 v[50:51], v9 offset:33280
 v_mfma_f32_16x16x32_bf16 v[80:83], a[56:59], v[40:43], v[80:83]
 s_waitcnt lgkmcnt(2)
 s_cmp_lt_u32 s62, 24
 s_cbranch_scc0 L_j0_9
 ds_read_b64_tr_b16 v[196:197], v23 offset:0
 ds_read_b64_tr_b16 v[198:199], v23 offset:2048
 ds_read_b64_tr_b16 v[204:205], v23 offset:32
 ds_read_b64_tr_b16 v[206:207], v23 offset:2080
 ds_read_b64_tr_b16 v[212:213], v23 offset:64
 ds_read_b64_tr_b16 v[214:215], v23 offset:2112
 ds_read_b64_tr_b16 v[220:221], v23 offset:96
 ds_read_b64_tr_b16 v[222:223], v23 offset:2144
 s_waitcnt lgkmcnt(0)
 s_mov_b32 s68, 0
 buffer_store_dwordx4 v[196:199], v24, s[76:79], s68 offen sc1
 s_add_u32 s68, s68, 44032
 buffer_store_dwordx4 v[204:207], v24, s[76:79], s68 offen sc1
 s_add_u32 s68, s68, 44032
 buffer_store_dwordx4 v[212:215], v24, s[76:79], s68 offen sc1
 s_add_u32 s68, s68, 44032
 buffer_store_dwordx4 v[220:223], v24, s[76:79], s68 offen sc1
 s_add_u32 s68, s68, 44032
L_j0_9:
 v_mfma_f32_16x16x32_bf16 v[80:83], a[60:63], v[44:47], v[80:83]
 ds_read_b64_tr_b16 v[52:53], v9 offset:36864
 ds_read_b64_tr_b16 v[54:55], v9 offset:37376
 v_mfma_f32_16x16x32_bf16 v[84:87], a[124:127], v[44:47], v[84:87]
 s_add_u32 s5, s75, 4096
 buffer_store_dwordx4 v[192:195], v20, s[24:27], 0 offen offset:0 sc1
 v_mfma_f32_16x16x32_bf16 v[84:87], a[120:123], v[40:43], v[84:87]
 ds_read_b64_tr_b16 v[56:57], v9 offset:40960
 ds_read_b64_tr_b16 v[58:59], v9 offset:41472
 v_mfma_f32_16x16x32_bf16 v[84:87], a[116:119], v[36:39], v[84:87]
 v_mfma_f32_16x16x32_bf16 v[84:87], a[112:115], v[32:35], v[84:87]
 v_mfma_f32_16x16x32_bf16 v[88:91], a[176:179], v[32:35], v[88:91]
 buffer_load_dwordx4 a[208:211], v12, s[28:31], s5 offen offset:0 sc1
 v_mfma_f32_16x16x32_bf16 v[88:91], a[180:183], v[36:39], v[88:91]
 ds_read_b64_tr_b16 v[60:61], v9 offset:45056
 ds_read_b64_tr_b16 v[62:63], v9 offset:45568
 v_mfma_f32_16x16x32_bf16 v[88:91], a[184:187], v[40:43], v[88:91]
 v_mfma_f32_16x16x32_bf16 v[88:91], a[188:191], v[44:47], v[88:91]
 v_mfma_f32_16x16x32_bf16 v[92:95], a[252:255], v[44:47], v[92:95]
 buffer_load_dwordx4 a[212:215], v12, s[28:31], s5 offen offset:1024 sc1
 v_mfma_f32_16x16x32_bf16 v[92:95], a[248:251], v[40:43], v[92:95]
 v_mfma_f32_16x16x32_bf16 v[92:95], a[244:247], v[36:39], v[92:95]
 v_mfma_f32_16x16x32_bf16 v[92:95], a[240:243], v[32:35], v[92:95]
 s_waitcnt lgkmcnt(2)
 v_mfma_f32_16x16x32_bf16 v[112:115], a[48:51], v[48:51], v[112:115]
 buffer_load_dwordx4 a[216:219], v12, s[28:31], s5 offen offset:2048 sc1
 v_mfma_f32_16x16x32_bf16 v[112:115], a[52:55], v[52:55], v[112:115]
 ds_read_b64_tr_b16 v[32:33], v10 offset:32768
 ds_read_b64_tr_b16 v[34:35], v10 offset:33280
 v_mfma_f32_16x16x32_bf16 v[112:115], a[56:59], v[56:59], v[112:115]
 s_waitcnt lgkmcnt(2)
 ds_read_b64_tr_b16 v[36:37], v10 offset:36864
 v_mfma_f32_16x16x32_bf16 v[112:115], a[60:63], v[60:63], v[112:115]
 ds_read_b64_tr_b16 v[38:39], v10 offset:37376
 v_mfma_f32_16x16x32_bf16 v[116:119], a[124:127], v[60:63], v[116:119]
 v_mfma_f32_16x16x32_bf16 v[116:119], a[120:123], v[56:59], v[116:119]
 buffer_load_dwordx4 a[220:223], v12, s[28:31], s5 offen offset:3072 sc1
 v_mfma_f32_16x16x32_bf16 v[116:119], a[116:119], v[52:55], v[116:119]
 ds_read_b64_tr_b16 v[40:41], v10 offset:40960
 ds_read_b64_tr_b16 v[42:43], v10 offset:41472
 v_mfma_f32_16x16x32_bf16 v[116:119], a[112:115], v[48:51], v[116:119]
 buffer_store_dwordx4 v[200:203], v20, s[24:27], s65 offen offset:0 sc1
 v_mfma_f32_16x16x32_bf16 v[120:123], a[176:179], v[48:51], v[120:123]
 ds_read_b64_tr_b16 v[44:45], v10 offset:45056
 ds_read_b64_tr_b16 v[46:47], v10 offset:45568
 v_mfma_f32_16x16x32_bf16 v[120:123], a[180:183], v[52:55], v[120:123]
 s_add_u32 s5, s72, 8192
 v_mfma_f32_16x16x32_bf16 v[120:123], a[184:187], v[56:59], v[120:123]
 v_mfma_f32_16x16x32_bf16 v[120:123], a[188:191], v[60:63], v[120:123]
 v_mfma_f32_16x16x32_bf16 v[124:127], a[252:255], v[60:63], v[124:127]
 v_mfma_f32_16x16x32_bf16 v[124:127], a[248:251], v[56:59], v[124:127]
 buffer_load_dwordx4 a[32:35], v12, s[28:31], s5 offen offset:0 sc1
 v_mfma_f32_16x16x32_bf16 v[124:127], a[244:247], v[52:55], v[124:127]
 v_mfma_f32_16x16x32_bf16 v[124:127], a[240:243], v[48:51], v[124:127]
 s_waitcnt lgkmcnt(4)
 v_mfma_f32_16x16x32_bf16 v[144:147], a[48:51], v[32:35], v[144:147]
 ds_read_b64_tr_b16 v[48:49], v11 offset:32768
 ds_read_b64_tr_b16 v[50:51], v11 offset:33280
 v_mfma_f32_16x16x32_bf16 v[144:147], a[52:55], v[36:39], v[144:147]
 s_waitcnt lgkmcnt(4)
 v_mfma_f32_16x16x32_bf16 v[144:147], a[56:59], v[40:43], v[144:147]
 s_waitcnt lgkmcnt(2)
 buffer_load_dwordx4 a[36:39], v12, s[28:31], s5 offen offset:1024 sc1
 v_mfma_f32_16x16x32_bf16 v[144:147], a[60:63], v[44:47], v[144:147]
 ds_read_b64_tr_b16 v[52:53], v11 offset:36864
 ds_read_b64_tr_b16 v[54:55], v11 offset:37376
 v_mfma_f32_16x16x32_bf16 v[148:151], a[124:127], v[44:47], v[148:151]
 v_mfma_f32_16x16x32_bf16 v[148:151], a[120:123], v[40:43], v[148:151]
 ds_read_b64_tr_b16 v[56:57], v11 offset:40960
 ds_read_b64_tr_b16 v[58:59], v11 offset:41472
 v_mfma_f32_16x16x32_bf16 v[148:151], a[116:119], v[36:39], v[148:151]
 buffer_load_dwordx4 a[40:43], v12, s[28:31], s5 offen offset:2048 sc1
 v_mfma_f32_16x16x32_bf16 v[148:151], a[112:115], v[32:35], v[148:151]
 v_mfma_f32_16x16x32_bf16 v[152:155], a[176:179], v[32:35], v[152:155]
 ds_read_b64_tr_b16 v[60:61], v11 offset:45056
 ds_read_b64_tr_b16 v[62:63], v11 offset:45568
 v_mfma_f32_16x16x32_bf16 v[152:155], a[180:183], v[36:39], v[152:155]
 v_mfma_f32_16x16x32_bf16 v[152:155], a[184:187], v[40:43], v[152:155]
 buffer_load_dwordx4 a[44:47], v12, s[28:31], s5 offen offset:3072 sc1
 v_mfma_f32_16x16x32_bf16 v[152:155], a[188:191], v[44:47], v[152:155]
 buffer_store_dwordx4 v[208:211], v20, s[24:27], 0 offen offset:1024 sc1
 v_mfma_f32_16x16x32_bf16 v[156:159], a[252:255], v[44:47], v[156:159]
 v_mfma_f32_16x16x32_bf16 v[156:159], a[248:251], v[40:43], v[156:159]
 v_mfma_f32_16x16x32_bf16 v[156:159], a[244:247], v[36:39], v[156:159]
 v_mfma_f32_16x16x32_bf16 v[156:159], a[240:243], v[32:35], v[156:159]
 s_waitcnt lgkmcnt(2)
 v_mfma_f32_16x16x32_bf16 v[176:179], a[48:51], v[48:51], v[176:179]
 s_add_u32 m0, s58, 131072
 ds_read_b64_tr_b16 v[32:33], v8 offset:49152
 v_mfma_f32_16x16x32_bf16 v[176:179], a[52:55], v[52:55], v[176:179]
 ds_read_b64_tr_b16 v[34:35], v8 offset:49664
 ds_read_b64_tr_b16 v[36:37], v8 offset:53248
 v_mfma_f32_16x16x32_bf16 v[176:179], a[56:59], v[56:59], v[176:179]
 s_waitcnt lgkmcnt(3)
 v_mfma_f32_16x16x32_bf16 v[176:179], a[60:63], v[60:63], v[176:179]
 s_mov_b32 s4, 3145728
 ds_read_b64_tr_b16 v[38:39], v8 offset:53760
 v_mfma_f32_16x16x32_bf16 v[180:183], a[124:127], v[60:63], v[180:183]
 v_mfma_f32_16x16x32_bf16 v[180:183], a[120:123], v[56:59], v[180:183]
 buffer_load_dwordx4 v4, s[8:11], s4 offen offset:0 lds
 v_mfma_f32_16x16x32_bf16 v[180:183], a[116:119], v[52:55], v[180:183]
 ds_read_b64_tr_b16 v[40:41], v8 offset:57344
 ds_read_b64_tr_b16 v[42:43], v8 offset:57856
 v_mfma_f32_16x16x32_bf16 v[180:183], a[112:115], v[48:51], v[180:183]
 buffer_load_dwordx4 v5, s[8:11], s4 offen offset:1024 lds
 v_mfma_f32_16x16x32_bf16 v[184:187], a[176:179], v[48:51], v[184:187]
 ds_read_b64_tr_b16 v[44:45], v8 offset:61440
 ds_read_b64_tr_b16 v[46:47], v8 offset:61952
 v_mfma_f32_16x16x32_bf16 v[184:187], a[180:183], v[52:55], v[184:187]
 v_mfma_f32_16x16x32_bf16 v[184:187], a[184:187], v[56:59], v[184:187]
 buffer_load_dwordx4 v6, s[8:11], s4 offen offset:2048 lds
 v_mfma_f32_16x16x32_bf16 v[184:187], a[188:191], v[60:63], v[184:187]
 v_mfma_f32_16x16x32_bf16 v[188:191], a[252:255], v[60:63], v[188:191]
 buffer_load_dwordx4 v7, s[8:11], s4 offen offset:3072 lds
 v_mfma_f32_16x16x32_bf16 v[188:191], a[248:251], v[56:59], v[188:191]
 v_mfma_f32_16x16x32_bf16 v[188:191], a[244:247], v[52:55], v[188:191]
 v_mfma_f32_16x16x32_bf16 v[188:191], a[240:243], v[48:51], v[188:191]
 s_waitcnt lgkmcnt(4)
 s_waitcnt vmcnt(63)
 v_mfma_f32_16x16x32_bf16 v[64:67], v[32:35], a[0:3], 0
 ds_read_b64_tr_b16 v[48:49], v9 offset:49152
 ds_read_b64_tr_b16 v[50:51], v9 offset:49664
 v_mfma_f32_16x16x32_bf16 v[64:67], v[36:39], a[4:7], v[64:67]
 s_waitcnt lgkmcnt(4)
 v_mfma_f32_16x16x32_bf16 v[64:67], v[40:43], a[8:11], v[64:67]
 s_waitcnt lgkmcnt(2)
 ds_read_b64_tr_b16 v[52:53], v9 offset:53248
 v_mfma_f32_16x16x32_bf16 v[64:67], v[44:47], a[12:15], v[64:67]
 s_waitcnt vmcnt(57)
 ds_read_b64_tr_b16 v[54:55], v9 offset:53760
 v_mfma_f32_16x16x32_bf16 v[68:71], v[44:47], a[76:79], 0
 s_add_u32 s5, s73, 8192
 buffer_store_dwordx4 v[216:219], v20, s[24:27], s65 offen offset:1024 sc1
 v_mfma_f32_16x16x32_bf16 v[68:71], v[40:43], a[72:75], v[68:71]
 ds_read_b64_tr_b16 v[56:57], v9 offset:57344
 ds_read_b64_tr_b16 v[58:59], v9 offset:57856
 v_mfma_f32_16x16x32_bf16 v[68:71], v[36:39], a[68:71], v[68:71]
 v_mfma_f32_16x16x32_bf16 v[68:71], v[32:35], a[64:67], v[68:71]
 s_waitcnt vmcnt(48)
 v_mfma_f32_16x16x32_bf16 v[72:75], v[32:35], a[128:131], 0
 buffer_load_dwordx4 a[96:99], v12, s[28:31], s5 offen offset:0 sc1
 v_mfma_f32_16x16x32_bf16 v[72:75], v[36:39], a[132:135], v[72:75]
 v_mul_f32 v80, 0x5f800000, v80
 v_mul_f32 v84, 0x5f800000, v84
 v_mfma_f32_16x16x32_bf16 v[72:75], v[40:43], a[136:139], v[72:75]
 v_mul_f32 v81, 0x5f800000, v81
 v_mul_f32 v85, 0x5f800000, v85
 v_mfma_f32_16x16x32_bf16 v[72:75], v[44:47], a[140:143], v[72:75]
 s_waitcnt vmcnt(40)
 ds_read_b64_tr_b16 v[60:61], v9 offset:61440
 ds_read_b64_tr_b16 v[62:63], v9 offset:61952
 v_mfma_f32_16x16x32_bf16 v[76:79], v[44:47], a[204:207], 0
 buffer_load_dwordx4 a[100:103], v12, s[28:31], s5 offen offset:1024 sc1
 v_mfma_f32_16x16x32_bf16 v[76:79], v[40:43], a[200:203], v[76:79]
 v_mul_f32 v82, 0x5f800000, v82
 v_mul_f32 v86, 0x5f800000, v86
 v_mfma_f32_16x16x32_bf16 v[76:79], v[36:39], a[196:199], v[76:79]
 v_mul_f32 v83, 0x5f800000, v83
 v_mul_f32 v87, 0x5f800000, v87
 v_mfma_f32_16x16x32_bf16 v[76:79], v[32:35], a[192:195], v[76:79]
 s_waitcnt lgkmcnt(2)
 v_cvt_pk_bf16_f32 v80, v80, v81
 v_cvt_pk_bf16_f32 v81, v82, v83
 v_mfma_f32_16x16x32_bf16 v[96:99], v[48:51], a[0:3], 0
 buffer_load_dwordx4 a[104:107], v12, s[28:31], s5 offen offset:2048 sc1
 v_mfma_f32_16x16x32_bf16 v[96:99], v[52:55], a[4:7], v[96:99]
 ds_read_b64_tr_b16 v[32:33], v10 offset:49152
 v_cvt_pk_bf16_f32 v82, v84, v85
 v_mfma_f32_16x16x32_bf16 v[96:99], v[56:59], a[8:11], v[96:99]
 s_waitcnt lgkmcnt(1)
 v_cvt_pk_bf16_f32 v83, v86, v87
 v_mul_f32 v88, 0x5f800000, v88
 v_mul_f32 v92, 0x5f800000, v92
 v_mfma_f32_16x16x32_bf16 v[96:99], v[60:63], a[12:15], v[96:99]
 ds_read_b64_tr_b16 v[34:35], v10 offset:49664
 v_mul_f32 v89, 0x5f800000, v89
 v_mul_f32 v93, 0x5f800000, v93
 v_mfma_f32_16x16x32_bf16 v[100:103], v[60:63], a[76:79], 0
 v_mul_f32 v90, 0x5f800000, v90
 v_mul_f32 v94, 0x5f800000, v94
 v_mfma_f32_16x16x32_bf16 v[100:103], v[56:59], a[72:75], v[100:103]
 buffer_load_dwordx4 a[108:111], v12, s[28:31], s5 offen offset:3072 sc1
 v_mfma_f32_16x16x32_bf16 v[100:103], v[52:55], a[68:71], v[100:103]
 ds_read_b64_tr_b16 v[36:37], v10 offset:53248
 v_mul_f32 v91, 0x5f800000, v91
 v_mul_f32 v95, 0x5f800000, v95
 v_mfma_f32_16x16x32_bf16 v[100:103], v[48:51], a[64:67], v[100:103]
 buffer_store_dwordx4 v[224:227], v20, s[24:27], 0 offen offset:2048 sc1
 v_mfma_f32_16x16x32_bf16 v[104:107], v[48:51], a[128:131], 0
 ds_read_b64_tr_b16 v[38:39], v10 offset:53760
 v_cvt_pk_bf16_f32 v88, v88, v89
 v_mfma_f32_16x16x32_bf16 v[104:107], v[52:55], a[132:135], v[104:107]
 s_add_u32 s5, s74, 8192
 ds_read_b64_tr_b16 v[40:41], v10 offset:57344
 v_mfma_f32_16x16x32_bf16 v[104:107], v[56:59], a[136:139], v[104:107]
 ds_read_b64_tr_b16 v[42:43], v10 offset:57856
 v_cvt_pk_bf16_f32 v89, v90, v91
 v_mfma_f32_16x16x32_bf16 v[104:107], v[60:63], a[140:143], v[104:107]
 ds_read_b64_tr_b16 v[44:45], v10 offset:61440
 v_cvt_pk_bf16_f32 v90, v92, v93
 ds_read_b64_tr_b16 v[46:47], v10 offset:61952
 v_mfma_f32_16x16x32_bf16 v[108:111], v[60:63], a[204:207], 0
 v_cvt_pk_bf16_f32 v91, v94, v95
 v_mul_f32 v112, 0x5f800000, v112
 v_mul_f32 v116, 0x5f800000, v116
 v_mfma_f32_16x16x32_bf16 v[108:111], v[56:59], a[200:203], v[108:111]
 buffer_load_dwordx4 a[160:163], v12, s[28:31], s5 offen offset:0 sc1
 v_mfma_f32_16x16x32_bf16 v[108:111], v[52:55], a[196:199], v[108:111]
 v_mul_f32 v113, 0x5f800000, v113
 v_mul_f32 v117, 0x5f800000, v117
 v_mfma_f32_16x16x32_bf16 v[108:111], v[48:51], a[192:195], v[108:111]
 s_waitcnt lgkmcnt(6)
 v_mul_f32 v114, 0x5f800000, v114
 v_mul_f32 v118, 0x5f800000, v118
 v_mfma_f32_16x16x32_bf16 v[128:131], v[32:35], a[0:3], 0
 s_waitcnt lgkmcnt(4)
 v_mul_f32 v115, 0x5f800000, v115
 v_mul_f32 v119, 0x5f800000, v119
 v_mfma_f32_16x16x32_bf16 v[128:131], v[36:39], a[4:7], v[128:131]
 s_waitcnt lgkmcnt(2)
 v_cvt_pk_bf16_f32 v112, v112, v113
 v_cvt_pk_bf16_f32 v113, v114, v115
 v_mfma_f32_16x16x32_bf16 v[128:131], v[40:43], a[8:11], v[128:131]
 s_waitcnt lgkmcnt(0)
 buffer_load_dwordx4 a[164:167], v12, s[28:31], s5 offen offset:1024 sc1
 v_mfma_f32_16x16x32_bf16 v[128:131], v[44:47], a[12:15], v[128:131]
 ds_read_b64_tr_b16 v[48:49], v11 offset:49152
 v_cvt_pk_bf16_f32 v114, v116, v117
 v_mfma_f32_16x16x32_bf16 v[132:135], v[44:47], a[76:79], 0
 ds_read_b64_tr_b16 v[50:51], v11 offset:49664
 v_cvt_pk_bf16_f32 v115, v118, v119
 v_mfma_f32_16x16x32_bf16 v[132:135], v[40:43], a[72:75], v[132:135]
 ds_read_b64_tr_b16 v[52:53], v11 offset:53248
 v_mul_f32 v120, 0x5f800000, v120
 v_mul_f32 v124, 0x5f800000, v124
 v_mfma_f32_16x16x32_bf16 v[132:135], v[36:39], a[68:71], v[132:135]
 buffer_load_dwordx4 a[168:171], v12, s[28:31], s5 offen offset:2048 sc1
 v_mfma_f32_16x16x32_bf16 v[132:135], v[32:35], a[64:67], v[132:135]
 ds_read_b64_tr_b16 v[54:55], v11 offset:53760
 v_mul_f32 v121, 0x5f800000, v121
 v_mul_f32 v125, 0x5f800000, v125
 v_mfma_f32_16x16x32_bf16 v[136:139], v[32:35], a[128:131], 0
 ds_read_b64_tr_b16 v[56:57], v11 offset:57344
 v_mul_f32 v122, 0x5f800000, v122
 v_mul_f32 v126, 0x5f800000, v126
 v_mfma_f32_16x16x32_bf16 v[136:139], v[36:39], a[132:135], v[136:139]
 ds_read_b64_tr_b16 v[58:59], v11 offset:57856
 v_mul_f32 v123, 0x5f800000, v123
 v_mul_f32 v127, 0x5f800000, v127
 v_mfma_f32_16x16x32_bf16 v[136:139], v[40:43], a[136:139], v[136:139]
 buffer_load_dwordx4 a[172:175], v12, s[28:31], s5 offen offset:3072 sc1
 v_mfma_f32_16x16x32_bf16 v[136:139], v[44:47], a[140:143], v[136:139]
 buffer_store_dwordx4 v[232:235], v20, s[24:27], s65 offen offset:2048 sc1
 ds_read_b64_tr_b16 v[60:61], v11 offset:61440
 ds_read_b64_tr_b16 v[62:63], v11 offset:61952
 v_mfma_f32_16x16x32_bf16 v[140:143], v[44:47], a[204:207], 0
 v_cvt_pk_bf16_f32 v120, v120, v121
 v_cvt_pk_bf16_f32 v121, v122, v123
 v_mfma_f32_16x16x32_bf16 v[140:143], v[40:43], a[200:203], v[140:143]
 v_cvt_pk_bf16_f32 v122, v124, v125
 v_cvt_pk_bf16_f32 v123, v126, v127
 v_mfma_f32_16x16x32_bf16 v[140:143], v[36:39], a[196:199], v[140:143]
 v_mul_f32 v144, 0x5f800000, v144
 v_mul_f32 v148, 0x5f800000, v148
 v_mfma_f32_16x16x32_bf16 v[140:143], v[32:35], a[192:195], v[140:143]
 s_waitcnt lgkmcnt(6)
 s_barrier
 v_mfma_f32_16x16x32_bf16 v[160:163], v[48:51], a[0:3], 0
 s_waitcnt lgkmcnt(4)
 v_mul_f32 v145, 0x5f800000, v145
 v_mul_f32 v149, 0x5f800000, v149
 v_mfma_f32_16x16x32_bf16 v[160:163], v[52:55], a[4:7], v[160:163]
 s_waitcnt lgkmcnt(2)
 v_mul_f32 v146, 0x5f800000, v146
 v_mul_f32 v150, 0x5f800000, v150
 v_mfma_f32_16x16x32_bf16 v[160:163], v[56:59], a[8:11], v[160:163]
 s_waitcnt lgkmcnt(0)
 ds_read_b64_tr_b16 v[32:33], v8 offset:0
 v_mfma_f32_16x16x32_bf16 v[160:163], v[60:63], a[12:15], v[160:163]
 s_add_u32 m0, s58, 147456
 ds_read_b64_tr_b16 v[34:35], v8 offset:512
 v_mfma_f32_16x16x32_bf16 v[164:167], v[60:63], a[76:79], 0
 s_mov_b32 s4, 3145856
 v_mul_f32 v147, 0x5f800000, v147
 v_mul_f32 v151, 0x5f800000, v151
 v_mfma_f32_16x16x32_bf16 v[164:167], v[56:59], a[72:75], v[164:167]
 buffer_load_dwordx4 v4, s[8:11], s4 offen offset:0 lds
 v_mfma_f32_16x16x32_bf16 v[164:167], v[52:55], a[68:71], v[164:167]
 ds_read_b64_tr_b16 v[36:37], v8 offset:4096
 v_cvt_pk_bf16_f32 v144, v144, v145
 v_mfma_f32_16x16x32_bf16 v[164:167], v[48:51], a[64:67], v[164:167]
 buffer_load_dwordx4 v5, s[8:11], s4 offen offset:1024 lds
 v_mfma_f32_16x16x32_bf16 v[168:171], v[48:51], a[128:131], 0
 ds_read_b64_tr_b16 v[38:39], v8 offset:4608
 v_cvt_pk_bf16_f32 v145, v146, v147
 v_mfma_f32_16x16x32_bf16 v[168:171], v[52:55], a[132:135], v[168:171]
 ds_read_b64_tr_b16 v[40:41], v8 offset:8192
 v_cvt_pk_bf16_f32 v146, v148, v149
 v_mfma_f32_16x16x32_bf16 v[168:171], v[56:59], a[136:139], v[168:171]
 buffer_load_dwordx4 v6, s[8:11], s4 offen offset:2048 lds
 v_mfma_f32_16x16x32_bf16 v[168:171], v[60:63], a[140:143], v[168:171]
 ds_read_b64_tr_b16 v[42:43], v8 offset:8704
 v_cvt_pk_bf16_f32 v147, v150, v151
 ds_read_b64_tr_b16 v[44:45], v8 offset:12288
 ds_read_b64_tr_b16 v[46:47], v8 offset:12800
 v_mfma_f32_16x16x32_bf16 v[172:175], v[60:63], a[204:207], 0
 buffer_load_dwordx4 v7, s[8:11], s4 offen offset:3072 lds
 v_mfma_f32_16x16x32_bf16 v[172:175], v[56:59], a[200:203], v[172:175]
 v_mul_f32 v152, 0x5f800000, v152
 v_mul_f32 v156, 0x5f800000, v156
 v_mfma_f32_16x16x32_bf16 v[172:175], v[52:55], a[196:199], v[172:175]
 v_mul_f32 v153, 0x5f800000, v153
 v_mul_f32 v157, 0x5f800000, v157
 v_mfma_f32_16x16x32_bf16 v[172:175], v[48:51], a[192:195], v[172:175]
 v_mul_f32 v154, 0x5f800000, v154
 v_mul_f32 v158, 0x5f800000, v158
 v_mul_f32 v155, 0x5f800000, v155
 v_mul_f32 v159, 0x5f800000, v159
 v_cvt_pk_bf16_f32 v152, v152, v153
 v_cvt_pk_bf16_f32 v153, v154, v155
 v_cvt_pk_bf16_f32 v154, v156, v157
 v_cvt_pk_bf16_f32 v155, v158, v159
 v_mul_f32 v176, 0x5f800000, v176
 v_mul_f32 v180, 0x5f800000, v180
 v_mul_f32 v177, 0x5f800000, v177
 v_mul_f32 v181, 0x5f800000, v181
 v_mul_f32 v178, 0x5f800000, v178
 v_mul_f32 v182, 0x5f800000, v182
 v_mul_f32 v179, 0x5f800000, v179
 v_mul_f32 v183, 0x5f800000, v183
 v_cvt_pk_bf16_f32 v176, v176, v177
 v_cvt_pk_bf16_f32 v177, v178, v179
 v_cvt_pk_bf16_f32 v178, v180, v181
 v_cvt_pk_bf16_f32 v179, v182, v183
 v_mul_f32 v184, 0x5f800000, v184
 v_mul_f32 v188, 0x5f800000, v188
 v_mul_f32 v185, 0x5f800000, v185
 v_mul_f32 v189, 0x5f800000, v189
 v_mul_f32 v186, 0x5f800000, v186
 v_mul_f32 v190, 0x5f800000, v190
 v_mul_f32 v187, 0x5f800000, v187
 v_mul_f32 v191, 0x5f800000, v191
 v_cvt_pk_bf16_f32 v184, v184, v185
 v_cvt_pk_bf16_f32 v185, v186, v187
 v_cvt_pk_bf16_f32 v186, v188, v189
 v_cvt_pk_bf16_f32 v187, v190, v191
 s_waitcnt lgkmcnt(6)
 v_mfma_f32_16x16x32_bf16 v[196:199], v[32:35], a[0:3], 0
 s_waitcnt lgkmcnt(4)
 ds_read_b64_tr_b16 v[48:49], v9 offset:0
 v_mfma_f32_16x16x32_bf16 v[196:199], v[36:39], a[4:7], v[196:199]
 s_waitcnt lgkmcnt(3)
 ds_read_b64_tr_b16 v[50:51], v9 offset:512
 v_mfma_f32_16x16x32_bf16 v[196:199], v[40:43], a[8:11], v[196:199]
 s_waitcnt lgkmcnt(2)
 ds_read_b64_tr_b16 v[52:53], v9 offset:4096
 v_mfma_f32_16x16x32_bf16 v[196:199], v[44:47], a[12:15], v[196:199]
 ds_read_b64_tr_b16 v[54:55], v9 offset:4608
 v_mfma_f32_16x16x32_bf16 v[204:207], v[44:47], a[76:79], 0
 s_add_u32 s5, s75, 8192
 buffer_store_dwordx4 v[240:243], v20, s[24:27], 0 offen offset:3072 sc1
 v_mfma_f32_16x16x32_bf16 v[204:207], v[40:43], a[72:75], v[204:207]
 ds_read_b64_tr_b16 v[56:57], v9 offset:8192
 ds_read_b64_tr_b16 v[58:59], v9 offset:8704
 v_mfma_f32_16x16x32_bf16 v[204:207], v[36:39], a[68:71], v[204:207]
 v_mfma_f32_16x16x32_bf16 v[204:207], v[32:35], a[64:67], v[204:207]
 v_mfma_f32_16x16x32_bf16 v[212:215], v[32:35], a[128:131], 0
 ds_read_b64_tr_b16 v[60:61], v9 offset:12288
 ds_read_b64_tr_b16 v[62:63], v9 offset:12800
 v_mfma_f32_16x16x32_bf16 v[212:215], v[36:39], a[132:135], v[212:215]
 v_mfma_f32_16x16x32_bf16 v[212:215], v[40:43], a[136:139], v[212:215]
 v_mfma_f32_16x16x32_bf16 v[212:215], v[44:47], a[140:143], v[212:215]
 v_mfma_f32_16x16x32_bf16 v[220:223], v[44:47], a[204:207], 0
 v_mfma_f32_16x16x32_bf16 v[220:223], v[40:43], a[200:203], v[220:223]
 v_mfma_f32_16x16x32_bf16 v[220:223], v[36:39], a[196:199], v[220:223]
 v_mfma_f32_16x16x32_bf16 v[220:223], v[32:35], a[192:195], v[220:223]
 s_waitcnt lgkmcnt(2)
 buffer_load_dwordx4 a[224:227], v12, s[28:31], s5 offen offset:0 sc1
 v_mfma_f32_16x16x32_bf16 v[228:231], v[48:51], a[0:3], 0
 buffer_store_dwordx4 v[248:251], v20, s[24:27], s65 offen offset:3072 sc1
 v_mfma_f32_16x16x32_bf16 v[228:231], v[52:55], a[4:7], v[228:231]
 ds_read_b64_tr_b16 v[32:33], v10 offset:0
 ds_read_b64_tr_b16 v[34:35], v10 offset:512
 v_mfma_f32_16x16x32_bf16 v[228:231], v[56:59], a[8:11], v[228:231]
 s_waitcnt lgkmcnt(2)
 ds_read_b64_tr_b16 v[36:37], v10 offset:4096
 v_mfma_f32_16x16x32_bf16 v[228:231], v[60:63], a[12:15], v[228:231]
 ds_read_b64_tr_b16 v[38:39], v10 offset:4608
 v_mfma_f32_16x16x32_bf16 v[236:239], v[60:63], a[76:79], 0
 v_mfma_f32_16x16x32_bf16 v[236:239], v[56:59], a[72:75], v[236:239]
 ds_read_b64_tr_b16 v[40:41], v10 offset:8192
 ds_read_b64_tr_b16 v[42:43], v10 offset:8704
 v_mfma_f32_16x16x32_bf16 v[236:239], v[52:55], a[68:71], v[236:239]
 v_mfma_f32_16x16x32_bf16 v[236:239], v[48:51], a[64:67], v[236:239]
 v_mfma_f32_16x16x32_bf16 v[244:247], v[48:51], a[128:131], 0
 ds_read_b64_tr_b16 v[44:45], v10 offset:12288
 ds_read_b64_tr_b16 v[46:47], v10 offset:12800
 v_mfma_f32_16x16x32_bf16 v[244:247], v[52:55], a[132:135], v[244:247]
 v_mfma_f32_16x16x32_bf16 v[244:247], v[56:59], a[136:139], v[244:247]
 buffer_load_dwordx4 a[228:231], v12, s[28:31], s5 offen offset:1024 sc1
 v_mfma_f32_16x16x32_bf16 v[244:247], v[60:63], a[140:143], v[244:247]
 buffer_store_dwordx4 v[80:83], v20, s[24:27], s64 offen offset:0 sc1
 v_mfma_f32_16x16x32_bf16 v[252:255], v[60:63], a[204:207], 0
 v_mfma_f32_16x16x32_bf16 v[252:255], v[56:59], a[200:203], v[252:255]
 v_mfma_f32_16x16x32_bf16 v[252:255], v[52:55], a[196:199], v[252:255]
 v_mfma_f32_16x16x32_bf16 v[252:255], v[48:51], a[192:195], v[252:255]
 s_waitcnt lgkmcnt(2)
 v_mfma_f32_16x16x32_bf16 v[84:87], v[32:35], a[0:3], 0
 ds_read_b64_tr_b16 v[48:49], v11 offset:0
 ds_read_b64_tr_b16 v[50:51], v11 offset:512
 v_mfma_f32_16x16x32_bf16 v[84:87], v[36:39], a[4:7], v[84:87]
 v_mfma_f32_16x16x32_bf16 v[84:87], v[40:43], a[8:11], v[84:87]
 s_waitcnt lgkmcnt(2)
 ds_read_b64_tr_b16 v[52:53], v11 offset:4096
 v_mfma_f32_16x16x32_bf16 v[84:87], v[44:47], a[12:15], v[84:87]
 ds_read_b64_tr_b16 v[54:55], v11 offset:4608
 v_mfma_f32_16x16x32_bf16 v[92:95], v[44:47], a[76:79], 0
 v_mfma_f32_16x16x32_bf16 v[92:95], v[40:43], a[72:75], v[92:95]
 ds_read_b64_tr_b16 v[56:57], v11 offset:8192
 ds_read_b64_tr_b16 v[58:59], v11 offset:8704
 v_mfma_f32_16x16x32_bf16 v[92:95], v[36:39], a[68:71], v[92:95]
 buffer_load_dwordx4 a[232:235], v12, s[28:31], s5 offen offset:2048 sc1
 v_mfma_f32_16x16x32_bf16 v[92:95], v[32:35], a[64:67], v[92:95]
 buffer_store_dwordx4 v[88:91], v20, s[24:27], s66 offen offset:0 sc1
 v_mfma_f32_16x16x32_bf16 v[116:119], v[32:35], a[128:131], 0
 ds_read_b64_tr_b16 v[60:61], v11 offset:12288
 ds_read_b64_tr_b16 v[62:63], v11 offset:12800
 v_mfma_f32_16x16x32_bf16 v[116:119], v[36:39], a[132:135], v[116:119]
 v_mfma_f32_16x16x32_bf16 v[116:119], v[40:43], a[136:139], v[116:119]
 v_mfma_f32_16x16x32_bf16 v[116:119], v[44:47], a[140:143], v[116:119]
 v_mfma_f32_16x16x32_bf16 v[124:127], v[44:47], a[204:207], 0
 v_mfma_f32_16x16x32_bf16 v[124:127], v[40:43], a[200:203], v[124:127]
 v_mfma_f32_16x16x32_bf16 v[124:127], v[36:39], a[196:199], v[124:127]
 v_mfma_f32_16x16x32_bf16 v[124:127], v[32:35], a[192:195], v[124:127]
 s_waitcnt lgkmcnt(2)
 v_mfma_f32_16x16x32_bf16 v[148:151], v[48:51], a[0:3], 0
 v_add_u32 v8, 0x10000, v8
 v_mfma_f32_16x16x32_bf16 v[148:151], v[52:55], a[4:7], v[148:151]
 buffer_load_dwordx4 a[236:239], v12, s[28:31], s5 offen offset:3072 sc1
 v_mfma_f32_16x16x32_bf16 v[148:151], v[56:59], a[8:11], v[148:151]
 s_waitcnt lgkmcnt(0)
 buffer_store_dwordx4 v[112:115], v20, s[24:27], s64 offen offset:1024 sc1
 v_mfma_f32_16x16x32_bf16 v[148:151], v[60:63], a[12:15], v[148:151]
 ds_read_b64_tr_b16 v[32:33], v8 offset:0
 ds_read_b64_tr_b16 v[34:35], v8 offset:512
 v_mfma_f32_16x16x32_bf16 v[156:159], v[60:63], a[76:79], 0
 ds_read_b64_tr_b16 v[36:37], v8 offset:4096
 ds_read_b64_tr_b16 v[38:39], v8 offset:4608
 v_mfma_f32_16x16x32_bf16 v[156:159], v[56:59], a[72:75], v[156:159]
 ds_read_b64_tr_b16 v[40:41], v8 offset:8192
 v_mfma_f32_16x16x32_bf16 v[156:159], v[52:55], a[68:71], v[156:159]
 v_mfma_f32_16x16x32_bf16 v[156:159], v[48:51], a[64:67], v[156:159]
 ds_read_b64_tr_b16 v[42:43], v8 offset:8704
 ds_read_b64_tr_b16 v[44:45], v8 offset:12288
 v_mfma_f32_16x16x32_bf16 v[180:183], v[48:51], a[128:131], 0
 v_mfma_f32_16x16x32_bf16 v[180:183], v[52:55], a[132:135], v[180:183]
 ds_read_b64_tr_b16 v[46:47], v8 offset:12800
 v_mfma_f32_16x16x32_bf16 v[180:183], v[56:59], a[136:139], v[180:183]
 v_mfma_f32_16x16x32_bf16 v[180:183], v[60:63], a[140:143], v[180:183]
 v_mfma_f32_16x16x32_bf16 v[188:191], v[60:63], a[204:207], 0
 v_mfma_f32_16x16x32_bf16 v[188:191], v[56:59], a[200:203], v[188:191]
 v_mfma_f32_16x16x32_bf16 v[188:191], v[52:55], a[196:199], v[188:191]
 v_mfma_f32_16x16x32_bf16 v[188:191], v[48:51], a[192:195], v[188:191]
 s_waitcnt lgkmcnt(4)
 s_waitcnt vmcnt(57)
 v_mfma_f32_16x16x32_bf16 v[64:67], v[32:35], a[16:19], v[64:67]
 v_add_u32 v9, 0x10000, v9
 v_mfma_f32_16x16x32_bf16 v[64:67], v[36:39], a[20:23], v[64:67]
 s_waitcnt lgkmcnt(2)
 ds_read_b64_tr_b16 v[48:49], v9 offset:0
 v_mfma_f32_16x16x32_bf16 v[64:67], v[40:43], a[24:27], v[64:67]
 s_waitcnt lgkmcnt(1)
 ds_read_b64_tr_b16 v[50:51], v9 offset:512
 v_mfma_f32_16x16x32_bf16 v[64:67], v[44:47], a[28:31], v[64:67]
 s_waitcnt vmcnt(48)
 ds_read_b64_tr_b16 v[52:53], v9 offset:4096
 v_mfma_f32_16x16x32_bf16 v[68:71], v[44:47], a[92:95], v[68:71]
 buffer_store_dwordx4 v[120:123], v20, s[24:27], s66 offen offset:1024 sc1
 v_mfma_f32_16x16x32_bf16 v[68:71], v[40:43], a[88:91], v[68:71]
 ds_read_b64_tr_b16 v[54:55], v9 offset:4608
 ds_read_b64_tr_b16 v[56:57], v9 offset:8192
 v_mfma_f32_16x16x32_bf16 v[68:71], v[36:39], a[84:87], v[68:71]
 v_mfma_f32_16x16x32_bf16 v[68:71], v[32:35], a[80:83], v[68:71]
 s_waitcnt vmcnt(44)
 ds_read_b64_tr_b16 v[58:59], v9 offset:8704
 v_mfma_f32_16x16x32_bf16 v[72:75], v[32:35], a[144:147], v[72:75]
 ds_read_b64_tr_b16 v[60:61], v9 offset:12288
 ds_read_b64_tr_b16 v[62:63], v9 offset:12800
 v_mfma_f32_16x16x32_bf16 v[72:75], v[36:39], a[148:151], v[72:75]
 v_mfma_f32_16x16x32_bf16 v[72:75], v[40:43], a[152:155], v[72:75]
 v_mfma_f32_16x16x32_bf16 v[72:75], v[44:47], a[156:159], v[72:75]
 s_waitcnt vmcnt(35)
 v_mfma_f32_16x16x32_bf16 v[76:79], v[44:47], a[220:223], v[76:79]
 v_mfma_f32_16x16x32_bf16 v[76:79], v[40:43], a[216:219], v[76:79]
 v_mfma_f32_16x16x32_bf16 v[76:79], v[36:39], a[212:215], v[76:79]
 v_mfma_f32_16x16x32_bf16 v[76:79], v[32:35], a[208:211], v[76:79]
 s_waitcnt lgkmcnt(4)
 buffer_store_dwordx4 v[144:147], v20, s[24:27], s64 offen offset:2048 sc1
 v_mfma_f32_16x16x32_bf16 v[96:99], v[48:51], a[16:19], v[96:99]
 v_add_u32 v10, 0x10000, v10
 v_mfma_f32_16x16x32_bf16 v[96:99], v[52:55], a[20:23], v[96:99]
 s_waitcnt lgkmcnt(2)
 ds_read_b64_tr_b16 v[32:33], v10 offset:0
 v_mfma_f32_16x16x32_bf16 v[96:99], v[56:59], a[24:27], v[96:99]
 s_waitcnt lgkmcnt(1)
 ds_read_b64_tr_b16 v[34:35], v10 offset:512
 v_mfma_f32_16x16x32_bf16 v[96:99], v[60:63], a[28:31], v[96:99]
 ds_read_b64_tr_b16 v[36:37], v10 offset:4096
 ds_read_b64_tr_b16 v[38:39], v10 offset:4608
 v_mfma_f32_16x16x32_bf16 v[100:103], v[60:63], a[92:95], v[100:103]
 v_mfma_f32_16x16x32_bf16 v[100:103], v[56:59], a[88:91], v[100:103]
 ds_read_b64_tr_b16 v[40:41], v10 offset:8192
 v_mfma_f32_16x16x32_bf16 v[100:103], v[52:55], a[84:87], v[100:103]
 v_mfma_f32_16x16x32_bf16 v[100:103], v[48:51], a[80:83], v[100:103]
 ds_read_b64_tr_b16 v[42:43], v10 offset:8704
 ds_read_b64_tr_b16 v[44:45], v10 offset:12288
 v_mfma_f32_16x16x32_bf16 v[104:107], v[48:51], a[144:147], v[104:107]
 v_mfma_f32_16x16x32_bf16 v[104:107], v[52:55], a[148:151], v[104:107]
 ds_read_b64_tr_b16 v[46:47], v10 offset:12800
 v_mfma_f32_16x16x32_bf16 v[104:107], v[56:59], a[152:155], v[104:107]
 buffer_store_dwordx4 v[152:155], v20, s[24:27], s66 offen offset:2048 sc1
 v_mfma_f32_16x16x32_bf16 v[104:107], v[60:63], a[156:159], v[104:107]
 v_mfma_f32_16x16x32_bf16 v[108:111], v[60:63], a[220:223], v[108:111]
 v_mfma_f32_16x16x32_bf16 v[108:111], v[56:59], a[216:219], v[108:111]
 v_mfma_f32_16x16x32_bf16 v[108:111], v[52:55], a[212:215], v[108:111]
 v_mfma_f32_16x16x32_bf16 v[108:111], v[48:51], a[208:211], v[108:111]
 s_waitcnt lgkmcnt(4)
 v_mfma_f32_16x16x32_bf16 v[128:131], v[32:35], a[16:19], v[128:131]
 v_add_u32 v11, 0x10000, v11
 v_mfma_f32_16x16x32_bf16 v[128:131], v[36:39], a[20:23], v[128:131]
 s_waitcnt lgkmcnt(2)
 ds_read_b64_tr_b16 v[48:49], v11 offset:0
 v_mfma_f32_16x16x32_bf16 v[128:131], v[40:43], a[24:27], v[128:131]
 s_waitcnt lgkmcnt(1)
 ds_read_b64_tr_b16 v[50:51], v11 offset:512
 v_mfma_f32_16x16x32_bf16 v[128:131], v[44:47], a[28:31], v[128:131]
 ds_read_b64_tr_b16 v[52:53], v11 offset:4096
 ds_read_b64_tr_b16 v[54:55], v11 offset:4608
 v_mfma_f32_16x16x32_bf16 v[132:135], v[44:47], a[92:95], v[132:135]
 v_mfma_f32_16x16x32_bf16 v[132:135], v[40:43], a[88:91], v[132:135]
 ds_read_b64_tr_b16 v[56:57], v11 offset:8192
 v_mfma_f32_16x16x32_bf16 v[132:135], v[36:39], a[84:87], v[132:135]
 buffer_store_dwordx4 v[176:179], v20, s[24:27], s64 offen offset:3072 sc1
 v_mfma_f32_16x16x32_bf16 v[132:135], v[32:35], a[80:83], v[132:135]
 ds_read_b64_tr_b16 v[58:59], v11 offset:8704
 ds_read_b64_tr_b16 v[60:61], v11 offset:12288
 v_mfma_f32_16x16x32_bf16 v[136:139], v[32:35], a[144:147], v[136:139]
 v_mfma_f32_16x16x32_bf16 v[136:139], v[36:39], a[148:151], v[136:139]
 ds_read_b64_tr_b16 v[62:63], v11 offset:12800
 v_mfma_f32_16x16x32_bf16 v[136:139], v[40:43], a[152:155], v[136:139]
 v_mfma_f32_16x16x32_bf16 v[136:139], v[44:47], a[156:159], v[136:139]
 v_mfma_f32_16x16x32_bf16 v[140:143], v[44:47], a[220:223], v[140:143]
 v_mfma_f32_16x16x32_bf16 v[140:143], v[40:43], a[216:219], v[140:143]
 v_mfma_f32_16x16x32_bf16 v[140:143], v[36:39], a[212:215], v[140:143]
 v_mfma_f32_16x16x32_bf16 v[140:143], v[32:35], a[208:211], v[140:143]
 s_waitcnt lgkmcnt(4)
 s_barrier
 v_mfma_f32_16x16x32_bf16 v[160:163], v[48:51], a[16:19], v[160:163]
 ds_read_b64_tr_b16 v[32:33], v8 offset:16384
 ds_read_b64_tr_b16 v[34:35], v8 offset:16896
 v_mfma_f32_16x16x32_bf16 v[160:163], v[52:55], a[20:23], v[160:163]
 s_waitcnt lgkmcnt(4)
 buffer_store_dwordx4 v[184:187], v20, s[24:27], s66 offen offset:3072 sc1
 v_mfma_f32_16x16x32_bf16 v[160:163], v[56:59], a[24:27], v[160:163]
 s_waitcnt lgkmcnt(2)
 ds_read_b64_tr_b16 v[36:37], v8 offset:20480
 v_mfma_f32_16x16x32_bf16 v[160:163], v[60:63], a[28:31], v[160:163]
 ds_read_b64_tr_b16 v[38:39], v8 offset:20992
 v_mfma_f32_16x16x32_bf16 v[164:167], v[60:63], a[92:95], v[164:167]
 v_mfma_f32_16x16x32_bf16 v[164:167], v[56:59], a[88:91], v[164:167]
 ds_read_b64_tr_b16 v[40:41], v8 offset:24576
 ds_read_b64_tr_b16 v[42:43], v8 offset:25088
 v_mfma_f32_16x16x32_bf16 v[164:167], v[52:55], a[84:87], v[164:167]
 v_mfma_f32_16x16x32_bf16 v[164:167], v[48:51], a[80:83], v[164:167]
 v_mfma_f32_16x16x32_bf16 v[168:171], v[48:51], a[144:147], v[168:171]
 ds_read_b64_tr_b16 v[44:45], v8 offset:28672
 ds_read_b64_tr_b16 v[46:47], v8 offset:29184
 v_mfma_f32_16x16x32_bf16 v[168:171], v[52:55], a[148:151], v[168:171]
 v_mfma_f32_16x16x32_bf16 v[168:171], v[56:59], a[152:155], v[168:171]
 v_mfma_f32_16x16x32_bf16 v[168:171], v[60:63], a[156:159], v[168:171]
 v_mfma_f32_16x16x32_bf16 v[172:175], v[60:63], a[220:223], v[172:175]
 v_mfma_f32_16x16x32_bf16 v[172:175], v[56:59], a[216:219], v[172:175]
 v_mfma_f32_16x16x32_bf16 v[172:175], v[52:55], a[212:215], v[172:175]
 v_mfma_f32_16x16x32_bf16 v[172:175], v[48:51], a[208:211], v[172:175]
 s_waitcnt lgkmcnt(2)
 v_mfma_f32_16x16x32_bf16 v[196:199], v[32:35], a[16:19], v[196:199]
 ds_read_b64_tr_b16 v[48:49], v9 offset:16384
 ds_read_b64_tr_b16 v[50:51], v9 offset:16896
 v_mfma_f32_16x16x32_bf16 v[196:199], v[36:39], a[20:23], v[196:199]
 v_mfma_f32_16x16x32_bf16 v[196:199], v[40:43], a[24:27], v[196:199]
 s_waitcnt lgkmcnt(2)
 ds_read_b64_tr_b16 v[52:53], v9 offset:20480
 v_mfma_f32_16x16x32_bf16 v[196:199], v[44:47], a[28:31], v[196:199]
 ds_read_b64_tr_b16 v[54:55], v9 offset:20992
 v_mfma_f32_16x16x32_bf16 v[204:207], v[44:47], a[92:95], v[204:207]
 s_add_u32 s5, s72, 12288
 v_mfma_f32_16x16x32_bf16 v[204:207], v[40:43], a[88:91], v[204:207]
 ds_read_b64_tr_b16 v[56:57], v9 offset:24576
 ds_read_b64_tr_b16 v[58:59], v9 offset:25088
 v_mfma_f32_16x16x32_bf16 v[204:207], v[36:39], a[84:87], v[204:207]
 v_mfma_f32_16x16x32_bf16 v[204:207], v[32:35], a[80:83], v[204:207]
 v_mfma_f32_16x16x32_bf16 v[212:215], v[32:35], a[144:147], v[212:215]
 ds_read_b64_tr_b16 v[60:61], v9 offset:28672
 ds_read_b64_tr_b16 v[62:63], v9 offset:29184
 v_mfma_f32_16x16x32_bf16 v[212:215], v[36:39], a[148:151], v[212:215]
 buffer_load_dwordx4 a[48:51], v12, s[28:31], s5 offen offset:0 sc1
 v_mfma_f32_16x16x32_bf16 v[212:215], v[40:43], a[152:155], v[212:215]
 v_mfma_f32_16x16x32_bf16 v[212:215], v[44:47], a[156:159], v[212:215]
 v_mfma_f32_16x16x32_bf16 v[220:223], v[44:47], a[220:223], v[220:223]
 v_mfma_f32_16x16x32_bf16 v[220:223], v[40:43], a[216:219], v[220:223]
 v_mfma_f32_16x16x32_bf16 v[220:223], v[36:39], a[212:215], v[220:223]
 v_mfma_f32_16x16x32_bf16 v[220:223], v[32:35], a[208:211], v[220:223]
 s_waitcnt lgkmcnt(2)
 buffer_load_dwordx4 a[52:55], v12, s[28:31], s5 offen offset:1024 sc1
 v_mfma_f32_16x16x32_bf16 v[228:231], v[48:51], a[16:19], v[228:231]
 ds_read_b64_tr_b16 v[32:33], v10 offset:16384
 ds_read_b64_tr_b16 v[34:35], v10 offset:16896
 v_mfma_f32_16x16x32_bf16 v[228:231], v[52:55], a[20:23], v[228:231]
 v_mfma_f32_16x16x32_bf16 v[228:231], v[56:59], a[24:27], v[228:231]
 s_waitcnt lgkmcnt(2)
 ds_read_b64_tr_b16 v[36:37], v10 offset:20480
 v_mfma_f32_16x16x32_bf16 v[228:231], v[60:63], a[28:31], v[228:231]
 ds_read_b64_tr_b16 v[38:39], v10 offset:20992
 v_mfma_f32_16x16x32_bf16 v[236:239], v[60:63], a[92:95], v[236:239]
 v_mfma_f32_16x16x32_bf16 v[236:239], v[56:59], a[88:91], v[236:239]
 buffer_load_dwordx4 a[56:59], v12, s[28:31], s5 offen offset:2048 sc1
 v_mfma_f32_16x16x32_bf16 v[236:239], v[52:55], a[84:87], v[236:239]
 ds_read_b64_tr_b16 v[40:41], v10 offset:24576
 ds_read_b64_tr_b16 v[42:43], v10 offset:25088
 v_mfma_f32_16x16x32_bf16 v[236:239], v[48:51], a[80:83], v[236:239]
 v_mfma_f32_16x16x32_bf16 v[244:247], v[48:51], a[144:147], v[244:247]
 ds_read_b64_tr_b16 v[44:45], v10 offset:28672
 ds_read_b64_tr_b16 v[46:47], v10 offset:29184
 v_mfma_f32_16x16x32_bf16 v[244:247], v[52:55], a[148:151], v[244:247]
 v_mfma_f32_16x16x32_bf16 v[244:247], v[56:59], a[152:155], v[244:247]
 buffer_load_dwordx4 a[60:63], v12, s[28:31], s5 offen offset:3072 sc1
 v_mfma_f32_16x16x32_bf16 v[244:247], v[60:63], a[156:159], v[244:247]
 v_mfma_f32_16x16x32_bf16 v[252:255], v[60:63], a[220:223], v[252:255]
 v_mfma_f32_16x16x32_bf16 v[252:255], v[56:59], a[216:219], v[252:255]
 v_mfma_f32_16x16x32_bf16 v[252:255], v[52:55], a[212:215], v[252:255]
 v_mfma_f32_16x16x32_bf16 v[252:255], v[48:51], a[208:211], v[252:255]
 s_waitcnt lgkmcnt(4)
 v_mfma_f32_16x16x32_bf16 v[84:87], v[32:35], a[16:19], v[84:87]
 s_add_u32 s5, s73, 12288
 ds_read_b64_tr_b16 v[48:49], v11 offset:16384
 v_mfma_f32_16x16x32_bf16 v[84:87], v[36:39], a[20:23], v[84:87]
 s_waitcnt lgkmcnt(3)
 ds_read_b64_tr_b16 v[50:51], v11 offset:16896
 v_mfma_f32_16x16x32_bf16 v[84:87], v[40:43], a[24:27], v[84:87]
 s_waitcnt lgkmcnt(2)
 ds_read_b64_tr_b16 v[52:53], v11 offset:20480
 v_mfma_f32_16x16x32_bf16 v[84:87], v[44:47], a[28:31], v[84:87]
 ds_read_b64_tr_b16 v[54:55], v11 offset:20992
 v_mfma_f32_16x16x32_bf16 v[92:95], v[44:47], a[92:95], v[92:95]
 v_mfma_f32_16x16x32_bf16 v[92:95], v[40:43], a[88:91], v[92:95]
 ds_read_b64_tr_b16 v[56:57], v11 offset:24576
 ds_read_b64_tr_b16 v[58:59], v11 offset:25088
 v_mfma_f32_16x16x32_bf16 v[92:95], v[36:39], a[84:87], v[92:95]
 buffer_load_dwordx4 a[112:115], v12, s[28:31], s5 offen offset:0 sc1
 v_mfma_f32_16x16x32_bf16 v[92:95], v[32:35], a[80:83], v[92:95]
 v_mfma_f32_16x16x32_bf16 v[116:119], v[32:35], a[144:147], v[116:119]
 ds_read_b64_tr_b16 v[60:61], v11 offset:28672
 ds_read_b64_tr_b16 v[62:63], v11 offset:29184
 v_mfma_f32_16x16x32_bf16 v[116:119], v[36:39], a[148:151], v[116:119]
 v_mfma_f32_16x16x32_bf16 v[116:119], v[40:43], a[152:155], v[116:119]
 v_mfma_f32_16x16x32_bf16 v[116:119], v[44:47], a[156:159], v[116:119]
 buffer_load_dwordx4 a[116:119], v12, s[28:31], s5 offen offset:1024 sc1
 v_mfma_f32_16x16x32_bf16 v[124:127], v[44:47], a[220:223], v[124:127]
 v_mfma_f32_16x16x32_bf16 v[124:127], v[40:43], a[216:219], v[124:127]
 v_mfma_f32_16x16x32_bf16 v[124:127], v[36:39], a[212:215], v[124:127]
 v_mfma_f32_16x16x32_bf16 v[124:127], v[32:35], a[208:211], v[124:127]
 s_waitcnt lgkmcnt(2)
 v_mfma_f32_16x16x32_bf16 v[148:151], v[48:51], a[16:19], v[148:151]
 ds_read_b64_tr_b16 v[32:33], v8 offset:32768
 ds_read_b64_tr_b16 v[34:35], v8 offset:33280
 v_mfma_f32_16x16x32_bf16 v[148:151], v[52:55], a[20:23], v[148:151]
 buffer_load_dwordx4 a[120:123], v12, s[28:31], s5 offen offset:2048 sc1
 v_mfma_f32_16x16x32_bf16 v[148:151], v[56:59], a[24:27], v[148:151]
 s_waitcnt lgkmcnt(2)
 ds_read_b64_tr_b16 v[36:37], v8 offset:36864
 v_mfma_f32_16x16x32_bf16 v[148:151], v[60:63], a[28:31], v[148:151]
 ds_read_b64_tr_b16 v[38:39], v8 offset:37376
 v_mfma_f32_16x16x32_bf16 v[156:159], v[60:63], a[92:95], v[156:159]
 v_mfma_f32_16x16x32_bf16 v[156:159], v[56:59], a[88:91], v[156:159]
 ds_read_b64_tr_b16 v[40:41], v8 offset:40960
 ds_read_b64_tr_b16 v[42:43], v8 offset:41472
 v_mfma_f32_16x16x32_bf16 v[156:159], v[52:55], a[84:87], v[156:159]
 v_mfma_f32_16x16x32_bf16 v[156:159], v[48:51], a[80:83], v[156:159]
 buffer_load_dwordx4 a[124:127], v12, s[28:31], s5 offen offset:3072 sc1
 v_mfma_f32_16x16x32_bf16 v[180:183], v[48:51], a[144:147], v[180:183]
 ds_read_b64_tr_b16 v[44:45], v8 offset:45056
 ds_read_b64_tr_b16 v[46:47], v8 offset:45568
 v_mfma_f32_16x16x32_bf16 v[180:183], v[52:55], a[148:151], v[180:183]
 v_mfma_f32_16x16x32_bf16 v[180:183], v[56:59], a[152:155], v[180:183]
 v_mfma_f32_16x16x32_bf16 v[180:183], v[60:63], a[156:159], v[180:183]
 v_mfma_f32_16x16x32_bf16 v[188:191], v[60:63], a[220:223], v[188:191]
 v_mfma_f32_16x16x32_bf16 v[188:191], v[56:59], a[216:219], v[188:191]
 v_mfma_f32_16x16x32_bf16 v[188:191], v[52:55], a[212:215], v[188:191]
 v_mfma_f32_16x16x32_bf16 v[188:191], v[48:51], a[208:211], v[188:191]
 s_waitcnt lgkmcnt(2)
 s_waitcnt vmcnt(42)
 v_mfma_f32_16x16x32_bf16 v[64:67], v[32:35], a[32:35], v[64:67]
 ds_read_b64_tr_b16 v[48:49], v9 offset:32768
 ds_read_b64_tr_b16 v[50:51], v9 offset:33280
 v_mfma_f32_16x16x32_bf16 v[64:67], v[36:39], a[36:39], v[64:67]
 v_mfma_f32_16x16x32_bf16 v[64:67], v[40:43], a[40:43], v[64:67]
 s_waitcnt lgkmcnt(2)
 ds_read_b64_tr_b16 v[52:53], v9 offset:36864
 v_mfma_f32_16x16x32_bf16 v[64:67], v[44:47], a[44:47], v[64:67]
 s_waitcnt vmcnt(32)
 ds_read_b64_tr_b16 v[54:55], v9 offset:37376
 v_mfma_f32_16x16x32_bf16 v[68:71], v[44:47], a[108:111], v[68:71]
 s_add_u32 s5, s74, 12288
 v_mfma_f32_16x16x32_bf16 v[68:71], v[40:43], a[104:107], v[68:71]
 ds_read_b64_tr_b16 v[56:57], v9 offset:40960
 ds_read_b64_tr_b16 v[58:59], v9 offset:41472
 v_mfma_f32_16x16x32_bf16 v[68:71], v[36:39], a[100:103], v[68:71]
 v_mfma_f32_16x16x32_bf16 v[68:71], v[32:35], a[96:99], v[68:71]
 s_waitcnt vmcnt(27)
 v_mfma_f32_16x16x32_bf16 v[72:75], v[32:35], a[160:163], v[72:75]
 ds_read_b64_tr_b16 v[60:61], v9 offset:45056
 ds_read_b64_tr_b16 v[62:63], v9 offset:45568
 v_mfma_f32_16x16x32_bf16 v[72:75], v[36:39], a[164:167], v[72:75]
 buffer_load_dwordx4 a[176:179], v12, s[28:31], s5 offen offset:0 sc1
 v_mfma_f32_16x16x32_bf16 v[72:75], v[40:43], a[168:171], v[72:75]
 v_mfma_f32_16x16x32_bf16 v[72:75], v[44:47], a[172:175], v[72:75]
 s_waitcnt vmcnt(15)
 v_mfma_f32_16x16x32_bf16 v[76:79], v[44:47], a[236:239], v[76:79]
 v_mfma_f32_16x16x32_bf16 v[76:79], v[40:43], a[232:235], v[76:79]
 v_mfma_f32_16x16x32_bf16 v[76:79], v[36:39], a[228:231], v[76:79]
 v_mfma_f32_16x16x32_bf16 v[76:79], v[32:35], a[224:227], v[76:79]
 s_waitcnt lgkmcnt(2)
 buffer_load_dwordx4 a[180:183], v12, s[28:31], s5 offen offset:1024 sc1
 v_mfma_f32_16x16x32_bf16 v[96:99], v[48:51], a[32:35], v[96:99]
 ds_read_b64_tr_b16 v[32:33], v10 offset:32768
 ds_read_b64_tr_b16 v[34:35], v10 offset:33280
 v_mfma_f32_16x16x32_bf16 v[96:99], v[52:55], a[36:39], v[96:99]
 v_mfma_f32_16x16x32_bf16 v[96:99], v[56:59], a[40:43], v[96:99]
 s_waitcnt lgkmcnt(2)
 ds_read_b64_tr_b16 v[36:37], v10 offset:36864
 v_mfma_f32_16x16x32_bf16 v[96:99], v[60:63], a[44:47], v[96:99]
 ds_read_b64_tr_b16 v[38:39], v10 offset:37376
 v_mfma_f32_16x16x32_bf16 v[100:103], v[60:63], a[108:111], v[100:103]
 v_mfma_f32_16x16x32_bf16 v[100:103], v[56:59], a[104:107], v[100:103]
 buffer_load_dwordx4 a[184:187], v12, s[28:31], s5 offen offset:2048 sc1
 v_mfma_f32_16x16x32_bf16 v[100:103], v[52:55], a[100:103], v[100:103]
 ds_read_b64_tr_b16 v[40:41], v10 offset:40960
 ds_read_b64_tr_b16 v[42:43], v10 offset:41472
 v_mfma_f32_16x16x32_bf16 v[100:103], v[48:51], a[96:99], v[100:103]
 v_mfma_f32_16x16x32_bf16 v[104:107], v[48:51], a[160:163], v[104:107]
 ds_read_b64_tr_b16 v[44:45], v10 offset:45056
 ds_read_b64_tr_b16 v[46:47], v10 offset:45568
 v_mfma_f32_16x16x32_bf16 v[104:107], v[52:55], a[164:167], v[104:107]
 v_mfma_f32_16x16x32_bf16 v[104:107], v[56:59], a[168:171], v[104:107]
 buffer_load_dwordx4 a[188:191], v12, s[28:31], s5 offen offset:3072 sc1
 v_mfma_f32_16x16x32_bf16 v[104:107], v[60:63], a[172:175], v[104:107]
 v_mfma_f32_16x16x32_bf16 v[108:111], v[60:63], a[236:239], v[108:111]
 v_mfma_f32_16x16x32_bf16 v[108:111], v[56:59], a[232:235], v[108:111]
 v_mfma_f32_16x16x32_bf16 v[108:111], v[52:55], a[228:231], v[108:111]
 v_mfma_f32_16x16x32_bf16 v[108:111], v[48:51], a[224:227], v[108:111]
 s_waitcnt lgkmcnt(4)
 v_mfma_f32_16x16x32_bf16 v[128:131], v[32:35], a[32:35], v[128:131]
 s_add_u32 s5, s75, 12288
 ds_read_b64_tr_b16 v[48:49], v11 offset:32768
 v_mfma_f32_16x16x32_bf16 v[128:131], v[36:39], a[36:39], v[128:131]
 s_waitcnt lgkmcnt(3)
 ds_read_b64_tr_b16 v[50:51], v11 offset:33280
 v_mfma_f32_16x16x32_bf16 v[128:131], v[40:43], a[40:43], v[128:131]
 s_waitcnt lgkmcnt(2)
 ds_read_b64_tr_b16 v[52:53], v11 offset:36864
 v_mfma_f32_16x16x32_bf16 v[128:131], v[44:47], a[44:47], v[128:131]
 ds_read_b64_tr_b16 v[54:55], v11 offset:37376
 v_mfma_f32_16x16x32_bf16 v[132:135], v[44:47], a[108:111], v[132:135]
 v_mfma_f32_16x16x32_bf16 v[132:135], v[40:43], a[104:107], v[132:135]
 ds_read_b64_tr_b16 v[56:57], v11 offset:40960
 ds_read_b64_tr_b16 v[58:59], v11 offset:41472
 v_mfma_f32_16x16x32_bf16 v[132:135], v[36:39], a[100:103], v[132:135]
 buffer_load_dwordx4 a[240:243], v12, s[28:31], s5 offen offset:0 sc1
 v_mfma_f32_16x16x32_bf16 v[132:135], v[32:35], a[96:99], v[132:135]
 v_mfma_f32_16x16x32_bf16 v[136:139], v[32:35], a[160:163], v[136:139]
 ds_read_b64_tr_b16 v[60:61], v11 offset:45056
 ds_read_b64_tr_b16 v[62:63], v11 offset:45568
 v_mfma_f32_16x16x32_bf16 v[136:139], v[36:39], a[164:167], v[136:139]
 v_mfma_f32_16x16x32_bf16 v[136:139], v[40:43], a[168:171], v[136:139]
 v_mfma_f32_16x16x32_bf16 v[136:139], v[44:47], a[172:175], v[136:139]
 buffer_load_dwordx4 a[244:247], v12, s[28:31], s5 offen offset:1024 sc1
 v_mfma_f32_16x16x32_bf16 v[140:143], v[44:47], a[236:239], v[140:143]
 v_mfma_f32_16x16x32_bf16 v[140:143], v[40:43], a[232:235], v[140:143]
 v_mfma_f32_16x16x32_bf16 v[140:143], v[36:39], a[228:231], v[140:143]
 v_mfma_f32_16x16x32_bf16 v[140:143], v[32:35], a[224:227], v[140:143]
 s_waitcnt lgkmcnt(2)
 s_waitcnt vmcnt(14)
 s_barrier
 s_cmp_eq_u32 s3, 0
 s_cbranch_scc0 L_pub_10
 s_mul_i32 s4, s2, 128
 s_add_u32 s4, s4, 32768
 v_lshl_add_u32 v2, v0, 2, s4
 v_mov_b32 v3, s100
 s_mov_b64 exec, 0xffffffff
 buffer_store_dword v3, v2, s[96:99], 0 offen sc1
 s_mov_b64 exec, -1
L_pub_10:
 v_mfma_f32_16x16x32_bf16 v[160:163], v[48:51], a[32:35], v[160:163]
 s_lshl_b32 s43, s2, 2
 ds_read_b64_tr_b16 v[32:33], v8 offset:49152
 v_mfma_f32_16x16x32_bf16 v[160:163], v[52:55], a[36:39], v[160:163]
 s_add_u32 s43, s43, s3
 buffer_load_dwordx4 a[248:251], v12, s[28:31], s5 offen offset:2048 sc1
 v_mfma_f32_16x16x32_bf16 v[160:163], v[56:59], a[40:43], v[160:163]
 s_waitcnt lgkmcnt(1)
 ds_read_b64_tr_b16 v[34:35], v8 offset:49664
 v_mfma_f32_16x16x32_bf16 v[160:163], v[60:63], a[44:47], v[160:163]
 s_lshr_b32 s44, s43, 3
 ds_read_b64_tr_b16 v[36:37], v8 offset:53248
 v_mfma_f32_16x16x32_bf16 v[164:167], v[60:63], a[108:111], v[164:167]
 s_and_b32 s45, s43, 7
 ds_read_b64_tr_b16 v[38:39], v8 offset:53760
 v_mfma_f32_16x16x32_bf16 v[164:167], v[56:59], a[104:107], v[164:167]
 s_lshl_b32 s6, s44, 15
 ds_read_b64_tr_b16 v[40:41], v8 offset:57344
 v_mfma_f32_16x16x32_bf16 v[164:167], v[52:55], a[100:103], v[164:167]
 s_lshl_b32 s7, s45, 7
 ds_read_b64_tr_b16 v[42:43], v8 offset:57856
 v_mfma_f32_16x16x32_bf16 v[164:167], v[48:51], a[96:99], v[164:167]
 buffer_load_dwordx4 a[252:255], v12, s[28:31], s5 offen offset:3072 sc1
 v_mfma_f32_16x16x32_bf16 v[168:171], v[48:51], a[160:163], v[168:171]
 s_add_u32 s6, s6, s7
 ds_read_b64_tr_b16 v[44:45], v8 offset:61440
 v_mfma_f32_16x16x32_bf16 v[168:171], v[52:55], a[164:167], v[168:171]
 s_sub_u32 s7, 4194304, s6
 ds_read_b64_tr_b16 v[46:47], v8 offset:61952
 v_mfma_f32_16x16x32_bf16 v[168:171], v[56:59], a[168:171], v[168:171]
 s_add_u32 s8, s46, s6
 s_addc_u32 s9, s47, 0
 s_mov_b32 s10, s7
 s_mov_b32 s11, 0x20000
 v_mfma_f32_16x16x32_bf16 v[168:171], v[60:63], a[172:175], v[168:171]
 v_mfma_f32_16x16x32_bf16 v[172:175], v[60:63], a[236:239], v[172:175]
 s_lshl_b32 s7, s45, 19
 v_mfma_f32_16x16x32_bf16 v[172:175], v[56:59], a[232:235], v[172:175]
 s_lshl_b32 s44, s44, 10
 v_mfma_f32_16x16x32_bf16 v[172:175], v[52:55], a[228:231], v[172:175]
 s_add_u32 s7, s7, s44
 v_mfma_f32_16x16x32_bf16 v[172:175], v[48:51], a[224:227], v[172:175]
 s_waitcnt lgkmcnt(4)
 v_mfma_f32_16x16x32_bf16 v[196:199], v[32:35], a[32:35], v[196:199]
 s_add_u32 s7, s7, 52428800
 ds_read_b64_tr_b16 v[48:49], v9 offset:49152
 v_mfma_f32_16x16x32_bf16 v[196:199], v[36:39], a[36:39], v[196:199]
 s_waitcnt lgkmcnt(3)
 ds_read_b64_tr_b16 v[50:51], v9 offset:49664
 v_mfma_f32_16x16x32_bf16 v[196:199], v[40:43], a[40:43], v[196:199]
 s_waitcnt lgkmcnt(2)
 ds_read_b64_tr_b16 v[52:53], v9 offset:53248
 v_mfma_f32_16x16x32_bf16 v[196:199], v[44:47], a[44:47], v[196:199]
 s_add_u32 s24, s60, s7
 s_addc_u32 s25, s61, 0
 s_mov_b32 s26, 394240
 s_mov_b32 s27, 0x20000
 v_mfma_f32_16x16x32_bf16 v[204:207], v[44:47], a[108:111], v[204:207]
 s_cmp_ge_u32 s43, 352
 s_cselect_b32 s44, 1, 0
 s_cselect_b32 s38, s52, s50
 s_cselect_b32 s39, s53, s51
 v_mfma_f32_16x16x32_bf16 v[204:207], v[40:43], a[104:107], v[204:207]
 s_mul_i32 s45, s44, 352
 ds_read_b64_tr_b16 v[54:55], v9 offset:53760
 v_mfma_f32_16x16x32_bf16 v[204:207], v[36:39], a[100:103], v[204:207]
 s_sub_u32 s45, s43, s45
 ds_read_b64_tr_b16 v[56:57], v9 offset:57344
 v_mfma_f32_16x16x32_bf16 v[204:207], v[32:35], a[96:99], v[204:207]
 s_mul_i32 s6, s45, 2979
 ds_read_b64_tr_b16 v[58:59], v9 offset:57856
 v_mfma_f32_16x16x32_bf16 v[212:215], v[32:35], a[160:163], v[212:215]
 s_lshr_b32 s6, s6, 16
 ds_read_b64_tr_b16 v[60:61], v9 offset:61440
 v_mfma_f32_16x16x32_bf16 v[212:215], v[36:39], a[164:167], v[212:215]
 s_mul_i32 s7, s6, 22
 ds_read_b64_tr_b16 v[62:63], v9 offset:61952
 v_mfma_f32_16x16x32_bf16 v[212:215], v[40:43], a[168:171], v[212:215]
 s_sub_u32 s7, s45, s7
 v_mfma_f32_16x16x32_bf16 v[212:215], v[44:47], a[172:175], v[212:215]
 s_mul_i32 s48, s6, 88064
 v_mfma_f32_16x16x32_bf16 v[220:223], v[44:47], a[236:239], v[220:223]
 s_lshl_b32 s45, s7, 7
 v_mfma_f32_16x16x32_bf16 v[220:223], v[40:43], a[232:235], v[220:223]
 s_add_u32 s48, s48, s45
 v_mfma_f32_16x16x32_bf16 v[220:223], v[36:39], a[228:231], v[220:223]
 s_lshl_b32 s45, s7, 17
 v_mfma_f32_16x16x32_bf16 v[220:223], v[32:35], a[224:227], v[220:223]
 s_waitcnt lgkmcnt(4)
 v_mfma_f32_16x16x32_bf16 v[228:231], v[48:51], a[32:35], v[228:231]
 s_lshl_b32 s62, s44, 14
 ds_read_b64_tr_b16 v[32:33], v10 offset:49152
 v_mfma_f32_16x16x32_bf16 v[228:231], v[52:55], a[36:39], v[228:231]
 s_waitcnt lgkmcnt(3)
 ds_read_b64_tr_b16 v[34:35], v10 offset:49664
 v_mfma_f32_16x16x32_bf16 v[228:231], v[56:59], a[40:43], v[228:231]
 s_waitcnt lgkmcnt(2)
 ds_read_b64_tr_b16 v[36:37], v10 offset:53248
 v_mfma_f32_16x16x32_bf16 v[228:231], v[60:63], a[44:47], v[228:231]
 s_add_u32 s45, s45, s62
 ds_read_b64_tr_b16 v[38:39], v10 offset:53760
 v_mfma_f32_16x16x32_bf16 v[236:239], v[60:63], a[108:111], v[236:239]
 s_lshl_b32 s62, s6, 10
 v_mfma_f32_16x16x32_bf16 v[236:239], v[56:59], a[104:107], v[236:239]
 s_add_u32 s45, s45, s62
 ds_read_b64_tr_b16 v[40:41], v10 offset:57344
 v_mfma_f32_16x16x32_bf16 v[236:239], v[52:55], a[100:103], v[236:239]
 s_add_u32 s45, s45, 56623104
 ds_read_b64_tr_b16 v[42:43], v10 offset:57856
 v_mfma_f32_16x16x32_bf16 v[236:239], v[48:51], a[96:99], v[236:239]
 s_lshl_b32 s62, s44, 4
 v_mfma_f32_16x16x32_bf16 v[244:247], v[48:51], a[160:163], v[244:247]
 s_add_u32 s62, s62, s6
 ds_read_b64_tr_b16 v[44:45], v10 offset:61440
 v_mfma_f32_16x16x32_bf16 v[244:247], v[52:55], a[164:167], v[244:247]
 s_mul_i32 s62, s62, 5632
 ds_read_b64_tr_b16 v[46:47], v10 offset:61952
 v_mfma_f32_16x16x32_bf16 v[244:247], v[56:59], a[168:171], v[244:247]
 s_lshl_b32 s7, s7, 8
 v_mfma_f32_16x16x32_bf16 v[244:247], v[60:63], a[172:175], v[244:247]
 s_add_u32 s62, s62, s7
 v_mfma_f32_16x16x32_bf16 v[252:255], v[60:63], a[236:239], v[252:255]
 s_add_u32 s62, s62, 59768832
 v_mfma_f32_16x16x32_bf16 v[252:255], v[56:59], a[232:235], v[252:255]
 s_sub_u32 s44, s43, 704
 v_mfma_f32_16x16x32_bf16 v[252:255], v[52:55], a[228:231], v[252:255]
 s_lshr_b32 s6, s44, 3
 v_mfma_f32_16x16x32_bf16 v[252:255], v[48:51], a[224:227], v[252:255]
 s_waitcnt lgkmcnt(4)
 v_mfma_f32_16x16x32_bf16 v[84:87], v[32:35], a[32:35], v[84:87]
 s_and_b32 s7, s44, 7
 ds_read_b64_tr_b16 v[48:49], v11 offset:49152
 v_mfma_f32_16x16x32_bf16 v[84:87], v[36:39], a[36:39], v[84:87]
 s_waitcnt lgkmcnt(3)
 ds_read_b64_tr_b16 v[50:51], v11 offset:49664
 v_mfma_f32_16x16x32_bf16 v[84:87], v[40:43], a[40:43], v[84:87]
 s_waitcnt lgkmcnt(2)
 ds_read_b64_tr_b16 v[52:53], v11 offset:53248
 v_mfma_f32_16x16x32_bf16 v[84:87], v[44:47], a[44:47], v[84:87]
 s_lshl_b32 s63, s6, 15
 ds_read_b64_tr_b16 v[54:55], v11 offset:53760
 v_mfma_f32_16x16x32_bf16 v[92:95], v[44:47], a[108:111], v[92:95]
 s_lshl_b32 s65, s7, 7
 v_mfma_f32_16x16x32_bf16 v[92:95], v[40:43], a[104:107], v[92:95]
 s_add_u32 s63, s63, s65
 ds_read_b64_tr_b16 v[56:57], v11 offset:57344
 v_mfma_f32_16x16x32_bf16 v[92:95], v[36:39], a[100:103], v[92:95]
 s_mul_i32 s65, s7, 176128
 ds_read_b64_tr_b16 v[58:59], v11 offset:57856
 v_mfma_f32_16x16x32_bf16 v[92:95], v[32:35], a[96:99], v[92:95]
 s_lshl_b32 s6, s6, 10
 v_mfma_f32_16x16x32_bf16 v[116:119], v[32:35], a[160:163], v[116:119]
 s_add_u32 s65, s65, s6
 ds_read_b64_tr_b16 v[60:61], v11 offset:61440
 v_mfma_f32_16x16x32_bf16 v[116:119], v[36:39], a[164:167], v[116:119]
 s_add_u32 s65, s65, 60817408
 ds_read_b64_tr_b16 v[62:63], v11 offset:61952
 v_mfma_f32_16x16x32_bf16 v[116:119], v[40:43], a[168:171], v[116:119]
 s_mov_b32 s66, 1409024
 v_mfma_f32_16x16x32_bf16 v[116:119], v[44:47], a[172:175], v[116:119]
 s_mov_b32 s67, 32768
 v_mfma_f32_16x16x32_bf16 v[124:127], v[44:47], a[236:239], v[124:127]
 s_mov_b32 s7, 99328
 buffer_load_dword v16, v19, s[96:99], 0 offen sc1
 v_mfma_f32_16x16x32_bf16 v[124:127], v[40:43], a[232:235], v[124:127]
 s_mov_b32 s44, 2752
 v_mfma_f32_16x16x32_bf16 v[124:127], v[36:39], a[228:231], v[124:127]
 s_mov_b32 s6, 256
 v_mfma_f32_16x16x32_bf16 v[124:127], v[32:35], a[224:227], v[124:127]
 s_waitcnt lgkmcnt(4)
 v_mfma_f32_16x16x32_bf16 v[148:151], v[48:51], a[32:35], v[148:151]
 s_cmp_ge_u32 s43, 704
 s_cselect_b32 s38, s54, s38
 s_cselect_b32 s39, s55, s39
 v_mfma_f32_16x16x32_bf16 v[148:151], v[52:55], a[36:39], v[148:151]
 s_waitcnt lgkmcnt(2)
 v_add_u32 v8, 0x10000, v8
 v_mfma_f32_16x16x32_bf16 v[148:151], v[56:59], a[40:43], v[148:151]
 s_waitcnt lgkmcnt(0)
 ds_read_b64_tr_b16 v[32:33], v8 offset:0
 v_mfma_f32_16x16x32_bf16 v[148:151], v[60:63], a[44:47], v[148:151]
 s_cmp_ge_u32 s43, 704
 s_cselect_b32 s48, s63, s48
 s_cselect_b32 s45, s65, s45
 v_mfma_f32_16x16x32_bf16 v[156:159], v[60:63], a[108:111], v[156:159]
 s_cmp_ge_u32 s43, 704
 s_cselect_b32 s66, 1409024, s66
 s_cselect_b32 s41, 44032, s67
 v_mfma_f32_16x16x32_bf16 v[156:159], v[56:59], a[104:107], v[156:159]
 s_cmp_ge_u32 s43, 704
 s_cselect_b32 s7, 133120, s7
 s_cselect_b32 s44, 1024, s44
 v_mfma_f32_16x16x32_bf16 v[156:159], v[52:55], a[100:103], v[156:159]
 s_cmp_ge_u32 s43, 704
 s_cselect_b32 s6, 0, s6
 s_cselect_b32 s62, 59768832, s62
 v_mfma_f32_16x16x32_bf16 v[156:159], v[48:51], a[96:99], v[156:159]
 s_sub_u32 s49, s66, s48
 ds_read_b64_tr_b16 v[34:35], v8 offset:512
 v_mfma_f32_16x16x32_bf16 v[180:183], v[48:51], a[160:163], v[180:183]
 s_add_u32 s20, s38, s48
 s_addc_u32 s21, s39, 0
 s_mov_b32 s22, s49
 s_mov_b32 s23, 0x20000
 v_mfma_f32_16x16x32_bf16 v[180:183], v[52:55], a[164:167], v[180:183]
 s_add_u32 s28, s60, s45
 s_addc_u32 s29, s61, 0
 s_mov_b32 s30, s7
 s_mov_b32 s31, 0x20000
 v_mfma_f32_16x16x32_bf16 v[180:183], v[56:59], a[168:171], v[180:183]
 s_add_u32 s88, s60, s62
 s_addc_u32 s89, s61, 0
 s_mov_b32 s90, s6
 s_mov_b32 s91, 0x20000
 v_mfma_f32_16x16x32_bf16 v[180:183], v[60:63], a[172:175], v[180:183]
 s_lshl_b32 s40, s44, 3
 ds_read_b64_tr_b16 v[36:37], v8 offset:4096
 ds_read_b64_tr_b16 v[38:39], v8 offset:4608
 ds_read_b64_tr_b16 v[40:41], v8 offset:8192
 ds_read_b64_tr_b16 v[42:43], v8 offset:8704
 ds_read_b64_tr_b16 v[44:45], v8 offset:12288
 ds_read_b64_tr_b16 v[46:47], v8 offset:12800
 v_mfma_f32_16x16x32_bf16 v[188:191], v[60:63], a[236:239], v[188:191]
 s_sub_u32 s40, s40, 1024
 v_mfma_f32_16x16x32_bf16 v[188:191], v[56:59], a[232:235], v[188:191]
 s_lshl_b32 s6, s3, 13
 v_mfma_f32_16x16x32_bf16 v[188:191], v[52:55], a[228:231], v[188:191]
 s_add_u32 s6, s6, 131072
 v_lshrrev_b32 v17, 3, v0
 v_and_b32 v18, 7, v0
 v_mfma_f32_16x16x32_bf16 v[188:191], v[48:51], a[224:227], v[188:191]
 v_lshlrev_b32 v18, 4, v18
 v_lshl_add_u32 v4, v17, 10, v18
 v_mul_lo_u32 v17, v17, s44
 v_add_u32 v5, v17, v18
 v_bfe_u32 v17, v0, 2, 4
 v_lshlrev_b32 v17, 7, v17
 v_and_b32 v18, 3, v0
 v_lshl_add_u32 v17, v18, 3, v17
 v_add_u32 v6, s6, v17
 v_lshrrev_b32 v17, 4, v0
 v_lshlrev_b32 v17, 4, v17
 v_and_b32 v18, 15, v0
 v_lshl_add_u32 v7, v18, 6, v17
 s_waitcnt lgkmcnt(6)
 s_waitcnt vmcnt(13)
 v_mfma_f32_16x16x32_bf16 v[64:67], v[32:35], a[48:51], v[64:67]
 s_waitcnt lgkmcnt(4)
 v_add_u32 v9, 0x10000, v9
 v_mfma_f32_16x16x32_bf16 v[64:67], v[36:39], a[52:55], v[64:67]
 s_waitcnt lgkmcnt(2)
 ds_read_b64_tr_b16 v[48:49], v9 offset:0
 v_mfma_f32_16x16x32_bf16 v[64:67], v[40:43], a[56:59], v[64:67]
 s_waitcnt lgkmcnt(1)
 ds_read_b64_tr_b16 v[50:51], v9 offset:512
 v_mfma_f32_16x16x32_bf16 v[64:67], v[44:47], a[60:63], v[64:67]
 s_waitcnt vmcnt(9)
 ds_read_b64_tr_b16 v[52:53], v9 offset:4096
 v_mfma_f32_16x16x32_bf16 v[68:71], v[44:47], a[124:127], v[68:71]
 s_lshl_b32 s6, s70, 12
 s_add_u32 s6, s6, 35651584
 v_mfma_f32_16x16x32_bf16 v[68:71], v[40:43], a[120:123], v[68:71]
 s_add_u32 s16, s60, s6
 s_addc_u32 s17, s61, 0
 s_mov_b32 s18, 16777216
 s_mov_b32 s19, 0x20000
 v_mfma_f32_16x16x32_bf16 v[68:71], v[36:39], a[116:119], v[68:71]
 ds_read_b64_tr_b16 v[54:55], v9 offset:4608
 v_lshrrev_b32 v26, 4, v0
 v_mfma_f32_16x16x32_bf16 v[68:71], v[32:35], a[112:115], v[68:71]
 s_waitcnt vmcnt(5)
 v_lshlrev_b32 v26, 2, v26
 v_and_b32 v27, 15, v0
 v_mfma_f32_16x16x32_bf16 v[72:75], v[32:35], a[176:179], v[72:75]
 ds_read_b64_tr_b16 v[56:57], v9 offset:8192
 ds_read_b64_tr_b16 v[58:59], v9 offset:8704
 v_mfma_f32_16x16x32_bf16 v[72:75], v[36:39], a[180:183], v[72:75]
 ds_read_b64_tr_b16 v[60:61], v9 offset:12288
 v_sub_u32 v26, v27, v26
 v_mfma_f32_16x16x32_bf16 v[72:75], v[40:43], a[184:187], v[72:75]
 ds_read_b64_tr_b16 v[62:63], v9 offset:12800
 v_mfma_f32_16x16x32_bf16 v[72:75], v[44:47], a[188:191], v[72:75]
 s_waitcnt vmcnt(1)
 v_cmp_le_i32 s[80:81], 0, v26
 v_mfma_f32_16x16x32_bf16 v[76:79], v[44:47], a[252:255], v[76:79]
 v_mfma_f32_16x16x32_bf16 v[76:79], v[40:43], a[248:251], v[76:79]
 v_mfma_f32_16x16x32_bf16 v[76:79], v[36:39], a[244:247], v[76:79]
 v_cmp_le_i32 s[82:83], 1, v26
 v_mfma_f32_16x16x32_bf16 v[76:79], v[32:35], a[240:243], v[76:79]
 s_waitcnt lgkmcnt(6)
 v_mfma_f32_16x16x32_bf16 v[96:99], v[48:51], a[48:51], v[96:99]
 s_waitcnt lgkmcnt(4)
 v_add_u32 v10, 0x10000, v10
 v_cmp_le_i32 s[84:85], 2, v26
 v_mfma_f32_16x16x32_bf16 v[96:99], v[52:55], a[52:55], v[96:99]
 s_waitcnt lgkmcnt(2)
 ds_read_b64_tr_b16 v[32:33], v10 offset:0
 v_mfma_f32_16x16x32_bf16 v[96:99], v[56:59], a[56:59], v[96:99]
 s_waitcnt lgkmcnt(1)
 v_cmp_le_i32 s[86:87], 3, v26
 v_mfma_f32_16x16x32_bf16 v[96:99], v[60:63], a[60:63], v[96:99]
 ds_read_b64_tr_b16 v[34:35], v10 offset:512
 ds_read_b64_tr_b16 v[36:37], v10 offset:4096
 v_mfma_f32_16x16x32_bf16 v[100:103], v[60:63], a[124:127], v[100:103]
 ds_read_b64_tr_b16 v[38:39], v10 offset:4608
 ds_read_b64_tr_b16 v[40:41], v10 offset:8192
 v_mfma_f32_16x16x32_bf16 v[100:103], v[56:59], a[120:123], v[100:103]
 v_mov_b32 v22, 0x3f803f80
 v_mfma_f32_16x16x32_bf16 v[100:103], v[52:55], a[116:119], v[100:103]
 v_mfma_f32_16x16x32_bf16 v[100:103], v[48:51], a[112:115], v[100:103]
 ds_read_b64_tr_b16 v[42:43], v10 offset:8704
 v_mov_b32 v23, 0x3f803f80
 v_mfma_f32_16x16x32_bf16 v[104:107], v[48:51], a[176:179], v[104:107]
 s_waitcnt vmcnt(0)
 v_cmp_ne_u32 vcc, s100, v16
 v_mfma_f32_16x16x32_bf16 v[104:107], v[52:55], a[180:183], v[104:107]
 ds_read_b64_tr_b16 v[44:45], v10 offset:12288
 ds_read_b64_tr_b16 v[46:47], v10 offset:12800
 v_mfma_f32_16x16x32_bf16 v[104:107], v[56:59], a[184:187], v[104:107]
 v_mov_b32 v24, 0x3f803f80
 v_mfma_f32_16x16x32_bf16 v[104:107], v[60:63], a[188:191], v[104:107]
 s_nop 0
 v_mfma_f32_16x16x32_bf16 v[108:111], v[60:63], a[252:255], v[108:111]
 v_mov_b32 v25, 0x3f803f80
 v_mfma_f32_16x16x32_bf16 v[108:111], v[56:59], a[248:251], v[108:111]
 s_cbranch_vccnz L_po_5
L_pb_6:
 v_mfma_f32_16x16x32_bf16 v[108:111], v[52:55], a[244:247], v[108:111]
 v_mfma_f32_16x16x32_bf16 v[108:111], v[48:51], a[240:243], v[108:111]
 s_waitcnt lgkmcnt(4)
 v_mfma_f32_16x16x32_bf16 v[128:131], v[32:35], a[48:51], v[128:131]
 s_add_u32 m0, s58, 16384
 s_nop 0
 buffer_load_dwordx4 v13, s[12:15], 0 offen offset:0 sc1 lds
 v_mfma_f32_16x16x32_bf16 v[128:131], v[36:39], a[52:55], v[128:131]
 s_waitcnt lgkmcnt(2)
 v_add_u32 v11, 0x10000, v11
 v_mfma_f32_16x16x32_bf16 v[128:131], v[40:43], a[56:59], v[128:131]
 s_waitcnt lgkmcnt(0)
 buffer_load_dwordx4 v13, s[12:15], 0 offen offset:1024 sc1 lds
 v_mfma_f32_16x16x32_bf16 v[128:131], v[44:47], a[60:63], v[128:131]
 s_mov_b32 s64, 0x60006000
 ds_read_b64_tr_b16 v[48:49], v11 offset:0
 v_mfma_f32_16x16x32_bf16 v[132:135], v[44:47], a[124:127], v[132:135]
 s_mov_b32 s68, 2
 buffer_load_dwordx4 v13, s[12:15], 0 offen offset:2048 sc1 lds
 v_mfma_f32_16x16x32_bf16 v[132:135], v[40:43], a[120:123], v[132:135]
 ds_read_b64_tr_b16 v[50:51], v11 offset:512
 ds_read_b64_tr_b16 v[52:53], v11 offset:4096
 v_mfma_f32_16x16x32_bf16 v[132:135], v[36:39], a[116:119], v[132:135]
 buffer_load_dwordx4 v13, s[12:15], 0 offen offset:3072 sc1 lds
 v_mfma_f32_16x16x32_bf16 v[132:135], v[32:35], a[112:115], v[132:135]
 s_mov_b32 s59, 0
 ds_read_b64_tr_b16 v[54:55], v11 offset:4608
 v_mfma_f32_16x16x32_bf16 v[136:139], v[32:35], a[176:179], v[136:139]
 s_add_u32 s77, s58, 32768
 ds_read_b64_tr_b16 v[56:57], v11 offset:8192
 v_mfma_f32_16x16x32_bf16 v[136:139], v[36:39], a[180:183], v[136:139]
 s_lshl_b32 s6, s3, 13
 ds_read_b64_tr_b16 v[58:59], v11 offset:8704
 v_mfma_f32_16x16x32_bf16 v[136:139], v[40:43], a[184:187], v[136:139]
 s_mov_b32 s78, 0
 ds_read_b64_tr_b16 v[60:61], v11 offset:12288
 v_mfma_f32_16x16x32_bf16 v[136:139], v[44:47], a[188:191], v[136:139]
 s_add_u32 s6, s6, 163840
 ds_read_b64_tr_b16 v[62:63], v11 offset:12800
 v_mfma_f32_16x16x32_bf16 v[140:143], v[44:47], a[252:255], v[140:143]
 s_mov_b32 m0, s77
 v_lshlrev_b32 v15, 7, v0
 v_mfma_f32_16x16x32_bf16 v[140:143], v[40:43], a[248:251], v[140:143]
 buffer_load_dwordx4 v13, s[32:35], s78 offen offset:0 sc1 lds
 v_mfma_f32_16x16x32_bf16 v[140:143], v[36:39], a[244:247], v[140:143]
 v_add_u32 v15, s6, v15
 v_mfma_f32_16x16x32_bf16 v[140:143], v[32:35], a[240:243], v[140:143]
 s_waitcnt lgkmcnt(6)
 s_barrier
 v_mfma_f32_16x16x32_bf16 v[160:163], v[48:51], a[48:51], v[160:163]
 s_waitcnt lgkmcnt(4)
 buffer_load_dwordx4 v13, s[32:35], s78 offen offset:1024 sc1 lds
 v_mfma_f32_16x16x32_bf16 v[160:163], v[52:55], a[52:55], v[160:163]
 s_waitcnt lgkmcnt(2)
 buffer_load_dwordx4 v13, s[32:35], s78 offen offset:2048 sc1 lds
 v_mfma_f32_16x16x32_bf16 v[160:163], v[56:59], a[56:59], v[160:163]
 s_waitcnt lgkmcnt(0)
 buffer_load_dwordx4 v13, s[32:35], s78 offen offset:3072 sc1 lds
 v_mfma_f32_16x16x32_bf16 v[160:163], v[60:63], a[60:63], v[160:163]
 s_lshl_b32 s72, s72, 3
 ds_read_b64_tr_b16 v[32:33], v8 offset:16384
 v_mfma_f32_16x16x32_bf16 v[164:167], v[60:63], a[124:127], v[164:167]
 s_add_u32 m0, s77, 16384
 ds_read_b64_tr_b16 v[34:35], v8 offset:16896
 v_mfma_f32_16x16x32_bf16 v[164:167], v[56:59], a[120:123], v[164:167]
 s_lshl_b32 s73, s73, 3
 ds_read_b64_tr_b16 v[36:37], v8 offset:20480
 v_mfma_f32_16x16x32_bf16 v[164:167], v[52:55], a[116:119], v[164:167]
 s_add_u32 s78, s78, 16384
 ds_read_b64_tr_b16 v[38:39], v8 offset:20992
 v_mfma_f32_16x16x32_bf16 v[164:167], v[48:51], a[112:115], v[164:167]
 buffer_load_dwordx4 v13, s[12:15], s78 offen offset:0 sc1 lds
 v_mfma_f32_16x16x32_bf16 v[168:171], v[48:51], a[176:179], v[168:171]
 s_lshl_b32 s74, s74, 3
 ds_read_b64_tr_b16 v[40:41], v8 offset:24576
 v_mfma_f32_16x16x32_bf16 v[168:171], v[52:55], a[180:183], v[168:171]
 buffer_load_dwordx4 v13, s[12:15], s78 offen offset:1024 sc1 lds
 v_mfma_f32_16x16x32_bf16 v[168:171], v[56:59], a[184:187], v[168:171]
 s_lshl_b32 s75, s75, 3
 ds_read_b64_tr_b16 v[42:43], v8 offset:25088
 v_mfma_f32_16x16x32_bf16 v[168:171], v[60:63], a[188:191], v[168:171]
 buffer_load_dwordx4 v13, s[12:15], s78 offen offset:2048 sc1 lds
 ds_read_b64_tr_b16 v[44:45], v8 offset:28672
 ds_read_b64_tr_b16 v[46:47], v8 offset:29184
 v_mfma_f32_16x16x32_bf16 v[172:175], v[60:63], a[252:255], v[172:175]
 v_mfma_f32_16x16x32_bf16 v[172:175], v[56:59], a[248:251], v[172:175]
 buffer_load_dwordx4 v13, s[12:15], s78 offen offset:3072 sc1 lds
 v_mfma_f32_16x16x32_bf16 v[172:175], v[52:55], a[244:247], v[172:175]
 v_mfma_f32_16x16x32_bf16 v[172:175], v[48:51], a[240:243], v[172:175]
 s_waitcnt lgkmcnt(6)
 v_mfma_f32_16x16x32_bf16 v[196:199], v[32:35], a[48:51], v[196:199]
 s_waitcnt lgkmcnt(4)
 ds_read_b64_tr_b16 v[48:49], v9 offset:16384
 v_mfma_f32_16x16x32_bf16 v[196:199], v[36:39], a[52:55], v[196:199]
 s_waitcnt lgkmcnt(3)
 ds_read_b64_tr_b16 v[50:51], v9 offset:16896
 v_mfma_f32_16x16x32_bf16 v[196:199], v[40:43], a[56:59], v[196:199]
 s_waitcnt lgkmcnt(2)
 ds_read_b64_tr_b16 v[52:53], v9 offset:20480
 v_mfma_f32_16x16x32_bf16 v[196:199], v[44:47], a[60:63], v[196:199]
 s_add_u32 s77, s58, 65536
 ds_read_b64_tr_b16 v[54:55], v9 offset:20992
 v_mfma_f32_16x16x32_bf16 v[204:207], v[44:47], a[124:127], v[204:207]
 s_mov_b32 s78, 16384
 v_mfma_f32_16x16x32_bf16 v[204:207], v[40:43], a[120:123], v[204:207]
 s_mov_b32 m0, s77
 ds_read_b64_tr_b16 v[56:57], v9 offset:24576
 v_mfma_f32_16x16x32_bf16 v[204:207], v[36:39], a[116:119], v[204:207]
 ds_read_b64_tr_b16 v[58:59], v9 offset:25088
 v_mfma_f32_16x16x32_bf16 v[204:207], v[32:35], a[112:115], v[204:207]
 buffer_load_dwordx4 v13, s[32:35], s78 offen offset:0 sc1 lds
 v_mfma_f32_16x16x32_bf16 v[212:215], v[32:35], a[176:179], v[212:215]
 v_mul_f32 v64, 1040356334, v64
 v_mul_f32 v65, 1040356334, v65
 v_mfma_f32_16x16x32_bf16 v[212:215], v[36:39], a[180:183], v[212:215]
 buffer_load_dwordx4 v13, s[32:35], s78 offen offset:1024 sc1 lds
 v_mfma_f32_16x16x32_bf16 v[212:215], v[40:43], a[184:187], v[212:215]
 ds_read_b64_tr_b16 v[60:61], v9 offset:28672
 v_cvt_pk_bf16_f32 v64, v64, v65
 v_mfma_f32_16x16x32_bf16 v[212:215], v[44:47], a[188:191], v[212:215]
 buffer_load_dwordx4 v13, s[32:35], s78 offen offset:2048 sc1 lds
 ds_read_b64_tr_b16 v[62:63], v9 offset:29184
 v_mfma_f32_16x16x32_bf16 v[220:223], v[44:47], a[252:255], v[220:223]
 v_accvgpr_write_b32 a0, v64
 v_mul_f32 v66, 1040356334, v66
 v_mul_f32 v67, 1040356334, v67
 v_mfma_f32_16x16x32_bf16 v[220:223], v[40:43], a[248:251], v[220:223]
 v_cvt_pk_bf16_f32 v66, v66, v67
 v_accvgpr_write_b32 a1, v66
 v_mfma_f32_16x16x32_bf16 v[220:223], v[36:39], a[244:247], v[220:223]
 buffer_load_dwordx4 v13, s[32:35], s78 offen offset:3072 sc1 lds
 v_mfma_f32_16x16x32_bf16 v[220:223], v[32:35], a[240:243], v[220:223]
 s_waitcnt lgkmcnt(4)
 v_mul_f32 v96, 1040356334, v96
 v_mul_f32 v97, 1040356334, v97
 v_mfma_f32_16x16x32_bf16 v[228:231], v[48:51], a[48:51], v[228:231]
 s_add_u32 m0, s77, 16384
 v_cvt_pk_bf16_f32 v96, v96, v97
 v_accvgpr_write_b32 a2, v96
 v_mfma_f32_16x16x32_bf16 v[228:231], v[52:55], a[52:55], v[228:231]
 s_waitcnt lgkmcnt(2)
 v_mul_f32 v98, 1040356334, v98
 v_mul_f32 v99, 1040356334, v99
 v_mfma_f32_16x16x32_bf16 v[228:231], v[56:59], a[56:59], v[228:231]
 s_waitcnt lgkmcnt(0)
 ds_read_b64_tr_b16 v[32:33], v10 offset:16384
 v_mfma_f32_16x16x32_bf16 v[228:231], v[60:63], a[60:63], v[228:231]
 s_add_u32 s78, s78, 16384
 ds_read_b64_tr_b16 v[34:35], v10 offset:16896
 v_mfma_f32_16x16x32_bf16 v[236:239], v[60:63], a[124:127], v[236:239]
 ds_read_b64_tr_b16 v[36:37], v10 offset:20480
 v_cvt_pk_bf16_f32 v98, v98, v99
 v_mfma_f32_16x16x32_bf16 v[236:239], v[56:59], a[120:123], v[236:239]
 buffer_load_dwordx4 v13, s[12:15], s78 offen offset:0 sc1 lds
 v_mfma_f32_16x16x32_bf16 v[236:239], v[52:55], a[116:119], v[236:239]
 ds_read_b64_tr_b16 v[38:39], v10 offset:20992
 v_accvgpr_write_b32 a3, v98
 v_mfma_f32_16x16x32_bf16 v[236:239], v[48:51], a[112:115], v[236:239]
 buffer_load_dwordx4 v13, s[12:15], s78 offen offset:1024 sc1 lds
 v_mfma_f32_16x16x32_bf16 v[244:247], v[48:51], a[176:179], v[244:247]
 ds_read_b64_tr_b16 v[40:41], v10 offset:24576
 v_mul_f32 v128, 1040356334, v128
 v_mul_f32 v129, 1040356334, v129
 v_mfma_f32_16x16x32_bf16 v[244:247], v[52:55], a[180:183], v[244:247]
 buffer_load_dwordx4 v13, s[12:15], s78 offen offset:2048 sc1 lds
 v_mfma_f32_16x16x32_bf16 v[244:247], v[56:59], a[184:187], v[244:247]
 ds_read_b64_tr_b16 v[42:43], v10 offset:25088
 v_cvt_pk_bf16_f32 v128, v128, v129
 v_mfma_f32_16x16x32_bf16 v[244:247], v[60:63], a[188:191], v[244:247]
 ds_read_b64_tr_b16 v[44:45], v10 offset:28672
 v_accvgpr_write_b32 a4, v128
 ds_read_b64_tr_b16 v[46:47], v10 offset:29184
 v_mfma_f32_16x16x32_bf16 v[252:255], v[60:63], a[252:255], v[252:255]
 buffer_load_dwordx4 v13, s[12:15], s78 offen offset:3072 sc1 lds
 v_mfma_f32_16x16x32_bf16 v[252:255], v[56:59], a[248:251], v[252:255]
 v_mul_f32 v130, 1040356334, v130
 v_mul_f32 v131, 1040356334, v131
 v_mfma_f32_16x16x32_bf16 v[252:255], v[52:55], a[244:247], v[252:255]
 s_add_u32 s77, s58, 98304
 v_cvt_pk_bf16_f32 v130, v130, v131
 v_accvgpr_write_b32 a5, v130
 v_mfma_f32_16x16x32_bf16 v[252:255], v[48:51], a[240:243], v[252:255]
 s_waitcnt lgkmcnt(6)
 v_mul_f32 v160, 1040356334, v160
 v_mul_f32 v161, 1040356334, v161
 v_mfma_f32_16x16x32_bf16 v[84:87], v[32:35], a[48:51], v[84:87]
 s_waitcnt lgkmcnt(4)
 v_cvt_pk_bf16_f32 v160, v160, v161
 v_accvgpr_write_b32 a6, v160
 v_mfma_f32_16x16x32_bf16 v[84:87], v[36:39], a[52:55], v[84:87]
 s_waitcnt lgkmcnt(2)
 v_mul_f32 v162, 1040356334, v162
 v_mul_f32 v163, 1040356334, v163
 v_mfma_f32_16x16x32_bf16 v[84:87], v[40:43], a[56:59], v[84:87]
 s_waitcnt lgkmcnt(0)
 ds_read_b64_tr_b16 v[48:49], v11 offset:16384
 v_mfma_f32_16x16x32_bf16 v[84:87], v[44:47], a[60:63], v[84:87]
 s_mov_b32 s78, 32768
 ds_read_b64_tr_b16 v[50:51], v11 offset:16896
 v_mfma_f32_16x16x32_bf16 v[92:95], v[44:47], a[124:127], v[92:95]
 s_mov_b32 m0, s77
 v_cvt_pk_bf16_f32 v162, v162, v163
 v_accvgpr_write_b32 a7, v162
 v_mfma_f32_16x16x32_bf16 v[92:95], v[40:43], a[120:123], v[92:95]
 buffer_load_dwordx4 v13, s[32:35], s78 offen offset:0 sc1 lds
 v_mfma_f32_16x16x32_bf16 v[92:95], v[36:39], a[116:119], v[92:95]
 ds_read_b64_tr_b16 v[52:53], v11 offset:20480
 v_mul_f32 v68, 1040356334, v68
 v_mul_f32 v69, 1040356334, v69
 v_mfma_f32_16x16x32_bf16 v[92:95], v[32:35], a[112:115], v[92:95]
 buffer_load_dwordx4 v13, s[32:35], s78 offen offset:1024 sc1 lds
 v_mfma_f32_16x16x32_bf16 v[116:119], v[32:35], a[176:179], v[116:119]
 ds_read_b64_tr_b16 v[54:55], v11 offset:20992
 v_cvt_pk_bf16_f32 v68, v68, v69
 v_mfma_f32_16x16x32_bf16 v[116:119], v[36:39], a[180:183], v[116:119]
 ds_read_b64_tr_b16 v[56:57], v11 offset:24576
 v_accvgpr_write_b32 a64, v68
 v_mfma_f32_16x16x32_bf16 v[116:119], v[40:43], a[184:187], v[116:119]
 buffer_load_dwordx4 v13, s[32:35], s78 offen offset:2048 sc1 lds
 v_mfma_f32_16x16x32_bf16 v[116:119], v[44:47], a[188:191], v[116:119]
 ds_read_b64_tr_b16 v[58:59], v11 offset:25088
 v_mul_f32 v70, 1040356334, v70
 v_mul_f32 v71, 1040356334, v71
 ds_read_b64_tr_b16 v[60:61], v11 offset:28672
 ds_read_b64_tr_b16 v[62:63], v11 offset:29184
 v_mfma_f32_16x16x32_bf16 v[124:127], v[44:47], a[252:255], v[124:127]
 buffer_load_dwordx4 v13, s[32:35], s78 offen offset:3072 sc1 lds
 v_mfma_f32_16x16x32_bf16 v[124:127], v[40:43], a[248:251], v[124:127]
 v_cvt_pk_bf16_f32 v70, v70, v71
 v_accvgpr_write_b32 a65, v70
 v_mfma_f32_16x16x32_bf16 v[124:127], v[36:39], a[244:247], v[124:127]
 s_add_u32 m0, s77, 16384
 v_mul_f32 v100, 1040356334, v100
 v_mul_f32 v101, 1040356334, v101
 v_mfma_f32_16x16x32_bf16 v[124:127], v[32:35], a[240:243], v[124:127]
 s_waitcnt lgkmcnt(6)
 v_cvt_pk_bf16_f32 v100, v100, v101
 v_accvgpr_write_b32 a66, v100
 v_mfma_f32_16x16x32_bf16 v[148:151], v[48:51], a[48:51], v[148:151]
 s_waitcnt lgkmcnt(4)
 v_mul_f32 v102, 1040356334, v102
 v_mul_f32 v103, 1040356334, v103
 v_mfma_f32_16x16x32_bf16 v[148:151], v[52:55], a[52:55], v[148:151]
 s_waitcnt lgkmcnt(2)
 v_cvt_pk_bf16_f32 v102, v102, v103
 v_accvgpr_write_b32 a67, v102
 v_mfma_f32_16x16x32_bf16 v[148:151], v[56:59], a[56:59], v[148:151]
 s_waitcnt lgkmcnt(0)
 v_mul_f32 v132, 1040356334, v132
 v_mul_f32 v133, 1040356334, v133
 v_mfma_f32_16x16x32_bf16 v[148:151], v[60:63], a[60:63], v[148:151]
 s_add_u32 s78, s78, 16384
 buffer_load_dwordx4 v13, s[12:15], s78 offen offset:0 sc1 lds
 v_mfma_f32_16x16x32_bf16 v[156:159], v[60:63], a[124:127], v[156:159]
 v_cvt_pk_bf16_f32 v132, v132, v133
 v_accvgpr_write_b32 a68, v132
 v_mfma_f32_16x16x32_bf16 v[156:159], v[56:59], a[120:123], v[156:159]
 buffer_load_dwordx4 v13, s[12:15], s78 offen offset:1024 sc1 lds
 v_mfma_f32_16x16x32_bf16 v[156:159], v[52:55], a[116:119], v[156:159]
 v_mul_f32 v134, 1040356334, v134
 v_mul_f32 v135, 1040356334, v135
 v_mfma_f32_16x16x32_bf16 v[156:159], v[48:51], a[112:115], v[156:159]
 v_cvt_pk_bf16_f32 v134, v134, v135
 v_accvgpr_write_b32 a69, v134
 v_mfma_f32_16x16x32_bf16 v[180:183], v[48:51], a[176:179], v[180:183]
 buffer_load_dwordx4 v13, s[12:15], s78 offen offset:2048 sc1 lds
 v_mfma_f32_16x16x32_bf16 v[180:183], v[52:55], a[180:183], v[180:183]
 v_mul_f32 v164, 1040356334, v164
 v_mul_f32 v165, 1040356334, v165
 v_mfma_f32_16x16x32_bf16 v[180:183], v[56:59], a[184:187], v[180:183]
 buffer_load_dwordx4 v13, s[12:15], s78 offen offset:3072 sc1 lds
 v_mfma_f32_16x16x32_bf16 v[180:183], v[60:63], a[188:191], v[180:183]
 v_cvt_pk_bf16_f32 v164, v164, v165
 v_accvgpr_write_b32 a70, v164
 v_mfma_f32_16x16x32_bf16 v[188:191], v[60:63], a[252:255], v[188:191]
 v_mul_f32 v166, 1040356334, v166
 v_mul_f32 v167, 1040356334, v167
 v_mfma_f32_16x16x32_bf16 v[188:191], v[56:59], a[248:251], v[188:191]
 v_cvt_pk_bf16_f32 v166, v166, v167
 v_accvgpr_write_b32 a71, v166
 v_mfma_f32_16x16x32_bf16 v[188:191], v[52:55], a[244:247], v[188:191]
 v_mul_f32 v72, 1040356334, v72
 v_mul_f32 v73, 1040356334, v73
 v_mfma_f32_16x16x32_bf16 v[188:191], v[48:51], a[240:243], v[188:191]
 v_cvt_pk_bf16_f32 v72, v72, v73
 v_accvgpr_write_b32 a128, v72
 v_mul_f32 v74, 1040356334, v74
 v_mul_f32 v75, 1040356334, v75
 v_cvt_pk_bf16_f32 v74, v74, v75
 v_accvgpr_write_b32 a129, v74
 v_mul_f32 v104, 1040356334, v104
 v_mul_f32 v105, 1040356334, v105
 v_cvt_pk_bf16_f32 v104, v104, v105
 v_accvgpr_write_b32 a130, v104
 v_mul_f32 v106, 1040356334, v106
 v_mul_f32 v107, 1040356334, v107
 v_cvt_pk_bf16_f32 v106, v106, v107
 v_accvgpr_write_b32 a131, v106
 v_mul_f32 v136, 1040356334, v136
 v_mul_f32 v137, 1040356334, v137
 v_cvt_pk_bf16_f32 v136, v136, v137
 v_accvgpr_write_b32 a132, v136
 v_mul_f32 v138, 1040356334, v138
 v_mul_f32 v139, 1040356334, v139
 v_cvt_pk_bf16_f32 v138, v138, v139
 v_accvgpr_write_b32 a133, v138
 v_mul_f32 v168, 1040356334, v168
 v_mul_f32 v169, 1040356334, v169
 v_cvt_pk_bf16_f32 v168, v168, v169
 v_accvgpr_write_b32 a134, v168
 v_mul_f32 v170, 1040356334, v170
 v_mul_f32 v171, 1040356334, v171
 v_cvt_pk_bf16_f32 v170, v170, v171
 v_accvgpr_write_b32 a135, v170
 v_mul_f32 v76, 1040356334, v76
 v_mul_f32 v77, 1040356334, v77
 v_cvt_pk_bf16_f32 v76, v76, v77
 v_accvgpr_write_b32 a192, v76
 v_mul_f32 v78, 1040356334, v78
 v_mul_f32 v79, 1040356334, v79
 v_cvt_pk_bf16_f32 v78, v78, v79
 v_accvgpr_write_b32 a193, v78
 v_mul_f32 v108, 1040356334, v108
 v_mul_f32 v109, 1040356334, v109
 v_cvt_pk_bf16_f32 v108, v108, v109
 v_accvgpr_write_b32 a194, v108
 v_mul_f32 v110, 1040356334, v110
 v_mul_f32 v111, 1040356334, v111
 v_cvt_pk_bf16_f32 v110, v110, v111
 v_accvgpr_write_b32 a195, v110
 v_mul_f32 v140, 1040356334, v140
 v_mul_f32 v141, 1040356334, v141
 v_cvt_pk_bf16_f32 v140, v140, v141
 v_accvgpr_write_b32 a196, v140
 v_mul_f32 v142, 1040356334, v142
 v_mul_f32 v143, 1040356334, v143
 v_cvt_pk_bf16_f32 v142, v142, v143
 v_accvgpr_write_b32 a197, v142
 v_mul_f32 v172, 1040356334, v172
 v_mul_f32 v173, 1040356334, v173
 v_cvt_pk_bf16_f32 v172, v172, v173
 v_accvgpr_write_b32 a198, v172
 v_mul_f32 v174, 1040356334, v174
 v_mul_f32 v175, 1040356334, v175
 v_cvt_pk_bf16_f32 v174, v174, v175
 v_accvgpr_write_b32 a199, v174
 s_nop 7
 v_mul_f32 v196, 1040356334, v196
 v_mul_f32 v197, 1040356334, v197
 v_cvt_pk_bf16_f32 v196, v196, v197
 v_accvgpr_write_b32 a8, v196
 v_mul_f32 v198, 1040356334, v198
 v_mul_f32 v199, 1040356334, v199
 v_cvt_pk_bf16_f32 v198, v198, v199
 v_accvgpr_write_b32 a9, v198
 v_mul_f32 v228, 1040356334, v228
 v_mul_f32 v229, 1040356334, v229
 v_cvt_pk_bf16_f32 v228, v228, v229
 v_accvgpr_write_b32 a10, v228
 v_mul_f32 v230, 1040356334, v230
 v_mul_f32 v231, 1040356334, v231
 v_cvt_pk_bf16_f32 v230, v230, v231
 v_accvgpr_write_b32 a11, v230
 v_mul_f32 v84, 1040356334, v84
 v_mul_f32 v85, 1040356334, v85
 v_cvt_pk_bf16_f32 v84, v84, v85
 v_accvgpr_write_b32 a12, v84
 v_mul_f32 v86, 1040356334, v86
 v_mul_f32 v87, 1040356334, v87
 v_cvt_pk_bf16_f32 v86, v86, v87
 v_accvgpr_write_b32 a13, v86
 v_mul_f32 v148, 1040356334, v148
 v_mul_f32 v149, 1040356334, v149
 v_cvt_pk_bf16_f32 v148, v148, v149
 v_accvgpr_write_b32 a14, v148
 v_mul_f32 v150, 1040356334, v150
 v_mul_f32 v151, 1040356334, v151
 v_cvt_pk_bf16_f32 v150, v150, v151
 v_accvgpr_write_b32 a15, v150
 v_mul_f32 v204, 1040356334, v204
 v_mul_f32 v205, 1040356334, v205
 v_cvt_pk_bf16_f32 v204, v204, v205
 v_accvgpr_write_b32 a72, v204
 v_mul_f32 v206, 1040356334, v206
 v_mul_f32 v207, 1040356334, v207
 v_cvt_pk_bf16_f32 v206, v206, v207
 v_accvgpr_write_b32 a73, v206
 v_mul_f32 v236, 1040356334, v236
 v_mul_f32 v237, 1040356334, v237
 v_cvt_pk_bf16_f32 v236, v236, v237
 v_accvgpr_write_b32 a74, v236
 v_mul_f32 v238, 1040356334, v238
 v_mul_f32 v239, 1040356334, v239
 v_cvt_pk_bf16_f32 v238, v238, v239
 v_accvgpr_write_b32 a75, v238
 v_mul_f32 v92, 1040356334, v92
 v_mul_f32 v93, 1040356334, v93
 v_cvt_pk_bf16_f32 v92, v92, v93
 v_accvgpr_write_b32 a76, v92
 v_mul_f32 v94, 1040356334, v94
 v_mul_f32 v95, 1040356334, v95
 v_cvt_pk_bf16_f32 v94, v94, v95
 v_accvgpr_write_b32 a77, v94
 v_mul_f32 v156, 1040356334, v156
 v_mul_f32 v157, 1040356334, v157
 v_cvt_pk_bf16_f32 v156, v156, v157
 v_accvgpr_write_b32 a78, v156
 v_mul_f32 v158, 1040356334, v158
 v_mul_f32 v159, 1040356334, v159
 v_cvt_pk_bf16_f32 v158, v158, v159
 v_accvgpr_write_b32 a79, v158
 v_mul_f32 v212, 1040356334, v212
 v_mul_f32 v213, 1040356334, v213
 v_cvt_pk_bf16_f32 v212, v212, v213
 v_accvgpr_write_b32 a136, v212
 v_mul_f32 v214, 1040356334, v214
 v_mul_f32 v215, 1040356334, v215
 v_cvt_pk_bf16_f32 v214, v214, v215
 v_accvgpr_write_b32 a137, v214
 v_mul_f32 v244, 1040356334, v244
 v_mul_f32 v245, 1040356334, v245
 v_cvt_pk_bf16_f32 v244, v244, v245
 v_accvgpr_write_b32 a138, v244
 v_mul_f32 v246, 1040356334, v246
 v_mul_f32 v247, 1040356334, v247
 v_cvt_pk_bf16_f32 v246, v246, v247
 v_accvgpr_write_b32 a139, v246
 v_mul_f32 v116, 1040356334, v116
 v_mul_f32 v117, 1040356334, v117
 v_cvt_pk_bf16_f32 v116, v116, v117
 v_accvgpr_write_b32 a140, v116
 v_mul_f32 v118, 1040356334, v118
 v_mul_f32 v119, 1040356334, v119
 v_cvt_pk_bf16_f32 v118, v118, v119
 v_accvgpr_write_b32 a141, v118
 v_mul_f32 v180, 1040356334, v180
 v_mul_f32 v181, 1040356334, v181
 v_cvt_pk_bf16_f32 v180, v180, v181
 v_accvgpr_write_b32 a142, v180
 v_mul_f32 v182, 1040356334, v182
 v_mul_f32 v183, 1040356334, v183
 v_cvt_pk_bf16_f32 v182, v182, v183
 v_accvgpr_write_b32 a143, v182
 v_mul_f32 v220, 1040356334, v220
 v_mul_f32 v221, 1040356334, v221
 v_cvt_pk_bf16_f32 v220, v220, v221
 v_accvgpr_write_b32 a200, v220
 v_mul_f32 v222, 1040356334, v222
 v_mul_f32 v223, 1040356334, v223
 v_cvt_pk_bf16_f32 v222, v222, v223
 v_accvgpr_write_b32 a201, v222
 v_mul_f32 v252, 1040356334, v252
 v_mul_f32 v253, 1040356334, v253
 v_cvt_pk_bf16_f32 v252, v252, v253
 v_accvgpr_write_b32 a202, v252
 v_mul_f32 v254, 1040356334, v254
 v_mul_f32 v255, 1040356334, v255
 v_cvt_pk_bf16_f32 v254, v254, v255
 v_accvgpr_write_b32 a203, v254
 v_mul_f32 v124, 1040356334, v124
 v_mul_f32 v125, 1040356334, v125
 v_cvt_pk_bf16_f32 v124, v124, v125
 v_accvgpr_write_b32 a204, v124
 v_mul_f32 v126, 1040356334, v126
 v_mul_f32 v127, 1040356334, v127
 v_cvt_pk_bf16_f32 v126, v126, v127
 v_accvgpr_write_b32 a205, v126
 v_mul_f32 v188, 1040356334, v188
 v_mul_f32 v189, 1040356334, v189
 v_cvt_pk_bf16_f32 v188, v188, v189
 v_accvgpr_write_b32 a206, v188
 v_mul_f32 v190, 1040356334, v190
 v_mul_f32 v191, 1040356334, v191
 v_cvt_pk_bf16_f32 v190, v190, v191
 v_accvgpr_write_b32 a207, v190
 s_waitcnt vmcnt(24)
 s_barrier
 v_mov_b32 v14, v12
 ds_read_b128 a[16:19], v14 offset:16384
 ds_read_b128 a[20:23], v14 offset:17408
 ds_read_b128 a[24:27], v14 offset:18432
 ds_read_b128 a[28:31], v14 offset:19456
 ds_read_b128 a[44:47], v14 offset:23552
 ds_read_b128 a[40:43], v14 offset:22528
 ds_read_b128 a[36:39], v14 offset:21504
 ds_read_b128 a[32:35], v14 offset:20480
 ds_read_b128 a[48:51], v14 offset:24576
 ds_read_b128 a[52:55], v14 offset:25600
 ds_read_b128 a[56:59], v14 offset:26624
 ds_read_b128 a[60:63], v14 offset:27648
 ds_read_b128 a[92:95], v14 offset:31744
 ds_read_b128 a[88:91], v14 offset:30720
 ds_read_b128 a[84:87], v14 offset:29696
 ds_read_b128 a[80:83], v14 offset:28672
 v_add_u32 v14, 32768, v12
 s_mov_b32 s78, 49152
 s_mov_b32 s77, s58
 s_mov_b32 s76, 32768
 s_getpc_b64 s[6:7]
L_cw_11:
 s_add_u32 s6, s6, sequential_preLN__compressed_kv_cla__glu_gated_swiglu__prompt_kernel_cA - L_cw_11
 s_addc_u32 s7, s7, 0
 s_lshr_b32 s4, s2, 3
 s_lshl_b32 s4, s4, 2
 s_add_u32 s4, s4, s3
 s_lshl_b32 s4, s4, 7
 v_lshlrev_b32 v2, 14, v0
 v_add_u32 v2, s4, v2
 v_cmp_gt_u32 vcc, sequential_preLN__compressed_kv_cla__glu_gated_swiglu__prompt_kernel_cend - sequential_preLN__compressed_kv_cla__glu_gated_swiglu__prompt_kernel_cA, v2
 s_and_saveexec_b64 s[92:93], vcc
 s_cbranch_execz L_cs_12
 global_load_dword a255, v2, s[6:7]
L_cs_12:
 s_mov_b64 exec, s[92:93]
sequential_preLN__compressed_kv_cla__glu_gated_swiglu__prompt_kernel_cA:
 s_cmp_eq_u32 s71, 0
 s_cbranch_scc0 L_gen_17
L_w0_18:
 s_cmp_eq_u32 s3, 0
 s_cbranch_scc0 L_w1_19
 s_waitcnt lgkmcnt(15)
 v_mov_b32 v3, 4048155338
 v_cndmask_b32 v28, v3, 0, s[80:81]
 v_cndmask_b32 v29, v3, 0, s[82:83]
 v_cndmask_b32 v30, v3, 0, s[84:85]
 v_cndmask_b32 v31, v3, 0, s[86:87]
 s_nop 1
 v_mfma_f32_16x16x32_bf16 v[64:67], a[16:19], a[0:3], v[28:31]
 s_waitcnt lgkmcnt(14)
 v_mov_b32 v160, 0
 v_mov_b32 v161, 0
 v_mfma_f32_16x16x32_bf16 v[64:67], a[20:23], a[4:7], v[64:67]
 s_waitcnt lgkmcnt(13)
 v_mov_b32 v162, 0
 v_mfma_f32_16x16x32_bf16 v[64:67], a[24:27], a[8:11], v[64:67]
 s_waitcnt lgkmcnt(12)
 v_mov_b32 v163, 0
 v_mfma_f32_16x16x32_bf16 v[64:67], a[28:31], a[12:15], v[64:67]
 s_waitcnt lgkmcnt(0)
 s_waitcnt vmcnt(16)
 s_barrier
 v_mfma_f32_16x16x32_bf16 v[80:83], a[16:19], a[64:67], 0
 s_lshl_b32 s6, s3, 13
 v_mov_b32 v164, 0
 v_mov_b32 v68, 4048155338
 v_mfma_f32_16x16x32_bf16 v[80:83], a[20:23], a[68:71], v[80:83]
 s_add_u32 m0, s6, 131072
 v_mov_b32 v69, 4048155338
 v_mov_b32 v70, 4048155338
 v_mfma_f32_16x16x32_bf16 v[80:83], a[24:27], a[72:75], v[80:83]
 s_mov_b32 s42, 0
 ds_read_b128 a[96:99], v14 offset:0
 v_mfma_f32_16x16x32_bf16 v[80:83], a[28:31], a[76:79], v[80:83]
 buffer_load_dwordx4 v4, s[8:11], s42 offen offset:0 lds
 v_mfma_f32_16x16x32_bf16 v[84:87], a[44:47], a[76:79], 0
 ds_read_b128 a[144:147], v14 offset:8192
 v_mov_b32 v71, 4048155338
 v_mfma_f32_16x16x32_bf16 v[84:87], a[40:43], a[72:75], v[84:87]
 ds_read_b128 a[148:151], v14 offset:9216
 v_mov_b32 v72, 4048155338
 v_mfma_f32_16x16x32_bf16 v[84:87], a[36:39], a[68:71], v[84:87]
 ds_read_b128 a[100:103], v14 offset:1024
 v_mov_b32 v73, 4048155338
 v_mfma_f32_16x16x32_bf16 v[84:87], a[32:35], a[64:67], v[84:87]
 ds_read_b128 a[104:107], v14 offset:2048
 v_mov_b32 v74, 4048155338
 v_mfma_f32_16x16x32_bf16 v[88:91], a[48:51], a[64:67], 0
 s_add_u32 s42, s42, 7168
 v_mov_b32 v75, 4048155338
 v_mov_b32 v76, 4048155338
 v_mfma_f32_16x16x32_bf16 v[88:91], a[52:55], a[68:71], v[88:91]
 buffer_load_dwordx4 v4, s[8:11], s42 offen offset:1024 lds
 v_mfma_f32_16x16x32_bf16 v[88:91], a[56:59], a[72:75], v[88:91]
 ds_read_b128 a[152:155], v14 offset:10240
 v_mov_b32 v77, 4048155338
 v_mfma_f32_16x16x32_bf16 v[88:91], a[60:63], a[76:79], v[88:91]
 ds_read_b128 a[156:159], v14 offset:11264
 v_mov_b32 v78, 4048155338
 v_mfma_f32_16x16x32_bf16 v[92:95], a[92:95], a[76:79], 0
 ds_read_b128 a[108:111], v14 offset:3072
 ds_read_b128 a[112:115], v14 offset:4096
 ds_read_b128 a[160:163], v14 offset:12288
 ds_read_b128 a[164:167], v14 offset:13312
 ds_read_b128 a[116:119], v14 offset:5120
 ds_read_b128 a[120:123], v14 offset:6144
 ds_read_b128 a[168:171], v14 offset:14336
 ds_read_b128 a[172:175], v14 offset:15360
 ds_read_b128 a[124:127], v14 offset:7168
 v_mfma_f32_16x16x32_bf16 v[92:95], a[88:91], a[72:75], v[92:95]
 v_mov_b32 v79, 4048155338
 v_mov_b32 v50, 0
 v_mov_b32 v51, 0
 v_mfma_f32_16x16x32_bf16 v[92:95], a[84:87], a[68:71], v[92:95]
 s_add_u32 s42, s42, 7168
 v_max3_f32 v26, v64, v65, v66
 v_max_f32 v26, v26, v67
 v_mov_b32 v27, v26
 s_nop 1
 v_permlane16_swap_b32 v26, v27
 v_max_f32 v26, v26, v27
 v_mov_b32 v27, v26
 s_nop 1
 v_permlane32_swap_b32 v26, v27
 v_max_f32 v26, v26, v27
 v_sub_f32 v32, 0xc2cc0000, v26
 v_sub_f32 v33, 0xc2cc0000, v26
 v_sub_f32 v34, 0xc2cc0000, v26
 v_sub_f32 v35, 0xc2cc0000, v26
 v_add_f32 v64, v64, v32
 v_add_f32 v65, v65, v32
 v_add_f32 v66, v66, v32
 v_add_f32 v67, v67, v32
 v_exp_f32 v16, v64
 v_exp_f32 v17, v65
 v_exp_f32 v18, v66
 v_cvt_pk_bf16_f32 v48, v16, v17
 v_exp_f32 v19, v67
 s_nop 0
 v_cvt_pk_bf16_f32 v49, v18, v19
 v_mfma_f32_16x16x32_bf16 v[92:95], a[80:83], a[64:67], v[92:95]
 s_waitcnt lgkmcnt(13)
 v_mov_b32 v165, 0
 v_mov_b32 v166, 0
 v_mfma_f32_16x16x32_bf16 v[96:99], a[96:99], v[48:51], 0
 s_waitcnt lgkmcnt(12)
 buffer_load_dwordx4 v4, s[8:11], s42 offen offset:2048 lds
 v_mfma_f32_16x16x32_bf16 v[100:103], a[100:103], v[48:51], 0
 s_waitcnt lgkmcnt(11)
 v_mov_b32 v167, 0
 v_mov_b32 v168, 0
 v_mfma_f32_16x16x32_bf16 v[104:107], a[104:107], v[48:51], 0
 s_waitcnt lgkmcnt(8)
 v_mov_b32 v169, 0
 v_mov_b32 v170, 0
 v_mfma_f32_16x16x32_bf16 v[108:111], a[108:111], v[48:51], 0
 s_waitcnt lgkmcnt(7)
 v_max3_f32 v26, v80, v81, v82
 v_max3_f32 v26, v26, v83, v84
 v_mfma_f32_16x16x32_bf16 v[112:115], a[112:115], v[48:51], 0
 s_waitcnt lgkmcnt(4)
 v_max3_f32 v26, v26, v85, v86
 v_max3_f32 v26, v26, v87, v88
 v_mfma_f32_16x16x32_bf16 v[116:119], a[116:119], v[48:51], 0
 s_waitcnt lgkmcnt(3)
 v_max3_f32 v26, v26, v89, v90
 v_max3_f32 v26, v26, v91, v92
 v_mfma_f32_16x16x32_bf16 v[120:123], a[120:123], v[48:51], 0
 s_waitcnt lgkmcnt(0)
 v_max3_f32 v26, v26, v93, v94
 v_max_f32 v26, v26, v95
 v_mfma_f32_16x16x32_bf16 v[124:127], a[124:127], v[48:51], 0
 s_add_u32 s42, s42, 7168
 v_mov_b32 v27, v26
 s_nop 1
 v_permlane16_swap_b32 v26, v27
 v_mfma_f32_16x16x32_bf16 a[176:179], v[22:25], v[48:51], 0
 buffer_load_dwordx4 v4, s[8:11], s42 offen offset:3072 lds
 v_mfma_f32_16x16x32_bf16 v[64:67], a[16:19], a[192:195], 0
 s_lshl_b32 s6, s3, 13
 v_max_f32 v26, v26, v27
 v_mov_b32 v27, v26
 v_mfma_f32_16x16x32_bf16 v[64:67], a[20:23], a[196:199], v[64:67]
 s_nop 0
 v_permlane32_swap_b32 v26, v27
 v_max_f32 v26, v26, v27
 v_mfma_f32_16x16x32_bf16 v[64:67], a[24:27], a[200:203], v[64:67]
 v_sub_f32 v36, 0xc2cc0000, v26
 v_sub_f32 v37, 0xc2cc0000, v26
 v_mfma_f32_16x16x32_bf16 v[64:67], a[28:31], a[204:207], v[64:67]
 s_add_u32 m0, s6, 135168
 v_sub_f32 v38, 0xc2cc0000, v26
 v_sub_f32 v39, 0xc2cc0000, v26
 v_mfma_f32_16x16x32_bf16 v[68:71], a[44:47], a[204:207], 0
 v_add_f32 v80, v80, v36
 v_add_f32 v81, v81, v36
 v_mfma_f32_16x16x32_bf16 v[68:71], a[40:43], a[200:203], v[68:71]
 v_add_f32 v82, v82, v36
 v_add_f32 v83, v83, v36
 v_mfma_f32_16x16x32_bf16 v[68:71], a[36:39], a[196:199], v[68:71]
 s_mov_b32 s42, 0
 v_add_f32 v84, v84, v36
 v_add_f32 v85, v85, v36
 v_mfma_f32_16x16x32_bf16 v[68:71], a[32:35], a[192:195], v[68:71]
 buffer_load_dwordx4 v5, s[20:23], s42 offen offset:0 lds
 v_mfma_f32_16x16x32_bf16 v[72:75], a[48:51], a[192:195], 0
 v_add_f32 v86, v86, v36
 v_add_f32 v87, v87, v36
 v_mfma_f32_16x16x32_bf16 v[72:75], a[52:55], a[196:199], v[72:75]
 v_add_f32 v88, v88, v36
 v_add_f32 v89, v89, v36
 v_mfma_f32_16x16x32_bf16 v[72:75], a[56:59], a[200:203], v[72:75]
 v_add_f32 v90, v90, v36
 v_add_f32 v91, v91, v36
 v_mfma_f32_16x16x32_bf16 v[72:75], a[60:63], a[204:207], v[72:75]
 s_add_u32 s42, s42, s40
 v_add_f32 v92, v92, v36
 v_add_f32 v93, v93, v36
 v_mfma_f32_16x16x32_bf16 v[76:79], a[92:95], a[204:207], 0
 buffer_load_dwordx4 v5, s[20:23], s42 offen offset:1024 lds
 v_mfma_f32_16x16x32_bf16 v[76:79], a[88:91], a[200:203], v[76:79]
 v_add_f32 v94, v94, v36
 v_add_f32 v95, v95, v36
 v_mfma_f32_16x16x32_bf16 v[76:79], a[84:87], a[196:199], v[76:79]
 v_exp_f32 v16, v80
 v_exp_f32 v17, v81
 v_exp_f32 v18, v82
 v_cvt_pk_bf16_f32 v56, v16, v17
 v_exp_f32 v19, v83
 v_exp_f32 v16, v84
 v_cvt_pk_bf16_f32 v57, v18, v19
 v_exp_f32 v17, v85
 v_exp_f32 v18, v86
 v_cvt_pk_bf16_f32 v58, v16, v17
 v_exp_f32 v19, v87
 v_exp_f32 v16, v88
 v_cvt_pk_bf16_f32 v59, v18, v19
 v_exp_f32 v17, v89
 v_exp_f32 v18, v90
 v_cvt_pk_bf16_f32 v60, v16, v17
 v_exp_f32 v19, v91
 v_exp_f32 v16, v92
 v_cvt_pk_bf16_f32 v61, v18, v19
 v_exp_f32 v17, v93
 v_exp_f32 v18, v94
 v_cvt_pk_bf16_f32 v62, v16, v17
 v_exp_f32 v19, v95
 s_nop 0
 v_cvt_pk_bf16_f32 v63, v18, v19
 v_mfma_f32_16x16x32_bf16 v[76:79], a[80:83], a[192:195], v[76:79]
 v_mov_b32 v171, 0
 v_mov_b32 v172, 0
 v_mfma_f32_16x16x32_bf16 v[128:131], a[96:99], v[56:59], 0
 v_mov_b32 v173, 0
 v_mov_b32 v174, 0
 v_mfma_f32_16x16x32_bf16 v[128:131], a[144:147], v[60:63], v[128:131]
 s_add_u32 s42, s42, s40
 v_mov_b32 v175, 0
 v_mov_b32 v176, 0
 v_mfma_f32_16x16x32_bf16 v[132:135], a[148:151], v[60:63], 0
 buffer_load_dwordx4 v5, s[20:23], s42 offen offset:2048 lds
 v_mfma_f32_16x16x32_bf16 v[132:135], a[100:103], v[56:59], v[132:135]
 v_max3_f32 v26, v64, v65, v66
 v_max3_f32 v26, v26, v67, v68
 v_mfma_f32_16x16x32_bf16 v[136:139], a[104:107], v[56:59], 0
 v_max3_f32 v26, v26, v69, v70
 v_max3_f32 v26, v26, v71, v72
 v_mfma_f32_16x16x32_bf16 v[136:139], a[152:155], v[60:63], v[136:139]
 v_max3_f32 v26, v26, v73, v74
 v_max3_f32 v26, v26, v75, v76
 v_mfma_f32_16x16x32_bf16 v[140:143], a[156:159], v[60:63], 0
 v_max3_f32 v26, v26, v77, v78
 v_max_f32 v26, v26, v79
 v_mfma_f32_16x16x32_bf16 v[140:143], a[108:111], v[56:59], v[140:143]
 s_add_u32 s42, s42, s40
 v_mov_b32 v27, v26
 s_nop 1
 v_permlane16_swap_b32 v26, v27
 v_mfma_f32_16x16x32_bf16 v[144:147], a[112:115], v[56:59], 0
 buffer_load_dwordx4 v5, s[20:23], s42 offen offset:3072 lds
 v_mfma_f32_16x16x32_bf16 v[144:147], a[160:163], v[60:63], v[144:147]
 v_max_f32 v26, v26, v27
 v_mov_b32 v27, v26
 v_mfma_f32_16x16x32_bf16 v[148:151], a[164:167], v[60:63], 0
 s_nop 0
 v_permlane32_swap_b32 v26, v27
 v_max_f32 v26, v26, v27
 v_mfma_f32_16x16x32_bf16 v[148:151], a[116:119], v[56:59], v[148:151]
 v_sub_f32 v44, 0xc2cc0000, v26
 v_sub_f32 v45, 0xc2cc0000, v26
 v_mfma_f32_16x16x32_bf16 v[152:155], a[120:123], v[56:59], 0
 s_mov_b32 m0, s77
 v_sub_f32 v46, 0xc2cc0000, v26
 v_sub_f32 v47, 0xc2cc0000, v26
 v_mfma_f32_16x16x32_bf16 v[152:155], a[168:171], v[60:63], v[152:155]
 buffer_load_dwordx4 v13, s[32:35], s78 offen offset:0 sc1 lds
 v_mfma_f32_16x16x32_bf16 v[156:159], a[172:175], v[60:63], 0
 v_add_f32 v64, v64, v44
 v_add_f32 v65, v65, v44
 v_mfma_f32_16x16x32_bf16 v[156:159], a[124:127], v[56:59], v[156:159]
 v_add_f32 v66, v66, v44
 v_add_f32 v67, v67, v44
 v_mfma_f32_16x16x32_bf16 a[180:183], v[22:25], v[56:59], 0
 buffer_load_dwordx4 v13, s[32:35], s78 offen offset:1024 sc1 lds
 v_mfma_f32_16x16x32_bf16 a[180:183], v[22:25], v[60:63], a[180:183]
 v_add_f32 v68, v68, v44
 v_add_f32 v69, v69, v44
 v_mfma_f32_16x16x32_bf16 v[80:83], a[16:19], a[128:131], 0
 ds_read_b128 a[16:19], v14 offset:16384
 v_add_f32 v70, v70, v44
 v_mfma_f32_16x16x32_bf16 v[80:83], a[20:23], a[132:135], v[80:83]
 buffer_load_dwordx4 v13, s[32:35], s78 offen offset:2048 sc1 lds
 v_mfma_f32_16x16x32_bf16 v[80:83], a[24:27], a[136:139], v[80:83]
 ds_read_b128 a[20:23], v14 offset:17408
 v_add_f32 v71, v71, v44
 v_mfma_f32_16x16x32_bf16 v[80:83], a[28:31], a[140:143], v[80:83]
 ds_read_b128 a[24:27], v14 offset:18432
 v_add_f32 v72, v72, v44
 v_mfma_f32_16x16x32_bf16 v[84:87], a[44:47], a[140:143], 0
 buffer_load_dwordx4 v13, s[32:35], s78 offen offset:3072 sc1 lds
 v_mfma_f32_16x16x32_bf16 v[84:87], a[40:43], a[136:139], v[84:87]
 ds_read_b128 a[28:31], v14 offset:19456
 v_add_f32 v73, v73, v44
 v_mfma_f32_16x16x32_bf16 v[84:87], a[36:39], a[132:135], v[84:87]
 ds_read_b128 a[44:47], v14 offset:23552
 v_add_f32 v74, v74, v44
 v_mfma_f32_16x16x32_bf16 v[84:87], a[32:35], a[128:131], v[84:87]
 ds_read_b128 a[40:43], v14 offset:22528
 v_add_f32 v75, v75, v44
 v_mfma_f32_16x16x32_bf16 v[88:91], a[48:51], a[128:131], 0
 s_add_u32 m0, s77, 16384
 v_add_f32 v76, v76, v44
 v_add_f32 v77, v77, v44
 v_mfma_f32_16x16x32_bf16 v[88:91], a[52:55], a[132:135], v[88:91]
 ds_read_b128 a[36:39], v14 offset:21504
 v_add_f32 v78, v78, v44
 v_mfma_f32_16x16x32_bf16 v[88:91], a[56:59], a[136:139], v[88:91]
 ds_read_b128 a[32:35], v14 offset:20480
 v_add_f32 v79, v79, v44
 v_mfma_f32_16x16x32_bf16 v[88:91], a[60:63], a[140:143], v[88:91]
 s_add_u32 s78, s78, 16384
 v_exp_f32 v16, v64
 v_mfma_f32_16x16x32_bf16 v[92:95], a[92:95], a[140:143], 0
 buffer_load_dwordx4 v13, s[12:15], s78 offen offset:0 sc1 lds
 v_mfma_f32_16x16x32_bf16 v[92:95], a[88:91], a[136:139], v[92:95]
 ds_read_b128 a[48:51], v14 offset:24576
 v_mov_b32 v177, 0
 v_mfma_f32_16x16x32_bf16 v[92:95], a[84:87], a[132:135], v[92:95]
 v_exp_f32 v17, v65
 v_exp_f32 v18, v66
 v_cvt_pk_bf16_f32 v48, v16, v17
 v_exp_f32 v19, v67
 v_exp_f32 v16, v68
 v_cvt_pk_bf16_f32 v49, v18, v19
 v_exp_f32 v17, v69
 v_exp_f32 v18, v70
 v_cvt_pk_bf16_f32 v50, v16, v17
 v_exp_f32 v19, v71
 v_exp_f32 v16, v72
 v_cvt_pk_bf16_f32 v51, v18, v19
 v_exp_f32 v17, v73
 v_exp_f32 v18, v74
 v_cvt_pk_bf16_f32 v52, v16, v17
 v_exp_f32 v19, v75
 v_exp_f32 v16, v76
 v_cvt_pk_bf16_f32 v53, v18, v19
 v_exp_f32 v17, v77
 v_exp_f32 v18, v78
 v_cvt_pk_bf16_f32 v54, v16, v17
 v_exp_f32 v19, v79
 s_nop 0
 v_cvt_pk_bf16_f32 v55, v18, v19
 v_mfma_f32_16x16x32_bf16 v[92:95], a[80:83], a[128:131], v[92:95]
 buffer_load_dwordx4 v13, s[12:15], s78 offen offset:1024 sc1 lds
 v_mfma_f32_16x16x32_bf16 v[192:195], a[96:99], v[48:51], 0
 ds_read_b128 a[52:55], v14 offset:25600
 v_mov_b32 v178, 0
 v_mfma_f32_16x16x32_bf16 v[192:195], a[144:147], v[52:55], v[192:195]
 ds_read_b128 a[56:59], v14 offset:26624
 v_mov_b32 v179, 0
 v_mfma_f32_16x16x32_bf16 v[196:199], a[148:151], v[52:55], 0
 buffer_load_dwordx4 v13, s[12:15], s78 offen offset:2048 sc1 lds
 v_mfma_f32_16x16x32_bf16 v[196:199], a[100:103], v[48:51], v[196:199]
 ds_read_b128 a[60:63], v14 offset:27648
 v_mov_b32 v180, 0
 v_mfma_f32_16x16x32_bf16 v[200:203], a[104:107], v[48:51], 0
 ds_read_b128 a[92:95], v14 offset:31744
 v_mov_b32 v181, 0
 v_mfma_f32_16x16x32_bf16 v[200:203], a[152:155], v[52:55], v[200:203]
 buffer_load_dwordx4 v13, s[12:15], s78 offen offset:3072 sc1 lds
 v_mfma_f32_16x16x32_bf16 v[204:207], a[156:159], v[52:55], 0
 s_add_u32 s79, s76, s58
 v_mov_b32 v182, 0
 v_mov_b32 v183, 0
 v_mfma_f32_16x16x32_bf16 v[204:207], a[108:111], v[48:51], v[204:207]
 s_add_u32 s76, s76, 32768
 v_mov_b32 v184, 0
 v_mov_b32 v185, 0
 v_mfma_f32_16x16x32_bf16 v[208:211], a[112:115], v[48:51], 0
 s_and_b32 s76, s76, 0x1ffff
 v_mov_b32 v186, 0
 v_mov_b32 v187, 0
 v_mfma_f32_16x16x32_bf16 v[208:211], a[160:163], v[52:55], v[208:211]
 ds_read_b128 a[88:91], v14 offset:30720
 v_mov_b32 v188, 0
 v_mfma_f32_16x16x32_bf16 v[212:215], a[164:167], v[52:55], 0
 ds_read_b128 a[84:87], v14 offset:29696
 v_mov_b32 v189, 0
 v_mfma_f32_16x16x32_bf16 v[212:215], a[116:119], v[48:51], v[212:215]
 v_mov_b32 v190, 0
 v_mov_b32 v191, 0
 v_mfma_f32_16x16x32_bf16 v[216:219], a[120:123], v[48:51], 0
 v_accvgpr_write_b32 a184, 0
 v_accvgpr_write_b32 a185, 0
 v_mfma_f32_16x16x32_bf16 v[216:219], a[168:171], v[52:55], v[216:219]
 ds_read_b128 a[80:83], v14 offset:28672
 v_accvgpr_write_b32 a186, 0
 v_mfma_f32_16x16x32_bf16 v[220:223], a[172:175], v[52:55], 0
 v_accvgpr_write_b32 a187, 0
 v_max3_f32 v26, v80, v81, v82
 v_mfma_f32_16x16x32_bf16 v[220:223], a[124:127], v[48:51], v[220:223]
 v_max3_f32 v26, v26, v83, v84
 v_max3_f32 v26, v26, v85, v86
 v_mfma_f32_16x16x32_bf16 a[188:191], v[22:25], v[48:51], 0
 v_max3_f32 v26, v26, v87, v88
 v_max3_f32 v26, v26, v89, v90
 v_max3_f32 v26, v26, v91, v92
 v_mfma_f32_16x16x32_bf16 a[188:191], v[22:25], v[52:55], a[188:191]
 s_mov_b32 s77, s79
 v_add_u32 v14, s76, v12
 v_max3_f32 v26, v26, v93, v94
 v_max_f32 v26, v26, v95
 v_mov_b32 v27, v26
 s_nop 1
 v_permlane16_swap_b32 v26, v27
 v_max_f32 v26, v26, v27
 v_mov_b32 v27, v26
 s_nop 1
 v_permlane32_swap_b32 v26, v27
 v_max_f32 v26, v26, v27
 v_sub_f32 v40, 0xc2cc0000, v26
 v_sub_f32 v41, 0xc2cc0000, v26
 v_sub_f32 v42, 0xc2cc0000, v26
 v_sub_f32 v43, 0xc2cc0000, v26
 v_add_f32 v80, v80, v40
 v_add_f32 v81, v81, v40
 v_add_f32 v82, v82, v40
 v_add_f32 v83, v83, v40
 v_add_f32 v84, v84, v40
 v_add_f32 v85, v85, v40
 v_add_f32 v86, v86, v40
 v_add_f32 v87, v87, v40
 v_add_f32 v88, v88, v40
 v_add_f32 v89, v89, v40
 v_add_f32 v90, v90, v40
 v_add_f32 v91, v91, v40
 v_add_f32 v92, v92, v40
 v_add_f32 v93, v93, v40
 v_add_f32 v94, v94, v40
 v_add_f32 v95, v95, v40
 v_exp_f32 v16, v80
 v_exp_f32 v17, v81
 v_exp_f32 v18, v82
 v_cvt_pk_bf16_f32 v56, v16, v17
 v_exp_f32 v19, v83
 v_exp_f32 v16, v84
 v_cvt_pk_bf16_f32 v57, v18, v19
 v_exp_f32 v17, v85
 v_exp_f32 v18, v86
 v_cvt_pk_bf16_f32 v58, v16, v17
 v_or3_b32 v21, v56, v57, v58
 v_exp_f32 v19, v87
 v_exp_f32 v16, v88
 v_cvt_pk_bf16_f32 v59, v18, v19
 v_exp_f32 v17, v89
 v_exp_f32 v18, v90
 v_cvt_pk_bf16_f32 v60, v16, v17
 v_or3_b32 v21, v21, v59, v60
 v_exp_f32 v19, v91
 v_exp_f32 v16, v92
 v_cvt_pk_bf16_f32 v61, v18, v19
 v_exp_f32 v17, v93
 s_branch L_a2w0_13
L_w1_19:
 s_cmp_eq_u32 s3, 1
 s_cbranch_scc0 L_w2_20
 s_waitcnt lgkmcnt(3)
 v_mfma_f32_16x16x32_bf16 v[64:67], a[16:19], a[0:3], 0
 v_mov_b32 v160, 0
 v_mov_b32 v161, 0
 v_mfma_f32_16x16x32_bf16 v[64:67], a[20:23], a[4:7], v[64:67]
 v_mov_b32 v162, 0
 v_mfma_f32_16x16x32_bf16 v[64:67], a[24:27], a[8:11], v[64:67]
 v_mov_b32 v163, 0
 v_mfma_f32_16x16x32_bf16 v[64:67], a[28:31], a[12:15], v[64:67]
 v_mov_b32 v3, 4048155338
 v_cndmask_b32 v28, v3, 0, s[80:81]
 v_cndmask_b32 v29, v3, 0, s[82:83]
 v_cndmask_b32 v30, v3, 0, s[84:85]
 v_cndmask_b32 v31, v3, 0, s[86:87]
 s_nop 1
 v_mfma_f32_16x16x32_bf16 v[68:71], a[44:47], a[12:15], v[28:31]
 v_mfma_f32_16x16x32_bf16 v[68:71], a[40:43], a[8:11], v[68:71]
 v_mov_b32 v164, 0
 v_mfma_f32_16x16x32_bf16 v[68:71], a[36:39], a[4:7], v[68:71]
 v_mfma_f32_16x16x32_bf16 v[68:71], a[32:35], a[0:3], v[68:71]
 s_waitcnt lgkmcnt(0)
 s_waitcnt vmcnt(16)
 s_barrier
 v_mfma_f32_16x16x32_bf16 v[80:83], a[16:19], a[64:67], 0
 s_lshl_b32 s6, s3, 13
 v_mov_b32 v72, 4048155338
 v_mov_b32 v73, 4048155338
 v_mfma_f32_16x16x32_bf16 v[80:83], a[20:23], a[68:71], v[80:83]
 ds_read_b128 a[96:99], v14 offset:0
 v_mov_b32 v74, 4048155338
 v_mfma_f32_16x16x32_bf16 v[80:83], a[24:27], a[72:75], v[80:83]
 s_add_u32 m0, s6, 131072
 s_mov_b32 s42, 0
 v_mov_b32 v75, 4048155338
 v_mfma_f32_16x16x32_bf16 v[80:83], a[28:31], a[76:79], v[80:83]
 buffer_load_dwordx4 v4, s[8:11], s42 offen offset:0 lds
 v_mfma_f32_16x16x32_bf16 v[84:87], a[44:47], a[76:79], 0
 ds_read_b128 a[144:147], v14 offset:8192
 v_mov_b32 v76, 4048155338
 v_mfma_f32_16x16x32_bf16 v[84:87], a[40:43], a[72:75], v[84:87]
 ds_read_b128 a[148:151], v14 offset:9216
 v_mov_b32 v77, 4048155338
 v_mfma_f32_16x16x32_bf16 v[84:87], a[36:39], a[68:71], v[84:87]
 ds_read_b128 a[100:103], v14 offset:1024
 v_mov_b32 v78, 4048155338
 v_mfma_f32_16x16x32_bf16 v[84:87], a[32:35], a[64:67], v[84:87]
 ds_read_b128 a[104:107], v14 offset:2048
 v_mov_b32 v79, 4048155338
 v_mfma_f32_16x16x32_bf16 v[88:91], a[48:51], a[64:67], 0
 s_add_u32 s42, s42, 7168
 v_max3_f32 v26, v64, v65, v66
 v_max3_f32 v26, v26, v67, v68
 v_mfma_f32_16x16x32_bf16 v[88:91], a[52:55], a[68:71], v[88:91]
 buffer_load_dwordx4 v4, s[8:11], s42 offen offset:1024 lds
 v_mfma_f32_16x16x32_bf16 v[88:91], a[56:59], a[72:75], v[88:91]
 ds_read_b128 a[152:155], v14 offset:10240
 v_max3_f32 v26, v26, v69, v70
 v_mfma_f32_16x16x32_bf16 v[88:91], a[60:63], a[76:79], v[88:91]
 ds_read_b128 a[156:159], v14 offset:11264
 v_max_f32 v26, v26, v71
 v_mfma_f32_16x16x32_bf16 v[92:95], a[92:95], a[76:79], 0
 ds_read_b128 a[108:111], v14 offset:3072
 ds_read_b128 a[112:115], v14 offset:4096
 ds_read_b128 a[160:163], v14 offset:12288
 ds_read_b128 a[164:167], v14 offset:13312
 ds_read_b128 a[116:119], v14 offset:5120
 ds_read_b128 a[120:123], v14 offset:6144
 ds_read_b128 a[168:171], v14 offset:14336
 ds_read_b128 a[172:175], v14 offset:15360
 ds_read_b128 a[124:127], v14 offset:7168
 v_mfma_f32_16x16x32_bf16 v[92:95], a[88:91], a[72:75], v[92:95]
 v_mov_b32 v27, v26
 s_nop 1
 v_permlane16_swap_b32 v26, v27
 v_mfma_f32_16x16x32_bf16 v[92:95], a[84:87], a[68:71], v[92:95]
 s_add_u32 s42, s42, 7168
 v_max_f32 v26, v26, v27
 v_mov_b32 v27, v26
 s_nop 1
 v_permlane32_swap_b32 v26, v27
 v_max_f32 v26, v26, v27
 v_sub_f32 v32, 0xc2cc0000, v26
 v_sub_f32 v33, 0xc2cc0000, v26
 v_sub_f32 v34, 0xc2cc0000, v26
 v_sub_f32 v35, 0xc2cc0000, v26
 v_add_f32 v64, v64, v32
 v_add_f32 v65, v65, v32
 v_add_f32 v66, v66, v32
 v_add_f32 v67, v67, v32
 v_add_f32 v68, v68, v32
 v_add_f32 v69, v69, v32
 v_add_f32 v70, v70, v32
 v_add_f32 v71, v71, v32
 v_exp_f32 v16, v64
 v_exp_f32 v17, v65
 v_exp_f32 v18, v66
 v_cvt_pk_bf16_f32 v48, v16, v17
 v_exp_f32 v19, v67
 v_exp_f32 v16, v68
 v_cvt_pk_bf16_f32 v49, v18, v19
 v_exp_f32 v17, v69
 v_exp_f32 v18, v70
 v_cvt_pk_bf16_f32 v50, v16, v17
 v_exp_f32 v19, v71
 s_nop 0
 v_cvt_pk_bf16_f32 v51, v18, v19
 v_mfma_f32_16x16x32_bf16 v[92:95], a[80:83], a[64:67], v[92:95]
 s_waitcnt lgkmcnt(13)
 v_mov_b32 v165, 0
 v_mov_b32 v166, 0
 v_mfma_f32_16x16x32_bf16 v[96:99], a[96:99], v[48:51], 0
 s_waitcnt lgkmcnt(12)
 buffer_load_dwordx4 v4, s[8:11], s42 offen offset:2048 lds
 v_mfma_f32_16x16x32_bf16 v[100:103], a[100:103], v[48:51], 0
 s_waitcnt lgkmcnt(11)
 v_mov_b32 v167, 0
 v_mov_b32 v168, 0
 v_mfma_f32_16x16x32_bf16 v[104:107], a[104:107], v[48:51], 0
 s_waitcnt lgkmcnt(8)
 v_mov_b32 v169, 0
 v_mov_b32 v170, 0
 v_mfma_f32_16x16x32_bf16 v[108:111], a[108:111], v[48:51], 0
 s_waitcnt lgkmcnt(7)
 v_max3_f32 v26, v80, v81, v82
 v_max3_f32 v26, v26, v83, v84
 v_mfma_f32_16x16x32_bf16 v[112:115], a[112:115], v[48:51], 0
 s_waitcnt lgkmcnt(4)
 v_max3_f32 v26, v26, v85, v86
 v_max3_f32 v26, v26, v87, v88
 v_mfma_f32_16x16x32_bf16 v[116:119], a[116:119], v[48:51], 0
 s_waitcnt lgkmcnt(3)
 v_max3_f32 v26, v26, v89, v90
 v_max3_f32 v26, v26, v91, v92
 v_mfma_f32_16x16x32_bf16 v[120:123], a[120:123], v[48:51], 0
 s_waitcnt lgkmcnt(0)
 v_max3_f32 v26, v26, v93, v94
 v_max_f32 v26, v26, v95
 v_mfma_f32_16x16x32_bf16 v[124:127], a[124:127], v[48:51], 0
 s_add_u32 s42, s42, 7168
 v_mov_b32 v27, v26
 s_nop 1
 v_permlane16_swap_b32 v26, v27
 v_mfma_f32_16x16x32_bf16 a[176:179], v[22:25], v[48:51], 0
 buffer_load_dwordx4 v4, s[8:11], s42 offen offset:3072 lds
 v_mfma_f32_16x16x32_bf16 v[64:67], a[16:19], a[192:195], 0
 s_lshl_b32 s6, s3, 13
 v_max_f32 v26, v26, v27
 v_mov_b32 v27, v26
 v_mfma_f32_16x16x32_bf16 v[64:67], a[20:23], a[196:199], v[64:67]
 s_nop 0
 v_permlane32_swap_b32 v26, v27
 v_max_f32 v26, v26, v27
 v_mfma_f32_16x16x32_bf16 v[64:67], a[24:27], a[200:203], v[64:67]
 v_sub_f32 v36, 0xc2cc0000, v26
 v_sub_f32 v37, 0xc2cc0000, v26
 v_mfma_f32_16x16x32_bf16 v[64:67], a[28:31], a[204:207], v[64:67]
 s_add_u32 m0, s6, 135168
 v_sub_f32 v38, 0xc2cc0000, v26
 v_sub_f32 v39, 0xc2cc0000, v26
 v_mfma_f32_16x16x32_bf16 v[68:71], a[44:47], a[204:207], 0
 v_add_f32 v80, v80, v36
 v_add_f32 v81, v81, v36
 v_mfma_f32_16x16x32_bf16 v[68:71], a[40:43], a[200:203], v[68:71]
 v_add_f32 v82, v82, v36
 v_add_f32 v83, v83, v36
 v_mfma_f32_16x16x32_bf16 v[68:71], a[36:39], a[196:199], v[68:71]
 s_mov_b32 s42, 0
 v_add_f32 v84, v84, v36
 v_add_f32 v85, v85, v36
 v_mfma_f32_16x16x32_bf16 v[68:71], a[32:35], a[192:195], v[68:71]
 buffer_load_dwordx4 v5, s[20:23], s42 offen offset:0 lds
 v_mfma_f32_16x16x32_bf16 v[72:75], a[48:51], a[192:195], 0
 v_add_f32 v86, v86, v36
 v_add_f32 v87, v87, v36
 v_mfma_f32_16x16x32_bf16 v[72:75], a[52:55], a[196:199], v[72:75]
 v_add_f32 v88, v88, v36
 v_add_f32 v89, v89, v36
 v_mfma_f32_16x16x32_bf16 v[72:75], a[56:59], a[200:203], v[72:75]
 v_add_f32 v90, v90, v36
 v_add_f32 v91, v91, v36
 v_mfma_f32_16x16x32_bf16 v[72:75], a[60:63], a[204:207], v[72:75]
 s_add_u32 s42, s42, s40
 v_add_f32 v92, v92, v36
 v_add_f32 v93, v93, v36
 v_mfma_f32_16x16x32_bf16 v[76:79], a[92:95], a[204:207], 0
 buffer_load_dwordx4 v5, s[20:23], s42 offen offset:1024 lds
 v_mfma_f32_16x16x32_bf16 v[76:79], a[88:91], a[200:203], v[76:79]
 v_add_f32 v94, v94, v36
 v_add_f32 v95, v95, v36
 v_exp_f32 v16, v80
 v_mfma_f32_16x16x32_bf16 v[76:79], a[84:87], a[196:199], v[76:79]
 v_exp_f32 v17, v81
 v_exp_f32 v18, v82
 v_cvt_pk_bf16_f32 v56, v16, v17
 v_exp_f32 v19, v83
 v_exp_f32 v16, v84
 v_cvt_pk_bf16_f32 v57, v18, v19
 v_exp_f32 v17, v85
 v_exp_f32 v18, v86
 v_cvt_pk_bf16_f32 v58, v16, v17
 v_exp_f32 v19, v87
 v_exp_f32 v16, v88
 v_cvt_pk_bf16_f32 v59, v18, v19
 v_exp_f32 v17, v89
 v_exp_f32 v18, v90
 v_cvt_pk_bf16_f32 v60, v16, v17
 v_exp_f32 v19, v91
 v_exp_f32 v16, v92
 v_cvt_pk_bf16_f32 v61, v18, v19
 v_exp_f32 v17, v93
 v_exp_f32 v18, v94
 v_cvt_pk_bf16_f32 v62, v16, v17
 v_exp_f32 v19, v95
 s_nop 0
 v_cvt_pk_bf16_f32 v63, v18, v19
 v_mfma_f32_16x16x32_bf16 v[76:79], a[80:83], a[192:195], v[76:79]
 v_mov_b32 v171, 0
 v_mov_b32 v172, 0
 v_mfma_f32_16x16x32_bf16 v[128:131], a[96:99], v[56:59], 0
 v_mov_b32 v173, 0
 v_mov_b32 v174, 0
 v_mfma_f32_16x16x32_bf16 v[128:131], a[144:147], v[60:63], v[128:131]
 s_add_u32 s42, s42, s40
 v_mov_b32 v175, 0
 v_mov_b32 v176, 0
 v_mfma_f32_16x16x32_bf16 v[132:135], a[148:151], v[60:63], 0
 buffer_load_dwordx4 v5, s[20:23], s42 offen offset:2048 lds
 v_mfma_f32_16x16x32_bf16 v[132:135], a[100:103], v[56:59], v[132:135]
 v_max3_f32 v26, v64, v65, v66
 v_max3_f32 v26, v26, v67, v68
 v_mfma_f32_16x16x32_bf16 v[136:139], a[104:107], v[56:59], 0
 v_max3_f32 v26, v26, v69, v70
 v_max3_f32 v26, v26, v71, v72
 v_mfma_f32_16x16x32_bf16 v[136:139], a[152:155], v[60:63], v[136:139]
 v_max3_f32 v26, v26, v73, v74
 v_max3_f32 v26, v26, v75, v76
 v_mfma_f32_16x16x32_bf16 v[140:143], a[156:159], v[60:63], 0
 v_max3_f32 v26, v26, v77, v78
 v_max_f32 v26, v26, v79
 v_mfma_f32_16x16x32_bf16 v[140:143], a[108:111], v[56:59], v[140:143]
 s_add_u32 s42, s42, s40
 v_mov_b32 v27, v26
 s_nop 1
 v_permlane16_swap_b32 v26, v27
 v_mfma_f32_16x16x32_bf16 v[144:147], a[112:115], v[56:59], 0
 buffer_load_dwordx4 v5, s[20:23], s42 offen offset:3072 lds
 v_mfma_f32_16x16x32_bf16 v[144:147], a[160:163], v[60:63], v[144:147]
 v_max_f32 v26, v26, v27
 v_mov_b32 v27, v26
 v_mfma_f32_16x16x32_bf16 v[148:151], a[164:167], v[60:63], 0
 s_nop 0
 v_permlane32_swap_b32 v26, v27
 v_max_f32 v26, v26, v27
 v_mfma_f32_16x16x32_bf16 v[148:151], a[116:119], v[56:59], v[148:151]
 v_sub_f32 v44, 0xc2cc0000, v26
 v_sub_f32 v45, 0xc2cc0000, v26
 v_mfma_f32_16x16x32_bf16 v[152:155], a[120:123], v[56:59], 0
 s_mov_b32 m0, s77
 v_sub_f32 v46, 0xc2cc0000, v26
 v_sub_f32 v47, 0xc2cc0000, v26
 v_mfma_f32_16x16x32_bf16 v[152:155], a[168:171], v[60:63], v[152:155]
 buffer_load_dwordx4 v13, s[32:35], s78 offen offset:0 sc1 lds
 v_mfma_f32_16x16x32_bf16 v[156:159], a[172:175], v[60:63], 0
 v_add_f32 v64, v64, v44
 v_add_f32 v65, v65, v44
 v_mfma_f32_16x16x32_bf16 v[156:159], a[124:127], v[56:59], v[156:159]
 v_add_f32 v66, v66, v44
 v_add_f32 v67, v67, v44
 v_mfma_f32_16x16x32_bf16 a[180:183], v[22:25], v[56:59], 0
 buffer_load_dwordx4 v13, s[32:35], s78 offen offset:1024 sc1 lds
 v_mfma_f32_16x16x32_bf16 a[180:183], v[22:25], v[60:63], a[180:183]
 v_add_f32 v68, v68, v44
 v_add_f32 v69, v69, v44
 v_mfma_f32_16x16x32_bf16 v[80:83], a[16:19], a[128:131], 0
 ds_read_b128 a[16:19], v14 offset:16384
 v_add_f32 v70, v70, v44
 v_mfma_f32_16x16x32_bf16 v[80:83], a[20:23], a[132:135], v[80:83]
 buffer_load_dwordx4 v13, s[32:35], s78 offen offset:2048 sc1 lds
 v_mfma_f32_16x16x32_bf16 v[80:83], a[24:27], a[136:139], v[80:83]
 ds_read_b128 a[20:23], v14 offset:17408
 v_add_f32 v71, v71, v44
 v_mfma_f32_16x16x32_bf16 v[80:83], a[28:31], a[140:143], v[80:83]
 ds_read_b128 a[24:27], v14 offset:18432
 v_add_f32 v72, v72, v44
 v_mfma_f32_16x16x32_bf16 v[84:87], a[44:47], a[140:143], 0
 buffer_load_dwordx4 v13, s[32:35], s78 offen offset:3072 sc1 lds
 v_mfma_f32_16x16x32_bf16 v[84:87], a[40:43], a[136:139], v[84:87]
 ds_read_b128 a[28:31], v14 offset:19456
 v_add_f32 v73, v73, v44
 v_mfma_f32_16x16x32_bf16 v[84:87], a[36:39], a[132:135], v[84:87]
 ds_read_b128 a[44:47], v14 offset:23552
 v_add_f32 v74, v74, v44
 v_mfma_f32_16x16x32_bf16 v[84:87], a[32:35], a[128:131], v[84:87]
 ds_read_b128 a[40:43], v14 offset:22528
 v_add_f32 v75, v75, v44
 v_mfma_f32_16x16x32_bf16 v[88:91], a[48:51], a[128:131], 0
 s_add_u32 m0, s77, 16384
 v_add_f32 v76, v76, v44
 v_add_f32 v77, v77, v44
 v_mfma_f32_16x16x32_bf16 v[88:91], a[52:55], a[132:135], v[88:91]
 ds_read_b128 a[36:39], v14 offset:21504
 v_add_f32 v78, v78, v44
 v_mfma_f32_16x16x32_bf16 v[88:91], a[56:59], a[136:139], v[88:91]
 ds_read_b128 a[32:35], v14 offset:20480
 v_add_f32 v79, v79, v44
 v_mfma_f32_16x16x32_bf16 v[88:91], a[60:63], a[140:143], v[88:91]
 s_add_u32 s78, s78, 16384
 v_exp_f32 v16, v64
 v_mfma_f32_16x16x32_bf16 v[92:95], a[92:95], a[140:143], 0
 buffer_load_dwordx4 v13, s[12:15], s78 offen offset:0 sc1 lds
 v_mfma_f32_16x16x32_bf16 v[92:95], a[88:91], a[136:139], v[92:95]
 ds_read_b128 a[48:51], v14 offset:24576
 v_mov_b32 v177, 0
 v_mfma_f32_16x16x32_bf16 v[92:95], a[84:87], a[132:135], v[92:95]
 v_exp_f32 v17, v65
 v_exp_f32 v18, v66
 v_cvt_pk_bf16_f32 v48, v16, v17
 v_exp_f32 v19, v67
 v_exp_f32 v16, v68
 v_cvt_pk_bf16_f32 v49, v18, v19
 v_exp_f32 v17, v69
 v_exp_f32 v18, v70
 v_cvt_pk_bf16_f32 v50, v16, v17
 v_exp_f32 v19, v71
 v_exp_f32 v16, v72
 v_cvt_pk_bf16_f32 v51, v18, v19
 v_exp_f32 v17, v73
 v_exp_f32 v18, v74
 v_cvt_pk_bf16_f32 v52, v16, v17
 v_exp_f32 v19, v75
 v_exp_f32 v16, v76
 v_cvt_pk_bf16_f32 v53, v18, v19
 v_exp_f32 v17, v77
 v_exp_f32 v18, v78
 v_cvt_pk_bf16_f32 v54, v16, v17
 v_exp_f32 v19, v79
 s_nop 0
 v_cvt_pk_bf16_f32 v55, v18, v19
 v_mfma_f32_16x16x32_bf16 v[92:95], a[80:83], a[128:131], v[92:95]
 buffer_load_dwordx4 v13, s[12:15], s78 offen offset:1024 sc1 lds
 v_mfma_f32_16x16x32_bf16 v[192:195], a[96:99], v[48:51], 0
 ds_read_b128 a[52:55], v14 offset:25600
 v_mov_b32 v178, 0
 v_mfma_f32_16x16x32_bf16 v[192:195], a[144:147], v[52:55], v[192:195]
 ds_read_b128 a[56:59], v14 offset:26624
 v_mov_b32 v179, 0
 v_mfma_f32_16x16x32_bf16 v[196:199], a[148:151], v[52:55], 0
 buffer_load_dwordx4 v13, s[12:15], s78 offen offset:2048 sc1 lds
 v_mfma_f32_16x16x32_bf16 v[196:199], a[100:103], v[48:51], v[196:199]
 ds_read_b128 a[60:63], v14 offset:27648
 v_mov_b32 v180, 0
 v_mfma_f32_16x16x32_bf16 v[200:203], a[104:107], v[48:51], 0
 ds_read_b128 a[92:95], v14 offset:31744
 v_mov_b32 v181, 0
 v_mfma_f32_16x16x32_bf16 v[200:203], a[152:155], v[52:55], v[200:203]
 buffer_load_dwordx4 v13, s[12:15], s78 offen offset:3072 sc1 lds
 v_mfma_f32_16x16x32_bf16 v[204:207], a[156:159], v[52:55], 0
 s_add_u32 s79, s76, s58
 v_mov_b32 v182, 0
 v_mov_b32 v183, 0
 v_mfma_f32_16x16x32_bf16 v[204:207], a[108:111], v[48:51], v[204:207]
 s_add_u32 s76, s76, 32768
 v_mov_b32 v184, 0
 v_mov_b32 v185, 0
 v_mfma_f32_16x16x32_bf16 v[208:211], a[112:115], v[48:51], 0
 s_and_b32 s76, s76, 0x1ffff
 v_mov_b32 v186, 0
 v_mov_b32 v187, 0
 v_mfma_f32_16x16x32_bf16 v[208:211], a[160:163], v[52:55], v[208:211]
 ds_read_b128 a[88:91], v14 offset:30720
 v_mov_b32 v188, 0
 v_mfma_f32_16x16x32_bf16 v[212:215], a[164:167], v[52:55], 0
 ds_read_b128 a[84:87], v14 offset:29696
 v_max3_f32 v26, v80, v81, v82
 v_mfma_f32_16x16x32_bf16 v[212:215], a[116:119], v[48:51], v[212:215]
 ds_read_b128 a[80:83], v14 offset:28672
 v_max3_f32 v26, v26, v83, v84
 v_mfma_f32_16x16x32_bf16 v[216:219], a[120:123], v[48:51], 0
 v_max3_f32 v26, v26, v85, v86
 v_max3_f32 v26, v26, v87, v88
 v_mfma_f32_16x16x32_bf16 v[216:219], a[168:171], v[52:55], v[216:219]
 v_max3_f32 v26, v26, v89, v90
 v_max3_f32 v26, v26, v91, v92
 v_mfma_f32_16x16x32_bf16 v[220:223], a[172:175], v[52:55], 0
 v_max3_f32 v26, v26, v93, v94
 v_max_f32 v26, v26, v95
 v_mfma_f32_16x16x32_bf16 v[220:223], a[124:127], v[48:51], v[220:223]
 v_mov_b32 v27, v26
 s_nop 1
 v_permlane16_swap_b32 v26, v27
 v_mfma_f32_16x16x32_bf16 a[188:191], v[22:25], v[48:51], 0
 v_max_f32 v26, v26, v27
 v_mov_b32 v27, v26
 v_mfma_f32_16x16x32_bf16 a[188:191], v[22:25], v[52:55], a[188:191]
 s_mov_b32 s77, s79
 v_add_u32 v14, s76, v12
 v_mov_b32 v189, 0
 v_mov_b32 v190, 0
 v_mov_b32 v191, 0
 v_permlane32_swap_b32 v26, v27
 v_max_f32 v26, v26, v27
 v_sub_f32 v40, 0xc2cc0000, v26
 v_sub_f32 v41, 0xc2cc0000, v26
 v_sub_f32 v42, 0xc2cc0000, v26
 v_sub_f32 v43, 0xc2cc0000, v26
 v_add_f32 v80, v80, v40
 v_add_f32 v81, v81, v40
 v_add_f32 v82, v82, v40
 v_add_f32 v83, v83, v40
 v_add_f32 v84, v84, v40
 v_add_f32 v85, v85, v40
 v_add_f32 v86, v86, v40
 v_add_f32 v87, v87, v40
 v_add_f32 v88, v88, v40
 v_add_f32 v89, v89, v40
 v_add_f32 v90, v90, v40
 v_add_f32 v91, v91, v40
 v_add_f32 v92, v92, v40
 v_add_f32 v93, v93, v40
 v_add_f32 v94, v94, v40
 v_add_f32 v95, v95, v40
 v_exp_f32 v16, v80
 v_exp_f32 v17, v81
 v_exp_f32 v18, v82
 v_cvt_pk_bf16_f32 v56, v16, v17
 v_exp_f32 v19, v83
 v_exp_f32 v16, v84
 v_cvt_pk_bf16_f32 v57, v18, v19
 v_exp_f32 v17, v85
 v_exp_f32 v18, v86
 v_cvt_pk_bf16_f32 v58, v16, v17
 v_or3_b32 v21, v56, v57, v58
 v_exp_f32 v19, v87
 v_exp_f32 v16, v88
 v_cvt_pk_bf16_f32 v59, v18, v19
 v_exp_f32 v17, v89
 v_exp_f32 v18, v90
 v_cvt_pk_bf16_f32 v60, v16, v17
 v_or3_b32 v21, v21, v59, v60
 v_exp_f32 v19, v91
 v_exp_f32 v16, v92
 v_cvt_pk_bf16_f32 v61, v18, v19
 v_exp_f32 v17, v93
 v_accvgpr_write_b32 a184, 0
 v_accvgpr_write_b32 a185, 0
 v_accvgpr_write_b32 a186, 0
 v_accvgpr_write_b32 a187, 0
 s_branch L_a2w1_14
L_w2_20:
 s_cmp_eq_u32 s3, 2
 s_cbranch_scc0 L_w3_21
 s_waitcnt lgkmcnt(3)
 v_mfma_f32_16x16x32_bf16 v[64:67], a[16:19], a[0:3], 0
 v_mov_b32 v160, 0
 v_mov_b32 v161, 0
 v_mfma_f32_16x16x32_bf16 v[64:67], a[20:23], a[4:7], v[64:67]
 v_mov_b32 v162, 0
 v_mfma_f32_16x16x32_bf16 v[64:67], a[24:27], a[8:11], v[64:67]
 v_mfma_f32_16x16x32_bf16 v[64:67], a[28:31], a[12:15], v[64:67]
 v_mfma_f32_16x16x32_bf16 v[68:71], a[44:47], a[12:15], 0
 v_mfma_f32_16x16x32_bf16 v[68:71], a[40:43], a[8:11], v[68:71]
 v_mfma_f32_16x16x32_bf16 v[68:71], a[36:39], a[4:7], v[68:71]
 v_mfma_f32_16x16x32_bf16 v[68:71], a[32:35], a[0:3], v[68:71]
 v_mov_b32 v3, 4048155338
 v_cndmask_b32 v28, v3, 0, s[80:81]
 v_cndmask_b32 v29, v3, 0, s[82:83]
 v_cndmask_b32 v30, v3, 0, s[84:85]
 v_cndmask_b32 v31, v3, 0, s[86:87]
 s_nop 1
 v_mfma_f32_16x16x32_bf16 v[72:75], a[48:51], a[0:3], v[28:31]
 v_mov_b32 v163, 0
 v_mfma_f32_16x16x32_bf16 v[72:75], a[52:55], a[4:7], v[72:75]
 v_mov_b32 v164, 0
 v_mfma_f32_16x16x32_bf16 v[72:75], a[56:59], a[8:11], v[72:75]
 v_mov_b32 v165, 0
 v_mfma_f32_16x16x32_bf16 v[72:75], a[60:63], a[12:15], v[72:75]
 s_waitcnt lgkmcnt(0)
 s_waitcnt vmcnt(16)
 s_barrier
 v_mfma_f32_16x16x32_bf16 v[80:83], a[16:19], a[64:67], 0
 s_lshl_b32 s6, s3, 13
 v_mov_b32 v76, 4048155338
 v_mov_b32 v77, 4048155338
 v_mfma_f32_16x16x32_bf16 v[80:83], a[20:23], a[68:71], v[80:83]
 ds_read_b128 a[96:99], v14 offset:0
 v_mov_b32 v78, 4048155338
 v_mfma_f32_16x16x32_bf16 v[80:83], a[24:27], a[72:75], v[80:83]
 ds_read_b128 a[144:147], v14 offset:8192
 v_mov_b32 v79, 4048155338
 v_mfma_f32_16x16x32_bf16 v[80:83], a[28:31], a[76:79], v[80:83]
 s_add_u32 m0, s6, 131072
 v_mov_b32 v54, 0
 v_mov_b32 v55, 0
 v_mfma_f32_16x16x32_bf16 v[84:87], a[44:47], a[76:79], 0
 s_mov_b32 s42, 0
 v_max3_f32 v26, v64, v65, v66
 v_max3_f32 v26, v26, v67, v68
 v_mfma_f32_16x16x32_bf16 v[84:87], a[40:43], a[72:75], v[84:87]
 ds_read_b128 a[148:151], v14 offset:9216
 v_max3_f32 v26, v26, v69, v70
 v_mfma_f32_16x16x32_bf16 v[84:87], a[36:39], a[68:71], v[84:87]
 ds_read_b128 a[100:103], v14 offset:1024
 v_max3_f32 v26, v26, v71, v72
 v_mfma_f32_16x16x32_bf16 v[84:87], a[32:35], a[64:67], v[84:87]
 buffer_load_dwordx4 v4, s[8:11], s42 offen offset:0 lds
 v_mfma_f32_16x16x32_bf16 v[88:91], a[48:51], a[64:67], 0
 ds_read_b128 a[104:107], v14 offset:2048
 v_max3_f32 v26, v26, v73, v74
 v_mfma_f32_16x16x32_bf16 v[88:91], a[52:55], a[68:71], v[88:91]
 s_add_u32 s42, s42, 7168
 ds_read_b128 a[152:155], v14 offset:10240
 v_mfma_f32_16x16x32_bf16 v[88:91], a[56:59], a[72:75], v[88:91]
 buffer_load_dwordx4 v4, s[8:11], s42 offen offset:1024 lds
 v_mfma_f32_16x16x32_bf16 v[88:91], a[60:63], a[76:79], v[88:91]
 ds_read_b128 a[156:159], v14 offset:11264
 v_max_f32 v26, v26, v75
 v_mfma_f32_16x16x32_bf16 v[92:95], a[92:95], a[76:79], 0
 ds_read_b128 a[108:111], v14 offset:3072
 ds_read_b128 a[112:115], v14 offset:4096
 ds_read_b128 a[160:163], v14 offset:12288
 ds_read_b128 a[164:167], v14 offset:13312
 ds_read_b128 a[116:119], v14 offset:5120
 ds_read_b128 a[120:123], v14 offset:6144
 ds_read_b128 a[168:171], v14 offset:14336
 ds_read_b128 a[172:175], v14 offset:15360
 ds_read_b128 a[124:127], v14 offset:7168
 v_mfma_f32_16x16x32_bf16 v[92:95], a[88:91], a[72:75], v[92:95]
 v_mov_b32 v27, v26
 s_nop 1
 v_permlane16_swap_b32 v26, v27
 v_mfma_f32_16x16x32_bf16 v[92:95], a[84:87], a[68:71], v[92:95]
 v_max_f32 v26, v26, v27
 v_mov_b32 v27, v26
 s_nop 1
 v_permlane32_swap_b32 v26, v27
 v_max_f32 v26, v26, v27
 v_sub_f32 v32, 0xc2cc0000, v26
 v_sub_f32 v33, 0xc2cc0000, v26
 v_sub_f32 v34, 0xc2cc0000, v26
 v_sub_f32 v35, 0xc2cc0000, v26
 v_add_f32 v64, v64, v32
 v_add_f32 v65, v65, v32
 v_add_f32 v66, v66, v32
 v_add_f32 v67, v67, v32
 v_add_f32 v68, v68, v32
 v_add_f32 v69, v69, v32
 v_add_f32 v70, v70, v32
 v_add_f32 v71, v71, v32
 v_add_f32 v72, v72, v32
 v_add_f32 v73, v73, v32
 v_add_f32 v74, v74, v32
 v_add_f32 v75, v75, v32
 v_exp_f32 v16, v64
 v_exp_f32 v17, v65
 v_exp_f32 v18, v66
 v_cvt_pk_bf16_f32 v48, v16, v17
 v_exp_f32 v19, v67
 v_exp_f32 v16, v68
 v_cvt_pk_bf16_f32 v49, v18, v19
 v_exp_f32 v17, v69
 v_exp_f32 v18, v70
 v_cvt_pk_bf16_f32 v50, v16, v17
 v_exp_f32 v19, v71
 v_exp_f32 v16, v72
 v_cvt_pk_bf16_f32 v51, v18, v19
 v_exp_f32 v17, v73
 v_exp_f32 v18, v74
 v_cvt_pk_bf16_f32 v52, v16, v17
 v_exp_f32 v19, v75
 s_nop 0
 v_cvt_pk_bf16_f32 v53, v18, v19
 v_mfma_f32_16x16x32_bf16 v[92:95], a[80:83], a[64:67], v[92:95]
 s_waitcnt lgkmcnt(13)
 v_mov_b32 v166, 0
 v_mov_b32 v167, 0
 v_mfma_f32_16x16x32_bf16 v[96:99], a[96:99], v[48:51], 0
 s_add_u32 s42, s42, 7168
 v_mov_b32 v168, 0
 v_mov_b32 v169, 0
 v_mfma_f32_16x16x32_bf16 v[96:99], a[144:147], v[52:55], v[96:99]
 buffer_load_dwordx4 v4, s[8:11], s42 offen offset:2048 lds
 v_mfma_f32_16x16x32_bf16 v[100:103], a[148:151], v[52:55], 0
 s_waitcnt lgkmcnt(11)
 v_mov_b32 v170, 0
 v_mov_b32 v171, 0
 v_mfma_f32_16x16x32_bf16 v[100:103], a[100:103], v[48:51], v[100:103]
 v_max3_f32 v26, v80, v81, v82
 v_max3_f32 v26, v26, v83, v84
 v_mfma_f32_16x16x32_bf16 v[104:107], a[104:107], v[48:51], 0
 s_waitcnt lgkmcnt(10)
 v_max3_f32 v26, v26, v85, v86
 v_max3_f32 v26, v26, v87, v88
 v_mfma_f32_16x16x32_bf16 v[104:107], a[152:155], v[52:55], v[104:107]
 s_waitcnt lgkmcnt(9)
 v_max3_f32 v26, v26, v89, v90
 v_max3_f32 v26, v26, v91, v92
 v_mfma_f32_16x16x32_bf16 v[108:111], a[156:159], v[52:55], 0
 s_waitcnt lgkmcnt(0)
 s_add_u32 s42, s42, 7168
 v_max3_f32 v26, v26, v93, v94
 v_max_f32 v26, v26, v95
 v_mfma_f32_16x16x32_bf16 v[108:111], a[108:111], v[48:51], v[108:111]
 buffer_load_dwordx4 v4, s[8:11], s42 offen offset:3072 lds
 v_mfma_f32_16x16x32_bf16 v[112:115], a[112:115], v[48:51], 0
 v_mov_b32 v27, v26
 s_nop 1
 v_permlane16_swap_b32 v26, v27
 v_mfma_f32_16x16x32_bf16 v[112:115], a[160:163], v[52:55], v[112:115]
 v_max_f32 v26, v26, v27
 v_mov_b32 v27, v26
 v_mfma_f32_16x16x32_bf16 v[116:119], a[164:167], v[52:55], 0
 s_nop 0
 v_permlane32_swap_b32 v26, v27
 v_max_f32 v26, v26, v27
 v_mfma_f32_16x16x32_bf16 v[116:119], a[116:119], v[48:51], v[116:119]
 v_sub_f32 v36, 0xc2cc0000, v26
 v_sub_f32 v37, 0xc2cc0000, v26
 v_mfma_f32_16x16x32_bf16 v[120:123], a[120:123], v[48:51], 0
 s_lshl_b32 s6, s3, 13
 v_sub_f32 v38, 0xc2cc0000, v26
 v_sub_f32 v39, 0xc2cc0000, v26
 v_mfma_f32_16x16x32_bf16 v[120:123], a[168:171], v[52:55], v[120:123]
 v_add_f32 v80, v80, v36
 v_add_f32 v81, v81, v36
 v_mfma_f32_16x16x32_bf16 v[124:127], a[172:175], v[52:55], 0
 v_add_f32 v82, v82, v36
 v_add_f32 v83, v83, v36
 v_mfma_f32_16x16x32_bf16 v[124:127], a[124:127], v[48:51], v[124:127]
 s_add_u32 m0, s6, 135168
 v_add_f32 v84, v84, v36
 v_add_f32 v85, v85, v36
 v_mfma_f32_16x16x32_bf16 a[176:179], v[22:25], v[48:51], 0
 v_add_f32 v86, v86, v36
 v_add_f32 v87, v87, v36
 v_mfma_f32_16x16x32_bf16 a[176:179], v[22:25], v[52:55], a[176:179]
 v_add_f32 v88, v88, v36
 v_add_f32 v89, v89, v36
 v_mfma_f32_16x16x32_bf16 v[64:67], a[16:19], a[192:195], 0
 s_mov_b32 s42, 0
 v_add_f32 v90, v90, v36
 v_add_f32 v91, v91, v36
 v_mfma_f32_16x16x32_bf16 v[64:67], a[20:23], a[196:199], v[64:67]
 buffer_load_dwordx4 v5, s[20:23], s42 offen offset:0 lds
 v_mfma_f32_16x16x32_bf16 v[64:67], a[24:27], a[200:203], v[64:67]
 v_add_f32 v92, v92, v36
 v_add_f32 v93, v93, v36
 v_mfma_f32_16x16x32_bf16 v[64:67], a[28:31], a[204:207], v[64:67]
 v_add_f32 v94, v94, v36
 v_add_f32 v95, v95, v36
 v_mfma_f32_16x16x32_bf16 v[68:71], a[44:47], a[204:207], 0
 v_exp_f32 v16, v80
 v_mfma_f32_16x16x32_bf16 v[68:71], a[40:43], a[200:203], v[68:71]
 v_exp_f32 v17, v81
 v_mfma_f32_16x16x32_bf16 v[68:71], a[36:39], a[196:199], v[68:71]
 s_add_u32 s42, s42, s40
 v_exp_f32 v18, v82
 v_mfma_f32_16x16x32_bf16 v[68:71], a[32:35], a[192:195], v[68:71]
 buffer_load_dwordx4 v5, s[20:23], s42 offen offset:1024 lds
 v_mfma_f32_16x16x32_bf16 v[72:75], a[48:51], a[192:195], 0
 v_mov_b32 v172, 0
 v_cvt_pk_bf16_f32 v56, v16, v17
 v_mfma_f32_16x16x32_bf16 v[72:75], a[52:55], a[196:199], v[72:75]
 v_exp_f32 v19, v83
 v_mfma_f32_16x16x32_bf16 v[72:75], a[56:59], a[200:203], v[72:75]
 v_exp_f32 v16, v84
 v_mfma_f32_16x16x32_bf16 v[72:75], a[60:63], a[204:207], v[72:75]
 v_cvt_pk_bf16_f32 v57, v18, v19
 v_exp_f32 v17, v85
 v_mfma_f32_16x16x32_bf16 v[76:79], a[92:95], a[204:207], 0
 v_exp_f32 v18, v86
 v_mfma_f32_16x16x32_bf16 v[76:79], a[88:91], a[200:203], v[76:79]
 s_add_u32 s42, s42, s40
 v_cvt_pk_bf16_f32 v58, v16, v17
 v_exp_f32 v19, v87
 v_mfma_f32_16x16x32_bf16 v[76:79], a[84:87], a[196:199], v[76:79]
 v_exp_f32 v16, v88
 v_cvt_pk_bf16_f32 v59, v18, v19
 v_exp_f32 v17, v89
 v_exp_f32 v18, v90
 v_cvt_pk_bf16_f32 v60, v16, v17
 v_exp_f32 v19, v91
 v_exp_f32 v16, v92
 v_cvt_pk_bf16_f32 v61, v18, v19
 v_exp_f32 v17, v93
 v_exp_f32 v18, v94
 v_cvt_pk_bf16_f32 v62, v16, v17
 v_exp_f32 v19, v95
 s_nop 0
 v_cvt_pk_bf16_f32 v63, v18, v19
 v_mfma_f32_16x16x32_bf16 v[76:79], a[80:83], a[192:195], v[76:79]
 buffer_load_dwordx4 v5, s[20:23], s42 offen offset:2048 lds
 v_mfma_f32_16x16x32_bf16 v[128:131], a[96:99], v[56:59], 0
 v_mov_b32 v173, 0
 v_mov_b32 v174, 0
 v_mfma_f32_16x16x32_bf16 v[128:131], a[144:147], v[60:63], v[128:131]
 v_mov_b32 v175, 0
 v_mov_b32 v176, 0
 v_mfma_f32_16x16x32_bf16 v[132:135], a[148:151], v[60:63], 0
 v_mov_b32 v177, 0
 v_mov_b32 v178, 0
 v_mfma_f32_16x16x32_bf16 v[132:135], a[100:103], v[56:59], v[132:135]
 s_add_u32 s42, s42, s40
 v_mov_b32 v179, 0
 v_mov_b32 v180, 0
 v_mfma_f32_16x16x32_bf16 v[136:139], a[104:107], v[56:59], 0
 buffer_load_dwordx4 v5, s[20:23], s42 offen offset:3072 lds
 v_mfma_f32_16x16x32_bf16 v[136:139], a[152:155], v[60:63], v[136:139]
 v_mov_b32 v181, 0
 v_max3_f32 v26, v64, v65, v66
 v_mfma_f32_16x16x32_bf16 v[140:143], a[156:159], v[60:63], 0
 v_max3_f32 v26, v26, v67, v68
 v_max3_f32 v26, v26, v69, v70
 v_mfma_f32_16x16x32_bf16 v[140:143], a[108:111], v[56:59], v[140:143]
 v_max3_f32 v26, v26, v71, v72
 v_max3_f32 v26, v26, v73, v74
 v_mfma_f32_16x16x32_bf16 v[144:147], a[112:115], v[56:59], 0
 v_max3_f32 v26, v26, v75, v76
 v_max3_f32 v26, v26, v77, v78
 v_mfma_f32_16x16x32_bf16 v[144:147], a[160:163], v[60:63], v[144:147]
 s_mov_b32 m0, s77
 v_max_f32 v26, v26, v79
 v_mov_b32 v27, v26
 v_mfma_f32_16x16x32_bf16 v[148:151], a[164:167], v[60:63], 0
 buffer_load_dwordx4 v13, s[32:35], s78 offen offset:0 sc1 lds
 v_mfma_f32_16x16x32_bf16 v[148:151], a[116:119], v[56:59], v[148:151]
 v_permlane16_swap_b32 v26, v27
 v_max_f32 v26, v26, v27
 v_mfma_f32_16x16x32_bf16 v[152:155], a[120:123], v[56:59], 0
 v_mov_b32 v27, v26
 s_nop 1
 v_permlane32_swap_b32 v26, v27
 v_mfma_f32_16x16x32_bf16 v[152:155], a[168:171], v[60:63], v[152:155]
 buffer_load_dwordx4 v13, s[32:35], s78 offen offset:1024 sc1 lds
 v_mfma_f32_16x16x32_bf16 v[156:159], a[172:175], v[60:63], 0
 v_max_f32 v26, v26, v27
 v_sub_f32 v44, 0xc2cc0000, v26
 v_mfma_f32_16x16x32_bf16 v[156:159], a[124:127], v[56:59], v[156:159]
 v_sub_f32 v45, 0xc2cc0000, v26
 v_sub_f32 v46, 0xc2cc0000, v26
 v_mfma_f32_16x16x32_bf16 a[180:183], v[22:25], v[56:59], 0
 buffer_load_dwordx4 v13, s[32:35], s78 offen offset:2048 sc1 lds
 v_mfma_f32_16x16x32_bf16 a[180:183], v[22:25], v[60:63], a[180:183]
 v_sub_f32 v47, 0xc2cc0000, v26
 v_add_f32 v64, v64, v44
 v_mfma_f32_16x16x32_bf16 v[80:83], a[16:19], a[128:131], 0
 ds_read_b128 a[16:19], v14 offset:16384
 v_add_f32 v65, v65, v44
 v_mfma_f32_16x16x32_bf16 v[80:83], a[20:23], a[132:135], v[80:83]
 ds_read_b128 a[20:23], v14 offset:17408
 v_add_f32 v66, v66, v44
 v_mfma_f32_16x16x32_bf16 v[80:83], a[24:27], a[136:139], v[80:83]
 buffer_load_dwordx4 v13, s[32:35], s78 offen offset:3072 sc1 lds
 v_mfma_f32_16x16x32_bf16 v[80:83], a[28:31], a[140:143], v[80:83]
 ds_read_b128 a[24:27], v14 offset:18432
 v_add_f32 v67, v67, v44
 v_mfma_f32_16x16x32_bf16 v[84:87], a[44:47], a[140:143], 0
 ds_read_b128 a[28:31], v14 offset:19456
 v_add_f32 v68, v68, v44
 v_mfma_f32_16x16x32_bf16 v[84:87], a[40:43], a[136:139], v[84:87]
 ds_read_b128 a[44:47], v14 offset:23552
 v_add_f32 v69, v69, v44
 v_mfma_f32_16x16x32_bf16 v[84:87], a[36:39], a[132:135], v[84:87]
 ds_read_b128 a[40:43], v14 offset:22528
 v_add_f32 v70, v70, v44
 v_mfma_f32_16x16x32_bf16 v[84:87], a[32:35], a[128:131], v[84:87]
 s_add_u32 m0, s77, 16384
 v_add_f32 v71, v71, v44
 v_add_f32 v72, v72, v44
 v_mfma_f32_16x16x32_bf16 v[88:91], a[48:51], a[128:131], 0
 ds_read_b128 a[36:39], v14 offset:21504
 v_add_f32 v73, v73, v44
 v_mfma_f32_16x16x32_bf16 v[88:91], a[52:55], a[132:135], v[88:91]
 v_add_f32 v74, v74, v44
 v_add_f32 v75, v75, v44
 v_mfma_f32_16x16x32_bf16 v[88:91], a[56:59], a[136:139], v[88:91]
 s_add_u32 s78, s78, 16384
 v_add_f32 v76, v76, v44
 v_add_f32 v77, v77, v44
 v_mfma_f32_16x16x32_bf16 v[88:91], a[60:63], a[140:143], v[88:91]
 buffer_load_dwordx4 v13, s[12:15], s78 offen offset:0 sc1 lds
 v_mfma_f32_16x16x32_bf16 v[92:95], a[92:95], a[140:143], 0
 ds_read_b128 a[32:35], v14 offset:20480
 v_add_f32 v78, v78, v44
 v_mfma_f32_16x16x32_bf16 v[92:95], a[88:91], a[136:139], v[92:95]
 ds_read_b128 a[48:51], v14 offset:24576
 v_add_f32 v79, v79, v44
 v_mfma_f32_16x16x32_bf16 v[92:95], a[84:87], a[132:135], v[92:95]
 v_exp_f32 v16, v64
 v_exp_f32 v17, v65
 v_exp_f32 v18, v66
 v_cvt_pk_bf16_f32 v48, v16, v17
 v_exp_f32 v19, v67
 v_exp_f32 v16, v68
 v_cvt_pk_bf16_f32 v49, v18, v19
 v_exp_f32 v17, v69
 v_exp_f32 v18, v70
 v_cvt_pk_bf16_f32 v50, v16, v17
 v_exp_f32 v19, v71
 v_exp_f32 v16, v72
 v_cvt_pk_bf16_f32 v51, v18, v19
 v_exp_f32 v17, v73
 v_exp_f32 v18, v74
 v_cvt_pk_bf16_f32 v52, v16, v17
 v_exp_f32 v19, v75
 v_exp_f32 v16, v76
 v_cvt_pk_bf16_f32 v53, v18, v19
 v_exp_f32 v17, v77
 v_exp_f32 v18, v78
 v_cvt_pk_bf16_f32 v54, v16, v17
 v_exp_f32 v19, v79
 s_nop 0
 v_cvt_pk_bf16_f32 v55, v18, v19
 v_mfma_f32_16x16x32_bf16 v[92:95], a[80:83], a[128:131], v[92:95]
 buffer_load_dwordx4 v13, s[12:15], s78 offen offset:1024 sc1 lds
 v_mfma_f32_16x16x32_bf16 v[192:195], a[96:99], v[48:51], 0
 ds_read_b128 a[52:55], v14 offset:25600
 v_mov_b32 v182, 0
 v_mfma_f32_16x16x32_bf16 v[192:195], a[144:147], v[52:55], v[192:195]
 buffer_load_dwordx4 v13, s[12:15], s78 offen offset:2048 sc1 lds
 v_mfma_f32_16x16x32_bf16 v[196:199], a[148:151], v[52:55], 0
 ds_read_b128 a[56:59], v14 offset:26624
 v_mov_b32 v183, 0
 v_mfma_f32_16x16x32_bf16 v[196:199], a[100:103], v[48:51], v[196:199]
 ds_read_b128 a[60:63], v14 offset:27648
 v_mov_b32 v184, 0
 v_mfma_f32_16x16x32_bf16 v[200:203], a[104:107], v[48:51], 0
 buffer_load_dwordx4 v13, s[12:15], s78 offen offset:3072 sc1 lds
 v_mfma_f32_16x16x32_bf16 v[200:203], a[152:155], v[52:55], v[200:203]
 ds_read_b128 a[92:95], v14 offset:31744
 v_mov_b32 v185, 0
 v_mfma_f32_16x16x32_bf16 v[204:207], a[156:159], v[52:55], 0
 s_add_u32 s79, s76, s58
 v_mov_b32 v186, 0
 v_mov_b32 v187, 0
 v_mfma_f32_16x16x32_bf16 v[204:207], a[108:111], v[48:51], v[204:207]
 s_add_u32 s76, s76, 32768
 v_mov_b32 v188, 0
 v_max3_f32 v26, v80, v81, v82
 v_mfma_f32_16x16x32_bf16 v[208:211], a[112:115], v[48:51], 0
 s_and_b32 s76, s76, 0x1ffff
 v_max3_f32 v26, v26, v83, v84
 v_max3_f32 v26, v26, v85, v86
 v_mfma_f32_16x16x32_bf16 v[208:211], a[160:163], v[52:55], v[208:211]
 ds_read_b128 a[88:91], v14 offset:30720
 v_max3_f32 v26, v26, v87, v88
 v_mfma_f32_16x16x32_bf16 v[212:215], a[164:167], v[52:55], 0
 ds_read_b128 a[84:87], v14 offset:29696
 v_max3_f32 v26, v26, v89, v90
 v_mfma_f32_16x16x32_bf16 v[212:215], a[116:119], v[48:51], v[212:215]
 ds_read_b128 a[80:83], v14 offset:28672
 v_max3_f32 v26, v26, v91, v92
 v_mfma_f32_16x16x32_bf16 v[216:219], a[120:123], v[48:51], 0
 v_max3_f32 v26, v26, v93, v94
 v_max_f32 v26, v26, v95
 v_mfma_f32_16x16x32_bf16 v[216:219], a[168:171], v[52:55], v[216:219]
 v_mov_b32 v27, v26
 s_nop 1
 v_permlane16_swap_b32 v26, v27
 v_mfma_f32_16x16x32_bf16 v[220:223], a[172:175], v[52:55], 0
 v_max_f32 v26, v26, v27
 v_mov_b32 v27, v26
 v_mfma_f32_16x16x32_bf16 v[220:223], a[124:127], v[48:51], v[220:223]
 s_nop 0
 v_permlane32_swap_b32 v26, v27
 v_max_f32 v26, v26, v27
 v_mfma_f32_16x16x32_bf16 a[188:191], v[22:25], v[48:51], 0
 v_sub_f32 v40, 0xc2cc0000, v26
 v_sub_f32 v41, 0xc2cc0000, v26
 v_sub_f32 v42, 0xc2cc0000, v26
 v_mfma_f32_16x16x32_bf16 a[188:191], v[22:25], v[52:55], a[188:191]
 s_mov_b32 s77, s79
 v_add_u32 v14, s76, v12
 v_mov_b32 v189, 0
 v_mov_b32 v190, 0
 v_mov_b32 v191, 0
 v_sub_f32 v43, 0xc2cc0000, v26
 v_add_f32 v80, v80, v40
 v_add_f32 v81, v81, v40
 v_add_f32 v82, v82, v40
 v_add_f32 v83, v83, v40
 v_add_f32 v84, v84, v40
 v_add_f32 v85, v85, v40
 v_add_f32 v86, v86, v40
 v_add_f32 v87, v87, v40
 v_add_f32 v88, v88, v40
 v_add_f32 v89, v89, v40
 v_add_f32 v90, v90, v40
 v_add_f32 v91, v91, v40
 v_add_f32 v92, v92, v40
 v_add_f32 v93, v93, v40
 v_add_f32 v94, v94, v40
 v_add_f32 v95, v95, v40
 v_exp_f32 v16, v80
 v_exp_f32 v17, v81
 v_exp_f32 v18, v82
 v_cvt_pk_bf16_f32 v56, v16, v17
 v_exp_f32 v19, v83
 v_exp_f32 v16, v84
 v_cvt_pk_bf16_f32 v57, v18, v19
 v_exp_f32 v17, v85
 v_exp_f32 v18, v86
 v_cvt_pk_bf16_f32 v58, v16, v17
 v_or3_b32 v21, v56, v57, v58
 v_exp_f32 v19, v87
 v_exp_f32 v16, v88
 v_cvt_pk_bf16_f32 v59, v18, v19
 v_exp_f32 v17, v89
 v_exp_f32 v18, v90
 v_cvt_pk_bf16_f32 v60, v16, v17
 v_or3_b32 v21, v21, v59, v60
 v_exp_f32 v19, v91
 v_exp_f32 v16, v92
 v_cvt_pk_bf16_f32 v61, v18, v19
 v_exp_f32 v17, v93
 v_accvgpr_write_b32 a184, 0
 v_accvgpr_write_b32 a185, 0
 v_accvgpr_write_b32 a186, 0
 v_accvgpr_write_b32 a187, 0
 s_branch L_a2w2_15
L_w3_21:
 s_waitcnt lgkmcnt(3)
 v_mfma_f32_16x16x32_bf16 v[64:67], a[16:19], a[0:3], 0
 v_mov_b32 v160, 0
 v_mfma_f32_16x16x32_bf16 v[64:67], a[20:23], a[4:7], v[64:67]
 v_mfma_f32_16x16x32_bf16 v[64:67], a[24:27], a[8:11], v[64:67]
 v_mfma_f32_16x16x32_bf16 v[64:67], a[28:31], a[12:15], v[64:67]
 v_mfma_f32_16x16x32_bf16 v[68:71], a[44:47], a[12:15], 0
 v_mfma_f32_16x16x32_bf16 v[68:71], a[40:43], a[8:11], v[68:71]
 v_mfma_f32_16x16x32_bf16 v[68:71], a[36:39], a[4:7], v[68:71]
 v_mfma_f32_16x16x32_bf16 v[68:71], a[32:35], a[0:3], v[68:71]
 v_mfma_f32_16x16x32_bf16 v[72:75], a[48:51], a[0:3], 0
 v_mov_b32 v161, 0
 v_mfma_f32_16x16x32_bf16 v[72:75], a[52:55], a[4:7], v[72:75]
 v_mov_b32 v162, 0
 v_mfma_f32_16x16x32_bf16 v[72:75], a[56:59], a[8:11], v[72:75]
 v_mov_b32 v163, 0
 v_mfma_f32_16x16x32_bf16 v[72:75], a[60:63], a[12:15], v[72:75]
 v_mov_b32 v164, 0
 v_mov_b32 v3, 4048155338
 v_cndmask_b32 v28, v3, 0, s[80:81]
 v_cndmask_b32 v29, v3, 0, s[82:83]
 v_cndmask_b32 v30, v3, 0, s[84:85]
 v_cndmask_b32 v31, v3, 0, s[86:87]
 s_nop 1
 v_mfma_f32_16x16x32_bf16 v[76:79], a[92:95], a[12:15], v[28:31]
 s_waitcnt lgkmcnt(0)
 v_mov_b32 v165, 0
 v_mfma_f32_16x16x32_bf16 v[76:79], a[88:91], a[8:11], v[76:79]
 v_mov_b32 v166, 0
 v_mfma_f32_16x16x32_bf16 v[76:79], a[84:87], a[4:7], v[76:79]
 v_mfma_f32_16x16x32_bf16 v[76:79], a[80:83], a[0:3], v[76:79]
 s_waitcnt vmcnt(16)
 s_barrier
 v_mfma_f32_16x16x32_bf16 v[80:83], a[16:19], a[64:67], 0
 ds_read_b128 a[96:99], v14 offset:0
 v_mov_b32 v167, 0
 v_mfma_f32_16x16x32_bf16 v[80:83], a[20:23], a[68:71], v[80:83]
 s_lshl_b32 s6, s3, 13
 ds_read_b128 a[144:147], v14 offset:8192
 v_mfma_f32_16x16x32_bf16 v[80:83], a[24:27], a[72:75], v[80:83]
 s_add_u32 m0, s6, 131072
 ds_read_b128 a[148:151], v14 offset:9216
 v_mfma_f32_16x16x32_bf16 v[80:83], a[28:31], a[76:79], v[80:83]
 s_mov_b32 s42, 0
 v_max3_f32 v26, v64, v65, v66
 v_max3_f32 v26, v26, v67, v68
 v_mfma_f32_16x16x32_bf16 v[84:87], a[44:47], a[76:79], 0
 buffer_load_dwordx4 v4, s[8:11], s42 offen offset:0 lds
 v_mfma_f32_16x16x32_bf16 v[84:87], a[40:43], a[72:75], v[84:87]
 ds_read_b128 a[100:103], v14 offset:1024
 v_max3_f32 v26, v26, v69, v70
 v_mfma_f32_16x16x32_bf16 v[84:87], a[36:39], a[68:71], v[84:87]
 ds_read_b128 a[104:107], v14 offset:2048
 v_max3_f32 v26, v26, v71, v72
 v_mfma_f32_16x16x32_bf16 v[84:87], a[32:35], a[64:67], v[84:87]
 ds_read_b128 a[152:155], v14 offset:10240
 v_max3_f32 v26, v26, v73, v74
 v_mfma_f32_16x16x32_bf16 v[88:91], a[48:51], a[64:67], 0
 ds_read_b128 a[156:159], v14 offset:11264
 v_max3_f32 v26, v26, v75, v76
 v_mfma_f32_16x16x32_bf16 v[88:91], a[52:55], a[68:71], v[88:91]
 s_add_u32 s42, s42, 7168
 ds_read_b128 a[108:111], v14 offset:3072
 v_mfma_f32_16x16x32_bf16 v[88:91], a[56:59], a[72:75], v[88:91]
 buffer_load_dwordx4 v4, s[8:11], s42 offen offset:1024 lds
 v_mfma_f32_16x16x32_bf16 v[88:91], a[60:63], a[76:79], v[88:91]
 ds_read_b128 a[112:115], v14 offset:4096
 v_max3_f32 v26, v26, v77, v78
 v_mfma_f32_16x16x32_bf16 v[92:95], a[92:95], a[76:79], 0
 ds_read_b128 a[160:163], v14 offset:12288
 ds_read_b128 a[164:167], v14 offset:13312
 ds_read_b128 a[116:119], v14 offset:5120
 ds_read_b128 a[120:123], v14 offset:6144
 ds_read_b128 a[168:171], v14 offset:14336
 ds_read_b128 a[172:175], v14 offset:15360
 ds_read_b128 a[124:127], v14 offset:7168
 v_mfma_f32_16x16x32_bf16 v[92:95], a[88:91], a[72:75], v[92:95]
 v_max_f32 v26, v26, v79
 v_mov_b32 v27, v26
 v_mfma_f32_16x16x32_bf16 v[92:95], a[84:87], a[68:71], v[92:95]
 s_nop 0
 v_permlane16_swap_b32 v26, v27
 v_max_f32 v26, v26, v27
 v_mov_b32 v27, v26
 s_nop 1
 v_permlane32_swap_b32 v26, v27
 v_max_f32 v26, v26, v27
 v_sub_f32 v32, 0xc2cc0000, v26
 v_sub_f32 v33, 0xc2cc0000, v26
 v_sub_f32 v34, 0xc2cc0000, v26
 v_sub_f32 v35, 0xc2cc0000, v26
 v_add_f32 v64, v64, v32
 v_add_f32 v65, v65, v32
 v_add_f32 v66, v66, v32
 v_add_f32 v67, v67, v32
 v_add_f32 v68, v68, v32
 v_add_f32 v69, v69, v32
 v_add_f32 v70, v70, v32
 v_add_f32 v71, v71, v32
 v_add_f32 v72, v72, v32
 v_add_f32 v73, v73, v32
 v_add_f32 v74, v74, v32
 v_add_f32 v75, v75, v32
 v_add_f32 v76, v76, v32
 v_add_f32 v77, v77, v32
 v_add_f32 v78, v78, v32
 v_add_f32 v79, v79, v32
 v_exp_f32 v16, v64
 v_exp_f32 v17, v65
 v_exp_f32 v18, v66
 v_cvt_pk_bf16_f32 v48, v16, v17
 v_exp_f32 v19, v67
 v_exp_f32 v16, v68
 v_cvt_pk_bf16_f32 v49, v18, v19
 v_exp_f32 v17, v69
 v_exp_f32 v18, v70
 v_cvt_pk_bf16_f32 v50, v16, v17
 v_exp_f32 v19, v71
 v_exp_f32 v16, v72
 v_cvt_pk_bf16_f32 v51, v18, v19
 v_exp_f32 v17, v73
 v_exp_f32 v18, v74
 v_cvt_pk_bf16_f32 v52, v16, v17
 v_exp_f32 v19, v75
 v_exp_f32 v16, v76
 v_cvt_pk_bf16_f32 v53, v18, v19
 v_exp_f32 v17, v77
 v_exp_f32 v18, v78
 v_cvt_pk_bf16_f32 v54, v16, v17
 v_exp_f32 v19, v79
 s_nop 0
 v_cvt_pk_bf16_f32 v55, v18, v19
 v_mfma_f32_16x16x32_bf16 v[92:95], a[80:83], a[64:67], v[92:95]
 s_waitcnt lgkmcnt(12)
 v_mov_b32 v168, 0
 v_mfma_f32_16x16x32_bf16 v[96:99], a[96:99], v[48:51], 0
 s_add_u32 s42, s42, 7168
 v_mov_b32 v169, 0
 v_mov_b32 v170, 0
 v_mfma_f32_16x16x32_bf16 v[96:99], a[144:147], v[52:55], v[96:99]
 buffer_load_dwordx4 v4, s[8:11], s42 offen offset:2048 lds
 v_mfma_f32_16x16x32_bf16 v[100:103], a[148:151], v[52:55], 0
 v_mov_b32 v171, 0
 v_mov_b32 v172, 0
 v_mfma_f32_16x16x32_bf16 v[100:103], a[100:103], v[48:51], v[100:103]
 s_waitcnt lgkmcnt(8)
 v_max3_f32 v26, v80, v81, v82
 v_max3_f32 v26, v26, v83, v84
 v_mfma_f32_16x16x32_bf16 v[104:107], a[104:107], v[48:51], 0
 v_max3_f32 v26, v26, v85, v86
 v_max3_f32 v26, v26, v87, v88
 v_mfma_f32_16x16x32_bf16 v[104:107], a[152:155], v[52:55], v[104:107]
 v_max3_f32 v26, v26, v89, v90
 v_max3_f32 v26, v26, v91, v92
 v_mfma_f32_16x16x32_bf16 v[108:111], a[156:159], v[52:55], 0
 s_add_u32 s42, s42, 7168
 v_max3_f32 v26, v26, v93, v94
 v_max_f32 v26, v26, v95
 v_mfma_f32_16x16x32_bf16 v[108:111], a[108:111], v[48:51], v[108:111]
 s_waitcnt lgkmcnt(0)
 buffer_load_dwordx4 v4, s[8:11], s42 offen offset:3072 lds
 v_mfma_f32_16x16x32_bf16 v[112:115], a[112:115], v[48:51], 0
 v_mov_b32 v27, v26
 s_nop 1
 v_permlane16_swap_b32 v26, v27
 v_mfma_f32_16x16x32_bf16 v[112:115], a[160:163], v[52:55], v[112:115]
 v_max_f32 v26, v26, v27
 v_mov_b32 v27, v26
 v_mfma_f32_16x16x32_bf16 v[116:119], a[164:167], v[52:55], 0
 s_nop 0
 v_permlane32_swap_b32 v26, v27
 v_max_f32 v26, v26, v27
 v_mfma_f32_16x16x32_bf16 v[116:119], a[116:119], v[48:51], v[116:119]
 v_sub_f32 v36, 0xc2cc0000, v26
 v_sub_f32 v37, 0xc2cc0000, v26
 v_mfma_f32_16x16x32_bf16 v[120:123], a[120:123], v[48:51], 0
 s_lshl_b32 s6, s3, 13
 v_sub_f32 v38, 0xc2cc0000, v26
 v_sub_f32 v39, 0xc2cc0000, v26
 v_mfma_f32_16x16x32_bf16 v[120:123], a[168:171], v[52:55], v[120:123]
 v_add_f32 v80, v80, v36
 v_add_f32 v81, v81, v36
 v_mfma_f32_16x16x32_bf16 v[124:127], a[172:175], v[52:55], 0
 v_add_f32 v82, v82, v36
 v_add_f32 v83, v83, v36
 v_mfma_f32_16x16x32_bf16 v[124:127], a[124:127], v[48:51], v[124:127]
 s_add_u32 m0, s6, 135168
 v_add_f32 v84, v84, v36
 v_add_f32 v85, v85, v36
 v_mfma_f32_16x16x32_bf16 a[176:179], v[22:25], v[48:51], 0
 v_add_f32 v86, v86, v36
 v_add_f32 v87, v87, v36
 v_mfma_f32_16x16x32_bf16 a[176:179], v[22:25], v[52:55], a[176:179]
 v_add_f32 v88, v88, v36
 v_add_f32 v89, v89, v36
 v_mfma_f32_16x16x32_bf16 v[64:67], a[16:19], a[192:195], 0
 s_mov_b32 s42, 0
 v_add_f32 v90, v90, v36
 v_add_f32 v91, v91, v36
 v_mfma_f32_16x16x32_bf16 v[64:67], a[20:23], a[196:199], v[64:67]
 buffer_load_dwordx4 v5, s[20:23], s42 offen offset:0 lds
 v_mfma_f32_16x16x32_bf16 v[64:67], a[24:27], a[200:203], v[64:67]
 v_add_f32 v92, v92, v36
 v_add_f32 v93, v93, v36
 v_mfma_f32_16x16x32_bf16 v[64:67], a[28:31], a[204:207], v[64:67]
 v_add_f32 v94, v94, v36
 v_add_f32 v95, v95, v36
 v_mfma_f32_16x16x32_bf16 v[68:71], a[44:47], a[204:207], 0
 v_exp_f32 v16, v80
 v_mfma_f32_16x16x32_bf16 v[68:71], a[40:43], a[200:203], v[68:71]
 v_exp_f32 v17, v81
 v_mfma_f32_16x16x32_bf16 v[68:71], a[36:39], a[196:199], v[68:71]
 s_add_u32 s42, s42, s40
 v_exp_f32 v18, v82
 v_mfma_f32_16x16x32_bf16 v[68:71], a[32:35], a[192:195], v[68:71]
 buffer_load_dwordx4 v5, s[20:23], s42 offen offset:1024 lds
 v_mfma_f32_16x16x32_bf16 v[72:75], a[48:51], a[192:195], 0
 v_mov_b32 v173, 0
 v_cvt_pk_bf16_f32 v56, v16, v17
 v_mfma_f32_16x16x32_bf16 v[72:75], a[52:55], a[196:199], v[72:75]
 v_exp_f32 v19, v83
 v_mfma_f32_16x16x32_bf16 v[72:75], a[56:59], a[200:203], v[72:75]
 v_exp_f32 v16, v84
 v_mfma_f32_16x16x32_bf16 v[72:75], a[60:63], a[204:207], v[72:75]
 v_cvt_pk_bf16_f32 v57, v18, v19
 v_exp_f32 v17, v85
 v_mfma_f32_16x16x32_bf16 v[76:79], a[92:95], a[204:207], 0
 v_exp_f32 v18, v86
 v_mfma_f32_16x16x32_bf16 v[76:79], a[88:91], a[200:203], v[76:79]
 s_add_u32 s42, s42, s40
 v_cvt_pk_bf16_f32 v58, v16, v17
 v_exp_f32 v19, v87
 v_mfma_f32_16x16x32_bf16 v[76:79], a[84:87], a[196:199], v[76:79]
 v_exp_f32 v16, v88
 v_cvt_pk_bf16_f32 v59, v18, v19
 v_exp_f32 v17, v89
 v_exp_f32 v18, v90
 v_cvt_pk_bf16_f32 v60, v16, v17
 v_exp_f32 v19, v91
 v_exp_f32 v16, v92
 v_cvt_pk_bf16_f32 v61, v18, v19
 v_exp_f32 v17, v93
 v_exp_f32 v18, v94
 v_cvt_pk_bf16_f32 v62, v16, v17
 v_exp_f32 v19, v95
 s_nop 0
 v_cvt_pk_bf16_f32 v63, v18, v19
 v_mfma_f32_16x16x32_bf16 v[76:79], a[80:83], a[192:195], v[76:79]
 buffer_load_dwordx4 v5, s[20:23], s42 offen offset:2048 lds
 v_mfma_f32_16x16x32_bf16 v[128:131], a[96:99], v[56:59], 0
 v_mov_b32 v174, 0
 v_mov_b32 v175, 0
 v_mfma_f32_16x16x32_bf16 v[128:131], a[144:147], v[60:63], v[128:131]
 v_mov_b32 v176, 0
 v_mov_b32 v177, 0
 v_mfma_f32_16x16x32_bf16 v[132:135], a[148:151], v[60:63], 0
 v_mov_b32 v178, 0
 v_mov_b32 v179, 0
 v_mfma_f32_16x16x32_bf16 v[132:135], a[100:103], v[56:59], v[132:135]
 s_add_u32 s42, s42, s40
 v_mov_b32 v180, 0
 v_mov_b32 v181, 0
 v_mfma_f32_16x16x32_bf16 v[136:139], a[104:107], v[56:59], 0
 buffer_load_dwordx4 v5, s[20:23], s42 offen offset:3072 lds
 v_mfma_f32_16x16x32_bf16 v[136:139], a[152:155], v[60:63], v[136:139]
 v_mov_b32 v182, 0
 v_max3_f32 v26, v64, v65, v66
 v_mfma_f32_16x16x32_bf16 v[140:143], a[156:159], v[60:63], 0
 v_max3_f32 v26, v26, v67, v68
 v_max3_f32 v26, v26, v69, v70
 v_mfma_f32_16x16x32_bf16 v[140:143], a[108:111], v[56:59], v[140:143]
 v_max3_f32 v26, v26, v71, v72
 v_max3_f32 v26, v26, v73, v74
 v_mfma_f32_16x16x32_bf16 v[144:147], a[112:115], v[56:59], 0
 v_max3_f32 v26, v26, v75, v76
 v_max3_f32 v26, v26, v77, v78
 v_mfma_f32_16x16x32_bf16 v[144:147], a[160:163], v[60:63], v[144:147]
 s_mov_b32 m0, s77
 v_max_f32 v26, v26, v79
 v_mov_b32 v27, v26
 v_mfma_f32_16x16x32_bf16 v[148:151], a[164:167], v[60:63], 0
 buffer_load_dwordx4 v13, s[32:35], s78 offen offset:0 sc1 lds
 v_mfma_f32_16x16x32_bf16 v[148:151], a[116:119], v[56:59], v[148:151]
 v_permlane16_swap_b32 v26, v27
 v_max_f32 v26, v26, v27
 v_mfma_f32_16x16x32_bf16 v[152:155], a[120:123], v[56:59], 0
 v_mov_b32 v27, v26
 s_nop 1
 v_permlane32_swap_b32 v26, v27
 v_mfma_f32_16x16x32_bf16 v[152:155], a[168:171], v[60:63], v[152:155]
 buffer_load_dwordx4 v13, s[32:35], s78 offen offset:1024 sc1 lds
 v_mfma_f32_16x16x32_bf16 v[156:159], a[172:175], v[60:63], 0
 v_max_f32 v26, v26, v27
 v_sub_f32 v44, 0xc2cc0000, v26
 v_mfma_f32_16x16x32_bf16 v[156:159], a[124:127], v[56:59], v[156:159]
 v_sub_f32 v45, 0xc2cc0000, v26
 v_sub_f32 v46, 0xc2cc0000, v26
 v_mfma_f32_16x16x32_bf16 a[180:183], v[22:25], v[56:59], 0
 buffer_load_dwordx4 v13, s[32:35], s78 offen offset:2048 sc1 lds
 v_mfma_f32_16x16x32_bf16 a[180:183], v[22:25], v[60:63], a[180:183]
 v_sub_f32 v47, 0xc2cc0000, v26
 v_add_f32 v64, v64, v44
 v_mfma_f32_16x16x32_bf16 v[80:83], a[16:19], a[128:131], 0
 ds_read_b128 a[16:19], v14 offset:16384
 v_add_f32 v65, v65, v44
 v_mfma_f32_16x16x32_bf16 v[80:83], a[20:23], a[132:135], v[80:83]
 ds_read_b128 a[20:23], v14 offset:17408
 v_add_f32 v66, v66, v44
 v_mfma_f32_16x16x32_bf16 v[80:83], a[24:27], a[136:139], v[80:83]
 buffer_load_dwordx4 v13, s[32:35], s78 offen offset:3072 sc1 lds
 v_mfma_f32_16x16x32_bf16 v[80:83], a[28:31], a[140:143], v[80:83]
 ds_read_b128 a[24:27], v14 offset:18432
 v_add_f32 v67, v67, v44
 v_mfma_f32_16x16x32_bf16 v[84:87], a[44:47], a[140:143], 0
 ds_read_b128 a[28:31], v14 offset:19456
 v_add_f32 v68, v68, v44
 v_mfma_f32_16x16x32_bf16 v[84:87], a[40:43], a[136:139], v[84:87]
 ds_read_b128 a[44:47], v14 offset:23552
 v_add_f32 v69, v69, v44
 v_mfma_f32_16x16x32_bf16 v[84:87], a[36:39], a[132:135], v[84:87]
 ds_read_b128 a[40:43], v14 offset:22528
 v_add_f32 v70, v70, v44
 v_mfma_f32_16x16x32_bf16 v[84:87], a[32:35], a[128:131], v[84:87]
 s_add_u32 m0, s77, 16384
 v_add_f32 v71, v71, v44
 v_add_f32 v72, v72, v44
 v_mfma_f32_16x16x32_bf16 v[88:91], a[48:51], a[128:131], 0
 ds_read_b128 a[36:39], v14 offset:21504
 v_add_f32 v73, v73, v44
 v_mfma_f32_16x16x32_bf16 v[88:91], a[52:55], a[132:135], v[88:91]
 v_add_f32 v74, v74, v44
 v_add_f32 v75, v75, v44
 v_mfma_f32_16x16x32_bf16 v[88:91], a[56:59], a[136:139], v[88:91]
 s_add_u32 s78, s78, 16384
 v_add_f32 v76, v76, v44
 v_add_f32 v77, v77, v44
 v_mfma_f32_16x16x32_bf16 v[88:91], a[60:63], a[140:143], v[88:91]
 buffer_load_dwordx4 v13, s[12:15], s78 offen offset:0 sc1 lds
 v_mfma_f32_16x16x32_bf16 v[92:95], a[92:95], a[140:143], 0
 ds_read_b128 a[32:35], v14 offset:20480
 v_add_f32 v78, v78, v44
 v_mfma_f32_16x16x32_bf16 v[92:95], a[88:91], a[136:139], v[92:95]
 ds_read_b128 a[48:51], v14 offset:24576
 v_add_f32 v79, v79, v44
 v_mfma_f32_16x16x32_bf16 v[92:95], a[84:87], a[132:135], v[92:95]
 v_exp_f32 v16, v64
 v_exp_f32 v17, v65
 v_exp_f32 v18, v66
 v_cvt_pk_bf16_f32 v48, v16, v17
 v_exp_f32 v19, v67
 v_exp_f32 v16, v68
 v_cvt_pk_bf16_f32 v49, v18, v19
 v_exp_f32 v17, v69
 v_exp_f32 v18, v70
 v_cvt_pk_bf16_f32 v50, v16, v17
 v_exp_f32 v19, v71
 v_exp_f32 v16, v72
 v_cvt_pk_bf16_f32 v51, v18, v19
 v_exp_f32 v17, v73
 v_exp_f32 v18, v74
 v_cvt_pk_bf16_f32 v52, v16, v17
 v_exp_f32 v19, v75
 v_exp_f32 v16, v76
 v_cvt_pk_bf16_f32 v53, v18, v19
 v_exp_f32 v17, v77
 v_exp_f32 v18, v78
 v_cvt_pk_bf16_f32 v54, v16, v17
 v_exp_f32 v19, v79
 s_nop 0
 v_cvt_pk_bf16_f32 v55, v18, v19
 v_mfma_f32_16x16x32_bf16 v[92:95], a[80:83], a[128:131], v[92:95]
 buffer_load_dwordx4 v13, s[12:15], s78 offen offset:1024 sc1 lds
 v_mfma_f32_16x16x32_bf16 v[192:195], a[96:99], v[48:51], 0
 ds_read_b128 a[52:55], v14 offset:25600
 v_mov_b32 v183, 0
 v_mfma_f32_16x16x32_bf16 v[192:195], a[144:147], v[52:55], v[192:195]
 buffer_load_dwordx4 v13, s[12:15], s78 offen offset:2048 sc1 lds
 v_mfma_f32_16x16x32_bf16 v[196:199], a[148:151], v[52:55], 0
 ds_read_b128 a[56:59], v14 offset:26624
 v_mov_b32 v184, 0
 v_mfma_f32_16x16x32_bf16 v[196:199], a[100:103], v[48:51], v[196:199]
 ds_read_b128 a[60:63], v14 offset:27648
 v_max3_f32 v26, v80, v81, v82
 v_mfma_f32_16x16x32_bf16 v[200:203], a[104:107], v[48:51], 0
 buffer_load_dwordx4 v13, s[12:15], s78 offen offset:3072 sc1 lds
 v_mfma_f32_16x16x32_bf16 v[200:203], a[152:155], v[52:55], v[200:203]
 ds_read_b128 a[92:95], v14 offset:31744
 v_max3_f32 v26, v26, v83, v84
 v_mfma_f32_16x16x32_bf16 v[204:207], a[156:159], v[52:55], 0
 s_add_u32 s79, s76, s58
 v_max3_f32 v26, v26, v85, v86
 v_max3_f32 v26, v26, v87, v88
 v_mfma_f32_16x16x32_bf16 v[204:207], a[108:111], v[48:51], v[204:207]
 s_add_u32 s76, s76, 32768
 v_max3_f32 v26, v26, v89, v90
 v_max3_f32 v26, v26, v91, v92
 v_mfma_f32_16x16x32_bf16 v[208:211], a[112:115], v[48:51], 0
 s_and_b32 s76, s76, 0x1ffff
 v_max3_f32 v26, v26, v93, v94
 v_max_f32 v26, v26, v95
 v_mfma_f32_16x16x32_bf16 v[208:211], a[160:163], v[52:55], v[208:211]
 ds_read_b128 a[88:91], v14 offset:30720
 v_mov_b32 v27, v26
 v_mfma_f32_16x16x32_bf16 v[212:215], a[164:167], v[52:55], 0
 ds_read_b128 a[84:87], v14 offset:29696
 v_permlane16_swap_b32 v26, v27
 v_mfma_f32_16x16x32_bf16 v[212:215], a[116:119], v[48:51], v[212:215]
 ds_read_b128 a[80:83], v14 offset:28672
 v_max_f32 v26, v26, v27
 v_mfma_f32_16x16x32_bf16 v[216:219], a[120:123], v[48:51], 0
 v_mov_b32 v27, v26
 s_nop 1
 v_permlane32_swap_b32 v26, v27
 v_mfma_f32_16x16x32_bf16 v[216:219], a[168:171], v[52:55], v[216:219]
 v_max_f32 v26, v26, v27
 v_sub_f32 v40, 0xc2cc0000, v26
 v_mfma_f32_16x16x32_bf16 v[220:223], a[172:175], v[52:55], 0
 v_sub_f32 v41, 0xc2cc0000, v26
 v_sub_f32 v42, 0xc2cc0000, v26
 v_mfma_f32_16x16x32_bf16 v[220:223], a[124:127], v[48:51], v[220:223]
 v_sub_f32 v43, 0xc2cc0000, v26
 v_add_f32 v80, v80, v40
 v_mfma_f32_16x16x32_bf16 a[188:191], v[22:25], v[48:51], 0
 v_add_f32 v81, v81, v40
 v_add_f32 v82, v82, v40
 v_add_f32 v83, v83, v40
 v_mfma_f32_16x16x32_bf16 a[188:191], v[22:25], v[52:55], a[188:191]
 s_mov_b32 s77, s79
 v_add_u32 v14, s76, v12
 v_mov_b32 v185, 0
 v_mov_b32 v186, 0
 v_mov_b32 v187, 0
 v_add_f32 v84, v84, v40
 v_add_f32 v85, v85, v40
 v_add_f32 v86, v86, v40
 v_add_f32 v87, v87, v40
 v_add_f32 v88, v88, v40
 v_add_f32 v89, v89, v40
 v_add_f32 v90, v90, v40
 v_add_f32 v91, v91, v40
 v_add_f32 v92, v92, v40
 v_add_f32 v93, v93, v40
 v_add_f32 v94, v94, v40
 v_add_f32 v95, v95, v40
 v_exp_f32 v16, v80
 v_exp_f32 v17, v81
 v_exp_f32 v18, v82
 v_cvt_pk_bf16_f32 v56, v16, v17
 v_exp_f32 v19, v83
 v_exp_f32 v16, v84
 v_cvt_pk_bf16_f32 v57, v18, v19
 v_exp_f32 v17, v85
 v_exp_f32 v18, v86
 v_cvt_pk_bf16_f32 v58, v16, v17
 v_or3_b32 v21, v56, v57, v58
 v_exp_f32 v19, v87
 v_exp_f32 v16, v88
 v_cvt_pk_bf16_f32 v59, v18, v19
 v_exp_f32 v17, v89
 v_exp_f32 v18, v90
 v_cvt_pk_bf16_f32 v60, v16, v17
 v_or3_b32 v21, v21, v59, v60
 v_exp_f32 v19, v91
 v_exp_f32 v16, v92
 v_cvt_pk_bf16_f32 v61, v18, v19
 v_exp_f32 v17, v93
 v_mov_b32 v188, 0
 v_mov_b32 v189, 0
 v_mov_b32 v190, 0
 v_mov_b32 v191, 0
 v_accvgpr_write_b32 a184, 0
 v_accvgpr_write_b32 a185, 0
 v_accvgpr_write_b32 a186, 0
 v_accvgpr_write_b32 a187, 0
 s_branch L_a2w3_16
L_vj_22:
L_gen_17:
 s_waitcnt lgkmcnt(3)
 v_mfma_f32_16x16x32_bf16 v[64:67], a[16:19], a[0:3], 0
 v_mov_b32 v160, 0
 v_mov_b32 v161, 0
 v_mfma_f32_16x16x32_bf16 v[64:67], a[20:23], a[4:7], v[64:67]
 v_mov_b32 v162, 0
 v_mov_b32 v163, 0
 v_mfma_f32_16x16x32_bf16 v[64:67], a[24:27], a[8:11], v[64:67]
 v_mov_b32 v164, 0
 v_mov_b32 v165, 0
 v_mfma_f32_16x16x32_bf16 v[64:67], a[28:31], a[12:15], v[64:67]
 v_mov_b32 v166, 0
 v_mov_b32 v167, 0
 v_mfma_f32_16x16x32_bf16 v[68:71], a[44:47], a[12:15], 0
 v_mov_b32 v168, 0
 v_mov_b32 v169, 0
 v_mfma_f32_16x16x32_bf16 v[68:71], a[40:43], a[8:11], v[68:71]
 v_mov_b32 v170, 0
 v_mov_b32 v171, 0
 v_mfma_f32_16x16x32_bf16 v[68:71], a[36:39], a[4:7], v[68:71]
 v_mov_b32 v172, 0
 v_mov_b32 v173, 0
 v_mfma_f32_16x16x32_bf16 v[68:71], a[32:35], a[0:3], v[68:71]
 v_mov_b32 v174, 0
 v_mov_b32 v175, 0
 v_mfma_f32_16x16x32_bf16 v[72:75], a[48:51], a[0:3], 0
 v_mov_b32 v176, 0
 v_mov_b32 v177, 0
 v_mfma_f32_16x16x32_bf16 v[72:75], a[52:55], a[4:7], v[72:75]
 v_mov_b32 v178, 0
 v_mov_b32 v179, 0
 v_mov_b32 v180, 0
 v_mfma_f32_16x16x32_bf16 v[72:75], a[56:59], a[8:11], v[72:75]
 v_mov_b32 v181, 0
 v_mov_b32 v182, 0
 v_mov_b32 v183, 0
 v_mfma_f32_16x16x32_bf16 v[72:75], a[60:63], a[12:15], v[72:75]
 v_mov_b32 v184, 0
 v_mov_b32 v185, 0
 v_mov_b32 v186, 0
 v_mfma_f32_16x16x32_bf16 v[76:79], a[92:95], a[12:15], 0
 s_waitcnt lgkmcnt(0)
 v_mov_b32 v187, 0
 v_mov_b32 v188, 0
 v_mov_b32 v189, 0
 v_mfma_f32_16x16x32_bf16 v[76:79], a[88:91], a[8:11], v[76:79]
 v_mov_b32 v190, 0
 v_mov_b32 v191, 0
 v_accvgpr_write_b32 a184, 0
 v_mfma_f32_16x16x32_bf16 v[76:79], a[84:87], a[4:7], v[76:79]
 v_accvgpr_write_b32 a185, 0
 v_accvgpr_write_b32 a186, 0
 v_accvgpr_write_b32 a187, 0
 v_mfma_f32_16x16x32_bf16 v[76:79], a[80:83], a[0:3], v[76:79]
 s_waitcnt vmcnt(16)
 s_barrier
 v_mfma_f32_16x16x32_bf16 v[80:83], a[16:19], a[64:67], 0
 s_lshl_b32 s6, s3, 13
 ds_read_b128 a[96:99], v14 offset:0
 v_mfma_f32_16x16x32_bf16 v[80:83], a[20:23], a[68:71], v[80:83]
 s_add_u32 m0, s6, 131072
 ds_read_b128 a[144:147], v14 offset:8192
 v_mfma_f32_16x16x32_bf16 v[80:83], a[24:27], a[72:75], v[80:83]
 ds_read_b128 a[148:151], v14 offset:9216
 v_mfma_f32_16x16x32_bf16 v[80:83], a[28:31], a[76:79], v[80:83]
 s_mov_b32 s42, 0
 v_max3_f32 v26, v64, v65, v66
 v_max3_f32 v26, v26, v67, v68
 v_mfma_f32_16x16x32_bf16 v[84:87], a[44:47], a[76:79], 0
 buffer_load_dwordx4 v4, s[8:11], s42 offen offset:0 lds
 v_mfma_f32_16x16x32_bf16 v[84:87], a[40:43], a[72:75], v[84:87]
 ds_read_b128 a[100:103], v14 offset:1024
 v_max3_f32 v26, v26, v69, v70
 v_mfma_f32_16x16x32_bf16 v[84:87], a[36:39], a[68:71], v[84:87]
 ds_read_b128 a[104:107], v14 offset:2048
 v_max3_f32 v26, v26, v71, v72
 v_mfma_f32_16x16x32_bf16 v[84:87], a[32:35], a[64:67], v[84:87]
 ds_read_b128 a[152:155], v14 offset:10240
 v_max3_f32 v26, v26, v73, v74
 v_mfma_f32_16x16x32_bf16 v[88:91], a[48:51], a[64:67], 0
 ds_read_b128 a[156:159], v14 offset:11264
 v_max3_f32 v26, v26, v75, v76
 v_mfma_f32_16x16x32_bf16 v[88:91], a[52:55], a[68:71], v[88:91]
 ds_read_b128 a[108:111], v14 offset:3072
 v_max3_f32 v26, v26, v77, v78
 v_mfma_f32_16x16x32_bf16 v[88:91], a[56:59], a[72:75], v[88:91]
 ds_read_b128 a[112:115], v14 offset:4096
 v_max_f32 v26, v26, v79
 v_mfma_f32_16x16x32_bf16 v[88:91], a[60:63], a[76:79], v[88:91]
 ds_read_b128 a[160:163], v14 offset:12288
 v_mov_b32 v27, v26
 v_mfma_f32_16x16x32_bf16 v[92:95], a[92:95], a[76:79], 0
 ds_read_b128 a[164:167], v14 offset:13312
 ds_read_b128 a[116:119], v14 offset:5120
 ds_read_b128 a[120:123], v14 offset:6144
 ds_read_b128 a[168:171], v14 offset:14336
 ds_read_b128 a[172:175], v14 offset:15360
 ds_read_b128 a[124:127], v14 offset:7168
 v_mfma_f32_16x16x32_bf16 v[92:95], a[88:91], a[72:75], v[92:95]
 v_permlane16_swap_b32 v26, v27
 v_max_f32 v26, v26, v27
 v_mfma_f32_16x16x32_bf16 v[92:95], a[84:87], a[68:71], v[92:95]
 v_mov_b32 v27, v26
 s_nop 1
 v_permlane32_swap_b32 v26, v27
 v_max_f32 v26, v26, v27
 v_sub_f32 v32, 0xc2cc0000, v26
 v_sub_f32 v33, 0xc2cc0000, v26
 v_sub_f32 v34, 0xc2cc0000, v26
 v_sub_f32 v35, 0xc2cc0000, v26
 v_add_f32 v64, v64, v32
 v_add_f32 v65, v65, v32
 v_add_f32 v66, v66, v32
 v_add_f32 v67, v67, v32
 v_add_f32 v68, v68, v32
 v_add_f32 v69, v69, v32
 v_add_f32 v70, v70, v32
 v_add_f32 v71, v71, v32
 v_add_f32 v72, v72, v32
 v_add_f32 v73, v73, v32
 v_add_f32 v74, v74, v32
 v_add_f32 v75, v75, v32
 v_add_f32 v76, v76, v32
 v_add_f32 v77, v77, v32
 v_add_f32 v78, v78, v32
 v_add_f32 v79, v79, v32
 v_exp_f32 v16, v64
 v_exp_f32 v17, v65
 v_exp_f32 v18, v66
 v_cvt_pk_bf16_f32 v48, v16, v17
 v_exp_f32 v19, v67
 v_exp_f32 v16, v68
 v_cvt_pk_bf16_f32 v49, v18, v19
 v_exp_f32 v17, v69
 v_exp_f32 v18, v70
 v_cvt_pk_bf16_f32 v50, v16, v17
 v_exp_f32 v19, v71
 v_exp_f32 v16, v72
 v_cvt_pk_bf16_f32 v51, v18, v19
 v_exp_f32 v17, v73
 v_exp_f32 v18, v74
 v_cvt_pk_bf16_f32 v52, v16, v17
 v_exp_f32 v19, v75
 v_exp_f32 v16, v76
 v_cvt_pk_bf16_f32 v53, v18, v19
 v_exp_f32 v17, v77
 v_exp_f32 v18, v78
 v_cvt_pk_bf16_f32 v54, v16, v17
 v_exp_f32 v19, v79
 s_nop 0
 v_cvt_pk_bf16_f32 v55, v18, v19
 v_mfma_f32_16x16x32_bf16 v[92:95], a[80:83], a[64:67], v[92:95]
 s_waitcnt lgkmcnt(12)
 s_add_u32 s42, s42, 7168
 v_mfma_f32_16x16x32_bf16 v[96:99], a[96:99], v[48:51], 0
 buffer_load_dwordx4 v4, s[8:11], s42 offen offset:1024 lds
 v_mfma_f32_16x16x32_bf16 v[96:99], a[144:147], v[52:55], v[96:99]
 s_add_u32 s42, s42, 7168
 v_mfma_f32_16x16x32_bf16 v[100:103], a[148:151], v[52:55], 0
 buffer_load_dwordx4 v4, s[8:11], s42 offen offset:2048 lds
 v_mfma_f32_16x16x32_bf16 v[100:103], a[100:103], v[48:51], v[100:103]
 s_waitcnt lgkmcnt(8)
 v_max3_f32 v26, v80, v81, v82
 v_max3_f32 v26, v26, v83, v84
 v_mfma_f32_16x16x32_bf16 v[104:107], a[104:107], v[48:51], 0
 v_max3_f32 v26, v26, v85, v86
 v_max3_f32 v26, v26, v87, v88
 v_mfma_f32_16x16x32_bf16 v[104:107], a[152:155], v[52:55], v[104:107]
 v_max3_f32 v26, v26, v89, v90
 v_max3_f32 v26, v26, v91, v92
 v_mfma_f32_16x16x32_bf16 v[108:111], a[156:159], v[52:55], 0
 v_max3_f32 v26, v26, v93, v94
 v_max_f32 v26, v26, v95
 v_mfma_f32_16x16x32_bf16 v[108:111], a[108:111], v[48:51], v[108:111]
 s_waitcnt lgkmcnt(0)
 s_add_u32 s42, s42, 7168
 v_mov_b32 v27, v26
 s_nop 1
 v_permlane16_swap_b32 v26, v27
 v_mfma_f32_16x16x32_bf16 v[112:115], a[112:115], v[48:51], 0
 buffer_load_dwordx4 v4, s[8:11], s42 offen offset:3072 lds
 v_mfma_f32_16x16x32_bf16 v[112:115], a[160:163], v[52:55], v[112:115]
 v_max_f32 v26, v26, v27
 v_mov_b32 v27, v26
 v_mfma_f32_16x16x32_bf16 v[116:119], a[164:167], v[52:55], 0
 s_nop 0
 v_permlane32_swap_b32 v26, v27
 v_max_f32 v26, v26, v27
 v_mfma_f32_16x16x32_bf16 v[116:119], a[116:119], v[48:51], v[116:119]
 v_sub_f32 v36, 0xc2cc0000, v26
 v_sub_f32 v37, 0xc2cc0000, v26
 v_mfma_f32_16x16x32_bf16 v[120:123], a[120:123], v[48:51], 0
 s_lshl_b32 s6, s3, 13
 v_sub_f32 v38, 0xc2cc0000, v26
 v_sub_f32 v39, 0xc2cc0000, v26
 v_mfma_f32_16x16x32_bf16 v[120:123], a[168:171], v[52:55], v[120:123]
 v_add_f32 v80, v80, v36
 v_add_f32 v81, v81, v36
 v_mfma_f32_16x16x32_bf16 v[124:127], a[172:175], v[52:55], 0
 v_add_f32 v82, v82, v36
 v_add_f32 v83, v83, v36
 v_mfma_f32_16x16x32_bf16 v[124:127], a[124:127], v[48:51], v[124:127]
 s_add_u32 m0, s6, 135168
 v_add_f32 v84, v84, v36
 v_add_f32 v85, v85, v36
 v_mfma_f32_16x16x32_bf16 a[176:179], v[22:25], v[48:51], 0
 v_add_f32 v86, v86, v36
 v_add_f32 v87, v87, v36
 v_mfma_f32_16x16x32_bf16 a[176:179], v[22:25], v[52:55], a[176:179]
 v_add_f32 v88, v88, v36
 v_add_f32 v89, v89, v36
 v_mfma_f32_16x16x32_bf16 v[64:67], a[16:19], a[192:195], 0
 s_mov_b32 s42, 0
 v_add_f32 v90, v90, v36
 v_add_f32 v91, v91, v36
 v_mfma_f32_16x16x32_bf16 v[64:67], a[20:23], a[196:199], v[64:67]
 buffer_load_dwordx4 v5, s[20:23], s42 offen offset:0 lds
 v_mfma_f32_16x16x32_bf16 v[64:67], a[24:27], a[200:203], v[64:67]
 v_add_f32 v92, v92, v36
 v_add_f32 v93, v93, v36
 v_mfma_f32_16x16x32_bf16 v[64:67], a[28:31], a[204:207], v[64:67]
 v_add_f32 v94, v94, v36
 v_add_f32 v95, v95, v36
 v_mfma_f32_16x16x32_bf16 v[68:71], a[44:47], a[204:207], 0
 v_exp_f32 v16, v80
 v_mfma_f32_16x16x32_bf16 v[68:71], a[40:43], a[200:203], v[68:71]
 v_exp_f32 v17, v81
 v_mfma_f32_16x16x32_bf16 v[68:71], a[36:39], a[196:199], v[68:71]
 s_add_u32 s42, s42, s40
 v_exp_f32 v18, v82
 v_mfma_f32_16x16x32_bf16 v[68:71], a[32:35], a[192:195], v[68:71]
 v_cvt_pk_bf16_f32 v56, v16, v17
 v_exp_f32 v19, v83
 v_mfma_f32_16x16x32_bf16 v[72:75], a[48:51], a[192:195], 0
 v_exp_f32 v16, v84
 v_mfma_f32_16x16x32_bf16 v[72:75], a[52:55], a[196:199], v[72:75]
 v_cvt_pk_bf16_f32 v57, v18, v19
 v_exp_f32 v17, v85
 v_mfma_f32_16x16x32_bf16 v[72:75], a[56:59], a[200:203], v[72:75]
 v_exp_f32 v18, v86
 v_mfma_f32_16x16x32_bf16 v[72:75], a[60:63], a[204:207], v[72:75]
 v_cvt_pk_bf16_f32 v58, v16, v17
 v_exp_f32 v19, v87
 v_mfma_f32_16x16x32_bf16 v[76:79], a[92:95], a[204:207], 0
 v_exp_f32 v16, v88
 v_cvt_pk_bf16_f32 v59, v18, v19
 v_mfma_f32_16x16x32_bf16 v[76:79], a[88:91], a[200:203], v[76:79]
 v_exp_f32 v17, v89
 v_exp_f32 v18, v90
 v_mfma_f32_16x16x32_bf16 v[76:79], a[84:87], a[196:199], v[76:79]
 v_cvt_pk_bf16_f32 v60, v16, v17
 v_exp_f32 v19, v91
 v_exp_f32 v16, v92
 v_cvt_pk_bf16_f32 v61, v18, v19
 v_exp_f32 v17, v93
 v_exp_f32 v18, v94
 v_cvt_pk_bf16_f32 v62, v16, v17
 v_exp_f32 v19, v95
 s_nop 0
 v_cvt_pk_bf16_f32 v63, v18, v19
 v_mfma_f32_16x16x32_bf16 v[76:79], a[80:83], a[192:195], v[76:79]
 buffer_load_dwordx4 v5, s[20:23], s42 offen offset:1024 lds
 v_mfma_f32_16x16x32_bf16 v[128:131], a[96:99], v[56:59], 0
 s_add_u32 s42, s42, s40
 v_mfma_f32_16x16x32_bf16 v[128:131], a[144:147], v[60:63], v[128:131]
 buffer_load_dwordx4 v5, s[20:23], s42 offen offset:2048 lds
 v_mfma_f32_16x16x32_bf16 v[132:135], a[148:151], v[60:63], 0
 v_mfma_f32_16x16x32_bf16 v[132:135], a[100:103], v[56:59], v[132:135]
 s_add_u32 s42, s42, s40
 v_max3_f32 v26, v64, v65, v66
 v_max3_f32 v26, v26, v67, v68
 v_mfma_f32_16x16x32_bf16 v[136:139], a[104:107], v[56:59], 0
 buffer_load_dwordx4 v5, s[20:23], s42 offen offset:3072 lds
 v_mfma_f32_16x16x32_bf16 v[136:139], a[152:155], v[60:63], v[136:139]
 v_max3_f32 v26, v26, v69, v70
 v_max3_f32 v26, v26, v71, v72
 v_mfma_f32_16x16x32_bf16 v[140:143], a[156:159], v[60:63], 0
 v_max3_f32 v26, v26, v73, v74
 v_max3_f32 v26, v26, v75, v76
 v_mfma_f32_16x16x32_bf16 v[140:143], a[108:111], v[56:59], v[140:143]
 v_max3_f32 v26, v26, v77, v78
 v_max_f32 v26, v26, v79
 v_mfma_f32_16x16x32_bf16 v[144:147], a[112:115], v[56:59], 0
 v_mov_b32 v27, v26
 s_nop 1
 v_permlane16_swap_b32 v26, v27
 v_mfma_f32_16x16x32_bf16 v[144:147], a[160:163], v[60:63], v[144:147]
 s_mov_b32 m0, s77
 v_max_f32 v26, v26, v27
 v_mov_b32 v27, v26
 v_mfma_f32_16x16x32_bf16 v[148:151], a[164:167], v[60:63], 0
 buffer_load_dwordx4 v13, s[32:35], s78 offen offset:0 sc1 lds
 v_mfma_f32_16x16x32_bf16 v[148:151], a[116:119], v[56:59], v[148:151]
 v_permlane32_swap_b32 v26, v27
 v_max_f32 v26, v26, v27
 v_mfma_f32_16x16x32_bf16 v[152:155], a[120:123], v[56:59], 0
 v_sub_f32 v44, 0xc2cc0000, v26
 v_sub_f32 v45, 0xc2cc0000, v26
 v_mfma_f32_16x16x32_bf16 v[152:155], a[168:171], v[60:63], v[152:155]
 buffer_load_dwordx4 v13, s[32:35], s78 offen offset:1024 sc1 lds
 v_mfma_f32_16x16x32_bf16 v[156:159], a[172:175], v[60:63], 0
 v_sub_f32 v46, 0xc2cc0000, v26
 v_sub_f32 v47, 0xc2cc0000, v26
 v_mfma_f32_16x16x32_bf16 v[156:159], a[124:127], v[56:59], v[156:159]
 v_add_f32 v64, v64, v44
 v_add_f32 v65, v65, v44
 v_mfma_f32_16x16x32_bf16 a[180:183], v[22:25], v[56:59], 0
 buffer_load_dwordx4 v13, s[32:35], s78 offen offset:2048 sc1 lds
 v_mfma_f32_16x16x32_bf16 a[180:183], v[22:25], v[60:63], a[180:183]
 v_add_f32 v66, v66, v44
 v_add_f32 v67, v67, v44
 v_mfma_f32_16x16x32_bf16 v[80:83], a[16:19], a[128:131], 0
 ds_read_b128 a[16:19], v14 offset:16384
 v_add_f32 v68, v68, v44
 v_mfma_f32_16x16x32_bf16 v[80:83], a[20:23], a[132:135], v[80:83]
 ds_read_b128 a[20:23], v14 offset:17408
 v_add_f32 v69, v69, v44
 v_mfma_f32_16x16x32_bf16 v[80:83], a[24:27], a[136:139], v[80:83]
 ds_read_b128 a[24:27], v14 offset:18432
 v_add_f32 v70, v70, v44
 v_mfma_f32_16x16x32_bf16 v[80:83], a[28:31], a[140:143], v[80:83]
 v_add_f32 v71, v71, v44
 v_add_f32 v72, v72, v44
 v_mfma_f32_16x16x32_bf16 v[84:87], a[44:47], a[140:143], 0
 buffer_load_dwordx4 v13, s[32:35], s78 offen offset:3072 sc1 lds
 v_mfma_f32_16x16x32_bf16 v[84:87], a[40:43], a[136:139], v[84:87]
 ds_read_b128 a[28:31], v14 offset:19456
 v_add_f32 v73, v73, v44
 v_mfma_f32_16x16x32_bf16 v[84:87], a[36:39], a[132:135], v[84:87]
 ds_read_b128 a[44:47], v14 offset:23552
 v_add_f32 v74, v74, v44
 v_mfma_f32_16x16x32_bf16 v[84:87], a[32:35], a[128:131], v[84:87]
 s_add_u32 m0, s77, 16384
 v_add_f32 v75, v75, v44
 v_add_f32 v76, v76, v44
 v_mfma_f32_16x16x32_bf16 v[88:91], a[48:51], a[128:131], 0
 ds_read_b128 a[40:43], v14 offset:22528
 v_add_f32 v77, v77, v44
 v_mfma_f32_16x16x32_bf16 v[88:91], a[52:55], a[132:135], v[88:91]
 ds_read_b128 a[36:39], v14 offset:21504
 v_add_f32 v78, v78, v44
 v_mfma_f32_16x16x32_bf16 v[88:91], a[56:59], a[136:139], v[88:91]
 ds_read_b128 a[32:35], v14 offset:20480
 v_add_f32 v79, v79, v44
 v_mfma_f32_16x16x32_bf16 v[88:91], a[60:63], a[140:143], v[88:91]
 s_add_u32 s78, s78, 16384
 v_exp_f32 v16, v64
 v_mfma_f32_16x16x32_bf16 v[92:95], a[92:95], a[140:143], 0
 ds_read_b128 a[48:51], v14 offset:24576
 v_exp_f32 v17, v65
 v_mfma_f32_16x16x32_bf16 v[92:95], a[88:91], a[136:139], v[92:95]
 v_exp_f32 v18, v66
 v_mfma_f32_16x16x32_bf16 v[92:95], a[84:87], a[132:135], v[92:95]
 v_cvt_pk_bf16_f32 v48, v16, v17
 v_exp_f32 v19, v67
 v_exp_f32 v16, v68
 v_cvt_pk_bf16_f32 v49, v18, v19
 v_exp_f32 v17, v69
 v_exp_f32 v18, v70
 v_cvt_pk_bf16_f32 v50, v16, v17
 v_exp_f32 v19, v71
 v_exp_f32 v16, v72
 v_cvt_pk_bf16_f32 v51, v18, v19
 v_exp_f32 v17, v73
 v_exp_f32 v18, v74
 v_cvt_pk_bf16_f32 v52, v16, v17
 v_exp_f32 v19, v75
 v_exp_f32 v16, v76
 v_cvt_pk_bf16_f32 v53, v18, v19
 v_exp_f32 v17, v77
 v_exp_f32 v18, v78
 v_cvt_pk_bf16_f32 v54, v16, v17
 v_exp_f32 v19, v79
 s_nop 0
 v_cvt_pk_bf16_f32 v55, v18, v19
 v_mfma_f32_16x16x32_bf16 v[92:95], a[80:83], a[128:131], v[92:95]
 buffer_load_dwordx4 v13, s[12:15], s78 offen offset:0 sc1 lds
 v_mfma_f32_16x16x32_bf16 v[192:195], a[96:99], v[48:51], 0
 buffer_load_dwordx4 v13, s[12:15], s78 offen offset:1024 sc1 lds
 v_mfma_f32_16x16x32_bf16 v[192:195], a[144:147], v[52:55], v[192:195]
 buffer_load_dwordx4 v13, s[12:15], s78 offen offset:2048 sc1 lds
 v_mfma_f32_16x16x32_bf16 v[196:199], a[148:151], v[52:55], 0
 ds_read_b128 a[52:55], v14 offset:25600
 v_mfma_f32_16x16x32_bf16 v[196:199], a[100:103], v[48:51], v[196:199]
 ds_read_b128 a[56:59], v14 offset:26624
 v_max3_f32 v26, v80, v81, v82
 v_mfma_f32_16x16x32_bf16 v[200:203], a[104:107], v[48:51], 0
 buffer_load_dwordx4 v13, s[12:15], s78 offen offset:3072 sc1 lds
 v_mfma_f32_16x16x32_bf16 v[200:203], a[152:155], v[52:55], v[200:203]
 ds_read_b128 a[60:63], v14 offset:27648
 v_max3_f32 v26, v26, v83, v84
 v_mfma_f32_16x16x32_bf16 v[204:207], a[156:159], v[52:55], 0
 s_add_u32 s79, s76, s58
 v_max3_f32 v26, v26, v85, v86
 v_max3_f32 v26, v26, v87, v88
 v_mfma_f32_16x16x32_bf16 v[204:207], a[108:111], v[48:51], v[204:207]
 s_add_u32 s76, s76, 32768
 v_max3_f32 v26, v26, v89, v90
 v_max3_f32 v26, v26, v91, v92
 v_mfma_f32_16x16x32_bf16 v[208:211], a[112:115], v[48:51], 0
 s_and_b32 s76, s76, 0x1ffff
 v_max3_f32 v26, v26, v93, v94
 v_max_f32 v26, v26, v95
 v_mfma_f32_16x16x32_bf16 v[208:211], a[160:163], v[52:55], v[208:211]
 ds_read_b128 a[92:95], v14 offset:31744
 v_mov_b32 v27, v26
 v_mfma_f32_16x16x32_bf16 v[212:215], a[164:167], v[52:55], 0
 ds_read_b128 a[88:91], v14 offset:30720
 v_permlane16_swap_b32 v26, v27
 v_mfma_f32_16x16x32_bf16 v[212:215], a[116:119], v[48:51], v[212:215]
 ds_read_b128 a[84:87], v14 offset:29696
 v_max_f32 v26, v26, v27
 v_mfma_f32_16x16x32_bf16 v[216:219], a[120:123], v[48:51], 0
 ds_read_b128 a[80:83], v14 offset:28672
 v_mov_b32 v27, v26
 v_mfma_f32_16x16x32_bf16 v[216:219], a[168:171], v[52:55], v[216:219]
 s_nop 0
 v_permlane32_swap_b32 v26, v27
 v_max_f32 v26, v26, v27
 v_sub_f32 v40, 0xc2cc0000, v26
 v_mfma_f32_16x16x32_bf16 v[220:223], a[172:175], v[52:55], 0
 v_sub_f32 v41, 0xc2cc0000, v26
 v_sub_f32 v42, 0xc2cc0000, v26
 v_sub_f32 v43, 0xc2cc0000, v26
 v_mfma_f32_16x16x32_bf16 v[220:223], a[124:127], v[48:51], v[220:223]
 v_add_f32 v80, v80, v40
 v_add_f32 v81, v81, v40
 v_add_f32 v82, v82, v40
 v_mfma_f32_16x16x32_bf16 a[188:191], v[22:25], v[48:51], 0
 v_add_f32 v83, v83, v40
 v_add_f32 v84, v84, v40
 v_add_f32 v85, v85, v40
 v_mfma_f32_16x16x32_bf16 a[188:191], v[22:25], v[52:55], a[188:191]
 s_mov_b32 s77, s79
 v_add_u32 v14, s76, v12
 v_add_f32 v86, v86, v40
 v_add_f32 v87, v87, v40
 v_add_f32 v88, v88, v40
 v_add_f32 v89, v89, v40
 v_add_f32 v90, v90, v40
 v_add_f32 v91, v91, v40
 v_add_f32 v92, v92, v40
 v_add_f32 v93, v93, v40
 v_add_f32 v94, v94, v40
 v_add_f32 v95, v95, v40
 v_exp_f32 v16, v80
 v_exp_f32 v17, v81
 v_exp_f32 v18, v82
 v_cvt_pk_bf16_f32 v56, v16, v17
 v_exp_f32 v19, v83
 v_exp_f32 v16, v84
 v_cvt_pk_bf16_f32 v57, v18, v19
 v_exp_f32 v17, v85
 v_exp_f32 v18, v86
 v_cvt_pk_bf16_f32 v58, v16, v17
 v_or3_b32 v21, v56, v57, v58
 v_exp_f32 v19, v87
 v_exp_f32 v16, v88
 v_cvt_pk_bf16_f32 v59, v18, v19
 v_exp_f32 v17, v89
 v_exp_f32 v18, v90
 v_cvt_pk_bf16_f32 v60, v16, v17
 v_or3_b32 v21, v21, v59, v60
 v_exp_f32 v19, v91
 v_exp_f32 v16, v92
 v_cvt_pk_bf16_f32 v61, v18, v19
 v_exp_f32 v17, v93
 s_lshl_b32 s69, s71, 1
 s_sub_u32 s69, s69, 1
 s_cmp_eq_u32 s69, 0
 s_cbranch_scc1 L_le_24
L_lp_23:
 s_waitcnt lgkmcnt(4)
 v_mfma_f32_16x16x32_bf16 v[64:67], a[16:19], a[0:3], v[32:35]
 v_exp_f32 v18, v94
 v_mfma_f32_16x16x32_bf16 v[64:67], a[20:23], a[4:7], v[64:67]
 v_cvt_pk_bf16_f32 v62, v16, v17
 v_or3_b32 v21, v21, v61, v62
 v_mfma_f32_16x16x32_bf16 v[64:67], a[24:27], a[8:11], v[64:67]
 v_exp_f32 v19, v95
 v_mfma_f32_16x16x32_bf16 v[64:67], a[28:31], a[12:15], v[64:67]
 v_cvt_pk_bf16_f32 v63, v18, v19
 v_or_b32 v21, v21, v63
 v_mfma_f32_16x16x32_bf16 v[68:71], a[44:47], a[12:15], v[32:35]
 v_and_b32 v21, s64, v21
 v_mfma_f32_16x16x32_bf16 v[68:71], a[40:43], a[8:11], v[68:71]
 v_mfma_f32_16x16x32_bf16 v[68:71], a[36:39], a[4:7], v[68:71]
 v_mfma_f32_16x16x32_bf16 v[68:71], a[32:35], a[0:3], v[68:71]
 v_cmp_ne_u32 vcc, 0, v21
 v_mfma_f32_16x16x32_bf16 v[72:75], a[48:51], a[0:3], v[32:35]
 v_exp_f32 v16, v64
 v_mfma_f32_16x16x32_bf16 v[72:75], a[52:55], a[4:7], v[72:75]
 s_cbranch_vccnz L_so_25
L_sb_26:
 v_exp_f32 v17, v65
 v_mfma_f32_16x16x32_bf16 v[72:75], a[56:59], a[8:11], v[72:75]
 v_exp_f32 v18, v66
 v_mfma_f32_16x16x32_bf16 v[72:75], a[60:63], a[12:15], v[72:75]
 s_waitcnt lgkmcnt(0)
 v_cvt_pk_bf16_f32 v48, v16, v17
 v_mfma_f32_16x16x32_bf16 v[76:79], a[92:95], a[12:15], v[32:35]
 v_exp_f32 v19, v67
 v_mfma_f32_16x16x32_bf16 v[76:79], a[88:91], a[8:11], v[76:79]
 v_exp_f32 v16, v68
 v_mfma_f32_16x16x32_bf16 v[76:79], a[84:87], a[4:7], v[76:79]
 v_cvt_pk_bf16_f32 v49, v18, v19
 v_exp_f32 v17, v69
 v_mfma_f32_16x16x32_bf16 v[76:79], a[80:83], a[0:3], v[76:79]
 s_waitcnt vmcnt(16)
 s_barrier
 s_sub_u32 s68, s68, 1
 s_cbranch_scc1 L_fo_33
L_fb_34:
 v_mfma_f32_16x16x32_bf16 v[160:163], a[96:99], v[56:59], v[160:163]
 v_exp_f32 v18, v70
 v_mfma_f32_16x16x32_bf16 v[160:163], a[144:147], v[60:63], v[160:163]
 ds_read_b128 a[96:99], v14 offset:0
 v_cvt_pk_bf16_f32 v50, v16, v17
 v_mfma_f32_16x16x32_bf16 v[164:167], a[148:151], v[60:63], v[164:167]
 ds_read_b128 a[144:147], v14 offset:8192
 v_or3_b32 v20, v48, v49, v50
 v_mfma_f32_16x16x32_bf16 v[164:167], a[100:103], v[56:59], v[164:167]
 v_exp_f32 v19, v71
 v_mfma_f32_16x16x32_bf16 v[168:171], a[104:107], v[56:59], v[168:171]
 s_mov_b32 m0, s77
 v_exp_f32 v16, v72
 v_mfma_f32_16x16x32_bf16 v[168:171], a[152:155], v[60:63], v[168:171]
 buffer_load_dwordx4 v13, s[32:35], s78 offen offset:0 sc1 lds
 v_mfma_f32_16x16x32_bf16 v[172:175], a[156:159], v[60:63], v[172:175]
 ds_read_b128 a[148:151], v14 offset:9216
 v_cvt_pk_bf16_f32 v51, v18, v19
 v_mfma_f32_16x16x32_bf16 v[172:175], a[108:111], v[56:59], v[172:175]
 v_exp_f32 v17, v73
 v_mfma_f32_16x16x32_bf16 v[176:179], a[112:115], v[56:59], v[176:179]
 v_exp_f32 v18, v74
 v_mfma_f32_16x16x32_bf16 v[176:179], a[160:163], v[60:63], v[176:179]
 ds_read_b128 a[100:103], v14 offset:1024
 v_cvt_pk_bf16_f32 v52, v16, v17
 v_mfma_f32_16x16x32_bf16 v[180:183], a[164:167], v[60:63], v[180:183]
 ds_read_b128 a[104:107], v14 offset:2048
 v_or3_b32 v20, v20, v51, v52
 v_mfma_f32_16x16x32_bf16 v[180:183], a[116:119], v[56:59], v[180:183]
 v_exp_f32 v19, v75
 v_mfma_f32_16x16x32_bf16 v[184:187], a[120:123], v[56:59], v[184:187]
 v_exp_f32 v16, v76
 v_mfma_f32_16x16x32_bf16 v[184:187], a[168:171], v[60:63], v[184:187]
 ds_read_b128 a[152:155], v14 offset:10240
 v_cvt_pk_bf16_f32 v53, v18, v19
 v_mfma_f32_16x16x32_bf16 v[188:191], a[172:175], v[60:63], v[188:191]
 v_exp_f32 v17, v77
 v_mfma_f32_16x16x32_bf16 v[188:191], a[124:127], v[56:59], v[188:191]
 buffer_load_dwordx4 v13, s[32:35], s78 offen offset:1024 sc1 lds
 v_mfma_f32_16x16x32_bf16 a[184:187], v[22:25], v[56:59], a[184:187]
 v_exp_f32 v18, v78
 v_mfma_f32_16x16x32_bf16 a[184:187], v[22:25], v[60:63], a[184:187]
 ds_read_b128 a[156:159], v14 offset:11264
 v_cvt_pk_bf16_f32 v54, v16, v17
 v_mfma_f32_16x16x32_bf16 v[80:83], a[16:19], a[64:67], v[36:39]
 ds_read_b128 a[108:111], v14 offset:3072
 v_or3_b32 v20, v20, v53, v54
 v_mfma_f32_16x16x32_bf16 v[80:83], a[20:23], a[68:71], v[80:83]
 v_exp_f32 v19, v79
 v_mfma_f32_16x16x32_bf16 v[80:83], a[24:27], a[72:75], v[80:83]
 ds_read_b128 a[112:115], v14 offset:4096
 v_cvt_pk_bf16_f32 v55, v18, v19
 v_mfma_f32_16x16x32_bf16 v[80:83], a[28:31], a[76:79], v[80:83]
 ds_read_b128 a[160:163], v14 offset:12288
 v_or_b32 v20, v20, v55
 v_mfma_f32_16x16x32_bf16 v[84:87], a[44:47], a[76:79], v[36:39]
 ds_read_b128 a[164:167], v14 offset:13312
 v_and_b32 v20, s64, v20
 v_mfma_f32_16x16x32_bf16 v[84:87], a[40:43], a[72:75], v[84:87]
 ds_read_b128 a[116:119], v14 offset:5120
 v_mfma_f32_16x16x32_bf16 v[84:87], a[36:39], a[68:71], v[84:87]
 ds_read_b128 a[120:123], v14 offset:6144
 v_mfma_f32_16x16x32_bf16 v[84:87], a[32:35], a[64:67], v[84:87]
 ds_read_b128 a[168:171], v14 offset:14336
 v_cmp_ne_u32 vcc, 0, v20
 v_mfma_f32_16x16x32_bf16 v[88:91], a[48:51], a[64:67], v[36:39]
 buffer_load_dwordx4 v13, s[32:35], s78 offen offset:2048 sc1 lds
 v_mfma_f32_16x16x32_bf16 v[88:91], a[52:55], a[68:71], v[88:91]
 v_exp_f32 v16, v80
 v_mfma_f32_16x16x32_bf16 v[88:91], a[56:59], a[72:75], v[88:91]
 ds_read_b128 a[172:175], v14 offset:15360
 v_mfma_f32_16x16x32_bf16 v[88:91], a[60:63], a[76:79], v[88:91]
 s_cbranch_vccnz L_so_27
L_sb_28:
 v_mfma_f32_16x16x32_bf16 v[92:95], a[92:95], a[76:79], v[36:39]
 ds_read_b128 a[124:127], v14 offset:7168
 v_mfma_f32_16x16x32_bf16 v[92:95], a[88:91], a[72:75], v[92:95]
 v_exp_f32 v17, v81
 v_mfma_f32_16x16x32_bf16 v[92:95], a[84:87], a[68:71], v[92:95]
 v_exp_f32 v18, v82
 v_mfma_f32_16x16x32_bf16 v[92:95], a[80:83], a[64:67], v[92:95]
 s_waitcnt lgkmcnt(4)
 v_cvt_pk_bf16_f32 v56, v16, v17
 v_mfma_f32_16x16x32_bf16 v[96:99], a[96:99], v[48:51], v[96:99]
 v_exp_f32 v19, v83
 v_mfma_f32_16x16x32_bf16 v[96:99], a[144:147], v[52:55], v[96:99]
 v_exp_f32 v16, v84
 v_mfma_f32_16x16x32_bf16 v[100:103], a[148:151], v[52:55], v[100:103]
 buffer_load_dwordx4 v13, s[32:35], s78 offen offset:3072 sc1 lds
 v_mfma_f32_16x16x32_bf16 v[100:103], a[100:103], v[48:51], v[100:103]
 v_cvt_pk_bf16_f32 v57, v18, v19
 v_mfma_f32_16x16x32_bf16 v[104:107], a[104:107], v[48:51], v[104:107]
 v_exp_f32 v17, v85
 v_mfma_f32_16x16x32_bf16 v[104:107], a[152:155], v[52:55], v[104:107]
 v_exp_f32 v18, v86
 v_mfma_f32_16x16x32_bf16 v[108:111], a[156:159], v[52:55], v[108:111]
 v_cvt_pk_bf16_f32 v58, v16, v17
 v_or3_b32 v21, v56, v57, v58
 v_mfma_f32_16x16x32_bf16 v[108:111], a[108:111], v[48:51], v[108:111]
 v_exp_f32 v19, v87
 v_mfma_f32_16x16x32_bf16 v[112:115], a[112:115], v[48:51], v[112:115]
 v_exp_f32 v16, v88
 v_mfma_f32_16x16x32_bf16 v[112:115], a[160:163], v[52:55], v[112:115]
 v_cvt_pk_bf16_f32 v59, v18, v19
 v_mfma_f32_16x16x32_bf16 v[116:119], a[164:167], v[52:55], v[116:119]
 v_exp_f32 v17, v89
 v_mfma_f32_16x16x32_bf16 v[116:119], a[116:119], v[48:51], v[116:119]
 s_waitcnt lgkmcnt(0)
 v_exp_f32 v18, v90
 v_mfma_f32_16x16x32_bf16 v[120:123], a[120:123], v[48:51], v[120:123]
 v_cvt_pk_bf16_f32 v60, v16, v17
 v_or3_b32 v21, v21, v59, v60
 v_mfma_f32_16x16x32_bf16 v[120:123], a[168:171], v[52:55], v[120:123]
 v_exp_f32 v19, v91
 v_mfma_f32_16x16x32_bf16 v[124:127], a[172:175], v[52:55], v[124:127]
 v_exp_f32 v16, v92
 v_mfma_f32_16x16x32_bf16 v[124:127], a[124:127], v[48:51], v[124:127]
 v_cvt_pk_bf16_f32 v61, v18, v19
 v_mfma_f32_16x16x32_bf16 a[176:179], v[22:25], v[48:51], a[176:179]
 v_exp_f32 v17, v93
 v_mfma_f32_16x16x32_bf16 a[176:179], v[22:25], v[52:55], a[176:179]
 v_exp_f32 v18, v94
 v_mfma_f32_16x16x32_bf16 v[64:67], a[16:19], a[192:195], v[44:47]
 v_cvt_pk_bf16_f32 v62, v16, v17
 v_or3_b32 v21, v21, v61, v62
 v_mfma_f32_16x16x32_bf16 v[64:67], a[20:23], a[196:199], v[64:67]
 v_exp_f32 v19, v95
 v_mfma_f32_16x16x32_bf16 v[64:67], a[24:27], a[200:203], v[64:67]
 v_cvt_pk_bf16_f32 v63, v18, v19
 v_or_b32 v21, v21, v63
 v_mfma_f32_16x16x32_bf16 v[64:67], a[28:31], a[204:207], v[64:67]
 v_mfma_f32_16x16x32_bf16 v[68:71], a[44:47], a[204:207], v[44:47]
 v_mfma_f32_16x16x32_bf16 v[68:71], a[40:43], a[200:203], v[68:71]
 v_mfma_f32_16x16x32_bf16 v[68:71], a[36:39], a[196:199], v[68:71]
 v_mfma_f32_16x16x32_bf16 v[68:71], a[32:35], a[192:195], v[68:71]
 v_and_b32 v21, s64, v21
 v_cmp_ne_u32 vcc, 0, v21
 v_mfma_f32_16x16x32_bf16 v[72:75], a[48:51], a[192:195], v[44:47]
 s_nop 0
 v_exp_f32 v16, v64
 v_mfma_f32_16x16x32_bf16 v[72:75], a[52:55], a[196:199], v[72:75]
 v_exp_f32 v17, v65
 v_mfma_f32_16x16x32_bf16 v[72:75], a[56:59], a[200:203], v[72:75]
 v_exp_f32 v18, v66
 v_mfma_f32_16x16x32_bf16 v[72:75], a[60:63], a[204:207], v[72:75]
 s_cbranch_vccnz L_so_29
L_sb_30:
 v_cvt_pk_bf16_f32 v48, v16, v17
 v_mfma_f32_16x16x32_bf16 v[76:79], a[92:95], a[204:207], v[44:47]
 v_exp_f32 v19, v67
 v_mfma_f32_16x16x32_bf16 v[76:79], a[88:91], a[200:203], v[76:79]
 v_exp_f32 v16, v68
 v_mfma_f32_16x16x32_bf16 v[76:79], a[84:87], a[196:199], v[76:79]
 v_cvt_pk_bf16_f32 v49, v18, v19
 v_mfma_f32_16x16x32_bf16 v[76:79], a[80:83], a[192:195], v[76:79]
 v_exp_f32 v17, v69
 v_mfma_f32_16x16x32_bf16 v[128:131], a[96:99], v[56:59], v[128:131]
 v_exp_f32 v18, v70
 v_mfma_f32_16x16x32_bf16 v[128:131], a[144:147], v[60:63], v[128:131]
 v_cvt_pk_bf16_f32 v50, v16, v17
 v_or3_b32 v20, v48, v49, v50
 v_mfma_f32_16x16x32_bf16 v[132:135], a[148:151], v[60:63], v[132:135]
 v_exp_f32 v19, v71
 v_mfma_f32_16x16x32_bf16 v[132:135], a[100:103], v[56:59], v[132:135]
 v_exp_f32 v16, v72
 v_mfma_f32_16x16x32_bf16 v[136:139], a[104:107], v[56:59], v[136:139]
 v_cvt_pk_bf16_f32 v51, v18, v19
 v_mfma_f32_16x16x32_bf16 v[136:139], a[152:155], v[60:63], v[136:139]
 v_exp_f32 v17, v73
 v_mfma_f32_16x16x32_bf16 v[140:143], a[156:159], v[60:63], v[140:143]
 v_exp_f32 v18, v74
 v_mfma_f32_16x16x32_bf16 v[140:143], a[108:111], v[56:59], v[140:143]
 v_cvt_pk_bf16_f32 v52, v16, v17
 v_or3_b32 v20, v20, v51, v52
 v_mfma_f32_16x16x32_bf16 v[144:147], a[112:115], v[56:59], v[144:147]
 s_add_u32 m0, s77, 16384
 v_exp_f32 v19, v75
 v_mfma_f32_16x16x32_bf16 v[144:147], a[160:163], v[60:63], v[144:147]
 s_add_u32 s78, s78, 16384
 v_exp_f32 v16, v76
 v_mfma_f32_16x16x32_bf16 v[148:151], a[164:167], v[60:63], v[148:151]
 buffer_load_dwordx4 v13, s[12:15], s78 offen offset:0 sc1 lds
 v_mfma_f32_16x16x32_bf16 v[148:151], a[116:119], v[56:59], v[148:151]
 buffer_load_dwordx4 v13, s[12:15], s78 offen offset:1024 sc1 lds
 v_mfma_f32_16x16x32_bf16 v[152:155], a[120:123], v[56:59], v[152:155]
 v_cvt_pk_bf16_f32 v53, v18, v19
 v_mfma_f32_16x16x32_bf16 v[152:155], a[168:171], v[60:63], v[152:155]
 v_exp_f32 v17, v77
 v_mfma_f32_16x16x32_bf16 v[156:159], a[172:175], v[60:63], v[156:159]
 v_exp_f32 v18, v78
 v_mfma_f32_16x16x32_bf16 v[156:159], a[124:127], v[56:59], v[156:159]
 v_cvt_pk_bf16_f32 v54, v16, v17
 v_or3_b32 v20, v20, v53, v54
 v_mfma_f32_16x16x32_bf16 a[180:183], v[22:25], v[56:59], a[180:183]
 v_exp_f32 v19, v79
 v_mfma_f32_16x16x32_bf16 a[180:183], v[22:25], v[60:63], a[180:183]
 v_cvt_pk_bf16_f32 v55, v18, v19
 v_or_b32 v20, v20, v55
 v_mfma_f32_16x16x32_bf16 v[80:83], a[16:19], a[128:131], v[40:43]
 ds_read_b128 a[16:19], v14 offset:16384
 v_and_b32 v20, s64, v20
 v_mfma_f32_16x16x32_bf16 v[80:83], a[20:23], a[132:135], v[80:83]
 ds_read_b128 a[20:23], v14 offset:17408
 v_mfma_f32_16x16x32_bf16 v[80:83], a[24:27], a[136:139], v[80:83]
 ds_read_b128 a[24:27], v14 offset:18432
 v_mfma_f32_16x16x32_bf16 v[80:83], a[28:31], a[140:143], v[80:83]
 buffer_load_dwordx4 v13, s[12:15], s78 offen offset:2048 sc1 lds
 v_mfma_f32_16x16x32_bf16 v[84:87], a[44:47], a[140:143], v[40:43]
 ds_read_b128 a[28:31], v14 offset:19456
 v_mfma_f32_16x16x32_bf16 v[84:87], a[40:43], a[136:139], v[84:87]
 ds_read_b128 a[44:47], v14 offset:23552
 v_mfma_f32_16x16x32_bf16 v[84:87], a[36:39], a[132:135], v[84:87]
 ds_read_b128 a[40:43], v14 offset:22528
 v_mfma_f32_16x16x32_bf16 v[84:87], a[32:35], a[128:131], v[84:87]
 v_cmp_ne_u32 vcc, 0, v20
 v_mfma_f32_16x16x32_bf16 v[88:91], a[48:51], a[128:131], v[40:43]
 v_exp_f32 v16, v80
 v_mfma_f32_16x16x32_bf16 v[88:91], a[52:55], a[132:135], v[88:91]
 s_cbranch_vccnz L_so_31
L_sb_32:
 v_exp_f32 v17, v81
 v_mfma_f32_16x16x32_bf16 v[88:91], a[56:59], a[136:139], v[88:91]
 v_exp_f32 v18, v82
 v_mfma_f32_16x16x32_bf16 v[88:91], a[60:63], a[140:143], v[88:91]
 ds_read_b128 a[36:39], v14 offset:21504
 v_cvt_pk_bf16_f32 v56, v16, v17
 v_mfma_f32_16x16x32_bf16 v[92:95], a[92:95], a[140:143], v[40:43]
 v_exp_f32 v19, v83
 v_mfma_f32_16x16x32_bf16 v[92:95], a[88:91], a[136:139], v[92:95]
 buffer_load_dwordx4 v13, s[12:15], s78 offen offset:3072 sc1 lds
 v_mfma_f32_16x16x32_bf16 v[92:95], a[84:87], a[132:135], v[92:95]
 v_exp_f32 v16, v84
 v_mfma_f32_16x16x32_bf16 v[92:95], a[80:83], a[128:131], v[92:95]
 ds_read_b128 a[32:35], v14 offset:20480
 v_cvt_pk_bf16_f32 v57, v18, v19
 v_mfma_f32_16x16x32_bf16 v[192:195], a[96:99], v[48:51], v[192:195]
 v_exp_f32 v17, v85
 v_mfma_f32_16x16x32_bf16 v[192:195], a[144:147], v[52:55], v[192:195]
 v_exp_f32 v18, v86
 v_mfma_f32_16x16x32_bf16 v[196:199], a[148:151], v[52:55], v[196:199]
 ds_read_b128 a[48:51], v14 offset:24576
 v_cvt_pk_bf16_f32 v58, v16, v17
 v_mfma_f32_16x16x32_bf16 v[196:199], a[100:103], v[48:51], v[196:199]
 ds_read_b128 a[52:55], v14 offset:25600
 v_or3_b32 v21, v56, v57, v58
 v_mfma_f32_16x16x32_bf16 v[200:203], a[104:107], v[48:51], v[200:203]
 v_exp_f32 v19, v87
 v_mfma_f32_16x16x32_bf16 v[200:203], a[152:155], v[52:55], v[200:203]
 v_exp_f32 v16, v88
 v_mfma_f32_16x16x32_bf16 v[204:207], a[156:159], v[52:55], v[204:207]
 ds_read_b128 a[56:59], v14 offset:26624
 v_cvt_pk_bf16_f32 v59, v18, v19
 v_mfma_f32_16x16x32_bf16 v[204:207], a[108:111], v[48:51], v[204:207]
 s_add_u32 s79, s76, s58
 v_exp_f32 v17, v89
 v_mfma_f32_16x16x32_bf16 v[208:211], a[112:115], v[48:51], v[208:211]
 s_add_u32 s76, s76, 32768
 v_exp_f32 v18, v90
 v_mfma_f32_16x16x32_bf16 v[208:211], a[160:163], v[52:55], v[208:211]
 ds_read_b128 a[60:63], v14 offset:27648
 v_cvt_pk_bf16_f32 v60, v16, v17
 v_mfma_f32_16x16x32_bf16 v[212:215], a[164:167], v[52:55], v[212:215]
 ds_read_b128 a[92:95], v14 offset:31744
 v_or3_b32 v21, v21, v59, v60
 v_mfma_f32_16x16x32_bf16 v[212:215], a[116:119], v[48:51], v[212:215]
 s_and_b32 s76, s76, 0x1ffff
 v_exp_f32 v19, v91
 v_mfma_f32_16x16x32_bf16 v[216:219], a[120:123], v[48:51], v[216:219]
 v_exp_f32 v16, v92
 v_mfma_f32_16x16x32_bf16 v[216:219], a[168:171], v[52:55], v[216:219]
 ds_read_b128 a[88:91], v14 offset:30720
 v_cvt_pk_bf16_f32 v61, v18, v19
 v_mfma_f32_16x16x32_bf16 v[220:223], a[172:175], v[52:55], v[220:223]
 v_exp_f32 v17, v93
 v_mfma_f32_16x16x32_bf16 v[220:223], a[124:127], v[48:51], v[220:223]
 ds_read_b128 a[84:87], v14 offset:29696
 v_mfma_f32_16x16x32_bf16 a[188:191], v[22:25], v[48:51], a[188:191]
 ds_read_b128 a[80:83], v14 offset:28672
 v_mfma_f32_16x16x32_bf16 a[188:191], v[22:25], v[52:55], a[188:191]
 s_mov_b32 s77, s79
 v_add_u32 v14, s76, v12
 s_sub_u32 s69, s69, 1
 s_cmp_lg_u32 s69, 0
 s_cbranch_scc1 L_lp_23
L_le_24:
L_w0_35:
 s_cmp_eq_u32 s3, 0
 s_cbranch_scc0 L_w1_36
 s_waitcnt lgkmcnt(5)
 v_mov_b32 v3, 4048155338
 v_cndmask_b32 v28, v3, v32, s[80:81]
 v_cndmask_b32 v29, v3, v33, s[82:83]
 v_cndmask_b32 v30, v3, v34, s[84:85]
 v_cndmask_b32 v31, v3, v35, s[86:87]
 s_nop 1
 v_mfma_f32_16x16x32_bf16 v[64:67], a[16:19], a[0:3], v[28:31]
 v_exp_f32 v18, v94
 v_mfma_f32_16x16x32_bf16 v[64:67], a[20:23], a[4:7], v[64:67]
 v_cvt_pk_bf16_f32 v62, v16, v17
 v_or3_b32 v21, v21, v61, v62
 v_exp_f32 v19, v95
 s_nop 0
 v_cvt_pk_bf16_f32 v63, v18, v19
 v_or_b32 v21, v21, v63
 v_and_b32 v21, s64, v21
 v_mfma_f32_16x16x32_bf16 v[64:67], a[24:27], a[8:11], v[64:67]
 v_cmp_ne_u32 vcc, 0, v21
 v_mfma_f32_16x16x32_bf16 v[64:67], a[28:31], a[12:15], v[64:67]
 s_cbranch_vccnz L_so_40
L_sb_41:
 s_waitcnt lgkmcnt(0)
 s_waitcnt vmcnt(16)
 s_barrier
 s_sub_u32 s68, s68, 1
 s_cbranch_scc1 L_fo_48
L_fb_49:
 v_mfma_f32_16x16x32_bf16 v[160:163], a[96:99], v[56:59], v[160:163]
 s_mov_b32 m0, s77
 v_mov_b32 v68, 4048155338
 v_mov_b32 v69, 4048155338
 v_mfma_f32_16x16x32_bf16 v[160:163], a[144:147], v[60:63], v[160:163]
 ds_read_b128 a[96:99], v14 offset:0
 v_mov_b32 v70, 4048155338
 v_mfma_f32_16x16x32_bf16 v[164:167], a[148:151], v[60:63], v[164:167]
 ds_read_b128 a[144:147], v14 offset:8192
 v_mov_b32 v71, 4048155338
 v_mfma_f32_16x16x32_bf16 v[164:167], a[100:103], v[56:59], v[164:167]
 ds_read_b128 a[148:151], v14 offset:9216
 v_mov_b32 v72, 4048155338
 v_mfma_f32_16x16x32_bf16 v[168:171], a[104:107], v[56:59], v[168:171]
 buffer_load_dwordx4 v13, s[32:35], s78 offen offset:0 sc1 lds
 v_mfma_f32_16x16x32_bf16 v[168:171], a[152:155], v[60:63], v[168:171]
 ds_read_b128 a[100:103], v14 offset:1024
 v_mov_b32 v73, 4048155338
 v_mfma_f32_16x16x32_bf16 v[172:175], a[156:159], v[60:63], v[172:175]
 ds_read_b128 a[104:107], v14 offset:2048
 v_mov_b32 v74, 4048155338
 v_mfma_f32_16x16x32_bf16 v[172:175], a[108:111], v[56:59], v[172:175]
 ds_read_b128 a[152:155], v14 offset:10240
 v_mov_b32 v75, 4048155338
 v_mfma_f32_16x16x32_bf16 v[176:179], a[112:115], v[56:59], v[176:179]
 ds_read_b128 a[156:159], v14 offset:11264
 v_mov_b32 v76, 4048155338
 v_mfma_f32_16x16x32_bf16 v[176:179], a[160:163], v[60:63], v[176:179]
 ds_read_b128 a[108:111], v14 offset:3072
 v_mov_b32 v77, 4048155338
 v_mfma_f32_16x16x32_bf16 v[180:183], a[164:167], v[60:63], v[180:183]
 v_mov_b32 v78, 4048155338
 v_mfma_f32_16x16x32_bf16 v[180:183], a[116:119], v[56:59], v[180:183]
 ds_read_b128 a[112:115], v14 offset:4096
 v_mov_b32 v79, 4048155338
 v_mfma_f32_16x16x32_bf16 v[184:187], a[120:123], v[56:59], v[184:187]
 v_mov_b32 v50, 0
 v_mov_b32 v51, 0
 v_mfma_f32_16x16x32_bf16 v[184:187], a[168:171], v[60:63], v[184:187]
 v_exp_f32 v16, v64
 v_mfma_f32_16x16x32_bf16 v[188:191], a[172:175], v[60:63], v[188:191]
 buffer_load_dwordx4 v13, s[32:35], s78 offen offset:1024 sc1 lds
 v_mfma_f32_16x16x32_bf16 v[188:191], a[124:127], v[56:59], v[188:191]
 v_exp_f32 v17, v65
 v_mfma_f32_16x16x32_bf16 a[184:187], v[22:25], v[56:59], a[184:187]
 v_exp_f32 v18, v66
 v_mfma_f32_16x16x32_bf16 a[184:187], v[22:25], v[60:63], a[184:187]
 ds_read_b128 a[160:163], v14 offset:12288
 v_cvt_pk_bf16_f32 v48, v16, v17
 v_mfma_f32_16x16x32_bf16 v[80:83], a[16:19], a[64:67], v[36:39]
 ds_read_b128 a[164:167], v14 offset:13312
 v_mfma_f32_16x16x32_bf16 v[80:83], a[20:23], a[68:71], v[80:83]
 v_exp_f32 v19, v67
 v_mfma_f32_16x16x32_bf16 v[80:83], a[24:27], a[72:75], v[80:83]
 ds_read_b128 a[116:119], v14 offset:5120
 v_cvt_pk_bf16_f32 v49, v18, v19
 v_mfma_f32_16x16x32_bf16 v[80:83], a[28:31], a[76:79], v[80:83]
 ds_read_b128 a[120:123], v14 offset:6144
 v_or_b32 v20, v48, v49
 v_mfma_f32_16x16x32_bf16 v[84:87], a[44:47], a[76:79], v[36:39]
 ds_read_b128 a[168:171], v14 offset:14336
 v_and_b32 v20, s64, v20
 v_mfma_f32_16x16x32_bf16 v[84:87], a[40:43], a[72:75], v[84:87]
 buffer_load_dwordx4 v13, s[32:35], s78 offen offset:2048 sc1 lds
 v_mfma_f32_16x16x32_bf16 v[84:87], a[36:39], a[68:71], v[84:87]
 ds_read_b128 a[172:175], v14 offset:15360
 v_mfma_f32_16x16x32_bf16 v[84:87], a[32:35], a[64:67], v[84:87]
 ds_read_b128 a[124:127], v14 offset:7168
 v_cmp_ne_u32 vcc, 0, v20
 v_mfma_f32_16x16x32_bf16 v[88:91], a[48:51], a[64:67], v[36:39]
 v_exp_f32 v16, v80
 v_mfma_f32_16x16x32_bf16 v[88:91], a[52:55], a[68:71], v[88:91]
 v_exp_f32 v17, v81
 v_mfma_f32_16x16x32_bf16 v[88:91], a[56:59], a[72:75], v[88:91]
 v_exp_f32 v18, v82
 v_mfma_f32_16x16x32_bf16 v[88:91], a[60:63], a[76:79], v[88:91]
 s_cbranch_vccnz L_so_42
L_sb_43:
 v_cvt_pk_bf16_f32 v56, v16, v17
 v_mfma_f32_16x16x32_bf16 v[92:95], a[92:95], a[76:79], v[36:39]
 v_exp_f32 v19, v83
 v_mfma_f32_16x16x32_bf16 v[92:95], a[88:91], a[72:75], v[92:95]
 v_exp_f32 v16, v84
 v_mfma_f32_16x16x32_bf16 v[92:95], a[84:87], a[68:71], v[92:95]
 v_cvt_pk_bf16_f32 v57, v18, v19
 v_mfma_f32_16x16x32_bf16 v[92:95], a[80:83], a[64:67], v[92:95]
 s_waitcnt lgkmcnt(2)
 v_exp_f32 v17, v85
 v_mfma_f32_16x16x32_bf16 v[96:99], a[96:99], v[48:51], v[96:99]
 v_exp_f32 v18, v86
 v_mfma_f32_16x16x32_bf16 v[100:103], a[100:103], v[48:51], v[100:103]
 v_cvt_pk_bf16_f32 v58, v16, v17
 v_or3_b32 v21, v56, v57, v58
 v_mfma_f32_16x16x32_bf16 v[104:107], a[104:107], v[48:51], v[104:107]
 v_exp_f32 v19, v87
 v_mfma_f32_16x16x32_bf16 v[108:111], a[108:111], v[48:51], v[108:111]
 v_exp_f32 v16, v88
 v_mfma_f32_16x16x32_bf16 v[112:115], a[112:115], v[48:51], v[112:115]
 v_cvt_pk_bf16_f32 v59, v18, v19
 v_mfma_f32_16x16x32_bf16 v[116:119], a[116:119], v[48:51], v[116:119]
 v_exp_f32 v17, v89
 v_mfma_f32_16x16x32_bf16 v[120:123], a[120:123], v[48:51], v[120:123]
 s_waitcnt lgkmcnt(0)
 v_exp_f32 v18, v90
 v_mfma_f32_16x16x32_bf16 v[124:127], a[124:127], v[48:51], v[124:127]
 v_cvt_pk_bf16_f32 v60, v16, v17
 v_or3_b32 v21, v21, v59, v60
 v_mfma_f32_16x16x32_bf16 a[176:179], v[22:25], v[48:51], a[176:179]
 v_exp_f32 v19, v91
 v_mfma_f32_16x16x32_bf16 v[64:67], a[16:19], a[192:195], v[44:47]
 v_exp_f32 v16, v92
 v_mfma_f32_16x16x32_bf16 v[64:67], a[20:23], a[196:199], v[64:67]
 v_cvt_pk_bf16_f32 v61, v18, v19
 v_mfma_f32_16x16x32_bf16 v[64:67], a[24:27], a[200:203], v[64:67]
 v_exp_f32 v17, v93
 v_mfma_f32_16x16x32_bf16 v[64:67], a[28:31], a[204:207], v[64:67]
 v_exp_f32 v18, v94
 v_mfma_f32_16x16x32_bf16 v[68:71], a[44:47], a[204:207], v[44:47]
 v_cvt_pk_bf16_f32 v62, v16, v17
 v_or3_b32 v21, v21, v61, v62
 v_mfma_f32_16x16x32_bf16 v[68:71], a[40:43], a[200:203], v[68:71]
 v_exp_f32 v19, v95
 v_mfma_f32_16x16x32_bf16 v[68:71], a[36:39], a[196:199], v[68:71]
 v_cvt_pk_bf16_f32 v63, v18, v19
 v_or_b32 v21, v21, v63
 v_mfma_f32_16x16x32_bf16 v[68:71], a[32:35], a[192:195], v[68:71]
 v_and_b32 v21, s64, v21
 v_cmp_ne_u32 vcc, 0, v21
 v_mfma_f32_16x16x32_bf16 v[72:75], a[48:51], a[192:195], v[44:47]
 v_exp_f32 v16, v64
 v_mfma_f32_16x16x32_bf16 v[72:75], a[52:55], a[196:199], v[72:75]
 v_exp_f32 v17, v65
 v_mfma_f32_16x16x32_bf16 v[72:75], a[56:59], a[200:203], v[72:75]
 v_exp_f32 v18, v66
 v_mfma_f32_16x16x32_bf16 v[72:75], a[60:63], a[204:207], v[72:75]
 s_cbranch_vccnz L_so_44
L_sb_45:
 v_cvt_pk_bf16_f32 v48, v16, v17
 v_mfma_f32_16x16x32_bf16 v[76:79], a[92:95], a[204:207], v[44:47]
 buffer_load_dwordx4 v13, s[32:35], s78 offen offset:3072 sc1 lds
 v_mfma_f32_16x16x32_bf16 v[76:79], a[88:91], a[200:203], v[76:79]
 s_add_u32 m0, s77, 16384
 v_exp_f32 v19, v67
 v_mfma_f32_16x16x32_bf16 v[76:79], a[84:87], a[196:199], v[76:79]
 s_add_u32 s78, s78, 16384
 v_exp_f32 v16, v68
 v_mfma_f32_16x16x32_bf16 v[76:79], a[80:83], a[192:195], v[76:79]
 v_cvt_pk_bf16_f32 v49, v18, v19
 v_mfma_f32_16x16x32_bf16 v[128:131], a[96:99], v[56:59], v[128:131]
 v_exp_f32 v17, v69
 v_mfma_f32_16x16x32_bf16 v[128:131], a[144:147], v[60:63], v[128:131]
 v_exp_f32 v18, v70
 v_mfma_f32_16x16x32_bf16 v[132:135], a[148:151], v[60:63], v[132:135]
 v_cvt_pk_bf16_f32 v50, v16, v17
 v_or3_b32 v20, v48, v49, v50
 v_mfma_f32_16x16x32_bf16 v[132:135], a[100:103], v[56:59], v[132:135]
 buffer_load_dwordx4 v13, s[12:15], s78 offen offset:0 sc1 lds
 v_mfma_f32_16x16x32_bf16 v[136:139], a[104:107], v[56:59], v[136:139]
 v_exp_f32 v19, v71
 v_mfma_f32_16x16x32_bf16 v[136:139], a[152:155], v[60:63], v[136:139]
 v_exp_f32 v16, v72
 v_mfma_f32_16x16x32_bf16 v[140:143], a[156:159], v[60:63], v[140:143]
 v_cvt_pk_bf16_f32 v51, v18, v19
 v_mfma_f32_16x16x32_bf16 v[140:143], a[108:111], v[56:59], v[140:143]
 v_exp_f32 v17, v73
 v_mfma_f32_16x16x32_bf16 v[144:147], a[112:115], v[56:59], v[144:147]
 v_exp_f32 v18, v74
 v_mfma_f32_16x16x32_bf16 v[144:147], a[160:163], v[60:63], v[144:147]
 v_cvt_pk_bf16_f32 v52, v16, v17
 v_or3_b32 v20, v20, v51, v52
 v_mfma_f32_16x16x32_bf16 v[148:151], a[164:167], v[60:63], v[148:151]
 v_exp_f32 v19, v75
 v_mfma_f32_16x16x32_bf16 v[148:151], a[116:119], v[56:59], v[148:151]
 v_exp_f32 v16, v76
 v_mfma_f32_16x16x32_bf16 v[152:155], a[120:123], v[56:59], v[152:155]
 v_cvt_pk_bf16_f32 v53, v18, v19
 v_mfma_f32_16x16x32_bf16 v[152:155], a[168:171], v[60:63], v[152:155]
 buffer_load_dwordx4 v13, s[12:15], s78 offen offset:1024 sc1 lds
 v_mfma_f32_16x16x32_bf16 v[156:159], a[172:175], v[60:63], v[156:159]
 v_exp_f32 v17, v77
 v_mfma_f32_16x16x32_bf16 v[156:159], a[124:127], v[56:59], v[156:159]
 v_exp_f32 v18, v78
 v_mfma_f32_16x16x32_bf16 a[180:183], v[22:25], v[56:59], a[180:183]
 v_cvt_pk_bf16_f32 v54, v16, v17
 v_or3_b32 v20, v20, v53, v54
 v_mfma_f32_16x16x32_bf16 a[180:183], v[22:25], v[60:63], a[180:183]
 v_exp_f32 v19, v79
 v_mfma_f32_16x16x32_bf16 v[80:83], a[16:19], a[128:131], v[40:43]
 ds_read_b128 a[16:19], v14 offset:16384
 v_cvt_pk_bf16_f32 v55, v18, v19
 v_mfma_f32_16x16x32_bf16 v[80:83], a[20:23], a[132:135], v[80:83]
 ds_read_b128 a[20:23], v14 offset:17408
 v_or_b32 v20, v20, v55
 v_mfma_f32_16x16x32_bf16 v[80:83], a[24:27], a[136:139], v[80:83]
 ds_read_b128 a[24:27], v14 offset:18432
 v_mfma_f32_16x16x32_bf16 v[80:83], a[28:31], a[140:143], v[80:83]
 ds_read_b128 a[28:31], v14 offset:19456
 v_mfma_f32_16x16x32_bf16 v[84:87], a[44:47], a[140:143], v[40:43]
 buffer_load_dwordx4 v13, s[12:15], s78 offen offset:2048 sc1 lds
 v_mfma_f32_16x16x32_bf16 v[84:87], a[40:43], a[136:139], v[84:87]
 ds_read_b128 a[44:47], v14 offset:23552
 v_mfma_f32_16x16x32_bf16 v[84:87], a[36:39], a[132:135], v[84:87]
 ds_read_b128 a[40:43], v14 offset:22528
 v_mfma_f32_16x16x32_bf16 v[84:87], a[32:35], a[128:131], v[84:87]
 v_and_b32 v20, s64, v20
 v_cmp_ne_u32 vcc, 0, v20
 v_mfma_f32_16x16x32_bf16 v[88:91], a[48:51], a[128:131], v[40:43]
 v_exp_f32 v16, v80
 v_mfma_f32_16x16x32_bf16 v[88:91], a[52:55], a[132:135], v[88:91]
 s_cbranch_vccnz L_so_46
L_sb_47:
 v_exp_f32 v17, v81
 v_mfma_f32_16x16x32_bf16 v[88:91], a[56:59], a[136:139], v[88:91]
 v_exp_f32 v18, v82
 v_mfma_f32_16x16x32_bf16 v[88:91], a[60:63], a[140:143], v[88:91]
 ds_read_b128 a[36:39], v14 offset:21504
 v_cvt_pk_bf16_f32 v56, v16, v17
 v_mfma_f32_16x16x32_bf16 v[92:95], a[92:95], a[140:143], v[40:43]
 v_exp_f32 v19, v83
 v_mfma_f32_16x16x32_bf16 v[92:95], a[88:91], a[136:139], v[92:95]
 v_exp_f32 v16, v84
 v_mfma_f32_16x16x32_bf16 v[92:95], a[84:87], a[132:135], v[92:95]
 ds_read_b128 a[32:35], v14 offset:20480
 v_cvt_pk_bf16_f32 v57, v18, v19
 v_mfma_f32_16x16x32_bf16 v[92:95], a[80:83], a[128:131], v[92:95]
 v_exp_f32 v17, v85
 v_mfma_f32_16x16x32_bf16 v[192:195], a[96:99], v[48:51], v[192:195]
 buffer_load_dwordx4 v13, s[12:15], s78 offen offset:3072 sc1 lds
 v_mfma_f32_16x16x32_bf16 v[192:195], a[144:147], v[52:55], v[192:195]
 v_exp_f32 v18, v86
 v_mfma_f32_16x16x32_bf16 v[196:199], a[148:151], v[52:55], v[196:199]
 ds_read_b128 a[48:51], v14 offset:24576
 v_cvt_pk_bf16_f32 v58, v16, v17
 v_mfma_f32_16x16x32_bf16 v[196:199], a[100:103], v[48:51], v[196:199]
 ds_read_b128 a[52:55], v14 offset:25600
 v_or3_b32 v21, v56, v57, v58
 v_mfma_f32_16x16x32_bf16 v[200:203], a[104:107], v[48:51], v[200:203]
 v_exp_f32 v19, v87
 v_mfma_f32_16x16x32_bf16 v[200:203], a[152:155], v[52:55], v[200:203]
 v_exp_f32 v16, v88
 v_mfma_f32_16x16x32_bf16 v[204:207], a[156:159], v[52:55], v[204:207]
 ds_read_b128 a[56:59], v14 offset:26624
 v_cvt_pk_bf16_f32 v59, v18, v19
 v_mfma_f32_16x16x32_bf16 v[204:207], a[108:111], v[48:51], v[204:207]
 s_add_u32 s79, s76, s58
 v_exp_f32 v17, v89
 v_mfma_f32_16x16x32_bf16 v[208:211], a[112:115], v[48:51], v[208:211]
 s_add_u32 s76, s76, 32768
 v_exp_f32 v18, v90
 v_mfma_f32_16x16x32_bf16 v[208:211], a[160:163], v[52:55], v[208:211]
 ds_read_b128 a[60:63], v14 offset:27648
 v_cvt_pk_bf16_f32 v60, v16, v17
 v_mfma_f32_16x16x32_bf16 v[212:215], a[164:167], v[52:55], v[212:215]
 ds_read_b128 a[92:95], v14 offset:31744
 v_or3_b32 v21, v21, v59, v60
 v_mfma_f32_16x16x32_bf16 v[212:215], a[116:119], v[48:51], v[212:215]
 s_and_b32 s76, s76, 0x1ffff
 v_exp_f32 v19, v91
 v_mfma_f32_16x16x32_bf16 v[216:219], a[120:123], v[48:51], v[216:219]
 v_exp_f32 v16, v92
 v_mfma_f32_16x16x32_bf16 v[216:219], a[168:171], v[52:55], v[216:219]
 ds_read_b128 a[88:91], v14 offset:30720
 v_cvt_pk_bf16_f32 v61, v18, v19
 v_mfma_f32_16x16x32_bf16 v[220:223], a[172:175], v[52:55], v[220:223]
 v_exp_f32 v17, v93
 v_mfma_f32_16x16x32_bf16 v[220:223], a[124:127], v[48:51], v[220:223]
 ds_read_b128 a[84:87], v14 offset:29696
 v_mfma_f32_16x16x32_bf16 a[188:191], v[22:25], v[48:51], a[188:191]
 ds_read_b128 a[80:83], v14 offset:28672
 v_mfma_f32_16x16x32_bf16 a[188:191], v[22:25], v[52:55], a[188:191]
 s_mov_b32 s77, s79
 v_add_u32 v14, s76, v12
L_a2w0_13:
 s_waitcnt lgkmcnt(5)
 v_mfma_f32_16x16x32_bf16 v[64:67], a[16:19], a[64:67], v[36:39]
 v_exp_f32 v18, v94
 v_mfma_f32_16x16x32_bf16 v[64:67], a[20:23], a[68:71], v[64:67]
 v_cvt_pk_bf16_f32 v62, v16, v17
 v_or3_b32 v21, v21, v61, v62
 v_mfma_f32_16x16x32_bf16 v[64:67], a[24:27], a[72:75], v[64:67]
 v_exp_f32 v19, v95
 v_mfma_f32_16x16x32_bf16 v[64:67], a[28:31], a[76:79], v[64:67]
 v_accvgpr_read_b32 v26, a176
 v_cvt_pk_bf16_f32 v63, v18, v19
 v_mfma_f32_16x16x32_bf16 v[68:71], a[44:47], a[76:79], v[36:39]
 v_rcp_f32 v26, v26
 v_mfma_f32_16x16x32_bf16 v[68:71], a[40:43], a[72:75], v[68:71]
 v_mul_f32 v26, 0x1f800000, v26
 v_or_b32 v21, v21, v63
 v_mfma_f32_16x16x32_bf16 v[68:71], a[36:39], a[68:71], v[68:71]
 v_mul_f32 v96, v96, v26
 v_mul_f32 v97, v97, v26
 v_mfma_f32_16x16x32_bf16 v[68:71], a[32:35], a[64:67], v[68:71]
 v_and_b32 v21, s64, v21
 v_cmp_ne_u32 vcc, 0, v21
 v_mfma_f32_16x16x32_bf16 v[72:75], a[48:51], a[64:67], v[36:39]
 v_exp_f32 v16, v64
 v_mfma_f32_16x16x32_bf16 v[72:75], a[52:55], a[68:71], v[72:75]
 s_cbranch_vccnz L_so_50
L_sb_51:
 v_exp_f32 v17, v65
 v_mfma_f32_16x16x32_bf16 v[72:75], a[56:59], a[72:75], v[72:75]
 s_waitcnt lgkmcnt(0)
 v_exp_f32 v18, v66
 v_mfma_f32_16x16x32_bf16 v[72:75], a[60:63], a[76:79], v[72:75]
 v_cvt_pk_bf16_f32 v96, v96, v97
 v_cvt_pk_bf16_f32 v48, v16, v17
 v_mov_b32 v3, 4048155338
 v_cndmask_b32 v28, v3, v36, s[80:81]
 v_cndmask_b32 v29, v3, v37, s[82:83]
 v_cndmask_b32 v30, v3, v38, s[84:85]
 v_cndmask_b32 v31, v3, v39, s[86:87]
 s_nop 1
 v_mfma_f32_16x16x32_bf16 v[76:79], a[92:95], a[76:79], v[28:31]
 v_mul_f32 v98, v98, v26
 v_mul_f32 v99, v99, v26
 v_mfma_f32_16x16x32_bf16 v[76:79], a[88:91], a[72:75], v[76:79]
 v_exp_f32 v19, v67
 v_mfma_f32_16x16x32_bf16 v[76:79], a[84:87], a[68:71], v[76:79]
 v_exp_f32 v16, v68
 v_mfma_f32_16x16x32_bf16 v[76:79], a[80:83], a[64:67], v[76:79]
 s_waitcnt vmcnt(16)
 s_barrier
 s_sub_u32 s68, s68, 1
 s_cbranch_scc1 L_fo_56
L_fb_57:
 v_mfma_f32_16x16x32_bf16 v[160:163], a[96:99], v[56:59], v[160:163]
 ds_read_b128 a[96:99], v14 offset:0
 v_cvt_pk_bf16_f32 v49, v18, v19
 v_mfma_f32_16x16x32_bf16 v[160:163], a[144:147], v[60:63], v[160:163]
 s_mov_b32 m0, s77
 v_exp_f32 v17, v69
 v_mfma_f32_16x16x32_bf16 v[164:167], a[148:151], v[60:63], v[164:167]
 buffer_load_dwordx4 v13, s[32:35], s78 offen offset:0 sc1 lds
 v_mfma_f32_16x16x32_bf16 v[164:167], a[100:103], v[56:59], v[164:167]
 ds_read_b128 a[144:147], v14 offset:8192
 v_exp_f32 v18, v70
 v_mfma_f32_16x16x32_bf16 v[168:171], a[104:107], v[56:59], v[168:171]
 ds_read_b128 a[148:151], v14 offset:9216
 v_cvt_pk_bf16_f32 v50, v16, v17
 v_mfma_f32_16x16x32_bf16 v[168:171], a[152:155], v[60:63], v[168:171]
 ds_read_b128 a[100:103], v14 offset:1024
 v_or3_b32 v20, v48, v49, v50
 v_mfma_f32_16x16x32_bf16 v[172:175], a[156:159], v[60:63], v[172:175]
 ds_read_b128 a[104:107], v14 offset:2048
 v_exp_f32 v19, v71
 v_mfma_f32_16x16x32_bf16 v[172:175], a[108:111], v[56:59], v[172:175]
 ds_read_b128 a[152:155], v14 offset:10240
 v_cvt_pk_bf16_f32 v97, v98, v99
 v_mfma_f32_16x16x32_bf16 v[176:179], a[112:115], v[56:59], v[176:179]
 ds_read_b128 a[156:159], v14 offset:11264
 v_exp_f32 v16, v72
 v_mfma_f32_16x16x32_bf16 v[176:179], a[160:163], v[60:63], v[176:179]
 buffer_load_dwordx4 v13, s[32:35], s78 offen offset:1024 sc1 lds
 v_mfma_f32_16x16x32_bf16 v[180:183], a[164:167], v[60:63], v[180:183]
 ds_read_b128 a[108:111], v14 offset:3072
 v_cvt_pk_bf16_f32 v51, v18, v19
 v_mfma_f32_16x16x32_bf16 v[180:183], a[116:119], v[56:59], v[180:183]
 v_exp_f32 v17, v73
 v_mfma_f32_16x16x32_bf16 v[184:187], a[120:123], v[56:59], v[184:187]
 v_exp_f32 v18, v74
 v_mfma_f32_16x16x32_bf16 v[184:187], a[168:171], v[60:63], v[184:187]
 ds_read_b128 a[112:115], v14 offset:4096
 v_cvt_pk_bf16_f32 v52, v16, v17
 v_mfma_f32_16x16x32_bf16 v[188:191], a[172:175], v[60:63], v[188:191]
 ds_read_b128 a[160:163], v14 offset:12288
 v_or3_b32 v20, v20, v51, v52
 v_mfma_f32_16x16x32_bf16 v[188:191], a[124:127], v[56:59], v[188:191]
 v_exp_f32 v19, v75
 v_mfma_f32_16x16x32_bf16 a[184:187], v[22:25], v[56:59], a[184:187]
 v_exp_f32 v16, v76
 v_mfma_f32_16x16x32_bf16 a[184:187], v[22:25], v[60:63], a[184:187]
 buffer_load_dwordx4 v13, s[32:35], s78 offen offset:2048 sc1 lds
 v_mfma_f32_16x16x32_bf16 v[80:83], a[16:19], a[192:195], v[44:47]
 ds_read_b128 a[164:167], v14 offset:13312
 v_cvt_pk_bf16_f32 v53, v18, v19
 v_mfma_f32_16x16x32_bf16 v[80:83], a[20:23], a[196:199], v[80:83]
 v_exp_f32 v17, v77
 v_mfma_f32_16x16x32_bf16 v[80:83], a[24:27], a[200:203], v[80:83]
 v_exp_f32 v18, v78
 v_mfma_f32_16x16x32_bf16 v[80:83], a[28:31], a[204:207], v[80:83]
 ds_read_b128 a[116:119], v14 offset:5120
 v_cvt_pk_bf16_f32 v54, v16, v17
 v_mfma_f32_16x16x32_bf16 v[84:87], a[44:47], a[204:207], v[44:47]
 ds_read_b128 a[120:123], v14 offset:6144
 v_or3_b32 v20, v20, v53, v54
 v_mfma_f32_16x16x32_bf16 v[84:87], a[40:43], a[200:203], v[84:87]
 v_exp_f32 v19, v79
 v_mfma_f32_16x16x32_bf16 v[84:87], a[36:39], a[196:199], v[84:87]
 buffer_load_dwordx4 v13, s[32:35], s78 offen offset:3072 sc1 lds
 v_mfma_f32_16x16x32_bf16 v[84:87], a[32:35], a[192:195], v[84:87]
 v_cvt_pk_bf16_f32 v55, v18, v19
 v_or_b32 v20, v20, v55
 v_and_b32 v20, s64, v20
 v_mfma_f32_16x16x32_bf16 v[88:91], a[48:51], a[192:195], v[44:47]
 ds_read_b128 a[168:171], v14 offset:14336
 v_cmp_ne_u32 vcc, 0, v20
 v_mfma_f32_16x16x32_bf16 v[88:91], a[52:55], a[196:199], v[88:91]
 v_mul_f32 v100, v100, v26
 v_mul_f32 v101, v101, v26
 v_mfma_f32_16x16x32_bf16 v[88:91], a[56:59], a[200:203], v[88:91]
 ds_read_b128 a[172:175], v14 offset:15360
 v_cvt_pk_bf16_f32 v98, v100, v101
 v_mfma_f32_16x16x32_bf16 v[88:91], a[60:63], a[204:207], v[88:91]
 s_cbranch_vccnz L_so_52
L_sb_53:
 v_mul_f32 v102, v102, v26
 v_mul_f32 v103, v103, v26
 v_mfma_f32_16x16x32_bf16 v[92:95], a[92:95], a[204:207], v[44:47]
 ds_read_b128 a[124:127], v14 offset:7168
 v_cvt_pk_bf16_f32 v99, v102, v103
 v_mfma_f32_16x16x32_bf16 v[92:95], a[88:91], a[200:203], v[92:95]
 v_exp_f32 v16, v80
 v_mfma_f32_16x16x32_bf16 v[92:95], a[84:87], a[196:199], v[92:95]
 v_exp_f32 v17, v81
 v_mfma_f32_16x16x32_bf16 v[92:95], a[80:83], a[192:195], v[92:95]
 s_waitcnt lgkmcnt(3)
 buffer_store_dwordx4 v[96:99], v12, s[16:19], s72 offen offset:0 sc1
 v_mul_f32 v104, v104, v26
 v_mul_f32 v105, v105, v26
 v_cvt_pk_bf16_f32 v104, v104, v105
 v_mul_f32 v106, v106, v26
 v_mul_f32 v107, v107, v26
 v_cvt_pk_bf16_f32 v105, v106, v107
 v_mul_f32 v108, v108, v26
 v_mul_f32 v109, v109, v26
 v_cvt_pk_bf16_f32 v106, v108, v109
 v_mul_f32 v110, v110, v26
 v_mul_f32 v111, v111, v26
 v_cvt_pk_bf16_f32 v107, v110, v111
 buffer_store_dwordx4 v[104:107], v12, s[16:19], s72 offen offset:1024 sc1
 v_mul_f32 v112, v112, v26
 v_mul_f32 v113, v113, v26
 v_cvt_pk_bf16_f32 v112, v112, v113
 v_mul_f32 v114, v114, v26
 v_mul_f32 v115, v115, v26
 v_cvt_pk_bf16_f32 v113, v114, v115
 v_mul_f32 v116, v116, v26
 v_mul_f32 v117, v117, v26
 v_cvt_pk_bf16_f32 v114, v116, v117
 v_mul_f32 v118, v118, v26
 v_mul_f32 v119, v119, v26
 v_cvt_pk_bf16_f32 v115, v118, v119
 buffer_store_dwordx4 v[112:115], v12, s[16:19], s72 offen offset:2048 sc1
 v_mul_f32 v120, v120, v26
 v_mul_f32 v121, v121, v26
 v_cvt_pk_bf16_f32 v120, v120, v121
 v_mul_f32 v122, v122, v26
 v_mul_f32 v123, v123, v26
 v_cvt_pk_bf16_f32 v121, v122, v123
 v_mul_f32 v124, v124, v26
 v_mul_f32 v125, v125, v26
 v_cvt_pk_bf16_f32 v122, v124, v125
 v_mul_f32 v126, v126, v26
 v_mul_f32 v127, v127, v26
 v_cvt_pk_bf16_f32 v123, v126, v127
 buffer_store_dwordx4 v[120:123], v12, s[16:19], s72 offen offset:3072 sc1
 v_mfma_f32_16x16x32_bf16 v[128:131], a[96:99], v[48:51], v[128:131]
 s_add_u32 m0, s77, 16384
 v_exp_f32 v18, v82
 v_mfma_f32_16x16x32_bf16 v[128:131], a[144:147], v[52:55], v[128:131]
 v_cvt_pk_bf16_f32 v56, v16, v17
 v_mfma_f32_16x16x32_bf16 v[132:135], a[148:151], v[52:55], v[132:135]
 v_exp_f32 v19, v83
 v_mfma_f32_16x16x32_bf16 v[132:135], a[100:103], v[48:51], v[132:135]
 v_exp_f32 v16, v84
 v_mfma_f32_16x16x32_bf16 v[136:139], a[104:107], v[48:51], v[136:139]
 v_cvt_pk_bf16_f32 v57, v18, v19
 v_mfma_f32_16x16x32_bf16 v[136:139], a[152:155], v[52:55], v[136:139]
 v_exp_f32 v17, v85
 v_mfma_f32_16x16x32_bf16 v[140:143], a[156:159], v[52:55], v[140:143]
 v_exp_f32 v18, v86
 v_mfma_f32_16x16x32_bf16 v[140:143], a[108:111], v[48:51], v[140:143]
 s_add_u32 s78, s78, 16384
 v_cvt_pk_bf16_f32 v58, v16, v17
 v_or3_b32 v21, v56, v57, v58
 v_mfma_f32_16x16x32_bf16 v[144:147], a[112:115], v[48:51], v[144:147]
 v_exp_f32 v19, v87
 v_mfma_f32_16x16x32_bf16 v[144:147], a[160:163], v[52:55], v[144:147]
 v_exp_f32 v16, v88
 v_mfma_f32_16x16x32_bf16 v[148:151], a[164:167], v[52:55], v[148:151]
 v_cvt_pk_bf16_f32 v59, v18, v19
 v_exp_f32 v17, v89
 v_mfma_f32_16x16x32_bf16 v[148:151], a[116:119], v[48:51], v[148:151]
 v_exp_f32 v18, v90
 v_mfma_f32_16x16x32_bf16 v[152:155], a[120:123], v[48:51], v[152:155]
 s_waitcnt lgkmcnt(0)
 buffer_load_dwordx4 v13, s[12:15], s78 offen offset:0 sc1 lds
 v_mfma_f32_16x16x32_bf16 v[152:155], a[168:171], v[52:55], v[152:155]
 v_cvt_pk_bf16_f32 v60, v16, v17
 v_or3_b32 v21, v21, v59, v60
 v_mfma_f32_16x16x32_bf16 v[156:159], a[172:175], v[52:55], v[156:159]
 v_exp_f32 v19, v91
 v_mfma_f32_16x16x32_bf16 v[156:159], a[124:127], v[48:51], v[156:159]
 v_exp_f32 v16, v92
 v_mfma_f32_16x16x32_bf16 a[180:183], v[22:25], v[48:51], a[180:183]
 v_cvt_pk_bf16_f32 v61, v18, v19
 v_exp_f32 v17, v93
 v_mfma_f32_16x16x32_bf16 a[180:183], v[22:25], v[52:55], a[180:183]
 v_exp_f32 v18, v94
 v_mfma_f32_16x16x32_bf16 v[64:67], a[16:19], a[128:131], v[40:43]
 ds_read_b128 a[16:19], v14 offset:16384
 v_cvt_pk_bf16_f32 v62, v16, v17
 v_mfma_f32_16x16x32_bf16 v[64:67], a[20:23], a[132:135], v[64:67]
 buffer_load_dwordx4 v13, s[12:15], s78 offen offset:1024 sc1 lds
 v_mfma_f32_16x16x32_bf16 v[64:67], a[24:27], a[136:139], v[64:67]
 ds_read_b128 a[20:23], v14 offset:17408
 v_or3_b32 v21, v21, v61, v62
 v_mfma_f32_16x16x32_bf16 v[64:67], a[28:31], a[140:143], v[64:67]
 v_exp_f32 v19, v95
 v_mfma_f32_16x16x32_bf16 v[68:71], a[44:47], a[140:143], v[40:43]
 ds_read_b128 a[24:27], v14 offset:18432
 v_cvt_pk_bf16_f32 v63, v18, v19
 v_mfma_f32_16x16x32_bf16 v[68:71], a[40:43], a[136:139], v[68:71]
 ds_read_b128 a[28:31], v14 offset:19456
 v_or_b32 v21, v21, v63
 v_mfma_f32_16x16x32_bf16 v[68:71], a[36:39], a[132:135], v[68:71]
 ds_read_b128 a[44:47], v14 offset:23552
 v_and_b32 v21, s64, v21
 v_mfma_f32_16x16x32_bf16 v[68:71], a[32:35], a[128:131], v[68:71]
 ds_read_b128 a[40:43], v14 offset:22528
 v_cmp_ne_u32 vcc, 0, v21
 v_mfma_f32_16x16x32_bf16 v[72:75], a[48:51], a[128:131], v[40:43]
 v_exp_f32 v16, v64
 v_mfma_f32_16x16x32_bf16 v[72:75], a[52:55], a[132:135], v[72:75]
 buffer_load_dwordx4 v13, s[12:15], s78 offen offset:2048 sc1 lds
 v_mfma_f32_16x16x32_bf16 v[72:75], a[56:59], a[136:139], v[72:75]
 s_cbranch_vccnz L_so_54
L_sb_55:
 v_exp_f32 v17, v65
 v_mfma_f32_16x16x32_bf16 v[72:75], a[60:63], a[140:143], v[72:75]
 v_exp_f32 v18, v66
 v_mfma_f32_16x16x32_bf16 v[76:79], a[92:95], a[140:143], v[40:43]
 ds_read_b128 a[36:39], v14 offset:21504
 v_cvt_pk_bf16_f32 v48, v16, v17
 v_mfma_f32_16x16x32_bf16 v[76:79], a[88:91], a[136:139], v[76:79]
 v_exp_f32 v19, v67
 v_mfma_f32_16x16x32_bf16 v[76:79], a[84:87], a[132:135], v[76:79]
 v_exp_f32 v16, v68
 v_mfma_f32_16x16x32_bf16 v[76:79], a[80:83], a[128:131], v[76:79]
 ds_read_b128 a[32:35], v14 offset:20480
 v_accvgpr_read_b32 v27, a180
 v_mfma_f32_16x16x32_bf16 v[192:195], a[96:99], v[56:59], v[192:195]
 buffer_load_dwordx4 v13, s[12:15], s78 offen offset:3072 sc1 lds
 v_mfma_f32_16x16x32_bf16 v[192:195], a[144:147], v[60:63], v[192:195]
 ds_read_b128 a[48:51], v14 offset:24576
 v_cvt_pk_bf16_f32 v49, v18, v19
 v_mfma_f32_16x16x32_bf16 v[196:199], a[148:151], v[60:63], v[196:199]
 v_rcp_f32 v27, v27
 v_mfma_f32_16x16x32_bf16 v[196:199], a[100:103], v[56:59], v[196:199]
 ds_read_b128 a[52:55], v14 offset:25600
 v_mul_f32 v27, 0x1f800000, v27
 v_mfma_f32_16x16x32_bf16 v[200:203], a[104:107], v[56:59], v[200:203]
 v_mul_f32 v128, v128, v27
 v_mul_f32 v129, v129, v27
 v_mfma_f32_16x16x32_bf16 v[200:203], a[152:155], v[60:63], v[200:203]
 ds_read_b128 a[56:59], v14 offset:26624
 v_cvt_pk_bf16_f32 v128, v128, v129
 v_mfma_f32_16x16x32_bf16 v[204:207], a[156:159], v[60:63], v[204:207]
 s_add_u32 s79, s76, s58
 v_mul_f32 v130, v130, v27
 v_mul_f32 v131, v131, v27
 v_mfma_f32_16x16x32_bf16 v[204:207], a[108:111], v[56:59], v[204:207]
 s_add_u32 s76, s76, 32768
 v_exp_f32 v17, v69
 v_mfma_f32_16x16x32_bf16 v[208:211], a[112:115], v[56:59], v[208:211]
 s_and_b32 s76, s76, 0x1ffff
 v_exp_f32 v18, v70
 v_mfma_f32_16x16x32_bf16 v[208:211], a[160:163], v[60:63], v[208:211]
 ds_read_b128 a[60:63], v14 offset:27648
 v_cvt_pk_bf16_f32 v129, v130, v131
 v_mfma_f32_16x16x32_bf16 v[212:215], a[164:167], v[60:63], v[212:215]
 ds_read_b128 a[92:95], v14 offset:31744
 v_cvt_pk_bf16_f32 v50, v16, v17
 v_mfma_f32_16x16x32_bf16 v[212:215], a[116:119], v[56:59], v[212:215]
 ds_read_b128 a[88:91], v14 offset:30720
 v_or3_b32 v20, v48, v49, v50
 v_mfma_f32_16x16x32_bf16 v[216:219], a[120:123], v[56:59], v[216:219]
 v_mul_f32 v132, v132, v27
 v_mul_f32 v133, v133, v27
 v_mfma_f32_16x16x32_bf16 v[216:219], a[168:171], v[60:63], v[216:219]
 ds_read_b128 a[84:87], v14 offset:29696
 v_cvt_pk_bf16_f32 v130, v132, v133
 v_mfma_f32_16x16x32_bf16 v[220:223], a[172:175], v[60:63], v[220:223]
 v_mul_f32 v134, v134, v27
 v_mul_f32 v135, v135, v27
 v_mfma_f32_16x16x32_bf16 v[220:223], a[124:127], v[56:59], v[220:223]
 ds_read_b128 a[80:83], v14 offset:28672
 v_cvt_pk_bf16_f32 v131, v134, v135
 v_mfma_f32_16x16x32_bf16 a[188:191], v[22:25], v[56:59], a[188:191]
 v_exp_f32 v19, v71
 v_exp_f32 v16, v72
 v_mfma_f32_16x16x32_bf16 a[188:191], v[22:25], v[60:63], a[188:191]
 s_mov_b32 s77, s79
 buffer_store_dwordx4 v[128:131], v12, s[16:19], s73 offen offset:0 sc1
 v_add_u32 v14, s76, v12
 v_mul_f32 v136, v136, v27
 v_mul_f32 v137, v137, v27
 v_cvt_pk_bf16_f32 v136, v136, v137
 v_cvt_pk_bf16_f32 v51, v18, v19
 v_exp_f32 v17, v73
 v_exp_f32 v18, v74
 v_cvt_pk_bf16_f32 v52, v16, v17
 v_or3_b32 v20, v20, v51, v52
 v_exp_f32 v19, v75
 v_exp_f32 v16, v76
 v_cvt_pk_bf16_f32 v53, v18, v19
 v_exp_f32 v17, v77
 v_mul_f32 v138, v138, v27
 v_mul_f32 v139, v139, v27
 v_cvt_pk_bf16_f32 v137, v138, v139
 v_mul_f32 v140, v140, v27
 v_mul_f32 v141, v141, v27
 v_cvt_pk_bf16_f32 v138, v140, v141
 v_mul_f32 v142, v142, v27
 v_mul_f32 v143, v143, v27
 v_cvt_pk_bf16_f32 v139, v142, v143
 buffer_store_dwordx4 v[136:139], v12, s[16:19], s73 offen offset:1024 sc1
 v_mul_f32 v144, v144, v27
 v_mul_f32 v145, v145, v27
 v_cvt_pk_bf16_f32 v144, v144, v145
 v_mul_f32 v146, v146, v27
 v_mul_f32 v147, v147, v27
 v_cvt_pk_bf16_f32 v145, v146, v147
 v_mul_f32 v148, v148, v27
 v_mul_f32 v149, v149, v27
 v_cvt_pk_bf16_f32 v146, v148, v149
 v_mul_f32 v150, v150, v27
 v_mul_f32 v151, v151, v27
 v_cvt_pk_bf16_f32 v147, v150, v151
 buffer_store_dwordx4 v[144:147], v12, s[16:19], s73 offen offset:2048 sc1
 v_mul_f32 v152, v152, v27
 v_mul_f32 v153, v153, v27
 v_cvt_pk_bf16_f32 v152, v152, v153
 v_mul_f32 v154, v154, v27
 v_mul_f32 v155, v155, v27
 v_cvt_pk_bf16_f32 v153, v154, v155
 v_mul_f32 v156, v156, v27
 v_mul_f32 v157, v157, v27
 v_cvt_pk_bf16_f32 v154, v156, v157
 v_mul_f32 v158, v158, v27
 v_mul_f32 v159, v159, v27
 v_cvt_pk_bf16_f32 v155, v158, v159
 buffer_store_dwordx4 v[152:155], v12, s[16:19], s73 offen offset:3072 sc1
 s_branch L_vj_39
L_w1_36:
 s_cmp_eq_u32 s3, 1
 s_cbranch_scc0 L_w2_37
 s_waitcnt lgkmcnt(5)
 v_mfma_f32_16x16x32_bf16 v[64:67], a[16:19], a[0:3], v[32:35]
 v_exp_f32 v18, v94
 v_mfma_f32_16x16x32_bf16 v[64:67], a[20:23], a[4:7], v[64:67]
 v_cvt_pk_bf16_f32 v62, v16, v17
 v_or3_b32 v21, v21, v61, v62
 v_mfma_f32_16x16x32_bf16 v[64:67], a[24:27], a[8:11], v[64:67]
 v_exp_f32 v19, v95
 v_mfma_f32_16x16x32_bf16 v[64:67], a[28:31], a[12:15], v[64:67]
 v_cvt_pk_bf16_f32 v63, v18, v19
 v_or_b32 v21, v21, v63
 v_mov_b32 v3, 4048155338
 v_cndmask_b32 v28, v3, v32, s[80:81]
 v_cndmask_b32 v29, v3, v33, s[82:83]
 v_cndmask_b32 v30, v3, v34, s[84:85]
 v_cndmask_b32 v31, v3, v35, s[86:87]
 s_nop 1
 v_mfma_f32_16x16x32_bf16 v[68:71], a[44:47], a[12:15], v[28:31]
 v_and_b32 v21, s64, v21
 v_mfma_f32_16x16x32_bf16 v[68:71], a[40:43], a[8:11], v[68:71]
 v_cmp_ne_u32 vcc, 0, v21
 v_mfma_f32_16x16x32_bf16 v[68:71], a[36:39], a[4:7], v[68:71]
 v_mfma_f32_16x16x32_bf16 v[68:71], a[32:35], a[0:3], v[68:71]
 s_cbranch_vccnz L_so_58
L_sb_59:
 s_waitcnt lgkmcnt(0)
 s_waitcnt vmcnt(16)
 s_barrier
 s_sub_u32 s68, s68, 1
 s_cbranch_scc1 L_fo_66
L_fb_67:
 v_mfma_f32_16x16x32_bf16 v[160:163], a[96:99], v[56:59], v[160:163]
 ds_read_b128 a[96:99], v14 offset:0
 v_mov_b32 v72, 4048155338
 v_mfma_f32_16x16x32_bf16 v[160:163], a[144:147], v[60:63], v[160:163]
 ds_read_b128 a[144:147], v14 offset:8192
 v_mov_b32 v73, 4048155338
 v_mfma_f32_16x16x32_bf16 v[164:167], a[148:151], v[60:63], v[164:167]
 ds_read_b128 a[148:151], v14 offset:9216
 v_mov_b32 v74, 4048155338
 v_mfma_f32_16x16x32_bf16 v[164:167], a[100:103], v[56:59], v[164:167]
 s_mov_b32 m0, s77
 v_mov_b32 v75, 4048155338
 v_mfma_f32_16x16x32_bf16 v[168:171], a[104:107], v[56:59], v[168:171]
 buffer_load_dwordx4 v13, s[32:35], s78 offen offset:0 sc1 lds
 v_mfma_f32_16x16x32_bf16 v[168:171], a[152:155], v[60:63], v[168:171]
 ds_read_b128 a[100:103], v14 offset:1024
 v_mov_b32 v76, 4048155338
 v_mfma_f32_16x16x32_bf16 v[172:175], a[156:159], v[60:63], v[172:175]
 ds_read_b128 a[104:107], v14 offset:2048
 v_mov_b32 v77, 4048155338
 v_mfma_f32_16x16x32_bf16 v[172:175], a[108:111], v[56:59], v[172:175]
 ds_read_b128 a[152:155], v14 offset:10240
 v_mov_b32 v78, 4048155338
 v_mfma_f32_16x16x32_bf16 v[176:179], a[112:115], v[56:59], v[176:179]
 ds_read_b128 a[156:159], v14 offset:11264
 v_mov_b32 v79, 4048155338
 v_mfma_f32_16x16x32_bf16 v[176:179], a[160:163], v[60:63], v[176:179]
 v_exp_f32 v16, v64
 v_mfma_f32_16x16x32_bf16 v[180:183], a[164:167], v[60:63], v[180:183]
 v_exp_f32 v17, v65
 v_mfma_f32_16x16x32_bf16 v[180:183], a[116:119], v[56:59], v[180:183]
 v_exp_f32 v18, v66
 v_mfma_f32_16x16x32_bf16 v[184:187], a[120:123], v[56:59], v[184:187]
 ds_read_b128 a[108:111], v14 offset:3072
 v_cvt_pk_bf16_f32 v48, v16, v17
 v_mfma_f32_16x16x32_bf16 v[184:187], a[168:171], v[60:63], v[184:187]
 v_exp_f32 v19, v67
 v_mfma_f32_16x16x32_bf16 v[188:191], a[172:175], v[60:63], v[188:191]
 buffer_load_dwordx4 v13, s[32:35], s78 offen offset:1024 sc1 lds
 v_mfma_f32_16x16x32_bf16 v[188:191], a[124:127], v[56:59], v[188:191]
 v_exp_f32 v16, v68
 v_mfma_f32_16x16x32_bf16 a[184:187], v[22:25], v[56:59], a[184:187]
 ds_read_b128 a[112:115], v14 offset:4096
 v_cvt_pk_bf16_f32 v49, v18, v19
 v_mfma_f32_16x16x32_bf16 a[184:187], v[22:25], v[60:63], a[184:187]
 v_exp_f32 v17, v69
 v_mfma_f32_16x16x32_bf16 v[80:83], a[16:19], a[64:67], v[36:39]
 v_exp_f32 v18, v70
 v_mfma_f32_16x16x32_bf16 v[80:83], a[20:23], a[68:71], v[80:83]
 ds_read_b128 a[160:163], v14 offset:12288
 v_cvt_pk_bf16_f32 v50, v16, v17
 v_mfma_f32_16x16x32_bf16 v[80:83], a[24:27], a[72:75], v[80:83]
 ds_read_b128 a[164:167], v14 offset:13312
 v_or3_b32 v20, v48, v49, v50
 v_mfma_f32_16x16x32_bf16 v[80:83], a[28:31], a[76:79], v[80:83]
 v_exp_f32 v19, v71
 v_mfma_f32_16x16x32_bf16 v[84:87], a[44:47], a[76:79], v[36:39]
 ds_read_b128 a[116:119], v14 offset:5120
 v_cvt_pk_bf16_f32 v51, v18, v19
 v_mfma_f32_16x16x32_bf16 v[84:87], a[40:43], a[72:75], v[84:87]
 buffer_load_dwordx4 v13, s[32:35], s78 offen offset:2048 sc1 lds
 v_mfma_f32_16x16x32_bf16 v[84:87], a[36:39], a[68:71], v[84:87]
 ds_read_b128 a[120:123], v14 offset:6144
 v_or_b32 v20, v20, v51
 v_mfma_f32_16x16x32_bf16 v[84:87], a[32:35], a[64:67], v[84:87]
 ds_read_b128 a[168:171], v14 offset:14336
 v_and_b32 v20, s64, v20
 v_mfma_f32_16x16x32_bf16 v[88:91], a[48:51], a[64:67], v[36:39]
 ds_read_b128 a[172:175], v14 offset:15360
 v_cmp_ne_u32 vcc, 0, v20
 v_mfma_f32_16x16x32_bf16 v[88:91], a[52:55], a[68:71], v[88:91]
 v_exp_f32 v16, v80
 v_mfma_f32_16x16x32_bf16 v[88:91], a[56:59], a[72:75], v[88:91]
 s_cbranch_vccnz L_so_60
L_sb_61:
 v_exp_f32 v17, v81
 v_mfma_f32_16x16x32_bf16 v[88:91], a[60:63], a[76:79], v[88:91]
 v_exp_f32 v18, v82
 v_mfma_f32_16x16x32_bf16 v[92:95], a[92:95], a[76:79], v[36:39]
 ds_read_b128 a[124:127], v14 offset:7168
 v_cvt_pk_bf16_f32 v56, v16, v17
 v_mfma_f32_16x16x32_bf16 v[92:95], a[88:91], a[72:75], v[92:95]
 v_exp_f32 v19, v83
 v_mfma_f32_16x16x32_bf16 v[92:95], a[84:87], a[68:71], v[92:95]
 v_exp_f32 v16, v84
 v_mfma_f32_16x16x32_bf16 v[92:95], a[80:83], a[64:67], v[92:95]
 s_waitcnt lgkmcnt(4)
 v_cvt_pk_bf16_f32 v57, v18, v19
 v_mfma_f32_16x16x32_bf16 v[96:99], a[96:99], v[48:51], v[96:99]
 v_exp_f32 v17, v85
 v_mfma_f32_16x16x32_bf16 v[100:103], a[100:103], v[48:51], v[100:103]
 v_exp_f32 v18, v86
 v_mfma_f32_16x16x32_bf16 v[104:107], a[104:107], v[48:51], v[104:107]
 v_cvt_pk_bf16_f32 v58, v16, v17
 v_or3_b32 v21, v56, v57, v58
 v_mfma_f32_16x16x32_bf16 v[108:111], a[108:111], v[48:51], v[108:111]
 v_exp_f32 v19, v87
 v_mfma_f32_16x16x32_bf16 v[112:115], a[112:115], v[48:51], v[112:115]
 v_exp_f32 v16, v88
 v_mfma_f32_16x16x32_bf16 v[116:119], a[116:119], v[48:51], v[116:119]
 s_waitcnt lgkmcnt(1)
 v_cvt_pk_bf16_f32 v59, v18, v19
 v_exp_f32 v17, v89
 v_mfma_f32_16x16x32_bf16 v[120:123], a[120:123], v[48:51], v[120:123]
 s_waitcnt lgkmcnt(0)
 v_exp_f32 v18, v90
 v_mfma_f32_16x16x32_bf16 v[124:127], a[124:127], v[48:51], v[124:127]
 buffer_load_dwordx4 v13, s[32:35], s78 offen offset:3072 sc1 lds
 v_mfma_f32_16x16x32_bf16 a[176:179], v[22:25], v[48:51], a[176:179]
 v_cvt_pk_bf16_f32 v60, v16, v17
 v_or3_b32 v21, v21, v59, v60
 v_mfma_f32_16x16x32_bf16 v[64:67], a[16:19], a[192:195], v[44:47]
 v_exp_f32 v19, v91
 v_mfma_f32_16x16x32_bf16 v[64:67], a[20:23], a[196:199], v[64:67]
 v_exp_f32 v16, v92
 v_mfma_f32_16x16x32_bf16 v[64:67], a[24:27], a[200:203], v[64:67]
 s_add_u32 m0, s77, 16384
 v_cvt_pk_bf16_f32 v61, v18, v19
 v_exp_f32 v17, v93
 v_mfma_f32_16x16x32_bf16 v[64:67], a[28:31], a[204:207], v[64:67]
 v_exp_f32 v18, v94
 v_mfma_f32_16x16x32_bf16 v[68:71], a[44:47], a[204:207], v[44:47]
 v_cvt_pk_bf16_f32 v62, v16, v17
 v_or3_b32 v21, v21, v61, v62
 v_mfma_f32_16x16x32_bf16 v[68:71], a[40:43], a[200:203], v[68:71]
 v_exp_f32 v19, v95
 v_mfma_f32_16x16x32_bf16 v[68:71], a[36:39], a[196:199], v[68:71]
 v_cvt_pk_bf16_f32 v63, v18, v19
 v_or_b32 v21, v21, v63
 v_mfma_f32_16x16x32_bf16 v[68:71], a[32:35], a[192:195], v[68:71]
 v_and_b32 v21, s64, v21
 v_cmp_ne_u32 vcc, 0, v21
 v_mfma_f32_16x16x32_bf16 v[72:75], a[48:51], a[192:195], v[44:47]
 v_exp_f32 v16, v64
 v_mfma_f32_16x16x32_bf16 v[72:75], a[52:55], a[196:199], v[72:75]
 v_exp_f32 v17, v65
 v_mfma_f32_16x16x32_bf16 v[72:75], a[56:59], a[200:203], v[72:75]
 v_exp_f32 v18, v66
 v_mfma_f32_16x16x32_bf16 v[72:75], a[60:63], a[204:207], v[72:75]
 s_cbranch_vccnz L_so_62
L_sb_63:
 v_cvt_pk_bf16_f32 v48, v16, v17
 v_mfma_f32_16x16x32_bf16 v[76:79], a[92:95], a[204:207], v[44:47]
 s_add_u32 s78, s78, 16384
 v_exp_f32 v19, v67
 v_mfma_f32_16x16x32_bf16 v[76:79], a[88:91], a[200:203], v[76:79]
 v_exp_f32 v16, v68
 v_mfma_f32_16x16x32_bf16 v[76:79], a[84:87], a[196:199], v[76:79]
 v_cvt_pk_bf16_f32 v49, v18, v19
 v_mfma_f32_16x16x32_bf16 v[76:79], a[80:83], a[192:195], v[76:79]
 v_exp_f32 v17, v69
 v_mfma_f32_16x16x32_bf16 v[128:131], a[96:99], v[56:59], v[128:131]
 v_exp_f32 v18, v70
 v_mfma_f32_16x16x32_bf16 v[128:131], a[144:147], v[60:63], v[128:131]
 v_cvt_pk_bf16_f32 v50, v16, v17
 v_or3_b32 v20, v48, v49, v50
 v_mfma_f32_16x16x32_bf16 v[132:135], a[148:151], v[60:63], v[132:135]
 v_exp_f32 v19, v71
 v_mfma_f32_16x16x32_bf16 v[132:135], a[100:103], v[56:59], v[132:135]
 buffer_load_dwordx4 v13, s[12:15], s78 offen offset:0 sc1 lds
 v_mfma_f32_16x16x32_bf16 v[136:139], a[104:107], v[56:59], v[136:139]
 v_exp_f32 v16, v72
 v_mfma_f32_16x16x32_bf16 v[136:139], a[152:155], v[60:63], v[136:139]
 v_cvt_pk_bf16_f32 v51, v18, v19
 v_mfma_f32_16x16x32_bf16 v[140:143], a[156:159], v[60:63], v[140:143]
 v_exp_f32 v17, v73
 v_mfma_f32_16x16x32_bf16 v[140:143], a[108:111], v[56:59], v[140:143]
 v_exp_f32 v18, v74
 v_mfma_f32_16x16x32_bf16 v[144:147], a[112:115], v[56:59], v[144:147]
 v_cvt_pk_bf16_f32 v52, v16, v17
 v_or3_b32 v20, v20, v51, v52
 v_mfma_f32_16x16x32_bf16 v[144:147], a[160:163], v[60:63], v[144:147]
 v_exp_f32 v19, v75
 v_mfma_f32_16x16x32_bf16 v[148:151], a[164:167], v[60:63], v[148:151]
 v_exp_f32 v16, v76
 v_mfma_f32_16x16x32_bf16 v[148:151], a[116:119], v[56:59], v[148:151]
 v_cvt_pk_bf16_f32 v53, v18, v19
 v_mfma_f32_16x16x32_bf16 v[152:155], a[120:123], v[56:59], v[152:155]
 v_exp_f32 v17, v77
 v_mfma_f32_16x16x32_bf16 v[152:155], a[168:171], v[60:63], v[152:155]
 buffer_load_dwordx4 v13, s[12:15], s78 offen offset:1024 sc1 lds
 v_mfma_f32_16x16x32_bf16 v[156:159], a[172:175], v[60:63], v[156:159]
 v_exp_f32 v18, v78
 v_mfma_f32_16x16x32_bf16 v[156:159], a[124:127], v[56:59], v[156:159]
 v_cvt_pk_bf16_f32 v54, v16, v17
 v_or3_b32 v20, v20, v53, v54
 v_mfma_f32_16x16x32_bf16 a[180:183], v[22:25], v[56:59], a[180:183]
 v_exp_f32 v19, v79
 v_mfma_f32_16x16x32_bf16 a[180:183], v[22:25], v[60:63], a[180:183]
 v_cvt_pk_bf16_f32 v55, v18, v19
 v_or_b32 v20, v20, v55
 v_mfma_f32_16x16x32_bf16 v[80:83], a[16:19], a[128:131], v[40:43]
 ds_read_b128 a[16:19], v14 offset:16384
 v_mfma_f32_16x16x32_bf16 v[80:83], a[20:23], a[132:135], v[80:83]
 ds_read_b128 a[20:23], v14 offset:17408
 v_mfma_f32_16x16x32_bf16 v[80:83], a[24:27], a[136:139], v[80:83]
 ds_read_b128 a[24:27], v14 offset:18432
 v_mfma_f32_16x16x32_bf16 v[80:83], a[28:31], a[140:143], v[80:83]
 ds_read_b128 a[28:31], v14 offset:19456
 v_mfma_f32_16x16x32_bf16 v[84:87], a[44:47], a[140:143], v[40:43]
 buffer_load_dwordx4 v13, s[12:15], s78 offen offset:2048 sc1 lds
 v_mfma_f32_16x16x32_bf16 v[84:87], a[40:43], a[136:139], v[84:87]
 ds_read_b128 a[44:47], v14 offset:23552
 v_mfma_f32_16x16x32_bf16 v[84:87], a[36:39], a[132:135], v[84:87]
 ds_read_b128 a[40:43], v14 offset:22528
 v_mfma_f32_16x16x32_bf16 v[84:87], a[32:35], a[128:131], v[84:87]
 v_and_b32 v20, s64, v20
 v_cmp_ne_u32 vcc, 0, v20
 v_mfma_f32_16x16x32_bf16 v[88:91], a[48:51], a[128:131], v[40:43]
 v_exp_f32 v16, v80
 v_mfma_f32_16x16x32_bf16 v[88:91], a[52:55], a[132:135], v[88:91]
 s_cbranch_vccnz L_so_64
L_sb_65:
 v_exp_f32 v17, v81
 v_mfma_f32_16x16x32_bf16 v[88:91], a[56:59], a[136:139], v[88:91]
 v_exp_f32 v18, v82
 v_mfma_f32_16x16x32_bf16 v[88:91], a[60:63], a[140:143], v[88:91]
 ds_read_b128 a[36:39], v14 offset:21504
 v_cvt_pk_bf16_f32 v56, v16, v17
 v_mfma_f32_16x16x32_bf16 v[92:95], a[92:95], a[140:143], v[40:43]
 v_exp_f32 v19, v83
 v_mfma_f32_16x16x32_bf16 v[92:95], a[88:91], a[136:139], v[92:95]
 v_exp_f32 v16, v84
 v_mfma_f32_16x16x32_bf16 v[92:95], a[84:87], a[132:135], v[92:95]
 buffer_load_dwordx4 v13, s[12:15], s78 offen offset:3072 sc1 lds
 v_mfma_f32_16x16x32_bf16 v[92:95], a[80:83], a[128:131], v[92:95]
 ds_read_b128 a[32:35], v14 offset:20480
 v_cvt_pk_bf16_f32 v57, v18, v19
 v_mfma_f32_16x16x32_bf16 v[192:195], a[96:99], v[48:51], v[192:195]
 v_exp_f32 v17, v85
 v_mfma_f32_16x16x32_bf16 v[192:195], a[144:147], v[52:55], v[192:195]
 v_exp_f32 v18, v86
 v_mfma_f32_16x16x32_bf16 v[196:199], a[148:151], v[52:55], v[196:199]
 ds_read_b128 a[48:51], v14 offset:24576
 v_cvt_pk_bf16_f32 v58, v16, v17
 v_mfma_f32_16x16x32_bf16 v[196:199], a[100:103], v[48:51], v[196:199]
 ds_read_b128 a[52:55], v14 offset:25600
 v_or3_b32 v21, v56, v57, v58
 v_mfma_f32_16x16x32_bf16 v[200:203], a[104:107], v[48:51], v[200:203]
 v_exp_f32 v19, v87
 v_mfma_f32_16x16x32_bf16 v[200:203], a[152:155], v[52:55], v[200:203]
 v_exp_f32 v16, v88
 v_mfma_f32_16x16x32_bf16 v[204:207], a[156:159], v[52:55], v[204:207]
 ds_read_b128 a[56:59], v14 offset:26624
 v_cvt_pk_bf16_f32 v59, v18, v19
 v_mfma_f32_16x16x32_bf16 v[204:207], a[108:111], v[48:51], v[204:207]
 s_add_u32 s79, s76, s58
 v_exp_f32 v17, v89
 v_mfma_f32_16x16x32_bf16 v[208:211], a[112:115], v[48:51], v[208:211]
 s_add_u32 s76, s76, 32768
 v_exp_f32 v18, v90
 v_mfma_f32_16x16x32_bf16 v[208:211], a[160:163], v[52:55], v[208:211]
 ds_read_b128 a[60:63], v14 offset:27648
 v_cvt_pk_bf16_f32 v60, v16, v17
 v_mfma_f32_16x16x32_bf16 v[212:215], a[164:167], v[52:55], v[212:215]
 ds_read_b128 a[92:95], v14 offset:31744
 v_or3_b32 v21, v21, v59, v60
 v_mfma_f32_16x16x32_bf16 v[212:215], a[116:119], v[48:51], v[212:215]
 s_and_b32 s76, s76, 0x1ffff
 v_exp_f32 v19, v91
 v_mfma_f32_16x16x32_bf16 v[216:219], a[120:123], v[48:51], v[216:219]
 v_exp_f32 v16, v92
 v_mfma_f32_16x16x32_bf16 v[216:219], a[168:171], v[52:55], v[216:219]
 ds_read_b128 a[88:91], v14 offset:30720
 v_cvt_pk_bf16_f32 v61, v18, v19
 v_mfma_f32_16x16x32_bf16 v[220:223], a[172:175], v[52:55], v[220:223]
 v_exp_f32 v17, v93
 v_mfma_f32_16x16x32_bf16 v[220:223], a[124:127], v[48:51], v[220:223]
 ds_read_b128 a[84:87], v14 offset:29696
 v_mfma_f32_16x16x32_bf16 a[188:191], v[22:25], v[48:51], a[188:191]
 ds_read_b128 a[80:83], v14 offset:28672
 v_mfma_f32_16x16x32_bf16 a[188:191], v[22:25], v[52:55], a[188:191]
 s_mov_b32 s77, s79
 v_add_u32 v14, s76, v12
L_a2w1_14:
 s_waitcnt lgkmcnt(5)
 v_mfma_f32_16x16x32_bf16 v[64:67], a[16:19], a[64:67], v[36:39]
 v_exp_f32 v18, v94
 v_mfma_f32_16x16x32_bf16 v[64:67], a[20:23], a[68:71], v[64:67]
 v_cvt_pk_bf16_f32 v62, v16, v17
 v_or3_b32 v21, v21, v61, v62
 v_mfma_f32_16x16x32_bf16 v[64:67], a[24:27], a[72:75], v[64:67]
 v_exp_f32 v19, v95
 v_mfma_f32_16x16x32_bf16 v[64:67], a[28:31], a[76:79], v[64:67]
 v_accvgpr_read_b32 v26, a176
 v_cvt_pk_bf16_f32 v63, v18, v19
 v_mfma_f32_16x16x32_bf16 v[68:71], a[44:47], a[76:79], v[36:39]
 v_rcp_f32 v26, v26
 v_mfma_f32_16x16x32_bf16 v[68:71], a[40:43], a[72:75], v[68:71]
 v_mul_f32 v26, 0x1f800000, v26
 v_or_b32 v21, v21, v63
 v_mfma_f32_16x16x32_bf16 v[68:71], a[36:39], a[68:71], v[68:71]
 v_mul_f32 v96, v96, v26
 v_mul_f32 v97, v97, v26
 v_mfma_f32_16x16x32_bf16 v[68:71], a[32:35], a[64:67], v[68:71]
 v_cvt_pk_bf16_f32 v96, v96, v97
 v_and_b32 v21, s64, v21
 v_mov_b32 v3, 4048155338
 v_cndmask_b32 v28, v3, v36, s[80:81]
 v_cndmask_b32 v29, v3, v37, s[82:83]
 v_cndmask_b32 v30, v3, v38, s[84:85]
 v_cndmask_b32 v31, v3, v39, s[86:87]
 s_nop 1
 v_mfma_f32_16x16x32_bf16 v[72:75], a[48:51], a[64:67], v[28:31]
 v_cmp_ne_u32 vcc, 0, v21
 v_mov_b32 v76, 4048155338
 v_mfma_f32_16x16x32_bf16 v[72:75], a[52:55], a[68:71], v[72:75]
 s_cbranch_vccnz L_so_68
L_sb_69:
 v_mul_f32 v98, v98, v26
 v_mul_f32 v99, v99, v26
 v_mfma_f32_16x16x32_bf16 v[72:75], a[56:59], a[72:75], v[72:75]
 s_waitcnt lgkmcnt(0)
 v_cvt_pk_bf16_f32 v97, v98, v99
 v_mov_b32 v77, 4048155338
 v_mfma_f32_16x16x32_bf16 v[72:75], a[60:63], a[76:79], v[72:75]
 s_waitcnt vmcnt(16)
 s_barrier
 s_sub_u32 s68, s68, 1
 s_cbranch_scc1 L_fo_74
L_fb_75:
 v_mfma_f32_16x16x32_bf16 v[160:163], a[96:99], v[56:59], v[160:163]
 s_mov_b32 m0, s77
 v_mul_f32 v100, v100, v26
 v_mul_f32 v101, v101, v26
 v_mfma_f32_16x16x32_bf16 v[160:163], a[144:147], v[60:63], v[160:163]
 ds_read_b128 a[96:99], v14 offset:0
 v_cvt_pk_bf16_f32 v98, v100, v101
 v_mfma_f32_16x16x32_bf16 v[164:167], a[148:151], v[60:63], v[164:167]
 buffer_load_dwordx4 v13, s[32:35], s78 offen offset:0 sc1 lds
 v_mfma_f32_16x16x32_bf16 v[164:167], a[100:103], v[56:59], v[164:167]
 ds_read_b128 a[144:147], v14 offset:8192
 v_mov_b32 v78, 4048155338
 v_mfma_f32_16x16x32_bf16 v[168:171], a[104:107], v[56:59], v[168:171]
 ds_read_b128 a[148:151], v14 offset:9216
 v_mov_b32 v79, 4048155338
 v_mfma_f32_16x16x32_bf16 v[168:171], a[152:155], v[60:63], v[168:171]
 ds_read_b128 a[100:103], v14 offset:1024
 v_mov_b32 v54, 0
 v_mov_b32 v55, 0
 v_mfma_f32_16x16x32_bf16 v[172:175], a[156:159], v[60:63], v[172:175]
 v_exp_f32 v16, v64
 v_mfma_f32_16x16x32_bf16 v[172:175], a[108:111], v[56:59], v[172:175]
 ds_read_b128 a[104:107], v14 offset:2048
 v_exp_f32 v17, v65
 v_mfma_f32_16x16x32_bf16 v[176:179], a[112:115], v[56:59], v[176:179]
 ds_read_b128 a[152:155], v14 offset:10240
 v_exp_f32 v18, v66
 v_mfma_f32_16x16x32_bf16 v[176:179], a[160:163], v[60:63], v[176:179]
 buffer_load_dwordx4 v13, s[32:35], s78 offen offset:1024 sc1 lds
 v_mfma_f32_16x16x32_bf16 v[180:183], a[164:167], v[60:63], v[180:183]
 ds_read_b128 a[156:159], v14 offset:11264
 v_cvt_pk_bf16_f32 v48, v16, v17
 v_mfma_f32_16x16x32_bf16 v[180:183], a[116:119], v[56:59], v[180:183]
 v_exp_f32 v19, v67
 v_mfma_f32_16x16x32_bf16 v[184:187], a[120:123], v[56:59], v[184:187]
 v_exp_f32 v16, v68
 v_mfma_f32_16x16x32_bf16 v[184:187], a[168:171], v[60:63], v[184:187]
 ds_read_b128 a[108:111], v14 offset:3072
 v_cvt_pk_bf16_f32 v49, v18, v19
 v_mfma_f32_16x16x32_bf16 v[188:191], a[172:175], v[60:63], v[188:191]
 v_exp_f32 v17, v69
 v_mfma_f32_16x16x32_bf16 v[188:191], a[124:127], v[56:59], v[188:191]
 v_exp_f32 v18, v70
 v_mfma_f32_16x16x32_bf16 a[184:187], v[22:25], v[56:59], a[184:187]
 ds_read_b128 a[112:115], v14 offset:4096
 v_cvt_pk_bf16_f32 v50, v16, v17
 v_mfma_f32_16x16x32_bf16 a[184:187], v[22:25], v[60:63], a[184:187]
 buffer_load_dwordx4 v13, s[32:35], s78 offen offset:2048 sc1 lds
 v_mfma_f32_16x16x32_bf16 v[80:83], a[16:19], a[192:195], v[44:47]
 ds_read_b128 a[160:163], v14 offset:12288
 v_or3_b32 v20, v48, v49, v50
 v_mfma_f32_16x16x32_bf16 v[80:83], a[20:23], a[196:199], v[80:83]
 v_exp_f32 v19, v71
 v_mfma_f32_16x16x32_bf16 v[80:83], a[24:27], a[200:203], v[80:83]
 v_exp_f32 v16, v72
 v_mfma_f32_16x16x32_bf16 v[80:83], a[28:31], a[204:207], v[80:83]
 ds_read_b128 a[164:167], v14 offset:13312
 v_cvt_pk_bf16_f32 v51, v18, v19
 v_mfma_f32_16x16x32_bf16 v[84:87], a[44:47], a[204:207], v[44:47]
 v_exp_f32 v17, v73
 v_mfma_f32_16x16x32_bf16 v[84:87], a[40:43], a[200:203], v[84:87]
 v_exp_f32 v18, v74
 v_mfma_f32_16x16x32_bf16 v[84:87], a[36:39], a[196:199], v[84:87]
 buffer_load_dwordx4 v13, s[32:35], s78 offen offset:3072 sc1 lds
 v_mfma_f32_16x16x32_bf16 v[84:87], a[32:35], a[192:195], v[84:87]
 ds_read_b128 a[116:119], v14 offset:5120
 v_cvt_pk_bf16_f32 v52, v16, v17
 v_or3_b32 v20, v20, v51, v52
 v_exp_f32 v19, v75
 s_nop 0
 v_cvt_pk_bf16_f32 v53, v18, v19
 v_or_b32 v20, v20, v53
 v_and_b32 v20, s64, v20
 v_mfma_f32_16x16x32_bf16 v[88:91], a[48:51], a[192:195], v[44:47]
 ds_read_b128 a[120:123], v14 offset:6144
 v_cmp_ne_u32 vcc, 0, v20
 v_mfma_f32_16x16x32_bf16 v[88:91], a[52:55], a[196:199], v[88:91]
 v_mul_f32 v102, v102, v26
 v_mul_f32 v103, v103, v26
 v_mfma_f32_16x16x32_bf16 v[88:91], a[56:59], a[200:203], v[88:91]
 ds_read_b128 a[168:171], v14 offset:14336
 v_cvt_pk_bf16_f32 v99, v102, v103
 v_mfma_f32_16x16x32_bf16 v[88:91], a[60:63], a[204:207], v[88:91]
 ds_read_b128 a[172:175], v14 offset:15360
 s_cbranch_vccnz L_so_70
L_sb_71:
 v_mfma_f32_16x16x32_bf16 v[92:95], a[92:95], a[204:207], v[44:47]
 ds_read_b128 a[124:127], v14 offset:7168
 v_mfma_f32_16x16x32_bf16 v[92:95], a[88:91], a[200:203], v[92:95]
 v_exp_f32 v16, v80
 v_mfma_f32_16x16x32_bf16 v[92:95], a[84:87], a[196:199], v[92:95]
 v_exp_f32 v17, v81
 v_mfma_f32_16x16x32_bf16 v[92:95], a[80:83], a[192:195], v[92:95]
 s_waitcnt lgkmcnt(5)
 buffer_store_dwordx4 v[96:99], v12, s[16:19], s72 offen offset:0 sc1
 v_mul_f32 v104, v104, v26
 v_mul_f32 v105, v105, v26
 v_cvt_pk_bf16_f32 v104, v104, v105
 v_mul_f32 v106, v106, v26
 v_mul_f32 v107, v107, v26
 v_cvt_pk_bf16_f32 v105, v106, v107
 v_mul_f32 v108, v108, v26
 v_mul_f32 v109, v109, v26
 v_cvt_pk_bf16_f32 v106, v108, v109
 v_mul_f32 v110, v110, v26
 v_mul_f32 v111, v111, v26
 v_cvt_pk_bf16_f32 v107, v110, v111
 buffer_store_dwordx4 v[104:107], v12, s[16:19], s72 offen offset:1024 sc1
 v_mul_f32 v112, v112, v26
 v_mul_f32 v113, v113, v26
 v_cvt_pk_bf16_f32 v112, v112, v113
 v_mul_f32 v114, v114, v26
 v_mul_f32 v115, v115, v26
 v_cvt_pk_bf16_f32 v113, v114, v115
 v_mul_f32 v116, v116, v26
 v_mul_f32 v117, v117, v26
 v_cvt_pk_bf16_f32 v114, v116, v117
 v_mul_f32 v118, v118, v26
 v_mul_f32 v119, v119, v26
 v_cvt_pk_bf16_f32 v115, v118, v119
 buffer_store_dwordx4 v[112:115], v12, s[16:19], s72 offen offset:2048 sc1
 v_mul_f32 v120, v120, v26
 v_mul_f32 v121, v121, v26
 v_cvt_pk_bf16_f32 v120, v120, v121
 v_mul_f32 v122, v122, v26
 v_mul_f32 v123, v123, v26
 v_cvt_pk_bf16_f32 v121, v122, v123
 v_mul_f32 v124, v124, v26
 v_mul_f32 v125, v125, v26
 v_cvt_pk_bf16_f32 v122, v124, v125
 v_mul_f32 v126, v126, v26
 v_mul_f32 v127, v127, v26
 v_cvt_pk_bf16_f32 v123, v126, v127
 buffer_store_dwordx4 v[120:123], v12, s[16:19], s72 offen offset:3072 sc1
 v_mfma_f32_16x16x32_bf16 v[128:131], a[96:99], v[48:51], v[128:131]
 s_add_u32 m0, s77, 16384
 v_exp_f32 v18, v82
 v_mfma_f32_16x16x32_bf16 v[128:131], a[144:147], v[52:55], v[128:131]
 v_cvt_pk_bf16_f32 v56, v16, v17
 v_mfma_f32_16x16x32_bf16 v[132:135], a[148:151], v[52:55], v[132:135]
 v_exp_f32 v19, v83
 v_mfma_f32_16x16x32_bf16 v[132:135], a[100:103], v[48:51], v[132:135]
 v_exp_f32 v16, v84
 v_mfma_f32_16x16x32_bf16 v[136:139], a[104:107], v[48:51], v[136:139]
 v_cvt_pk_bf16_f32 v57, v18, v19
 v_mfma_f32_16x16x32_bf16 v[136:139], a[152:155], v[52:55], v[136:139]
 v_exp_f32 v17, v85
 v_mfma_f32_16x16x32_bf16 v[140:143], a[156:159], v[52:55], v[140:143]
 v_exp_f32 v18, v86
 v_mfma_f32_16x16x32_bf16 v[140:143], a[108:111], v[48:51], v[140:143]
 s_add_u32 s78, s78, 16384
 v_cvt_pk_bf16_f32 v58, v16, v17
 v_or3_b32 v21, v56, v57, v58
 v_mfma_f32_16x16x32_bf16 v[144:147], a[112:115], v[48:51], v[144:147]
 v_exp_f32 v19, v87
 v_mfma_f32_16x16x32_bf16 v[144:147], a[160:163], v[52:55], v[144:147]
 v_exp_f32 v16, v88
 v_mfma_f32_16x16x32_bf16 v[148:151], a[164:167], v[52:55], v[148:151]
 s_waitcnt lgkmcnt(0)
 v_cvt_pk_bf16_f32 v59, v18, v19
 v_exp_f32 v17, v89
 v_mfma_f32_16x16x32_bf16 v[148:151], a[116:119], v[48:51], v[148:151]
 v_exp_f32 v18, v90
 v_mfma_f32_16x16x32_bf16 v[152:155], a[120:123], v[48:51], v[152:155]
 buffer_load_dwordx4 v13, s[12:15], s78 offen offset:0 sc1 lds
 v_mfma_f32_16x16x32_bf16 v[152:155], a[168:171], v[52:55], v[152:155]
 v_cvt_pk_bf16_f32 v60, v16, v17
 v_or3_b32 v21, v21, v59, v60
 v_mfma_f32_16x16x32_bf16 v[156:159], a[172:175], v[52:55], v[156:159]
 v_exp_f32 v19, v91
 v_mfma_f32_16x16x32_bf16 v[156:159], a[124:127], v[48:51], v[156:159]
 v_exp_f32 v16, v92
 v_mfma_f32_16x16x32_bf16 a[180:183], v[22:25], v[48:51], a[180:183]
 v_cvt_pk_bf16_f32 v61, v18, v19
 v_exp_f32 v17, v93
 v_mfma_f32_16x16x32_bf16 a[180:183], v[22:25], v[52:55], a[180:183]
 v_exp_f32 v18, v94
 v_mfma_f32_16x16x32_bf16 v[64:67], a[16:19], a[128:131], v[40:43]
 ds_read_b128 a[16:19], v14 offset:16384
 v_cvt_pk_bf16_f32 v62, v16, v17
 v_mfma_f32_16x16x32_bf16 v[64:67], a[20:23], a[132:135], v[64:67]
 buffer_load_dwordx4 v13, s[12:15], s78 offen offset:1024 sc1 lds
 v_mfma_f32_16x16x32_bf16 v[64:67], a[24:27], a[136:139], v[64:67]
 ds_read_b128 a[20:23], v14 offset:17408
 v_or3_b32 v21, v21, v61, v62
 v_mfma_f32_16x16x32_bf16 v[64:67], a[28:31], a[140:143], v[64:67]
 v_exp_f32 v19, v95
 v_mfma_f32_16x16x32_bf16 v[68:71], a[44:47], a[140:143], v[40:43]
 ds_read_b128 a[24:27], v14 offset:18432
 v_cvt_pk_bf16_f32 v63, v18, v19
 v_mfma_f32_16x16x32_bf16 v[68:71], a[40:43], a[136:139], v[68:71]
 ds_read_b128 a[28:31], v14 offset:19456
 v_or_b32 v21, v21, v63
 v_mfma_f32_16x16x32_bf16 v[68:71], a[36:39], a[132:135], v[68:71]
 ds_read_b128 a[44:47], v14 offset:23552
 v_and_b32 v21, s64, v21
 v_mfma_f32_16x16x32_bf16 v[68:71], a[32:35], a[128:131], v[68:71]
 ds_read_b128 a[40:43], v14 offset:22528
 v_cmp_ne_u32 vcc, 0, v21
 v_mfma_f32_16x16x32_bf16 v[72:75], a[48:51], a[128:131], v[40:43]
 v_exp_f32 v16, v64
 v_mfma_f32_16x16x32_bf16 v[72:75], a[52:55], a[132:135], v[72:75]
 buffer_load_dwordx4 v13, s[12:15], s78 offen offset:2048 sc1 lds
 v_mfma_f32_16x16x32_bf16 v[72:75], a[56:59], a[136:139], v[72:75]
 s_cbranch_vccnz L_so_72
L_sb_73:
 v_exp_f32 v17, v65
 v_mfma_f32_16x16x32_bf16 v[72:75], a[60:63], a[140:143], v[72:75]
 v_exp_f32 v18, v66
 v_mfma_f32_16x16x32_bf16 v[76:79], a[92:95], a[140:143], v[40:43]
 ds_read_b128 a[36:39], v14 offset:21504
 v_accvgpr_read_b32 v27, a180
 v_mfma_f32_16x16x32_bf16 v[76:79], a[88:91], a[136:139], v[76:79]
 ds_read_b128 a[32:35], v14 offset:20480
 v_cvt_pk_bf16_f32 v48, v16, v17
 v_mfma_f32_16x16x32_bf16 v[76:79], a[84:87], a[132:135], v[76:79]
 v_rcp_f32 v27, v27
 v_mfma_f32_16x16x32_bf16 v[76:79], a[80:83], a[128:131], v[76:79]
 ds_read_b128 a[48:51], v14 offset:24576
 v_mul_f32 v27, 0x1f800000, v27
 v_mfma_f32_16x16x32_bf16 v[192:195], a[96:99], v[56:59], v[192:195]
 buffer_load_dwordx4 v13, s[12:15], s78 offen offset:3072 sc1 lds
 v_mfma_f32_16x16x32_bf16 v[192:195], a[144:147], v[60:63], v[192:195]
 v_mul_f32 v128, v128, v27
 v_mul_f32 v129, v129, v27
 v_mfma_f32_16x16x32_bf16 v[196:199], a[148:151], v[60:63], v[196:199]
 v_exp_f32 v19, v67
 v_mfma_f32_16x16x32_bf16 v[196:199], a[100:103], v[56:59], v[196:199]
 ds_read_b128 a[52:55], v14 offset:25600
 v_cvt_pk_bf16_f32 v128, v128, v129
 v_mfma_f32_16x16x32_bf16 v[200:203], a[104:107], v[56:59], v[200:203]
 v_exp_f32 v16, v68
 v_mfma_f32_16x16x32_bf16 v[200:203], a[152:155], v[60:63], v[200:203]
 ds_read_b128 a[56:59], v14 offset:26624
 v_cvt_pk_bf16_f32 v49, v18, v19
 v_mfma_f32_16x16x32_bf16 v[204:207], a[156:159], v[60:63], v[204:207]
 s_add_u32 s79, s76, s58
 v_mul_f32 v130, v130, v27
 v_mul_f32 v131, v131, v27
 v_mfma_f32_16x16x32_bf16 v[204:207], a[108:111], v[56:59], v[204:207]
 s_add_u32 s76, s76, 32768
 v_exp_f32 v17, v69
 v_mfma_f32_16x16x32_bf16 v[208:211], a[112:115], v[56:59], v[208:211]
 s_and_b32 s76, s76, 0x1ffff
 v_exp_f32 v18, v70
 v_mfma_f32_16x16x32_bf16 v[208:211], a[160:163], v[60:63], v[208:211]
 ds_read_b128 a[60:63], v14 offset:27648
 v_cvt_pk_bf16_f32 v129, v130, v131
 v_mfma_f32_16x16x32_bf16 v[212:215], a[164:167], v[60:63], v[212:215]
 ds_read_b128 a[92:95], v14 offset:31744
 v_cvt_pk_bf16_f32 v50, v16, v17
 v_mfma_f32_16x16x32_bf16 v[212:215], a[116:119], v[56:59], v[212:215]
 ds_read_b128 a[88:91], v14 offset:30720
 v_or3_b32 v20, v48, v49, v50
 v_mfma_f32_16x16x32_bf16 v[216:219], a[120:123], v[56:59], v[216:219]
 v_mul_f32 v132, v132, v27
 v_mul_f32 v133, v133, v27
 v_mfma_f32_16x16x32_bf16 v[216:219], a[168:171], v[60:63], v[216:219]
 ds_read_b128 a[84:87], v14 offset:29696
 v_cvt_pk_bf16_f32 v130, v132, v133
 v_mfma_f32_16x16x32_bf16 v[220:223], a[172:175], v[60:63], v[220:223]
 v_mul_f32 v134, v134, v27
 v_mul_f32 v135, v135, v27
 v_mfma_f32_16x16x32_bf16 v[220:223], a[124:127], v[56:59], v[220:223]
 ds_read_b128 a[80:83], v14 offset:28672
 v_cvt_pk_bf16_f32 v131, v134, v135
 v_mfma_f32_16x16x32_bf16 a[188:191], v[22:25], v[56:59], a[188:191]
 v_exp_f32 v19, v71
 v_exp_f32 v16, v72
 v_mfma_f32_16x16x32_bf16 a[188:191], v[22:25], v[60:63], a[188:191]
 s_mov_b32 s77, s79
 buffer_store_dwordx4 v[128:131], v12, s[16:19], s73 offen offset:0 sc1
 v_add_u32 v14, s76, v12
 v_mul_f32 v136, v136, v27
 v_mul_f32 v137, v137, v27
 v_cvt_pk_bf16_f32 v136, v136, v137
 v_cvt_pk_bf16_f32 v51, v18, v19
 v_exp_f32 v17, v73
 v_exp_f32 v18, v74
 v_cvt_pk_bf16_f32 v52, v16, v17
 v_or3_b32 v20, v20, v51, v52
 v_exp_f32 v19, v75
 v_exp_f32 v16, v76
 v_cvt_pk_bf16_f32 v53, v18, v19
 v_exp_f32 v17, v77
 v_mul_f32 v138, v138, v27
 v_mul_f32 v139, v139, v27
 v_cvt_pk_bf16_f32 v137, v138, v139
 v_mul_f32 v140, v140, v27
 v_mul_f32 v141, v141, v27
 v_cvt_pk_bf16_f32 v138, v140, v141
 v_mul_f32 v142, v142, v27
 v_mul_f32 v143, v143, v27
 v_cvt_pk_bf16_f32 v139, v142, v143
 buffer_store_dwordx4 v[136:139], v12, s[16:19], s73 offen offset:1024 sc1
 v_mul_f32 v144, v144, v27
 v_mul_f32 v145, v145, v27
 v_cvt_pk_bf16_f32 v144, v144, v145
 v_mul_f32 v146, v146, v27
 v_mul_f32 v147, v147, v27
 v_cvt_pk_bf16_f32 v145, v146, v147
 v_mul_f32 v148, v148, v27
 v_mul_f32 v149, v149, v27
 v_cvt_pk_bf16_f32 v146, v148, v149
 v_mul_f32 v150, v150, v27
 v_mul_f32 v151, v151, v27
 v_cvt_pk_bf16_f32 v147, v150, v151
 buffer_store_dwordx4 v[144:147], v12, s[16:19], s73 offen offset:2048 sc1
 v_mul_f32 v152, v152, v27
 v_mul_f32 v153, v153, v27
 v_cvt_pk_bf16_f32 v152, v152, v153
 v_mul_f32 v154, v154, v27
 v_mul_f32 v155, v155, v27
 v_cvt_pk_bf16_f32 v153, v154, v155
 v_mul_f32 v156, v156, v27
 v_mul_f32 v157, v157, v27
 v_cvt_pk_bf16_f32 v154, v156, v157
 v_mul_f32 v158, v158, v27
 v_mul_f32 v159, v159, v27
 v_cvt_pk_bf16_f32 v155, v158, v159
 buffer_store_dwordx4 v[152:155], v12, s[16:19], s73 offen offset:3072 sc1
 s_branch L_vj_39
L_w2_37:
 s_cmp_eq_u32 s3, 2
 s_cbranch_scc0 L_w3_38
 s_waitcnt lgkmcnt(5)
 v_mfma_f32_16x16x32_bf16 v[64:67], a[16:19], a[0:3], v[32:35]
 v_exp_f32 v18, v94
 v_mfma_f32_16x16x32_bf16 v[64:67], a[20:23], a[4:7], v[64:67]
 v_cvt_pk_bf16_f32 v62, v16, v17
 v_or3_b32 v21, v21, v61, v62
 v_mfma_f32_16x16x32_bf16 v[64:67], a[24:27], a[8:11], v[64:67]
 v_exp_f32 v19, v95
 v_mfma_f32_16x16x32_bf16 v[64:67], a[28:31], a[12:15], v[64:67]
 v_cvt_pk_bf16_f32 v63, v18, v19
 v_or_b32 v21, v21, v63
 v_mfma_f32_16x16x32_bf16 v[68:71], a[44:47], a[12:15], v[32:35]
 v_and_b32 v21, s64, v21
 v_mfma_f32_16x16x32_bf16 v[68:71], a[40:43], a[8:11], v[68:71]
 v_mfma_f32_16x16x32_bf16 v[68:71], a[36:39], a[4:7], v[68:71]
 v_mfma_f32_16x16x32_bf16 v[68:71], a[32:35], a[0:3], v[68:71]
 v_cmp_ne_u32 vcc, 0, v21
 v_mov_b32 v3, 4048155338
 v_cndmask_b32 v28, v3, v32, s[80:81]
 v_cndmask_b32 v29, v3, v33, s[82:83]
 v_cndmask_b32 v30, v3, v34, s[84:85]
 v_cndmask_b32 v31, v3, v35, s[86:87]
 s_nop 1
 v_mfma_f32_16x16x32_bf16 v[72:75], a[48:51], a[0:3], v[28:31]
 v_mov_b32 v76, 4048155338
 v_mov_b32 v77, 4048155338
 v_mfma_f32_16x16x32_bf16 v[72:75], a[52:55], a[4:7], v[72:75]
 s_cbranch_vccnz L_so_76
L_sb_77:
 v_mov_b32 v78, 4048155338
 v_mov_b32 v79, 4048155338
 v_mfma_f32_16x16x32_bf16 v[72:75], a[56:59], a[8:11], v[72:75]
 s_waitcnt lgkmcnt(0)
 v_mov_b32 v54, 0
 v_mov_b32 v55, 0
 v_mfma_f32_16x16x32_bf16 v[72:75], a[60:63], a[12:15], v[72:75]
 s_waitcnt vmcnt(16)
 s_barrier
 s_sub_u32 s68, s68, 1
 s_cbranch_scc1 L_fo_84
L_fb_85:
 v_mfma_f32_16x16x32_bf16 v[160:163], a[96:99], v[56:59], v[160:163]
 s_mov_b32 m0, s77
 v_exp_f32 v16, v64
 v_mfma_f32_16x16x32_bf16 v[160:163], a[144:147], v[60:63], v[160:163]
 ds_read_b128 a[96:99], v14 offset:0
 v_exp_f32 v17, v65
 v_mfma_f32_16x16x32_bf16 v[164:167], a[148:151], v[60:63], v[164:167]
 v_exp_f32 v18, v66
 v_mfma_f32_16x16x32_bf16 v[164:167], a[100:103], v[56:59], v[164:167]
 ds_read_b128 a[144:147], v14 offset:8192
 v_cvt_pk_bf16_f32 v48, v16, v17
 v_mfma_f32_16x16x32_bf16 v[168:171], a[104:107], v[56:59], v[168:171]
 v_exp_f32 v19, v67
 v_mfma_f32_16x16x32_bf16 v[168:171], a[152:155], v[60:63], v[168:171]
 buffer_load_dwordx4 v13, s[32:35], s78 offen offset:0 sc1 lds
 v_mfma_f32_16x16x32_bf16 v[172:175], a[156:159], v[60:63], v[172:175]
 v_exp_f32 v16, v68
 v_mfma_f32_16x16x32_bf16 v[172:175], a[108:111], v[56:59], v[172:175]
 ds_read_b128 a[148:151], v14 offset:9216
 v_cvt_pk_bf16_f32 v49, v18, v19
 v_mfma_f32_16x16x32_bf16 v[176:179], a[112:115], v[56:59], v[176:179]
 v_exp_f32 v17, v69
 v_mfma_f32_16x16x32_bf16 v[176:179], a[160:163], v[60:63], v[176:179]
 v_exp_f32 v18, v70
 v_mfma_f32_16x16x32_bf16 v[180:183], a[164:167], v[60:63], v[180:183]
 ds_read_b128 a[100:103], v14 offset:1024
 v_cvt_pk_bf16_f32 v50, v16, v17
 v_mfma_f32_16x16x32_bf16 v[180:183], a[116:119], v[56:59], v[180:183]
 ds_read_b128 a[104:107], v14 offset:2048
 v_or3_b32 v20, v48, v49, v50
 v_mfma_f32_16x16x32_bf16 v[184:187], a[120:123], v[56:59], v[184:187]
 v_exp_f32 v19, v71
 v_mfma_f32_16x16x32_bf16 v[184:187], a[168:171], v[60:63], v[184:187]
 v_exp_f32 v16, v72
 v_mfma_f32_16x16x32_bf16 v[188:191], a[172:175], v[60:63], v[188:191]
 ds_read_b128 a[152:155], v14 offset:10240
 v_cvt_pk_bf16_f32 v51, v18, v19
 v_mfma_f32_16x16x32_bf16 v[188:191], a[124:127], v[56:59], v[188:191]
 buffer_load_dwordx4 v13, s[32:35], s78 offen offset:1024 sc1 lds
 v_mfma_f32_16x16x32_bf16 a[184:187], v[22:25], v[56:59], a[184:187]
 v_exp_f32 v17, v73
 v_mfma_f32_16x16x32_bf16 a[184:187], v[22:25], v[60:63], a[184:187]
 v_exp_f32 v18, v74
 v_mfma_f32_16x16x32_bf16 v[80:83], a[16:19], a[64:67], v[36:39]
 ds_read_b128 a[156:159], v14 offset:11264
 v_cvt_pk_bf16_f32 v52, v16, v17
 v_mfma_f32_16x16x32_bf16 v[80:83], a[20:23], a[68:71], v[80:83]
 ds_read_b128 a[108:111], v14 offset:3072
 v_or3_b32 v20, v20, v51, v52
 v_mfma_f32_16x16x32_bf16 v[80:83], a[24:27], a[72:75], v[80:83]
 v_exp_f32 v19, v75
 v_mfma_f32_16x16x32_bf16 v[80:83], a[28:31], a[76:79], v[80:83]
 ds_read_b128 a[112:115], v14 offset:4096
 v_cvt_pk_bf16_f32 v53, v18, v19
 v_mfma_f32_16x16x32_bf16 v[84:87], a[44:47], a[76:79], v[36:39]
 ds_read_b128 a[160:163], v14 offset:12288
 v_or_b32 v20, v20, v53
 v_mfma_f32_16x16x32_bf16 v[84:87], a[40:43], a[72:75], v[84:87]
 ds_read_b128 a[164:167], v14 offset:13312
 v_and_b32 v20, s64, v20
 v_mfma_f32_16x16x32_bf16 v[84:87], a[36:39], a[68:71], v[84:87]
 ds_read_b128 a[116:119], v14 offset:5120
 v_mfma_f32_16x16x32_bf16 v[84:87], a[32:35], a[64:67], v[84:87]
 ds_read_b128 a[120:123], v14 offset:6144
 v_cmp_ne_u32 vcc, 0, v20
 v_mfma_f32_16x16x32_bf16 v[88:91], a[48:51], a[64:67], v[36:39]
 buffer_load_dwordx4 v13, s[32:35], s78 offen offset:2048 sc1 lds
 v_mfma_f32_16x16x32_bf16 v[88:91], a[52:55], a[68:71], v[88:91]
 s_cbranch_vccnz L_so_78
L_sb_79:
 v_exp_f32 v16, v80
 v_mfma_f32_16x16x32_bf16 v[88:91], a[56:59], a[72:75], v[88:91]
 ds_read_b128 a[168:171], v14 offset:14336
 v_mfma_f32_16x16x32_bf16 v[88:91], a[60:63], a[76:79], v[88:91]
 ds_read_b128 a[172:175], v14 offset:15360
 v_mfma_f32_16x16x32_bf16 v[92:95], a[92:95], a[76:79], v[36:39]
 ds_read_b128 a[124:127], v14 offset:7168
 v_mfma_f32_16x16x32_bf16 v[92:95], a[88:91], a[72:75], v[92:95]
 v_exp_f32 v17, v81
 v_mfma_f32_16x16x32_bf16 v[92:95], a[84:87], a[68:71], v[92:95]
 v_exp_f32 v18, v82
 v_mfma_f32_16x16x32_bf16 v[92:95], a[80:83], a[64:67], v[92:95]
 s_waitcnt lgkmcnt(5)
 v_cvt_pk_bf16_f32 v56, v16, v17
 v_mfma_f32_16x16x32_bf16 v[96:99], a[96:99], v[48:51], v[96:99]
 v_exp_f32 v19, v83
 v_mfma_f32_16x16x32_bf16 v[96:99], a[144:147], v[52:55], v[96:99]
 v_exp_f32 v16, v84
 v_mfma_f32_16x16x32_bf16 v[100:103], a[148:151], v[52:55], v[100:103]
 buffer_load_dwordx4 v13, s[32:35], s78 offen offset:3072 sc1 lds
 v_mfma_f32_16x16x32_bf16 v[100:103], a[100:103], v[48:51], v[100:103]
 v_cvt_pk_bf16_f32 v57, v18, v19
 v_mfma_f32_16x16x32_bf16 v[104:107], a[104:107], v[48:51], v[104:107]
 v_exp_f32 v17, v85
 v_mfma_f32_16x16x32_bf16 v[104:107], a[152:155], v[52:55], v[104:107]
 v_exp_f32 v18, v86
 v_mfma_f32_16x16x32_bf16 v[108:111], a[156:159], v[52:55], v[108:111]
 v_cvt_pk_bf16_f32 v58, v16, v17
 v_or3_b32 v21, v56, v57, v58
 v_mfma_f32_16x16x32_bf16 v[108:111], a[108:111], v[48:51], v[108:111]
 v_exp_f32 v19, v87
 v_mfma_f32_16x16x32_bf16 v[112:115], a[112:115], v[48:51], v[112:115]
 v_exp_f32 v16, v88
 v_mfma_f32_16x16x32_bf16 v[112:115], a[160:163], v[52:55], v[112:115]
 v_cvt_pk_bf16_f32 v59, v18, v19
 v_mfma_f32_16x16x32_bf16 v[116:119], a[164:167], v[52:55], v[116:119]
 s_waitcnt lgkmcnt(0)
 v_exp_f32 v17, v89
 v_mfma_f32_16x16x32_bf16 v[116:119], a[116:119], v[48:51], v[116:119]
 v_exp_f32 v18, v90
 v_mfma_f32_16x16x32_bf16 v[120:123], a[120:123], v[48:51], v[120:123]
 v_cvt_pk_bf16_f32 v60, v16, v17
 v_or3_b32 v21, v21, v59, v60
 v_mfma_f32_16x16x32_bf16 v[120:123], a[168:171], v[52:55], v[120:123]
 v_exp_f32 v19, v91
 v_mfma_f32_16x16x32_bf16 v[124:127], a[172:175], v[52:55], v[124:127]
 v_exp_f32 v16, v92
 v_mfma_f32_16x16x32_bf16 v[124:127], a[124:127], v[48:51], v[124:127]
 s_add_u32 m0, s77, 16384
 v_cvt_pk_bf16_f32 v61, v18, v19
 v_mfma_f32_16x16x32_bf16 a[176:179], v[22:25], v[48:51], a[176:179]
 v_exp_f32 v17, v93
 v_mfma_f32_16x16x32_bf16 a[176:179], v[22:25], v[52:55], a[176:179]
 v_exp_f32 v18, v94
 v_mfma_f32_16x16x32_bf16 v[64:67], a[16:19], a[192:195], v[44:47]
 v_cvt_pk_bf16_f32 v62, v16, v17
 v_or3_b32 v21, v21, v61, v62
 v_mfma_f32_16x16x32_bf16 v[64:67], a[20:23], a[196:199], v[64:67]
 v_exp_f32 v19, v95
 v_mfma_f32_16x16x32_bf16 v[64:67], a[24:27], a[200:203], v[64:67]
 v_cvt_pk_bf16_f32 v63, v18, v19
 v_or_b32 v21, v21, v63
 v_mfma_f32_16x16x32_bf16 v[64:67], a[28:31], a[204:207], v[64:67]
 v_mfma_f32_16x16x32_bf16 v[68:71], a[44:47], a[204:207], v[44:47]
 v_mfma_f32_16x16x32_bf16 v[68:71], a[40:43], a[200:203], v[68:71]
 v_mfma_f32_16x16x32_bf16 v[68:71], a[36:39], a[196:199], v[68:71]
 v_mfma_f32_16x16x32_bf16 v[68:71], a[32:35], a[192:195], v[68:71]
 s_add_u32 s78, s78, 16384
 v_and_b32 v21, s64, v21
 v_cmp_ne_u32 vcc, 0, v21
 v_mfma_f32_16x16x32_bf16 v[72:75], a[48:51], a[192:195], v[44:47]
 v_exp_f32 v16, v64
 v_mfma_f32_16x16x32_bf16 v[72:75], a[52:55], a[196:199], v[72:75]
 v_exp_f32 v17, v65
 v_mfma_f32_16x16x32_bf16 v[72:75], a[56:59], a[200:203], v[72:75]
 v_exp_f32 v18, v66
 v_mfma_f32_16x16x32_bf16 v[72:75], a[60:63], a[204:207], v[72:75]
 s_cbranch_vccnz L_so_80
L_sb_81:
 v_cvt_pk_bf16_f32 v48, v16, v17
 v_mfma_f32_16x16x32_bf16 v[76:79], a[92:95], a[204:207], v[44:47]
 v_exp_f32 v19, v67
 v_mfma_f32_16x16x32_bf16 v[76:79], a[88:91], a[200:203], v[76:79]
 v_exp_f32 v16, v68
 v_mfma_f32_16x16x32_bf16 v[76:79], a[84:87], a[196:199], v[76:79]
 v_cvt_pk_bf16_f32 v49, v18, v19
 v_mfma_f32_16x16x32_bf16 v[76:79], a[80:83], a[192:195], v[76:79]
 v_exp_f32 v17, v69
 v_mfma_f32_16x16x32_bf16 v[128:131], a[96:99], v[56:59], v[128:131]
 v_exp_f32 v18, v70
 v_mfma_f32_16x16x32_bf16 v[128:131], a[144:147], v[60:63], v[128:131]
 v_cvt_pk_bf16_f32 v50, v16, v17
 v_or3_b32 v20, v48, v49, v50
 v_mfma_f32_16x16x32_bf16 v[132:135], a[148:151], v[60:63], v[132:135]
 v_exp_f32 v19, v71
 v_mfma_f32_16x16x32_bf16 v[132:135], a[100:103], v[56:59], v[132:135]
 v_exp_f32 v16, v72
 v_mfma_f32_16x16x32_bf16 v[136:139], a[104:107], v[56:59], v[136:139]
 v_cvt_pk_bf16_f32 v51, v18, v19
 v_mfma_f32_16x16x32_bf16 v[136:139], a[152:155], v[60:63], v[136:139]
 v_exp_f32 v17, v73
 v_mfma_f32_16x16x32_bf16 v[140:143], a[156:159], v[60:63], v[140:143]
 v_exp_f32 v18, v74
 v_mfma_f32_16x16x32_bf16 v[140:143], a[108:111], v[56:59], v[140:143]
 v_cvt_pk_bf16_f32 v52, v16, v17
 v_or3_b32 v20, v20, v51, v52
 v_mfma_f32_16x16x32_bf16 v[144:147], a[112:115], v[56:59], v[144:147]
 v_exp_f32 v19, v75
 v_mfma_f32_16x16x32_bf16 v[144:147], a[160:163], v[60:63], v[144:147]
 v_exp_f32 v16, v76
 v_mfma_f32_16x16x32_bf16 v[148:151], a[164:167], v[60:63], v[148:151]
 v_cvt_pk_bf16_f32 v53, v18, v19
 v_mfma_f32_16x16x32_bf16 v[148:151], a[116:119], v[56:59], v[148:151]
 v_exp_f32 v17, v77
 v_mfma_f32_16x16x32_bf16 v[152:155], a[120:123], v[56:59], v[152:155]
 v_exp_f32 v18, v78
 v_mfma_f32_16x16x32_bf16 v[152:155], a[168:171], v[60:63], v[152:155]
 buffer_load_dwordx4 v13, s[12:15], s78 offen offset:0 sc1 lds
 v_mfma_f32_16x16x32_bf16 v[156:159], a[172:175], v[60:63], v[156:159]
 buffer_load_dwordx4 v13, s[12:15], s78 offen offset:1024 sc1 lds
 v_mfma_f32_16x16x32_bf16 v[156:159], a[124:127], v[56:59], v[156:159]
 v_cvt_pk_bf16_f32 v54, v16, v17
 v_or3_b32 v20, v20, v53, v54
 v_mfma_f32_16x16x32_bf16 a[180:183], v[22:25], v[56:59], a[180:183]
 v_exp_f32 v19, v79
 v_mfma_f32_16x16x32_bf16 a[180:183], v[22:25], v[60:63], a[180:183]
 v_cvt_pk_bf16_f32 v55, v18, v19
 v_or_b32 v20, v20, v55
 v_mfma_f32_16x16x32_bf16 v[80:83], a[16:19], a[128:131], v[40:43]
 ds_read_b128 a[16:19], v14 offset:16384
 v_and_b32 v20, s64, v20
 v_mfma_f32_16x16x32_bf16 v[80:83], a[20:23], a[132:135], v[80:83]
 ds_read_b128 a[20:23], v14 offset:17408
 v_mfma_f32_16x16x32_bf16 v[80:83], a[24:27], a[136:139], v[80:83]
 ds_read_b128 a[24:27], v14 offset:18432
 v_mfma_f32_16x16x32_bf16 v[80:83], a[28:31], a[140:143], v[80:83]
 buffer_load_dwordx4 v13, s[12:15], s78 offen offset:2048 sc1 lds
 v_mfma_f32_16x16x32_bf16 v[84:87], a[44:47], a[140:143], v[40:43]
 ds_read_b128 a[28:31], v14 offset:19456
 v_mfma_f32_16x16x32_bf16 v[84:87], a[40:43], a[136:139], v[84:87]
 ds_read_b128 a[44:47], v14 offset:23552
 v_mfma_f32_16x16x32_bf16 v[84:87], a[36:39], a[132:135], v[84:87]
 ds_read_b128 a[40:43], v14 offset:22528
 v_mfma_f32_16x16x32_bf16 v[84:87], a[32:35], a[128:131], v[84:87]
 v_cmp_ne_u32 vcc, 0, v20
 v_mfma_f32_16x16x32_bf16 v[88:91], a[48:51], a[128:131], v[40:43]
 v_exp_f32 v16, v80
 v_mfma_f32_16x16x32_bf16 v[88:91], a[52:55], a[132:135], v[88:91]
 s_cbranch_vccnz L_so_82
L_sb_83:
 v_exp_f32 v17, v81
 v_mfma_f32_16x16x32_bf16 v[88:91], a[56:59], a[136:139], v[88:91]
 v_exp_f32 v18, v82
 v_mfma_f32_16x16x32_bf16 v[88:91], a[60:63], a[140:143], v[88:91]
 ds_read_b128 a[36:39], v14 offset:21504
 v_cvt_pk_bf16_f32 v56, v16, v17
 v_mfma_f32_16x16x32_bf16 v[92:95], a[92:95], a[140:143], v[40:43]
 v_exp_f32 v19, v83
 v_mfma_f32_16x16x32_bf16 v[92:95], a[88:91], a[136:139], v[92:95]
 buffer_load_dwordx4 v13, s[12:15], s78 offen offset:3072 sc1 lds
 v_mfma_f32_16x16x32_bf16 v[92:95], a[84:87], a[132:135], v[92:95]
 v_exp_f32 v16, v84
 v_mfma_f32_16x16x32_bf16 v[92:95], a[80:83], a[128:131], v[92:95]
 ds_read_b128 a[32:35], v14 offset:20480
 v_cvt_pk_bf16_f32 v57, v18, v19
 v_mfma_f32_16x16x32_bf16 v[192:195], a[96:99], v[48:51], v[192:195]
 v_exp_f32 v17, v85
 v_mfma_f32_16x16x32_bf16 v[192:195], a[144:147], v[52:55], v[192:195]
 v_exp_f32 v18, v86
 v_mfma_f32_16x16x32_bf16 v[196:199], a[148:151], v[52:55], v[196:199]
 ds_read_b128 a[48:51], v14 offset:24576
 v_cvt_pk_bf16_f32 v58, v16, v17
 v_mfma_f32_16x16x32_bf16 v[196:199], a[100:103], v[48:51], v[196:199]
 ds_read_b128 a[52:55], v14 offset:25600
 v_or3_b32 v21, v56, v57, v58
 v_mfma_f32_16x16x32_bf16 v[200:203], a[104:107], v[48:51], v[200:203]
 v_exp_f32 v19, v87
 v_mfma_f32_16x16x32_bf16 v[200:203], a[152:155], v[52:55], v[200:203]
 v_exp_f32 v16, v88
 v_mfma_f32_16x16x32_bf16 v[204:207], a[156:159], v[52:55], v[204:207]
 ds_read_b128 a[56:59], v14 offset:26624
 v_cvt_pk_bf16_f32 v59, v18, v19
 v_mfma_f32_16x16x32_bf16 v[204:207], a[108:111], v[48:51], v[204:207]
 s_add_u32 s79, s76, s58
 v_exp_f32 v17, v89
 v_mfma_f32_16x16x32_bf16 v[208:211], a[112:115], v[48:51], v[208:211]
 s_add_u32 s76, s76, 32768
 v_exp_f32 v18, v90
 v_mfma_f32_16x16x32_bf16 v[208:211], a[160:163], v[52:55], v[208:211]
 ds_read_b128 a[60:63], v14 offset:27648
 v_cvt_pk_bf16_f32 v60, v16, v17
 v_mfma_f32_16x16x32_bf16 v[212:215], a[164:167], v[52:55], v[212:215]
 ds_read_b128 a[92:95], v14 offset:31744
 v_or3_b32 v21, v21, v59, v60
 v_mfma_f32_16x16x32_bf16 v[212:215], a[116:119], v[48:51], v[212:215]
 s_and_b32 s76, s76, 0x1ffff
 v_exp_f32 v19, v91
 v_mfma_f32_16x16x32_bf16 v[216:219], a[120:123], v[48:51], v[216:219]
 v_exp_f32 v16, v92
 v_mfma_f32_16x16x32_bf16 v[216:219], a[168:171], v[52:55], v[216:219]
 ds_read_b128 a[88:91], v14 offset:30720
 v_cvt_pk_bf16_f32 v61, v18, v19
 v_mfma_f32_16x16x32_bf16 v[220:223], a[172:175], v[52:55], v[220:223]
 v_exp_f32 v17, v93
 v_mfma_f32_16x16x32_bf16 v[220:223], a[124:127], v[48:51], v[220:223]
 ds_read_b128 a[84:87], v14 offset:29696
 v_mfma_f32_16x16x32_bf16 a[188:191], v[22:25], v[48:51], a[188:191]
 ds_read_b128 a[80:83], v14 offset:28672
 v_mfma_f32_16x16x32_bf16 a[188:191], v[22:25], v[52:55], a[188:191]
 s_mov_b32 s77, s79
 v_add_u32 v14, s76, v12
L_a2w2_15:
 s_waitcnt lgkmcnt(5)
 v_mfma_f32_16x16x32_bf16 v[64:67], a[16:19], a[64:67], v[36:39]
 v_exp_f32 v18, v94
 v_mfma_f32_16x16x32_bf16 v[64:67], a[20:23], a[68:71], v[64:67]
 v_cvt_pk_bf16_f32 v62, v16, v17
 v_or3_b32 v21, v21, v61, v62
 v_mfma_f32_16x16x32_bf16 v[64:67], a[24:27], a[72:75], v[64:67]
 v_exp_f32 v19, v95
 v_mfma_f32_16x16x32_bf16 v[64:67], a[28:31], a[76:79], v[64:67]
 v_accvgpr_read_b32 v26, a176
 v_cvt_pk_bf16_f32 v63, v18, v19
 v_mov_b32 v3, 4048155338
 v_cndmask_b32 v28, v3, v36, s[80:81]
 v_cndmask_b32 v29, v3, v37, s[82:83]
 v_cndmask_b32 v30, v3, v38, s[84:85]
 v_cndmask_b32 v31, v3, v39, s[86:87]
 s_nop 1
 v_mfma_f32_16x16x32_bf16 v[68:71], a[44:47], a[76:79], v[28:31]
 v_rcp_f32 v26, v26
 v_mfma_f32_16x16x32_bf16 v[68:71], a[40:43], a[72:75], v[68:71]
 v_or_b32 v21, v21, v63
 v_and_b32 v21, s64, v21
 v_mfma_f32_16x16x32_bf16 v[68:71], a[36:39], a[68:71], v[68:71]
 v_mul_f32 v26, 0x1f800000, v26
 v_cmp_ne_u32 vcc, 0, v21
 v_mfma_f32_16x16x32_bf16 v[68:71], a[32:35], a[64:67], v[68:71]
 s_cbranch_vccnz L_so_86
L_sb_87:
 s_waitcnt lgkmcnt(0)
 s_waitcnt vmcnt(16)
 s_barrier
 s_sub_u32 s68, s68, 1
 s_cbranch_scc1 L_fo_92
L_fb_93:
 v_mfma_f32_16x16x32_bf16 v[160:163], a[96:99], v[56:59], v[160:163]
 s_mov_b32 m0, s77
 v_mul_f32 v96, v96, v26
 v_mul_f32 v97, v97, v26
 v_mfma_f32_16x16x32_bf16 v[160:163], a[144:147], v[60:63], v[160:163]
 buffer_load_dwordx4 v13, s[32:35], s78 offen offset:0 sc1 lds
 v_mfma_f32_16x16x32_bf16 v[164:167], a[148:151], v[60:63], v[164:167]
 ds_read_b128 a[96:99], v14 offset:0
 v_cvt_pk_bf16_f32 v96, v96, v97
 v_mfma_f32_16x16x32_bf16 v[164:167], a[100:103], v[56:59], v[164:167]
 ds_read_b128 a[144:147], v14 offset:8192
 v_mov_b32 v72, 4048155338
 v_mfma_f32_16x16x32_bf16 v[168:171], a[104:107], v[56:59], v[168:171]
 ds_read_b128 a[148:151], v14 offset:9216
 v_mov_b32 v73, 4048155338
 v_mfma_f32_16x16x32_bf16 v[168:171], a[152:155], v[60:63], v[168:171]
 ds_read_b128 a[100:103], v14 offset:1024
 v_mov_b32 v74, 4048155338
 v_mfma_f32_16x16x32_bf16 v[172:175], a[156:159], v[60:63], v[172:175]
 ds_read_b128 a[104:107], v14 offset:2048
 v_mov_b32 v75, 4048155338
 v_mfma_f32_16x16x32_bf16 v[172:175], a[108:111], v[56:59], v[172:175]
 ds_read_b128 a[152:155], v14 offset:10240
 v_mov_b32 v76, 4048155338
 v_mfma_f32_16x16x32_bf16 v[176:179], a[112:115], v[56:59], v[176:179]
 buffer_load_dwordx4 v13, s[32:35], s78 offen offset:1024 sc1 lds
 v_mfma_f32_16x16x32_bf16 v[176:179], a[160:163], v[60:63], v[176:179]
 ds_read_b128 a[156:159], v14 offset:11264
 v_mov_b32 v77, 4048155338
 v_mfma_f32_16x16x32_bf16 v[180:183], a[164:167], v[60:63], v[180:183]
 ds_read_b128 a[108:111], v14 offset:3072
 v_mov_b32 v78, 4048155338
 v_mfma_f32_16x16x32_bf16 v[180:183], a[116:119], v[56:59], v[180:183]
 ds_read_b128 a[112:115], v14 offset:4096
 v_mov_b32 v79, 4048155338
 v_mfma_f32_16x16x32_bf16 v[184:187], a[120:123], v[56:59], v[184:187]
 v_exp_f32 v16, v64
 v_mfma_f32_16x16x32_bf16 v[184:187], a[168:171], v[60:63], v[184:187]
 v_exp_f32 v17, v65
 v_mfma_f32_16x16x32_bf16 v[188:191], a[172:175], v[60:63], v[188:191]
 buffer_load_dwordx4 v13, s[32:35], s78 offen offset:2048 sc1 lds
 v_mfma_f32_16x16x32_bf16 v[188:191], a[124:127], v[56:59], v[188:191]
 v_exp_f32 v18, v66
 v_mfma_f32_16x16x32_bf16 a[184:187], v[22:25], v[56:59], a[184:187]
 ds_read_b128 a[160:163], v14 offset:12288
 v_cvt_pk_bf16_f32 v48, v16, v17
 v_mfma_f32_16x16x32_bf16 a[184:187], v[22:25], v[60:63], a[184:187]
 v_exp_f32 v19, v67
 v_mfma_f32_16x16x32_bf16 v[80:83], a[16:19], a[192:195], v[44:47]
 v_exp_f32 v16, v68
 v_mfma_f32_16x16x32_bf16 v[80:83], a[20:23], a[196:199], v[80:83]
 ds_read_b128 a[164:167], v14 offset:13312
 v_cvt_pk_bf16_f32 v49, v18, v19
 v_mfma_f32_16x16x32_bf16 v[80:83], a[24:27], a[200:203], v[80:83]
 v_exp_f32 v17, v69
 v_mfma_f32_16x16x32_bf16 v[80:83], a[28:31], a[204:207], v[80:83]
 buffer_load_dwordx4 v13, s[32:35], s78 offen offset:3072 sc1 lds
 v_mfma_f32_16x16x32_bf16 v[84:87], a[44:47], a[204:207], v[44:47]
 v_exp_f32 v18, v70
 v_mfma_f32_16x16x32_bf16 v[84:87], a[40:43], a[200:203], v[84:87]
 ds_read_b128 a[116:119], v14 offset:5120
 v_cvt_pk_bf16_f32 v50, v16, v17
 v_mfma_f32_16x16x32_bf16 v[84:87], a[36:39], a[196:199], v[84:87]
 ds_read_b128 a[120:123], v14 offset:6144
 v_or3_b32 v20, v48, v49, v50
 v_mfma_f32_16x16x32_bf16 v[84:87], a[32:35], a[192:195], v[84:87]
 v_exp_f32 v19, v71
 s_nop 0
 v_cvt_pk_bf16_f32 v51, v18, v19
 v_or_b32 v20, v20, v51
 v_and_b32 v20, s64, v20
 v_mfma_f32_16x16x32_bf16 v[88:91], a[48:51], a[192:195], v[44:47]
 ds_read_b128 a[168:171], v14 offset:14336
 v_cmp_ne_u32 vcc, 0, v20
 v_mfma_f32_16x16x32_bf16 v[88:91], a[52:55], a[196:199], v[88:91]
 v_mul_f32 v98, v98, v26
 v_mul_f32 v99, v99, v26
 v_mfma_f32_16x16x32_bf16 v[88:91], a[56:59], a[200:203], v[88:91]
 ds_read_b128 a[172:175], v14 offset:15360
 v_cvt_pk_bf16_f32 v97, v98, v99
 v_mfma_f32_16x16x32_bf16 v[88:91], a[60:63], a[204:207], v[88:91]
 s_cbranch_vccnz L_so_88
L_sb_89:
 v_mul_f32 v100, v100, v26
 v_mul_f32 v101, v101, v26
 v_mfma_f32_16x16x32_bf16 v[92:95], a[92:95], a[204:207], v[44:47]
 ds_read_b128 a[124:127], v14 offset:7168
 v_cvt_pk_bf16_f32 v98, v100, v101
 v_mfma_f32_16x16x32_bf16 v[92:95], a[88:91], a[200:203], v[92:95]
 s_add_u32 m0, s77, 16384
 v_mul_f32 v102, v102, v26
 v_mul_f32 v103, v103, v26
 v_cvt_pk_bf16_f32 v99, v102, v103
 v_mfma_f32_16x16x32_bf16 v[92:95], a[84:87], a[196:199], v[92:95]
 v_exp_f32 v16, v80
 v_mfma_f32_16x16x32_bf16 v[92:95], a[80:83], a[192:195], v[92:95]
 s_waitcnt lgkmcnt(4)
 buffer_store_dwordx4 v[96:99], v12, s[16:19], s72 offen offset:0 sc1
 v_mul_f32 v104, v104, v26
 v_mul_f32 v105, v105, v26
 v_cvt_pk_bf16_f32 v104, v104, v105
 v_mul_f32 v106, v106, v26
 v_mul_f32 v107, v107, v26
 v_cvt_pk_bf16_f32 v105, v106, v107
 v_mul_f32 v108, v108, v26
 v_mul_f32 v109, v109, v26
 v_cvt_pk_bf16_f32 v106, v108, v109
 v_mul_f32 v110, v110, v26
 v_mul_f32 v111, v111, v26
 v_cvt_pk_bf16_f32 v107, v110, v111
 buffer_store_dwordx4 v[104:107], v12, s[16:19], s72 offen offset:1024 sc1
 v_mul_f32 v112, v112, v26
 v_mul_f32 v113, v113, v26
 v_cvt_pk_bf16_f32 v112, v112, v113
 v_mul_f32 v114, v114, v26
 v_mul_f32 v115, v115, v26
 v_cvt_pk_bf16_f32 v113, v114, v115
 v_mul_f32 v116, v116, v26
 v_mul_f32 v117, v117, v26
 v_cvt_pk_bf16_f32 v114, v116, v117
 v_mul_f32 v118, v118, v26
 v_mul_f32 v119, v119, v26
 v_cvt_pk_bf16_f32 v115, v118, v119
 buffer_store_dwordx4 v[112:115], v12, s[16:19], s72 offen offset:2048 sc1
 v_mul_f32 v120, v120, v26
 v_mul_f32 v121, v121, v26
 v_cvt_pk_bf16_f32 v120, v120, v121
 v_mul_f32 v122, v122, v26
 v_mul_f32 v123, v123, v26
 v_cvt_pk_bf16_f32 v121, v122, v123
 v_mul_f32 v124, v124, v26
 v_mul_f32 v125, v125, v26
 v_cvt_pk_bf16_f32 v122, v124, v125
 v_mul_f32 v126, v126, v26
 v_mul_f32 v127, v127, v26
 v_cvt_pk_bf16_f32 v123, v126, v127
 buffer_store_dwordx4 v[120:123], v12, s[16:19], s72 offen offset:3072 sc1
 v_mfma_f32_16x16x32_bf16 v[128:131], a[96:99], v[48:51], v[128:131]
 v_exp_f32 v17, v81
 v_mfma_f32_16x16x32_bf16 v[132:135], a[100:103], v[48:51], v[132:135]
 v_exp_f32 v18, v82
 v_mfma_f32_16x16x32_bf16 v[136:139], a[104:107], v[48:51], v[136:139]
 s_add_u32 s78, s78, 16384
 v_cvt_pk_bf16_f32 v56, v16, v17
 v_exp_f32 v19, v83
 v_mfma_f32_16x16x32_bf16 v[140:143], a[108:111], v[48:51], v[140:143]
 v_exp_f32 v16, v84
 v_mfma_f32_16x16x32_bf16 v[144:147], a[112:115], v[48:51], v[144:147]
 v_cvt_pk_bf16_f32 v57, v18, v19
 v_exp_f32 v17, v85
 v_mfma_f32_16x16x32_bf16 v[148:151], a[116:119], v[48:51], v[148:151]
 s_waitcnt lgkmcnt(1)
 v_exp_f32 v18, v86
 v_mfma_f32_16x16x32_bf16 v[152:155], a[120:123], v[48:51], v[152:155]
 s_waitcnt lgkmcnt(0)
 v_cvt_pk_bf16_f32 v58, v16, v17
 v_or3_b32 v21, v56, v57, v58
 v_mfma_f32_16x16x32_bf16 v[156:159], a[124:127], v[48:51], v[156:159]
 buffer_load_dwordx4 v13, s[12:15], s78 offen offset:0 sc1 lds
 v_mfma_f32_16x16x32_bf16 a[180:183], v[22:25], v[48:51], a[180:183]
 v_exp_f32 v19, v87
 v_mfma_f32_16x16x32_bf16 v[64:67], a[16:19], a[128:131], v[40:43]
 v_exp_f32 v16, v88
 v_mfma_f32_16x16x32_bf16 v[64:67], a[20:23], a[132:135], v[64:67]
 ds_read_b128 a[16:19], v14 offset:16384
 v_cvt_pk_bf16_f32 v59, v18, v19
 v_mfma_f32_16x16x32_bf16 v[64:67], a[24:27], a[136:139], v[64:67]
 v_exp_f32 v17, v89
 v_mfma_f32_16x16x32_bf16 v[64:67], a[28:31], a[140:143], v[64:67]
 v_exp_f32 v18, v90
 v_mfma_f32_16x16x32_bf16 v[68:71], a[44:47], a[140:143], v[40:43]
 ds_read_b128 a[20:23], v14 offset:17408
 v_cvt_pk_bf16_f32 v60, v16, v17
 v_mfma_f32_16x16x32_bf16 v[68:71], a[40:43], a[136:139], v[68:71]
 ds_read_b128 a[24:27], v14 offset:18432
 v_or3_b32 v21, v21, v59, v60
 v_mfma_f32_16x16x32_bf16 v[68:71], a[36:39], a[132:135], v[68:71]
 v_exp_f32 v19, v91
 v_mfma_f32_16x16x32_bf16 v[68:71], a[32:35], a[128:131], v[68:71]
 ds_read_b128 a[28:31], v14 offset:19456
 v_exp_f32 v16, v92
 v_cvt_pk_bf16_f32 v61, v18, v19
 v_exp_f32 v17, v93
 v_exp_f32 v18, v94
 v_cvt_pk_bf16_f32 v62, v16, v17
 v_or3_b32 v21, v21, v61, v62
 v_exp_f32 v19, v95
 s_nop 0
 v_cvt_pk_bf16_f32 v63, v18, v19
 v_or_b32 v21, v21, v63
 v_and_b32 v21, s64, v21
 v_mfma_f32_16x16x32_bf16 v[72:75], a[48:51], a[128:131], v[40:43]
 ds_read_b128 a[44:47], v14 offset:23552
 v_cmp_ne_u32 vcc, 0, v21
 v_mfma_f32_16x16x32_bf16 v[72:75], a[52:55], a[132:135], v[72:75]
 buffer_load_dwordx4 v13, s[12:15], s78 offen offset:1024 sc1 lds
 v_mfma_f32_16x16x32_bf16 v[72:75], a[56:59], a[136:139], v[72:75]
 buffer_load_dwordx4 v13, s[12:15], s78 offen offset:2048 sc1 lds
 v_mfma_f32_16x16x32_bf16 v[72:75], a[60:63], a[140:143], v[72:75]
 s_cbranch_vccnz L_so_90
L_sb_91:
 v_exp_f32 v16, v64
 v_mfma_f32_16x16x32_bf16 v[76:79], a[92:95], a[140:143], v[40:43]
 ds_read_b128 a[40:43], v14 offset:22528
 v_accvgpr_read_b32 v27, a180
 v_mfma_f32_16x16x32_bf16 v[76:79], a[88:91], a[136:139], v[76:79]
 v_rcp_f32 v27, v27
 v_mfma_f32_16x16x32_bf16 v[76:79], a[84:87], a[132:135], v[76:79]
 ds_read_b128 a[36:39], v14 offset:21504
 v_mul_f32 v27, 0x1f800000, v27
 v_mfma_f32_16x16x32_bf16 v[76:79], a[80:83], a[128:131], v[76:79]
 v_mul_f32 v128, v128, v27
 v_mul_f32 v129, v129, v27
 v_mfma_f32_16x16x32_bf16 v[192:195], a[96:99], v[56:59], v[192:195]
 ds_read_b128 a[32:35], v14 offset:20480
 v_cvt_pk_bf16_f32 v128, v128, v129
 v_mfma_f32_16x16x32_bf16 v[192:195], a[144:147], v[60:63], v[192:195]
 buffer_load_dwordx4 v13, s[12:15], s78 offen offset:3072 sc1 lds
 v_mfma_f32_16x16x32_bf16 v[196:199], a[148:151], v[60:63], v[196:199]
 v_mul_f32 v130, v130, v27
 v_mul_f32 v131, v131, v27
 v_mfma_f32_16x16x32_bf16 v[196:199], a[100:103], v[56:59], v[196:199]
 ds_read_b128 a[48:51], v14 offset:24576
 v_cvt_pk_bf16_f32 v129, v130, v131
 v_mfma_f32_16x16x32_bf16 v[200:203], a[104:107], v[56:59], v[200:203]
 ds_read_b128 a[52:55], v14 offset:25600
 v_mul_f32 v132, v132, v27
 v_mul_f32 v133, v133, v27
 v_mfma_f32_16x16x32_bf16 v[200:203], a[152:155], v[60:63], v[200:203]
 ds_read_b128 a[56:59], v14 offset:26624
 v_cvt_pk_bf16_f32 v130, v132, v133
 v_mfma_f32_16x16x32_bf16 v[204:207], a[156:159], v[60:63], v[204:207]
 s_add_u32 s79, s76, s58
 v_mul_f32 v134, v134, v27
 v_mul_f32 v135, v135, v27
 v_mfma_f32_16x16x32_bf16 v[204:207], a[108:111], v[56:59], v[204:207]
 s_add_u32 s76, s76, 32768
 v_exp_f32 v17, v65
 v_mfma_f32_16x16x32_bf16 v[208:211], a[112:115], v[56:59], v[208:211]
 s_and_b32 s76, s76, 0x1ffff
 v_exp_f32 v18, v66
 v_mfma_f32_16x16x32_bf16 v[208:211], a[160:163], v[60:63], v[208:211]
 ds_read_b128 a[60:63], v14 offset:27648
 v_cvt_pk_bf16_f32 v131, v134, v135
 v_mfma_f32_16x16x32_bf16 v[212:215], a[164:167], v[60:63], v[212:215]
 ds_read_b128 a[92:95], v14 offset:31744
 v_cvt_pk_bf16_f32 v48, v16, v17
 v_mfma_f32_16x16x32_bf16 v[212:215], a[116:119], v[56:59], v[212:215]
 ds_read_b128 a[88:91], v14 offset:30720
 v_exp_f32 v19, v67
 v_mfma_f32_16x16x32_bf16 v[216:219], a[120:123], v[56:59], v[216:219]
 v_exp_f32 v16, v68
 v_mfma_f32_16x16x32_bf16 v[216:219], a[168:171], v[60:63], v[216:219]
 ds_read_b128 a[84:87], v14 offset:29696
 v_cvt_pk_bf16_f32 v49, v18, v19
 v_mfma_f32_16x16x32_bf16 v[220:223], a[172:175], v[60:63], v[220:223]
 v_exp_f32 v17, v69
 v_mfma_f32_16x16x32_bf16 v[220:223], a[124:127], v[56:59], v[220:223]
 v_exp_f32 v18, v70
 v_mfma_f32_16x16x32_bf16 a[188:191], v[22:25], v[56:59], a[188:191]
 ds_read_b128 a[80:83], v14 offset:28672
 v_cvt_pk_bf16_f32 v50, v16, v17
 v_mfma_f32_16x16x32_bf16 a[188:191], v[22:25], v[60:63], a[188:191]
 s_mov_b32 s77, s79
 buffer_store_dwordx4 v[128:131], v12, s[16:19], s73 offen offset:0 sc1
 v_add_u32 v14, s76, v12
 v_mul_f32 v136, v136, v27
 v_mul_f32 v137, v137, v27
 v_cvt_pk_bf16_f32 v136, v136, v137
 v_or3_b32 v20, v48, v49, v50
 v_exp_f32 v19, v71
 v_exp_f32 v16, v72
 v_cvt_pk_bf16_f32 v51, v18, v19
 v_exp_f32 v17, v73
 v_exp_f32 v18, v74
 v_cvt_pk_bf16_f32 v52, v16, v17
 v_or3_b32 v20, v20, v51, v52
 v_exp_f32 v19, v75
 v_exp_f32 v16, v76
 v_cvt_pk_bf16_f32 v53, v18, v19
 v_exp_f32 v17, v77
 v_mul_f32 v138, v138, v27
 v_mul_f32 v139, v139, v27
 v_cvt_pk_bf16_f32 v137, v138, v139
 v_mul_f32 v140, v140, v27
 v_mul_f32 v141, v141, v27
 v_cvt_pk_bf16_f32 v138, v140, v141
 v_mul_f32 v142, v142, v27
 v_mul_f32 v143, v143, v27
 v_cvt_pk_bf16_f32 v139, v142, v143
 buffer_store_dwordx4 v[136:139], v12, s[16:19], s73 offen offset:1024 sc1
 v_mul_f32 v144, v144, v27
 v_mul_f32 v145, v145, v27
 v_cvt_pk_bf16_f32 v144, v144, v145
 v_mul_f32 v146, v146, v27
 v_mul_f32 v147, v147, v27
 v_cvt_pk_bf16_f32 v145, v146, v147
 v_mul_f32 v148, v148, v27
 v_mul_f32 v149, v149, v27
 v_cvt_pk_bf16_f32 v146, v148, v149
 v_mul_f32 v150, v150, v27
 v_mul_f32 v151, v151, v27
 v_cvt_pk_bf16_f32 v147, v150, v151
 buffer_store_dwordx4 v[144:147], v12, s[16:19], s73 offen offset:2048 sc1
 v_mul_f32 v152, v152, v27
 v_mul_f32 v153, v153, v27
 v_cvt_pk_bf16_f32 v152, v152, v153
 v_mul_f32 v154, v154, v27
 v_mul_f32 v155, v155, v27
 v_cvt_pk_bf16_f32 v153, v154, v155
 v_mul_f32 v156, v156, v27
 v_mul_f32 v157, v157, v27
 v_cvt_pk_bf16_f32 v154, v156, v157
 v_mul_f32 v158, v158, v27
 v_mul_f32 v159, v159, v27
 v_cvt_pk_bf16_f32 v155, v158, v159
 buffer_store_dwordx4 v[152:155], v12, s[16:19], s73 offen offset:3072 sc1
 s_branch L_vj_39
L_w3_38:
 s_waitcnt lgkmcnt(5)
 v_mfma_f32_16x16x32_bf16 v[64:67], a[16:19], a[0:3], v[32:35]
 v_exp_f32 v18, v94
 v_mfma_f32_16x16x32_bf16 v[64:67], a[20:23], a[4:7], v[64:67]
 v_cvt_pk_bf16_f32 v62, v16, v17
 v_or3_b32 v21, v21, v61, v62
 v_mfma_f32_16x16x32_bf16 v[64:67], a[24:27], a[8:11], v[64:67]
 v_exp_f32 v19, v95
 v_mfma_f32_16x16x32_bf16 v[64:67], a[28:31], a[12:15], v[64:67]
 v_cvt_pk_bf16_f32 v63, v18, v19
 v_or_b32 v21, v21, v63
 v_mfma_f32_16x16x32_bf16 v[68:71], a[44:47], a[12:15], v[32:35]
 v_and_b32 v21, s64, v21
 v_mfma_f32_16x16x32_bf16 v[68:71], a[40:43], a[8:11], v[68:71]
 v_mfma_f32_16x16x32_bf16 v[68:71], a[36:39], a[4:7], v[68:71]
 v_mfma_f32_16x16x32_bf16 v[68:71], a[32:35], a[0:3], v[68:71]
 v_cmp_ne_u32 vcc, 0, v21
 v_mfma_f32_16x16x32_bf16 v[72:75], a[48:51], a[0:3], v[32:35]
 v_exp_f32 v16, v64
 v_mfma_f32_16x16x32_bf16 v[72:75], a[52:55], a[4:7], v[72:75]
 v_exp_f32 v17, v65
 v_mfma_f32_16x16x32_bf16 v[72:75], a[56:59], a[8:11], v[72:75]
 s_waitcnt lgkmcnt(0)
 v_exp_f32 v18, v66
 v_mfma_f32_16x16x32_bf16 v[72:75], a[60:63], a[12:15], v[72:75]
 s_cbranch_vccnz L_so_94
L_sb_95:
 v_cvt_pk_bf16_f32 v48, v16, v17
 v_mov_b32 v3, 4048155338
 v_cndmask_b32 v28, v3, v32, s[80:81]
 v_cndmask_b32 v29, v3, v33, s[82:83]
 v_cndmask_b32 v30, v3, v34, s[84:85]
 v_cndmask_b32 v31, v3, v35, s[86:87]
 s_nop 1
 v_mfma_f32_16x16x32_bf16 v[76:79], a[92:95], a[12:15], v[28:31]
 v_exp_f32 v19, v67
 v_mfma_f32_16x16x32_bf16 v[76:79], a[88:91], a[8:11], v[76:79]
 v_exp_f32 v16, v68
 v_mfma_f32_16x16x32_bf16 v[76:79], a[84:87], a[4:7], v[76:79]
 v_cvt_pk_bf16_f32 v49, v18, v19
 v_mfma_f32_16x16x32_bf16 v[76:79], a[80:83], a[0:3], v[76:79]
 s_waitcnt vmcnt(16)
 s_barrier
 s_sub_u32 s68, s68, 1
 s_cbranch_scc1 L_fo_102
L_fb_103:
 v_mfma_f32_16x16x32_bf16 v[160:163], a[96:99], v[56:59], v[160:163]
 v_exp_f32 v17, v69
 v_mfma_f32_16x16x32_bf16 v[160:163], a[144:147], v[60:63], v[160:163]
 v_exp_f32 v18, v70
 v_mfma_f32_16x16x32_bf16 v[164:167], a[148:151], v[60:63], v[164:167]
 ds_read_b128 a[96:99], v14 offset:0
 v_cvt_pk_bf16_f32 v50, v16, v17
 v_mfma_f32_16x16x32_bf16 v[164:167], a[100:103], v[56:59], v[164:167]
 ds_read_b128 a[144:147], v14 offset:8192
 v_or3_b32 v20, v48, v49, v50
 v_mfma_f32_16x16x32_bf16 v[168:171], a[104:107], v[56:59], v[168:171]
 s_mov_b32 m0, s77
 v_exp_f32 v19, v71
 v_mfma_f32_16x16x32_bf16 v[168:171], a[152:155], v[60:63], v[168:171]
 buffer_load_dwordx4 v13, s[32:35], s78 offen offset:0 sc1 lds
 v_mfma_f32_16x16x32_bf16 v[172:175], a[156:159], v[60:63], v[172:175]
 v_exp_f32 v16, v72
 v_mfma_f32_16x16x32_bf16 v[172:175], a[108:111], v[56:59], v[172:175]
 ds_read_b128 a[148:151], v14 offset:9216
 v_cvt_pk_bf16_f32 v51, v18, v19
 v_mfma_f32_16x16x32_bf16 v[176:179], a[112:115], v[56:59], v[176:179]
 v_exp_f32 v17, v73
 v_mfma_f32_16x16x32_bf16 v[176:179], a[160:163], v[60:63], v[176:179]
 v_exp_f32 v18, v74
 v_mfma_f32_16x16x32_bf16 v[180:183], a[164:167], v[60:63], v[180:183]
 ds_read_b128 a[100:103], v14 offset:1024
 v_cvt_pk_bf16_f32 v52, v16, v17
 v_mfma_f32_16x16x32_bf16 v[180:183], a[116:119], v[56:59], v[180:183]
 ds_read_b128 a[104:107], v14 offset:2048
 v_or3_b32 v20, v20, v51, v52
 v_mfma_f32_16x16x32_bf16 v[184:187], a[120:123], v[56:59], v[184:187]
 v_exp_f32 v19, v75
 v_mfma_f32_16x16x32_bf16 v[184:187], a[168:171], v[60:63], v[184:187]
 v_exp_f32 v16, v76
 v_mfma_f32_16x16x32_bf16 v[188:191], a[172:175], v[60:63], v[188:191]
 ds_read_b128 a[152:155], v14 offset:10240
 v_cvt_pk_bf16_f32 v53, v18, v19
 v_mfma_f32_16x16x32_bf16 v[188:191], a[124:127], v[56:59], v[188:191]
 buffer_load_dwordx4 v13, s[32:35], s78 offen offset:1024 sc1 lds
 v_mfma_f32_16x16x32_bf16 a[184:187], v[22:25], v[56:59], a[184:187]
 v_exp_f32 v17, v77
 v_mfma_f32_16x16x32_bf16 a[184:187], v[22:25], v[60:63], a[184:187]
 v_exp_f32 v18, v78
 v_mfma_f32_16x16x32_bf16 v[80:83], a[16:19], a[64:67], v[36:39]
 ds_read_b128 a[156:159], v14 offset:11264
 v_cvt_pk_bf16_f32 v54, v16, v17
 v_mfma_f32_16x16x32_bf16 v[80:83], a[20:23], a[68:71], v[80:83]
 ds_read_b128 a[108:111], v14 offset:3072
 v_or3_b32 v20, v20, v53, v54
 v_mfma_f32_16x16x32_bf16 v[80:83], a[24:27], a[72:75], v[80:83]
 v_exp_f32 v19, v79
 v_mfma_f32_16x16x32_bf16 v[80:83], a[28:31], a[76:79], v[80:83]
 ds_read_b128 a[112:115], v14 offset:4096
 v_cvt_pk_bf16_f32 v55, v18, v19
 v_mfma_f32_16x16x32_bf16 v[84:87], a[44:47], a[76:79], v[36:39]
 ds_read_b128 a[160:163], v14 offset:12288
 v_or_b32 v20, v20, v55
 v_mfma_f32_16x16x32_bf16 v[84:87], a[40:43], a[72:75], v[84:87]
 ds_read_b128 a[164:167], v14 offset:13312
 v_and_b32 v20, s64, v20
 v_mfma_f32_16x16x32_bf16 v[84:87], a[36:39], a[68:71], v[84:87]
 ds_read_b128 a[116:119], v14 offset:5120
 v_mfma_f32_16x16x32_bf16 v[84:87], a[32:35], a[64:67], v[84:87]
 ds_read_b128 a[120:123], v14 offset:6144
 v_cmp_ne_u32 vcc, 0, v20
 v_mfma_f32_16x16x32_bf16 v[88:91], a[48:51], a[64:67], v[36:39]
 buffer_load_dwordx4 v13, s[32:35], s78 offen offset:2048 sc1 lds
 v_mfma_f32_16x16x32_bf16 v[88:91], a[52:55], a[68:71], v[88:91]
 ds_read_b128 a[168:171], v14 offset:14336
 v_mfma_f32_16x16x32_bf16 v[88:91], a[56:59], a[72:75], v[88:91]
 ds_read_b128 a[172:175], v14 offset:15360
 v_mfma_f32_16x16x32_bf16 v[88:91], a[60:63], a[76:79], v[88:91]
 s_cbranch_vccnz L_so_96
L_sb_97:
 v_mfma_f32_16x16x32_bf16 v[92:95], a[92:95], a[76:79], v[36:39]
 ds_read_b128 a[124:127], v14 offset:7168
 v_mfma_f32_16x16x32_bf16 v[92:95], a[88:91], a[72:75], v[92:95]
 v_exp_f32 v16, v80
 v_mfma_f32_16x16x32_bf16 v[92:95], a[84:87], a[68:71], v[92:95]
 v_exp_f32 v17, v81
 v_mfma_f32_16x16x32_bf16 v[92:95], a[80:83], a[64:67], v[92:95]
 s_waitcnt lgkmcnt(5)
 v_exp_f32 v18, v82
 v_mfma_f32_16x16x32_bf16 v[96:99], a[96:99], v[48:51], v[96:99]
 v_cvt_pk_bf16_f32 v56, v16, v17
 v_mfma_f32_16x16x32_bf16 v[96:99], a[144:147], v[52:55], v[96:99]
 v_exp_f32 v19, v83
 v_mfma_f32_16x16x32_bf16 v[100:103], a[148:151], v[52:55], v[100:103]
 buffer_load_dwordx4 v13, s[32:35], s78 offen offset:3072 sc1 lds
 v_mfma_f32_16x16x32_bf16 v[100:103], a[100:103], v[48:51], v[100:103]
 v_exp_f32 v16, v84
 v_mfma_f32_16x16x32_bf16 v[104:107], a[104:107], v[48:51], v[104:107]
 v_cvt_pk_bf16_f32 v57, v18, v19
 v_mfma_f32_16x16x32_bf16 v[104:107], a[152:155], v[52:55], v[104:107]
 v_exp_f32 v17, v85
 v_mfma_f32_16x16x32_bf16 v[108:111], a[156:159], v[52:55], v[108:111]
 v_exp_f32 v18, v86
 v_mfma_f32_16x16x32_bf16 v[108:111], a[108:111], v[48:51], v[108:111]
 v_cvt_pk_bf16_f32 v58, v16, v17
 v_or3_b32 v21, v56, v57, v58
 v_mfma_f32_16x16x32_bf16 v[112:115], a[112:115], v[48:51], v[112:115]
 v_exp_f32 v19, v87
 v_mfma_f32_16x16x32_bf16 v[112:115], a[160:163], v[52:55], v[112:115]
 v_exp_f32 v16, v88
 v_mfma_f32_16x16x32_bf16 v[116:119], a[164:167], v[52:55], v[116:119]
 s_waitcnt lgkmcnt(0)
 v_cvt_pk_bf16_f32 v59, v18, v19
 v_mfma_f32_16x16x32_bf16 v[116:119], a[116:119], v[48:51], v[116:119]
 v_exp_f32 v17, v89
 v_mfma_f32_16x16x32_bf16 v[120:123], a[120:123], v[48:51], v[120:123]
 v_exp_f32 v18, v90
 v_mfma_f32_16x16x32_bf16 v[120:123], a[168:171], v[52:55], v[120:123]
 v_cvt_pk_bf16_f32 v60, v16, v17
 v_or3_b32 v21, v21, v59, v60
 v_mfma_f32_16x16x32_bf16 v[124:127], a[172:175], v[52:55], v[124:127]
 v_exp_f32 v19, v91
 v_mfma_f32_16x16x32_bf16 v[124:127], a[124:127], v[48:51], v[124:127]
 s_add_u32 m0, s77, 16384
 v_exp_f32 v16, v92
 v_mfma_f32_16x16x32_bf16 a[176:179], v[22:25], v[48:51], a[176:179]
 v_cvt_pk_bf16_f32 v61, v18, v19
 v_mfma_f32_16x16x32_bf16 a[176:179], v[22:25], v[52:55], a[176:179]
 v_exp_f32 v17, v93
 v_mfma_f32_16x16x32_bf16 v[64:67], a[16:19], a[192:195], v[44:47]
 v_exp_f32 v18, v94
 v_mfma_f32_16x16x32_bf16 v[64:67], a[20:23], a[196:199], v[64:67]
 v_cvt_pk_bf16_f32 v62, v16, v17
 v_or3_b32 v21, v21, v61, v62
 v_mfma_f32_16x16x32_bf16 v[64:67], a[24:27], a[200:203], v[64:67]
 v_exp_f32 v19, v95
 v_mfma_f32_16x16x32_bf16 v[64:67], a[28:31], a[204:207], v[64:67]
 v_cvt_pk_bf16_f32 v63, v18, v19
 v_or_b32 v21, v21, v63
 v_mfma_f32_16x16x32_bf16 v[68:71], a[44:47], a[204:207], v[44:47]
 v_mfma_f32_16x16x32_bf16 v[68:71], a[40:43], a[200:203], v[68:71]
 v_mfma_f32_16x16x32_bf16 v[68:71], a[36:39], a[196:199], v[68:71]
 v_mfma_f32_16x16x32_bf16 v[68:71], a[32:35], a[192:195], v[68:71]
 v_and_b32 v21, s64, v21
 v_cmp_ne_u32 vcc, 0, v21
 v_mfma_f32_16x16x32_bf16 v[72:75], a[48:51], a[192:195], v[44:47]
 v_exp_f32 v16, v64
 v_mfma_f32_16x16x32_bf16 v[72:75], a[52:55], a[196:199], v[72:75]
 v_exp_f32 v17, v65
 v_mfma_f32_16x16x32_bf16 v[72:75], a[56:59], a[200:203], v[72:75]
 v_exp_f32 v18, v66
 v_mfma_f32_16x16x32_bf16 v[72:75], a[60:63], a[204:207], v[72:75]
 s_cbranch_vccnz L_so_98
L_sb_99:
 v_cvt_pk_bf16_f32 v48, v16, v17
 v_mfma_f32_16x16x32_bf16 v[76:79], a[92:95], a[204:207], v[44:47]
 v_exp_f32 v19, v67
 v_mfma_f32_16x16x32_bf16 v[76:79], a[88:91], a[200:203], v[76:79]
 v_exp_f32 v16, v68
 v_mfma_f32_16x16x32_bf16 v[76:79], a[84:87], a[196:199], v[76:79]
 v_cvt_pk_bf16_f32 v49, v18, v19
 v_mfma_f32_16x16x32_bf16 v[76:79], a[80:83], a[192:195], v[76:79]
 v_exp_f32 v17, v69
 v_mfma_f32_16x16x32_bf16 v[128:131], a[96:99], v[56:59], v[128:131]
 v_exp_f32 v18, v70
 v_mfma_f32_16x16x32_bf16 v[128:131], a[144:147], v[60:63], v[128:131]
 v_cvt_pk_bf16_f32 v50, v16, v17
 v_or3_b32 v20, v48, v49, v50
 v_mfma_f32_16x16x32_bf16 v[132:135], a[148:151], v[60:63], v[132:135]
 v_exp_f32 v19, v71
 v_mfma_f32_16x16x32_bf16 v[132:135], a[100:103], v[56:59], v[132:135]
 v_exp_f32 v16, v72
 v_mfma_f32_16x16x32_bf16 v[136:139], a[104:107], v[56:59], v[136:139]
 v_cvt_pk_bf16_f32 v51, v18, v19
 v_mfma_f32_16x16x32_bf16 v[136:139], a[152:155], v[60:63], v[136:139]
 v_exp_f32 v17, v73
 v_mfma_f32_16x16x32_bf16 v[140:143], a[156:159], v[60:63], v[140:143]
 v_exp_f32 v18, v74
 v_mfma_f32_16x16x32_bf16 v[140:143], a[108:111], v[56:59], v[140:143]
 v_cvt_pk_bf16_f32 v52, v16, v17
 v_or3_b32 v20, v20, v51, v52
 v_mfma_f32_16x16x32_bf16 v[144:147], a[112:115], v[56:59], v[144:147]
 v_exp_f32 v19, v75
 v_mfma_f32_16x16x32_bf16 v[144:147], a[160:163], v[60:63], v[144:147]
 v_exp_f32 v16, v76
 v_mfma_f32_16x16x32_bf16 v[148:151], a[164:167], v[60:63], v[148:151]
 s_add_u32 s78, s78, 16384
 v_cvt_pk_bf16_f32 v53, v18, v19
 v_mfma_f32_16x16x32_bf16 v[148:151], a[116:119], v[56:59], v[148:151]
 buffer_load_dwordx4 v13, s[12:15], s78 offen offset:0 sc1 lds
 v_mfma_f32_16x16x32_bf16 v[152:155], a[120:123], v[56:59], v[152:155]
 buffer_load_dwordx4 v13, s[12:15], s78 offen offset:1024 sc1 lds
 v_mfma_f32_16x16x32_bf16 v[152:155], a[168:171], v[60:63], v[152:155]
 v_exp_f32 v17, v77
 v_mfma_f32_16x16x32_bf16 v[156:159], a[172:175], v[60:63], v[156:159]
 v_exp_f32 v18, v78
 v_mfma_f32_16x16x32_bf16 v[156:159], a[124:127], v[56:59], v[156:159]
 v_cvt_pk_bf16_f32 v54, v16, v17
 v_or3_b32 v20, v20, v53, v54
 v_mfma_f32_16x16x32_bf16 a[180:183], v[22:25], v[56:59], a[180:183]
 v_exp_f32 v19, v79
 v_mfma_f32_16x16x32_bf16 a[180:183], v[22:25], v[60:63], a[180:183]
 v_cvt_pk_bf16_f32 v55, v18, v19
 v_or_b32 v20, v20, v55
 v_mfma_f32_16x16x32_bf16 v[80:83], a[16:19], a[128:131], v[40:43]
 ds_read_b128 a[16:19], v14 offset:16384
 v_and_b32 v20, s64, v20
 v_mfma_f32_16x16x32_bf16 v[80:83], a[20:23], a[132:135], v[80:83]
 ds_read_b128 a[20:23], v14 offset:17408
 v_mfma_f32_16x16x32_bf16 v[80:83], a[24:27], a[136:139], v[80:83]
 ds_read_b128 a[24:27], v14 offset:18432
 v_mfma_f32_16x16x32_bf16 v[80:83], a[28:31], a[140:143], v[80:83]
 buffer_load_dwordx4 v13, s[12:15], s78 offen offset:2048 sc1 lds
 v_mfma_f32_16x16x32_bf16 v[84:87], a[44:47], a[140:143], v[40:43]
 ds_read_b128 a[28:31], v14 offset:19456
 v_mfma_f32_16x16x32_bf16 v[84:87], a[40:43], a[136:139], v[84:87]
 ds_read_b128 a[44:47], v14 offset:23552
 v_mfma_f32_16x16x32_bf16 v[84:87], a[36:39], a[132:135], v[84:87]
 ds_read_b128 a[40:43], v14 offset:22528
 v_mfma_f32_16x16x32_bf16 v[84:87], a[32:35], a[128:131], v[84:87]
 v_cmp_ne_u32 vcc, 0, v20
 v_mfma_f32_16x16x32_bf16 v[88:91], a[48:51], a[128:131], v[40:43]
 v_exp_f32 v16, v80
 v_mfma_f32_16x16x32_bf16 v[88:91], a[52:55], a[132:135], v[88:91]
 s_cbranch_vccnz L_so_100
L_sb_101:
 v_exp_f32 v17, v81
 v_mfma_f32_16x16x32_bf16 v[88:91], a[56:59], a[136:139], v[88:91]
 v_exp_f32 v18, v82
 v_mfma_f32_16x16x32_bf16 v[88:91], a[60:63], a[140:143], v[88:91]
 ds_read_b128 a[36:39], v14 offset:21504
 v_cvt_pk_bf16_f32 v56, v16, v17
 v_mfma_f32_16x16x32_bf16 v[92:95], a[92:95], a[140:143], v[40:43]
 v_exp_f32 v19, v83
 v_mfma_f32_16x16x32_bf16 v[92:95], a[88:91], a[136:139], v[92:95]
 buffer_load_dwordx4 v13, s[12:15], s78 offen offset:3072 sc1 lds
 v_mfma_f32_16x16x32_bf16 v[92:95], a[84:87], a[132:135], v[92:95]
 v_exp_f32 v16, v84
 v_mfma_f32_16x16x32_bf16 v[92:95], a[80:83], a[128:131], v[92:95]
 ds_read_b128 a[32:35], v14 offset:20480
 v_cvt_pk_bf16_f32 v57, v18, v19
 v_mfma_f32_16x16x32_bf16 v[192:195], a[96:99], v[48:51], v[192:195]
 v_exp_f32 v17, v85
 v_mfma_f32_16x16x32_bf16 v[192:195], a[144:147], v[52:55], v[192:195]
 v_exp_f32 v18, v86
 v_mfma_f32_16x16x32_bf16 v[196:199], a[148:151], v[52:55], v[196:199]
 ds_read_b128 a[48:51], v14 offset:24576
 v_cvt_pk_bf16_f32 v58, v16, v17
 v_mfma_f32_16x16x32_bf16 v[196:199], a[100:103], v[48:51], v[196:199]
 ds_read_b128 a[52:55], v14 offset:25600
 v_or3_b32 v21, v56, v57, v58
 v_mfma_f32_16x16x32_bf16 v[200:203], a[104:107], v[48:51], v[200:203]
 v_exp_f32 v19, v87
 v_mfma_f32_16x16x32_bf16 v[200:203], a[152:155], v[52:55], v[200:203]
 v_exp_f32 v16, v88
 v_mfma_f32_16x16x32_bf16 v[204:207], a[156:159], v[52:55], v[204:207]
 ds_read_b128 a[56:59], v14 offset:26624
 v_cvt_pk_bf16_f32 v59, v18, v19
 v_mfma_f32_16x16x32_bf16 v[204:207], a[108:111], v[48:51], v[204:207]
 s_add_u32 s79, s76, s58
 v_exp_f32 v17, v89
 v_mfma_f32_16x16x32_bf16 v[208:211], a[112:115], v[48:51], v[208:211]
 s_add_u32 s76, s76, 32768
 v_exp_f32 v18, v90
 v_mfma_f32_16x16x32_bf16 v[208:211], a[160:163], v[52:55], v[208:211]
 ds_read_b128 a[60:63], v14 offset:27648
 v_cvt_pk_bf16_f32 v60, v16, v17
 v_mfma_f32_16x16x32_bf16 v[212:215], a[164:167], v[52:55], v[212:215]
 ds_read_b128 a[92:95], v14 offset:31744
 v_or3_b32 v21, v21, v59, v60
 v_mfma_f32_16x16x32_bf16 v[212:215], a[116:119], v[48:51], v[212:215]
 s_and_b32 s76, s76, 0x1ffff
 v_exp_f32 v19, v91
 v_mfma_f32_16x16x32_bf16 v[216:219], a[120:123], v[48:51], v[216:219]
 v_exp_f32 v16, v92
 v_mfma_f32_16x16x32_bf16 v[216:219], a[168:171], v[52:55], v[216:219]
 ds_read_b128 a[88:91], v14 offset:30720
 v_cvt_pk_bf16_f32 v61, v18, v19
 v_mfma_f32_16x16x32_bf16 v[220:223], a[172:175], v[52:55], v[220:223]
 v_exp_f32 v17, v93
 v_mfma_f32_16x16x32_bf16 v[220:223], a[124:127], v[48:51], v[220:223]
 ds_read_b128 a[84:87], v14 offset:29696
 v_mfma_f32_16x16x32_bf16 a[188:191], v[22:25], v[48:51], a[188:191]
 ds_read_b128 a[80:83], v14 offset:28672
 v_mfma_f32_16x16x32_bf16 a[188:191], v[22:25], v[52:55], a[188:191]
 s_mov_b32 s77, s79
 v_add_u32 v14, s76, v12
L_a2w3_16:
 s_waitcnt lgkmcnt(5)
 v_mov_b32 v3, 4048155338
 v_cndmask_b32 v28, v3, v36, s[80:81]
 v_cndmask_b32 v29, v3, v37, s[82:83]
 v_cndmask_b32 v30, v3, v38, s[84:85]
 v_cndmask_b32 v31, v3, v39, s[86:87]
 s_nop 1
 v_mfma_f32_16x16x32_bf16 v[64:67], a[16:19], a[64:67], v[28:31]
 v_exp_f32 v18, v94
 v_mfma_f32_16x16x32_bf16 v[64:67], a[20:23], a[68:71], v[64:67]
 v_cvt_pk_bf16_f32 v62, v16, v17
 v_or3_b32 v21, v21, v61, v62
 v_exp_f32 v19, v95
 s_nop 0
 v_cvt_pk_bf16_f32 v63, v18, v19
 v_or_b32 v21, v21, v63
 v_and_b32 v21, s64, v21
 v_mfma_f32_16x16x32_bf16 v[64:67], a[24:27], a[72:75], v[64:67]
 v_accvgpr_read_b32 v26, a176
 v_cmp_ne_u32 vcc, 0, v21
 v_mfma_f32_16x16x32_bf16 v[64:67], a[28:31], a[76:79], v[64:67]
 s_cbranch_vccnz L_so_104
L_sb_105:
 s_waitcnt lgkmcnt(0)
 s_waitcnt vmcnt(16)
 s_barrier
 s_sub_u32 s68, s68, 1
 s_cbranch_scc1 L_fo_110
L_fb_111:
 v_mfma_f32_16x16x32_bf16 v[160:163], a[96:99], v[56:59], v[160:163]
 s_mov_b32 m0, s77
 v_rcp_f32 v26, v26
 v_mfma_f32_16x16x32_bf16 v[160:163], a[144:147], v[60:63], v[160:163]
 buffer_load_dwordx4 v13, s[32:35], s78 offen offset:0 sc1 lds
 v_mfma_f32_16x16x32_bf16 v[164:167], a[148:151], v[60:63], v[164:167]
 ds_read_b128 a[96:99], v14 offset:0
 v_mul_f32 v26, 0x1f800000, v26
 v_mfma_f32_16x16x32_bf16 v[164:167], a[100:103], v[56:59], v[164:167]
 ds_read_b128 a[144:147], v14 offset:8192
 v_mov_b32 v68, 4048155338
 v_mfma_f32_16x16x32_bf16 v[168:171], a[104:107], v[56:59], v[168:171]
 v_mul_f32 v96, v96, v26
 v_mul_f32 v97, v97, v26
 v_mfma_f32_16x16x32_bf16 v[168:171], a[152:155], v[60:63], v[168:171]
 v_cvt_pk_bf16_f32 v96, v96, v97
 v_mov_b32 v69, 4048155338
 v_mfma_f32_16x16x32_bf16 v[172:175], a[156:159], v[60:63], v[172:175]
 ds_read_b128 a[148:151], v14 offset:9216
 v_mov_b32 v70, 4048155338
 v_mfma_f32_16x16x32_bf16 v[172:175], a[108:111], v[56:59], v[172:175]
 ds_read_b128 a[100:103], v14 offset:1024
 v_mov_b32 v71, 4048155338
 v_mfma_f32_16x16x32_bf16 v[176:179], a[112:115], v[56:59], v[176:179]
 buffer_load_dwordx4 v13, s[32:35], s78 offen offset:1024 sc1 lds
 v_mfma_f32_16x16x32_bf16 v[176:179], a[160:163], v[60:63], v[176:179]
 ds_read_b128 a[104:107], v14 offset:2048
 v_mov_b32 v72, 4048155338
 v_mfma_f32_16x16x32_bf16 v[180:183], a[164:167], v[60:63], v[180:183]
 ds_read_b128 a[152:155], v14 offset:10240
 v_mov_b32 v73, 4048155338
 v_mfma_f32_16x16x32_bf16 v[180:183], a[116:119], v[56:59], v[180:183]
 ds_read_b128 a[156:159], v14 offset:11264
 v_mov_b32 v74, 4048155338
 v_mfma_f32_16x16x32_bf16 v[184:187], a[120:123], v[56:59], v[184:187]
 ds_read_b128 a[108:111], v14 offset:3072
 v_mov_b32 v75, 4048155338
 v_mfma_f32_16x16x32_bf16 v[184:187], a[168:171], v[60:63], v[184:187]
 ds_read_b128 a[112:115], v14 offset:4096
 v_mov_b32 v76, 4048155338
 v_mfma_f32_16x16x32_bf16 v[188:191], a[172:175], v[60:63], v[188:191]
 buffer_load_dwordx4 v13, s[32:35], s78 offen offset:2048 sc1 lds
 v_mfma_f32_16x16x32_bf16 v[188:191], a[124:127], v[56:59], v[188:191]
 ds_read_b128 a[160:163], v14 offset:12288
 v_mov_b32 v77, 4048155338
 v_mfma_f32_16x16x32_bf16 a[184:187], v[22:25], v[56:59], a[184:187]
 ds_read_b128 a[164:167], v14 offset:13312
 v_mov_b32 v78, 4048155338
 v_mfma_f32_16x16x32_bf16 a[184:187], v[22:25], v[60:63], a[184:187]
 ds_read_b128 a[116:119], v14 offset:5120
 v_mov_b32 v79, 4048155338
 v_mfma_f32_16x16x32_bf16 v[80:83], a[16:19], a[192:195], v[44:47]
 v_mov_b32 v50, 0
 v_mov_b32 v51, 0
 v_mfma_f32_16x16x32_bf16 v[80:83], a[20:23], a[196:199], v[80:83]
 v_exp_f32 v16, v64
 v_mfma_f32_16x16x32_bf16 v[80:83], a[24:27], a[200:203], v[80:83]
 v_exp_f32 v17, v65
 v_mfma_f32_16x16x32_bf16 v[80:83], a[28:31], a[204:207], v[80:83]
 buffer_load_dwordx4 v13, s[32:35], s78 offen offset:3072 sc1 lds
 v_mfma_f32_16x16x32_bf16 v[84:87], a[44:47], a[204:207], v[44:47]
 v_exp_f32 v18, v66
 v_mfma_f32_16x16x32_bf16 v[84:87], a[40:43], a[200:203], v[84:87]
 ds_read_b128 a[120:123], v14 offset:6144
 v_cvt_pk_bf16_f32 v48, v16, v17
 v_mfma_f32_16x16x32_bf16 v[84:87], a[36:39], a[196:199], v[84:87]
 v_exp_f32 v19, v67
 v_mfma_f32_16x16x32_bf16 v[84:87], a[32:35], a[192:195], v[84:87]
 v_cvt_pk_bf16_f32 v49, v18, v19
 v_or_b32 v20, v48, v49
 v_and_b32 v20, s64, v20
 v_mfma_f32_16x16x32_bf16 v[88:91], a[48:51], a[192:195], v[44:47]
 ds_read_b128 a[168:171], v14 offset:14336
 v_cmp_ne_u32 vcc, 0, v20
 v_mfma_f32_16x16x32_bf16 v[88:91], a[52:55], a[196:199], v[88:91]
 v_mul_f32 v98, v98, v26
 v_mul_f32 v99, v99, v26
 v_mfma_f32_16x16x32_bf16 v[88:91], a[56:59], a[200:203], v[88:91]
 ds_read_b128 a[172:175], v14 offset:15360
 v_cvt_pk_bf16_f32 v97, v98, v99
 v_mfma_f32_16x16x32_bf16 v[88:91], a[60:63], a[204:207], v[88:91]
 s_cbranch_vccnz L_so_106
L_sb_107:
 v_mul_f32 v100, v100, v26
 v_mul_f32 v101, v101, v26
 v_mfma_f32_16x16x32_bf16 v[92:95], a[92:95], a[204:207], v[44:47]
 ds_read_b128 a[124:127], v14 offset:7168
 v_cvt_pk_bf16_f32 v98, v100, v101
 v_mfma_f32_16x16x32_bf16 v[92:95], a[88:91], a[200:203], v[92:95]
 s_add_u32 m0, s77, 16384
 v_mul_f32 v102, v102, v26
 v_mul_f32 v103, v103, v26
 v_cvt_pk_bf16_f32 v99, v102, v103
 v_mfma_f32_16x16x32_bf16 v[92:95], a[84:87], a[196:199], v[92:95]
 v_exp_f32 v16, v80
 v_mfma_f32_16x16x32_bf16 v[92:95], a[80:83], a[192:195], v[92:95]
 s_waitcnt lgkmcnt(3)
 buffer_store_dwordx4 v[96:99], v12, s[16:19], s72 offen offset:0 sc1
 v_mul_f32 v104, v104, v26
 v_mul_f32 v105, v105, v26
 v_cvt_pk_bf16_f32 v104, v104, v105
 v_mul_f32 v106, v106, v26
 v_mul_f32 v107, v107, v26
 v_cvt_pk_bf16_f32 v105, v106, v107
 v_mul_f32 v108, v108, v26
 v_mul_f32 v109, v109, v26
 v_cvt_pk_bf16_f32 v106, v108, v109
 v_mul_f32 v110, v110, v26
 v_mul_f32 v111, v111, v26
 v_cvt_pk_bf16_f32 v107, v110, v111
 buffer_store_dwordx4 v[104:107], v12, s[16:19], s72 offen offset:1024 sc1
 v_mul_f32 v112, v112, v26
 v_mul_f32 v113, v113, v26
 v_cvt_pk_bf16_f32 v112, v112, v113
 v_mul_f32 v114, v114, v26
 v_mul_f32 v115, v115, v26
 v_cvt_pk_bf16_f32 v113, v114, v115
 v_mul_f32 v116, v116, v26
 v_mul_f32 v117, v117, v26
 v_cvt_pk_bf16_f32 v114, v116, v117
 v_mul_f32 v118, v118, v26
 v_mul_f32 v119, v119, v26
 v_cvt_pk_bf16_f32 v115, v118, v119
 buffer_store_dwordx4 v[112:115], v12, s[16:19], s72 offen offset:2048 sc1
 v_mul_f32 v120, v120, v26
 v_mul_f32 v121, v121, v26
 v_cvt_pk_bf16_f32 v120, v120, v121
 v_mul_f32 v122, v122, v26
 v_mul_f32 v123, v123, v26
 v_cvt_pk_bf16_f32 v121, v122, v123
 v_mul_f32 v124, v124, v26
 v_mul_f32 v125, v125, v26
 v_cvt_pk_bf16_f32 v122, v124, v125
 v_mul_f32 v126, v126, v26
 v_mul_f32 v127, v127, v26
 v_cvt_pk_bf16_f32 v123, v126, v127
 buffer_store_dwordx4 v[120:123], v12, s[16:19], s72 offen offset:3072 sc1
 v_mfma_f32_16x16x32_bf16 v[128:131], a[96:99], v[48:51], v[128:131]
 v_exp_f32 v17, v81
 v_mfma_f32_16x16x32_bf16 v[132:135], a[100:103], v[48:51], v[132:135]
 v_exp_f32 v18, v82
 v_mfma_f32_16x16x32_bf16 v[136:139], a[104:107], v[48:51], v[136:139]
 s_add_u32 s78, s78, 16384
 v_cvt_pk_bf16_f32 v56, v16, v17
 v_exp_f32 v19, v83
 v_mfma_f32_16x16x32_bf16 v[140:143], a[108:111], v[48:51], v[140:143]
 v_exp_f32 v16, v84
 v_mfma_f32_16x16x32_bf16 v[144:147], a[112:115], v[48:51], v[144:147]
 v_cvt_pk_bf16_f32 v57, v18, v19
 v_exp_f32 v17, v85
 v_mfma_f32_16x16x32_bf16 v[148:151], a[116:119], v[48:51], v[148:151]
 v_exp_f32 v18, v86
 v_mfma_f32_16x16x32_bf16 v[152:155], a[120:123], v[48:51], v[152:155]
 s_waitcnt lgkmcnt(0)
 v_cvt_pk_bf16_f32 v58, v16, v17
 v_or3_b32 v21, v56, v57, v58
 v_mfma_f32_16x16x32_bf16 v[156:159], a[124:127], v[48:51], v[156:159]
 buffer_load_dwordx4 v13, s[12:15], s78 offen offset:0 sc1 lds
 v_mfma_f32_16x16x32_bf16 a[180:183], v[22:25], v[48:51], a[180:183]
 v_exp_f32 v19, v87
 v_mfma_f32_16x16x32_bf16 v[64:67], a[16:19], a[128:131], v[40:43]
 v_exp_f32 v16, v88
 v_mfma_f32_16x16x32_bf16 v[64:67], a[20:23], a[132:135], v[64:67]
 ds_read_b128 a[16:19], v14 offset:16384
 v_cvt_pk_bf16_f32 v59, v18, v19
 v_mfma_f32_16x16x32_bf16 v[64:67], a[24:27], a[136:139], v[64:67]
 v_exp_f32 v17, v89
 v_mfma_f32_16x16x32_bf16 v[64:67], a[28:31], a[140:143], v[64:67]
 v_exp_f32 v18, v90
 v_mfma_f32_16x16x32_bf16 v[68:71], a[44:47], a[140:143], v[40:43]
 ds_read_b128 a[20:23], v14 offset:17408
 v_cvt_pk_bf16_f32 v60, v16, v17
 v_mfma_f32_16x16x32_bf16 v[68:71], a[40:43], a[136:139], v[68:71]
 ds_read_b128 a[24:27], v14 offset:18432
 v_or3_b32 v21, v21, v59, v60
 v_mfma_f32_16x16x32_bf16 v[68:71], a[36:39], a[132:135], v[68:71]
 v_exp_f32 v19, v91
 v_mfma_f32_16x16x32_bf16 v[68:71], a[32:35], a[128:131], v[68:71]
 ds_read_b128 a[28:31], v14 offset:19456
 v_exp_f32 v16, v92
 v_cvt_pk_bf16_f32 v61, v18, v19
 v_exp_f32 v17, v93
 v_exp_f32 v18, v94
 v_cvt_pk_bf16_f32 v62, v16, v17
 v_or3_b32 v21, v21, v61, v62
 v_exp_f32 v19, v95
 s_nop 0
 v_cvt_pk_bf16_f32 v63, v18, v19
 v_or_b32 v21, v21, v63
 v_and_b32 v21, s64, v21
 v_mfma_f32_16x16x32_bf16 v[72:75], a[48:51], a[128:131], v[40:43]
 ds_read_b128 a[44:47], v14 offset:23552
 v_cmp_ne_u32 vcc, 0, v21
 v_mfma_f32_16x16x32_bf16 v[72:75], a[52:55], a[132:135], v[72:75]
 buffer_load_dwordx4 v13, s[12:15], s78 offen offset:1024 sc1 lds
 v_mfma_f32_16x16x32_bf16 v[72:75], a[56:59], a[136:139], v[72:75]
 buffer_load_dwordx4 v13, s[12:15], s78 offen offset:2048 sc1 lds
 v_mfma_f32_16x16x32_bf16 v[72:75], a[60:63], a[140:143], v[72:75]
 s_cbranch_vccnz L_so_108
L_sb_109:
 v_exp_f32 v16, v64
 v_mfma_f32_16x16x32_bf16 v[76:79], a[92:95], a[140:143], v[40:43]
 ds_read_b128 a[40:43], v14 offset:22528
 v_accvgpr_read_b32 v27, a180
 v_mfma_f32_16x16x32_bf16 v[76:79], a[88:91], a[136:139], v[76:79]
 v_rcp_f32 v27, v27
 v_mfma_f32_16x16x32_bf16 v[76:79], a[84:87], a[132:135], v[76:79]
 ds_read_b128 a[36:39], v14 offset:21504
 v_mul_f32 v27, 0x1f800000, v27
 v_mfma_f32_16x16x32_bf16 v[76:79], a[80:83], a[128:131], v[76:79]
 v_mul_f32 v128, v128, v27
 v_mul_f32 v129, v129, v27
 v_mfma_f32_16x16x32_bf16 v[192:195], a[96:99], v[56:59], v[192:195]
 ds_read_b128 a[32:35], v14 offset:20480
 v_cvt_pk_bf16_f32 v128, v128, v129
 v_mfma_f32_16x16x32_bf16 v[192:195], a[144:147], v[60:63], v[192:195]
 buffer_load_dwordx4 v13, s[12:15], s78 offen offset:3072 sc1 lds
 v_mfma_f32_16x16x32_bf16 v[196:199], a[148:151], v[60:63], v[196:199]
 v_mul_f32 v130, v130, v27
 v_mul_f32 v131, v131, v27
 v_mfma_f32_16x16x32_bf16 v[196:199], a[100:103], v[56:59], v[196:199]
 ds_read_b128 a[48:51], v14 offset:24576
 v_cvt_pk_bf16_f32 v129, v130, v131
 v_mfma_f32_16x16x32_bf16 v[200:203], a[104:107], v[56:59], v[200:203]
 ds_read_b128 a[52:55], v14 offset:25600
 v_mul_f32 v132, v132, v27
 v_mul_f32 v133, v133, v27
 v_mfma_f32_16x16x32_bf16 v[200:203], a[152:155], v[60:63], v[200:203]
 ds_read_b128 a[56:59], v14 offset:26624
 v_cvt_pk_bf16_f32 v130, v132, v133
 v_mfma_f32_16x16x32_bf16 v[204:207], a[156:159], v[60:63], v[204:207]
 s_add_u32 s79, s76, s58
 v_mul_f32 v134, v134, v27
 v_mul_f32 v135, v135, v27
 v_mfma_f32_16x16x32_bf16 v[204:207], a[108:111], v[56:59], v[204:207]
 s_add_u32 s76, s76, 32768
 v_exp_f32 v17, v65
 v_mfma_f32_16x16x32_bf16 v[208:211], a[112:115], v[56:59], v[208:211]
 s_and_b32 s76, s76, 0x1ffff
 v_exp_f32 v18, v66
 v_mfma_f32_16x16x32_bf16 v[208:211], a[160:163], v[60:63], v[208:211]
 ds_read_b128 a[60:63], v14 offset:27648
 v_cvt_pk_bf16_f32 v131, v134, v135
 v_mfma_f32_16x16x32_bf16 v[212:215], a[164:167], v[60:63], v[212:215]
 ds_read_b128 a[92:95], v14 offset:31744
 v_cvt_pk_bf16_f32 v48, v16, v17
 v_mfma_f32_16x16x32_bf16 v[212:215], a[116:119], v[56:59], v[212:215]
 ds_read_b128 a[88:91], v14 offset:30720
 v_exp_f32 v19, v67
 v_mfma_f32_16x16x32_bf16 v[216:219], a[120:123], v[56:59], v[216:219]
 v_exp_f32 v16, v68
 v_mfma_f32_16x16x32_bf16 v[216:219], a[168:171], v[60:63], v[216:219]
 ds_read_b128 a[84:87], v14 offset:29696
 v_cvt_pk_bf16_f32 v49, v18, v19
 v_mfma_f32_16x16x32_bf16 v[220:223], a[172:175], v[60:63], v[220:223]
 v_exp_f32 v17, v69
 v_mfma_f32_16x16x32_bf16 v[220:223], a[124:127], v[56:59], v[220:223]
 v_exp_f32 v18, v70
 v_mfma_f32_16x16x32_bf16 a[188:191], v[22:25], v[56:59], a[188:191]
 ds_read_b128 a[80:83], v14 offset:28672
 v_cvt_pk_bf16_f32 v50, v16, v17
 v_mfma_f32_16x16x32_bf16 a[188:191], v[22:25], v[60:63], a[188:191]
 s_mov_b32 s77, s79
 buffer_store_dwordx4 v[128:131], v12, s[16:19], s73 offen offset:0 sc1
 v_add_u32 v14, s76, v12
 v_mul_f32 v136, v136, v27
 v_mul_f32 v137, v137, v27
 v_cvt_pk_bf16_f32 v136, v136, v137
 v_or3_b32 v20, v48, v49, v50
 v_exp_f32 v19, v71
 v_exp_f32 v16, v72
 v_cvt_pk_bf16_f32 v51, v18, v19
 v_exp_f32 v17, v73
 v_exp_f32 v18, v74
 v_cvt_pk_bf16_f32 v52, v16, v17
 v_or3_b32 v20, v20, v51, v52
 v_exp_f32 v19, v75
 v_exp_f32 v16, v76
 v_cvt_pk_bf16_f32 v53, v18, v19
 v_exp_f32 v17, v77
 v_mul_f32 v138, v138, v27
 v_mul_f32 v139, v139, v27
 v_cvt_pk_bf16_f32 v137, v138, v139
 v_mul_f32 v140, v140, v27
 v_mul_f32 v141, v141, v27
 v_cvt_pk_bf16_f32 v138, v140, v141
 v_mul_f32 v142, v142, v27
 v_mul_f32 v143, v143, v27
 v_cvt_pk_bf16_f32 v139, v142, v143
 buffer_store_dwordx4 v[136:139], v12, s[16:19], s73 offen offset:1024 sc1
 v_mul_f32 v144, v144, v27
 v_mul_f32 v145, v145, v27
 v_cvt_pk_bf16_f32 v144, v144, v145
 v_mul_f32 v146, v146, v27
 v_mul_f32 v147, v147, v27
 v_cvt_pk_bf16_f32 v145, v146, v147
 v_mul_f32 v148, v148, v27
 v_mul_f32 v149, v149, v27
 v_cvt_pk_bf16_f32 v146, v148, v149
 v_mul_f32 v150, v150, v27
 v_mul_f32 v151, v151, v27
 v_cvt_pk_bf16_f32 v147, v150, v151
 buffer_store_dwordx4 v[144:147], v12, s[16:19], s73 offen offset:2048 sc1
 v_mul_f32 v152, v152, v27
 v_mul_f32 v153, v153, v27
 v_cvt_pk_bf16_f32 v152, v152, v153
 v_mul_f32 v154, v154, v27
 v_mul_f32 v155, v155, v27
 v_cvt_pk_bf16_f32 v153, v154, v155
 v_mul_f32 v156, v156, v27
 v_mul_f32 v157, v157, v27
 v_cvt_pk_bf16_f32 v154, v156, v157
 v_mul_f32 v158, v158, v27
 v_mul_f32 v159, v159, v27
 v_cvt_pk_bf16_f32 v155, v158, v159
 buffer_store_dwordx4 v[152:155], v12, s[16:19], s73 offen offset:3072 sc1
L_vj_39:
 s_cmp_eq_u32 s71, 7
 s_cbranch_scc1 L_no4_112
 s_lshl_b32 s4, s71, 2
 s_sub_u32 s69, 24, s4
 s_cmp_eq_u32 s69, 0
 s_cbranch_scc1 L_le_114
L_lp_113:
 s_waitcnt lgkmcnt(4)
 v_mfma_f32_16x16x32_bf16 v[80:83], a[16:19], a[192:195], v[44:47]
 v_exp_f32 v18, v78
 v_mfma_f32_16x16x32_bf16 v[80:83], a[20:23], a[196:199], v[80:83]
 v_cvt_pk_bf16_f32 v54, v16, v17
 v_or3_b32 v20, v20, v53, v54
 v_mfma_f32_16x16x32_bf16 v[80:83], a[24:27], a[200:203], v[80:83]
 v_exp_f32 v19, v79
 v_mfma_f32_16x16x32_bf16 v[80:83], a[28:31], a[204:207], v[80:83]
 v_cvt_pk_bf16_f32 v55, v18, v19
 v_or_b32 v20, v20, v55
 v_mfma_f32_16x16x32_bf16 v[84:87], a[44:47], a[204:207], v[44:47]
 v_and_b32 v20, s64, v20
 v_mfma_f32_16x16x32_bf16 v[84:87], a[40:43], a[200:203], v[84:87]
 v_mfma_f32_16x16x32_bf16 v[84:87], a[36:39], a[196:199], v[84:87]
 v_mfma_f32_16x16x32_bf16 v[84:87], a[32:35], a[192:195], v[84:87]
 v_cmp_ne_u32 vcc, 0, v20
 v_mfma_f32_16x16x32_bf16 v[88:91], a[48:51], a[192:195], v[44:47]
 v_exp_f32 v16, v80
 v_mfma_f32_16x16x32_bf16 v[88:91], a[52:55], a[196:199], v[88:91]
 s_cbranch_vccnz L_so_115
L_sb_116:
 v_exp_f32 v17, v81
 v_mfma_f32_16x16x32_bf16 v[88:91], a[56:59], a[200:203], v[88:91]
 v_exp_f32 v18, v82
 v_mfma_f32_16x16x32_bf16 v[88:91], a[60:63], a[204:207], v[88:91]
 s_waitcnt lgkmcnt(0)
 v_cvt_pk_bf16_f32 v56, v16, v17
 v_exp_f32 v19, v83
 v_mfma_f32_16x16x32_bf16 v[92:95], a[92:95], a[204:207], v[44:47]
 v_exp_f32 v16, v84
 v_mfma_f32_16x16x32_bf16 v[92:95], a[88:91], a[200:203], v[92:95]
 v_cvt_pk_bf16_f32 v57, v18, v19
 v_exp_f32 v17, v85
 v_mfma_f32_16x16x32_bf16 v[92:95], a[84:87], a[196:199], v[92:95]
 v_exp_f32 v18, v86
 v_mfma_f32_16x16x32_bf16 v[92:95], a[80:83], a[192:195], v[92:95]
 s_waitcnt vmcnt(16)
 s_barrier
 s_sub_u32 s68, s68, 1
 s_cbranch_scc1 L_fo_119
L_fb_120:
 v_mfma_f32_16x16x32_bf16 v[160:163], a[96:99], v[48:51], v[160:163]
 ds_read_b128 a[96:99], v14 offset:0
 v_cvt_pk_bf16_f32 v58, v16, v17
 v_mfma_f32_16x16x32_bf16 v[160:163], a[144:147], v[52:55], v[160:163]
 ds_read_b128 a[144:147], v14 offset:8192
 v_or3_b32 v21, v56, v57, v58
 v_mfma_f32_16x16x32_bf16 v[164:167], a[148:151], v[52:55], v[164:167]
 s_mov_b32 m0, s77
 v_exp_f32 v19, v87
 v_mfma_f32_16x16x32_bf16 v[164:167], a[100:103], v[48:51], v[164:167]
 buffer_load_dwordx4 v13, s[32:35], s78 offen offset:0 sc1 lds
 v_mfma_f32_16x16x32_bf16 v[168:171], a[104:107], v[48:51], v[168:171]
 ds_read_b128 a[148:151], v14 offset:9216
 v_exp_f32 v16, v88
 v_mfma_f32_16x16x32_bf16 v[168:171], a[152:155], v[52:55], v[168:171]
 buffer_load_dwordx4 v13, s[32:35], s78 offen offset:1024 sc1 lds
 v_mfma_f32_16x16x32_bf16 v[172:175], a[156:159], v[52:55], v[172:175]
 ds_read_b128 a[100:103], v14 offset:1024
 v_cvt_pk_bf16_f32 v59, v18, v19
 v_mfma_f32_16x16x32_bf16 v[172:175], a[108:111], v[48:51], v[172:175]
 buffer_load_dwordx4 v13, s[32:35], s78 offen offset:2048 sc1 lds
 v_mfma_f32_16x16x32_bf16 v[176:179], a[112:115], v[48:51], v[176:179]
 ds_read_b128 a[104:107], v14 offset:2048
 v_exp_f32 v17, v89
 v_mfma_f32_16x16x32_bf16 v[176:179], a[160:163], v[52:55], v[176:179]
 ds_read_b128 a[152:155], v14 offset:10240
 v_exp_f32 v18, v90
 v_mfma_f32_16x16x32_bf16 v[180:183], a[164:167], v[52:55], v[180:183]
 ds_read_b128 a[156:159], v14 offset:11264
 v_cvt_pk_bf16_f32 v60, v16, v17
 v_mfma_f32_16x16x32_bf16 v[180:183], a[116:119], v[48:51], v[180:183]
 ds_read_b128 a[108:111], v14 offset:3072
 v_or3_b32 v21, v21, v59, v60
 v_mfma_f32_16x16x32_bf16 v[184:187], a[120:123], v[48:51], v[184:187]
 buffer_load_dwordx4 v13, s[32:35], s78 offen offset:3072 sc1 lds
 v_mfma_f32_16x16x32_bf16 v[184:187], a[168:171], v[52:55], v[184:187]
 ds_read_b128 a[112:115], v14 offset:4096
 v_exp_f32 v19, v91
 v_mfma_f32_16x16x32_bf16 v[188:191], a[172:175], v[52:55], v[188:191]
 ds_read_b128 a[160:163], v14 offset:12288
 v_exp_f32 v16, v92
 v_mfma_f32_16x16x32_bf16 v[188:191], a[124:127], v[48:51], v[188:191]
 ds_read_b128 a[164:167], v14 offset:13312
 v_cvt_pk_bf16_f32 v61, v18, v19
 v_mfma_f32_16x16x32_bf16 a[184:187], v[22:25], v[48:51], a[184:187]
 v_exp_f32 v17, v93
 v_mfma_f32_16x16x32_bf16 a[184:187], v[22:25], v[52:55], a[184:187]
 ds_read_b128 a[116:119], v14 offset:5120
 v_exp_f32 v18, v94
 v_mfma_f32_16x16x32_bf16 v[64:67], a[16:19], a[128:131], v[40:43]
 ds_read_b128 a[16:19], v14 offset:16384
 v_cvt_pk_bf16_f32 v62, v16, v17
 v_mfma_f32_16x16x32_bf16 v[64:67], a[20:23], a[132:135], v[64:67]
 ds_read_b128 a[20:23], v14 offset:17408
 v_or3_b32 v21, v21, v61, v62
 v_mfma_f32_16x16x32_bf16 v[64:67], a[24:27], a[136:139], v[64:67]
 s_add_u32 m0, s77, 16384
 v_exp_f32 v19, v95
 v_mfma_f32_16x16x32_bf16 v[64:67], a[28:31], a[140:143], v[64:67]
 ds_read_b128 a[24:27], v14 offset:18432
 v_cvt_pk_bf16_f32 v63, v18, v19
 v_mfma_f32_16x16x32_bf16 v[68:71], a[44:47], a[140:143], v[40:43]
 ds_read_b128 a[28:31], v14 offset:19456
 v_or_b32 v21, v21, v63
 v_mfma_f32_16x16x32_bf16 v[68:71], a[40:43], a[136:139], v[68:71]
 s_add_u32 s78, s78, 16384
 ds_read_b128 a[44:47], v14 offset:23552
 v_mfma_f32_16x16x32_bf16 v[68:71], a[36:39], a[132:135], v[68:71]
 buffer_load_dwordx4 v13, s[12:15], s78 offen offset:0 sc1 lds
 v_mfma_f32_16x16x32_bf16 v[68:71], a[32:35], a[128:131], v[68:71]
 ds_read_b128 a[120:123], v14 offset:6144
 v_and_b32 v21, s64, v21
 v_mfma_f32_16x16x32_bf16 v[72:75], a[48:51], a[128:131], v[40:43]
 ds_read_b128 a[168:171], v14 offset:14336
 v_cmp_ne_u32 vcc, 0, v21
 v_mfma_f32_16x16x32_bf16 v[72:75], a[52:55], a[132:135], v[72:75]
 ds_read_b128 a[172:175], v14 offset:15360
 v_exp_f32 v16, v64
 v_mfma_f32_16x16x32_bf16 v[72:75], a[56:59], a[136:139], v[72:75]
 s_cbranch_vccnz L_so_117
L_sb_118:
 v_exp_f32 v17, v65
 v_mfma_f32_16x16x32_bf16 v[72:75], a[60:63], a[140:143], v[72:75]
 buffer_load_dwordx4 v13, s[12:15], s78 offen offset:1024 sc1 lds
 v_mfma_f32_16x16x32_bf16 v[76:79], a[92:95], a[140:143], v[40:43]
 ds_read_b128 a[124:127], v14 offset:7168
 v_exp_f32 v18, v66
 v_mfma_f32_16x16x32_bf16 v[76:79], a[88:91], a[136:139], v[76:79]
 ds_read_b128 a[40:43], v14 offset:22528
 v_cvt_pk_bf16_f32 v48, v16, v17
 v_mfma_f32_16x16x32_bf16 v[76:79], a[84:87], a[132:135], v[76:79]
 ds_read_b128 a[36:39], v14 offset:21504
 v_exp_f32 v19, v67
 v_mfma_f32_16x16x32_bf16 v[76:79], a[80:83], a[128:131], v[76:79]
 s_waitcnt lgkmcnt(6)
 v_exp_f32 v16, v68
 v_mfma_f32_16x16x32_bf16 v[192:195], a[96:99], v[56:59], v[192:195]
 buffer_load_dwordx4 v13, s[12:15], s78 offen offset:2048 sc1 lds
 v_mfma_f32_16x16x32_bf16 v[192:195], a[144:147], v[60:63], v[192:195]
 ds_read_b128 a[32:35], v14 offset:20480
 v_cvt_pk_bf16_f32 v49, v18, v19
 v_mfma_f32_16x16x32_bf16 v[196:199], a[148:151], v[60:63], v[196:199]
 ds_read_b128 a[48:51], v14 offset:24576
 v_exp_f32 v17, v69
 v_mfma_f32_16x16x32_bf16 v[196:199], a[100:103], v[56:59], v[196:199]
 buffer_load_dwordx4 v13, s[12:15], s78 offen offset:3072 sc1 lds
 v_mfma_f32_16x16x32_bf16 v[200:203], a[104:107], v[56:59], v[200:203]
 ds_read_b128 a[52:55], v14 offset:25600
 v_exp_f32 v18, v70
 v_mfma_f32_16x16x32_bf16 v[200:203], a[152:155], v[60:63], v[200:203]
 ds_read_b128 a[56:59], v14 offset:26624
 v_cvt_pk_bf16_f32 v50, v16, v17
 v_mfma_f32_16x16x32_bf16 v[204:207], a[156:159], v[60:63], v[204:207]
 ds_read_b128 a[60:63], v14 offset:27648
 v_or3_b32 v20, v48, v49, v50
 v_mfma_f32_16x16x32_bf16 v[204:207], a[108:111], v[56:59], v[204:207]
 s_add_u32 s79, s76, s58
 v_exp_f32 v19, v71
 v_mfma_f32_16x16x32_bf16 v[208:211], a[112:115], v[56:59], v[208:211]
 s_add_u32 s76, s76, 32768
 v_exp_f32 v16, v72
 v_mfma_f32_16x16x32_bf16 v[208:211], a[160:163], v[60:63], v[208:211]
 ds_read_b128 a[92:95], v14 offset:31744
 v_cvt_pk_bf16_f32 v51, v18, v19
 v_mfma_f32_16x16x32_bf16 v[212:215], a[164:167], v[60:63], v[212:215]
 s_and_b32 s76, s76, 0x1ffff
 v_exp_f32 v17, v73
 v_mfma_f32_16x16x32_bf16 v[212:215], a[116:119], v[56:59], v[212:215]
 s_waitcnt lgkmcnt(5)
 v_exp_f32 v18, v74
 v_mfma_f32_16x16x32_bf16 v[216:219], a[120:123], v[56:59], v[216:219]
 ds_read_b128 a[88:91], v14 offset:30720
 v_cvt_pk_bf16_f32 v52, v16, v17
 v_mfma_f32_16x16x32_bf16 v[216:219], a[168:171], v[60:63], v[216:219]
 ds_read_b128 a[84:87], v14 offset:29696
 v_or3_b32 v20, v20, v51, v52
 v_mfma_f32_16x16x32_bf16 v[220:223], a[172:175], v[60:63], v[220:223]
 v_exp_f32 v19, v75
 v_mfma_f32_16x16x32_bf16 v[220:223], a[124:127], v[56:59], v[220:223]
 v_exp_f32 v16, v76
 v_mfma_f32_16x16x32_bf16 a[188:191], v[22:25], v[56:59], a[188:191]
 ds_read_b128 a[80:83], v14 offset:28672
 v_cvt_pk_bf16_f32 v53, v18, v19
 v_mfma_f32_16x16x32_bf16 a[188:191], v[22:25], v[60:63], a[188:191]
 s_mov_b32 s77, s79
 v_add_u32 v14, s76, v12
 v_exp_f32 v17, v77
 s_sub_u32 s69, s69, 1
 s_cmp_lg_u32 s69, 0
 s_cbranch_scc1 L_lp_113
L_le_114:
 s_waitcnt lgkmcnt(4)
 v_mfma_f32_16x16x32_bf16 v[80:83], a[16:19], a[192:195], v[44:47]
 v_exp_f32 v18, v78
 v_mfma_f32_16x16x32_bf16 v[80:83], a[20:23], a[196:199], v[80:83]
 v_cvt_pk_bf16_f32 v54, v16, v17
 v_or3_b32 v20, v20, v53, v54
 v_mfma_f32_16x16x32_bf16 v[80:83], a[24:27], a[200:203], v[80:83]
 v_exp_f32 v19, v79
 v_mfma_f32_16x16x32_bf16 v[80:83], a[28:31], a[204:207], v[80:83]
 v_cvt_pk_bf16_f32 v55, v18, v19
 v_or_b32 v20, v20, v55
 v_mfma_f32_16x16x32_bf16 v[84:87], a[44:47], a[204:207], v[44:47]
 v_and_b32 v20, s64, v20
 v_mfma_f32_16x16x32_bf16 v[84:87], a[40:43], a[200:203], v[84:87]
 v_mfma_f32_16x16x32_bf16 v[84:87], a[36:39], a[196:199], v[84:87]
 v_mfma_f32_16x16x32_bf16 v[84:87], a[32:35], a[192:195], v[84:87]
 v_cmp_ne_u32 vcc, 0, v20
 v_mfma_f32_16x16x32_bf16 v[88:91], a[48:51], a[192:195], v[44:47]
 v_exp_f32 v16, v80
 v_mfma_f32_16x16x32_bf16 v[88:91], a[52:55], a[196:199], v[88:91]
 s_cbranch_vccnz L_so_121
L_sb_122:
 v_exp_f32 v17, v81
 v_mfma_f32_16x16x32_bf16 v[88:91], a[56:59], a[200:203], v[88:91]
 v_exp_f32 v18, v82
 v_mfma_f32_16x16x32_bf16 v[88:91], a[60:63], a[204:207], v[88:91]
 s_waitcnt lgkmcnt(0)
 v_cvt_pk_bf16_f32 v56, v16, v17
 v_exp_f32 v19, v83
 v_mfma_f32_16x16x32_bf16 v[92:95], a[92:95], a[204:207], v[44:47]
 v_exp_f32 v16, v84
 v_mfma_f32_16x16x32_bf16 v[92:95], a[88:91], a[200:203], v[92:95]
 v_cvt_pk_bf16_f32 v57, v18, v19
 v_exp_f32 v17, v85
 v_mfma_f32_16x16x32_bf16 v[92:95], a[84:87], a[196:199], v[92:95]
 v_exp_f32 v18, v86
 v_mfma_f32_16x16x32_bf16 v[92:95], a[80:83], a[192:195], v[92:95]
 s_waitcnt vmcnt(16)
 s_barrier
 s_sub_u32 s68, s68, 1
 s_cbranch_scc1 L_fo_125
L_fb_126:
 v_mfma_f32_16x16x32_bf16 v[160:163], a[96:99], v[48:51], v[160:163]
 s_add_u32 s44, s42, 0
 s_and_b32 s44, s44, 0x7fff
 s_add_u32 s44, s44, s43
 v_mfma_f32_16x16x32_bf16 v[160:163], a[144:147], v[52:55], v[160:163]
 buffer_load_dwordx4 a[208:211], v4, s[8:11], s44 offen offset:0 sc1
 v_mfma_f32_16x16x32_bf16 v[164:167], a[148:151], v[52:55], v[164:167]
 buffer_load_dwordx4 a[212:215], v5, s[8:11], s44 offen offset:0 sc1
 v_mfma_f32_16x16x32_bf16 v[164:167], a[100:103], v[48:51], v[164:167]
 ds_read_b128 a[96:99], v14 offset:0
 v_cvt_pk_bf16_f32 v58, v16, v17
 v_mfma_f32_16x16x32_bf16 v[168:171], a[104:107], v[48:51], v[168:171]
 ds_read_b128 a[144:147], v14 offset:8192
 v_or3_b32 v21, v56, v57, v58
 v_mfma_f32_16x16x32_bf16 v[168:171], a[152:155], v[52:55], v[168:171]
 buffer_load_dwordx4 a[216:219], v6, s[8:11], s44 offen offset:0 sc1
 v_mfma_f32_16x16x32_bf16 v[172:175], a[156:159], v[52:55], v[172:175]
 s_mov_b32 m0, s77
 v_exp_f32 v19, v87
 v_mfma_f32_16x16x32_bf16 v[172:175], a[108:111], v[48:51], v[172:175]
 buffer_load_dwordx4 v13, s[32:35], s78 offen offset:0 sc1 lds
 v_mfma_f32_16x16x32_bf16 v[176:179], a[112:115], v[48:51], v[176:179]
 buffer_load_dwordx4 v13, s[32:35], s78 offen offset:1024 sc1 lds
 v_mfma_f32_16x16x32_bf16 v[176:179], a[160:163], v[52:55], v[176:179]
 buffer_load_dwordx4 v13, s[32:35], s78 offen offset:2048 sc1 lds
 v_mfma_f32_16x16x32_bf16 v[180:183], a[164:167], v[52:55], v[180:183]
 buffer_load_dwordx4 a[220:223], v7, s[8:11], s44 offen offset:0 sc1
 v_mfma_f32_16x16x32_bf16 v[180:183], a[116:119], v[48:51], v[180:183]
 ds_read_b128 a[148:151], v14 offset:9216
 v_exp_f32 v16, v88
 v_mfma_f32_16x16x32_bf16 v[184:187], a[120:123], v[48:51], v[184:187]
 buffer_load_dwordx4 a[224:227], v4, s[8:11], s44 offen offset:1024 sc1
 v_mfma_f32_16x16x32_bf16 v[184:187], a[168:171], v[52:55], v[184:187]
 buffer_load_dwordx4 v13, s[32:35], s78 offen offset:3072 sc1 lds
 v_mfma_f32_16x16x32_bf16 v[188:191], a[172:175], v[52:55], v[188:191]
 ds_read_b128 a[100:103], v14 offset:1024
 v_cvt_pk_bf16_f32 v59, v18, v19
 v_mfma_f32_16x16x32_bf16 v[188:191], a[124:127], v[48:51], v[188:191]
 ds_read_b128 a[104:107], v14 offset:2048
 v_exp_f32 v17, v89
 v_mfma_f32_16x16x32_bf16 a[184:187], v[22:25], v[48:51], a[184:187]
 buffer_load_dwordx4 a[228:231], v5, s[8:11], s44 offen offset:1024 sc1
 v_mfma_f32_16x16x32_bf16 a[184:187], v[22:25], v[52:55], a[184:187]
 ds_read_b128 a[152:155], v14 offset:10240
 v_exp_f32 v18, v90
 v_mfma_f32_16x16x32_bf16 v[64:67], a[16:19], a[128:131], v[40:43]
 ds_read_b128 a[16:19], v14 offset:16384
 v_cvt_pk_bf16_f32 v60, v16, v17
 v_mfma_f32_16x16x32_bf16 v[64:67], a[20:23], a[132:135], v[64:67]
 ds_read_b128 a[20:23], v14 offset:17408
 v_or3_b32 v21, v21, v59, v60
 v_mfma_f32_16x16x32_bf16 v[64:67], a[24:27], a[136:139], v[64:67]
 buffer_load_dwordx4 a[232:235], v6, s[8:11], s44 offen offset:1024 sc1
 v_mfma_f32_16x16x32_bf16 v[64:67], a[28:31], a[140:143], v[64:67]
 s_add_u32 m0, s77, 16384
 v_exp_f32 v19, v91
 v_mfma_f32_16x16x32_bf16 v[68:71], a[44:47], a[140:143], v[40:43]
 s_add_u32 s78, s78, 16384
 v_exp_f32 v16, v92
 v_mfma_f32_16x16x32_bf16 v[68:71], a[40:43], a[136:139], v[68:71]
 buffer_load_dwordx4 a[236:239], v7, s[8:11], s44 offen offset:1024 sc1
 v_mfma_f32_16x16x32_bf16 v[68:71], a[36:39], a[132:135], v[68:71]
 ds_read_b128 a[24:27], v14 offset:18432
 v_cvt_pk_bf16_f32 v61, v18, v19
 v_mfma_f32_16x16x32_bf16 v[68:71], a[32:35], a[128:131], v[68:71]
 ds_read_b128 a[156:159], v14 offset:11264
 v_exp_f32 v17, v93
 v_exp_f32 v18, v94
 v_cvt_pk_bf16_f32 v62, v16, v17
 v_or3_b32 v21, v21, v61, v62
 v_exp_f32 v19, v95
 s_nop 0
 v_cvt_pk_bf16_f32 v63, v18, v19
 v_or_b32 v21, v21, v63
 v_and_b32 v21, s64, v21
 v_mfma_f32_16x16x32_bf16 v[72:75], a[48:51], a[128:131], v[40:43]
 ds_read_b128 a[108:111], v14 offset:3072
 v_cmp_ne_u32 vcc, 0, v21
 v_mfma_f32_16x16x32_bf16 v[72:75], a[52:55], a[132:135], v[72:75]
 buffer_load_dwordx4 v13, s[12:15], s78 offen offset:0 sc1 lds
 v_mfma_f32_16x16x32_bf16 v[72:75], a[56:59], a[136:139], v[72:75]
 ds_read_b128 a[112:115], v14 offset:4096
 v_exp_f32 v16, v64
 v_mfma_f32_16x16x32_bf16 v[72:75], a[60:63], a[140:143], v[72:75]
 s_cbranch_vccnz L_so_123
L_sb_124:
 v_exp_f32 v17, v65
 v_mfma_f32_16x16x32_bf16 v[76:79], a[92:95], a[140:143], v[40:43]
 ds_read_b128 a[160:163], v14 offset:12288
 ds_read_b128 a[164:167], v14 offset:13312
 ds_read_b128 a[116:119], v14 offset:5120
 ds_read_b128 a[120:123], v14 offset:6144
 ds_read_b128 a[168:171], v14 offset:14336
 ds_read_b128 a[172:175], v14 offset:15360
 ds_read_b128 a[124:127], v14 offset:7168
 v_mfma_f32_16x16x32_bf16 v[76:79], a[88:91], a[136:139], v[76:79]
 buffer_load_dwordx4 v13, s[12:15], s78 offen offset:1024 sc1 lds
 v_mfma_f32_16x16x32_bf16 v[76:79], a[84:87], a[132:135], v[76:79]
 s_add_u32 s44, s42, 8192
 s_and_b32 s44, s44, 0x7fff
 s_add_u32 s44, s44, s43
 v_mfma_f32_16x16x32_bf16 v[76:79], a[80:83], a[128:131], v[76:79]
 s_waitcnt lgkmcnt(11)
 v_exp_f32 v18, v66
 v_mfma_f32_16x16x32_bf16 v[192:195], a[96:99], v[56:59], v[192:195]
 buffer_load_dwordx4 a[64:67], v4, s[8:11], s44 offen offset:0 sc1
 v_mfma_f32_16x16x32_bf16 v[192:195], a[144:147], v[60:63], v[192:195]
 buffer_load_dwordx4 v13, s[12:15], s78 offen offset:2048 sc1 lds
 v_mfma_f32_16x16x32_bf16 v[196:199], a[148:151], v[60:63], v[196:199]
 buffer_load_dwordx4 a[68:71], v5, s[8:11], s44 offen offset:0 sc1
 v_mfma_f32_16x16x32_bf16 v[196:199], a[100:103], v[56:59], v[196:199]
 buffer_load_dwordx4 a[72:75], v6, s[8:11], s44 offen offset:0 sc1
 v_mfma_f32_16x16x32_bf16 v[200:203], a[104:107], v[56:59], v[200:203]
 buffer_load_dwordx4 v13, s[12:15], s78 offen offset:3072 sc1 lds
 v_mfma_f32_16x16x32_bf16 v[200:203], a[152:155], v[60:63], v[200:203]
 s_waitcnt lgkmcnt(7)
 ds_read_b128 a[28:31], v14 offset:19456
 v_cvt_pk_bf16_f32 v48, v16, v17
 v_mfma_f32_16x16x32_bf16 v[204:207], a[156:159], v[60:63], v[204:207]
 s_add_u32 s79, s76, s58
 v_exp_f32 v19, v67
 v_mfma_f32_16x16x32_bf16 v[204:207], a[108:111], v[56:59], v[204:207]
 buffer_load_dwordx4 a[76:79], v7, s[8:11], s44 offen offset:0 sc1
 v_mfma_f32_16x16x32_bf16 v[208:211], a[112:115], v[56:59], v[208:211]
 s_waitcnt lgkmcnt(1)
 s_add_u32 s76, s76, 32768
 v_exp_f32 v16, v68
 v_mfma_f32_16x16x32_bf16 v[208:211], a[160:163], v[60:63], v[208:211]
 ds_read_b128 a[44:47], v14 offset:23552
 v_cvt_pk_bf16_f32 v49, v18, v19
 v_mfma_f32_16x16x32_bf16 v[212:215], a[164:167], v[60:63], v[212:215]
 ds_read_b128 a[40:43], v14 offset:22528
 v_mfma_f32_16x16x32_bf16 v[212:215], a[116:119], v[56:59], v[212:215]
 ds_read_b128 a[36:39], v14 offset:21504
 v_exp_f32 v17, v69
 v_mfma_f32_16x16x32_bf16 v[216:219], a[120:123], v[56:59], v[216:219]
 s_and_b32 s76, s76, 0x1ffff
 ds_read_b128 a[32:35], v14 offset:20480
 v_mfma_f32_16x16x32_bf16 v[216:219], a[168:171], v[60:63], v[216:219]
 ds_read_b128 a[48:51], v14 offset:24576
 v_exp_f32 v18, v70
 v_mfma_f32_16x16x32_bf16 v[220:223], a[172:175], v[60:63], v[220:223]
 ds_read_b128 a[52:55], v14 offset:25600
 v_cvt_pk_bf16_f32 v50, v16, v17
 v_or3_b32 v20, v48, v49, v50
 v_mfma_f32_16x16x32_bf16 v[220:223], a[124:127], v[56:59], v[220:223]
 ds_read_b128 a[56:59], v14 offset:26624
 v_exp_f32 v19, v71
 v_mfma_f32_16x16x32_bf16 a[188:191], v[22:25], v[56:59], a[188:191]
 ds_read_b128 a[60:63], v14 offset:27648
 ds_read_b128 a[92:95], v14 offset:31744
 ds_read_b128 a[88:91], v14 offset:30720
 ds_read_b128 a[84:87], v14 offset:29696
 ds_read_b128 a[80:83], v14 offset:28672
 v_mfma_f32_16x16x32_bf16 a[188:191], v[22:25], v[60:63], a[188:191]
 s_mov_b32 s77, s79
 v_add_u32 v14, s76, v12
 v_exp_f32 v16, v72
 v_cvt_pk_bf16_f32 v51, v18, v19
 v_exp_f32 v17, v73
 v_exp_f32 v18, v74
 v_cvt_pk_bf16_f32 v52, v16, v17
 v_or3_b32 v20, v20, v51, v52
 v_exp_f32 v19, v75
 v_exp_f32 v16, v76
 v_cvt_pk_bf16_f32 v53, v18, v19
 v_exp_f32 v17, v77
 v_mfma_f32_16x16x32_bf16 v[80:83], a[16:19], a[192:195], v[44:47]
 v_exp_f32 v18, v78
 v_mfma_f32_16x16x32_bf16 v[80:83], a[20:23], a[196:199], v[80:83]
 v_cvt_pk_bf16_f32 v54, v16, v17
 v_or3_b32 v20, v20, v53, v54
 v_mfma_f32_16x16x32_bf16 v[80:83], a[24:27], a[200:203], v[80:83]
 s_waitcnt lgkmcnt(10)
 v_exp_f32 v19, v79
 v_mfma_f32_16x16x32_bf16 v[80:83], a[28:31], a[204:207], v[80:83]
 v_cvt_pk_bf16_f32 v55, v18, v19
 v_or_b32 v20, v20, v55
 v_mfma_f32_16x16x32_bf16 v[84:87], a[44:47], a[204:207], v[44:47]
 v_and_b32 v20, s64, v20
 v_mfma_f32_16x16x32_bf16 v[84:87], a[40:43], a[200:203], v[84:87]
 s_waitcnt lgkmcnt(7)
 v_mfma_f32_16x16x32_bf16 v[84:87], a[36:39], a[196:199], v[84:87]
 v_mfma_f32_16x16x32_bf16 v[84:87], a[32:35], a[192:195], v[84:87]
 v_cmp_ne_u32 vcc, 0, v20
 v_mfma_f32_16x16x32_bf16 v[88:91], a[48:51], a[192:195], v[44:47]
 s_waitcnt lgkmcnt(0)
 v_exp_f32 v16, v80
 v_mfma_f32_16x16x32_bf16 v[88:91], a[52:55], a[196:199], v[88:91]
 s_cbranch_vccnz L_so_127
L_sb_128:
 v_exp_f32 v17, v81
 v_mfma_f32_16x16x32_bf16 v[88:91], a[56:59], a[200:203], v[88:91]
 v_exp_f32 v18, v82
 v_mfma_f32_16x16x32_bf16 v[88:91], a[60:63], a[204:207], v[88:91]
 v_cvt_pk_bf16_f32 v56, v16, v17
 v_exp_f32 v19, v83
 v_mfma_f32_16x16x32_bf16 v[92:95], a[92:95], a[204:207], v[44:47]
 v_exp_f32 v16, v84
 v_mfma_f32_16x16x32_bf16 v[92:95], a[88:91], a[200:203], v[92:95]
 v_cvt_pk_bf16_f32 v57, v18, v19
 v_exp_f32 v17, v85
 v_mfma_f32_16x16x32_bf16 v[92:95], a[84:87], a[196:199], v[92:95]
 v_exp_f32 v18, v86
 v_mfma_f32_16x16x32_bf16 v[92:95], a[80:83], a[192:195], v[92:95]
 s_waitcnt vmcnt(16)
 s_barrier
 s_sub_u32 s68, s68, 1
 s_cbranch_scc1 L_fo_131
L_fb_132:
 v_mfma_f32_16x16x32_bf16 v[160:163], a[96:99], v[48:51], v[160:163]
 s_add_u32 s44, s42, 2048
 s_and_b32 s44, s44, 0x7fff
 s_add_u32 s44, s44, s43
 v_mfma_f32_16x16x32_bf16 v[160:163], a[144:147], v[52:55], v[160:163]
 buffer_load_dwordx4 a[240:243], v4, s[8:11], s44 offen offset:0 sc1
 v_mfma_f32_16x16x32_bf16 v[164:167], a[148:151], v[52:55], v[164:167]
 buffer_load_dwordx4 a[244:247], v5, s[8:11], s44 offen offset:0 sc1
 v_mfma_f32_16x16x32_bf16 v[164:167], a[100:103], v[48:51], v[164:167]
 ds_read_b128 a[96:99], v14 offset:0
 v_cvt_pk_bf16_f32 v58, v16, v17
 v_mfma_f32_16x16x32_bf16 v[168:171], a[104:107], v[48:51], v[168:171]
 ds_read_b128 a[144:147], v14 offset:8192
 v_or3_b32 v21, v56, v57, v58
 v_mfma_f32_16x16x32_bf16 v[168:171], a[152:155], v[52:55], v[168:171]
 buffer_load_dwordx4 a[248:251], v6, s[8:11], s44 offen offset:0 sc1
 v_mfma_f32_16x16x32_bf16 v[172:175], a[156:159], v[52:55], v[172:175]
 s_mov_b32 m0, s77
 v_exp_f32 v19, v87
 v_mfma_f32_16x16x32_bf16 v[172:175], a[108:111], v[48:51], v[172:175]
 buffer_load_dwordx4 v13, s[32:35], s78 offen offset:0 sc1 lds
 v_mfma_f32_16x16x32_bf16 v[176:179], a[112:115], v[48:51], v[176:179]
 buffer_load_dwordx4 v13, s[32:35], s78 offen offset:1024 sc1 lds
 v_mfma_f32_16x16x32_bf16 v[176:179], a[160:163], v[52:55], v[176:179]
 buffer_load_dwordx4 v13, s[32:35], s78 offen offset:2048 sc1 lds
 v_mfma_f32_16x16x32_bf16 v[180:183], a[164:167], v[52:55], v[180:183]
 buffer_load_dwordx4 a[252:255], v7, s[8:11], s44 offen offset:0 sc1
 v_mfma_f32_16x16x32_bf16 v[180:183], a[116:119], v[48:51], v[180:183]
 ds_read_b128 a[148:151], v14 offset:9216
 v_exp_f32 v16, v88
 v_mfma_f32_16x16x32_bf16 v[184:187], a[120:123], v[48:51], v[184:187]
 buffer_load_dwordx4 a[0:3], v4, s[8:11], s44 offen offset:1024 sc1
 v_mfma_f32_16x16x32_bf16 v[184:187], a[168:171], v[52:55], v[184:187]
 buffer_load_dwordx4 v13, s[32:35], s78 offen offset:3072 sc1 lds
 v_mfma_f32_16x16x32_bf16 v[188:191], a[172:175], v[52:55], v[188:191]
 ds_read_b128 a[100:103], v14 offset:1024
 v_cvt_pk_bf16_f32 v59, v18, v19
 v_mfma_f32_16x16x32_bf16 v[188:191], a[124:127], v[48:51], v[188:191]
 ds_read_b128 a[104:107], v14 offset:2048
 v_exp_f32 v17, v89
 v_mfma_f32_16x16x32_bf16 a[184:187], v[22:25], v[48:51], a[184:187]
 buffer_load_dwordx4 a[4:7], v5, s[8:11], s44 offen offset:1024 sc1
 v_mfma_f32_16x16x32_bf16 a[184:187], v[22:25], v[52:55], a[184:187]
 ds_read_b128 a[152:155], v14 offset:10240
 v_exp_f32 v18, v90
 v_mfma_f32_16x16x32_bf16 v[64:67], a[16:19], a[128:131], v[40:43]
 ds_read_b128 a[16:19], v14 offset:16384
 v_cvt_pk_bf16_f32 v60, v16, v17
 v_mfma_f32_16x16x32_bf16 v[64:67], a[20:23], a[132:135], v[64:67]
 ds_read_b128 a[20:23], v14 offset:17408
 v_or3_b32 v21, v21, v59, v60
 v_mfma_f32_16x16x32_bf16 v[64:67], a[24:27], a[136:139], v[64:67]
 buffer_load_dwordx4 a[8:11], v6, s[8:11], s44 offen offset:1024 sc1
 v_mfma_f32_16x16x32_bf16 v[64:67], a[28:31], a[140:143], v[64:67]
 s_add_u32 m0, s77, 16384
 v_exp_f32 v19, v91
 v_mfma_f32_16x16x32_bf16 v[68:71], a[44:47], a[140:143], v[40:43]
 s_add_u32 s78, s78, 16384
 v_exp_f32 v16, v92
 v_mfma_f32_16x16x32_bf16 v[68:71], a[40:43], a[136:139], v[68:71]
 buffer_load_dwordx4 a[12:15], v7, s[8:11], s44 offen offset:1024 sc1
 v_mfma_f32_16x16x32_bf16 v[68:71], a[36:39], a[132:135], v[68:71]
 buffer_load_dwordx4 v13, s[12:15], s78 offen offset:0 sc1 lds
 v_mfma_f32_16x16x32_bf16 v[68:71], a[32:35], a[128:131], v[68:71]
 ds_read_b128 a[156:159], v14 offset:11264
 v_cvt_pk_bf16_f32 v61, v18, v19
 v_exp_f32 v17, v93
 v_exp_f32 v18, v94
 v_cvt_pk_bf16_f32 v62, v16, v17
 v_or3_b32 v21, v21, v61, v62
 v_exp_f32 v19, v95
 s_nop 0
 v_cvt_pk_bf16_f32 v63, v18, v19
 v_or_b32 v21, v21, v63
 v_and_b32 v21, s64, v21
 v_mfma_f32_16x16x32_bf16 v[72:75], a[48:51], a[128:131], v[40:43]
 ds_read_b128 a[108:111], v14 offset:3072
 v_cmp_ne_u32 vcc, 0, v21
 v_mfma_f32_16x16x32_bf16 v[72:75], a[52:55], a[132:135], v[72:75]
 ds_read_b128 a[112:115], v14 offset:4096
 v_exp_f32 v16, v64
 v_mfma_f32_16x16x32_bf16 v[72:75], a[56:59], a[136:139], v[72:75]
 ds_read_b128 a[160:163], v14 offset:12288
 v_exp_f32 v17, v65
 v_mfma_f32_16x16x32_bf16 v[72:75], a[60:63], a[140:143], v[72:75]
 s_cbranch_vccnz L_so_129
L_sb_130:
 v_exp_f32 v18, v66
 v_mfma_f32_16x16x32_bf16 v[76:79], a[92:95], a[140:143], v[40:43]
 ds_read_b128 a[164:167], v14 offset:13312
 ds_read_b128 a[116:119], v14 offset:5120
 ds_read_b128 a[120:123], v14 offset:6144
 ds_read_b128 a[168:171], v14 offset:14336
 ds_read_b128 a[172:175], v14 offset:15360
 ds_read_b128 a[124:127], v14 offset:7168
 v_mfma_f32_16x16x32_bf16 v[76:79], a[88:91], a[136:139], v[76:79]
 buffer_load_dwordx4 v13, s[12:15], s78 offen offset:1024 sc1 lds
 v_mfma_f32_16x16x32_bf16 v[76:79], a[84:87], a[132:135], v[76:79]
 ds_read_b128 a[24:27], v14 offset:18432
 v_cvt_pk_bf16_f32 v48, v16, v17
 v_mfma_f32_16x16x32_bf16 v[76:79], a[80:83], a[128:131], v[76:79]
 s_waitcnt lgkmcnt(11)
 v_exp_f32 v19, v67
 v_mfma_f32_16x16x32_bf16 v[192:195], a[96:99], v[56:59], v[192:195]
 buffer_load_dwordx4 v13, s[12:15], s78 offen offset:2048 sc1 lds
 v_mfma_f32_16x16x32_bf16 v[192:195], a[144:147], v[60:63], v[192:195]
 s_add_u32 s44, s42, 8192
 s_and_b32 s44, s44, 0x7fff
 s_add_u32 s44, s44, s43
 v_mfma_f32_16x16x32_bf16 v[196:199], a[148:151], v[60:63], v[196:199]
 buffer_load_dwordx4 a[176:179], v4, s[8:11], s44 offen offset:1024 sc1
 v_mfma_f32_16x16x32_bf16 v[196:199], a[100:103], v[56:59], v[196:199]
 buffer_load_dwordx4 a[180:183], v5, s[8:11], s44 offen offset:1024 sc1
 v_mfma_f32_16x16x32_bf16 v[200:203], a[104:107], v[56:59], v[200:203]
 buffer_load_dwordx4 v[32:35], v6, s[8:11], s44 offen offset:1024 sc1
 v_mfma_f32_16x16x32_bf16 v[200:203], a[152:155], v[60:63], v[200:203]
 s_waitcnt lgkmcnt(7)
 buffer_load_dwordx4 v13, s[12:15], s78 offen offset:3072 sc1 lds
 v_mfma_f32_16x16x32_bf16 v[204:207], a[156:159], v[60:63], v[204:207]
 s_add_u32 s79, s76, s58
 v_exp_f32 v16, v68
 v_mfma_f32_16x16x32_bf16 v[204:207], a[108:111], v[56:59], v[204:207]
 buffer_load_dwordx4 v[36:39], v7, s[8:11], s44 offen offset:1024 sc1
 v_mfma_f32_16x16x32_bf16 v[208:211], a[112:115], v[56:59], v[208:211]
 ds_read_b128 a[28:31], v14 offset:19456
 v_cvt_pk_bf16_f32 v49, v18, v19
 v_mfma_f32_16x16x32_bf16 v[208:211], a[160:163], v[60:63], v[208:211]
 s_waitcnt lgkmcnt(1)
 ds_read_b128 a[44:47], v14 offset:23552
 v_exp_f32 v17, v69
 v_mfma_f32_16x16x32_bf16 v[212:215], a[164:167], v[60:63], v[212:215]
 v_exp_f32 v18, v70
 v_mfma_f32_16x16x32_bf16 v[212:215], a[116:119], v[56:59], v[212:215]
 ds_read_b128 a[40:43], v14 offset:22528
 v_cvt_pk_bf16_f32 v50, v16, v17
 v_mfma_f32_16x16x32_bf16 v[216:219], a[120:123], v[56:59], v[216:219]
 s_add_u32 s76, s76, 32768
 ds_read_b128 a[36:39], v14 offset:21504
 v_mfma_f32_16x16x32_bf16 v[216:219], a[168:171], v[60:63], v[216:219]
 s_and_b32 s76, s76, 0x1ffff
 ds_read_b128 a[32:35], v14 offset:20480
 v_mfma_f32_16x16x32_bf16 v[220:223], a[172:175], v[60:63], v[220:223]
 ds_read_b128 a[48:51], v14 offset:24576
 v_or3_b32 v20, v48, v49, v50
 v_mfma_f32_16x16x32_bf16 v[220:223], a[124:127], v[56:59], v[220:223]
 ds_read_b128 a[52:55], v14 offset:25600
 v_exp_f32 v19, v71
 v_mfma_f32_16x16x32_bf16 a[188:191], v[22:25], v[56:59], a[188:191]
 ds_read_b128 a[56:59], v14 offset:26624
 ds_read_b128 a[60:63], v14 offset:27648
 ds_read_b128 a[92:95], v14 offset:31744
 ds_read_b128 a[88:91], v14 offset:30720
 ds_read_b128 a[84:87], v14 offset:29696
 ds_read_b128 a[80:83], v14 offset:28672
 v_mfma_f32_16x16x32_bf16 a[188:191], v[22:25], v[60:63], a[188:191]
 s_mov_b32 s77, s79
 v_add_u32 v14, s76, v12
 v_exp_f32 v16, v72
 v_cvt_pk_bf16_f32 v51, v18, v19
 v_exp_f32 v17, v73
 v_exp_f32 v18, v74
 v_cvt_pk_bf16_f32 v52, v16, v17
 v_or3_b32 v20, v20, v51, v52
 v_exp_f32 v19, v75
 v_exp_f32 v16, v76
 v_cvt_pk_bf16_f32 v53, v18, v19
 v_exp_f32 v17, v77
 v_mfma_f32_16x16x32_bf16 v[80:83], a[16:19], a[192:195], v[44:47]
 v_exp_f32 v18, v78
 v_mfma_f32_16x16x32_bf16 v[80:83], a[20:23], a[196:199], v[80:83]
 v_cvt_pk_bf16_f32 v54, v16, v17
 v_or3_b32 v20, v20, v53, v54
 v_mfma_f32_16x16x32_bf16 v[80:83], a[24:27], a[200:203], v[80:83]
 s_waitcnt lgkmcnt(11)
 v_exp_f32 v19, v79
 v_mfma_f32_16x16x32_bf16 v[80:83], a[28:31], a[204:207], v[80:83]
 v_cvt_pk_bf16_f32 v55, v18, v19
 v_or_b32 v20, v20, v55
 v_mfma_f32_16x16x32_bf16 v[84:87], a[44:47], a[204:207], v[44:47]
 s_waitcnt lgkmcnt(9)
 v_and_b32 v20, s64, v20
 v_mfma_f32_16x16x32_bf16 v[84:87], a[40:43], a[200:203], v[84:87]
 v_mfma_f32_16x16x32_bf16 v[84:87], a[36:39], a[196:199], v[84:87]
 s_waitcnt lgkmcnt(7)
 v_mfma_f32_16x16x32_bf16 v[84:87], a[32:35], a[192:195], v[84:87]
 v_cmp_ne_u32 vcc, 0, v20
 v_mfma_f32_16x16x32_bf16 v[88:91], a[48:51], a[192:195], v[44:47]
 s_waitcnt lgkmcnt(0)
 v_exp_f32 v16, v80
 v_mfma_f32_16x16x32_bf16 v[88:91], a[52:55], a[196:199], v[88:91]
 v_exp_f32 v17, v81
 v_mfma_f32_16x16x32_bf16 v[88:91], a[56:59], a[200:203], v[88:91]
 v_exp_f32 v18, v82
 v_mfma_f32_16x16x32_bf16 v[88:91], a[60:63], a[204:207], v[88:91]
 s_cbranch_vccnz L_so_133
L_sb_134:
 v_cvt_pk_bf16_f32 v56, v16, v17
 v_mfma_f32_16x16x32_bf16 v[92:95], a[92:95], a[204:207], v[44:47]
 v_exp_f32 v19, v83
 v_mfma_f32_16x16x32_bf16 v[92:95], a[88:91], a[200:203], v[92:95]
 v_exp_f32 v16, v84
 v_mfma_f32_16x16x32_bf16 v[92:95], a[84:87], a[196:199], v[92:95]
 v_cvt_pk_bf16_f32 v57, v18, v19
 v_exp_f32 v17, v85
 v_mfma_f32_16x16x32_bf16 v[92:95], a[80:83], a[192:195], v[92:95]
 s_waitcnt vmcnt(16)
 s_barrier
 s_sub_u32 s68, s68, 1
 s_cbranch_scc1 L_fo_137
L_fb_138:
 v_mfma_f32_16x16x32_bf16 v[160:163], a[96:99], v[48:51], v[160:163]
 s_mov_b32 m0, s77
 v_exp_f32 v18, v86
 v_mfma_f32_16x16x32_bf16 v[160:163], a[144:147], v[52:55], v[160:163]
 buffer_load_dwordx4 v13, s[32:35], s78 offen offset:0 sc1 lds
 v_mfma_f32_16x16x32_bf16 v[164:167], a[148:151], v[52:55], v[164:167]
 buffer_load_dwordx4 v13, s[32:35], s78 offen offset:1024 sc1 lds
 v_mfma_f32_16x16x32_bf16 v[164:167], a[100:103], v[48:51], v[164:167]
 buffer_load_dwordx4 v13, s[32:35], s78 offen offset:2048 sc1 lds
 v_mfma_f32_16x16x32_bf16 v[168:171], a[104:107], v[48:51], v[168:171]
 s_add_u32 s44, s42, 4096
 s_and_b32 s44, s44, 0x7fff
 s_add_u32 s44, s44, s43
 v_mfma_f32_16x16x32_bf16 v[168:171], a[152:155], v[52:55], v[168:171]
 buffer_load_dwordx4 v[96:99], v4, s[8:11], s44 offen offset:0 sc1
 v_mfma_f32_16x16x32_bf16 v[172:175], a[156:159], v[52:55], v[172:175]
 buffer_load_dwordx4 v[100:103], v5, s[8:11], s44 offen offset:0 sc1
 v_mfma_f32_16x16x32_bf16 v[172:175], a[108:111], v[48:51], v[172:175]
 buffer_load_dwordx4 v13, s[32:35], s78 offen offset:3072 sc1 lds
 v_mfma_f32_16x16x32_bf16 v[176:179], a[112:115], v[48:51], v[176:179]
 ds_read_b128 a[96:99], v14 offset:0
 v_cvt_pk_bf16_f32 v58, v16, v17
 v_mfma_f32_16x16x32_bf16 v[176:179], a[160:163], v[52:55], v[176:179]
 ds_read_b128 a[144:147], v14 offset:8192
 v_or3_b32 v21, v56, v57, v58
 v_mfma_f32_16x16x32_bf16 v[180:183], a[164:167], v[52:55], v[180:183]
 ds_read_b128 a[148:151], v14 offset:9216
 v_exp_f32 v19, v87
 v_mfma_f32_16x16x32_bf16 v[180:183], a[116:119], v[48:51], v[180:183]
 buffer_load_dwordx4 v[104:107], v6, s[8:11], s44 offen offset:0 sc1
 v_mfma_f32_16x16x32_bf16 v[184:187], a[120:123], v[48:51], v[184:187]
 s_add_u32 m0, s77, 16384
 v_exp_f32 v16, v88
 v_mfma_f32_16x16x32_bf16 v[184:187], a[168:171], v[52:55], v[184:187]
 ds_read_b128 a[100:103], v14 offset:1024
 v_cvt_pk_bf16_f32 v59, v18, v19
 v_mfma_f32_16x16x32_bf16 v[188:191], a[172:175], v[52:55], v[188:191]
 s_add_u32 s78, s78, 16384
 v_exp_f32 v17, v89
 v_mfma_f32_16x16x32_bf16 v[188:191], a[124:127], v[48:51], v[188:191]
 buffer_load_dwordx4 v13, s[12:15], s78 offen offset:0 sc1 lds
 v_mfma_f32_16x16x32_bf16 a[184:187], v[22:25], v[48:51], a[184:187]
 ds_read_b128 a[104:107], v14 offset:2048
 v_exp_f32 v18, v90
 v_mfma_f32_16x16x32_bf16 a[184:187], v[22:25], v[52:55], a[184:187]
 buffer_load_dwordx4 v[108:111], v7, s[8:11], s44 offen offset:0 sc1
 v_mfma_f32_16x16x32_bf16 v[64:67], a[16:19], a[128:131], v[40:43]
 buffer_load_dwordx4 v13, s[12:15], s78 offen offset:1024 sc1 lds
 v_mfma_f32_16x16x32_bf16 v[64:67], a[20:23], a[132:135], v[64:67]
 ds_read_b128 a[16:19], v14 offset:16384
 v_cvt_pk_bf16_f32 v60, v16, v17
 v_mfma_f32_16x16x32_bf16 v[64:67], a[24:27], a[136:139], v[64:67]
 buffer_load_dwordx4 v13, s[12:15], s78 offen offset:2048 sc1 lds
 v_mfma_f32_16x16x32_bf16 v[64:67], a[28:31], a[140:143], v[64:67]
 ds_read_b128 a[152:155], v14 offset:10240
 v_or3_b32 v21, v21, v59, v60
 v_mfma_f32_16x16x32_bf16 v[68:71], a[44:47], a[140:143], v[40:43]
 buffer_load_dwordx4 v[112:115], v4, s[8:11], s44 offen offset:1024 sc1
 v_mfma_f32_16x16x32_bf16 v[68:71], a[40:43], a[136:139], v[68:71]
 buffer_load_dwordx4 v13, s[12:15], s78 offen offset:3072 sc1 lds
 v_mfma_f32_16x16x32_bf16 v[68:71], a[36:39], a[132:135], v[68:71]
 ds_read_b128 a[156:159], v14 offset:11264
 v_exp_f32 v19, v91
 v_mfma_f32_16x16x32_bf16 v[68:71], a[32:35], a[128:131], v[68:71]
 ds_read_b128 a[108:111], v14 offset:3072
 v_exp_f32 v16, v92
 v_cvt_pk_bf16_f32 v61, v18, v19
 v_exp_f32 v17, v93
 v_exp_f32 v18, v94
 v_cvt_pk_bf16_f32 v62, v16, v17
 v_or3_b32 v21, v21, v61, v62
 v_exp_f32 v19, v95
 s_nop 0
 v_cvt_pk_bf16_f32 v63, v18, v19
 v_or_b32 v21, v21, v63
 v_and_b32 v21, s64, v21
 v_mfma_f32_16x16x32_bf16 v[72:75], a[48:51], a[128:131], v[40:43]
 ds_read_b128 a[112:115], v14 offset:4096
 v_cmp_ne_u32 vcc, 0, v21
 v_mfma_f32_16x16x32_bf16 v[72:75], a[52:55], a[132:135], v[72:75]
 ds_read_b128 a[160:163], v14 offset:12288
 v_exp_f32 v16, v64
 v_mfma_f32_16x16x32_bf16 v[72:75], a[56:59], a[136:139], v[72:75]
 buffer_load_dwordx4 v[116:119], v5, s[8:11], s44 offen offset:1024 sc1
 v_mfma_f32_16x16x32_bf16 v[72:75], a[60:63], a[140:143], v[72:75]
 s_cbranch_vccnz L_so_135
L_sb_136:
 v_exp_f32 v17, v65
 v_mfma_f32_16x16x32_bf16 v[76:79], a[92:95], a[140:143], v[40:43]
 ds_read_b128 a[164:167], v14 offset:13312
 ds_read_b128 a[116:119], v14 offset:5120
 ds_read_b128 a[120:123], v14 offset:6144
 ds_read_b128 a[168:171], v14 offset:14336
 ds_read_b128 a[172:175], v14 offset:15360
 ds_read_b128 a[124:127], v14 offset:7168
 v_mfma_f32_16x16x32_bf16 v[76:79], a[88:91], a[136:139], v[76:79]
 s_add_u32 s39, s42, 10240
 s_and_b32 s39, s39, 0x7fff
 s_add_u32 s39, s39, s43
 v_mfma_f32_16x16x32_bf16 v[76:79], a[84:87], a[132:135], v[76:79]
 s_add_u32 m0, s45, 0
 v_exp_f32 v18, v66
 v_mfma_f32_16x16x32_bf16 v[76:79], a[80:83], a[128:131], v[76:79]
 s_waitcnt lgkmcnt(10)
 ds_read_b128 a[20:23], v14 offset:17408
 v_mfma_f32_16x16x32_bf16 v[192:195], a[96:99], v[56:59], v[192:195]
 buffer_load_dwordx4 v4, s[8:11], s39 offen offset:0 sc1 lds
 v_mfma_f32_16x16x32_bf16 v[192:195], a[144:147], v[60:63], v[192:195]
 buffer_load_dwordx4 v[120:123], v6, s[8:11], s44 offen offset:1024 sc1
 v_mfma_f32_16x16x32_bf16 v[196:199], a[148:151], v[60:63], v[196:199]
 buffer_load_dwordx4 v4, s[8:11], s39 offen offset:1024 sc1 lds
 v_mfma_f32_16x16x32_bf16 v[196:199], a[100:103], v[56:59], v[196:199]
 ds_read_b128 a[24:27], v14 offset:18432
 v_cvt_pk_bf16_f32 v48, v16, v17
 v_mfma_f32_16x16x32_bf16 v[200:203], a[104:107], v[56:59], v[200:203]
 ds_read_b128 a[28:31], v14 offset:19456
 v_exp_f32 v19, v67
 v_mfma_f32_16x16x32_bf16 v[200:203], a[152:155], v[60:63], v[200:203]
 s_waitcnt lgkmcnt(9)
 buffer_load_dwordx4 v[124:127], v7, s[8:11], s44 offen offset:1024 sc1
 v_mfma_f32_16x16x32_bf16 v[204:207], a[156:159], v[60:63], v[204:207]
 s_add_u32 m0, s45, 2048
 v_exp_f32 v16, v68
 v_mfma_f32_16x16x32_bf16 v[204:207], a[108:111], v[56:59], v[204:207]
 buffer_load_dwordx4 v5, s[8:11], s39 offen offset:0 sc1 lds
 v_mfma_f32_16x16x32_bf16 v[208:211], a[112:115], v[56:59], v[208:211]
 ds_read_b128 a[44:47], v14 offset:23552
 v_cvt_pk_bf16_f32 v49, v18, v19
 v_mfma_f32_16x16x32_bf16 v[208:211], a[160:163], v[60:63], v[208:211]
 s_waitcnt lgkmcnt(3)
 v_exp_f32 v17, v69
 v_mfma_f32_16x16x32_bf16 v[212:215], a[164:167], v[60:63], v[212:215]
 buffer_load_dwordx4 v5, s[8:11], s39 offen offset:1024 sc1 lds
 v_mfma_f32_16x16x32_bf16 v[212:215], a[116:119], v[56:59], v[212:215]
 s_add_u32 s79, s76, s58
 v_exp_f32 v18, v70
 v_mfma_f32_16x16x32_bf16 v[216:219], a[120:123], v[56:59], v[216:219]
 s_add_u32 s76, s76, 32768
 ds_read_b128 a[40:43], v14 offset:22528
 v_mfma_f32_16x16x32_bf16 v[216:219], a[168:171], v[60:63], v[216:219]
 s_and_b32 s76, s76, 0x1ffff
 ds_read_b128 a[36:39], v14 offset:21504
 v_mfma_f32_16x16x32_bf16 v[220:223], a[172:175], v[60:63], v[220:223]
 ds_read_b128 a[32:35], v14 offset:20480
 v_cvt_pk_bf16_f32 v50, v16, v17
 v_mfma_f32_16x16x32_bf16 v[220:223], a[124:127], v[56:59], v[220:223]
 ds_read_b128 a[48:51], v14 offset:24576
 v_or3_b32 v20, v48, v49, v50
 v_mfma_f32_16x16x32_bf16 a[188:191], v[22:25], v[56:59], a[188:191]
 ds_read_b128 a[52:55], v14 offset:25600
 ds_read_b128 a[56:59], v14 offset:26624
 ds_read_b128 a[60:63], v14 offset:27648
 ds_read_b128 a[92:95], v14 offset:31744
 ds_read_b128 a[88:91], v14 offset:30720
 ds_read_b128 a[84:87], v14 offset:29696
 ds_read_b128 a[80:83], v14 offset:28672
 v_mfma_f32_16x16x32_bf16 a[188:191], v[22:25], v[60:63], a[188:191]
 s_mov_b32 s77, s79
 v_add_u32 v14, s76, v12
 v_exp_f32 v19, v71
 v_exp_f32 v16, v72
 v_cvt_pk_bf16_f32 v51, v18, v19
 v_exp_f32 v17, v73
 v_exp_f32 v18, v74
 v_cvt_pk_bf16_f32 v52, v16, v17
 v_or3_b32 v20, v20, v51, v52
 v_exp_f32 v19, v75
 v_exp_f32 v16, v76
 v_cvt_pk_bf16_f32 v53, v18, v19
 v_exp_f32 v17, v77
 v_mfma_f32_16x16x32_bf16 v[80:83], a[16:19], a[192:195], v[44:47]
 v_exp_f32 v18, v78
 v_mfma_f32_16x16x32_bf16 v[80:83], a[20:23], a[196:199], v[80:83]
 s_waitcnt lgkmcnt(11)
 v_cvt_pk_bf16_f32 v54, v16, v17
 v_or3_b32 v20, v20, v53, v54
 v_mfma_f32_16x16x32_bf16 v[80:83], a[24:27], a[200:203], v[80:83]
 v_exp_f32 v19, v79
 v_mfma_f32_16x16x32_bf16 v[80:83], a[28:31], a[204:207], v[80:83]
 v_cvt_pk_bf16_f32 v55, v18, v19
 v_or_b32 v20, v20, v55
 v_mfma_f32_16x16x32_bf16 v[84:87], a[44:47], a[204:207], v[44:47]
 s_waitcnt lgkmcnt(10)
 v_and_b32 v20, s64, v20
 v_mfma_f32_16x16x32_bf16 v[84:87], a[40:43], a[200:203], v[84:87]
 s_waitcnt lgkmcnt(9)
 v_mfma_f32_16x16x32_bf16 v[84:87], a[36:39], a[196:199], v[84:87]
 s_waitcnt lgkmcnt(8)
 v_mfma_f32_16x16x32_bf16 v[84:87], a[32:35], a[192:195], v[84:87]
 s_waitcnt lgkmcnt(7)
 v_cmp_ne_u32 vcc, 0, v20
 v_mfma_f32_16x16x32_bf16 v[88:91], a[48:51], a[192:195], v[44:47]
 s_waitcnt lgkmcnt(0)
 v_exp_f32 v16, v80
 v_mfma_f32_16x16x32_bf16 v[88:91], a[52:55], a[196:199], v[88:91]
 s_cbranch_vccnz L_so_139
L_sb_140:
 v_exp_f32 v17, v81
 v_mfma_f32_16x16x32_bf16 v[88:91], a[56:59], a[200:203], v[88:91]
 v_exp_f32 v18, v82
 v_mfma_f32_16x16x32_bf16 v[88:91], a[60:63], a[204:207], v[88:91]
 v_cvt_pk_bf16_f32 v56, v16, v17
 v_exp_f32 v19, v83
 v_mfma_f32_16x16x32_bf16 v[92:95], a[92:95], a[204:207], v[44:47]
 v_exp_f32 v16, v84
 v_mfma_f32_16x16x32_bf16 v[92:95], a[88:91], a[200:203], v[92:95]
 v_cvt_pk_bf16_f32 v57, v18, v19
 v_exp_f32 v17, v85
 v_mfma_f32_16x16x32_bf16 v[92:95], a[84:87], a[196:199], v[92:95]
 v_exp_f32 v18, v86
 v_mfma_f32_16x16x32_bf16 v[92:95], a[80:83], a[192:195], v[92:95]
 s_waitcnt vmcnt(16)
 s_barrier
 s_sub_u32 s68, s68, 1
 s_cbranch_scc1 L_fo_143
L_fb_144:
 v_mfma_f32_16x16x32_bf16 v[160:163], a[96:99], v[48:51], v[160:163]
 s_add_u32 s39, s42, 10240
 s_and_b32 s39, s39, 0x7fff
 s_add_u32 s39, s39, s43
 v_mfma_f32_16x16x32_bf16 v[160:163], a[144:147], v[52:55], v[160:163]
 s_add_u32 m0, s45, 4096
 v_cvt_pk_bf16_f32 v58, v16, v17
 v_or3_b32 v21, v56, v57, v58
 v_mfma_f32_16x16x32_bf16 v[164:167], a[148:151], v[52:55], v[164:167]
 buffer_load_dwordx4 v6, s[8:11], s39 offen offset:0 sc1 lds
 v_mfma_f32_16x16x32_bf16 v[164:167], a[100:103], v[48:51], v[164:167]
 buffer_load_dwordx4 v6, s[8:11], s39 offen offset:1024 sc1 lds
 v_mfma_f32_16x16x32_bf16 v[168:171], a[104:107], v[48:51], v[168:171]
 s_add_u32 s44, s42, 6144
 s_and_b32 s44, s44, 0x7fff
 s_add_u32 s44, s44, s43
 v_mfma_f32_16x16x32_bf16 v[168:171], a[152:155], v[52:55], v[168:171]
 buffer_load_dwordx4 v[128:131], v4, s[8:11], s44 offen offset:0 sc1
 v_mfma_f32_16x16x32_bf16 v[172:175], a[156:159], v[52:55], v[172:175]
 buffer_load_dwordx4 v[132:135], v5, s[8:11], s44 offen offset:0 sc1
 v_mfma_f32_16x16x32_bf16 v[172:175], a[108:111], v[48:51], v[172:175]
 s_add_u32 m0, s45, 6144
 v_exp_f32 v19, v87
 v_mfma_f32_16x16x32_bf16 v[176:179], a[112:115], v[48:51], v[176:179]
 buffer_load_dwordx4 v7, s[8:11], s39 offen offset:0 sc1 lds
 v_mfma_f32_16x16x32_bf16 v[176:179], a[160:163], v[52:55], v[176:179]
 buffer_load_dwordx4 v7, s[8:11], s39 offen offset:1024 sc1 lds
 v_mfma_f32_16x16x32_bf16 v[180:183], a[164:167], v[52:55], v[180:183]
 ds_read_b128 a[96:99], v14 offset:0
 v_exp_f32 v16, v88
 v_mfma_f32_16x16x32_bf16 v[180:183], a[116:119], v[48:51], v[180:183]
 buffer_load_dwordx4 v[136:139], v6, s[8:11], s44 offen offset:0 sc1
 v_mfma_f32_16x16x32_bf16 v[184:187], a[120:123], v[48:51], v[184:187]
 ds_read_b128 a[144:147], v14 offset:8192
 v_cvt_pk_bf16_f32 v59, v18, v19
 v_mfma_f32_16x16x32_bf16 v[184:187], a[168:171], v[52:55], v[184:187]
 ds_read_b128 a[148:151], v14 offset:9216
 v_exp_f32 v17, v89
 v_mfma_f32_16x16x32_bf16 v[188:191], a[172:175], v[52:55], v[188:191]
 s_add_u32 s49, s77, s58
 v_exp_f32 v18, v90
 v_mfma_f32_16x16x32_bf16 v[188:191], a[124:127], v[48:51], v[188:191]
 ds_read_b128 a[100:103], v14 offset:1024
 v_cvt_pk_bf16_f32 v60, v16, v17
 v_mfma_f32_16x16x32_bf16 a[184:187], v[22:25], v[48:51], a[184:187]
 ds_read_b128 a[104:107], v14 offset:2048
 v_or3_b32 v21, v21, v59, v60
 v_mfma_f32_16x16x32_bf16 a[184:187], v[22:25], v[52:55], a[184:187]
 buffer_load_dwordx4 v[140:143], v7, s[8:11], s44 offen offset:0 sc1
 v_mfma_f32_16x16x32_bf16 v[64:67], a[16:19], a[128:131], v[40:43]
 s_add_u32 s39, s42, 14336
 s_and_b32 s39, s39, 0x7fff
 s_add_u32 s39, s39, s43
 v_mfma_f32_16x16x32_bf16 v[64:67], a[20:23], a[132:135], v[64:67]
 s_add_u32 m0, s49, 0
 v_exp_f32 v19, v91
 v_mfma_f32_16x16x32_bf16 v[64:67], a[24:27], a[136:139], v[64:67]
 buffer_load_dwordx4 v4, s[8:11], s39 offen offset:0 sc1 lds
 v_mfma_f32_16x16x32_bf16 v[64:67], a[28:31], a[140:143], v[64:67]
 buffer_load_dwordx4 v4, s[8:11], s39 offen offset:1024 sc1 lds
 v_mfma_f32_16x16x32_bf16 v[68:71], a[44:47], a[140:143], v[40:43]
 buffer_load_dwordx4 v[144:147], v4, s[8:11], s44 offen offset:1024 sc1
 v_mfma_f32_16x16x32_bf16 v[68:71], a[40:43], a[136:139], v[68:71]
 ds_read_b128 a[152:155], v14 offset:10240
 v_exp_f32 v16, v92
 v_mfma_f32_16x16x32_bf16 v[68:71], a[36:39], a[132:135], v[68:71]
 ds_read_b128 a[156:159], v14 offset:11264
 v_cvt_pk_bf16_f32 v61, v18, v19
 v_mfma_f32_16x16x32_bf16 v[68:71], a[32:35], a[128:131], v[68:71]
 ds_read_b128 a[108:111], v14 offset:3072
 v_exp_f32 v17, v93
 v_exp_f32 v18, v94
 v_cvt_pk_bf16_f32 v62, v16, v17
 v_or3_b32 v21, v21, v61, v62
 v_exp_f32 v19, v95
 s_nop 0
 v_cvt_pk_bf16_f32 v63, v18, v19
 v_or_b32 v21, v21, v63
 v_and_b32 v21, s64, v21
 v_mfma_f32_16x16x32_bf16 v[72:75], a[48:51], a[128:131], v[40:43]
 ds_read_b128 a[112:115], v14 offset:4096
 v_cmp_ne_u32 vcc, 0, v21
 v_mfma_f32_16x16x32_bf16 v[72:75], a[52:55], a[132:135], v[72:75]
 s_add_u32 m0, s49, 2048
 s_nop 0
 buffer_load_dwordx4 v5, s[8:11], s39 offen offset:0 sc1 lds
 v_mfma_f32_16x16x32_bf16 v[72:75], a[56:59], a[136:139], v[72:75]
 buffer_load_dwordx4 v[148:151], v5, s[8:11], s44 offen offset:1024 sc1
 v_mfma_f32_16x16x32_bf16 v[72:75], a[60:63], a[140:143], v[72:75]
 buffer_load_dwordx4 v5, s[8:11], s39 offen offset:1024 sc1 lds
 s_cbranch_vccnz L_so_141
L_sb_142:
 v_mfma_f32_16x16x32_bf16 v[76:79], a[92:95], a[140:143], v[40:43]
 ds_read_b128 a[160:163], v14 offset:12288
 ds_read_b128 a[164:167], v14 offset:13312
 ds_read_b128 a[116:119], v14 offset:5120
 ds_read_b128 a[120:123], v14 offset:6144
 ds_read_b128 a[168:171], v14 offset:14336
 ds_read_b128 a[172:175], v14 offset:15360
 ds_read_b128 a[124:127], v14 offset:7168
 v_mfma_f32_16x16x32_bf16 v[76:79], a[88:91], a[136:139], v[76:79]
 ds_read_b128 a[16:19], v14 offset:16384
 v_exp_f32 v16, v64
 v_mfma_f32_16x16x32_bf16 v[76:79], a[84:87], a[132:135], v[76:79]
 ds_read_b128 a[20:23], v14 offset:17408
 v_exp_f32 v17, v65
 v_mfma_f32_16x16x32_bf16 v[76:79], a[80:83], a[128:131], v[76:79]
 s_waitcnt lgkmcnt(12)
 v_exp_f32 v18, v66
 v_mfma_f32_16x16x32_bf16 v[192:195], a[96:99], v[56:59], v[192:195]
 buffer_load_dwordx4 v[152:155], v6, s[8:11], s44 offen offset:1024 sc1
 v_mfma_f32_16x16x32_bf16 v[192:195], a[144:147], v[60:63], v[192:195]
 ds_read_b128 a[24:27], v14 offset:18432
 v_cvt_pk_bf16_f32 v48, v16, v17
 v_mfma_f32_16x16x32_bf16 v[196:199], a[148:151], v[60:63], v[196:199]
 s_add_u32 m0, s49, 4096
 v_exp_f32 v19, v67
 v_mfma_f32_16x16x32_bf16 v[196:199], a[100:103], v[56:59], v[196:199]
 buffer_load_dwordx4 v6, s[8:11], s39 offen offset:0 sc1 lds
 v_mfma_f32_16x16x32_bf16 v[200:203], a[104:107], v[56:59], v[200:203]
 buffer_load_dwordx4 v6, s[8:11], s39 offen offset:1024 sc1 lds
 v_mfma_f32_16x16x32_bf16 v[200:203], a[152:155], v[60:63], v[200:203]
 s_waitcnt lgkmcnt(10)
 buffer_load_dwordx4 v[156:159], v7, s[8:11], s44 offen offset:1024 sc1
 v_mfma_f32_16x16x32_bf16 v[204:207], a[156:159], v[60:63], v[204:207]
 s_add_u32 m0, s49, 6144
 v_exp_f32 v16, v68
 v_mfma_f32_16x16x32_bf16 v[204:207], a[108:111], v[56:59], v[204:207]
 buffer_load_dwordx4 v7, s[8:11], s39 offen offset:0 sc1 lds
 v_mfma_f32_16x16x32_bf16 v[208:211], a[112:115], v[56:59], v[208:211]
 s_waitcnt lgkmcnt(1)
 ds_read_b128 a[28:31], v14 offset:19456
 v_cvt_pk_bf16_f32 v49, v18, v19
 v_mfma_f32_16x16x32_bf16 v[208:211], a[160:163], v[60:63], v[208:211]
 buffer_load_dwordx4 v7, s[8:11], s39 offen offset:1024 sc1 lds
 v_mfma_f32_16x16x32_bf16 v[212:215], a[164:167], v[60:63], v[212:215]
 v_exp_f32 v17, v69
 v_mfma_f32_16x16x32_bf16 v[212:215], a[116:119], v[56:59], v[212:215]
 s_add_u32 s79, s76, s58
 v_exp_f32 v18, v70
 v_mfma_f32_16x16x32_bf16 v[216:219], a[120:123], v[56:59], v[216:219]
 s_add_u32 s76, s76, 32768
 ds_read_b128 a[44:47], v14 offset:23552
 v_mfma_f32_16x16x32_bf16 v[216:219], a[168:171], v[60:63], v[216:219]
 s_and_b32 s76, s76, 0x1ffff
 ds_read_b128 a[40:43], v14 offset:22528
 v_mfma_f32_16x16x32_bf16 v[220:223], a[172:175], v[60:63], v[220:223]
 ds_read_b128 a[36:39], v14 offset:21504
 v_cvt_pk_bf16_f32 v50, v16, v17
 v_or3_b32 v20, v48, v49, v50
 v_mfma_f32_16x16x32_bf16 v[220:223], a[124:127], v[56:59], v[220:223]
 ds_read_b128 a[32:35], v14 offset:20480
 v_exp_f32 v19, v71
 v_mfma_f32_16x16x32_bf16 a[188:191], v[22:25], v[56:59], a[188:191]
 ds_read_b128 a[48:51], v14 offset:24576
 ds_read_b128 a[52:55], v14 offset:25600
 ds_read_b128 a[56:59], v14 offset:26624
 ds_read_b128 a[60:63], v14 offset:27648
 ds_read_b128 a[92:95], v14 offset:31744
 ds_read_b128 a[88:91], v14 offset:30720
 ds_read_b128 a[84:87], v14 offset:29696
 ds_read_b128 a[80:83], v14 offset:28672
 v_mfma_f32_16x16x32_bf16 a[188:191], v[22:25], v[60:63], a[188:191]
 s_mov_b32 s77, s79
 v_add_u32 v14, s76, v12
 v_exp_f32 v16, v72
 v_cvt_pk_bf16_f32 v51, v18, v19
 v_exp_f32 v17, v73
 v_exp_f32 v18, v74
 v_cvt_pk_bf16_f32 v52, v16, v17
 v_or3_b32 v20, v20, v51, v52
 v_exp_f32 v19, v75
 v_exp_f32 v16, v76
 v_cvt_pk_bf16_f32 v53, v18, v19
 v_exp_f32 v17, v77
sequential_preLN__compressed_kv_cla__glu_gated_swiglu__prompt_kernel_cB:
L_w0_145:
 s_cmp_eq_u32 s3, 0
 s_cbranch_scc0 L_w1_146
 s_waitcnt lgkmcnt(13)
 v_mfma_f32_16x16x32_bf16 v[80:83], a[16:19], a[192:195], v[44:47]
 v_exp_f32 v18, v78
 v_mfma_f32_16x16x32_bf16 v[80:83], a[20:23], a[196:199], v[80:83]
 v_cvt_pk_bf16_f32 v54, v16, v17
 v_or3_b32 v20, v20, v53, v54
 v_mfma_f32_16x16x32_bf16 v[80:83], a[24:27], a[200:203], v[80:83]
 s_waitcnt lgkmcnt(12)
 v_exp_f32 v19, v79
 v_mfma_f32_16x16x32_bf16 v[80:83], a[28:31], a[204:207], v[80:83]
 s_waitcnt lgkmcnt(11)
 v_cvt_pk_bf16_f32 v55, v18, v19
 v_or_b32 v20, v20, v55
 v_mfma_f32_16x16x32_bf16 v[84:87], a[44:47], a[204:207], v[44:47]
 s_waitcnt lgkmcnt(10)
 v_and_b32 v20, s64, v20
 v_mfma_f32_16x16x32_bf16 v[84:87], a[40:43], a[200:203], v[84:87]
 s_waitcnt lgkmcnt(9)
 v_mfma_f32_16x16x32_bf16 v[84:87], a[36:39], a[196:199], v[84:87]
 s_waitcnt lgkmcnt(8)
 v_mfma_f32_16x16x32_bf16 v[84:87], a[32:35], a[192:195], v[84:87]
 s_waitcnt lgkmcnt(7)
 v_cmp_ne_u32 vcc, 0, v20
 v_mfma_f32_16x16x32_bf16 v[88:91], a[48:51], a[192:195], v[44:47]
 s_waitcnt lgkmcnt(0)
 v_exp_f32 v16, v80
 v_mfma_f32_16x16x32_bf16 v[88:91], a[52:55], a[196:199], v[88:91]
 s_cbranch_vccnz L_so_150
L_sb_151:
 v_exp_f32 v17, v81
 v_mfma_f32_16x16x32_bf16 v[88:91], a[56:59], a[200:203], v[88:91]
 v_exp_f32 v18, v82
 v_mfma_f32_16x16x32_bf16 v[88:91], a[60:63], a[204:207], v[88:91]
 v_cvt_pk_bf16_f32 v56, v16, v17
 v_exp_f32 v19, v83
 v_mfma_f32_16x16x32_bf16 v[92:95], a[92:95], a[204:207], v[44:47]
 v_exp_f32 v16, v84
 v_mfma_f32_16x16x32_bf16 v[92:95], a[88:91], a[200:203], v[92:95]
 v_cvt_pk_bf16_f32 v57, v18, v19
 v_exp_f32 v17, v85
 v_mfma_f32_16x16x32_bf16 v[92:95], a[84:87], a[196:199], v[92:95]
 v_exp_f32 v18, v86
 v_mfma_f32_16x16x32_bf16 v[92:95], a[80:83], a[192:195], v[92:95]
 s_waitcnt vmcnt(0)
 s_barrier
 s_sub_u32 s68, s68, 1
 s_cbranch_scc1 L_fo_154
L_fb_155:
 v_mfma_f32_16x16x32_bf16 v[160:163], a[96:99], v[48:51], v[160:163]
 ds_read_b128 a[96:99], v14 offset:0
 v_cvt_pk_bf16_f32 v58, v16, v17
 v_mfma_f32_16x16x32_bf16 v[160:163], a[144:147], v[52:55], v[160:163]
 ds_read_b128 a[144:147], v14 offset:8192
 v_or3_b32 v21, v56, v57, v58
 v_mfma_f32_16x16x32_bf16 v[164:167], a[148:151], v[52:55], v[164:167]
 s_add_u32 s48, s77, s58
 v_exp_f32 v19, v87
 v_mfma_f32_16x16x32_bf16 v[164:167], a[100:103], v[48:51], v[164:167]
 s_sub_u32 s49, s48, 32768
 s_and_b32 s49, s49, 0x1ffff
 v_exp_f32 v16, v88
 v_mfma_f32_16x16x32_bf16 v[168:171], a[104:107], v[48:51], v[168:171]
 ds_read_b128 a[148:151], v14 offset:9216
 v_add_u32 v9, s48, v4
 v_mfma_f32_16x16x32_bf16 v[168:171], a[152:155], v[52:55], v[168:171]
 ds_read_b128 a[100:103], v14 offset:1024
 v_cvt_pk_bf16_f32 v59, v18, v19
 v_mfma_f32_16x16x32_bf16 v[172:175], a[156:159], v[52:55], v[172:175]
 s_add_u32 s44, s42, 12288
 s_and_b32 s44, s44, 0x7fff
 s_add_u32 s44, s44, s43
 v_mfma_f32_16x16x32_bf16 v[172:175], a[108:111], v[48:51], v[172:175]
 s_add_u32 m0, s48, 0
 v_exp_f32 v17, v89
 v_mfma_f32_16x16x32_bf16 v[176:179], a[112:115], v[48:51], v[176:179]
 buffer_load_dwordx4 v4, s[8:11], s44 offen offset:0 sc1 lds
 v_mfma_f32_16x16x32_bf16 v[176:179], a[160:163], v[52:55], v[176:179]
 buffer_load_dwordx4 v4, s[8:11], s44 offen offset:1024 sc1 lds
 v_mfma_f32_16x16x32_bf16 v[180:183], a[164:167], v[52:55], v[180:183]
 ds_read_b128 a[104:107], v14 offset:2048
 v_exp_f32 v18, v90
 v_mfma_f32_16x16x32_bf16 v[180:183], a[116:119], v[48:51], v[180:183]
 ds_read_b128 a[152:155], v14 offset:10240
 v_cvt_pk_bf16_f32 v60, v16, v17
 v_mfma_f32_16x16x32_bf16 v[184:187], a[120:123], v[48:51], v[184:187]
 ds_read_b128 a[156:159], v14 offset:11264
 v_or3_b32 v21, v21, v59, v60
 v_mfma_f32_16x16x32_bf16 v[184:187], a[168:171], v[52:55], v[184:187]
 s_add_u32 m0, s48, 2048
 ds_read_b128 a[108:111], v14 offset:3072
 v_mfma_f32_16x16x32_bf16 v[188:191], a[172:175], v[52:55], v[188:191]
 buffer_load_dwordx4 v5, s[8:11], s44 offen offset:0 sc1 lds
 v_mfma_f32_16x16x32_bf16 v[188:191], a[124:127], v[48:51], v[188:191]
 ds_read_b128 a[112:115], v14 offset:4096
 v_exp_f32 v19, v91
 v_mfma_f32_16x16x32_bf16 a[184:187], v[22:25], v[48:51], a[184:187]
 buffer_load_dwordx4 v5, s[8:11], s44 offen offset:1024 sc1 lds
 v_mfma_f32_16x16x32_bf16 a[184:187], v[22:25], v[52:55], a[184:187]
 ds_read_b128 a[160:163], v14 offset:12288
 v_exp_f32 v16, v92
 v_mov_b32 v3, 4048155338
 v_cndmask_b32 v28, v3, v40, s[80:81]
 v_cndmask_b32 v29, v3, v41, s[82:83]
 v_cndmask_b32 v30, v3, v42, s[84:85]
 v_cndmask_b32 v31, v3, v43, s[86:87]
 s_nop 1
 v_mfma_f32_16x16x32_bf16 v[64:67], a[16:19], a[128:131], v[28:31]
 ds_read_b128 a[164:167], v14 offset:13312
 ds_read_b128 a[116:119], v14 offset:5120
 ds_read_b128 a[120:123], v14 offset:6144
 ds_read_b128 a[168:171], v14 offset:14336
 ds_read_b128 a[172:175], v14 offset:15360
 ds_read_b128 a[124:127], v14 offset:7168
 v_mfma_f32_16x16x32_bf16 v[64:67], a[20:23], a[132:135], v[64:67]
 ds_read_b128 a[16:19], v14 offset:16384
 v_cvt_pk_bf16_f32 v61, v18, v19
 v_exp_f32 v17, v93
 v_exp_f32 v18, v94
 v_cvt_pk_bf16_f32 v62, v16, v17
 v_or3_b32 v21, v21, v61, v62
 v_exp_f32 v19, v95
 s_nop 0
 v_cvt_pk_bf16_f32 v63, v18, v19
 v_or_b32 v21, v21, v63
 v_and_b32 v21, s64, v21
 v_mfma_f32_16x16x32_bf16 v[64:67], a[24:27], a[136:139], v[64:67]
 ds_read_b128 a[20:23], v14 offset:17408
 v_cmp_ne_u32 vcc, 0, v21
 v_mfma_f32_16x16x32_bf16 v[64:67], a[28:31], a[140:143], v[64:67]
 s_waitcnt lgkmcnt(12)
 s_add_u32 m0, s48, 4096
 s_cbranch_vccnz L_so_152
L_sb_153:
 v_mfma_f32_16x16x32_bf16 v[192:195], a[96:99], v[56:59], v[192:195]
 buffer_load_dwordx4 v6, s[8:11], s44 offen offset:0 sc1 lds
 v_mfma_f32_16x16x32_bf16 v[192:195], a[144:147], v[60:63], v[192:195]
 buffer_load_dwordx4 v6, s[8:11], s44 offen offset:1024 sc1 lds
 v_mfma_f32_16x16x32_bf16 v[196:199], a[148:151], v[60:63], v[196:199]
 ds_read_b128 a[24:27], v14 offset:18432
 v_mov_b32 v68, 4048155338
 v_mfma_f32_16x16x32_bf16 v[196:199], a[100:103], v[56:59], v[196:199]
 ds_read_b128 a[28:31], v14 offset:19456
 v_mov_b32 v69, 4048155338
 v_mfma_f32_16x16x32_bf16 v[200:203], a[104:107], v[56:59], v[200:203]
 ds_read_b128 a[44:47], v14 offset:23552
 v_mov_b32 v70, 4048155338
 v_mfma_f32_16x16x32_bf16 v[200:203], a[152:155], v[60:63], v[200:203]
 s_waitcnt lgkmcnt(11)
 s_add_u32 m0, s48, 6144
 v_mov_b32 v71, 4048155338
 v_mov_b32 v72, 4048155338
 v_mfma_f32_16x16x32_bf16 v[204:207], a[156:159], v[60:63], v[204:207]
 v_mov_b32 v73, 4048155338
 v_mov_b32 v74, 4048155338
 v_mfma_f32_16x16x32_bf16 v[204:207], a[108:111], v[56:59], v[204:207]
 buffer_load_dwordx4 v7, s[8:11], s44 offen offset:0 sc1 lds
 v_mfma_f32_16x16x32_bf16 v[208:211], a[112:115], v[56:59], v[208:211]
 buffer_load_dwordx4 v7, s[8:11], s44 offen offset:1024 sc1 lds
 v_mfma_f32_16x16x32_bf16 v[208:211], a[160:163], v[60:63], v[208:211]
 s_waitcnt lgkmcnt(3)
 s_add_u32 s79, s76, s58
 v_add_u32 v10, s49, v4
 v_mov_b32 v75, 4048155338
 v_mfma_f32_16x16x32_bf16 v[212:215], a[164:167], v[60:63], v[212:215]
 s_add_u32 s76, s76, 32768
 v_mov_b32 v76, 4048155338
 v_mov_b32 v77, 4048155338
 v_mfma_f32_16x16x32_bf16 v[212:215], a[116:119], v[56:59], v[212:215]
 ds_read_b128 a[40:43], v14 offset:22528
 v_mov_b32 v78, 4048155338
 v_mfma_f32_16x16x32_bf16 v[216:219], a[120:123], v[56:59], v[216:219]
 ds_read_b128 a[36:39], v14 offset:21504
 v_mov_b32 v79, 4048155338
 v_mfma_f32_16x16x32_bf16 v[216:219], a[168:171], v[60:63], v[216:219]
 s_and_b32 s76, s76, 0x1ffff
 ds_read_b128 a[32:35], v14 offset:20480
 v_mfma_f32_16x16x32_bf16 v[220:223], a[172:175], v[60:63], v[220:223]
 ds_read_b128 a[48:51], v14 offset:24576
 v_mov_b32 v50, 0
 v_mov_b32 v51, 0
 v_mfma_f32_16x16x32_bf16 v[220:223], a[124:127], v[56:59], v[220:223]
 ds_read_b128 a[52:55], v14 offset:25600
 ds_read_b128 a[56:59], v14 offset:26624
 v_mfma_f32_16x16x32_bf16 a[188:191], v[22:25], v[56:59], a[188:191]
 ds_read_b128 a[60:63], v14 offset:27648
 ds_read_b128 a[92:95], v14 offset:31744
 ds_read_b128 a[88:91], v14 offset:30720
 ds_read_b128 a[84:87], v14 offset:29696
 ds_read_b128 a[80:83], v14 offset:28672
 v_mfma_f32_16x16x32_bf16 a[188:191], v[22:25], v[60:63], a[188:191]
 s_mov_b32 s77, s79
 v_add_u32 v14, s76, v12
 v_exp_f32 v16, v64
 v_mfma_f32_16x16x32_bf16 v[80:83], a[16:19], a[192:195], v[44:47]
 v_exp_f32 v17, v65
 v_mfma_f32_16x16x32_bf16 v[80:83], a[20:23], a[196:199], v[80:83]
 s_waitcnt lgkmcnt(11)
 v_exp_f32 v18, v66
 v_mfma_f32_16x16x32_bf16 v[80:83], a[24:27], a[200:203], v[80:83]
 v_cvt_pk_bf16_f32 v48, v16, v17
 v_mfma_f32_16x16x32_bf16 v[80:83], a[28:31], a[204:207], v[80:83]
 v_exp_f32 v19, v67
 v_mfma_f32_16x16x32_bf16 v[84:87], a[44:47], a[204:207], v[44:47]
 s_waitcnt lgkmcnt(9)
 v_cvt_pk_bf16_f32 v49, v18, v19
 v_or_b32 v20, v48, v49
 v_mfma_f32_16x16x32_bf16 v[84:87], a[40:43], a[200:203], v[84:87]
 v_and_b32 v20, s64, v20
 v_mfma_f32_16x16x32_bf16 v[84:87], a[36:39], a[196:199], v[84:87]
 s_waitcnt lgkmcnt(7)
 v_mfma_f32_16x16x32_bf16 v[84:87], a[32:35], a[192:195], v[84:87]
 v_cmp_ne_u32 vcc, 0, v20
 v_mfma_f32_16x16x32_bf16 v[88:91], a[48:51], a[192:195], v[44:47]
 s_waitcnt lgkmcnt(0)
 v_exp_f32 v16, v80
 v_mfma_f32_16x16x32_bf16 v[88:91], a[52:55], a[196:199], v[88:91]
 s_cbranch_vccnz L_so_156
L_sb_157:
 v_exp_f32 v17, v81
 v_mfma_f32_16x16x32_bf16 v[88:91], a[56:59], a[200:203], v[88:91]
 v_exp_f32 v18, v82
 v_mfma_f32_16x16x32_bf16 v[88:91], a[60:63], a[204:207], v[88:91]
 v_cvt_pk_bf16_f32 v56, v16, v17
 v_exp_f32 v19, v83
 v_mov_b32 v3, 4048155338
 v_cndmask_b32 v28, v3, v44, s[80:81]
 v_cndmask_b32 v29, v3, v45, s[82:83]
 v_cndmask_b32 v30, v3, v46, s[84:85]
 v_cndmask_b32 v31, v3, v47, s[86:87]
 s_nop 1
 v_mfma_f32_16x16x32_bf16 v[92:95], a[92:95], a[204:207], v[28:31]
 v_exp_f32 v16, v84
 v_mfma_f32_16x16x32_bf16 v[92:95], a[88:91], a[200:203], v[92:95]
 v_cvt_pk_bf16_f32 v57, v18, v19
 v_exp_f32 v17, v85
 v_mfma_f32_16x16x32_bf16 v[92:95], a[84:87], a[196:199], v[92:95]
 v_exp_f32 v18, v86
 v_mfma_f32_16x16x32_bf16 v[92:95], a[80:83], a[192:195], v[92:95]
 s_barrier
 s_sub_u32 s68, s68, 1
 s_cbranch_scc1 L_fo_158
L_fb_159:
 v_mfma_f32_16x16x32_bf16 v[160:163], a[96:99], v[48:51], v[160:163]
 ds_read_b128 a[96:99], v14 offset:0
 v_cvt_pk_bf16_f32 v58, v16, v17
 v_mfma_f32_16x16x32_bf16 v[164:167], a[100:103], v[48:51], v[164:167]
 ds_read_b128 a[144:147], v14 offset:8192
 v_or3_b32 v21, v56, v57, v58
 v_mfma_f32_16x16x32_bf16 v[168:171], a[104:107], v[48:51], v[168:171]
 ds_read_b128 a[148:151], v14 offset:9216
 v_exp_f32 v19, v87
 v_mfma_f32_16x16x32_bf16 v[172:175], a[108:111], v[48:51], v[172:175]
 ds_read_b128 a[100:103], v14 offset:1024
 v_exp_f32 v16, v88
 v_mfma_f32_16x16x32_bf16 v[176:179], a[112:115], v[48:51], v[176:179]
 ds_read_b128 a[104:107], v14 offset:2048
 v_cvt_pk_bf16_f32 v59, v18, v19
 v_mfma_f32_16x16x32_bf16 v[180:183], a[116:119], v[48:51], v[180:183]
 ds_read_b128 a[152:155], v14 offset:10240
 v_exp_f32 v17, v89
 v_mfma_f32_16x16x32_bf16 v[184:187], a[120:123], v[48:51], v[184:187]
 ds_read_b128 a[156:159], v14 offset:11264
 v_exp_f32 v18, v90
 v_mfma_f32_16x16x32_bf16 v[188:191], a[124:127], v[48:51], v[188:191]
 ds_read_b128 a[108:111], v14 offset:3072
 v_cvt_pk_bf16_f32 v60, v16, v17
 v_or3_b32 v21, v21, v59, v60
 v_mfma_f32_16x16x32_bf16 a[184:187], v[22:25], v[48:51], a[184:187]
 ds_read_b128 a[112:115], v14 offset:4096
 ds_read_b128 a[160:163], v14 offset:12288
 ds_read_b128 a[164:167], v14 offset:13312
 ds_read_b128 a[116:119], v14 offset:5120
 ds_read_b128 a[120:123], v14 offset:6144
 v_exp_f32 v19, v91
 v_exp_f32 v16, v92
 v_cvt_pk_bf16_f32 v61, v18, v19
 v_exp_f32 v17, v93
 v_exp_f32 v18, v94
 v_cvt_pk_bf16_f32 v62, v16, v17
 v_or3_b32 v21, v21, v61, v62
 v_exp_f32 v19, v95
 s_nop 0
 v_cvt_pk_bf16_f32 v63, v18, v19
 v_or_b32 v21, v21, v63
 v_and_b32 v21, s64, v21
 ds_read_b128 a[168:171], v14 offset:14336
 ds_read_b128 a[172:175], v14 offset:15360
 ds_read_b128 a[124:127], v14 offset:7168
 v_cmp_ne_u32 vcc, 0, v21
 v_accvgpr_read_b32 v26, a184
 v_rcp_f32 v26, v26
 s_nop 0
 v_mul_f32 v26, 0x1f800000, v26
 s_nop 0
 s_cbranch_vccnz L_so_160
L_sb_161:
 s_waitcnt lgkmcnt(15)
 v_mfma_f32_16x16x32_bf16 v[192:195], a[96:99], v[56:59], v[192:195]
 s_waitcnt lgkmcnt(14)
 v_mul_f32 v160, v160, v26
 v_mul_f32 v161, v161, v26
 v_mfma_f32_16x16x32_bf16 v[192:195], a[144:147], v[60:63], v[192:195]
 s_waitcnt lgkmcnt(13)
 v_cvt_pk_bf16_f32 v160, v160, v161
 v_mfma_f32_16x16x32_bf16 v[196:199], a[148:151], v[60:63], v[196:199]
 s_waitcnt lgkmcnt(12)
 v_mul_f32 v162, v162, v26
 v_mul_f32 v163, v163, v26
 v_mfma_f32_16x16x32_bf16 v[196:199], a[100:103], v[56:59], v[196:199]
 s_waitcnt lgkmcnt(11)
 v_cvt_pk_bf16_f32 v161, v162, v163
 v_mfma_f32_16x16x32_bf16 v[200:203], a[104:107], v[56:59], v[200:203]
 s_waitcnt lgkmcnt(10)
 v_mul_f32 v164, v164, v26
 v_mul_f32 v165, v165, v26
 v_mfma_f32_16x16x32_bf16 v[200:203], a[152:155], v[60:63], v[200:203]
 s_waitcnt lgkmcnt(9)
 v_cvt_pk_bf16_f32 v162, v164, v165
 v_mfma_f32_16x16x32_bf16 v[204:207], a[156:159], v[60:63], v[204:207]
 s_waitcnt lgkmcnt(8)
 v_mul_f32 v166, v166, v26
 v_mul_f32 v167, v167, v26
 v_mfma_f32_16x16x32_bf16 v[204:207], a[108:111], v[56:59], v[204:207]
 s_waitcnt lgkmcnt(7)
 v_mfma_f32_16x16x32_bf16 v[208:211], a[112:115], v[56:59], v[208:211]
 s_waitcnt lgkmcnt(6)
 v_mfma_f32_16x16x32_bf16 v[208:211], a[160:163], v[60:63], v[208:211]
 s_waitcnt lgkmcnt(0)
 v_cvt_pk_bf16_f32 v163, v166, v167
 v_mfma_f32_16x16x32_bf16 v[212:215], a[164:167], v[60:63], v[212:215]
 v_mfma_f32_16x16x32_bf16 v[212:215], a[116:119], v[56:59], v[212:215]
 v_mfma_f32_16x16x32_bf16 v[216:219], a[120:123], v[56:59], v[216:219]
 v_mfma_f32_16x16x32_bf16 v[216:219], a[168:171], v[60:63], v[216:219]
 v_mfma_f32_16x16x32_bf16 v[220:223], a[172:175], v[60:63], v[220:223]
 v_mfma_f32_16x16x32_bf16 v[220:223], a[124:127], v[56:59], v[220:223]
 v_mfma_f32_16x16x32_bf16 a[188:191], v[22:25], v[56:59], a[188:191]
 v_mfma_f32_16x16x32_bf16 a[188:191], v[22:25], v[60:63], a[188:191]
 buffer_store_dwordx4 v[160:163], v12, s[16:19], s74 offen offset:0 sc1
 v_mul_f32 v168, v168, v26
 v_mul_f32 v169, v169, v26
 v_cvt_pk_bf16_f32 v168, v168, v169
 v_mul_f32 v170, v170, v26
 v_mul_f32 v171, v171, v26
 v_cvt_pk_bf16_f32 v169, v170, v171
 v_mul_f32 v172, v172, v26
 v_mul_f32 v173, v173, v26
 v_cvt_pk_bf16_f32 v170, v172, v173
 v_mul_f32 v174, v174, v26
 v_mul_f32 v175, v175, v26
 v_cvt_pk_bf16_f32 v171, v174, v175
 buffer_store_dwordx4 v[168:171], v12, s[16:19], s74 offen offset:1024 sc1
 v_mul_f32 v176, v176, v26
 v_mul_f32 v177, v177, v26
 v_cvt_pk_bf16_f32 v176, v176, v177
 v_mul_f32 v178, v178, v26
 v_mul_f32 v179, v179, v26
 v_cvt_pk_bf16_f32 v177, v178, v179
 v_mul_f32 v180, v180, v26
 v_mul_f32 v181, v181, v26
 v_cvt_pk_bf16_f32 v178, v180, v181
 v_mul_f32 v182, v182, v26
 v_mul_f32 v183, v183, v26
 v_cvt_pk_bf16_f32 v179, v182, v183
 buffer_store_dwordx4 v[176:179], v12, s[16:19], s74 offen offset:2048 sc1
 v_mul_f32 v184, v184, v26
 v_mul_f32 v185, v185, v26
 v_cvt_pk_bf16_f32 v184, v184, v185
 v_mul_f32 v186, v186, v26
 v_mul_f32 v187, v187, v26
 v_cvt_pk_bf16_f32 v185, v186, v187
 v_mul_f32 v188, v188, v26
 v_mul_f32 v189, v189, v26
 v_cvt_pk_bf16_f32 v186, v188, v189
 v_mul_f32 v190, v190, v26
 v_mul_f32 v191, v191, v26
 v_cvt_pk_bf16_f32 v187, v190, v191
 buffer_store_dwordx4 v[184:187], v12, s[16:19], s74 offen offset:3072 sc1
 v_accvgpr_read_b32 v27, a188
 v_rcp_f32 v27, v27
 s_nop 0
 v_mul_f32 v27, 0x1f800000, v27
 v_mul_f32 v192, v192, v27
 v_mul_f32 v193, v193, v27
 v_cvt_pk_bf16_f32 v192, v192, v193
 v_mul_f32 v194, v194, v27
 v_mul_f32 v195, v195, v27
 v_cvt_pk_bf16_f32 v193, v194, v195
 v_mul_f32 v196, v196, v27
 v_mul_f32 v197, v197, v27
 v_cvt_pk_bf16_f32 v194, v196, v197
 v_mul_f32 v198, v198, v27
 v_mul_f32 v199, v199, v27
 v_cvt_pk_bf16_f32 v195, v198, v199
 buffer_store_dwordx4 v[192:195], v12, s[16:19], s75 offen offset:0 sc1
 v_mul_f32 v200, v200, v27
 v_mul_f32 v201, v201, v27
 v_cvt_pk_bf16_f32 v200, v200, v201
 v_mul_f32 v202, v202, v27
 v_mul_f32 v203, v203, v27
 v_cvt_pk_bf16_f32 v201, v202, v203
 v_mul_f32 v204, v204, v27
 v_mul_f32 v205, v205, v27
 v_cvt_pk_bf16_f32 v202, v204, v205
 v_mul_f32 v206, v206, v27
 v_mul_f32 v207, v207, v27
 v_cvt_pk_bf16_f32 v203, v206, v207
 buffer_store_dwordx4 v[200:203], v12, s[16:19], s75 offen offset:1024 sc1
 v_mul_f32 v208, v208, v27
 v_mul_f32 v209, v209, v27
 v_cvt_pk_bf16_f32 v208, v208, v209
 v_mul_f32 v210, v210, v27
 v_mul_f32 v211, v211, v27
 v_cvt_pk_bf16_f32 v209, v210, v211
 v_mul_f32 v212, v212, v27
 v_mul_f32 v213, v213, v27
 v_cvt_pk_bf16_f32 v210, v212, v213
 v_mul_f32 v214, v214, v27
 v_mul_f32 v215, v215, v27
 v_cvt_pk_bf16_f32 v211, v214, v215
 buffer_store_dwordx4 v[208:211], v12, s[16:19], s75 offen offset:2048 sc1
 v_mul_f32 v216, v216, v27
 v_mul_f32 v217, v217, v27
 v_cvt_pk_bf16_f32 v216, v216, v217
 v_mul_f32 v218, v218, v27
 v_mul_f32 v219, v219, v27
 v_cvt_pk_bf16_f32 v217, v218, v219
 v_mul_f32 v220, v220, v27
 v_mul_f32 v221, v221, v27
 v_cvt_pk_bf16_f32 v218, v220, v221
 v_mul_f32 v222, v222, v27
 v_mul_f32 v223, v223, v27
 v_cvt_pk_bf16_f32 v219, v222, v223
 buffer_store_dwordx4 v[216:219], v12, s[16:19], s75 offen offset:3072 sc1
 s_branch L_vj_149
L_w1_146:
 s_cmp_eq_u32 s3, 1
 s_cbranch_scc0 L_w2_147
 s_waitcnt lgkmcnt(0)
 v_mfma_f32_16x16x32_bf16 v[80:83], a[16:19], a[192:195], v[44:47]
 v_exp_f32 v18, v78
 v_mfma_f32_16x16x32_bf16 v[80:83], a[20:23], a[196:199], v[80:83]
 v_cvt_pk_bf16_f32 v54, v16, v17
 v_or3_b32 v20, v20, v53, v54
 v_mfma_f32_16x16x32_bf16 v[80:83], a[24:27], a[200:203], v[80:83]
 v_exp_f32 v19, v79
 v_mfma_f32_16x16x32_bf16 v[80:83], a[28:31], a[204:207], v[80:83]
 v_cvt_pk_bf16_f32 v55, v18, v19
 v_or_b32 v20, v20, v55
 v_mfma_f32_16x16x32_bf16 v[84:87], a[44:47], a[204:207], v[44:47]
 v_and_b32 v20, s64, v20
 v_mfma_f32_16x16x32_bf16 v[84:87], a[40:43], a[200:203], v[84:87]
 v_mfma_f32_16x16x32_bf16 v[84:87], a[36:39], a[196:199], v[84:87]
 v_mfma_f32_16x16x32_bf16 v[84:87], a[32:35], a[192:195], v[84:87]
 v_cmp_ne_u32 vcc, 0, v20
 v_mfma_f32_16x16x32_bf16 v[88:91], a[48:51], a[192:195], v[44:47]
 v_exp_f32 v16, v80
 v_mfma_f32_16x16x32_bf16 v[88:91], a[52:55], a[196:199], v[88:91]
 s_cbranch_vccnz L_so_162
L_sb_163:
 v_exp_f32 v17, v81
 v_mfma_f32_16x16x32_bf16 v[88:91], a[56:59], a[200:203], v[88:91]
 v_exp_f32 v18, v82
 v_mfma_f32_16x16x32_bf16 v[88:91], a[60:63], a[204:207], v[88:91]
 v_cvt_pk_bf16_f32 v56, v16, v17
 v_exp_f32 v19, v83
 v_mfma_f32_16x16x32_bf16 v[92:95], a[92:95], a[204:207], v[44:47]
 v_exp_f32 v16, v84
 v_mfma_f32_16x16x32_bf16 v[92:95], a[88:91], a[200:203], v[92:95]
 v_cvt_pk_bf16_f32 v57, v18, v19
 v_exp_f32 v17, v85
 v_mfma_f32_16x16x32_bf16 v[92:95], a[84:87], a[196:199], v[92:95]
 v_exp_f32 v18, v86
 v_mfma_f32_16x16x32_bf16 v[92:95], a[80:83], a[192:195], v[92:95]
 s_waitcnt vmcnt(0)
 s_barrier
 s_sub_u32 s68, s68, 1
 s_cbranch_scc1 L_fo_166
L_fb_167:
 v_mfma_f32_16x16x32_bf16 v[160:163], a[96:99], v[48:51], v[160:163]
 ds_read_b128 a[96:99], v14 offset:0
 v_cvt_pk_bf16_f32 v58, v16, v17
 v_mfma_f32_16x16x32_bf16 v[160:163], a[144:147], v[52:55], v[160:163]
 ds_read_b128 a[144:147], v14 offset:8192
 v_or3_b32 v21, v56, v57, v58
 v_mfma_f32_16x16x32_bf16 v[164:167], a[148:151], v[52:55], v[164:167]
 s_add_u32 s48, s77, s58
 v_exp_f32 v19, v87
 v_mfma_f32_16x16x32_bf16 v[164:167], a[100:103], v[48:51], v[164:167]
 s_sub_u32 s49, s48, 32768
 s_and_b32 s49, s49, 0x1ffff
 v_exp_f32 v16, v88
 v_mfma_f32_16x16x32_bf16 v[168:171], a[104:107], v[48:51], v[168:171]
 ds_read_b128 a[148:151], v14 offset:9216
 v_add_u32 v9, s48, v4
 v_mfma_f32_16x16x32_bf16 v[168:171], a[152:155], v[52:55], v[168:171]
 ds_read_b128 a[100:103], v14 offset:1024
 v_cvt_pk_bf16_f32 v59, v18, v19
 v_mfma_f32_16x16x32_bf16 v[172:175], a[156:159], v[52:55], v[172:175]
 s_add_u32 s44, s42, 12288
 s_and_b32 s44, s44, 0x7fff
 s_add_u32 s44, s44, s43
 v_mfma_f32_16x16x32_bf16 v[172:175], a[108:111], v[48:51], v[172:175]
 s_add_u32 m0, s48, 0
 v_exp_f32 v17, v89
 v_mfma_f32_16x16x32_bf16 v[176:179], a[112:115], v[48:51], v[176:179]
 buffer_load_dwordx4 v4, s[8:11], s44 offen offset:0 sc1 lds
 v_mfma_f32_16x16x32_bf16 v[176:179], a[160:163], v[52:55], v[176:179]
 ds_read_b128 a[104:107], v14 offset:2048
 v_exp_f32 v18, v90
 v_mfma_f32_16x16x32_bf16 v[180:183], a[164:167], v[52:55], v[180:183]
 buffer_load_dwordx4 v4, s[8:11], s44 offen offset:1024 sc1 lds
 v_mfma_f32_16x16x32_bf16 v[180:183], a[116:119], v[48:51], v[180:183]
 ds_read_b128 a[152:155], v14 offset:10240
 v_cvt_pk_bf16_f32 v60, v16, v17
 v_mfma_f32_16x16x32_bf16 v[184:187], a[120:123], v[48:51], v[184:187]
 ds_read_b128 a[156:159], v14 offset:11264
 v_or3_b32 v21, v21, v59, v60
 v_mfma_f32_16x16x32_bf16 v[184:187], a[168:171], v[52:55], v[184:187]
 ds_read_b128 a[108:111], v14 offset:3072
 v_exp_f32 v19, v91
 v_mfma_f32_16x16x32_bf16 v[188:191], a[172:175], v[52:55], v[188:191]
 ds_read_b128 a[112:115], v14 offset:4096
 v_exp_f32 v16, v92
 v_mfma_f32_16x16x32_bf16 v[188:191], a[124:127], v[48:51], v[188:191]
 ds_read_b128 a[160:163], v14 offset:12288
 v_cvt_pk_bf16_f32 v61, v18, v19
 v_mfma_f32_16x16x32_bf16 a[184:187], v[22:25], v[48:51], a[184:187]
 s_add_u32 m0, s48, 2048
 v_exp_f32 v17, v93
 v_mfma_f32_16x16x32_bf16 a[184:187], v[22:25], v[52:55], a[184:187]
 buffer_load_dwordx4 v5, s[8:11], s44 offen offset:0 sc1 lds
 v_mfma_f32_16x16x32_bf16 v[64:67], a[16:19], a[128:131], v[40:43]
 buffer_load_dwordx4 v5, s[8:11], s44 offen offset:1024 sc1 lds
 v_mfma_f32_16x16x32_bf16 v[64:67], a[20:23], a[132:135], v[64:67]
 ds_read_b128 a[164:167], v14 offset:13312
 v_exp_f32 v18, v94
 v_mfma_f32_16x16x32_bf16 v[64:67], a[24:27], a[136:139], v[64:67]
 ds_read_b128 a[116:119], v14 offset:5120
 v_cvt_pk_bf16_f32 v62, v16, v17
 v_mfma_f32_16x16x32_bf16 v[64:67], a[28:31], a[140:143], v[64:67]
 ds_read_b128 a[120:123], v14 offset:6144
 v_or3_b32 v21, v21, v61, v62
 v_mov_b32 v3, 4048155338
 v_cndmask_b32 v28, v3, v40, s[80:81]
 v_cndmask_b32 v29, v3, v41, s[82:83]
 v_cndmask_b32 v30, v3, v42, s[84:85]
 v_cndmask_b32 v31, v3, v43, s[86:87]
 s_nop 1
 v_mfma_f32_16x16x32_bf16 v[68:71], a[44:47], a[140:143], v[28:31]
 ds_read_b128 a[168:171], v14 offset:14336
 ds_read_b128 a[172:175], v14 offset:15360
 ds_read_b128 a[124:127], v14 offset:7168
 v_mfma_f32_16x16x32_bf16 v[68:71], a[40:43], a[136:139], v[68:71]
 s_add_u32 m0, s48, 4096
 v_exp_f32 v19, v95
 s_nop 0
 v_cvt_pk_bf16_f32 v63, v18, v19
 v_or_b32 v21, v21, v63
 v_and_b32 v21, s64, v21
 v_mfma_f32_16x16x32_bf16 v[68:71], a[36:39], a[132:135], v[68:71]
 ds_read_b128 a[16:19], v14 offset:16384
 v_cmp_ne_u32 vcc, 0, v21
 v_mfma_f32_16x16x32_bf16 v[68:71], a[32:35], a[128:131], v[68:71]
 s_waitcnt lgkmcnt(7)
 s_cbranch_vccnz L_so_164
L_sb_165:
 v_mfma_f32_16x16x32_bf16 v[192:195], a[96:99], v[56:59], v[192:195]
 buffer_load_dwordx4 v6, s[8:11], s44 offen offset:0 sc1 lds
 v_mfma_f32_16x16x32_bf16 v[192:195], a[144:147], v[60:63], v[192:195]
 buffer_load_dwordx4 v6, s[8:11], s44 offen offset:1024 sc1 lds
 v_mfma_f32_16x16x32_bf16 v[196:199], a[148:151], v[60:63], v[196:199]
 ds_read_b128 a[20:23], v14 offset:17408
 v_mov_b32 v72, 4048155338
 v_mfma_f32_16x16x32_bf16 v[196:199], a[100:103], v[56:59], v[196:199]
 ds_read_b128 a[24:27], v14 offset:18432
 v_mov_b32 v73, 4048155338
 v_mfma_f32_16x16x32_bf16 v[200:203], a[104:107], v[56:59], v[200:203]
 s_add_u32 m0, s48, 6144
 ds_read_b128 a[28:31], v14 offset:19456
 v_mfma_f32_16x16x32_bf16 v[200:203], a[152:155], v[60:63], v[200:203]
 buffer_load_dwordx4 v7, s[8:11], s44 offen offset:0 sc1 lds
 v_mfma_f32_16x16x32_bf16 v[204:207], a[156:159], v[60:63], v[204:207]
 s_add_u32 s79, s76, s58
 v_mov_b32 v74, 4048155338
 v_mov_b32 v75, 4048155338
 v_mfma_f32_16x16x32_bf16 v[204:207], a[108:111], v[56:59], v[204:207]
 buffer_load_dwordx4 v7, s[8:11], s44 offen offset:1024 sc1 lds
 v_mfma_f32_16x16x32_bf16 v[208:211], a[112:115], v[56:59], v[208:211]
 v_mov_b32 v76, 4048155338
 v_mov_b32 v77, 4048155338
 v_mfma_f32_16x16x32_bf16 v[208:211], a[160:163], v[60:63], v[208:211]
 s_waitcnt lgkmcnt(3)
 ds_read_b128 a[44:47], v14 offset:23552
 v_mov_b32 v78, 4048155338
 v_mfma_f32_16x16x32_bf16 v[212:215], a[164:167], v[60:63], v[212:215]
 ds_read_b128 a[40:43], v14 offset:22528
 v_mov_b32 v79, 4048155338
 v_mfma_f32_16x16x32_bf16 v[212:215], a[116:119], v[56:59], v[212:215]
 s_add_u32 s76, s76, 32768
 v_exp_f32 v16, v64
 v_mfma_f32_16x16x32_bf16 v[216:219], a[120:123], v[56:59], v[216:219]
 ds_read_b128 a[36:39], v14 offset:21504
 v_add_u32 v10, s49, v4
 v_mfma_f32_16x16x32_bf16 v[216:219], a[168:171], v[60:63], v[216:219]
 s_and_b32 s76, s76, 0x1ffff
 ds_read_b128 a[32:35], v14 offset:20480
 v_mfma_f32_16x16x32_bf16 v[220:223], a[172:175], v[60:63], v[220:223]
 ds_read_b128 a[48:51], v14 offset:24576
 v_exp_f32 v17, v65
 v_mfma_f32_16x16x32_bf16 v[220:223], a[124:127], v[56:59], v[220:223]
 ds_read_b128 a[52:55], v14 offset:25600
 v_exp_f32 v18, v66
 v_mfma_f32_16x16x32_bf16 a[188:191], v[22:25], v[56:59], a[188:191]
 ds_read_b128 a[56:59], v14 offset:26624
 ds_read_b128 a[60:63], v14 offset:27648
 ds_read_b128 a[92:95], v14 offset:31744
 ds_read_b128 a[88:91], v14 offset:30720
 ds_read_b128 a[84:87], v14 offset:29696
 ds_read_b128 a[80:83], v14 offset:28672
 v_mfma_f32_16x16x32_bf16 a[188:191], v[22:25], v[60:63], a[188:191]
 s_mov_b32 s77, s79
 v_add_u32 v14, s76, v12
 v_cvt_pk_bf16_f32 v48, v16, v17
 v_exp_f32 v19, v67
 v_exp_f32 v16, v68
 v_cvt_pk_bf16_f32 v49, v18, v19
 v_mfma_f32_16x16x32_bf16 v[80:83], a[16:19], a[192:195], v[44:47]
 s_waitcnt lgkmcnt(12)
 v_exp_f32 v17, v69
 v_mfma_f32_16x16x32_bf16 v[80:83], a[20:23], a[196:199], v[80:83]
 v_exp_f32 v18, v70
 v_mfma_f32_16x16x32_bf16 v[80:83], a[24:27], a[200:203], v[80:83]
 v_cvt_pk_bf16_f32 v50, v16, v17
 v_or3_b32 v20, v48, v49, v50
 v_mfma_f32_16x16x32_bf16 v[80:83], a[28:31], a[204:207], v[80:83]
 s_waitcnt lgkmcnt(10)
 v_exp_f32 v19, v71
 v_mfma_f32_16x16x32_bf16 v[84:87], a[44:47], a[204:207], v[44:47]
 v_cvt_pk_bf16_f32 v51, v18, v19
 v_or_b32 v20, v20, v51
 v_mfma_f32_16x16x32_bf16 v[84:87], a[40:43], a[200:203], v[84:87]
 s_waitcnt lgkmcnt(8)
 v_and_b32 v20, s64, v20
 v_mfma_f32_16x16x32_bf16 v[84:87], a[36:39], a[196:199], v[84:87]
 v_mfma_f32_16x16x32_bf16 v[84:87], a[32:35], a[192:195], v[84:87]
 s_waitcnt lgkmcnt(6)
 v_cmp_ne_u32 vcc, 0, v20
 v_mov_b32 v3, 4048155338
 v_cndmask_b32 v28, v3, v44, s[80:81]
 v_cndmask_b32 v29, v3, v45, s[82:83]
 v_cndmask_b32 v30, v3, v46, s[84:85]
 v_cndmask_b32 v31, v3, v47, s[86:87]
 s_nop 1
 v_mfma_f32_16x16x32_bf16 v[88:91], a[48:51], a[192:195], v[28:31]
 v_mov_b32 v92, 4048155338
 v_mov_b32 v93, 4048155338
 v_mfma_f32_16x16x32_bf16 v[88:91], a[52:55], a[196:199], v[88:91]
 s_waitcnt lgkmcnt(0)
 v_mov_b32 v94, 4048155338
 v_mov_b32 v95, 4048155338
 v_mfma_f32_16x16x32_bf16 v[88:91], a[56:59], a[200:203], v[88:91]
 s_cbranch_vccnz L_so_168
L_sb_169:
 v_mov_b32 v62, 0
 v_mov_b32 v63, 0
 v_mfma_f32_16x16x32_bf16 v[88:91], a[60:63], a[204:207], v[88:91]
 s_barrier
 s_sub_u32 s68, s68, 1
 s_cbranch_scc1 L_fo_170
L_fb_171:
 v_mfma_f32_16x16x32_bf16 v[160:163], a[96:99], v[48:51], v[160:163]
 ds_read_b128 a[96:99], v14 offset:0
 v_exp_f32 v16, v80
 v_mfma_f32_16x16x32_bf16 v[164:167], a[100:103], v[48:51], v[164:167]
 ds_read_b128 a[144:147], v14 offset:8192
 v_exp_f32 v17, v81
 v_mfma_f32_16x16x32_bf16 v[168:171], a[104:107], v[48:51], v[168:171]
 ds_read_b128 a[148:151], v14 offset:9216
 v_exp_f32 v18, v82
 v_mfma_f32_16x16x32_bf16 v[172:175], a[108:111], v[48:51], v[172:175]
 ds_read_b128 a[100:103], v14 offset:1024
 v_cvt_pk_bf16_f32 v56, v16, v17
 v_mfma_f32_16x16x32_bf16 v[176:179], a[112:115], v[48:51], v[176:179]
 ds_read_b128 a[104:107], v14 offset:2048
 v_exp_f32 v19, v83
 v_mfma_f32_16x16x32_bf16 v[180:183], a[116:119], v[48:51], v[180:183]
 ds_read_b128 a[152:155], v14 offset:10240
 v_exp_f32 v16, v84
 v_mfma_f32_16x16x32_bf16 v[184:187], a[120:123], v[48:51], v[184:187]
 ds_read_b128 a[156:159], v14 offset:11264
 v_cvt_pk_bf16_f32 v57, v18, v19
 v_mfma_f32_16x16x32_bf16 v[188:191], a[124:127], v[48:51], v[188:191]
 ds_read_b128 a[108:111], v14 offset:3072
 v_exp_f32 v17, v85
 v_mfma_f32_16x16x32_bf16 a[184:187], v[22:25], v[48:51], a[184:187]
 ds_read_b128 a[112:115], v14 offset:4096
 ds_read_b128 a[160:163], v14 offset:12288
 ds_read_b128 a[164:167], v14 offset:13312
 ds_read_b128 a[116:119], v14 offset:5120
 ds_read_b128 a[120:123], v14 offset:6144
 v_exp_f32 v18, v86
 v_cvt_pk_bf16_f32 v58, v16, v17
 v_or3_b32 v21, v56, v57, v58
 v_exp_f32 v19, v87
 v_exp_f32 v16, v88
 v_cvt_pk_bf16_f32 v59, v18, v19
 v_exp_f32 v17, v89
 v_exp_f32 v18, v90
 v_cvt_pk_bf16_f32 v60, v16, v17
 v_or3_b32 v21, v21, v59, v60
 v_exp_f32 v19, v91
 s_nop 0
 v_cvt_pk_bf16_f32 v61, v18, v19
 v_or_b32 v21, v21, v61
 v_and_b32 v21, s64, v21
 ds_read_b128 a[168:171], v14 offset:14336
 ds_read_b128 a[172:175], v14 offset:15360
 ds_read_b128 a[124:127], v14 offset:7168
 v_cmp_ne_u32 vcc, 0, v21
 v_accvgpr_read_b32 v26, a184
 v_rcp_f32 v26, v26
 s_nop 0
 v_mul_f32 v26, 0x1f800000, v26
 s_nop 0
 s_cbranch_vccnz L_so_172
L_sb_173:
 s_waitcnt lgkmcnt(15)
 v_mfma_f32_16x16x32_bf16 v[192:195], a[96:99], v[56:59], v[192:195]
 s_waitcnt lgkmcnt(14)
 v_mul_f32 v160, v160, v26
 v_mul_f32 v161, v161, v26
 v_mfma_f32_16x16x32_bf16 v[192:195], a[144:147], v[60:63], v[192:195]
 s_waitcnt lgkmcnt(13)
 v_cvt_pk_bf16_f32 v160, v160, v161
 v_mfma_f32_16x16x32_bf16 v[196:199], a[148:151], v[60:63], v[196:199]
 s_waitcnt lgkmcnt(12)
 v_mul_f32 v162, v162, v26
 v_mul_f32 v163, v163, v26
 v_mfma_f32_16x16x32_bf16 v[196:199], a[100:103], v[56:59], v[196:199]
 s_waitcnt lgkmcnt(11)
 v_cvt_pk_bf16_f32 v161, v162, v163
 v_mfma_f32_16x16x32_bf16 v[200:203], a[104:107], v[56:59], v[200:203]
 s_waitcnt lgkmcnt(10)
 v_mul_f32 v164, v164, v26
 v_mul_f32 v165, v165, v26
 v_mfma_f32_16x16x32_bf16 v[200:203], a[152:155], v[60:63], v[200:203]
 s_waitcnt lgkmcnt(9)
 v_cvt_pk_bf16_f32 v162, v164, v165
 v_mfma_f32_16x16x32_bf16 v[204:207], a[156:159], v[60:63], v[204:207]
 s_waitcnt lgkmcnt(8)
 v_mul_f32 v166, v166, v26
 v_mul_f32 v167, v167, v26
 v_mfma_f32_16x16x32_bf16 v[204:207], a[108:111], v[56:59], v[204:207]
 s_waitcnt lgkmcnt(7)
 v_mfma_f32_16x16x32_bf16 v[208:211], a[112:115], v[56:59], v[208:211]
 s_waitcnt lgkmcnt(6)
 v_mfma_f32_16x16x32_bf16 v[208:211], a[160:163], v[60:63], v[208:211]
 s_waitcnt lgkmcnt(0)
 v_cvt_pk_bf16_f32 v163, v166, v167
 v_mfma_f32_16x16x32_bf16 v[212:215], a[164:167], v[60:63], v[212:215]
 v_mfma_f32_16x16x32_bf16 v[212:215], a[116:119], v[56:59], v[212:215]
 v_mfma_f32_16x16x32_bf16 v[216:219], a[120:123], v[56:59], v[216:219]
 v_mfma_f32_16x16x32_bf16 v[216:219], a[168:171], v[60:63], v[216:219]
 v_mfma_f32_16x16x32_bf16 v[220:223], a[172:175], v[60:63], v[220:223]
 v_mfma_f32_16x16x32_bf16 v[220:223], a[124:127], v[56:59], v[220:223]
 v_mfma_f32_16x16x32_bf16 a[188:191], v[22:25], v[56:59], a[188:191]
 v_mfma_f32_16x16x32_bf16 a[188:191], v[22:25], v[60:63], a[188:191]
 buffer_store_dwordx4 v[160:163], v12, s[16:19], s74 offen offset:0 sc1
 v_mul_f32 v168, v168, v26
 v_mul_f32 v169, v169, v26
 v_cvt_pk_bf16_f32 v168, v168, v169
 v_mul_f32 v170, v170, v26
 v_mul_f32 v171, v171, v26
 v_cvt_pk_bf16_f32 v169, v170, v171
 v_mul_f32 v172, v172, v26
 v_mul_f32 v173, v173, v26
 v_cvt_pk_bf16_f32 v170, v172, v173
 v_mul_f32 v174, v174, v26
 v_mul_f32 v175, v175, v26
 v_cvt_pk_bf16_f32 v171, v174, v175
 buffer_store_dwordx4 v[168:171], v12, s[16:19], s74 offen offset:1024 sc1
 v_mul_f32 v176, v176, v26
 v_mul_f32 v177, v177, v26
 v_cvt_pk_bf16_f32 v176, v176, v177
 v_mul_f32 v178, v178, v26
 v_mul_f32 v179, v179, v26
 v_cvt_pk_bf16_f32 v177, v178, v179
 v_mul_f32 v180, v180, v26
 v_mul_f32 v181, v181, v26
 v_cvt_pk_bf16_f32 v178, v180, v181
 v_mul_f32 v182, v182, v26
 v_mul_f32 v183, v183, v26
 v_cvt_pk_bf16_f32 v179, v182, v183
 buffer_store_dwordx4 v[176:179], v12, s[16:19], s74 offen offset:2048 sc1
 v_mul_f32 v184, v184, v26
 v_mul_f32 v185, v185, v26
 v_cvt_pk_bf16_f32 v184, v184, v185
 v_mul_f32 v186, v186, v26
 v_mul_f32 v187, v187, v26
 v_cvt_pk_bf16_f32 v185, v186, v187
 v_mul_f32 v188, v188, v26
 v_mul_f32 v189, v189, v26
 v_cvt_pk_bf16_f32 v186, v188, v189
 v_mul_f32 v190, v190, v26
 v_mul_f32 v191, v191, v26
 v_cvt_pk_bf16_f32 v187, v190, v191
 buffer_store_dwordx4 v[184:187], v12, s[16:19], s74 offen offset:3072 sc1
 v_accvgpr_read_b32 v27, a188
 v_rcp_f32 v27, v27
 s_nop 0
 v_mul_f32 v27, 0x1f800000, v27
 v_mul_f32 v192, v192, v27
 v_mul_f32 v193, v193, v27
 v_cvt_pk_bf16_f32 v192, v192, v193
 v_mul_f32 v194, v194, v27
 v_mul_f32 v195, v195, v27
 v_cvt_pk_bf16_f32 v193, v194, v195
 v_mul_f32 v196, v196, v27
 v_mul_f32 v197, v197, v27
 v_cvt_pk_bf16_f32 v194, v196, v197
 v_mul_f32 v198, v198, v27
 v_mul_f32 v199, v199, v27
 v_cvt_pk_bf16_f32 v195, v198, v199
 buffer_store_dwordx4 v[192:195], v12, s[16:19], s75 offen offset:0 sc1
 v_mul_f32 v200, v200, v27
 v_mul_f32 v201, v201, v27
 v_cvt_pk_bf16_f32 v200, v200, v201
 v_mul_f32 v202, v202, v27
 v_mul_f32 v203, v203, v27
 v_cvt_pk_bf16_f32 v201, v202, v203
 v_mul_f32 v204, v204, v27
 v_mul_f32 v205, v205, v27
 v_cvt_pk_bf16_f32 v202, v204, v205
 v_mul_f32 v206, v206, v27
 v_mul_f32 v207, v207, v27
 v_cvt_pk_bf16_f32 v203, v206, v207
 buffer_store_dwordx4 v[200:203], v12, s[16:19], s75 offen offset:1024 sc1
 v_mul_f32 v208, v208, v27
 v_mul_f32 v209, v209, v27
 v_cvt_pk_bf16_f32 v208, v208, v209
 v_mul_f32 v210, v210, v27
 v_mul_f32 v211, v211, v27
 v_cvt_pk_bf16_f32 v209, v210, v211
 v_mul_f32 v212, v212, v27
 v_mul_f32 v213, v213, v27
 v_cvt_pk_bf16_f32 v210, v212, v213
 v_mul_f32 v214, v214, v27
 v_mul_f32 v215, v215, v27
 v_cvt_pk_bf16_f32 v211, v214, v215
 buffer_store_dwordx4 v[208:211], v12, s[16:19], s75 offen offset:2048 sc1
 v_mul_f32 v216, v216, v27
 v_mul_f32 v217, v217, v27
 v_cvt_pk_bf16_f32 v216, v216, v217
 v_mul_f32 v218, v218, v27
 v_mul_f32 v219, v219, v27
 v_cvt_pk_bf16_f32 v217, v218, v219
 v_mul_f32 v220, v220, v27
 v_mul_f32 v221, v221, v27
 v_cvt_pk_bf16_f32 v218, v220, v221
 v_mul_f32 v222, v222, v27
 v_mul_f32 v223, v223, v27
 v_cvt_pk_bf16_f32 v219, v222, v223
 buffer_store_dwordx4 v[216:219], v12, s[16:19], s75 offen offset:3072 sc1
 s_branch L_vj_149
L_w2_147:
 s_cmp_eq_u32 s3, 2
 s_cbranch_scc0 L_w3_148
 s_waitcnt lgkmcnt(0)
 v_mfma_f32_16x16x32_bf16 v[80:83], a[16:19], a[192:195], v[44:47]
 v_exp_f32 v18, v78
 v_mfma_f32_16x16x32_bf16 v[80:83], a[20:23], a[196:199], v[80:83]
 v_cvt_pk_bf16_f32 v54, v16, v17
 v_or3_b32 v20, v20, v53, v54
 v_mfma_f32_16x16x32_bf16 v[80:83], a[24:27], a[200:203], v[80:83]
 v_exp_f32 v19, v79
 v_mfma_f32_16x16x32_bf16 v[80:83], a[28:31], a[204:207], v[80:83]
 v_cvt_pk_bf16_f32 v55, v18, v19
 v_or_b32 v20, v20, v55
 v_mfma_f32_16x16x32_bf16 v[84:87], a[44:47], a[204:207], v[44:47]
 v_and_b32 v20, s64, v20
 v_mfma_f32_16x16x32_bf16 v[84:87], a[40:43], a[200:203], v[84:87]
 v_mfma_f32_16x16x32_bf16 v[84:87], a[36:39], a[196:199], v[84:87]
 v_mfma_f32_16x16x32_bf16 v[84:87], a[32:35], a[192:195], v[84:87]
 v_cmp_ne_u32 vcc, 0, v20
 v_mfma_f32_16x16x32_bf16 v[88:91], a[48:51], a[192:195], v[44:47]
 v_exp_f32 v16, v80
 v_mfma_f32_16x16x32_bf16 v[88:91], a[52:55], a[196:199], v[88:91]
 v_exp_f32 v17, v81
 v_mfma_f32_16x16x32_bf16 v[88:91], a[56:59], a[200:203], v[88:91]
 v_exp_f32 v18, v82
 v_mfma_f32_16x16x32_bf16 v[88:91], a[60:63], a[204:207], v[88:91]
 s_cbranch_vccnz L_so_174
L_sb_175:
 v_cvt_pk_bf16_f32 v56, v16, v17
 v_mfma_f32_16x16x32_bf16 v[92:95], a[92:95], a[204:207], v[44:47]
 v_exp_f32 v19, v83
 v_mfma_f32_16x16x32_bf16 v[92:95], a[88:91], a[200:203], v[92:95]
 v_exp_f32 v16, v84
 v_mfma_f32_16x16x32_bf16 v[92:95], a[84:87], a[196:199], v[92:95]
 v_cvt_pk_bf16_f32 v57, v18, v19
 v_exp_f32 v17, v85
 v_mfma_f32_16x16x32_bf16 v[92:95], a[80:83], a[192:195], v[92:95]
 s_waitcnt vmcnt(0)
 s_barrier
 s_sub_u32 s68, s68, 1
 s_cbranch_scc1 L_fo_178
L_fb_179:
 v_mfma_f32_16x16x32_bf16 v[160:163], a[96:99], v[48:51], v[160:163]
 s_add_u32 s48, s77, s58
 v_exp_f32 v18, v86
 v_mfma_f32_16x16x32_bf16 v[160:163], a[144:147], v[52:55], v[160:163]
 ds_read_b128 a[96:99], v14 offset:0
 v_cvt_pk_bf16_f32 v58, v16, v17
 v_mfma_f32_16x16x32_bf16 v[164:167], a[148:151], v[52:55], v[164:167]
 ds_read_b128 a[144:147], v14 offset:8192
 v_or3_b32 v21, v56, v57, v58
 v_mfma_f32_16x16x32_bf16 v[164:167], a[100:103], v[48:51], v[164:167]
 s_sub_u32 s49, s48, 32768
 s_and_b32 s49, s49, 0x1ffff
 v_exp_f32 v19, v87
 v_mfma_f32_16x16x32_bf16 v[168:171], a[104:107], v[48:51], v[168:171]
 ds_read_b128 a[148:151], v14 offset:9216
 v_exp_f32 v16, v88
 v_mfma_f32_16x16x32_bf16 v[168:171], a[152:155], v[52:55], v[168:171]
 ds_read_b128 a[100:103], v14 offset:1024
 v_cvt_pk_bf16_f32 v59, v18, v19
 v_mfma_f32_16x16x32_bf16 v[172:175], a[156:159], v[52:55], v[172:175]
 ds_read_b128 a[104:107], v14 offset:2048
 v_add_u32 v9, s48, v4
 v_mfma_f32_16x16x32_bf16 v[172:175], a[108:111], v[48:51], v[172:175]
 s_add_u32 s44, s42, 12288
 s_and_b32 s44, s44, 0x7fff
 s_add_u32 s44, s44, s43
 v_mfma_f32_16x16x32_bf16 v[176:179], a[112:115], v[48:51], v[176:179]
 s_add_u32 m0, s48, 0
 v_exp_f32 v17, v89
 v_mfma_f32_16x16x32_bf16 v[176:179], a[160:163], v[52:55], v[176:179]
 buffer_load_dwordx4 v4, s[8:11], s44 offen offset:0 sc1 lds
 v_mfma_f32_16x16x32_bf16 v[180:183], a[164:167], v[52:55], v[180:183]
 ds_read_b128 a[152:155], v14 offset:10240
 v_exp_f32 v18, v90
 v_mfma_f32_16x16x32_bf16 v[180:183], a[116:119], v[48:51], v[180:183]
 buffer_load_dwordx4 v4, s[8:11], s44 offen offset:1024 sc1 lds
 v_mfma_f32_16x16x32_bf16 v[184:187], a[120:123], v[48:51], v[184:187]
 ds_read_b128 a[156:159], v14 offset:11264
 v_cvt_pk_bf16_f32 v60, v16, v17
 v_mfma_f32_16x16x32_bf16 v[184:187], a[168:171], v[52:55], v[184:187]
 ds_read_b128 a[108:111], v14 offset:3072
 v_or3_b32 v21, v21, v59, v60
 v_mfma_f32_16x16x32_bf16 v[188:191], a[172:175], v[52:55], v[188:191]
 ds_read_b128 a[112:115], v14 offset:4096
 v_exp_f32 v19, v91
 v_mfma_f32_16x16x32_bf16 v[188:191], a[124:127], v[48:51], v[188:191]
 ds_read_b128 a[160:163], v14 offset:12288
 v_exp_f32 v16, v92
 v_mfma_f32_16x16x32_bf16 a[184:187], v[22:25], v[48:51], a[184:187]
 ds_read_b128 a[164:167], v14 offset:13312
 v_cvt_pk_bf16_f32 v61, v18, v19
 v_mfma_f32_16x16x32_bf16 a[184:187], v[22:25], v[52:55], a[184:187]
 s_add_u32 m0, s48, 2048
 v_exp_f32 v17, v93
 v_mfma_f32_16x16x32_bf16 v[64:67], a[16:19], a[128:131], v[40:43]
 buffer_load_dwordx4 v5, s[8:11], s44 offen offset:0 sc1 lds
 v_mfma_f32_16x16x32_bf16 v[64:67], a[20:23], a[132:135], v[64:67]
 ds_read_b128 a[16:19], v14 offset:16384
 v_exp_f32 v18, v94
 v_mfma_f32_16x16x32_bf16 v[64:67], a[24:27], a[136:139], v[64:67]
 buffer_load_dwordx4 v5, s[8:11], s44 offen offset:1024 sc1 lds
 v_mfma_f32_16x16x32_bf16 v[64:67], a[28:31], a[140:143], v[64:67]
 ds_read_b128 a[116:119], v14 offset:5120
 v_cvt_pk_bf16_f32 v62, v16, v17
 v_mfma_f32_16x16x32_bf16 v[68:71], a[44:47], a[140:143], v[40:43]
 ds_read_b128 a[120:123], v14 offset:6144
 v_or3_b32 v21, v21, v61, v62
 v_mfma_f32_16x16x32_bf16 v[68:71], a[40:43], a[136:139], v[68:71]
 ds_read_b128 a[168:171], v14 offset:14336
 v_exp_f32 v19, v95
 v_mfma_f32_16x16x32_bf16 v[68:71], a[36:39], a[132:135], v[68:71]
 ds_read_b128 a[172:175], v14 offset:15360
 v_cvt_pk_bf16_f32 v63, v18, v19
 v_mfma_f32_16x16x32_bf16 v[68:71], a[32:35], a[128:131], v[68:71]
 s_add_u32 m0, s48, 4096
 v_or_b32 v21, v21, v63
 v_and_b32 v21, s64, v21
 v_mov_b32 v3, 4048155338
 v_cndmask_b32 v28, v3, v40, s[80:81]
 v_cndmask_b32 v29, v3, v41, s[82:83]
 v_cndmask_b32 v30, v3, v42, s[84:85]
 v_cndmask_b32 v31, v3, v43, s[86:87]
 s_nop 1
 v_mfma_f32_16x16x32_bf16 v[72:75], a[48:51], a[128:131], v[28:31]
 ds_read_b128 a[124:127], v14 offset:7168
 v_cmp_ne_u32 vcc, 0, v21
 v_mfma_f32_16x16x32_bf16 v[72:75], a[52:55], a[132:135], v[72:75]
 buffer_load_dwordx4 v6, s[8:11], s44 offen offset:0 sc1 lds
 v_mfma_f32_16x16x32_bf16 v[72:75], a[56:59], a[136:139], v[72:75]
 ds_read_b128 a[20:23], v14 offset:17408
 v_mov_b32 v76, 4048155338
 v_mfma_f32_16x16x32_bf16 v[72:75], a[60:63], a[140:143], v[72:75]
 s_waitcnt lgkmcnt(6)
 s_cbranch_vccnz L_so_176
L_sb_177:
 v_mov_b32 v77, 4048155338
 v_mfma_f32_16x16x32_bf16 v[192:195], a[96:99], v[56:59], v[192:195]
 ds_read_b128 a[24:27], v14 offset:18432
 v_mov_b32 v78, 4048155338
 v_mfma_f32_16x16x32_bf16 v[192:195], a[144:147], v[60:63], v[192:195]
 ds_read_b128 a[28:31], v14 offset:19456
 v_mov_b32 v79, 4048155338
 v_mfma_f32_16x16x32_bf16 v[196:199], a[148:151], v[60:63], v[196:199]
 buffer_load_dwordx4 v6, s[8:11], s44 offen offset:1024 sc1 lds
 v_mfma_f32_16x16x32_bf16 v[196:199], a[100:103], v[56:59], v[196:199]
 s_add_u32 m0, s48, 6144
 v_mov_b32 v54, 0
 v_mov_b32 v55, 0
 v_mfma_f32_16x16x32_bf16 v[200:203], a[104:107], v[56:59], v[200:203]
 buffer_load_dwordx4 v7, s[8:11], s44 offen offset:0 sc1 lds
 v_mfma_f32_16x16x32_bf16 v[200:203], a[152:155], v[60:63], v[200:203]
 ds_read_b128 a[44:47], v14 offset:23552
 v_exp_f32 v16, v64
 v_mfma_f32_16x16x32_bf16 v[204:207], a[156:159], v[60:63], v[204:207]
 s_add_u32 s79, s76, s58
 v_exp_f32 v17, v65
 v_mfma_f32_16x16x32_bf16 v[204:207], a[108:111], v[56:59], v[204:207]
 buffer_load_dwordx4 v7, s[8:11], s44 offen offset:1024 sc1 lds
 v_mfma_f32_16x16x32_bf16 v[208:211], a[112:115], v[56:59], v[208:211]
 s_add_u32 s76, s76, 32768
 v_exp_f32 v18, v66
 v_mfma_f32_16x16x32_bf16 v[208:211], a[160:163], v[60:63], v[208:211]
 ds_read_b128 a[40:43], v14 offset:22528
 v_cvt_pk_bf16_f32 v48, v16, v17
 v_mfma_f32_16x16x32_bf16 v[212:215], a[164:167], v[60:63], v[212:215]
 s_waitcnt lgkmcnt(3)
 v_exp_f32 v19, v67
 v_mfma_f32_16x16x32_bf16 v[212:215], a[116:119], v[56:59], v[212:215]
 s_and_b32 s76, s76, 0x1ffff
 v_exp_f32 v16, v68
 v_mfma_f32_16x16x32_bf16 v[216:219], a[120:123], v[56:59], v[216:219]
 ds_read_b128 a[36:39], v14 offset:21504
 v_add_u32 v10, s49, v4
 v_mfma_f32_16x16x32_bf16 v[216:219], a[168:171], v[60:63], v[216:219]
 ds_read_b128 a[32:35], v14 offset:20480
 v_cvt_pk_bf16_f32 v49, v18, v19
 v_mfma_f32_16x16x32_bf16 v[220:223], a[172:175], v[60:63], v[220:223]
 ds_read_b128 a[48:51], v14 offset:24576
 v_exp_f32 v17, v69
 v_mfma_f32_16x16x32_bf16 v[220:223], a[124:127], v[56:59], v[220:223]
 ds_read_b128 a[52:55], v14 offset:25600
 v_exp_f32 v18, v70
 v_mfma_f32_16x16x32_bf16 a[188:191], v[22:25], v[56:59], a[188:191]
 ds_read_b128 a[56:59], v14 offset:26624
 ds_read_b128 a[60:63], v14 offset:27648
 ds_read_b128 a[92:95], v14 offset:31744
 ds_read_b128 a[88:91], v14 offset:30720
 ds_read_b128 a[84:87], v14 offset:29696
 ds_read_b128 a[80:83], v14 offset:28672
 v_mfma_f32_16x16x32_bf16 a[188:191], v[22:25], v[60:63], a[188:191]
 s_mov_b32 s77, s79
 v_add_u32 v14, s76, v12
 v_cvt_pk_bf16_f32 v50, v16, v17
 v_or3_b32 v20, v48, v49, v50
 v_exp_f32 v19, v71
 v_exp_f32 v16, v72
 v_cvt_pk_bf16_f32 v51, v18, v19
 v_mfma_f32_16x16x32_bf16 v[80:83], a[16:19], a[192:195], v[44:47]
 v_exp_f32 v17, v73
 v_mfma_f32_16x16x32_bf16 v[80:83], a[20:23], a[196:199], v[80:83]
 v_exp_f32 v18, v74
 v_mfma_f32_16x16x32_bf16 v[80:83], a[24:27], a[200:203], v[80:83]
 s_waitcnt lgkmcnt(10)
 v_cvt_pk_bf16_f32 v52, v16, v17
 v_or3_b32 v20, v20, v51, v52
 v_mfma_f32_16x16x32_bf16 v[80:83], a[28:31], a[204:207], v[80:83]
 v_exp_f32 v19, v75
 v_mov_b32 v3, 4048155338
 v_cndmask_b32 v28, v3, v44, s[80:81]
 v_cndmask_b32 v29, v3, v45, s[82:83]
 v_cndmask_b32 v30, v3, v46, s[84:85]
 v_cndmask_b32 v31, v3, v47, s[86:87]
 s_nop 1
 v_mfma_f32_16x16x32_bf16 v[84:87], a[44:47], a[204:207], v[28:31]
 v_cvt_pk_bf16_f32 v53, v18, v19
 v_or_b32 v20, v20, v53
 v_mfma_f32_16x16x32_bf16 v[84:87], a[40:43], a[200:203], v[84:87]
 s_waitcnt lgkmcnt(8)
 v_and_b32 v20, s64, v20
 v_cmp_ne_u32 vcc, 0, v20
 v_mfma_f32_16x16x32_bf16 v[84:87], a[36:39], a[196:199], v[84:87]
 v_mfma_f32_16x16x32_bf16 v[84:87], a[32:35], a[192:195], v[84:87]
 s_cbranch_vccnz L_so_180
L_sb_181:
 s_waitcnt lgkmcnt(0)
 s_barrier
 s_sub_u32 s68, s68, 1
 s_cbranch_scc1 L_fo_182
L_fb_183:
 v_mfma_f32_16x16x32_bf16 v[160:163], a[96:99], v[48:51], v[160:163]
 ds_read_b128 a[96:99], v14 offset:0
 v_mov_b32 v88, 4048155338
 v_mov_b32 v89, 4048155338
 v_mfma_f32_16x16x32_bf16 v[160:163], a[144:147], v[52:55], v[160:163]
 ds_read_b128 a[144:147], v14 offset:8192
 v_mov_b32 v90, 4048155338
 v_mfma_f32_16x16x32_bf16 v[164:167], a[148:151], v[52:55], v[164:167]
 ds_read_b128 a[148:151], v14 offset:9216
 v_mov_b32 v91, 4048155338
 v_mfma_f32_16x16x32_bf16 v[164:167], a[100:103], v[48:51], v[164:167]
 ds_read_b128 a[100:103], v14 offset:1024
 v_mov_b32 v92, 4048155338
 v_mfma_f32_16x16x32_bf16 v[168:171], a[104:107], v[48:51], v[168:171]
 ds_read_b128 a[104:107], v14 offset:2048
 v_mov_b32 v93, 4048155338
 v_mfma_f32_16x16x32_bf16 v[168:171], a[152:155], v[52:55], v[168:171]
 ds_read_b128 a[152:155], v14 offset:10240
 v_mov_b32 v94, 4048155338
 v_mfma_f32_16x16x32_bf16 v[172:175], a[156:159], v[52:55], v[172:175]
 ds_read_b128 a[156:159], v14 offset:11264
 v_mov_b32 v95, 4048155338
 v_mfma_f32_16x16x32_bf16 v[172:175], a[108:111], v[48:51], v[172:175]
 ds_read_b128 a[108:111], v14 offset:3072
 v_exp_f32 v16, v80
 v_mfma_f32_16x16x32_bf16 v[176:179], a[112:115], v[48:51], v[176:179]
 ds_read_b128 a[112:115], v14 offset:4096
 v_exp_f32 v17, v81
 v_mfma_f32_16x16x32_bf16 v[176:179], a[160:163], v[52:55], v[176:179]
 ds_read_b128 a[160:163], v14 offset:12288
 v_exp_f32 v18, v82
 v_mfma_f32_16x16x32_bf16 v[180:183], a[164:167], v[52:55], v[180:183]
 ds_read_b128 a[164:167], v14 offset:13312
 v_cvt_pk_bf16_f32 v56, v16, v17
 v_mfma_f32_16x16x32_bf16 v[180:183], a[116:119], v[48:51], v[180:183]
 ds_read_b128 a[116:119], v14 offset:5120
 v_exp_f32 v19, v83
 v_mfma_f32_16x16x32_bf16 v[184:187], a[120:123], v[48:51], v[184:187]
 ds_read_b128 a[120:123], v14 offset:6144
 v_exp_f32 v16, v84
 v_mfma_f32_16x16x32_bf16 v[184:187], a[168:171], v[52:55], v[184:187]
 ds_read_b128 a[168:171], v14 offset:14336
 v_cvt_pk_bf16_f32 v57, v18, v19
 v_mfma_f32_16x16x32_bf16 v[188:191], a[172:175], v[52:55], v[188:191]
 ds_read_b128 a[172:175], v14 offset:15360
 v_exp_f32 v17, v85
 v_mfma_f32_16x16x32_bf16 v[188:191], a[124:127], v[48:51], v[188:191]
 v_exp_f32 v18, v86
 v_mfma_f32_16x16x32_bf16 a[184:187], v[22:25], v[48:51], a[184:187]
 ds_read_b128 a[124:127], v14 offset:7168
 v_cvt_pk_bf16_f32 v58, v16, v17
 v_mfma_f32_16x16x32_bf16 a[184:187], v[22:25], v[52:55], a[184:187]
 v_or3_b32 v21, v56, v57, v58
 v_exp_f32 v19, v87
 s_nop 0
 v_cvt_pk_bf16_f32 v59, v18, v19
 v_or_b32 v21, v21, v59
 v_and_b32 v21, s64, v21
 v_cmp_ne_u32 vcc, 0, v21
 s_nop 0
 v_accvgpr_read_b32 v26, a184
 v_rcp_f32 v26, v26
 s_nop 0
 v_mul_f32 v26, 0x1f800000, v26
 s_nop 0
 s_cbranch_vccnz L_so_184
L_sb_185:
 s_waitcnt lgkmcnt(8)
 v_mfma_f32_16x16x32_bf16 v[192:195], a[96:99], v[56:59], v[192:195]
 v_mul_f32 v160, v160, v26
 v_mul_f32 v161, v161, v26
 v_mfma_f32_16x16x32_bf16 v[196:199], a[100:103], v[56:59], v[196:199]
 v_cvt_pk_bf16_f32 v160, v160, v161
 v_mfma_f32_16x16x32_bf16 v[200:203], a[104:107], v[56:59], v[200:203]
 v_mul_f32 v162, v162, v26
 v_mul_f32 v163, v163, v26
 v_mfma_f32_16x16x32_bf16 v[204:207], a[108:111], v[56:59], v[204:207]
 s_waitcnt lgkmcnt(4)
 v_cvt_pk_bf16_f32 v161, v162, v163
 v_mfma_f32_16x16x32_bf16 v[208:211], a[112:115], v[56:59], v[208:211]
 v_mul_f32 v164, v164, v26
 v_mul_f32 v165, v165, v26
 v_mfma_f32_16x16x32_bf16 v[212:215], a[116:119], v[56:59], v[212:215]
 s_waitcnt lgkmcnt(2)
 v_cvt_pk_bf16_f32 v162, v164, v165
 v_mfma_f32_16x16x32_bf16 v[216:219], a[120:123], v[56:59], v[216:219]
 s_waitcnt lgkmcnt(0)
 v_mul_f32 v166, v166, v26
 v_mul_f32 v167, v167, v26
 v_mfma_f32_16x16x32_bf16 v[220:223], a[124:127], v[56:59], v[220:223]
 v_cvt_pk_bf16_f32 v163, v166, v167
 v_mfma_f32_16x16x32_bf16 a[188:191], v[22:25], v[56:59], a[188:191]
 buffer_store_dwordx4 v[160:163], v12, s[16:19], s74 offen offset:0 sc1
 v_mul_f32 v168, v168, v26
 v_mul_f32 v169, v169, v26
 v_cvt_pk_bf16_f32 v168, v168, v169
 v_mul_f32 v170, v170, v26
 v_mul_f32 v171, v171, v26
 v_cvt_pk_bf16_f32 v169, v170, v171
 v_mul_f32 v172, v172, v26
 v_mul_f32 v173, v173, v26
 v_cvt_pk_bf16_f32 v170, v172, v173
 v_mul_f32 v174, v174, v26
 v_mul_f32 v175, v175, v26
 v_cvt_pk_bf16_f32 v171, v174, v175
 buffer_store_dwordx4 v[168:171], v12, s[16:19], s74 offen offset:1024 sc1
 v_mul_f32 v176, v176, v26
 v_mul_f32 v177, v177, v26
 v_cvt_pk_bf16_f32 v176, v176, v177
 v_mul_f32 v178, v178, v26
 v_mul_f32 v179, v179, v26
 v_cvt_pk_bf16_f32 v177, v178, v179
 v_mul_f32 v180, v180, v26
 v_mul_f32 v181, v181, v26
 v_cvt_pk_bf16_f32 v178, v180, v181
 v_mul_f32 v182, v182, v26
 v_mul_f32 v183, v183, v26
 v_cvt_pk_bf16_f32 v179, v182, v183
 buffer_store_dwordx4 v[176:179], v12, s[16:19], s74 offen offset:2048 sc1
 v_mul_f32 v184, v184, v26
 v_mul_f32 v185, v185, v26
 v_cvt_pk_bf16_f32 v184, v184, v185
 v_mul_f32 v186, v186, v26
 v_mul_f32 v187, v187, v26
 v_cvt_pk_bf16_f32 v185, v186, v187
 v_mul_f32 v188, v188, v26
 v_mul_f32 v189, v189, v26
 v_cvt_pk_bf16_f32 v186, v188, v189
 v_mul_f32 v190, v190, v26
 v_mul_f32 v191, v191, v26
 v_cvt_pk_bf16_f32 v187, v190, v191
 buffer_store_dwordx4 v[184:187], v12, s[16:19], s74 offen offset:3072 sc1
 v_accvgpr_read_b32 v27, a188
 v_rcp_f32 v27, v27
 s_nop 0
 v_mul_f32 v27, 0x1f800000, v27
 v_mul_f32 v192, v192, v27
 v_mul_f32 v193, v193, v27
 v_cvt_pk_bf16_f32 v192, v192, v193
 v_mul_f32 v194, v194, v27
 v_mul_f32 v195, v195, v27
 v_cvt_pk_bf16_f32 v193, v194, v195
 v_mul_f32 v196, v196, v27
 v_mul_f32 v197, v197, v27
 v_cvt_pk_bf16_f32 v194, v196, v197
 v_mul_f32 v198, v198, v27
 v_mul_f32 v199, v199, v27
 v_cvt_pk_bf16_f32 v195, v198, v199
 buffer_store_dwordx4 v[192:195], v12, s[16:19], s75 offen offset:0 sc1
 v_mul_f32 v200, v200, v27
 v_mul_f32 v201, v201, v27
 v_cvt_pk_bf16_f32 v200, v200, v201
 v_mul_f32 v202, v202, v27
 v_mul_f32 v203, v203, v27
 v_cvt_pk_bf16_f32 v201, v202, v203
 v_mul_f32 v204, v204, v27
 v_mul_f32 v205, v205, v27
 v_cvt_pk_bf16_f32 v202, v204, v205
 v_mul_f32 v206, v206, v27
 v_mul_f32 v207, v207, v27
 v_cvt_pk_bf16_f32 v203, v206, v207
 buffer_store_dwordx4 v[200:203], v12, s[16:19], s75 offen offset:1024 sc1
 v_mul_f32 v208, v208, v27
 v_mul_f32 v209, v209, v27
 v_cvt_pk_bf16_f32 v208, v208, v209
 v_mul_f32 v210, v210, v27
 v_mul_f32 v211, v211, v27
 v_cvt_pk_bf16_f32 v209, v210, v211
 v_mul_f32 v212, v212, v27
 v_mul_f32 v213, v213, v27
 v_cvt_pk_bf16_f32 v210, v212, v213
 v_mul_f32 v214, v214, v27
 v_mul_f32 v215, v215, v27
 v_cvt_pk_bf16_f32 v211, v214, v215
 buffer_store_dwordx4 v[208:211], v12, s[16:19], s75 offen offset:2048 sc1
 v_mul_f32 v216, v216, v27
 v_mul_f32 v217, v217, v27
 v_cvt_pk_bf16_f32 v216, v216, v217
 v_mul_f32 v218, v218, v27
 v_mul_f32 v219, v219, v27
 v_cvt_pk_bf16_f32 v217, v218, v219
 v_mul_f32 v220, v220, v27
 v_mul_f32 v221, v221, v27
 v_cvt_pk_bf16_f32 v218, v220, v221
 v_mul_f32 v222, v222, v27
 v_mul_f32 v223, v223, v27
 v_cvt_pk_bf16_f32 v219, v222, v223
 buffer_store_dwordx4 v[216:219], v12, s[16:19], s75 offen offset:3072 sc1
 s_branch L_vj_149
L_w3_148:
 s_waitcnt lgkmcnt(0)
 v_mfma_f32_16x16x32_bf16 v[80:83], a[16:19], a[192:195], v[44:47]
 v_exp_f32 v18, v78
 v_mfma_f32_16x16x32_bf16 v[80:83], a[20:23], a[196:199], v[80:83]
 v_cvt_pk_bf16_f32 v54, v16, v17
 v_or3_b32 v20, v20, v53, v54
 v_mfma_f32_16x16x32_bf16 v[80:83], a[24:27], a[200:203], v[80:83]
 v_exp_f32 v19, v79
 v_mfma_f32_16x16x32_bf16 v[80:83], a[28:31], a[204:207], v[80:83]
 v_cvt_pk_bf16_f32 v55, v18, v19
 v_or_b32 v20, v20, v55
 v_mfma_f32_16x16x32_bf16 v[84:87], a[44:47], a[204:207], v[44:47]
 v_and_b32 v20, s64, v20
 v_mfma_f32_16x16x32_bf16 v[84:87], a[40:43], a[200:203], v[84:87]
 v_mfma_f32_16x16x32_bf16 v[84:87], a[36:39], a[196:199], v[84:87]
 v_mfma_f32_16x16x32_bf16 v[84:87], a[32:35], a[192:195], v[84:87]
 v_cmp_ne_u32 vcc, 0, v20
 v_mfma_f32_16x16x32_bf16 v[88:91], a[48:51], a[192:195], v[44:47]
 v_exp_f32 v16, v80
 v_mfma_f32_16x16x32_bf16 v[88:91], a[52:55], a[196:199], v[88:91]
 s_cbranch_vccnz L_so_186
L_sb_187:
 v_exp_f32 v17, v81
 v_mfma_f32_16x16x32_bf16 v[88:91], a[56:59], a[200:203], v[88:91]
 v_exp_f32 v18, v82
 v_mfma_f32_16x16x32_bf16 v[88:91], a[60:63], a[204:207], v[88:91]
 v_cvt_pk_bf16_f32 v56, v16, v17
 v_exp_f32 v19, v83
 v_mfma_f32_16x16x32_bf16 v[92:95], a[92:95], a[204:207], v[44:47]
 v_exp_f32 v16, v84
 v_mfma_f32_16x16x32_bf16 v[92:95], a[88:91], a[200:203], v[92:95]
 v_cvt_pk_bf16_f32 v57, v18, v19
 v_exp_f32 v17, v85
 v_mfma_f32_16x16x32_bf16 v[92:95], a[84:87], a[196:199], v[92:95]
 v_exp_f32 v18, v86
 v_mfma_f32_16x16x32_bf16 v[92:95], a[80:83], a[192:195], v[92:95]
 s_waitcnt vmcnt(0)
 s_barrier
 s_sub_u32 s68, s68, 1
 s_cbranch_scc1 L_fo_190
L_fb_191:
 v_mfma_f32_16x16x32_bf16 v[160:163], a[96:99], v[48:51], v[160:163]
 ds_read_b128 a[96:99], v14 offset:0
 v_cvt_pk_bf16_f32 v58, v16, v17
 v_mfma_f32_16x16x32_bf16 v[160:163], a[144:147], v[52:55], v[160:163]
 ds_read_b128 a[144:147], v14 offset:8192
 v_or3_b32 v21, v56, v57, v58
 v_mfma_f32_16x16x32_bf16 v[164:167], a[148:151], v[52:55], v[164:167]
 s_add_u32 s48, s77, s58
 v_exp_f32 v19, v87
 v_mfma_f32_16x16x32_bf16 v[164:167], a[100:103], v[48:51], v[164:167]
 s_sub_u32 s49, s48, 32768
 s_and_b32 s49, s49, 0x1ffff
 v_exp_f32 v16, v88
 v_mfma_f32_16x16x32_bf16 v[168:171], a[104:107], v[48:51], v[168:171]
 ds_read_b128 a[148:151], v14 offset:9216
 v_add_u32 v9, s48, v4
 v_mfma_f32_16x16x32_bf16 v[168:171], a[152:155], v[52:55], v[168:171]
 ds_read_b128 a[100:103], v14 offset:1024
 v_cvt_pk_bf16_f32 v59, v18, v19
 v_mfma_f32_16x16x32_bf16 v[172:175], a[156:159], v[52:55], v[172:175]
 ds_read_b128 a[104:107], v14 offset:2048
 v_exp_f32 v17, v89
 v_mfma_f32_16x16x32_bf16 v[172:175], a[108:111], v[48:51], v[172:175]
 ds_read_b128 a[152:155], v14 offset:10240
 v_exp_f32 v18, v90
 v_mfma_f32_16x16x32_bf16 v[176:179], a[112:115], v[48:51], v[176:179]
 ds_read_b128 a[156:159], v14 offset:11264
 v_cvt_pk_bf16_f32 v60, v16, v17
 v_mfma_f32_16x16x32_bf16 v[176:179], a[160:163], v[52:55], v[176:179]
 ds_read_b128 a[108:111], v14 offset:3072
 v_or3_b32 v21, v21, v59, v60
 v_mfma_f32_16x16x32_bf16 v[180:183], a[164:167], v[52:55], v[180:183]
 s_add_u32 s44, s42, 12288
 s_and_b32 s44, s44, 0x7fff
 s_add_u32 s44, s44, s43
 v_mfma_f32_16x16x32_bf16 v[180:183], a[116:119], v[48:51], v[180:183]
 s_add_u32 m0, s48, 0
 v_exp_f32 v19, v91
 v_mfma_f32_16x16x32_bf16 v[184:187], a[120:123], v[48:51], v[184:187]
 buffer_load_dwordx4 v4, s[8:11], s44 offen offset:0 sc1 lds
 v_mfma_f32_16x16x32_bf16 v[184:187], a[168:171], v[52:55], v[184:187]
 buffer_load_dwordx4 v4, s[8:11], s44 offen offset:1024 sc1 lds
 v_mfma_f32_16x16x32_bf16 v[188:191], a[172:175], v[52:55], v[188:191]
 ds_read_b128 a[112:115], v14 offset:4096
 v_exp_f32 v16, v92
 v_mfma_f32_16x16x32_bf16 v[188:191], a[124:127], v[48:51], v[188:191]
 ds_read_b128 a[160:163], v14 offset:12288
 v_cvt_pk_bf16_f32 v61, v18, v19
 v_mfma_f32_16x16x32_bf16 a[184:187], v[22:25], v[48:51], a[184:187]
 ds_read_b128 a[164:167], v14 offset:13312
 v_exp_f32 v17, v93
 v_mfma_f32_16x16x32_bf16 a[184:187], v[22:25], v[52:55], a[184:187]
 ds_read_b128 a[116:119], v14 offset:5120
 v_exp_f32 v18, v94
 v_mfma_f32_16x16x32_bf16 v[64:67], a[16:19], a[128:131], v[40:43]
 s_add_u32 m0, s48, 2048
 v_cvt_pk_bf16_f32 v62, v16, v17
 v_or3_b32 v21, v21, v61, v62
 v_mfma_f32_16x16x32_bf16 v[64:67], a[20:23], a[132:135], v[64:67]
 buffer_load_dwordx4 v5, s[8:11], s44 offen offset:0 sc1 lds
 v_mfma_f32_16x16x32_bf16 v[64:67], a[24:27], a[136:139], v[64:67]
 ds_read_b128 a[16:19], v14 offset:16384
 v_exp_f32 v19, v95
 v_mfma_f32_16x16x32_bf16 v[64:67], a[28:31], a[140:143], v[64:67]
 ds_read_b128 a[20:23], v14 offset:17408
 v_cvt_pk_bf16_f32 v63, v18, v19
 v_mfma_f32_16x16x32_bf16 v[68:71], a[44:47], a[140:143], v[40:43]
 buffer_load_dwordx4 v5, s[8:11], s44 offen offset:1024 sc1 lds
 v_mfma_f32_16x16x32_bf16 v[68:71], a[40:43], a[136:139], v[68:71]
 ds_read_b128 a[24:27], v14 offset:18432
 v_or_b32 v21, v21, v63
 v_mfma_f32_16x16x32_bf16 v[68:71], a[36:39], a[132:135], v[68:71]
 ds_read_b128 a[120:123], v14 offset:6144
 v_and_b32 v21, s64, v21
 v_mfma_f32_16x16x32_bf16 v[68:71], a[32:35], a[128:131], v[68:71]
 ds_read_b128 a[168:171], v14 offset:14336
 v_cmp_ne_u32 vcc, 0, v21
 v_mfma_f32_16x16x32_bf16 v[72:75], a[48:51], a[128:131], v[40:43]
 ds_read_b128 a[172:175], v14 offset:15360
 v_exp_f32 v16, v64
 v_mfma_f32_16x16x32_bf16 v[72:75], a[52:55], a[132:135], v[72:75]
 s_add_u32 m0, s48, 4096
 v_exp_f32 v17, v65
 v_mfma_f32_16x16x32_bf16 v[72:75], a[56:59], a[136:139], v[72:75]
 buffer_load_dwordx4 v6, s[8:11], s44 offen offset:0 sc1 lds
 v_mfma_f32_16x16x32_bf16 v[72:75], a[60:63], a[140:143], v[72:75]
 s_cbranch_vccnz L_so_188
L_sb_189:
 v_exp_f32 v18, v66
 v_mov_b32 v3, 4048155338
 v_cndmask_b32 v28, v3, v40, s[80:81]
 v_cndmask_b32 v29, v3, v41, s[82:83]
 v_cndmask_b32 v30, v3, v42, s[84:85]
 v_cndmask_b32 v31, v3, v43, s[86:87]
 s_nop 1
 v_mfma_f32_16x16x32_bf16 v[76:79], a[92:95], a[140:143], v[28:31]
 ds_read_b128 a[124:127], v14 offset:7168
 v_cvt_pk_bf16_f32 v48, v16, v17
 v_mfma_f32_16x16x32_bf16 v[76:79], a[88:91], a[136:139], v[76:79]
 buffer_load_dwordx4 v6, s[8:11], s44 offen offset:1024 sc1 lds
 v_mfma_f32_16x16x32_bf16 v[76:79], a[84:87], a[132:135], v[76:79]
 ds_read_b128 a[28:31], v14 offset:19456
 v_exp_f32 v19, v67
 v_mfma_f32_16x16x32_bf16 v[76:79], a[80:83], a[128:131], v[76:79]
 s_waitcnt lgkmcnt(5)
 v_exp_f32 v16, v68
 v_mfma_f32_16x16x32_bf16 v[192:195], a[96:99], v[56:59], v[192:195]
 ds_read_b128 a[44:47], v14 offset:23552
 v_cvt_pk_bf16_f32 v49, v18, v19
 v_mfma_f32_16x16x32_bf16 v[192:195], a[144:147], v[60:63], v[192:195]
 ds_read_b128 a[40:43], v14 offset:22528
 v_exp_f32 v17, v69
 v_mfma_f32_16x16x32_bf16 v[196:199], a[148:151], v[60:63], v[196:199]
 s_add_u32 m0, s48, 6144
 v_exp_f32 v18, v70
 v_mfma_f32_16x16x32_bf16 v[196:199], a[100:103], v[56:59], v[196:199]
 buffer_load_dwordx4 v7, s[8:11], s44 offen offset:0 sc1 lds
 v_mfma_f32_16x16x32_bf16 v[200:203], a[104:107], v[56:59], v[200:203]
 ds_read_b128 a[36:39], v14 offset:21504
 v_cvt_pk_bf16_f32 v50, v16, v17
 v_mfma_f32_16x16x32_bf16 v[200:203], a[152:155], v[60:63], v[200:203]
 ds_read_b128 a[32:35], v14 offset:20480
 v_or3_b32 v20, v48, v49, v50
 v_mfma_f32_16x16x32_bf16 v[204:207], a[156:159], v[60:63], v[204:207]
 buffer_load_dwordx4 v7, s[8:11], s44 offen offset:1024 sc1 lds
 v_mfma_f32_16x16x32_bf16 v[204:207], a[108:111], v[56:59], v[204:207]
 s_add_u32 s79, s76, s58
 v_exp_f32 v19, v71
 v_mfma_f32_16x16x32_bf16 v[208:211], a[112:115], v[56:59], v[208:211]
 s_add_u32 s76, s76, 32768
 v_exp_f32 v16, v72
 v_mfma_f32_16x16x32_bf16 v[208:211], a[160:163], v[60:63], v[208:211]
 ds_read_b128 a[48:51], v14 offset:24576
 v_cvt_pk_bf16_f32 v51, v18, v19
 v_mfma_f32_16x16x32_bf16 v[212:215], a[164:167], v[60:63], v[212:215]
 s_and_b32 s76, s76, 0x1ffff
 v_exp_f32 v17, v73
 v_mfma_f32_16x16x32_bf16 v[212:215], a[116:119], v[56:59], v[212:215]
 s_waitcnt lgkmcnt(3)
 v_exp_f32 v18, v74
 v_mfma_f32_16x16x32_bf16 v[216:219], a[120:123], v[56:59], v[216:219]
 ds_read_b128 a[52:55], v14 offset:25600
 v_cvt_pk_bf16_f32 v52, v16, v17
 v_mfma_f32_16x16x32_bf16 v[216:219], a[168:171], v[60:63], v[216:219]
 ds_read_b128 a[56:59], v14 offset:26624
 v_or3_b32 v20, v20, v51, v52
 v_mfma_f32_16x16x32_bf16 v[220:223], a[172:175], v[60:63], v[220:223]
 ds_read_b128 a[60:63], v14 offset:27648
 v_exp_f32 v19, v75
 v_mfma_f32_16x16x32_bf16 v[220:223], a[124:127], v[56:59], v[220:223]
 ds_read_b128 a[92:95], v14 offset:31744
 v_exp_f32 v16, v76
 v_mfma_f32_16x16x32_bf16 a[188:191], v[22:25], v[56:59], a[188:191]
 ds_read_b128 a[88:91], v14 offset:30720
 ds_read_b128 a[84:87], v14 offset:29696
 ds_read_b128 a[80:83], v14 offset:28672
 v_mfma_f32_16x16x32_bf16 a[188:191], v[22:25], v[60:63], a[188:191]
 s_mov_b32 s77, s79
 v_add_u32 v14, s76, v12
 v_add_u32 v10, s49, v4
 v_cvt_pk_bf16_f32 v53, v18, v19
 v_exp_f32 v17, v77
 v_mov_b32 v3, 4048155338
 v_cndmask_b32 v28, v3, v44, s[80:81]
 v_cndmask_b32 v29, v3, v45, s[82:83]
 v_cndmask_b32 v30, v3, v46, s[84:85]
 v_cndmask_b32 v31, v3, v47, s[86:87]
 s_nop 1
 v_mfma_f32_16x16x32_bf16 v[80:83], a[16:19], a[192:195], v[28:31]
 v_exp_f32 v18, v78
 v_mfma_f32_16x16x32_bf16 v[80:83], a[20:23], a[196:199], v[80:83]
 v_cvt_pk_bf16_f32 v54, v16, v17
 v_or3_b32 v20, v20, v53, v54
 v_exp_f32 v19, v79
 s_nop 0
 v_cvt_pk_bf16_f32 v55, v18, v19
 v_or_b32 v20, v20, v55
 v_and_b32 v20, s64, v20
 v_mfma_f32_16x16x32_bf16 v[80:83], a[24:27], a[200:203], v[80:83]
 v_cmp_ne_u32 vcc, 0, v20
 v_mfma_f32_16x16x32_bf16 v[80:83], a[28:31], a[204:207], v[80:83]
 s_cbranch_vccnz L_so_192
L_sb_193:
 s_waitcnt lgkmcnt(0)
 s_barrier
 s_sub_u32 s68, s68, 1
 s_cbranch_scc1 L_fo_194
L_fb_195:
 v_mfma_f32_16x16x32_bf16 v[160:163], a[96:99], v[48:51], v[160:163]
 ds_read_b128 a[96:99], v14 offset:0
 v_mov_b32 v84, 4048155338
 v_mfma_f32_16x16x32_bf16 v[160:163], a[144:147], v[52:55], v[160:163]
 ds_read_b128 a[144:147], v14 offset:8192
 v_mov_b32 v85, 4048155338
 v_mfma_f32_16x16x32_bf16 v[164:167], a[148:151], v[52:55], v[164:167]
 ds_read_b128 a[148:151], v14 offset:9216
 v_mov_b32 v86, 4048155338
 v_mfma_f32_16x16x32_bf16 v[164:167], a[100:103], v[48:51], v[164:167]
 ds_read_b128 a[100:103], v14 offset:1024
 v_mov_b32 v87, 4048155338
 v_mfma_f32_16x16x32_bf16 v[168:171], a[104:107], v[48:51], v[168:171]
 ds_read_b128 a[104:107], v14 offset:2048
 v_mov_b32 v88, 4048155338
 v_mfma_f32_16x16x32_bf16 v[168:171], a[152:155], v[52:55], v[168:171]
 ds_read_b128 a[152:155], v14 offset:10240
 v_mov_b32 v89, 4048155338
 v_mfma_f32_16x16x32_bf16 v[172:175], a[156:159], v[52:55], v[172:175]
 ds_read_b128 a[156:159], v14 offset:11264
 v_mov_b32 v90, 4048155338
 v_mfma_f32_16x16x32_bf16 v[172:175], a[108:111], v[48:51], v[172:175]
 ds_read_b128 a[108:111], v14 offset:3072
 v_mov_b32 v91, 4048155338
 v_mfma_f32_16x16x32_bf16 v[176:179], a[112:115], v[48:51], v[176:179]
 ds_read_b128 a[112:115], v14 offset:4096
 v_mov_b32 v92, 4048155338
 v_mfma_f32_16x16x32_bf16 v[176:179], a[160:163], v[52:55], v[176:179]
 ds_read_b128 a[160:163], v14 offset:12288
 v_mov_b32 v93, 4048155338
 v_mfma_f32_16x16x32_bf16 v[180:183], a[164:167], v[52:55], v[180:183]
 ds_read_b128 a[164:167], v14 offset:13312
 v_mov_b32 v94, 4048155338
 v_mfma_f32_16x16x32_bf16 v[180:183], a[116:119], v[48:51], v[180:183]
 ds_read_b128 a[116:119], v14 offset:5120
 v_mov_b32 v95, 4048155338
 v_mfma_f32_16x16x32_bf16 v[184:187], a[120:123], v[48:51], v[184:187]
 ds_read_b128 a[120:123], v14 offset:6144
 v_mov_b32 v58, 0
 v_mov_b32 v59, 0
 v_mfma_f32_16x16x32_bf16 v[184:187], a[168:171], v[52:55], v[184:187]
 ds_read_b128 a[168:171], v14 offset:14336
 v_exp_f32 v16, v80
 v_mfma_f32_16x16x32_bf16 v[188:191], a[172:175], v[52:55], v[188:191]
 ds_read_b128 a[172:175], v14 offset:15360
 v_exp_f32 v17, v81
 v_mfma_f32_16x16x32_bf16 v[188:191], a[124:127], v[48:51], v[188:191]
 v_exp_f32 v18, v82
 v_mfma_f32_16x16x32_bf16 a[184:187], v[22:25], v[48:51], a[184:187]
 ds_read_b128 a[124:127], v14 offset:7168
 v_cvt_pk_bf16_f32 v56, v16, v17
 v_mfma_f32_16x16x32_bf16 a[184:187], v[22:25], v[52:55], a[184:187]
 v_exp_f32 v19, v83
 s_nop 0
 v_cvt_pk_bf16_f32 v57, v18, v19
 v_or_b32 v21, v56, v57
 v_and_b32 v21, s64, v21
 v_cmp_ne_u32 vcc, 0, v21
 s_nop 1
 v_accvgpr_read_b32 v26, a184
 v_rcp_f32 v26, v26
 s_nop 0
 v_mul_f32 v26, 0x1f800000, v26
 s_nop 0
 s_cbranch_vccnz L_so_196
L_sb_197:
 s_waitcnt lgkmcnt(8)
 v_mfma_f32_16x16x32_bf16 v[192:195], a[96:99], v[56:59], v[192:195]
 v_mul_f32 v160, v160, v26
 v_mul_f32 v161, v161, v26
 v_mfma_f32_16x16x32_bf16 v[196:199], a[100:103], v[56:59], v[196:199]
 v_cvt_pk_bf16_f32 v160, v160, v161
 v_mfma_f32_16x16x32_bf16 v[200:203], a[104:107], v[56:59], v[200:203]
 v_mul_f32 v162, v162, v26
 v_mul_f32 v163, v163, v26
 v_mfma_f32_16x16x32_bf16 v[204:207], a[108:111], v[56:59], v[204:207]
 s_waitcnt lgkmcnt(4)
 v_cvt_pk_bf16_f32 v161, v162, v163
 v_mfma_f32_16x16x32_bf16 v[208:211], a[112:115], v[56:59], v[208:211]
 v_mul_f32 v164, v164, v26
 v_mul_f32 v165, v165, v26
 v_mfma_f32_16x16x32_bf16 v[212:215], a[116:119], v[56:59], v[212:215]
 s_waitcnt lgkmcnt(2)
 v_cvt_pk_bf16_f32 v162, v164, v165
 v_mfma_f32_16x16x32_bf16 v[216:219], a[120:123], v[56:59], v[216:219]
 s_waitcnt lgkmcnt(0)
 v_mul_f32 v166, v166, v26
 v_mul_f32 v167, v167, v26
 v_mfma_f32_16x16x32_bf16 v[220:223], a[124:127], v[56:59], v[220:223]
 v_cvt_pk_bf16_f32 v163, v166, v167
 v_mfma_f32_16x16x32_bf16 a[188:191], v[22:25], v[56:59], a[188:191]
 buffer_store_dwordx4 v[160:163], v12, s[16:19], s74 offen offset:0 sc1
 v_mul_f32 v168, v168, v26
 v_mul_f32 v169, v169, v26
 v_cvt_pk_bf16_f32 v168, v168, v169
 v_mul_f32 v170, v170, v26
 v_mul_f32 v171, v171, v26
 v_cvt_pk_bf16_f32 v169, v170, v171
 v_mul_f32 v172, v172, v26
 v_mul_f32 v173, v173, v26
 v_cvt_pk_bf16_f32 v170, v172, v173
 v_mul_f32 v174, v174, v26
 v_mul_f32 v175, v175, v26
 v_cvt_pk_bf16_f32 v171, v174, v175
 buffer_store_dwordx4 v[168:171], v12, s[16:19], s74 offen offset:1024 sc1
 v_mul_f32 v176, v176, v26
 v_mul_f32 v177, v177, v26
 v_cvt_pk_bf16_f32 v176, v176, v177
 v_mul_f32 v178, v178, v26
 v_mul_f32 v179, v179, v26
 v_cvt_pk_bf16_f32 v177, v178, v179
 v_mul_f32 v180, v180, v26
 v_mul_f32 v181, v181, v26
 v_cvt_pk_bf16_f32 v178, v180, v181
 v_mul_f32 v182, v182, v26
 v_mul_f32 v183, v183, v26
 v_cvt_pk_bf16_f32 v179, v182, v183
 buffer_store_dwordx4 v[176:179], v12, s[16:19], s74 offen offset:2048 sc1
 v_mul_f32 v184, v184, v26
 v_mul_f32 v185, v185, v26
 v_cvt_pk_bf16_f32 v184, v184, v185
 v_mul_f32 v186, v186, v26
 v_mul_f32 v187, v187, v26
 v_cvt_pk_bf16_f32 v185, v186, v187
 v_mul_f32 v188, v188, v26
 v_mul_f32 v189, v189, v26
 v_cvt_pk_bf16_f32 v186, v188, v189
 v_mul_f32 v190, v190, v26
 v_mul_f32 v191, v191, v26
 v_cvt_pk_bf16_f32 v187, v190, v191
 buffer_store_dwordx4 v[184:187], v12, s[16:19], s74 offen offset:3072 sc1
 v_accvgpr_read_b32 v27, a188
 v_rcp_f32 v27, v27
 s_nop 0
 v_mul_f32 v27, 0x1f800000, v27
 v_mul_f32 v192, v192, v27
 v_mul_f32 v193, v193, v27
 v_cvt_pk_bf16_f32 v192, v192, v193
 v_mul_f32 v194, v194, v27
 v_mul_f32 v195, v195, v27
 v_cvt_pk_bf16_f32 v193, v194, v195
 v_mul_f32 v196, v196, v27
 v_mul_f32 v197, v197, v27
 v_cvt_pk_bf16_f32 v194, v196, v197
 v_mul_f32 v198, v198, v27
 v_mul_f32 v199, v199, v27
 v_cvt_pk_bf16_f32 v195, v198, v199
 buffer_store_dwordx4 v[192:195], v12, s[16:19], s75 offen offset:0 sc1
 v_mul_f32 v200, v200, v27
 v_mul_f32 v201, v201, v27
 v_cvt_pk_bf16_f32 v200, v200, v201
 v_mul_f32 v202, v202, v27
 v_mul_f32 v203, v203, v27
 v_cvt_pk_bf16_f32 v201, v202, v203
 v_mul_f32 v204, v204, v27
 v_mul_f32 v205, v205, v27
 v_cvt_pk_bf16_f32 v202, v204, v205
 v_mul_f32 v206, v206, v27
 v_mul_f32 v207, v207, v27
 v_cvt_pk_bf16_f32 v203, v206, v207
 buffer_store_dwordx4 v[200:203], v12, s[16:19], s75 offen offset:1024 sc1
 v_mul_f32 v208, v208, v27
 v_mul_f32 v209, v209, v27
 v_cvt_pk_bf16_f32 v208, v208, v209
 v_mul_f32 v210, v210, v27
 v_mul_f32 v211, v211, v27
 v_cvt_pk_bf16_f32 v209, v210, v211
 v_mul_f32 v212, v212, v27
 v_mul_f32 v213, v213, v27
 v_cvt_pk_bf16_f32 v210, v212, v213
 v_mul_f32 v214, v214, v27
 v_mul_f32 v215, v215, v27
 v_cvt_pk_bf16_f32 v211, v214, v215
 buffer_store_dwordx4 v[208:211], v12, s[16:19], s75 offen offset:2048 sc1
 v_mul_f32 v216, v216, v27
 v_mul_f32 v217, v217, v27
 v_cvt_pk_bf16_f32 v216, v216, v217
 v_mul_f32 v218, v218, v27
 v_mul_f32 v219, v219, v27
 v_cvt_pk_bf16_f32 v217, v218, v219
 v_mul_f32 v220, v220, v27
 v_mul_f32 v221, v221, v27
 v_cvt_pk_bf16_f32 v218, v220, v221
 v_mul_f32 v222, v222, v27
 v_mul_f32 v223, v223, v27
 v_cvt_pk_bf16_f32 v219, v222, v223
 buffer_store_dwordx4 v[216:219], v12, s[16:19], s75 offen offset:3072 sc1
L_vj_149:
 s_branch L_bdone_198
L_no4_112:
L_w0_199:
 s_cmp_eq_u32 s3, 0
 s_cbranch_scc0 L_w1_200
 s_waitcnt lgkmcnt(0)
 v_mfma_f32_16x16x32_bf16 v[80:83], a[16:19], a[192:195], v[44:47]
 v_exp_f32 v18, v78
 v_mfma_f32_16x16x32_bf16 v[80:83], a[20:23], a[196:199], v[80:83]
 v_cvt_pk_bf16_f32 v54, v16, v17
 v_or3_b32 v20, v20, v53, v54
 v_mfma_f32_16x16x32_bf16 v[80:83], a[24:27], a[200:203], v[80:83]
 v_exp_f32 v19, v79
 v_mfma_f32_16x16x32_bf16 v[80:83], a[28:31], a[204:207], v[80:83]
 v_cvt_pk_bf16_f32 v55, v18, v19
 v_or_b32 v20, v20, v55
 v_mfma_f32_16x16x32_bf16 v[84:87], a[44:47], a[204:207], v[44:47]
 v_and_b32 v20, s64, v20
 v_mfma_f32_16x16x32_bf16 v[84:87], a[40:43], a[200:203], v[84:87]
 v_mfma_f32_16x16x32_bf16 v[84:87], a[36:39], a[196:199], v[84:87]
 v_mfma_f32_16x16x32_bf16 v[84:87], a[32:35], a[192:195], v[84:87]
 v_cmp_ne_u32 vcc, 0, v20
 v_mfma_f32_16x16x32_bf16 v[88:91], a[48:51], a[192:195], v[44:47]
 v_exp_f32 v16, v80
 v_mfma_f32_16x16x32_bf16 v[88:91], a[52:55], a[196:199], v[88:91]
 v_exp_f32 v17, v81
 v_mfma_f32_16x16x32_bf16 v[88:91], a[56:59], a[200:203], v[88:91]
 v_exp_f32 v18, v82
 v_mfma_f32_16x16x32_bf16 v[88:91], a[60:63], a[204:207], v[88:91]
 s_cbranch_vccnz L_so_204
L_sb_205:
 v_cvt_pk_bf16_f32 v56, v16, v17
 v_mfma_f32_16x16x32_bf16 v[92:95], a[92:95], a[204:207], v[44:47]
 v_exp_f32 v19, v83
 v_mfma_f32_16x16x32_bf16 v[92:95], a[88:91], a[200:203], v[92:95]
 v_exp_f32 v16, v84
 v_mfma_f32_16x16x32_bf16 v[92:95], a[84:87], a[196:199], v[92:95]
 v_cvt_pk_bf16_f32 v57, v18, v19
 v_exp_f32 v17, v85
 v_mfma_f32_16x16x32_bf16 v[92:95], a[80:83], a[192:195], v[92:95]
 s_waitcnt vmcnt(0)
 s_barrier
 s_sub_u32 s68, s68, 1
 s_cbranch_scc1 L_fo_208
L_fb_209:
 v_mfma_f32_16x16x32_bf16 v[160:163], a[96:99], v[48:51], v[160:163]
 s_add_u32 s48, s77, s58
 v_exp_f32 v18, v86
 v_mfma_f32_16x16x32_bf16 v[160:163], a[144:147], v[52:55], v[160:163]
 s_sub_u32 s49, s48, 32768
 s_and_b32 s49, s49, 0x1ffff
 v_add_u32 v9, s48, v4
 v_mfma_f32_16x16x32_bf16 v[164:167], a[148:151], v[52:55], v[164:167]
 s_add_u32 s44, s42, 12288
 s_and_b32 s44, s44, 0x7fff
 s_add_u32 s44, s44, s43
 v_mfma_f32_16x16x32_bf16 v[164:167], a[100:103], v[48:51], v[164:167]
 s_add_u32 m0, s48, 0
 v_cvt_pk_bf16_f32 v58, v16, v17
 v_or3_b32 v21, v56, v57, v58
 v_mfma_f32_16x16x32_bf16 v[168:171], a[104:107], v[48:51], v[168:171]
 buffer_load_dwordx4 v4, s[8:11], s44 offen offset:0 sc1 lds
 v_mfma_f32_16x16x32_bf16 v[168:171], a[152:155], v[52:55], v[168:171]
 buffer_load_dwordx4 v4, s[8:11], s44 offen offset:1024 sc1 lds
 v_mfma_f32_16x16x32_bf16 v[172:175], a[156:159], v[52:55], v[172:175]
 s_add_u32 m0, s48, 2048
 v_exp_f32 v19, v87
 v_mfma_f32_16x16x32_bf16 v[172:175], a[108:111], v[48:51], v[172:175]
 buffer_load_dwordx4 v5, s[8:11], s44 offen offset:0 sc1 lds
 v_mfma_f32_16x16x32_bf16 v[176:179], a[112:115], v[48:51], v[176:179]
 buffer_load_dwordx4 v5, s[8:11], s44 offen offset:1024 sc1 lds
 v_mfma_f32_16x16x32_bf16 v[176:179], a[160:163], v[52:55], v[176:179]
 s_add_u32 m0, s48, 4096
 v_exp_f32 v16, v88
 v_mfma_f32_16x16x32_bf16 v[180:183], a[164:167], v[52:55], v[180:183]
 buffer_load_dwordx4 v6, s[8:11], s44 offen offset:0 sc1 lds
 v_mfma_f32_16x16x32_bf16 v[180:183], a[116:119], v[48:51], v[180:183]
 buffer_load_dwordx4 v6, s[8:11], s44 offen offset:1024 sc1 lds
 v_mfma_f32_16x16x32_bf16 v[184:187], a[120:123], v[48:51], v[184:187]
 s_add_u32 m0, s48, 6144
 ds_read_b128 a[96:99], v14 offset:0
 v_mfma_f32_16x16x32_bf16 v[184:187], a[168:171], v[52:55], v[184:187]
 buffer_load_dwordx4 v7, s[8:11], s44 offen offset:0 sc1 lds
 v_mfma_f32_16x16x32_bf16 v[188:191], a[172:175], v[52:55], v[188:191]
 buffer_load_dwordx4 v7, s[8:11], s44 offen offset:1024 sc1 lds
 v_mfma_f32_16x16x32_bf16 v[188:191], a[124:127], v[48:51], v[188:191]
 ds_read_b128 a[144:147], v14 offset:8192
 v_add_u32 v10, s49, v4
 v_mfma_f32_16x16x32_bf16 a[184:187], v[22:25], v[48:51], a[184:187]
 ds_read_b128 a[148:151], v14 offset:9216
 v_cvt_pk_bf16_f32 v59, v18, v19
 v_mfma_f32_16x16x32_bf16 a[184:187], v[22:25], v[52:55], a[184:187]
 ds_read_b128 a[100:103], v14 offset:1024
 v_exp_f32 v17, v89
 v_mov_b32 v3, 4048155338
 v_cndmask_b32 v28, v3, v40, s[80:81]
 v_cndmask_b32 v29, v3, v41, s[82:83]
 v_cndmask_b32 v30, v3, v42, s[84:85]
 v_cndmask_b32 v31, v3, v43, s[86:87]
 s_nop 1
 v_mfma_f32_16x16x32_bf16 v[64:67], a[16:19], a[128:131], v[28:31]
 ds_read_b128 a[104:107], v14 offset:2048
 s_add_u32 s44, s42, 14336
 s_and_b32 s44, s44, 0x7fff
 s_add_u32 s44, s44, s43
 ds_read_b128 a[152:155], v14 offset:10240
 ds_read_b128 a[156:159], v14 offset:11264
 ds_read_b128 a[108:111], v14 offset:3072
 ds_read_b128 a[112:115], v14 offset:4096
 ds_read_b128 a[160:163], v14 offset:12288
 ds_read_b128 a[164:167], v14 offset:13312
 ds_read_b128 a[116:119], v14 offset:5120
 ds_read_b128 a[120:123], v14 offset:6144
 ds_read_b128 a[168:171], v14 offset:14336
 ds_read_b128 a[172:175], v14 offset:15360
 ds_read_b128 a[124:127], v14 offset:7168
 v_mfma_f32_16x16x32_bf16 v[64:67], a[20:23], a[132:135], v[64:67]
 s_add_u32 m0, s49, 0
 v_exp_f32 v18, v90
 v_cvt_pk_bf16_f32 v60, v16, v17
 v_or3_b32 v21, v21, v59, v60
 v_exp_f32 v19, v91
 v_exp_f32 v16, v92
 v_cvt_pk_bf16_f32 v61, v18, v19
 v_exp_f32 v17, v93
 v_exp_f32 v18, v94
 v_cvt_pk_bf16_f32 v62, v16, v17
 v_or3_b32 v21, v21, v61, v62
 v_exp_f32 v19, v95
 s_nop 0
 v_cvt_pk_bf16_f32 v63, v18, v19
 v_or_b32 v21, v21, v63
 v_and_b32 v21, s64, v21
 v_mfma_f32_16x16x32_bf16 v[64:67], a[24:27], a[136:139], v[64:67]
 buffer_load_dwordx4 v4, s[8:11], s44 offen offset:0 sc1 lds
 v_cmp_ne_u32 vcc, 0, v21
 v_mfma_f32_16x16x32_bf16 v[64:67], a[28:31], a[140:143], v[64:67]
 s_waitcnt lgkmcnt(15)
 s_cbranch_vccnz L_so_206
L_sb_207:
 v_mfma_f32_16x16x32_bf16 v[192:195], a[96:99], v[56:59], v[192:195]
 s_waitcnt lgkmcnt(14)
 buffer_load_dwordx4 v4, s[8:11], s44 offen offset:1024 sc1 lds
 v_mfma_f32_16x16x32_bf16 v[192:195], a[144:147], v[60:63], v[192:195]
 s_waitcnt lgkmcnt(13)
 s_add_u32 m0, s49, 2048
 v_mov_b32 v68, 4048155338
 v_mov_b32 v69, 4048155338
 v_mfma_f32_16x16x32_bf16 v[196:199], a[148:151], v[60:63], v[196:199]
 s_waitcnt lgkmcnt(12)
 buffer_load_dwordx4 v5, s[8:11], s44 offen offset:0 sc1 lds
 v_mfma_f32_16x16x32_bf16 v[196:199], a[100:103], v[56:59], v[196:199]
 s_waitcnt lgkmcnt(11)
 v_mov_b32 v70, 4048155338
 v_mov_b32 v71, 4048155338
 v_mfma_f32_16x16x32_bf16 v[200:203], a[104:107], v[56:59], v[200:203]
 s_waitcnt lgkmcnt(10)
 buffer_load_dwordx4 v5, s[8:11], s44 offen offset:1024 sc1 lds
 v_mfma_f32_16x16x32_bf16 v[200:203], a[152:155], v[60:63], v[200:203]
 s_waitcnt lgkmcnt(9)
 v_mov_b32 v72, 4048155338
 v_mov_b32 v73, 4048155338
 v_mfma_f32_16x16x32_bf16 v[204:207], a[156:159], v[60:63], v[204:207]
 s_waitcnt lgkmcnt(0)
 s_add_u32 m0, s49, 4096
 v_mov_b32 v74, 4048155338
 v_mov_b32 v75, 4048155338
 v_mfma_f32_16x16x32_bf16 v[204:207], a[108:111], v[56:59], v[204:207]
 buffer_load_dwordx4 v6, s[8:11], s44 offen offset:0 sc1 lds
 v_mfma_f32_16x16x32_bf16 v[208:211], a[112:115], v[56:59], v[208:211]
 buffer_load_dwordx4 v6, s[8:11], s44 offen offset:1024 sc1 lds
 v_mfma_f32_16x16x32_bf16 v[208:211], a[160:163], v[60:63], v[208:211]
 s_add_u32 s79, s76, s58
 s_add_u32 m0, s49, 6144
 v_mfma_f32_16x16x32_bf16 v[212:215], a[164:167], v[60:63], v[212:215]
 buffer_load_dwordx4 v7, s[8:11], s44 offen offset:0 sc1 lds
 v_mfma_f32_16x16x32_bf16 v[212:215], a[116:119], v[56:59], v[212:215]
 buffer_load_dwordx4 v7, s[8:11], s44 offen offset:1024 sc1 lds
 v_mfma_f32_16x16x32_bf16 v[216:219], a[120:123], v[56:59], v[216:219]
 s_add_u32 s76, s76, 32768
 ds_read_b128 a[16:19], v14 offset:16384
 v_mfma_f32_16x16x32_bf16 v[216:219], a[168:171], v[60:63], v[216:219]
 s_and_b32 s76, s76, 0x1ffff
 ds_read_b128 a[20:23], v14 offset:17408
 v_mfma_f32_16x16x32_bf16 v[220:223], a[172:175], v[60:63], v[220:223]
 ds_read_b128 a[24:27], v14 offset:18432
 v_mov_b32 v76, 4048155338
 v_mfma_f32_16x16x32_bf16 v[220:223], a[124:127], v[56:59], v[220:223]
 ds_read_b128 a[28:31], v14 offset:19456
 v_mov_b32 v77, 4048155338
 v_mfma_f32_16x16x32_bf16 a[188:191], v[22:25], v[56:59], a[188:191]
 ds_read_b128 a[44:47], v14 offset:23552
 s_add_u32 s44, s42, 10240
 s_and_b32 s44, s44, 0x7fff
 s_add_u32 s44, s44, s43
 ds_read_b128 a[40:43], v14 offset:22528
 ds_read_b128 a[36:39], v14 offset:21504
 ds_read_b128 a[32:35], v14 offset:20480
 ds_read_b128 a[48:51], v14 offset:24576
 ds_read_b128 a[52:55], v14 offset:25600
 ds_read_b128 a[56:59], v14 offset:26624
 ds_read_b128 a[60:63], v14 offset:27648
 ds_read_b128 a[92:95], v14 offset:31744
 ds_read_b128 a[88:91], v14 offset:30720
 ds_read_b128 a[84:87], v14 offset:29696
 ds_read_b128 a[80:83], v14 offset:28672
 v_mfma_f32_16x16x32_bf16 a[188:191], v[22:25], v[60:63], a[188:191]
 s_mov_b32 s77, s79
 v_add_u32 v14, s76, v12
 s_add_u32 m0, s45, 0
 s_nop 0
 buffer_load_dwordx4 v4, s[8:11], s44 offen offset:0 sc1 lds
 buffer_load_dwordx4 v4, s[8:11], s44 offen offset:1024 sc1 lds
 v_mov_b32 v78, 4048155338
 v_mov_b32 v79, 4048155338
 v_mov_b32 v50, 0
 v_mov_b32 v51, 0
 v_exp_f32 v16, v64
 s_add_u32 m0, s45, 2048
 s_nop 0
 buffer_load_dwordx4 v5, s[8:11], s44 offen offset:0 sc1 lds
 buffer_load_dwordx4 v5, s[8:11], s44 offen offset:1024 sc1 lds
 s_add_u32 m0, s45, 4096
 s_nop 0
 buffer_load_dwordx4 v6, s[8:11], s44 offen offset:0 sc1 lds
 buffer_load_dwordx4 v6, s[8:11], s44 offen offset:1024 sc1 lds
 s_add_u32 m0, s45, 6144
 s_nop 0
 buffer_load_dwordx4 v7, s[8:11], s44 offen offset:0 sc1 lds
 buffer_load_dwordx4 v7, s[8:11], s44 offen offset:1024 sc1 lds
 s_add_u32 s44, s42, 0
 s_and_b32 s44, s44, 0x7fff
 s_add_u32 s44, s44, s43
 buffer_load_dwordx4 a[208:211], v4, s[8:11], s44 offen offset:0 sc1
 buffer_load_dwordx4 a[212:215], v5, s[8:11], s44 offen offset:0 sc1
 buffer_load_dwordx4 a[216:219], v6, s[8:11], s44 offen offset:0 sc1
 buffer_load_dwordx4 a[220:223], v7, s[8:11], s44 offen offset:0 sc1
 buffer_load_dwordx4 a[224:227], v4, s[8:11], s44 offen offset:1024 sc1
 buffer_load_dwordx4 a[228:231], v5, s[8:11], s44 offen offset:1024 sc1
 buffer_load_dwordx4 a[232:235], v6, s[8:11], s44 offen offset:1024 sc1
 buffer_load_dwordx4 a[236:239], v7, s[8:11], s44 offen offset:1024 sc1
 s_add_u32 s44, s42, 2048
 s_and_b32 s44, s44, 0x7fff
 s_add_u32 s44, s44, s43
 buffer_load_dwordx4 a[240:243], v4, s[8:11], s44 offen offset:0 sc1
 buffer_load_dwordx4 a[244:247], v5, s[8:11], s44 offen offset:0 sc1
 buffer_load_dwordx4 a[248:251], v6, s[8:11], s44 offen offset:0 sc1
 buffer_load_dwordx4 a[252:255], v7, s[8:11], s44 offen offset:0 sc1
 buffer_load_dwordx4 a[0:3], v4, s[8:11], s44 offen offset:1024 sc1
 s_waitcnt lgkmcnt(15)
 v_mfma_f32_16x16x32_bf16 v[80:83], a[16:19], a[192:195], v[44:47]
 s_waitcnt lgkmcnt(14)
 buffer_load_dwordx4 a[4:7], v5, s[8:11], s44 offen offset:1024 sc1
 v_mfma_f32_16x16x32_bf16 v[80:83], a[20:23], a[196:199], v[80:83]
 s_waitcnt lgkmcnt(13)
 v_exp_f32 v17, v65
 v_mfma_f32_16x16x32_bf16 v[80:83], a[24:27], a[200:203], v[80:83]
 s_waitcnt lgkmcnt(12)
 v_exp_f32 v18, v66
 v_mfma_f32_16x16x32_bf16 v[80:83], a[28:31], a[204:207], v[80:83]
 s_waitcnt lgkmcnt(11)
 v_cvt_pk_bf16_f32 v48, v16, v17
 v_exp_f32 v19, v67
 v_mfma_f32_16x16x32_bf16 v[84:87], a[44:47], a[204:207], v[44:47]
 s_waitcnt lgkmcnt(10)
 v_cvt_pk_bf16_f32 v49, v18, v19
 v_or_b32 v20, v48, v49
 v_mfma_f32_16x16x32_bf16 v[84:87], a[40:43], a[200:203], v[84:87]
 s_waitcnt lgkmcnt(9)
 buffer_load_dwordx4 a[8:11], v6, s[8:11], s44 offen offset:1024 sc1
 v_mfma_f32_16x16x32_bf16 v[84:87], a[36:39], a[196:199], v[84:87]
 s_waitcnt lgkmcnt(8)
 buffer_load_dwordx4 a[12:15], v7, s[8:11], s44 offen offset:1024 sc1
 v_mfma_f32_16x16x32_bf16 v[84:87], a[32:35], a[192:195], v[84:87]
 s_waitcnt lgkmcnt(7)
 v_and_b32 v20, s64, v20
 v_cmp_ne_u32 vcc, 0, v20
 v_mfma_f32_16x16x32_bf16 v[88:91], a[48:51], a[192:195], v[44:47]
 s_waitcnt lgkmcnt(0)
 s_add_u32 s44, s42, 4096
 s_and_b32 s44, s44, 0x7fff
 s_add_u32 s44, s44, s43
 v_mfma_f32_16x16x32_bf16 v[88:91], a[52:55], a[196:199], v[88:91]
 buffer_load_dwordx4 v[96:99], v4, s[8:11], s44 offen offset:0 sc1
 v_mfma_f32_16x16x32_bf16 v[88:91], a[56:59], a[200:203], v[88:91]
 buffer_load_dwordx4 v[100:103], v5, s[8:11], s44 offen offset:0 sc1
 v_mfma_f32_16x16x32_bf16 v[88:91], a[60:63], a[204:207], v[88:91]
 buffer_load_dwordx4 v[104:107], v6, s[8:11], s44 offen offset:0 sc1
 s_cbranch_vccnz L_so_210
L_sb_211:
 v_mov_b32 v3, 4048155338
 v_cndmask_b32 v28, v3, v44, s[80:81]
 v_cndmask_b32 v29, v3, v45, s[82:83]
 v_cndmask_b32 v30, v3, v46, s[84:85]
 v_cndmask_b32 v31, v3, v47, s[86:87]
 s_nop 1
 v_mfma_f32_16x16x32_bf16 v[92:95], a[92:95], a[204:207], v[28:31]
 buffer_load_dwordx4 v[108:111], v7, s[8:11], s44 offen offset:0 sc1
 v_mfma_f32_16x16x32_bf16 v[92:95], a[88:91], a[200:203], v[92:95]
 buffer_load_dwordx4 v[112:115], v4, s[8:11], s44 offen offset:1024 sc1
 v_mfma_f32_16x16x32_bf16 v[92:95], a[84:87], a[196:199], v[92:95]
 buffer_load_dwordx4 v[116:119], v5, s[8:11], s44 offen offset:1024 sc1
 v_mfma_f32_16x16x32_bf16 v[92:95], a[80:83], a[192:195], v[92:95]
 s_barrier
 s_sub_u32 s68, s68, 1
 s_cbranch_scc1 L_fo_212
L_fb_213:
 v_mfma_f32_16x16x32_bf16 v[160:163], a[96:99], v[48:51], v[160:163]
 buffer_load_dwordx4 v[120:123], v6, s[8:11], s44 offen offset:1024 sc1
 v_mfma_f32_16x16x32_bf16 v[164:167], a[100:103], v[48:51], v[164:167]
 buffer_load_dwordx4 v[124:127], v7, s[8:11], s44 offen offset:1024 sc1
 v_mfma_f32_16x16x32_bf16 v[168:171], a[104:107], v[48:51], v[168:171]
 s_add_u32 s44, s42, 6144
 s_and_b32 s44, s44, 0x7fff
 s_add_u32 s44, s44, s43
 v_mfma_f32_16x16x32_bf16 v[172:175], a[108:111], v[48:51], v[172:175]
 buffer_load_dwordx4 v[128:131], v4, s[8:11], s44 offen offset:0 sc1
 v_mfma_f32_16x16x32_bf16 v[176:179], a[112:115], v[48:51], v[176:179]
 buffer_load_dwordx4 v[132:135], v5, s[8:11], s44 offen offset:0 sc1
 v_mfma_f32_16x16x32_bf16 v[180:183], a[116:119], v[48:51], v[180:183]
 buffer_load_dwordx4 v[136:139], v6, s[8:11], s44 offen offset:0 sc1
 v_mfma_f32_16x16x32_bf16 v[184:187], a[120:123], v[48:51], v[184:187]
 buffer_load_dwordx4 v[140:143], v7, s[8:11], s44 offen offset:0 sc1
 v_mfma_f32_16x16x32_bf16 v[188:191], a[124:127], v[48:51], v[188:191]
 ds_read_b128 a[96:99], v14 offset:0
 v_exp_f32 v16, v80
 v_mfma_f32_16x16x32_bf16 a[184:187], v[22:25], v[48:51], a[184:187]
 ds_read_b128 a[144:147], v14 offset:8192
 buffer_load_dwordx4 v[144:147], v4, s[8:11], s44 offen offset:1024 sc1
 ds_read_b128 a[148:151], v14 offset:9216
 buffer_load_dwordx4 v[148:151], v5, s[8:11], s44 offen offset:1024 sc1
 ds_read_b128 a[100:103], v14 offset:1024
 v_exp_f32 v17, v81
 v_exp_f32 v18, v82
 v_cvt_pk_bf16_f32 v56, v16, v17
 v_exp_f32 v19, v83
 v_exp_f32 v16, v84
 v_cvt_pk_bf16_f32 v57, v18, v19
 v_exp_f32 v17, v85
 v_exp_f32 v18, v86
 v_cvt_pk_bf16_f32 v58, v16, v17
 v_or3_b32 v21, v56, v57, v58
 v_exp_f32 v19, v87
 v_exp_f32 v16, v88
 v_cvt_pk_bf16_f32 v59, v18, v19
 v_exp_f32 v17, v89
 v_exp_f32 v18, v90
 v_cvt_pk_bf16_f32 v60, v16, v17
 v_or3_b32 v21, v21, v59, v60
 v_exp_f32 v19, v91
 v_exp_f32 v16, v92
 v_cvt_pk_bf16_f32 v61, v18, v19
 v_exp_f32 v17, v93
 v_exp_f32 v18, v94
 v_cvt_pk_bf16_f32 v62, v16, v17
 v_or3_b32 v21, v21, v61, v62
 v_exp_f32 v19, v95
 s_nop 0
 v_cvt_pk_bf16_f32 v63, v18, v19
 v_or_b32 v21, v21, v63
 v_and_b32 v21, s64, v21
 ds_read_b128 a[104:107], v14 offset:2048
 ds_read_b128 a[152:155], v14 offset:10240
 ds_read_b128 a[156:159], v14 offset:11264
 ds_read_b128 a[108:111], v14 offset:3072
 ds_read_b128 a[112:115], v14 offset:4096
 ds_read_b128 a[160:163], v14 offset:12288
 ds_read_b128 a[164:167], v14 offset:13312
 ds_read_b128 a[116:119], v14 offset:5120
 ds_read_b128 a[120:123], v14 offset:6144
 ds_read_b128 a[168:171], v14 offset:14336
 ds_read_b128 a[172:175], v14 offset:15360
 ds_read_b128 a[124:127], v14 offset:7168
 buffer_load_dwordx4 v[152:155], v6, s[8:11], s44 offen offset:1024 sc1
 buffer_load_dwordx4 v[156:159], v7, s[8:11], s44 offen offset:1024 sc1
 s_add_u32 s44, s42, 8192
 s_and_b32 s44, s44, 0x7fff
 s_add_u32 s44, s44, s43
 buffer_load_dwordx4 a[64:67], v4, s[8:11], s44 offen offset:0 sc1
 buffer_load_dwordx4 a[68:71], v5, s[8:11], s44 offen offset:0 sc1
 buffer_load_dwordx4 a[72:75], v6, s[8:11], s44 offen offset:0 sc1
 buffer_load_dwordx4 a[76:79], v7, s[8:11], s44 offen offset:0 sc1
 buffer_load_dwordx4 a[176:179], v4, s[8:11], s44 offen offset:1024 sc1
 buffer_load_dwordx4 a[180:183], v5, s[8:11], s44 offen offset:1024 sc1
 buffer_load_dwordx4 v[32:35], v6, s[8:11], s44 offen offset:1024 sc1
 buffer_load_dwordx4 v[36:39], v7, s[8:11], s44 offen offset:1024 sc1
 v_cmp_ne_u32 vcc, 0, v21
 v_accvgpr_read_b32 v26, a184
 v_rcp_f32 v26, v26
 s_nop 0
 v_mul_f32 v26, 0x1f800000, v26
 s_nop 0
 s_cbranch_vccnz L_so_214
L_sb_215:
 s_waitcnt lgkmcnt(15)
 v_mfma_f32_16x16x32_bf16 v[192:195], a[96:99], v[56:59], v[192:195]
 s_waitcnt lgkmcnt(14)
 v_mul_f32 v160, v160, v26
 v_mul_f32 v161, v161, v26
 v_mfma_f32_16x16x32_bf16 v[192:195], a[144:147], v[60:63], v[192:195]
 s_waitcnt lgkmcnt(13)
 v_cvt_pk_bf16_f32 v160, v160, v161
 v_mfma_f32_16x16x32_bf16 v[196:199], a[148:151], v[60:63], v[196:199]
 s_waitcnt lgkmcnt(12)
 v_mul_f32 v162, v162, v26
 v_mul_f32 v163, v163, v26
 v_mfma_f32_16x16x32_bf16 v[196:199], a[100:103], v[56:59], v[196:199]
 s_waitcnt lgkmcnt(11)
 v_cvt_pk_bf16_f32 v161, v162, v163
 v_mfma_f32_16x16x32_bf16 v[200:203], a[104:107], v[56:59], v[200:203]
 s_waitcnt lgkmcnt(10)
 v_mul_f32 v164, v164, v26
 v_mul_f32 v165, v165, v26
 v_mfma_f32_16x16x32_bf16 v[200:203], a[152:155], v[60:63], v[200:203]
 s_waitcnt lgkmcnt(9)
 v_cvt_pk_bf16_f32 v162, v164, v165
 v_mfma_f32_16x16x32_bf16 v[204:207], a[156:159], v[60:63], v[204:207]
 s_waitcnt lgkmcnt(8)
 v_mul_f32 v166, v166, v26
 v_mul_f32 v167, v167, v26
 v_mfma_f32_16x16x32_bf16 v[204:207], a[108:111], v[56:59], v[204:207]
 s_waitcnt lgkmcnt(7)
 v_mfma_f32_16x16x32_bf16 v[208:211], a[112:115], v[56:59], v[208:211]
 s_waitcnt lgkmcnt(6)
 v_mfma_f32_16x16x32_bf16 v[208:211], a[160:163], v[60:63], v[208:211]
 s_waitcnt lgkmcnt(0)
 v_cvt_pk_bf16_f32 v163, v166, v167
 v_mfma_f32_16x16x32_bf16 v[212:215], a[164:167], v[60:63], v[212:215]
 v_mfma_f32_16x16x32_bf16 v[212:215], a[116:119], v[56:59], v[212:215]
 v_mfma_f32_16x16x32_bf16 v[216:219], a[120:123], v[56:59], v[216:219]
 v_mfma_f32_16x16x32_bf16 v[216:219], a[168:171], v[60:63], v[216:219]
 v_mfma_f32_16x16x32_bf16 v[220:223], a[172:175], v[60:63], v[220:223]
 v_mfma_f32_16x16x32_bf16 v[220:223], a[124:127], v[56:59], v[220:223]
 v_mfma_f32_16x16x32_bf16 a[188:191], v[22:25], v[56:59], a[188:191]
 v_mfma_f32_16x16x32_bf16 a[188:191], v[22:25], v[60:63], a[188:191]
 buffer_store_dwordx4 v[160:163], v12, s[16:19], s74 offen offset:0 sc1
 v_mul_f32 v168, v168, v26
 v_mul_f32 v169, v169, v26
 v_cvt_pk_bf16_f32 v168, v168, v169
 v_mul_f32 v170, v170, v26
 v_mul_f32 v171, v171, v26
 v_cvt_pk_bf16_f32 v169, v170, v171
 v_mul_f32 v172, v172, v26
 v_mul_f32 v173, v173, v26
 v_cvt_pk_bf16_f32 v170, v172, v173
 v_mul_f32 v174, v174, v26
 v_mul_f32 v175, v175, v26
 v_cvt_pk_bf16_f32 v171, v174, v175
 buffer_store_dwordx4 v[168:171], v12, s[16:19], s74 offen offset:1024 sc1
 v_mul_f32 v176, v176, v26
 v_mul_f32 v177, v177, v26
 v_cvt_pk_bf16_f32 v176, v176, v177
 v_mul_f32 v178, v178, v26
 v_mul_f32 v179, v179, v26
 v_cvt_pk_bf16_f32 v177, v178, v179
 v_mul_f32 v180, v180, v26
 v_mul_f32 v181, v181, v26
 v_cvt_pk_bf16_f32 v178, v180, v181
 v_mul_f32 v182, v182, v26
 v_mul_f32 v183, v183, v26
 v_cvt_pk_bf16_f32 v179, v182, v183
 buffer_store_dwordx4 v[176:179], v12, s[16:19], s74 offen offset:2048 sc1
 v_mul_f32 v184, v184, v26
 v_mul_f32 v185, v185, v26
 v_cvt_pk_bf16_f32 v184, v184, v185
 v_mul_f32 v186, v186, v26
 v_mul_f32 v187, v187, v26
 v_cvt_pk_bf16_f32 v185, v186, v187
 v_mul_f32 v188, v188, v26
 v_mul_f32 v189, v189, v26
 v_cvt_pk_bf16_f32 v186, v188, v189
 v_mul_f32 v190, v190, v26
 v_mul_f32 v191, v191, v26
 v_cvt_pk_bf16_f32 v187, v190, v191
 buffer_store_dwordx4 v[184:187], v12, s[16:19], s74 offen offset:3072 sc1
 v_accvgpr_read_b32 v27, a188
 v_rcp_f32 v27, v27
 s_nop 0
 v_mul_f32 v27, 0x1f800000, v27
 v_mul_f32 v192, v192, v27
 v_mul_f32 v193, v193, v27
 v_cvt_pk_bf16_f32 v192, v192, v193
 v_mul_f32 v194, v194, v27
 v_mul_f32 v195, v195, v27
 v_cvt_pk_bf16_f32 v193, v194, v195
 v_mul_f32 v196, v196, v27
 v_mul_f32 v197, v197, v27
 v_cvt_pk_bf16_f32 v194, v196, v197
 v_mul_f32 v198, v198, v27
 v_mul_f32 v199, v199, v27
 v_cvt_pk_bf16_f32 v195, v198, v199
 buffer_store_dwordx4 v[192:195], v12, s[16:19], s75 offen offset:0 sc1
 v_mul_f32 v200, v200, v27
 v_mul_f32 v201, v201, v27
 v_cvt_pk_bf16_f32 v200, v200, v201
 v_mul_f32 v202, v202, v27
 v_mul_f32 v203, v203, v27
 v_cvt_pk_bf16_f32 v201, v202, v203
 v_mul_f32 v204, v204, v27
 v_mul_f32 v205, v205, v27
 v_cvt_pk_bf16_f32 v202, v204, v205
 v_mul_f32 v206, v206, v27
 v_mul_f32 v207, v207, v27
 v_cvt_pk_bf16_f32 v203, v206, v207
 buffer_store_dwordx4 v[200:203], v12, s[16:19], s75 offen offset:1024 sc1
 v_mul_f32 v208, v208, v27
 v_mul_f32 v209, v209, v27
 v_cvt_pk_bf16_f32 v208, v208, v209
 v_mul_f32 v210, v210, v27
 v_mul_f32 v211, v211, v27
 v_cvt_pk_bf16_f32 v209, v210, v211
 v_mul_f32 v212, v212, v27
 v_mul_f32 v213, v213, v27
 v_cvt_pk_bf16_f32 v210, v212, v213
 v_mul_f32 v214, v214, v27
 v_mul_f32 v215, v215, v27
 v_cvt_pk_bf16_f32 v211, v214, v215
 buffer_store_dwordx4 v[208:211], v12, s[16:19], s75 offen offset:2048 sc1
 v_mul_f32 v216, v216, v27
 v_mul_f32 v217, v217, v27
 v_cvt_pk_bf16_f32 v216, v216, v217
 v_mul_f32 v218, v218, v27
 v_mul_f32 v219, v219, v27
 v_cvt_pk_bf16_f32 v217, v218, v219
 v_mul_f32 v220, v220, v27
 v_mul_f32 v221, v221, v27
 v_cvt_pk_bf16_f32 v218, v220, v221
 v_mul_f32 v222, v222, v27
 v_mul_f32 v223, v223, v27
 v_cvt_pk_bf16_f32 v219, v222, v223
 buffer_store_dwordx4 v[216:219], v12, s[16:19], s75 offen offset:3072 sc1
 s_branch L_vj_203
L_w1_200:
 s_cmp_eq_u32 s3, 1
 s_cbranch_scc0 L_w2_201
 s_waitcnt lgkmcnt(0)
 v_mfma_f32_16x16x32_bf16 v[80:83], a[16:19], a[192:195], v[44:47]
 v_exp_f32 v18, v78
 v_mfma_f32_16x16x32_bf16 v[80:83], a[20:23], a[196:199], v[80:83]
 v_cvt_pk_bf16_f32 v54, v16, v17
 v_or3_b32 v20, v20, v53, v54
 v_mfma_f32_16x16x32_bf16 v[80:83], a[24:27], a[200:203], v[80:83]
 v_exp_f32 v19, v79
 v_mfma_f32_16x16x32_bf16 v[80:83], a[28:31], a[204:207], v[80:83]
 v_cvt_pk_bf16_f32 v55, v18, v19
 v_or_b32 v20, v20, v55
 v_mfma_f32_16x16x32_bf16 v[84:87], a[44:47], a[204:207], v[44:47]
 v_and_b32 v20, s64, v20
 v_mfma_f32_16x16x32_bf16 v[84:87], a[40:43], a[200:203], v[84:87]
 v_mfma_f32_16x16x32_bf16 v[84:87], a[36:39], a[196:199], v[84:87]
 v_mfma_f32_16x16x32_bf16 v[84:87], a[32:35], a[192:195], v[84:87]
 v_cmp_ne_u32 vcc, 0, v20
 v_mfma_f32_16x16x32_bf16 v[88:91], a[48:51], a[192:195], v[44:47]
 v_exp_f32 v16, v80
 v_mfma_f32_16x16x32_bf16 v[88:91], a[52:55], a[196:199], v[88:91]
 v_exp_f32 v17, v81
 v_mfma_f32_16x16x32_bf16 v[88:91], a[56:59], a[200:203], v[88:91]
 v_exp_f32 v18, v82
 v_mfma_f32_16x16x32_bf16 v[88:91], a[60:63], a[204:207], v[88:91]
 s_cbranch_vccnz L_so_216
L_sb_217:
 v_cvt_pk_bf16_f32 v56, v16, v17
 v_mfma_f32_16x16x32_bf16 v[92:95], a[92:95], a[204:207], v[44:47]
 v_exp_f32 v19, v83
 v_mfma_f32_16x16x32_bf16 v[92:95], a[88:91], a[200:203], v[92:95]
 v_exp_f32 v16, v84
 v_mfma_f32_16x16x32_bf16 v[92:95], a[84:87], a[196:199], v[92:95]
 v_cvt_pk_bf16_f32 v57, v18, v19
 v_exp_f32 v17, v85
 v_mfma_f32_16x16x32_bf16 v[92:95], a[80:83], a[192:195], v[92:95]
 s_waitcnt vmcnt(0)
 s_barrier
 s_sub_u32 s68, s68, 1
 s_cbranch_scc1 L_fo_220
L_fb_221:
 v_mfma_f32_16x16x32_bf16 v[160:163], a[96:99], v[48:51], v[160:163]
 s_add_u32 s48, s77, s58
 v_exp_f32 v18, v86
 v_mfma_f32_16x16x32_bf16 v[160:163], a[144:147], v[52:55], v[160:163]
 s_sub_u32 s49, s48, 32768
 s_and_b32 s49, s49, 0x1ffff
 v_add_u32 v9, s48, v4
 v_mfma_f32_16x16x32_bf16 v[164:167], a[148:151], v[52:55], v[164:167]
 s_add_u32 s44, s42, 12288
 s_and_b32 s44, s44, 0x7fff
 s_add_u32 s44, s44, s43
 v_mfma_f32_16x16x32_bf16 v[164:167], a[100:103], v[48:51], v[164:167]
 s_add_u32 m0, s48, 0
 v_cvt_pk_bf16_f32 v58, v16, v17
 v_or3_b32 v21, v56, v57, v58
 v_mfma_f32_16x16x32_bf16 v[168:171], a[104:107], v[48:51], v[168:171]
 buffer_load_dwordx4 v4, s[8:11], s44 offen offset:0 sc1 lds
 v_mfma_f32_16x16x32_bf16 v[168:171], a[152:155], v[52:55], v[168:171]
 buffer_load_dwordx4 v4, s[8:11], s44 offen offset:1024 sc1 lds
 v_mfma_f32_16x16x32_bf16 v[172:175], a[156:159], v[52:55], v[172:175]
 s_add_u32 m0, s48, 2048
 v_exp_f32 v19, v87
 v_mfma_f32_16x16x32_bf16 v[172:175], a[108:111], v[48:51], v[172:175]
 buffer_load_dwordx4 v5, s[8:11], s44 offen offset:0 sc1 lds
 v_mfma_f32_16x16x32_bf16 v[176:179], a[112:115], v[48:51], v[176:179]
 buffer_load_dwordx4 v5, s[8:11], s44 offen offset:1024 sc1 lds
 v_mfma_f32_16x16x32_bf16 v[176:179], a[160:163], v[52:55], v[176:179]
 s_add_u32 m0, s48, 4096
 v_exp_f32 v16, v88
 v_mfma_f32_16x16x32_bf16 v[180:183], a[164:167], v[52:55], v[180:183]
 buffer_load_dwordx4 v6, s[8:11], s44 offen offset:0 sc1 lds
 v_mfma_f32_16x16x32_bf16 v[180:183], a[116:119], v[48:51], v[180:183]
 buffer_load_dwordx4 v6, s[8:11], s44 offen offset:1024 sc1 lds
 v_mfma_f32_16x16x32_bf16 v[184:187], a[120:123], v[48:51], v[184:187]
 ds_read_b128 a[96:99], v14 offset:0
 v_cvt_pk_bf16_f32 v59, v18, v19
 v_mfma_f32_16x16x32_bf16 v[184:187], a[168:171], v[52:55], v[184:187]
 s_add_u32 m0, s48, 6144
 v_exp_f32 v17, v89
 v_mfma_f32_16x16x32_bf16 v[188:191], a[172:175], v[52:55], v[188:191]
 buffer_load_dwordx4 v7, s[8:11], s44 offen offset:0 sc1 lds
 v_mfma_f32_16x16x32_bf16 v[188:191], a[124:127], v[48:51], v[188:191]
 buffer_load_dwordx4 v7, s[8:11], s44 offen offset:1024 sc1 lds
 v_mfma_f32_16x16x32_bf16 a[184:187], v[22:25], v[48:51], a[184:187]
 ds_read_b128 a[144:147], v14 offset:8192
 v_add_u32 v10, s49, v4
 v_mfma_f32_16x16x32_bf16 a[184:187], v[22:25], v[52:55], a[184:187]
 s_add_u32 s44, s42, 14336
 s_and_b32 s44, s44, 0x7fff
 s_add_u32 s44, s44, s43
 v_mfma_f32_16x16x32_bf16 v[64:67], a[16:19], a[128:131], v[40:43]
 s_add_u32 m0, s49, 0
 v_exp_f32 v18, v90
 v_mfma_f32_16x16x32_bf16 v[64:67], a[20:23], a[132:135], v[64:67]
 buffer_load_dwordx4 v4, s[8:11], s44 offen offset:0 sc1 lds
 v_mfma_f32_16x16x32_bf16 v[64:67], a[24:27], a[136:139], v[64:67]
 buffer_load_dwordx4 v4, s[8:11], s44 offen offset:1024 sc1 lds
 v_mfma_f32_16x16x32_bf16 v[64:67], a[28:31], a[140:143], v[64:67]
 ds_read_b128 a[148:151], v14 offset:9216
 v_cvt_pk_bf16_f32 v60, v16, v17
 v_mov_b32 v3, 4048155338
 v_cndmask_b32 v28, v3, v40, s[80:81]
 v_cndmask_b32 v29, v3, v41, s[82:83]
 v_cndmask_b32 v30, v3, v42, s[84:85]
 v_cndmask_b32 v31, v3, v43, s[86:87]
 s_nop 1
 v_mfma_f32_16x16x32_bf16 v[68:71], a[44:47], a[140:143], v[28:31]
 ds_read_b128 a[100:103], v14 offset:1024
 ds_read_b128 a[104:107], v14 offset:2048
 ds_read_b128 a[152:155], v14 offset:10240
 ds_read_b128 a[156:159], v14 offset:11264
 ds_read_b128 a[108:111], v14 offset:3072
 ds_read_b128 a[112:115], v14 offset:4096
 ds_read_b128 a[160:163], v14 offset:12288
 ds_read_b128 a[164:167], v14 offset:13312
 ds_read_b128 a[116:119], v14 offset:5120
 ds_read_b128 a[120:123], v14 offset:6144
 ds_read_b128 a[168:171], v14 offset:14336
 ds_read_b128 a[172:175], v14 offset:15360
 ds_read_b128 a[124:127], v14 offset:7168
 v_mfma_f32_16x16x32_bf16 v[68:71], a[40:43], a[136:139], v[68:71]
 s_add_u32 m0, s49, 2048
 v_or3_b32 v21, v21, v59, v60
 v_exp_f32 v19, v91
 v_exp_f32 v16, v92
 v_cvt_pk_bf16_f32 v61, v18, v19
 v_exp_f32 v17, v93
 v_exp_f32 v18, v94
 v_cvt_pk_bf16_f32 v62, v16, v17
 v_or3_b32 v21, v21, v61, v62
 v_exp_f32 v19, v95
 s_nop 0
 v_cvt_pk_bf16_f32 v63, v18, v19
 v_or_b32 v21, v21, v63
 v_and_b32 v21, s64, v21
 v_mfma_f32_16x16x32_bf16 v[68:71], a[36:39], a[132:135], v[68:71]
 ds_read_b128 a[16:19], v14 offset:16384
 v_cmp_ne_u32 vcc, 0, v21
 v_mfma_f32_16x16x32_bf16 v[68:71], a[32:35], a[128:131], v[68:71]
 s_waitcnt lgkmcnt(15)
 s_cbranch_vccnz L_so_218
L_sb_219:
 v_mfma_f32_16x16x32_bf16 v[192:195], a[96:99], v[56:59], v[192:195]
 buffer_load_dwordx4 v5, s[8:11], s44 offen offset:0 sc1 lds
 v_mfma_f32_16x16x32_bf16 v[192:195], a[144:147], v[60:63], v[192:195]
 s_waitcnt lgkmcnt(14)
 buffer_load_dwordx4 v5, s[8:11], s44 offen offset:1024 sc1 lds
 v_mfma_f32_16x16x32_bf16 v[196:199], a[148:151], v[60:63], v[196:199]
 s_waitcnt lgkmcnt(13)
 s_add_u32 m0, s49, 4096
 v_mov_b32 v72, 4048155338
 v_mov_b32 v73, 4048155338
 v_mfma_f32_16x16x32_bf16 v[196:199], a[100:103], v[56:59], v[196:199]
 s_waitcnt lgkmcnt(12)
 buffer_load_dwordx4 v6, s[8:11], s44 offen offset:0 sc1 lds
 v_mfma_f32_16x16x32_bf16 v[200:203], a[104:107], v[56:59], v[200:203]
 s_waitcnt lgkmcnt(11)
 buffer_load_dwordx4 v6, s[8:11], s44 offen offset:1024 sc1 lds
 v_mfma_f32_16x16x32_bf16 v[200:203], a[152:155], v[60:63], v[200:203]
 s_waitcnt lgkmcnt(10)
 s_add_u32 m0, s49, 6144
 v_mov_b32 v74, 4048155338
 v_mfma_f32_16x16x32_bf16 v[204:207], a[156:159], v[60:63], v[204:207]
 s_waitcnt lgkmcnt(1)
 buffer_load_dwordx4 v7, s[8:11], s44 offen offset:0 sc1 lds
 v_mfma_f32_16x16x32_bf16 v[204:207], a[108:111], v[56:59], v[204:207]
 buffer_load_dwordx4 v7, s[8:11], s44 offen offset:1024 sc1 lds
 v_mfma_f32_16x16x32_bf16 v[208:211], a[112:115], v[56:59], v[208:211]
 s_add_u32 s44, s42, 10240
 s_and_b32 s44, s44, 0x7fff
 s_add_u32 s44, s44, s43
 v_mfma_f32_16x16x32_bf16 v[208:211], a[160:163], v[60:63], v[208:211]
 s_add_u32 m0, s45, 0
 s_nop 0
 buffer_load_dwordx4 v4, s[8:11], s44 offen offset:0 sc1 lds
 v_mfma_f32_16x16x32_bf16 v[212:215], a[164:167], v[60:63], v[212:215]
 buffer_load_dwordx4 v4, s[8:11], s44 offen offset:1024 sc1 lds
 v_mfma_f32_16x16x32_bf16 v[212:215], a[116:119], v[56:59], v[212:215]
 s_add_u32 s79, s76, s58
 s_add_u32 m0, s45, 2048
 v_mov_b32 v75, 4048155338
 v_mfma_f32_16x16x32_bf16 v[216:219], a[120:123], v[56:59], v[216:219]
 buffer_load_dwordx4 v5, s[8:11], s44 offen offset:0 sc1 lds
 v_mfma_f32_16x16x32_bf16 v[216:219], a[168:171], v[60:63], v[216:219]
 s_add_u32 s76, s76, 32768
 s_and_b32 s76, s76, 0x1ffff
 v_mfma_f32_16x16x32_bf16 v[220:223], a[172:175], v[60:63], v[220:223]
 buffer_load_dwordx4 v5, s[8:11], s44 offen offset:1024 sc1 lds
 v_mfma_f32_16x16x32_bf16 v[220:223], a[124:127], v[56:59], v[220:223]
 ds_read_b128 a[20:23], v14 offset:17408
 v_mov_b32 v76, 4048155338
 v_mov_b32 v77, 4048155338
 v_mfma_f32_16x16x32_bf16 a[188:191], v[22:25], v[56:59], a[188:191]
 ds_read_b128 a[24:27], v14 offset:18432
 s_add_u32 m0, s45, 4096
 ds_read_b128 a[28:31], v14 offset:19456
 ds_read_b128 a[44:47], v14 offset:23552
 ds_read_b128 a[40:43], v14 offset:22528
 ds_read_b128 a[36:39], v14 offset:21504
 ds_read_b128 a[32:35], v14 offset:20480
 ds_read_b128 a[48:51], v14 offset:24576
 ds_read_b128 a[52:55], v14 offset:25600
 ds_read_b128 a[56:59], v14 offset:26624
 ds_read_b128 a[60:63], v14 offset:27648
 ds_read_b128 a[92:95], v14 offset:31744
 ds_read_b128 a[88:91], v14 offset:30720
 ds_read_b128 a[84:87], v14 offset:29696
 ds_read_b128 a[80:83], v14 offset:28672
 v_mfma_f32_16x16x32_bf16 a[188:191], v[22:25], v[60:63], a[188:191]
 s_mov_b32 s77, s79
 buffer_load_dwordx4 v6, s[8:11], s44 offen offset:0 sc1 lds
 buffer_load_dwordx4 v6, s[8:11], s44 offen offset:1024 sc1 lds
 v_add_u32 v14, s76, v12
 v_mov_b32 v78, 4048155338
 v_mov_b32 v79, 4048155338
 v_exp_f32 v16, v64
 v_exp_f32 v17, v65
 v_exp_f32 v18, v66
 v_cvt_pk_bf16_f32 v48, v16, v17
 v_exp_f32 v19, v67
 v_exp_f32 v16, v68
 v_cvt_pk_bf16_f32 v49, v18, v19
 s_add_u32 m0, s45, 6144
 s_nop 0
 buffer_load_dwordx4 v7, s[8:11], s44 offen offset:0 sc1 lds
 buffer_load_dwordx4 v7, s[8:11], s44 offen offset:1024 sc1 lds
 s_add_u32 s44, s42, 0
 s_and_b32 s44, s44, 0x7fff
 s_add_u32 s44, s44, s43
 buffer_load_dwordx4 a[208:211], v4, s[8:11], s44 offen offset:0 sc1
 buffer_load_dwordx4 a[212:215], v5, s[8:11], s44 offen offset:0 sc1
 buffer_load_dwordx4 a[216:219], v6, s[8:11], s44 offen offset:0 sc1
 buffer_load_dwordx4 a[220:223], v7, s[8:11], s44 offen offset:0 sc1
 buffer_load_dwordx4 a[224:227], v4, s[8:11], s44 offen offset:1024 sc1
 buffer_load_dwordx4 a[228:231], v5, s[8:11], s44 offen offset:1024 sc1
 buffer_load_dwordx4 a[232:235], v6, s[8:11], s44 offen offset:1024 sc1
 buffer_load_dwordx4 a[236:239], v7, s[8:11], s44 offen offset:1024 sc1
 s_add_u32 s44, s42, 2048
 s_and_b32 s44, s44, 0x7fff
 s_add_u32 s44, s44, s43
 buffer_load_dwordx4 a[240:243], v4, s[8:11], s44 offen offset:0 sc1
 buffer_load_dwordx4 a[244:247], v5, s[8:11], s44 offen offset:0 sc1
 buffer_load_dwordx4 a[248:251], v6, s[8:11], s44 offen offset:0 sc1
 buffer_load_dwordx4 a[252:255], v7, s[8:11], s44 offen offset:0 sc1
 buffer_load_dwordx4 a[0:3], v4, s[8:11], s44 offen offset:1024 sc1
 s_waitcnt lgkmcnt(15)
 v_mfma_f32_16x16x32_bf16 v[80:83], a[16:19], a[192:195], v[44:47]
 s_waitcnt lgkmcnt(14)
 buffer_load_dwordx4 a[4:7], v5, s[8:11], s44 offen offset:1024 sc1
 v_mfma_f32_16x16x32_bf16 v[80:83], a[20:23], a[196:199], v[80:83]
 s_waitcnt lgkmcnt(13)
 v_exp_f32 v17, v69
 v_mfma_f32_16x16x32_bf16 v[80:83], a[24:27], a[200:203], v[80:83]
 s_waitcnt lgkmcnt(12)
 v_exp_f32 v18, v70
 v_mfma_f32_16x16x32_bf16 v[80:83], a[28:31], a[204:207], v[80:83]
 s_waitcnt lgkmcnt(11)
 v_cvt_pk_bf16_f32 v50, v16, v17
 v_or3_b32 v20, v48, v49, v50
 v_mfma_f32_16x16x32_bf16 v[84:87], a[44:47], a[204:207], v[44:47]
 s_waitcnt lgkmcnt(10)
 buffer_load_dwordx4 a[8:11], v6, s[8:11], s44 offen offset:1024 sc1
 v_mfma_f32_16x16x32_bf16 v[84:87], a[40:43], a[200:203], v[84:87]
 s_waitcnt lgkmcnt(9)
 v_exp_f32 v19, v71
 v_mfma_f32_16x16x32_bf16 v[84:87], a[36:39], a[196:199], v[84:87]
 s_waitcnt lgkmcnt(8)
 v_cvt_pk_bf16_f32 v51, v18, v19
 v_or_b32 v20, v20, v51
 v_mfma_f32_16x16x32_bf16 v[84:87], a[32:35], a[192:195], v[84:87]
 s_waitcnt lgkmcnt(7)
 v_and_b32 v20, s64, v20
 v_cmp_ne_u32 vcc, 0, v20
 v_mov_b32 v3, 4048155338
 v_cndmask_b32 v28, v3, v44, s[80:81]
 v_cndmask_b32 v29, v3, v45, s[82:83]
 v_cndmask_b32 v30, v3, v46, s[84:85]
 v_cndmask_b32 v31, v3, v47, s[86:87]
 s_nop 1
 v_mfma_f32_16x16x32_bf16 v[88:91], a[48:51], a[192:195], v[28:31]
 s_waitcnt lgkmcnt(0)
 buffer_load_dwordx4 a[12:15], v7, s[8:11], s44 offen offset:1024 sc1
 v_mfma_f32_16x16x32_bf16 v[88:91], a[52:55], a[196:199], v[88:91]
 s_add_u32 s44, s42, 4096
 s_and_b32 s44, s44, 0x7fff
 s_add_u32 s44, s44, s43
 v_mfma_f32_16x16x32_bf16 v[88:91], a[56:59], a[200:203], v[88:91]
 buffer_load_dwordx4 v[96:99], v4, s[8:11], s44 offen offset:0 sc1
 v_mfma_f32_16x16x32_bf16 v[88:91], a[60:63], a[204:207], v[88:91]
 s_cbranch_vccnz L_so_222
L_sb_223:
 s_barrier
 s_sub_u32 s68, s68, 1
 s_cbranch_scc1 L_fo_224
L_fb_225:
 v_mfma_f32_16x16x32_bf16 v[160:163], a[96:99], v[48:51], v[160:163]
 buffer_load_dwordx4 v[100:103], v5, s[8:11], s44 offen offset:0 sc1
 v_mfma_f32_16x16x32_bf16 v[164:167], a[100:103], v[48:51], v[164:167]
 buffer_load_dwordx4 v[104:107], v6, s[8:11], s44 offen offset:0 sc1
 v_mfma_f32_16x16x32_bf16 v[168:171], a[104:107], v[48:51], v[168:171]
 buffer_load_dwordx4 v[108:111], v7, s[8:11], s44 offen offset:0 sc1
 v_mfma_f32_16x16x32_bf16 v[172:175], a[108:111], v[48:51], v[172:175]
 buffer_load_dwordx4 v[112:115], v4, s[8:11], s44 offen offset:1024 sc1
 v_mfma_f32_16x16x32_bf16 v[176:179], a[112:115], v[48:51], v[176:179]
 buffer_load_dwordx4 v[116:119], v5, s[8:11], s44 offen offset:1024 sc1
 v_mfma_f32_16x16x32_bf16 v[180:183], a[116:119], v[48:51], v[180:183]
 buffer_load_dwordx4 v[120:123], v6, s[8:11], s44 offen offset:1024 sc1
 v_mfma_f32_16x16x32_bf16 v[184:187], a[120:123], v[48:51], v[184:187]
 ds_read_b128 a[96:99], v14 offset:0
 v_mov_b32 v92, 4048155338
 v_mfma_f32_16x16x32_bf16 v[188:191], a[124:127], v[48:51], v[188:191]
 ds_read_b128 a[144:147], v14 offset:8192
 v_mov_b32 v93, 4048155338
 v_mfma_f32_16x16x32_bf16 a[184:187], v[22:25], v[48:51], a[184:187]
 ds_read_b128 a[148:151], v14 offset:9216
 buffer_load_dwordx4 v[124:127], v7, s[8:11], s44 offen offset:1024 sc1
 ds_read_b128 a[100:103], v14 offset:1024
 s_add_u32 s44, s42, 6144
 s_and_b32 s44, s44, 0x7fff
 s_add_u32 s44, s44, s43
 ds_read_b128 a[104:107], v14 offset:2048
 v_mov_b32 v94, 4048155338
 v_mov_b32 v95, 4048155338
 v_mov_b32 v62, 0
 v_mov_b32 v63, 0
 v_exp_f32 v16, v80
 v_exp_f32 v17, v81
 v_exp_f32 v18, v82
 v_cvt_pk_bf16_f32 v56, v16, v17
 v_exp_f32 v19, v83
 v_exp_f32 v16, v84
 v_cvt_pk_bf16_f32 v57, v18, v19
 v_exp_f32 v17, v85
 v_exp_f32 v18, v86
 v_cvt_pk_bf16_f32 v58, v16, v17
 v_or3_b32 v21, v56, v57, v58
 v_exp_f32 v19, v87
 v_exp_f32 v16, v88
 v_cvt_pk_bf16_f32 v59, v18, v19
 v_exp_f32 v17, v89
 v_exp_f32 v18, v90
 v_cvt_pk_bf16_f32 v60, v16, v17
 v_or3_b32 v21, v21, v59, v60
 v_exp_f32 v19, v91
 s_nop 0
 v_cvt_pk_bf16_f32 v61, v18, v19
 v_or_b32 v21, v21, v61
 v_and_b32 v21, s64, v21
 ds_read_b128 a[152:155], v14 offset:10240
 ds_read_b128 a[156:159], v14 offset:11264
 ds_read_b128 a[108:111], v14 offset:3072
 ds_read_b128 a[112:115], v14 offset:4096
 ds_read_b128 a[160:163], v14 offset:12288
 ds_read_b128 a[164:167], v14 offset:13312
 ds_read_b128 a[116:119], v14 offset:5120
 ds_read_b128 a[120:123], v14 offset:6144
 ds_read_b128 a[168:171], v14 offset:14336
 ds_read_b128 a[172:175], v14 offset:15360
 ds_read_b128 a[124:127], v14 offset:7168
 buffer_load_dwordx4 v[128:131], v4, s[8:11], s44 offen offset:0 sc1
 buffer_load_dwordx4 v[132:135], v5, s[8:11], s44 offen offset:0 sc1
 buffer_load_dwordx4 v[136:139], v6, s[8:11], s44 offen offset:0 sc1
 buffer_load_dwordx4 v[140:143], v7, s[8:11], s44 offen offset:0 sc1
 buffer_load_dwordx4 v[144:147], v4, s[8:11], s44 offen offset:1024 sc1
 buffer_load_dwordx4 v[148:151], v5, s[8:11], s44 offen offset:1024 sc1
 buffer_load_dwordx4 v[152:155], v6, s[8:11], s44 offen offset:1024 sc1
 buffer_load_dwordx4 v[156:159], v7, s[8:11], s44 offen offset:1024 sc1
 s_add_u32 s44, s42, 8192
 s_and_b32 s44, s44, 0x7fff
 s_add_u32 s44, s44, s43
 buffer_load_dwordx4 a[64:67], v4, s[8:11], s44 offen offset:0 sc1
 buffer_load_dwordx4 a[68:71], v5, s[8:11], s44 offen offset:0 sc1
 buffer_load_dwordx4 a[72:75], v6, s[8:11], s44 offen offset:0 sc1
 buffer_load_dwordx4 a[76:79], v7, s[8:11], s44 offen offset:0 sc1
 buffer_load_dwordx4 a[176:179], v4, s[8:11], s44 offen offset:1024 sc1
 buffer_load_dwordx4 a[180:183], v5, s[8:11], s44 offen offset:1024 sc1
 buffer_load_dwordx4 v[32:35], v6, s[8:11], s44 offen offset:1024 sc1
 buffer_load_dwordx4 v[36:39], v7, s[8:11], s44 offen offset:1024 sc1
 v_cmp_ne_u32 vcc, 0, v21
 v_accvgpr_read_b32 v26, a184
 v_rcp_f32 v26, v26
 s_nop 0
 v_mul_f32 v26, 0x1f800000, v26
 s_nop 0
 s_cbranch_vccnz L_so_226
L_sb_227:
 s_waitcnt lgkmcnt(15)
 v_mfma_f32_16x16x32_bf16 v[192:195], a[96:99], v[56:59], v[192:195]
 s_waitcnt lgkmcnt(14)
 v_mul_f32 v160, v160, v26
 v_mul_f32 v161, v161, v26
 v_mfma_f32_16x16x32_bf16 v[192:195], a[144:147], v[60:63], v[192:195]
 s_waitcnt lgkmcnt(13)
 v_cvt_pk_bf16_f32 v160, v160, v161
 v_mfma_f32_16x16x32_bf16 v[196:199], a[148:151], v[60:63], v[196:199]
 s_waitcnt lgkmcnt(12)
 v_mul_f32 v162, v162, v26
 v_mul_f32 v163, v163, v26
 v_mfma_f32_16x16x32_bf16 v[196:199], a[100:103], v[56:59], v[196:199]
 s_waitcnt lgkmcnt(11)
 v_cvt_pk_bf16_f32 v161, v162, v163
 v_mfma_f32_16x16x32_bf16 v[200:203], a[104:107], v[56:59], v[200:203]
 s_waitcnt lgkmcnt(10)
 v_mul_f32 v164, v164, v26
 v_mul_f32 v165, v165, v26
 v_mfma_f32_16x16x32_bf16 v[200:203], a[152:155], v[60:63], v[200:203]
 s_waitcnt lgkmcnt(9)
 v_cvt_pk_bf16_f32 v162, v164, v165
 v_mfma_f32_16x16x32_bf16 v[204:207], a[156:159], v[60:63], v[204:207]
 s_waitcnt lgkmcnt(8)
 v_mul_f32 v166, v166, v26
 v_mul_f32 v167, v167, v26
 v_mfma_f32_16x16x32_bf16 v[204:207], a[108:111], v[56:59], v[204:207]
 s_waitcnt lgkmcnt(7)
 v_mfma_f32_16x16x32_bf16 v[208:211], a[112:115], v[56:59], v[208:211]
 s_waitcnt lgkmcnt(6)
 v_mfma_f32_16x16x32_bf16 v[208:211], a[160:163], v[60:63], v[208:211]
 s_waitcnt lgkmcnt(0)
 v_cvt_pk_bf16_f32 v163, v166, v167
 v_mfma_f32_16x16x32_bf16 v[212:215], a[164:167], v[60:63], v[212:215]
 v_mfma_f32_16x16x32_bf16 v[212:215], a[116:119], v[56:59], v[212:215]
 v_mfma_f32_16x16x32_bf16 v[216:219], a[120:123], v[56:59], v[216:219]
 v_mfma_f32_16x16x32_bf16 v[216:219], a[168:171], v[60:63], v[216:219]
 v_mfma_f32_16x16x32_bf16 v[220:223], a[172:175], v[60:63], v[220:223]
 v_mfma_f32_16x16x32_bf16 v[220:223], a[124:127], v[56:59], v[220:223]
 v_mfma_f32_16x16x32_bf16 a[188:191], v[22:25], v[56:59], a[188:191]
 v_mfma_f32_16x16x32_bf16 a[188:191], v[22:25], v[60:63], a[188:191]
 buffer_store_dwordx4 v[160:163], v12, s[16:19], s74 offen offset:0 sc1
 v_mul_f32 v168, v168, v26
 v_mul_f32 v169, v169, v26
 v_cvt_pk_bf16_f32 v168, v168, v169
 v_mul_f32 v170, v170, v26
 v_mul_f32 v171, v171, v26
 v_cvt_pk_bf16_f32 v169, v170, v171
 v_mul_f32 v172, v172, v26
 v_mul_f32 v173, v173, v26
 v_cvt_pk_bf16_f32 v170, v172, v173
 v_mul_f32 v174, v174, v26
 v_mul_f32 v175, v175, v26
 v_cvt_pk_bf16_f32 v171, v174, v175
 buffer_store_dwordx4 v[168:171], v12, s[16:19], s74 offen offset:1024 sc1
 v_mul_f32 v176, v176, v26
 v_mul_f32 v177, v177, v26
 v_cvt_pk_bf16_f32 v176, v176, v177
 v_mul_f32 v178, v178, v26
 v_mul_f32 v179, v179, v26
 v_cvt_pk_bf16_f32 v177, v178, v179
 v_mul_f32 v180, v180, v26
 v_mul_f32 v181, v181, v26
 v_cvt_pk_bf16_f32 v178, v180, v181
 v_mul_f32 v182, v182, v26
 v_mul_f32 v183, v183, v26
 v_cvt_pk_bf16_f32 v179, v182, v183
 buffer_store_dwordx4 v[176:179], v12, s[16:19], s74 offen offset:2048 sc1
 v_mul_f32 v184, v184, v26
 v_mul_f32 v185, v185, v26
 v_cvt_pk_bf16_f32 v184, v184, v185
 v_mul_f32 v186, v186, v26
 v_mul_f32 v187, v187, v26
 v_cvt_pk_bf16_f32 v185, v186, v187
 v_mul_f32 v188, v188, v26
 v_mul_f32 v189, v189, v26
 v_cvt_pk_bf16_f32 v186, v188, v189
 v_mul_f32 v190, v190, v26
 v_mul_f32 v191, v191, v26
 v_cvt_pk_bf16_f32 v187, v190, v191
 buffer_store_dwordx4 v[184:187], v12, s[16:19], s74 offen offset:3072 sc1
 v_accvgpr_read_b32 v27, a188
 v_rcp_f32 v27, v27
 s_nop 0
 v_mul_f32 v27, 0x1f800000, v27
 v_mul_f32 v192, v192, v27
 v_mul_f32 v193, v193, v27
 v_cvt_pk_bf16_f32 v192, v192, v193
 v_mul_f32 v194, v194, v27
 v_mul_f32 v195, v195, v27
 v_cvt_pk_bf16_f32 v193, v194, v195
 v_mul_f32 v196, v196, v27
 v_mul_f32 v197, v197, v27
 v_cvt_pk_bf16_f32 v194, v196, v197
 v_mul_f32 v198, v198, v27
 v_mul_f32 v199, v199, v27
 v_cvt_pk_bf16_f32 v195, v198, v199
 buffer_store_dwordx4 v[192:195], v12, s[16:19], s75 offen offset:0 sc1
 v_mul_f32 v200, v200, v27
 v_mul_f32 v201, v201, v27
 v_cvt_pk_bf16_f32 v200, v200, v201
 v_mul_f32 v202, v202, v27
 v_mul_f32 v203, v203, v27
 v_cvt_pk_bf16_f32 v201, v202, v203
 v_mul_f32 v204, v204, v27
 v_mul_f32 v205, v205, v27
 v_cvt_pk_bf16_f32 v202, v204, v205
 v_mul_f32 v206, v206, v27
 v_mul_f32 v207, v207, v27
 v_cvt_pk_bf16_f32 v203, v206, v207
 buffer_store_dwordx4 v[200:203], v12, s[16:19], s75 offen offset:1024 sc1
 v_mul_f32 v208, v208, v27
 v_mul_f32 v209, v209, v27
 v_cvt_pk_bf16_f32 v208, v208, v209
 v_mul_f32 v210, v210, v27
 v_mul_f32 v211, v211, v27
 v_cvt_pk_bf16_f32 v209, v210, v211
 v_mul_f32 v212, v212, v27
 v_mul_f32 v213, v213, v27
 v_cvt_pk_bf16_f32 v210, v212, v213
 v_mul_f32 v214, v214, v27
 v_mul_f32 v215, v215, v27
 v_cvt_pk_bf16_f32 v211, v214, v215
 buffer_store_dwordx4 v[208:211], v12, s[16:19], s75 offen offset:2048 sc1
 v_mul_f32 v216, v216, v27
 v_mul_f32 v217, v217, v27
 v_cvt_pk_bf16_f32 v216, v216, v217
 v_mul_f32 v218, v218, v27
 v_mul_f32 v219, v219, v27
 v_cvt_pk_bf16_f32 v217, v218, v219
 v_mul_f32 v220, v220, v27
 v_mul_f32 v221, v221, v27
 v_cvt_pk_bf16_f32 v218, v220, v221
 v_mul_f32 v222, v222, v27
 v_mul_f32 v223, v223, v27
 v_cvt_pk_bf16_f32 v219, v222, v223
 buffer_store_dwordx4 v[216:219], v12, s[16:19], s75 offen offset:3072 sc1
 s_branch L_vj_203
L_w2_201:
 s_cmp_eq_u32 s3, 2
 s_cbranch_scc0 L_w3_202
 s_waitcnt lgkmcnt(0)
 v_mfma_f32_16x16x32_bf16 v[80:83], a[16:19], a[192:195], v[44:47]
 v_exp_f32 v18, v78
 v_mfma_f32_16x16x32_bf16 v[80:83], a[20:23], a[196:199], v[80:83]
 v_cvt_pk_bf16_f32 v54, v16, v17
 v_or3_b32 v20, v20, v53, v54
 v_mfma_f32_16x16x32_bf16 v[80:83], a[24:27], a[200:203], v[80:83]
 v_exp_f32 v19, v79
 v_mfma_f32_16x16x32_bf16 v[80:83], a[28:31], a[204:207], v[80:83]
 v_cvt_pk_bf16_f32 v55, v18, v19
 v_or_b32 v20, v20, v55
 v_mfma_f32_16x16x32_bf16 v[84:87], a[44:47], a[204:207], v[44:47]
 v_and_b32 v20, s64, v20
 v_mfma_f32_16x16x32_bf16 v[84:87], a[40:43], a[200:203], v[84:87]
 v_mfma_f32_16x16x32_bf16 v[84:87], a[36:39], a[196:199], v[84:87]
 v_mfma_f32_16x16x32_bf16 v[84:87], a[32:35], a[192:195], v[84:87]
 v_cmp_ne_u32 vcc, 0, v20
 v_mfma_f32_16x16x32_bf16 v[88:91], a[48:51], a[192:195], v[44:47]
 v_exp_f32 v16, v80
 v_mfma_f32_16x16x32_bf16 v[88:91], a[52:55], a[196:199], v[88:91]
 s_cbranch_vccnz L_so_228
L_sb_229:
 v_exp_f32 v17, v81
 v_mfma_f32_16x16x32_bf16 v[88:91], a[56:59], a[200:203], v[88:91]
 v_exp_f32 v18, v82
 v_mfma_f32_16x16x32_bf16 v[88:91], a[60:63], a[204:207], v[88:91]
 v_cvt_pk_bf16_f32 v56, v16, v17
 v_exp_f32 v19, v83
 v_mfma_f32_16x16x32_bf16 v[92:95], a[92:95], a[204:207], v[44:47]
 v_exp_f32 v16, v84
 v_mfma_f32_16x16x32_bf16 v[92:95], a[88:91], a[200:203], v[92:95]
 v_cvt_pk_bf16_f32 v57, v18, v19
 v_exp_f32 v17, v85
 v_mfma_f32_16x16x32_bf16 v[92:95], a[84:87], a[196:199], v[92:95]
 v_exp_f32 v18, v86
 v_mfma_f32_16x16x32_bf16 v[92:95], a[80:83], a[192:195], v[92:95]
 s_waitcnt vmcnt(0)
 s_barrier
 s_sub_u32 s68, s68, 1
 s_cbranch_scc1 L_fo_232
L_fb_233:
 v_mfma_f32_16x16x32_bf16 v[160:163], a[96:99], v[48:51], v[160:163]
 s_add_u32 s48, s77, s58
 v_cvt_pk_bf16_f32 v58, v16, v17
 v_or3_b32 v21, v56, v57, v58
 v_mfma_f32_16x16x32_bf16 v[160:163], a[144:147], v[52:55], v[160:163]
 s_sub_u32 s49, s48, 32768
 s_and_b32 s49, s49, 0x1ffff
 v_add_u32 v9, s48, v4
 v_mfma_f32_16x16x32_bf16 v[164:167], a[148:151], v[52:55], v[164:167]
 s_add_u32 s44, s42, 12288
 s_and_b32 s44, s44, 0x7fff
 s_add_u32 s44, s44, s43
 v_mfma_f32_16x16x32_bf16 v[164:167], a[100:103], v[48:51], v[164:167]
 s_add_u32 m0, s48, 0
 v_exp_f32 v19, v87
 v_mfma_f32_16x16x32_bf16 v[168:171], a[104:107], v[48:51], v[168:171]
 buffer_load_dwordx4 v4, s[8:11], s44 offen offset:0 sc1 lds
 v_mfma_f32_16x16x32_bf16 v[168:171], a[152:155], v[52:55], v[168:171]
 buffer_load_dwordx4 v4, s[8:11], s44 offen offset:1024 sc1 lds
 v_mfma_f32_16x16x32_bf16 v[172:175], a[156:159], v[52:55], v[172:175]
 s_add_u32 m0, s48, 2048
 v_exp_f32 v16, v88
 v_mfma_f32_16x16x32_bf16 v[172:175], a[108:111], v[48:51], v[172:175]
 buffer_load_dwordx4 v5, s[8:11], s44 offen offset:0 sc1 lds
 v_mfma_f32_16x16x32_bf16 v[176:179], a[112:115], v[48:51], v[176:179]
 buffer_load_dwordx4 v5, s[8:11], s44 offen offset:1024 sc1 lds
 v_mfma_f32_16x16x32_bf16 v[176:179], a[160:163], v[52:55], v[176:179]
 ds_read_b128 a[96:99], v14 offset:0
 v_cvt_pk_bf16_f32 v59, v18, v19
 v_mfma_f32_16x16x32_bf16 v[180:183], a[164:167], v[52:55], v[180:183]
 s_add_u32 m0, s48, 4096
 v_exp_f32 v17, v89
 v_mfma_f32_16x16x32_bf16 v[180:183], a[116:119], v[48:51], v[180:183]
 buffer_load_dwordx4 v6, s[8:11], s44 offen offset:0 sc1 lds
 v_mfma_f32_16x16x32_bf16 v[184:187], a[120:123], v[48:51], v[184:187]
 buffer_load_dwordx4 v6, s[8:11], s44 offen offset:1024 sc1 lds
 v_mfma_f32_16x16x32_bf16 v[184:187], a[168:171], v[52:55], v[184:187]
 s_add_u32 m0, s48, 6144
 v_exp_f32 v18, v90
 v_mfma_f32_16x16x32_bf16 v[188:191], a[172:175], v[52:55], v[188:191]
 buffer_load_dwordx4 v7, s[8:11], s44 offen offset:0 sc1 lds
 v_mfma_f32_16x16x32_bf16 v[188:191], a[124:127], v[48:51], v[188:191]
 buffer_load_dwordx4 v7, s[8:11], s44 offen offset:1024 sc1 lds
 v_mfma_f32_16x16x32_bf16 a[184:187], v[22:25], v[48:51], a[184:187]
 ds_read_b128 a[144:147], v14 offset:8192
 v_add_u32 v10, s49, v4
 v_mfma_f32_16x16x32_bf16 a[184:187], v[22:25], v[52:55], a[184:187]
 s_add_u32 s44, s42, 14336
 s_and_b32 s44, s44, 0x7fff
 s_add_u32 s44, s44, s43
 v_mfma_f32_16x16x32_bf16 v[64:67], a[16:19], a[128:131], v[40:43]
 s_add_u32 m0, s49, 0
 v_cvt_pk_bf16_f32 v60, v16, v17
 v_or3_b32 v21, v21, v59, v60
 v_mfma_f32_16x16x32_bf16 v[64:67], a[20:23], a[132:135], v[64:67]
 buffer_load_dwordx4 v4, s[8:11], s44 offen offset:0 sc1 lds
 v_mfma_f32_16x16x32_bf16 v[64:67], a[24:27], a[136:139], v[64:67]
 buffer_load_dwordx4 v4, s[8:11], s44 offen offset:1024 sc1 lds
 v_mfma_f32_16x16x32_bf16 v[64:67], a[28:31], a[140:143], v[64:67]
 s_add_u32 m0, s49, 2048
 v_exp_f32 v19, v91
 v_mfma_f32_16x16x32_bf16 v[68:71], a[44:47], a[140:143], v[40:43]
 buffer_load_dwordx4 v5, s[8:11], s44 offen offset:0 sc1 lds
 v_mfma_f32_16x16x32_bf16 v[68:71], a[40:43], a[136:139], v[68:71]
 buffer_load_dwordx4 v5, s[8:11], s44 offen offset:1024 sc1 lds
 v_mfma_f32_16x16x32_bf16 v[68:71], a[36:39], a[132:135], v[68:71]
 s_add_u32 m0, s49, 4096
 v_exp_f32 v16, v92
 v_mfma_f32_16x16x32_bf16 v[68:71], a[32:35], a[128:131], v[68:71]
 ds_read_b128 a[148:151], v14 offset:9216
 v_cvt_pk_bf16_f32 v61, v18, v19
 v_exp_f32 v17, v93
 v_exp_f32 v18, v94
 v_cvt_pk_bf16_f32 v62, v16, v17
 v_or3_b32 v21, v21, v61, v62
 v_exp_f32 v19, v95
 s_nop 0
 v_cvt_pk_bf16_f32 v63, v18, v19
 v_or_b32 v21, v21, v63
 v_and_b32 v21, s64, v21
 v_mov_b32 v3, 4048155338
 v_cndmask_b32 v28, v3, v40, s[80:81]
 v_cndmask_b32 v29, v3, v41, s[82:83]
 v_cndmask_b32 v30, v3, v42, s[84:85]
 v_cndmask_b32 v31, v3, v43, s[86:87]
 s_nop 1
 v_mfma_f32_16x16x32_bf16 v[72:75], a[48:51], a[128:131], v[28:31]
 ds_read_b128 a[100:103], v14 offset:1024
 ds_read_b128 a[104:107], v14 offset:2048
 ds_read_b128 a[152:155], v14 offset:10240
 ds_read_b128 a[156:159], v14 offset:11264
 ds_read_b128 a[108:111], v14 offset:3072
 v_cmp_ne_u32 vcc, 0, v21
 ds_read_b128 a[112:115], v14 offset:4096
 ds_read_b128 a[160:163], v14 offset:12288
 ds_read_b128 a[164:167], v14 offset:13312
 ds_read_b128 a[116:119], v14 offset:5120
 ds_read_b128 a[120:123], v14 offset:6144
 ds_read_b128 a[168:171], v14 offset:14336
 ds_read_b128 a[172:175], v14 offset:15360
 ds_read_b128 a[124:127], v14 offset:7168
 v_mfma_f32_16x16x32_bf16 v[72:75], a[52:55], a[132:135], v[72:75]
 buffer_load_dwordx4 v6, s[8:11], s44 offen offset:0 sc1 lds
 v_mfma_f32_16x16x32_bf16 v[72:75], a[56:59], a[136:139], v[72:75]
 s_cbranch_vccnz L_so_230
L_sb_231:
 v_mov_b32 v76, 4048155338
 v_mov_b32 v77, 4048155338
 v_mfma_f32_16x16x32_bf16 v[72:75], a[60:63], a[140:143], v[72:75]
 s_waitcnt lgkmcnt(14)
 v_mov_b32 v78, 4048155338
 v_mov_b32 v79, 4048155338
 v_mfma_f32_16x16x32_bf16 v[192:195], a[96:99], v[56:59], v[192:195]
 buffer_load_dwordx4 v6, s[8:11], s44 offen offset:1024 sc1 lds
 v_mfma_f32_16x16x32_bf16 v[192:195], a[144:147], v[60:63], v[192:195]
 s_waitcnt lgkmcnt(13)
 s_add_u32 m0, s49, 6144
 v_mov_b32 v54, 0
 v_mov_b32 v55, 0
 v_mfma_f32_16x16x32_bf16 v[196:199], a[148:151], v[60:63], v[196:199]
 s_waitcnt lgkmcnt(12)
 buffer_load_dwordx4 v7, s[8:11], s44 offen offset:0 sc1 lds
 v_mfma_f32_16x16x32_bf16 v[196:199], a[100:103], v[56:59], v[196:199]
 s_waitcnt lgkmcnt(11)
 buffer_load_dwordx4 v7, s[8:11], s44 offen offset:1024 sc1 lds
 v_mfma_f32_16x16x32_bf16 v[200:203], a[104:107], v[56:59], v[200:203]
 s_waitcnt lgkmcnt(10)
 s_add_u32 s44, s42, 10240
 s_and_b32 s44, s44, 0x7fff
 s_add_u32 s44, s44, s43
 v_mfma_f32_16x16x32_bf16 v[200:203], a[152:155], v[60:63], v[200:203]
 s_waitcnt lgkmcnt(9)
 s_add_u32 m0, s45, 0
 v_exp_f32 v16, v64
 v_mfma_f32_16x16x32_bf16 v[204:207], a[156:159], v[60:63], v[204:207]
 s_waitcnt lgkmcnt(0)
 buffer_load_dwordx4 v4, s[8:11], s44 offen offset:0 sc1 lds
 v_mfma_f32_16x16x32_bf16 v[204:207], a[108:111], v[56:59], v[204:207]
 buffer_load_dwordx4 v4, s[8:11], s44 offen offset:1024 sc1 lds
 v_mfma_f32_16x16x32_bf16 v[208:211], a[112:115], v[56:59], v[208:211]
 s_add_u32 m0, s45, 2048
 v_exp_f32 v17, v65
 v_mfma_f32_16x16x32_bf16 v[208:211], a[160:163], v[60:63], v[208:211]
 buffer_load_dwordx4 v5, s[8:11], s44 offen offset:0 sc1 lds
 v_mfma_f32_16x16x32_bf16 v[212:215], a[164:167], v[60:63], v[212:215]
 v_exp_f32 v18, v66
 v_mfma_f32_16x16x32_bf16 v[212:215], a[116:119], v[56:59], v[212:215]
 buffer_load_dwordx4 v5, s[8:11], s44 offen offset:1024 sc1 lds
 v_mfma_f32_16x16x32_bf16 v[216:219], a[120:123], v[56:59], v[216:219]
 s_add_u32 s79, s76, s58
 s_add_u32 s76, s76, 32768
 v_cvt_pk_bf16_f32 v48, v16, v17
 v_mfma_f32_16x16x32_bf16 v[216:219], a[168:171], v[60:63], v[216:219]
 s_and_b32 s76, s76, 0x1ffff
 ds_read_b128 a[16:19], v14 offset:16384
 v_mfma_f32_16x16x32_bf16 v[220:223], a[172:175], v[60:63], v[220:223]
 s_add_u32 m0, s45, 4096
 s_nop 0
 buffer_load_dwordx4 v6, s[8:11], s44 offen offset:0 sc1 lds
 v_mfma_f32_16x16x32_bf16 v[220:223], a[124:127], v[56:59], v[220:223]
 buffer_load_dwordx4 v6, s[8:11], s44 offen offset:1024 sc1 lds
 v_mfma_f32_16x16x32_bf16 a[188:191], v[22:25], v[56:59], a[188:191]
 ds_read_b128 a[20:23], v14 offset:17408
 s_add_u32 m0, s45, 6144
 ds_read_b128 a[24:27], v14 offset:18432
 ds_read_b128 a[28:31], v14 offset:19456
 ds_read_b128 a[44:47], v14 offset:23552
 ds_read_b128 a[40:43], v14 offset:22528
 ds_read_b128 a[36:39], v14 offset:21504
 ds_read_b128 a[32:35], v14 offset:20480
 ds_read_b128 a[48:51], v14 offset:24576
 ds_read_b128 a[52:55], v14 offset:25600
 ds_read_b128 a[56:59], v14 offset:26624
 ds_read_b128 a[60:63], v14 offset:27648
 ds_read_b128 a[92:95], v14 offset:31744
 ds_read_b128 a[88:91], v14 offset:30720
 ds_read_b128 a[84:87], v14 offset:29696
 ds_read_b128 a[80:83], v14 offset:28672
 v_mfma_f32_16x16x32_bf16 a[188:191], v[22:25], v[60:63], a[188:191]
 s_mov_b32 s77, s79
 buffer_load_dwordx4 v7, s[8:11], s44 offen offset:0 sc1 lds
 buffer_load_dwordx4 v7, s[8:11], s44 offen offset:1024 sc1 lds
 v_add_u32 v14, s76, v12
 v_exp_f32 v19, v67
 v_exp_f32 v16, v68
 v_cvt_pk_bf16_f32 v49, v18, v19
 v_exp_f32 v17, v69
 v_exp_f32 v18, v70
 v_cvt_pk_bf16_f32 v50, v16, v17
 v_or3_b32 v20, v48, v49, v50
 v_exp_f32 v19, v71
 v_exp_f32 v16, v72
 v_cvt_pk_bf16_f32 v51, v18, v19
 s_add_u32 s44, s42, 0
 s_and_b32 s44, s44, 0x7fff
 s_add_u32 s44, s44, s43
 buffer_load_dwordx4 a[208:211], v4, s[8:11], s44 offen offset:0 sc1
 buffer_load_dwordx4 a[212:215], v5, s[8:11], s44 offen offset:0 sc1
 buffer_load_dwordx4 a[216:219], v6, s[8:11], s44 offen offset:0 sc1
 buffer_load_dwordx4 a[220:223], v7, s[8:11], s44 offen offset:0 sc1
 buffer_load_dwordx4 a[224:227], v4, s[8:11], s44 offen offset:1024 sc1
 buffer_load_dwordx4 a[228:231], v5, s[8:11], s44 offen offset:1024 sc1
 buffer_load_dwordx4 a[232:235], v6, s[8:11], s44 offen offset:1024 sc1
 buffer_load_dwordx4 a[236:239], v7, s[8:11], s44 offen offset:1024 sc1
 s_add_u32 s44, s42, 2048
 s_and_b32 s44, s44, 0x7fff
 s_add_u32 s44, s44, s43
 buffer_load_dwordx4 a[240:243], v4, s[8:11], s44 offen offset:0 sc1
 buffer_load_dwordx4 a[244:247], v5, s[8:11], s44 offen offset:0 sc1
 buffer_load_dwordx4 a[248:251], v6, s[8:11], s44 offen offset:0 sc1
 buffer_load_dwordx4 a[252:255], v7, s[8:11], s44 offen offset:0 sc1
 buffer_load_dwordx4 a[0:3], v4, s[8:11], s44 offen offset:1024 sc1
 s_waitcnt lgkmcnt(15)
 v_mfma_f32_16x16x32_bf16 v[80:83], a[16:19], a[192:195], v[44:47]
 s_waitcnt lgkmcnt(14)
 v_exp_f32 v17, v73
 v_mfma_f32_16x16x32_bf16 v[80:83], a[20:23], a[196:199], v[80:83]
 s_waitcnt lgkmcnt(13)
 v_exp_f32 v18, v74
 v_mfma_f32_16x16x32_bf16 v[80:83], a[24:27], a[200:203], v[80:83]
 s_waitcnt lgkmcnt(12)
 v_cvt_pk_bf16_f32 v52, v16, v17
 v_or3_b32 v20, v20, v51, v52
 v_mfma_f32_16x16x32_bf16 v[80:83], a[28:31], a[204:207], v[80:83]
 s_waitcnt lgkmcnt(11)
 v_exp_f32 v19, v75
 v_mov_b32 v3, 4048155338
 v_cndmask_b32 v28, v3, v44, s[80:81]
 v_cndmask_b32 v29, v3, v45, s[82:83]
 v_cndmask_b32 v30, v3, v46, s[84:85]
 v_cndmask_b32 v31, v3, v47, s[86:87]
 s_nop 1
 v_mfma_f32_16x16x32_bf16 v[84:87], a[44:47], a[204:207], v[28:31]
 s_waitcnt lgkmcnt(10)
 v_cvt_pk_bf16_f32 v53, v18, v19
 v_or_b32 v20, v20, v53
 v_mfma_f32_16x16x32_bf16 v[84:87], a[40:43], a[200:203], v[84:87]
 s_waitcnt lgkmcnt(9)
 v_and_b32 v20, s64, v20
 v_cmp_ne_u32 vcc, 0, v20
 v_mfma_f32_16x16x32_bf16 v[84:87], a[36:39], a[196:199], v[84:87]
 s_waitcnt lgkmcnt(8)
 buffer_load_dwordx4 a[4:7], v5, s[8:11], s44 offen offset:1024 sc1
 v_mfma_f32_16x16x32_bf16 v[84:87], a[32:35], a[192:195], v[84:87]
 s_cbranch_vccnz L_so_234
L_sb_235:
 s_waitcnt lgkmcnt(0)
 s_barrier
 s_sub_u32 s68, s68, 1
 s_cbranch_scc1 L_fo_236
L_fb_237:
 v_mfma_f32_16x16x32_bf16 v[160:163], a[96:99], v[48:51], v[160:163]
 buffer_load_dwordx4 a[8:11], v6, s[8:11], s44 offen offset:1024 sc1
 v_mfma_f32_16x16x32_bf16 v[160:163], a[144:147], v[52:55], v[160:163]
 buffer_load_dwordx4 a[12:15], v7, s[8:11], s44 offen offset:1024 sc1
 v_mfma_f32_16x16x32_bf16 v[164:167], a[148:151], v[52:55], v[164:167]
 s_add_u32 s44, s42, 4096
 s_and_b32 s44, s44, 0x7fff
 s_add_u32 s44, s44, s43
 v_mfma_f32_16x16x32_bf16 v[164:167], a[100:103], v[48:51], v[164:167]
 buffer_load_dwordx4 v[96:99], v4, s[8:11], s44 offen offset:0 sc1
 v_mfma_f32_16x16x32_bf16 v[168:171], a[104:107], v[48:51], v[168:171]
 buffer_load_dwordx4 v[100:103], v5, s[8:11], s44 offen offset:0 sc1
 v_mfma_f32_16x16x32_bf16 v[168:171], a[152:155], v[52:55], v[168:171]
 buffer_load_dwordx4 v[104:107], v6, s[8:11], s44 offen offset:0 sc1
 v_mfma_f32_16x16x32_bf16 v[172:175], a[156:159], v[52:55], v[172:175]
 buffer_load_dwordx4 v[108:111], v7, s[8:11], s44 offen offset:0 sc1
 v_mfma_f32_16x16x32_bf16 v[172:175], a[108:111], v[48:51], v[172:175]
 buffer_load_dwordx4 v[112:115], v4, s[8:11], s44 offen offset:1024 sc1
 v_mfma_f32_16x16x32_bf16 v[176:179], a[112:115], v[48:51], v[176:179]
 buffer_load_dwordx4 v[116:119], v5, s[8:11], s44 offen offset:1024 sc1
 v_mfma_f32_16x16x32_bf16 v[176:179], a[160:163], v[52:55], v[176:179]
 buffer_load_dwordx4 v[120:123], v6, s[8:11], s44 offen offset:1024 sc1
 v_mfma_f32_16x16x32_bf16 v[180:183], a[164:167], v[52:55], v[180:183]
 buffer_load_dwordx4 v[124:127], v7, s[8:11], s44 offen offset:1024 sc1
 v_mfma_f32_16x16x32_bf16 v[180:183], a[116:119], v[48:51], v[180:183]
 s_add_u32 s44, s42, 6144
 s_and_b32 s44, s44, 0x7fff
 s_add_u32 s44, s44, s43
 ds_read_b128 a[96:99], v14 offset:0
 v_mfma_f32_16x16x32_bf16 v[184:187], a[120:123], v[48:51], v[184:187]
 buffer_load_dwordx4 v[128:131], v4, s[8:11], s44 offen offset:0 sc1
 v_mfma_f32_16x16x32_bf16 v[184:187], a[168:171], v[52:55], v[184:187]
 buffer_load_dwordx4 v[132:135], v5, s[8:11], s44 offen offset:0 sc1
 v_mfma_f32_16x16x32_bf16 v[188:191], a[172:175], v[52:55], v[188:191]
 buffer_load_dwordx4 v[136:139], v6, s[8:11], s44 offen offset:0 sc1
 v_mfma_f32_16x16x32_bf16 v[188:191], a[124:127], v[48:51], v[188:191]
 buffer_load_dwordx4 v[140:143], v7, s[8:11], s44 offen offset:0 sc1
 v_mfma_f32_16x16x32_bf16 a[184:187], v[22:25], v[48:51], a[184:187]
 ds_read_b128 a[144:147], v14 offset:8192
 v_mov_b32 v88, 4048155338
 v_mfma_f32_16x16x32_bf16 a[184:187], v[22:25], v[52:55], a[184:187]
 ds_read_b128 a[148:151], v14 offset:9216
 buffer_load_dwordx4 v[144:147], v4, s[8:11], s44 offen offset:1024 sc1
 ds_read_b128 a[100:103], v14 offset:1024
 buffer_load_dwordx4 v[148:151], v5, s[8:11], s44 offen offset:1024 sc1
 ds_read_b128 a[104:107], v14 offset:2048
 v_mov_b32 v89, 4048155338
 v_mov_b32 v90, 4048155338
 v_mov_b32 v91, 4048155338
 v_mov_b32 v92, 4048155338
 v_mov_b32 v93, 4048155338
 v_mov_b32 v94, 4048155338
 v_mov_b32 v95, 4048155338
 v_exp_f32 v16, v80
 v_exp_f32 v17, v81
 v_exp_f32 v18, v82
 v_cvt_pk_bf16_f32 v56, v16, v17
 v_exp_f32 v19, v83
 v_exp_f32 v16, v84
 v_cvt_pk_bf16_f32 v57, v18, v19
 v_exp_f32 v17, v85
 v_exp_f32 v18, v86
 v_cvt_pk_bf16_f32 v58, v16, v17
 v_or3_b32 v21, v56, v57, v58
 v_exp_f32 v19, v87
 s_nop 0
 v_cvt_pk_bf16_f32 v59, v18, v19
 v_or_b32 v21, v21, v59
 v_and_b32 v21, s64, v21
 ds_read_b128 a[152:155], v14 offset:10240
 ds_read_b128 a[156:159], v14 offset:11264
 ds_read_b128 a[108:111], v14 offset:3072
 ds_read_b128 a[112:115], v14 offset:4096
 ds_read_b128 a[160:163], v14 offset:12288
 ds_read_b128 a[164:167], v14 offset:13312
 ds_read_b128 a[116:119], v14 offset:5120
 ds_read_b128 a[120:123], v14 offset:6144
 ds_read_b128 a[168:171], v14 offset:14336
 ds_read_b128 a[172:175], v14 offset:15360
 ds_read_b128 a[124:127], v14 offset:7168
 buffer_load_dwordx4 v[152:155], v6, s[8:11], s44 offen offset:1024 sc1
 buffer_load_dwordx4 v[156:159], v7, s[8:11], s44 offen offset:1024 sc1
 s_add_u32 s44, s42, 8192
 s_and_b32 s44, s44, 0x7fff
 s_add_u32 s44, s44, s43
 buffer_load_dwordx4 a[64:67], v4, s[8:11], s44 offen offset:0 sc1
 buffer_load_dwordx4 a[68:71], v5, s[8:11], s44 offen offset:0 sc1
 buffer_load_dwordx4 a[72:75], v6, s[8:11], s44 offen offset:0 sc1
 buffer_load_dwordx4 a[76:79], v7, s[8:11], s44 offen offset:0 sc1
 buffer_load_dwordx4 a[176:179], v4, s[8:11], s44 offen offset:1024 sc1
 buffer_load_dwordx4 a[180:183], v5, s[8:11], s44 offen offset:1024 sc1
 buffer_load_dwordx4 v[32:35], v6, s[8:11], s44 offen offset:1024 sc1
 buffer_load_dwordx4 v[36:39], v7, s[8:11], s44 offen offset:1024 sc1
 v_cmp_ne_u32 vcc, 0, v21
 v_accvgpr_read_b32 v26, a184
 v_rcp_f32 v26, v26
 s_nop 0
 v_mul_f32 v26, 0x1f800000, v26
 s_nop 0
 s_cbranch_vccnz L_so_238
L_sb_239:
 s_waitcnt lgkmcnt(15)
 v_mfma_f32_16x16x32_bf16 v[192:195], a[96:99], v[56:59], v[192:195]
 s_waitcnt lgkmcnt(12)
 v_mul_f32 v160, v160, v26
 v_mul_f32 v161, v161, v26
 v_mfma_f32_16x16x32_bf16 v[196:199], a[100:103], v[56:59], v[196:199]
 s_waitcnt lgkmcnt(11)
 v_cvt_pk_bf16_f32 v160, v160, v161
 v_mfma_f32_16x16x32_bf16 v[200:203], a[104:107], v[56:59], v[200:203]
 s_waitcnt lgkmcnt(8)
 v_mul_f32 v162, v162, v26
 v_mul_f32 v163, v163, v26
 v_mfma_f32_16x16x32_bf16 v[204:207], a[108:111], v[56:59], v[204:207]
 s_waitcnt lgkmcnt(7)
 v_cvt_pk_bf16_f32 v161, v162, v163
 v_mfma_f32_16x16x32_bf16 v[208:211], a[112:115], v[56:59], v[208:211]
 s_waitcnt lgkmcnt(4)
 v_mul_f32 v164, v164, v26
 v_mul_f32 v165, v165, v26
 v_mfma_f32_16x16x32_bf16 v[212:215], a[116:119], v[56:59], v[212:215]
 s_waitcnt lgkmcnt(3)
 v_cvt_pk_bf16_f32 v162, v164, v165
 v_mfma_f32_16x16x32_bf16 v[216:219], a[120:123], v[56:59], v[216:219]
 s_waitcnt lgkmcnt(0)
 v_mul_f32 v166, v166, v26
 v_mul_f32 v167, v167, v26
 v_mfma_f32_16x16x32_bf16 v[220:223], a[124:127], v[56:59], v[220:223]
 v_cvt_pk_bf16_f32 v163, v166, v167
 v_mfma_f32_16x16x32_bf16 a[188:191], v[22:25], v[56:59], a[188:191]
 buffer_store_dwordx4 v[160:163], v12, s[16:19], s74 offen offset:0 sc1
 v_mul_f32 v168, v168, v26
 v_mul_f32 v169, v169, v26
 v_cvt_pk_bf16_f32 v168, v168, v169
 v_mul_f32 v170, v170, v26
 v_mul_f32 v171, v171, v26
 v_cvt_pk_bf16_f32 v169, v170, v171
 v_mul_f32 v172, v172, v26
 v_mul_f32 v173, v173, v26
 v_cvt_pk_bf16_f32 v170, v172, v173
 v_mul_f32 v174, v174, v26
 v_mul_f32 v175, v175, v26
 v_cvt_pk_bf16_f32 v171, v174, v175
 buffer_store_dwordx4 v[168:171], v12, s[16:19], s74 offen offset:1024 sc1
 v_mul_f32 v176, v176, v26
 v_mul_f32 v177, v177, v26
 v_cvt_pk_bf16_f32 v176, v176, v177
 v_mul_f32 v178, v178, v26
 v_mul_f32 v179, v179, v26
 v_cvt_pk_bf16_f32 v177, v178, v179
 v_mul_f32 v180, v180, v26
 v_mul_f32 v181, v181, v26
 v_cvt_pk_bf16_f32 v178, v180, v181
 v_mul_f32 v182, v182, v26
 v_mul_f32 v183, v183, v26
 v_cvt_pk_bf16_f32 v179, v182, v183
 buffer_store_dwordx4 v[176:179], v12, s[16:19], s74 offen offset:2048 sc1
 v_mul_f32 v184, v184, v26
 v_mul_f32 v185, v185, v26
 v_cvt_pk_bf16_f32 v184, v184, v185
 v_mul_f32 v186, v186, v26
 v_mul_f32 v187, v187, v26
 v_cvt_pk_bf16_f32 v185, v186, v187
 v_mul_f32 v188, v188, v26
 v_mul_f32 v189, v189, v26
 v_cvt_pk_bf16_f32 v186, v188, v189
 v_mul_f32 v190, v190, v26
 v_mul_f32 v191, v191, v26
 v_cvt_pk_bf16_f32 v187, v190, v191
 buffer_store_dwordx4 v[184:187], v12, s[16:19], s74 offen offset:3072 sc1
 v_accvgpr_read_b32 v27, a188
 v_rcp_f32 v27, v27
 s_nop 0
 v_mul_f32 v27, 0x1f800000, v27
 v_mul_f32 v192, v192, v27
 v_mul_f32 v193, v193, v27
 v_cvt_pk_bf16_f32 v192, v192, v193
 v_mul_f32 v194, v194, v27
 v_mul_f32 v195, v195, v27
 v_cvt_pk_bf16_f32 v193, v194, v195
 v_mul_f32 v196, v196, v27
 v_mul_f32 v197, v197, v27
 v_cvt_pk_bf16_f32 v194, v196, v197
 v_mul_f32 v198, v198, v27
 v_mul_f32 v199, v199, v27
 v_cvt_pk_bf16_f32 v195, v198, v199
 buffer_store_dwordx4 v[192:195], v12, s[16:19], s75 offen offset:0 sc1
 v_mul_f32 v200, v200, v27
 v_mul_f32 v201, v201, v27
 v_cvt_pk_bf16_f32 v200, v200, v201
 v_mul_f32 v202, v202, v27
 v_mul_f32 v203, v203, v27
 v_cvt_pk_bf16_f32 v201, v202, v203
 v_mul_f32 v204, v204, v27
 v_mul_f32 v205, v205, v27
 v_cvt_pk_bf16_f32 v202, v204, v205
 v_mul_f32 v206, v206, v27
 v_mul_f32 v207, v207, v27
 v_cvt_pk_bf16_f32 v203, v206, v207
 buffer_store_dwordx4 v[200:203], v12, s[16:19], s75 offen offset:1024 sc1
 v_mul_f32 v208, v208, v27
 v_mul_f32 v209, v209, v27
 v_cvt_pk_bf16_f32 v208, v208, v209
 v_mul_f32 v210, v210, v27
 v_mul_f32 v211, v211, v27
 v_cvt_pk_bf16_f32 v209, v210, v211
 v_mul_f32 v212, v212, v27
 v_mul_f32 v213, v213, v27
 v_cvt_pk_bf16_f32 v210, v212, v213
 v_mul_f32 v214, v214, v27
 v_mul_f32 v215, v215, v27
 v_cvt_pk_bf16_f32 v211, v214, v215
 buffer_store_dwordx4 v[208:211], v12, s[16:19], s75 offen offset:2048 sc1
 v_mul_f32 v216, v216, v27
 v_mul_f32 v217, v217, v27
 v_cvt_pk_bf16_f32 v216, v216, v217
 v_mul_f32 v218, v218, v27
 v_mul_f32 v219, v219, v27
 v_cvt_pk_bf16_f32 v217, v218, v219
 v_mul_f32 v220, v220, v27
 v_mul_f32 v221, v221, v27
 v_cvt_pk_bf16_f32 v218, v220, v221
 v_mul_f32 v222, v222, v27
 v_mul_f32 v223, v223, v27
 v_cvt_pk_bf16_f32 v219, v222, v223
 buffer_store_dwordx4 v[216:219], v12, s[16:19], s75 offen offset:3072 sc1
 s_branch L_vj_203
L_w3_202:
 s_waitcnt lgkmcnt(0)
 v_mfma_f32_16x16x32_bf16 v[80:83], a[16:19], a[192:195], v[44:47]
 v_exp_f32 v18, v78
 v_mfma_f32_16x16x32_bf16 v[80:83], a[20:23], a[196:199], v[80:83]
 v_cvt_pk_bf16_f32 v54, v16, v17
 v_or3_b32 v20, v20, v53, v54
 v_mfma_f32_16x16x32_bf16 v[80:83], a[24:27], a[200:203], v[80:83]
 v_exp_f32 v19, v79
 v_mfma_f32_16x16x32_bf16 v[80:83], a[28:31], a[204:207], v[80:83]
 v_cvt_pk_bf16_f32 v55, v18, v19
 v_or_b32 v20, v20, v55
 v_mfma_f32_16x16x32_bf16 v[84:87], a[44:47], a[204:207], v[44:47]
 v_and_b32 v20, s64, v20
 v_mfma_f32_16x16x32_bf16 v[84:87], a[40:43], a[200:203], v[84:87]
 v_mfma_f32_16x16x32_bf16 v[84:87], a[36:39], a[196:199], v[84:87]
 v_mfma_f32_16x16x32_bf16 v[84:87], a[32:35], a[192:195], v[84:87]
 v_cmp_ne_u32 vcc, 0, v20
 v_mfma_f32_16x16x32_bf16 v[88:91], a[48:51], a[192:195], v[44:47]
 v_exp_f32 v16, v80
 v_mfma_f32_16x16x32_bf16 v[88:91], a[52:55], a[196:199], v[88:91]
 s_cbranch_vccnz L_so_240
L_sb_241:
 v_exp_f32 v17, v81
 v_mfma_f32_16x16x32_bf16 v[88:91], a[56:59], a[200:203], v[88:91]
 v_exp_f32 v18, v82
 v_mfma_f32_16x16x32_bf16 v[88:91], a[60:63], a[204:207], v[88:91]
 v_cvt_pk_bf16_f32 v56, v16, v17
 v_exp_f32 v19, v83
 v_mfma_f32_16x16x32_bf16 v[92:95], a[92:95], a[204:207], v[44:47]
 v_exp_f32 v16, v84
 v_mfma_f32_16x16x32_bf16 v[92:95], a[88:91], a[200:203], v[92:95]
 v_cvt_pk_bf16_f32 v57, v18, v19
 v_exp_f32 v17, v85
 v_mfma_f32_16x16x32_bf16 v[92:95], a[84:87], a[196:199], v[92:95]
 v_exp_f32 v18, v86
 v_mfma_f32_16x16x32_bf16 v[92:95], a[80:83], a[192:195], v[92:95]
 s_waitcnt vmcnt(0)
 s_barrier
 s_sub_u32 s68, s68, 1
 s_cbranch_scc1 L_fo_244
L_fb_245:
 v_mfma_f32_16x16x32_bf16 v[160:163], a[96:99], v[48:51], v[160:163]
 s_add_u32 s48, s77, s58
 v_cvt_pk_bf16_f32 v58, v16, v17
 v_or3_b32 v21, v56, v57, v58
 v_mfma_f32_16x16x32_bf16 v[160:163], a[144:147], v[52:55], v[160:163]
 s_sub_u32 s49, s48, 32768
 s_and_b32 s49, s49, 0x1ffff
 v_add_u32 v9, s48, v4
 v_mfma_f32_16x16x32_bf16 v[164:167], a[148:151], v[52:55], v[164:167]
 s_add_u32 s44, s42, 12288
 s_and_b32 s44, s44, 0x7fff
 s_add_u32 s44, s44, s43
 v_mfma_f32_16x16x32_bf16 v[164:167], a[100:103], v[48:51], v[164:167]
 s_add_u32 m0, s48, 0
 v_exp_f32 v19, v87
 v_mfma_f32_16x16x32_bf16 v[168:171], a[104:107], v[48:51], v[168:171]
 buffer_load_dwordx4 v4, s[8:11], s44 offen offset:0 sc1 lds
 v_mfma_f32_16x16x32_bf16 v[168:171], a[152:155], v[52:55], v[168:171]
 buffer_load_dwordx4 v4, s[8:11], s44 offen offset:1024 sc1 lds
 v_mfma_f32_16x16x32_bf16 v[172:175], a[156:159], v[52:55], v[172:175]
 s_add_u32 m0, s48, 2048
 v_exp_f32 v16, v88
 v_mfma_f32_16x16x32_bf16 v[172:175], a[108:111], v[48:51], v[172:175]
 buffer_load_dwordx4 v5, s[8:11], s44 offen offset:0 sc1 lds
 v_mfma_f32_16x16x32_bf16 v[176:179], a[112:115], v[48:51], v[176:179]
 buffer_load_dwordx4 v5, s[8:11], s44 offen offset:1024 sc1 lds
 v_mfma_f32_16x16x32_bf16 v[176:179], a[160:163], v[52:55], v[176:179]
 ds_read_b128 a[96:99], v14 offset:0
 v_cvt_pk_bf16_f32 v59, v18, v19
 v_mfma_f32_16x16x32_bf16 v[180:183], a[164:167], v[52:55], v[180:183]
 s_add_u32 m0, s48, 4096
 v_exp_f32 v17, v89
 v_mfma_f32_16x16x32_bf16 v[180:183], a[116:119], v[48:51], v[180:183]
 buffer_load_dwordx4 v6, s[8:11], s44 offen offset:0 sc1 lds
 v_mfma_f32_16x16x32_bf16 v[184:187], a[120:123], v[48:51], v[184:187]
 buffer_load_dwordx4 v6, s[8:11], s44 offen offset:1024 sc1 lds
 v_mfma_f32_16x16x32_bf16 v[184:187], a[168:171], v[52:55], v[184:187]
 s_add_u32 m0, s48, 6144
 v_exp_f32 v18, v90
 v_mfma_f32_16x16x32_bf16 v[188:191], a[172:175], v[52:55], v[188:191]
 buffer_load_dwordx4 v7, s[8:11], s44 offen offset:0 sc1 lds
 v_mfma_f32_16x16x32_bf16 v[188:191], a[124:127], v[48:51], v[188:191]
 buffer_load_dwordx4 v7, s[8:11], s44 offen offset:1024 sc1 lds
 v_mfma_f32_16x16x32_bf16 a[184:187], v[22:25], v[48:51], a[184:187]
 ds_read_b128 a[144:147], v14 offset:8192
 v_add_u32 v10, s49, v4
 v_mfma_f32_16x16x32_bf16 a[184:187], v[22:25], v[52:55], a[184:187]
 s_add_u32 s44, s42, 14336
 s_and_b32 s44, s44, 0x7fff
 s_add_u32 s44, s44, s43
 v_mfma_f32_16x16x32_bf16 v[64:67], a[16:19], a[128:131], v[40:43]
 s_add_u32 m0, s49, 0
 v_cvt_pk_bf16_f32 v60, v16, v17
 v_or3_b32 v21, v21, v59, v60
 v_mfma_f32_16x16x32_bf16 v[64:67], a[20:23], a[132:135], v[64:67]
 buffer_load_dwordx4 v4, s[8:11], s44 offen offset:0 sc1 lds
 v_mfma_f32_16x16x32_bf16 v[64:67], a[24:27], a[136:139], v[64:67]
 buffer_load_dwordx4 v4, s[8:11], s44 offen offset:1024 sc1 lds
 v_mfma_f32_16x16x32_bf16 v[64:67], a[28:31], a[140:143], v[64:67]
 s_add_u32 m0, s49, 2048
 v_exp_f32 v19, v91
 v_mfma_f32_16x16x32_bf16 v[68:71], a[44:47], a[140:143], v[40:43]
 buffer_load_dwordx4 v5, s[8:11], s44 offen offset:0 sc1 lds
 v_mfma_f32_16x16x32_bf16 v[68:71], a[40:43], a[136:139], v[68:71]
 buffer_load_dwordx4 v5, s[8:11], s44 offen offset:1024 sc1 lds
 v_mfma_f32_16x16x32_bf16 v[68:71], a[36:39], a[132:135], v[68:71]
 s_add_u32 m0, s49, 4096
 v_exp_f32 v16, v92
 v_mfma_f32_16x16x32_bf16 v[68:71], a[32:35], a[128:131], v[68:71]
 ds_read_b128 a[148:151], v14 offset:9216
 v_cvt_pk_bf16_f32 v61, v18, v19
 v_exp_f32 v17, v93
 v_exp_f32 v18, v94
 v_cvt_pk_bf16_f32 v62, v16, v17
 v_or3_b32 v21, v21, v61, v62
 v_exp_f32 v19, v95
 s_nop 0
 v_cvt_pk_bf16_f32 v63, v18, v19
 v_or_b32 v21, v21, v63
 v_and_b32 v21, s64, v21
 v_mfma_f32_16x16x32_bf16 v[72:75], a[48:51], a[128:131], v[40:43]
 ds_read_b128 a[100:103], v14 offset:1024
 v_cmp_ne_u32 vcc, 0, v21
 v_mfma_f32_16x16x32_bf16 v[72:75], a[52:55], a[132:135], v[72:75]
 buffer_load_dwordx4 v6, s[8:11], s44 offen offset:0 sc1 lds
 v_mfma_f32_16x16x32_bf16 v[72:75], a[56:59], a[136:139], v[72:75]
 buffer_load_dwordx4 v6, s[8:11], s44 offen offset:1024 sc1 lds
 v_mfma_f32_16x16x32_bf16 v[72:75], a[60:63], a[140:143], v[72:75]
 s_cbranch_vccnz L_so_242
L_sb_243:
 v_exp_f32 v16, v64
 v_mov_b32 v3, 4048155338
 v_cndmask_b32 v28, v3, v40, s[80:81]
 v_cndmask_b32 v29, v3, v41, s[82:83]
 v_cndmask_b32 v30, v3, v42, s[84:85]
 v_cndmask_b32 v31, v3, v43, s[86:87]
 s_nop 1
 v_mfma_f32_16x16x32_bf16 v[76:79], a[92:95], a[140:143], v[28:31]
 ds_read_b128 a[104:107], v14 offset:2048
 s_add_u32 m0, s49, 6144
 ds_read_b128 a[152:155], v14 offset:10240
 ds_read_b128 a[156:159], v14 offset:11264
 ds_read_b128 a[108:111], v14 offset:3072
 ds_read_b128 a[112:115], v14 offset:4096
 ds_read_b128 a[160:163], v14 offset:12288
 ds_read_b128 a[164:167], v14 offset:13312
 ds_read_b128 a[116:119], v14 offset:5120
 ds_read_b128 a[120:123], v14 offset:6144
 ds_read_b128 a[168:171], v14 offset:14336
 ds_read_b128 a[172:175], v14 offset:15360
 ds_read_b128 a[124:127], v14 offset:7168
 v_mfma_f32_16x16x32_bf16 v[76:79], a[88:91], a[136:139], v[76:79]
 buffer_load_dwordx4 v7, s[8:11], s44 offen offset:0 sc1 lds
 v_mfma_f32_16x16x32_bf16 v[76:79], a[84:87], a[132:135], v[76:79]
 buffer_load_dwordx4 v7, s[8:11], s44 offen offset:1024 sc1 lds
 v_mfma_f32_16x16x32_bf16 v[76:79], a[80:83], a[128:131], v[76:79]
 s_waitcnt lgkmcnt(14)
 v_exp_f32 v17, v65
 v_mfma_f32_16x16x32_bf16 v[192:195], a[96:99], v[56:59], v[192:195]
 s_add_u32 s44, s42, 10240
 s_and_b32 s44, s44, 0x7fff
 s_add_u32 s44, s44, s43
 v_mfma_f32_16x16x32_bf16 v[192:195], a[144:147], v[60:63], v[192:195]
 s_waitcnt lgkmcnt(13)
 s_add_u32 m0, s45, 0
 v_exp_f32 v18, v66
 v_mfma_f32_16x16x32_bf16 v[196:199], a[148:151], v[60:63], v[196:199]
 s_waitcnt lgkmcnt(12)
 buffer_load_dwordx4 v4, s[8:11], s44 offen offset:0 sc1 lds
 v_mfma_f32_16x16x32_bf16 v[196:199], a[100:103], v[56:59], v[196:199]
 s_waitcnt lgkmcnt(11)
 buffer_load_dwordx4 v4, s[8:11], s44 offen offset:1024 sc1 lds
 v_mfma_f32_16x16x32_bf16 v[200:203], a[104:107], v[56:59], v[200:203]
 s_waitcnt lgkmcnt(10)
 ds_read_b128 a[16:19], v14 offset:16384
 v_cvt_pk_bf16_f32 v48, v16, v17
 v_mfma_f32_16x16x32_bf16 v[200:203], a[152:155], v[60:63], v[200:203]
 s_waitcnt lgkmcnt(10)
 s_add_u32 m0, s45, 2048
 v_exp_f32 v19, v67
 v_mfma_f32_16x16x32_bf16 v[204:207], a[156:159], v[60:63], v[204:207]
 s_waitcnt lgkmcnt(1)
 buffer_load_dwordx4 v5, s[8:11], s44 offen offset:0 sc1 lds
 v_mfma_f32_16x16x32_bf16 v[204:207], a[108:111], v[56:59], v[204:207]
 buffer_load_dwordx4 v5, s[8:11], s44 offen offset:1024 sc1 lds
 v_mfma_f32_16x16x32_bf16 v[208:211], a[112:115], v[56:59], v[208:211]
 s_add_u32 m0, s45, 4096
 v_exp_f32 v16, v68
 v_mfma_f32_16x16x32_bf16 v[208:211], a[160:163], v[60:63], v[208:211]
 buffer_load_dwordx4 v6, s[8:11], s44 offen offset:0 sc1 lds
 v_mfma_f32_16x16x32_bf16 v[212:215], a[164:167], v[60:63], v[212:215]
 buffer_load_dwordx4 v6, s[8:11], s44 offen offset:1024 sc1 lds
 v_mfma_f32_16x16x32_bf16 v[212:215], a[116:119], v[56:59], v[212:215]
 s_add_u32 s79, s76, s58
 v_cvt_pk_bf16_f32 v49, v18, v19
 v_mfma_f32_16x16x32_bf16 v[216:219], a[120:123], v[56:59], v[216:219]
 s_add_u32 s76, s76, 32768
 v_exp_f32 v17, v69
 v_mfma_f32_16x16x32_bf16 v[216:219], a[168:171], v[60:63], v[216:219]
 s_and_b32 s76, s76, 0x1ffff
 v_exp_f32 v18, v70
 v_mfma_f32_16x16x32_bf16 v[220:223], a[172:175], v[60:63], v[220:223]
 ds_read_b128 a[20:23], v14 offset:17408
 v_cvt_pk_bf16_f32 v50, v16, v17
 v_mfma_f32_16x16x32_bf16 v[220:223], a[124:127], v[56:59], v[220:223]
 ds_read_b128 a[24:27], v14 offset:18432
 v_or3_b32 v20, v48, v49, v50
 v_mfma_f32_16x16x32_bf16 a[188:191], v[22:25], v[56:59], a[188:191]
 ds_read_b128 a[28:31], v14 offset:19456
 s_add_u32 m0, s45, 6144
 ds_read_b128 a[44:47], v14 offset:23552
 ds_read_b128 a[40:43], v14 offset:22528
 ds_read_b128 a[36:39], v14 offset:21504
 ds_read_b128 a[32:35], v14 offset:20480
 ds_read_b128 a[48:51], v14 offset:24576
 ds_read_b128 a[52:55], v14 offset:25600
 ds_read_b128 a[56:59], v14 offset:26624
 ds_read_b128 a[60:63], v14 offset:27648
 ds_read_b128 a[92:95], v14 offset:31744
 ds_read_b128 a[88:91], v14 offset:30720
 ds_read_b128 a[84:87], v14 offset:29696
 ds_read_b128 a[80:83], v14 offset:28672
 v_mfma_f32_16x16x32_bf16 a[188:191], v[22:25], v[60:63], a[188:191]
 s_mov_b32 s77, s79
 buffer_load_dwordx4 v7, s[8:11], s44 offen offset:0 sc1 lds
 buffer_load_dwordx4 v7, s[8:11], s44 offen offset:1024 sc1 lds
 v_add_u32 v14, s76, v12
 v_exp_f32 v19, v71
 v_exp_f32 v16, v72
 v_cvt_pk_bf16_f32 v51, v18, v19
 v_exp_f32 v17, v73
 v_exp_f32 v18, v74
 v_cvt_pk_bf16_f32 v52, v16, v17
 v_or3_b32 v20, v20, v51, v52
 v_exp_f32 v19, v75
 v_exp_f32 v16, v76
 v_cvt_pk_bf16_f32 v53, v18, v19
 v_exp_f32 v17, v77
 s_add_u32 s44, s42, 0
 s_and_b32 s44, s44, 0x7fff
 s_add_u32 s44, s44, s43
 buffer_load_dwordx4 a[208:211], v4, s[8:11], s44 offen offset:0 sc1
 buffer_load_dwordx4 a[212:215], v5, s[8:11], s44 offen offset:0 sc1
 buffer_load_dwordx4 a[216:219], v6, s[8:11], s44 offen offset:0 sc1
 buffer_load_dwordx4 a[220:223], v7, s[8:11], s44 offen offset:0 sc1
 buffer_load_dwordx4 a[224:227], v4, s[8:11], s44 offen offset:1024 sc1
 buffer_load_dwordx4 a[228:231], v5, s[8:11], s44 offen offset:1024 sc1
 buffer_load_dwordx4 a[232:235], v6, s[8:11], s44 offen offset:1024 sc1
 buffer_load_dwordx4 a[236:239], v7, s[8:11], s44 offen offset:1024 sc1
 s_add_u32 s44, s42, 2048
 s_and_b32 s44, s44, 0x7fff
 s_add_u32 s44, s44, s43
 buffer_load_dwordx4 a[240:243], v4, s[8:11], s44 offen offset:0 sc1
 buffer_load_dwordx4 a[244:247], v5, s[8:11], s44 offen offset:0 sc1
 buffer_load_dwordx4 a[248:251], v6, s[8:11], s44 offen offset:0 sc1
 buffer_load_dwordx4 a[252:255], v7, s[8:11], s44 offen offset:0 sc1
 buffer_load_dwordx4 a[0:3], v4, s[8:11], s44 offen offset:1024 sc1
 s_waitcnt lgkmcnt(15)
 v_mov_b32 v3, 4048155338
 v_cndmask_b32 v28, v3, v44, s[80:81]
 v_cndmask_b32 v29, v3, v45, s[82:83]
 v_cndmask_b32 v30, v3, v46, s[84:85]
 v_cndmask_b32 v31, v3, v47, s[86:87]
 s_nop 1
 v_mfma_f32_16x16x32_bf16 v[80:83], a[16:19], a[192:195], v[28:31]
 s_waitcnt lgkmcnt(14)
 v_exp_f32 v18, v78
 v_mfma_f32_16x16x32_bf16 v[80:83], a[20:23], a[196:199], v[80:83]
 s_waitcnt lgkmcnt(13)
 v_cvt_pk_bf16_f32 v54, v16, v17
 v_or3_b32 v20, v20, v53, v54
 v_exp_f32 v19, v79
 s_nop 0
 v_cvt_pk_bf16_f32 v55, v18, v19
 v_or_b32 v20, v20, v55
 v_and_b32 v20, s64, v20
 v_mfma_f32_16x16x32_bf16 v[80:83], a[24:27], a[200:203], v[80:83]
 s_waitcnt lgkmcnt(12)
 buffer_load_dwordx4 a[4:7], v5, s[8:11], s44 offen offset:1024 sc1
 v_cmp_ne_u32 vcc, 0, v20
 v_mfma_f32_16x16x32_bf16 v[80:83], a[28:31], a[204:207], v[80:83]
 s_cbranch_vccnz L_so_246
L_sb_247:
 s_waitcnt lgkmcnt(0)
 s_barrier
 s_sub_u32 s68, s68, 1
 s_cbranch_scc1 L_fo_248
L_fb_249:
 v_mfma_f32_16x16x32_bf16 v[160:163], a[96:99], v[48:51], v[160:163]
 buffer_load_dwordx4 a[8:11], v6, s[8:11], s44 offen offset:1024 sc1
 v_mfma_f32_16x16x32_bf16 v[160:163], a[144:147], v[52:55], v[160:163]
 buffer_load_dwordx4 a[12:15], v7, s[8:11], s44 offen offset:1024 sc1
 v_mfma_f32_16x16x32_bf16 v[164:167], a[148:151], v[52:55], v[164:167]
 s_add_u32 s44, s42, 4096
 s_and_b32 s44, s44, 0x7fff
 s_add_u32 s44, s44, s43
 v_mfma_f32_16x16x32_bf16 v[164:167], a[100:103], v[48:51], v[164:167]
 buffer_load_dwordx4 v[96:99], v4, s[8:11], s44 offen offset:0 sc1
 v_mfma_f32_16x16x32_bf16 v[168:171], a[104:107], v[48:51], v[168:171]
 buffer_load_dwordx4 v[100:103], v5, s[8:11], s44 offen offset:0 sc1
 v_mfma_f32_16x16x32_bf16 v[168:171], a[152:155], v[52:55], v[168:171]
 buffer_load_dwordx4 v[104:107], v6, s[8:11], s44 offen offset:0 sc1
 v_mfma_f32_16x16x32_bf16 v[172:175], a[156:159], v[52:55], v[172:175]
 buffer_load_dwordx4 v[108:111], v7, s[8:11], s44 offen offset:0 sc1
 v_mfma_f32_16x16x32_bf16 v[172:175], a[108:111], v[48:51], v[172:175]
 buffer_load_dwordx4 v[112:115], v4, s[8:11], s44 offen offset:1024 sc1
 v_mfma_f32_16x16x32_bf16 v[176:179], a[112:115], v[48:51], v[176:179]
 buffer_load_dwordx4 v[116:119], v5, s[8:11], s44 offen offset:1024 sc1
 v_mfma_f32_16x16x32_bf16 v[176:179], a[160:163], v[52:55], v[176:179]
 buffer_load_dwordx4 v[120:123], v6, s[8:11], s44 offen offset:1024 sc1
 v_mfma_f32_16x16x32_bf16 v[180:183], a[164:167], v[52:55], v[180:183]
 buffer_load_dwordx4 v[124:127], v7, s[8:11], s44 offen offset:1024 sc1
 v_mfma_f32_16x16x32_bf16 v[180:183], a[116:119], v[48:51], v[180:183]
 s_add_u32 s44, s42, 6144
 s_and_b32 s44, s44, 0x7fff
 s_add_u32 s44, s44, s43
 v_mfma_f32_16x16x32_bf16 v[184:187], a[120:123], v[48:51], v[184:187]
 buffer_load_dwordx4 v[128:131], v4, s[8:11], s44 offen offset:0 sc1
 v_mfma_f32_16x16x32_bf16 v[184:187], a[168:171], v[52:55], v[184:187]
 buffer_load_dwordx4 v[132:135], v5, s[8:11], s44 offen offset:0 sc1
 v_mfma_f32_16x16x32_bf16 v[188:191], a[172:175], v[52:55], v[188:191]
 buffer_load_dwordx4 v[136:139], v6, s[8:11], s44 offen offset:0 sc1
 v_mfma_f32_16x16x32_bf16 v[188:191], a[124:127], v[48:51], v[188:191]
 ds_read_b128 a[96:99], v14 offset:0
 v_mov_b32 v84, 4048155338
 v_mfma_f32_16x16x32_bf16 a[184:187], v[22:25], v[48:51], a[184:187]
 ds_read_b128 a[144:147], v14 offset:8192
 v_mov_b32 v85, 4048155338
 v_mfma_f32_16x16x32_bf16 a[184:187], v[22:25], v[52:55], a[184:187]
 ds_read_b128 a[148:151], v14 offset:9216
 buffer_load_dwordx4 v[140:143], v7, s[8:11], s44 offen offset:0 sc1
 ds_read_b128 a[100:103], v14 offset:1024
 buffer_load_dwordx4 v[144:147], v4, s[8:11], s44 offen offset:1024 sc1
 ds_read_b128 a[104:107], v14 offset:2048
 v_mov_b32 v86, 4048155338
 v_mov_b32 v87, 4048155338
 v_mov_b32 v88, 4048155338
 v_mov_b32 v89, 4048155338
 v_mov_b32 v90, 4048155338
 v_mov_b32 v91, 4048155338
 v_mov_b32 v92, 4048155338
 v_mov_b32 v93, 4048155338
 v_mov_b32 v94, 4048155338
 v_mov_b32 v95, 4048155338
 v_mov_b32 v58, 0
 v_mov_b32 v59, 0
 v_exp_f32 v16, v80
 v_exp_f32 v17, v81
 v_exp_f32 v18, v82
 v_cvt_pk_bf16_f32 v56, v16, v17
 v_exp_f32 v19, v83
 s_nop 0
 v_cvt_pk_bf16_f32 v57, v18, v19
 v_or_b32 v21, v56, v57
 v_and_b32 v21, s64, v21
 ds_read_b128 a[152:155], v14 offset:10240
 ds_read_b128 a[156:159], v14 offset:11264
 ds_read_b128 a[108:111], v14 offset:3072
 ds_read_b128 a[112:115], v14 offset:4096
 ds_read_b128 a[160:163], v14 offset:12288
 ds_read_b128 a[164:167], v14 offset:13312
 ds_read_b128 a[116:119], v14 offset:5120
 ds_read_b128 a[120:123], v14 offset:6144
 ds_read_b128 a[168:171], v14 offset:14336
 ds_read_b128 a[172:175], v14 offset:15360
 ds_read_b128 a[124:127], v14 offset:7168
 buffer_load_dwordx4 v[148:151], v5, s[8:11], s44 offen offset:1024 sc1
 buffer_load_dwordx4 v[152:155], v6, s[8:11], s44 offen offset:1024 sc1
 buffer_load_dwordx4 v[156:159], v7, s[8:11], s44 offen offset:1024 sc1
 s_add_u32 s44, s42, 8192
 s_and_b32 s44, s44, 0x7fff
 s_add_u32 s44, s44, s43
 buffer_load_dwordx4 a[64:67], v4, s[8:11], s44 offen offset:0 sc1
 buffer_load_dwordx4 a[68:71], v5, s[8:11], s44 offen offset:0 sc1
 buffer_load_dwordx4 a[72:75], v6, s[8:11], s44 offen offset:0 sc1
 buffer_load_dwordx4 a[76:79], v7, s[8:11], s44 offen offset:0 sc1
 buffer_load_dwordx4 a[176:179], v4, s[8:11], s44 offen offset:1024 sc1
 buffer_load_dwordx4 a[180:183], v5, s[8:11], s44 offen offset:1024 sc1
 buffer_load_dwordx4 v[32:35], v6, s[8:11], s44 offen offset:1024 sc1
 buffer_load_dwordx4 v[36:39], v7, s[8:11], s44 offen offset:1024 sc1
 v_cmp_ne_u32 vcc, 0, v21
 v_accvgpr_read_b32 v26, a184
 v_rcp_f32 v26, v26
 s_nop 0
 v_mul_f32 v26, 0x1f800000, v26
 s_nop 0
 s_cbranch_vccnz L_so_250
L_sb_251:
 s_waitcnt lgkmcnt(15)
 v_mfma_f32_16x16x32_bf16 v[192:195], a[96:99], v[56:59], v[192:195]
 s_waitcnt lgkmcnt(12)
 v_mul_f32 v160, v160, v26
 v_mul_f32 v161, v161, v26
 v_mfma_f32_16x16x32_bf16 v[196:199], a[100:103], v[56:59], v[196:199]
 s_waitcnt lgkmcnt(11)
 v_cvt_pk_bf16_f32 v160, v160, v161
 v_mfma_f32_16x16x32_bf16 v[200:203], a[104:107], v[56:59], v[200:203]
 s_waitcnt lgkmcnt(8)
 v_mul_f32 v162, v162, v26
 v_mul_f32 v163, v163, v26
 v_mfma_f32_16x16x32_bf16 v[204:207], a[108:111], v[56:59], v[204:207]
 s_waitcnt lgkmcnt(7)
 v_cvt_pk_bf16_f32 v161, v162, v163
 v_mfma_f32_16x16x32_bf16 v[208:211], a[112:115], v[56:59], v[208:211]
 s_waitcnt lgkmcnt(4)
 v_mul_f32 v164, v164, v26
 v_mul_f32 v165, v165, v26
 v_mfma_f32_16x16x32_bf16 v[212:215], a[116:119], v[56:59], v[212:215]
 s_waitcnt lgkmcnt(3)
 v_cvt_pk_bf16_f32 v162, v164, v165
 v_mfma_f32_16x16x32_bf16 v[216:219], a[120:123], v[56:59], v[216:219]
 s_waitcnt lgkmcnt(0)
 v_mul_f32 v166, v166, v26
 v_mul_f32 v167, v167, v26
 v_mfma_f32_16x16x32_bf16 v[220:223], a[124:127], v[56:59], v[220:223]
 v_cvt_pk_bf16_f32 v163, v166, v167
 v_mfma_f32_16x16x32_bf16 a[188:191], v[22:25], v[56:59], a[188:191]
 buffer_store_dwordx4 v[160:163], v12, s[16:19], s74 offen offset:0 sc1
 v_mul_f32 v168, v168, v26
 v_mul_f32 v169, v169, v26
 v_cvt_pk_bf16_f32 v168, v168, v169
 v_mul_f32 v170, v170, v26
 v_mul_f32 v171, v171, v26
 v_cvt_pk_bf16_f32 v169, v170, v171
 v_mul_f32 v172, v172, v26
 v_mul_f32 v173, v173, v26
 v_cvt_pk_bf16_f32 v170, v172, v173
 v_mul_f32 v174, v174, v26
 v_mul_f32 v175, v175, v26
 v_cvt_pk_bf16_f32 v171, v174, v175
 buffer_store_dwordx4 v[168:171], v12, s[16:19], s74 offen offset:1024 sc1
 v_mul_f32 v176, v176, v26
 v_mul_f32 v177, v177, v26
 v_cvt_pk_bf16_f32 v176, v176, v177
 v_mul_f32 v178, v178, v26
 v_mul_f32 v179, v179, v26
 v_cvt_pk_bf16_f32 v177, v178, v179
 v_mul_f32 v180, v180, v26
 v_mul_f32 v181, v181, v26
 v_cvt_pk_bf16_f32 v178, v180, v181
 v_mul_f32 v182, v182, v26
 v_mul_f32 v183, v183, v26
 v_cvt_pk_bf16_f32 v179, v182, v183
 buffer_store_dwordx4 v[176:179], v12, s[16:19], s74 offen offset:2048 sc1
 v_mul_f32 v184, v184, v26
 v_mul_f32 v185, v185, v26
 v_cvt_pk_bf16_f32 v184, v184, v185
 v_mul_f32 v186, v186, v26
 v_mul_f32 v187, v187, v26
 v_cvt_pk_bf16_f32 v185, v186, v187
 v_mul_f32 v188, v188, v26
 v_mul_f32 v189, v189, v26
 v_cvt_pk_bf16_f32 v186, v188, v189
 v_mul_f32 v190, v190, v26
 v_mul_f32 v191, v191, v26
 v_cvt_pk_bf16_f32 v187, v190, v191
 buffer_store_dwordx4 v[184:187], v12, s[16:19], s74 offen offset:3072 sc1
 v_accvgpr_read_b32 v27, a188
 v_rcp_f32 v27, v27
 s_nop 0
 v_mul_f32 v27, 0x1f800000, v27
 v_mul_f32 v192, v192, v27
 v_mul_f32 v193, v193, v27
 v_cvt_pk_bf16_f32 v192, v192, v193
 v_mul_f32 v194, v194, v27
 v_mul_f32 v195, v195, v27
 v_cvt_pk_bf16_f32 v193, v194, v195
 v_mul_f32 v196, v196, v27
 v_mul_f32 v197, v197, v27
 v_cvt_pk_bf16_f32 v194, v196, v197
 v_mul_f32 v198, v198, v27
 v_mul_f32 v199, v199, v27
 v_cvt_pk_bf16_f32 v195, v198, v199
 buffer_store_dwordx4 v[192:195], v12, s[16:19], s75 offen offset:0 sc1
 v_mul_f32 v200, v200, v27
 v_mul_f32 v201, v201, v27
 v_cvt_pk_bf16_f32 v200, v200, v201
 v_mul_f32 v202, v202, v27
 v_mul_f32 v203, v203, v27
 v_cvt_pk_bf16_f32 v201, v202, v203
 v_mul_f32 v204, v204, v27
 v_mul_f32 v205, v205, v27
 v_cvt_pk_bf16_f32 v202, v204, v205
 v_mul_f32 v206, v206, v27
 v_mul_f32 v207, v207, v27
 v_cvt_pk_bf16_f32 v203, v206, v207
 buffer_store_dwordx4 v[200:203], v12, s[16:19], s75 offen offset:1024 sc1
 v_mul_f32 v208, v208, v27
 v_mul_f32 v209, v209, v27
 v_cvt_pk_bf16_f32 v208, v208, v209
 v_mul_f32 v210, v210, v27
 v_mul_f32 v211, v211, v27
 v_cvt_pk_bf16_f32 v209, v210, v211
 v_mul_f32 v212, v212, v27
 v_mul_f32 v213, v213, v27
 v_cvt_pk_bf16_f32 v210, v212, v213
 v_mul_f32 v214, v214, v27
 v_mul_f32 v215, v215, v27
 v_cvt_pk_bf16_f32 v211, v214, v215
 buffer_store_dwordx4 v[208:211], v12, s[16:19], s75 offen offset:2048 sc1
 v_mul_f32 v216, v216, v27
 v_mul_f32 v217, v217, v27
 v_cvt_pk_bf16_f32 v216, v216, v217
 v_mul_f32 v218, v218, v27
 v_mul_f32 v219, v219, v27
 v_cvt_pk_bf16_f32 v217, v218, v219
 v_mul_f32 v220, v220, v27
 v_mul_f32 v221, v221, v27
 v_cvt_pk_bf16_f32 v218, v220, v221
 v_mul_f32 v222, v222, v27
 v_mul_f32 v223, v223, v27
 v_cvt_pk_bf16_f32 v219, v222, v223
 buffer_store_dwordx4 v[216:219], v12, s[16:19], s75 offen offset:3072 sc1
L_vj_203:
L_bdone_198:
 s_add_u32 s44, s42, 20480
 s_and_b32 s44, s44, 0x7fff
 s_add_u32 s44, s44, s43
 buffer_load_dwordx4 v[64:67], v4, s[8:11], s44 offen offset:0 sc1
 buffer_load_dwordx4 v[68:71], v5, s[8:11], s44 offen offset:0 sc1
 buffer_load_dwordx4 v[72:75], v6, s[8:11], s44 offen offset:0 sc1
 buffer_load_dwordx4 v[76:79], v7, s[8:11], s44 offen offset:0 sc1
 buffer_load_dwordx4 v[80:83], v4, s[8:11], s44 offen offset:1024 sc1
 buffer_load_dwordx4 v[84:87], v5, s[8:11], s44 offen offset:1024 sc1
 buffer_load_dwordx4 v[88:91], v6, s[8:11], s44 offen offset:1024 sc1
 buffer_load_dwordx4 v[92:95], v7, s[8:11], s44 offen offset:1024 sc1
 s_add_u32 s44, s42, 22528
 s_and_b32 s44, s44, 0x7fff
 s_add_u32 s44, s44, s43
 buffer_load_dwordx4 v[224:227], v4, s[8:11], s44 offen offset:0 sc1
 buffer_load_dwordx4 v[228:231], v5, s[8:11], s44 offen offset:0 sc1
 buffer_load_dwordx4 v[232:235], v6, s[8:11], s44 offen offset:0 sc1
 buffer_load_dwordx4 v[236:239], v7, s[8:11], s44 offen offset:0 sc1
 buffer_load_dwordx4 v[240:243], v4, s[8:11], s44 offen offset:1024 sc1
 buffer_load_dwordx4 v[244:247], v5, s[8:11], s44 offen offset:1024 sc1
 buffer_load_dwordx4 v[248:251], v6, s[8:11], s44 offen offset:1024 sc1
 buffer_load_dwordx4 v[252:255], v7, s[8:11], s44 offen offset:1024 sc1
 s_waitcnt vmcnt(16)
 s_barrier
 s_cmp_eq_u32 s3, 0
 s_cbranch_scc0 L_pub_252
 s_mul_i32 s4, s2, 128
 s_add_u32 s4, s4, 65536
 v_lshl_add_u32 v2, v0, 2, s4
 v_mov_b32 v3, s100
 s_mov_b64 exec, 0xffffffff
 buffer_store_dword v3, v2, s[96:99], 0 offen sc1
 s_mov_b64 exec, -1
L_pub_252:
 s_getpc_b64 s[6:7]
L_cw_253:
 s_add_u32 s6, s6, sequential_preLN__compressed_kv_cla__glu_gated_swiglu__prompt_kernel_cG - L_cw_253
 s_addc_u32 s7, s7, 0
 s_lshr_b32 s4, s2, 3
 s_lshl_b32 s4, s4, 2
 s_add_u32 s4, s4, s3
 s_lshl_b32 s4, s4, 7
 v_lshlrev_b32 v2, 14, v0
 v_add_u32 v2, s4, v2
 v_cmp_gt_u32 vcc, sequential_preLN__compressed_kv_cla__glu_gated_swiglu__prompt_kernel_cend - sequential_preLN__compressed_kv_cla__glu_gated_swiglu__prompt_kernel_cG, v2
 s_and_saveexec_b64 s[92:93], vcc
 s_cbranch_execz L_cs_254
 global_load_dword v3, v2, s[6:7]
L_cs_254:
 s_mov_b64 exec, s[92:93]
 v_lshrrev_b32 v12, 3, v0
 v_and_b32 v13, 7, v0
 v_lshlrev_b32 v13, 4, v13
 v_lshl_add_u32 v12, v12, 10, v13
 v_and_b32 v13, 15, v0
 v_lshlrev_b32 v13, 7, v13
 v_lshrrev_b32 v14, 4, v0
 v_lshl_add_u32 v13, v14, 3, v13
 v_add_u32 v15, s45, v13
 s_add_u32 s38, s48, 32768
 s_and_b32 s38, s38, 0x1ffff
 s_add_u32 s44, s42, 16384
 s_and_b32 s44, s44, 0x7fff
 s_add_u32 s44, s44, s43
 s_add_u32 m0, s38, 0
 s_nop 0
 buffer_load_dwordx4 v4, s[8:11], s44 offen offset:0 sc1 lds
 buffer_load_dwordx4 v4, s[8:11], s44 offen offset:1024 sc1 lds
 s_add_u32 m0, s38, 2048
 s_nop 0
 buffer_load_dwordx4 v5, s[8:11], s44 offen offset:0 sc1 lds
 buffer_load_dwordx4 v5, s[8:11], s44 offen offset:1024 sc1 lds
 s_add_u32 m0, s38, 4096
 s_nop 0
 buffer_load_dwordx4 v6, s[8:11], s44 offen offset:0 sc1 lds
 buffer_load_dwordx4 v6, s[8:11], s44 offen offset:1024 sc1 lds
 s_add_u32 m0, s38, 6144
 s_nop 0
 buffer_load_dwordx4 v7, s[8:11], s44 offen offset:0 sc1 lds
 buffer_load_dwordx4 v7, s[8:11], s44 offen offset:1024 sc1 lds
 s_add_u32 s39, s48, 65536
 s_and_b32 s39, s39, 0x1ffff
 s_add_u32 s44, s42, 18432
 s_and_b32 s44, s44, 0x7fff
 s_add_u32 s44, s44, s43
 s_add_u32 m0, s39, 0
 s_nop 0
 buffer_load_dwordx4 v4, s[8:11], s44 offen offset:0 sc1 lds
 buffer_load_dwordx4 v4, s[8:11], s44 offen offset:1024 sc1 lds
 s_add_u32 m0, s39, 2048
 s_nop 0
 buffer_load_dwordx4 v5, s[8:11], s44 offen offset:0 sc1 lds
 buffer_load_dwordx4 v5, s[8:11], s44 offen offset:1024 sc1 lds
 s_add_u32 m0, s39, 4096
 s_nop 0
 buffer_load_dwordx4 v6, s[8:11], s44 offen offset:0 sc1 lds
 buffer_load_dwordx4 v6, s[8:11], s44 offen offset:1024 sc1 lds
 s_add_u32 m0, s39, 6144
 s_nop 0
 buffer_load_dwordx4 v7, s[8:11], s44 offen offset:0 sc1 lds
 buffer_load_dwordx4 v7, s[8:11], s44 offen offset:1024 sc1 lds
 s_add_u32 s44, s42, 24576
 s_and_b32 s44, s44, 0x7fff
 s_add_u32 s44, s44, s43
 buffer_load_dwordx4 a[96:99], v4, s[8:11], s44 offen offset:0 sc1
 buffer_load_dwordx4 a[100:103], v5, s[8:11], s44 offen offset:0 sc1
 buffer_load_dwordx4 a[104:107], v6, s[8:11], s44 offen offset:0 sc1
 buffer_load_dwordx4 a[108:111], v7, s[8:11], s44 offen offset:0 sc1
 buffer_load_dwordx4 a[112:115], v4, s[8:11], s44 offen offset:1024 sc1
 buffer_load_dwordx4 a[116:119], v5, s[8:11], s44 offen offset:1024 sc1
 buffer_load_dwordx4 a[120:123], v6, s[8:11], s44 offen offset:1024 sc1
 buffer_load_dwordx4 a[124:127], v7, s[8:11], s44 offen offset:1024 sc1
 s_add_u32 s44, s42, 26624
 s_and_b32 s44, s44, 0x7fff
 s_add_u32 s44, s44, s43
 buffer_load_dwordx4 a[128:131], v4, s[8:11], s44 offen offset:0 sc1
 buffer_load_dwordx4 a[132:135], v5, s[8:11], s44 offen offset:0 sc1
 buffer_load_dwordx4 a[136:139], v6, s[8:11], s44 offen offset:0 sc1
 buffer_load_dwordx4 a[140:143], v7, s[8:11], s44 offen offset:0 sc1
 buffer_load_dwordx4 a[144:147], v4, s[8:11], s44 offen offset:1024 sc1
 buffer_load_dwordx4 a[148:151], v5, s[8:11], s44 offen offset:1024 sc1
 buffer_load_dwordx4 a[152:155], v6, s[8:11], s44 offen offset:1024 sc1
 buffer_load_dwordx4 a[156:159], v7, s[8:11], s44 offen offset:1024 sc1
 s_add_u32 s44, s42, 28672
 s_and_b32 s44, s44, 0x7fff
 s_add_u32 s44, s44, s43
 buffer_load_dwordx4 a[160:163], v4, s[8:11], s44 offen offset:0 sc1
 buffer_load_dwordx4 a[164:167], v5, s[8:11], s44 offen offset:0 sc1
 buffer_load_dwordx4 a[168:171], v6, s[8:11], s44 offen offset:0 sc1
 buffer_load_dwordx4 a[172:175], v7, s[8:11], s44 offen offset:0 sc1
 buffer_load_dwordx4 a[184:187], v4, s[8:11], s44 offen offset:1024 sc1
 buffer_load_dwordx4 a[188:191], v5, s[8:11], s44 offen offset:1024 sc1
 buffer_load_dwordx4 a[192:195], v6, s[8:11], s44 offen offset:1024 sc1
 buffer_load_dwordx4 a[196:199], v7, s[8:11], s44 offen offset:1024 sc1
 s_lshl_b32 s5, s40, 2
 s_add_u32 s5, s5, s3
 s_lshl_b32 s5, s5, 14
 s_lshl_b32 s4, s41, 11
 s_add_u32 s4, s4, s5
 s_add_u32 s4, s4, 62914560
 s_add_u32 s24, s60, s4
 s_addc_u32 s25, s61, 0
 s_mov_b32 s26, 2048
 s_mov_b32 s27, 0x20000
 s_lshr_b32 s5, s5, 4
 s_lshl_b32 s4, s41, 7
 s_add_u32 s4, s4, s5
 s_add_u32 s4, s4, 65011712
 s_add_u32 s88, s60, s4
 s_addc_u32 s89, s61, 0
 s_mov_b32 s90, 128
 s_mov_b32 s91, 0x20000
 s_mov_b32 s101, 0x40000
L_spin_255:
 buffer_load_dword v2, v11, s[96:99], 0 offen sc1
 s_waitcnt vmcnt(0)
 v_cmp_ne_u32 vcc, s100, v2
 s_nop 0
 s_cbranch_vccz L_ok_256
 s_sleep 1
 s_sub_u32 s101, s101, 1
 s_cmp_lg_u32 s101, 0
 s_cbranch_scc1 L_spin_255
L_ok_256:
 s_add_u32 s44, s42, 0
 s_and_b32 s44, s44, 0x7fff
 s_add_u32 s44, s44, s43
 buffer_load_dwordx4 a[16:19], v4, s[20:23], s44 offen offset:0 sc1
 buffer_load_dwordx4 a[20:23], v5, s[20:23], s44 offen offset:0 sc1
 buffer_load_dwordx4 a[24:27], v6, s[20:23], s44 offen offset:0 sc1
 buffer_load_dwordx4 a[28:31], v7, s[20:23], s44 offen offset:0 sc1
 buffer_load_dwordx4 a[32:35], v4, s[20:23], s44 offen offset:1024 sc1
 buffer_load_dwordx4 a[36:39], v5, s[20:23], s44 offen offset:1024 sc1
 buffer_load_dwordx4 a[40:43], v6, s[20:23], s44 offen offset:1024 sc1
 buffer_load_dwordx4 a[44:47], v7, s[20:23], s44 offen offset:1024 sc1
 s_add_u32 s44, s42, 2048
 s_and_b32 s44, s44, 0x7fff
 s_add_u32 s44, s44, s43
 buffer_load_dwordx4 a[48:51], v4, s[20:23], s44 offen offset:0 sc1
 buffer_load_dwordx4 a[52:55], v5, s[20:23], s44 offen offset:0 sc1
 buffer_load_dwordx4 a[56:59], v6, s[20:23], s44 offen offset:0 sc1
 buffer_load_dwordx4 a[60:63], v7, s[20:23], s44 offen offset:0 sc1
 buffer_load_dwordx4 a[80:83], v4, s[20:23], s44 offen offset:1024 sc1
 buffer_load_dwordx4 a[84:87], v5, s[20:23], s44 offen offset:1024 sc1
 buffer_load_dwordx4 a[88:91], v6, s[20:23], s44 offen offset:1024 sc1
 buffer_load_dwordx4 a[92:95], v7, s[20:23], s44 offen offset:1024 sc1
 s_add_u32 s44, s42, 4096
 s_and_b32 s44, s44, 0x7fff
 s_add_u32 s44, s44, s43
 buffer_load_dwordx4 a[200:203], v4, s[20:23], s44 offen offset:0 sc1
 buffer_load_dwordx4 a[204:207], v5, s[20:23], s44 offen offset:0 sc1
 s_waitcnt vmcnt(10)
 v_mfma_f32_16x16x32_bf16 v[160:163], a[208:211], a[16:19], 0
 v_mfma_f32_16x16x32_bf16 v[160:163], a[224:227], a[32:35], v[160:163]
 v_mfma_f32_16x16x32_bf16 v[176:179], a[224:227], a[36:39], 0
 v_mfma_f32_16x16x32_bf16 v[176:179], a[208:211], a[20:23], v[176:179]
 v_mfma_f32_16x16x32_bf16 v[192:195], a[208:211], a[24:27], 0
 v_mfma_f32_16x16x32_bf16 v[192:195], a[224:227], a[40:43], v[192:195]
 v_mfma_f32_16x16x32_bf16 v[208:211], a[224:227], a[44:47], 0
 v_mfma_f32_16x16x32_bf16 v[208:211], a[208:211], a[28:31], v[208:211]
 v_mfma_f32_16x16x32_bf16 v[212:215], a[212:215], a[28:31], 0
 v_mfma_f32_16x16x32_bf16 v[212:215], a[228:231], a[44:47], v[212:215]
 v_mfma_f32_16x16x32_bf16 v[196:199], a[228:231], a[40:43], 0
 v_mfma_f32_16x16x32_bf16 v[196:199], a[212:215], a[24:27], v[196:199]
 v_mfma_f32_16x16x32_bf16 v[180:183], a[212:215], a[20:23], 0
 v_mfma_f32_16x16x32_bf16 v[180:183], a[228:231], a[36:39], v[180:183]
 v_mfma_f32_16x16x32_bf16 v[164:167], a[228:231], a[32:35], 0
 v_mfma_f32_16x16x32_bf16 v[164:167], a[212:215], a[16:19], v[164:167]
 v_mfma_f32_16x16x32_bf16 v[168:171], a[216:219], a[16:19], 0
 v_mfma_f32_16x16x32_bf16 v[168:171], a[232:235], a[32:35], v[168:171]
 v_mfma_f32_16x16x32_bf16 v[184:187], a[232:235], a[36:39], 0
 v_mfma_f32_16x16x32_bf16 v[184:187], a[216:219], a[20:23], v[184:187]
 v_mfma_f32_16x16x32_bf16 v[200:203], a[216:219], a[24:27], 0
 v_mfma_f32_16x16x32_bf16 v[200:203], a[232:235], a[40:43], v[200:203]
 v_mfma_f32_16x16x32_bf16 v[216:219], a[232:235], a[44:47], 0
 v_mfma_f32_16x16x32_bf16 v[216:219], a[216:219], a[28:31], v[216:219]
 v_mfma_f32_16x16x32_bf16 v[220:223], a[220:223], a[28:31], 0
 v_mfma_f32_16x16x32_bf16 v[220:223], a[236:239], a[44:47], v[220:223]
 v_mfma_f32_16x16x32_bf16 v[204:207], a[236:239], a[40:43], 0
 v_mfma_f32_16x16x32_bf16 v[204:207], a[220:223], a[24:27], v[204:207]
 v_mfma_f32_16x16x32_bf16 v[188:191], a[220:223], a[20:23], 0
 v_mfma_f32_16x16x32_bf16 v[188:191], a[236:239], a[36:39], v[188:191]
 v_mfma_f32_16x16x32_bf16 v[172:175], a[236:239], a[32:35], 0
 v_mfma_f32_16x16x32_bf16 v[172:175], a[220:223], a[16:19], v[172:175]
 s_waitcnt vmcnt(2)
 v_mfma_f32_16x16x32_bf16 v[160:163], a[240:243], a[48:51], v[160:163]
 s_add_u32 s44, s42, 4096
 s_and_b32 s44, s44, 0x7fff
 s_add_u32 s44, s44, s43
 v_mfma_f32_16x16x32_bf16 v[160:163], a[0:3], a[80:83], v[160:163]
 buffer_load_dwordx4 a[16:19], v6, s[20:23], s44 offen offset:0 sc1
 v_mfma_f32_16x16x32_bf16 v[176:179], a[0:3], a[84:87], v[176:179]
 buffer_load_dwordx4 a[20:23], v7, s[20:23], s44 offen offset:0 sc1
 v_mfma_f32_16x16x32_bf16 v[176:179], a[240:243], a[52:55], v[176:179]
 buffer_load_dwordx4 a[24:27], v4, s[20:23], s44 offen offset:1024 sc1
 v_mfma_f32_16x16x32_bf16 v[192:195], a[240:243], a[56:59], v[192:195]
 v_mfma_f32_16x16x32_bf16 v[192:195], a[0:3], a[88:91], v[192:195]
 v_mfma_f32_16x16x32_bf16 v[208:211], a[0:3], a[92:95], v[208:211]
 v_mfma_f32_16x16x32_bf16 v[208:211], a[240:243], a[60:63], v[208:211]
 v_mfma_f32_16x16x32_bf16 v[212:215], a[244:247], a[60:63], v[212:215]
 v_mfma_f32_16x16x32_bf16 v[212:215], a[4:7], a[92:95], v[212:215]
 buffer_load_dwordx4 a[28:31], v5, s[20:23], s44 offen offset:1024 sc1
 v_mfma_f32_16x16x32_bf16 v[196:199], a[4:7], a[88:91], v[196:199]
 buffer_load_dwordx4 a[32:35], v6, s[20:23], s44 offen offset:1024 sc1
 v_mfma_f32_16x16x32_bf16 v[196:199], a[244:247], a[56:59], v[196:199]
 buffer_load_dwordx4 a[36:39], v7, s[20:23], s44 offen offset:1024 sc1
 v_mfma_f32_16x16x32_bf16 v[180:183], a[244:247], a[52:55], v[180:183]
 v_mfma_f32_16x16x32_bf16 v[180:183], a[4:7], a[84:87], v[180:183]
 v_mfma_f32_16x16x32_bf16 v[164:167], a[4:7], a[80:83], v[164:167]
 v_mfma_f32_16x16x32_bf16 v[164:167], a[244:247], a[48:51], v[164:167]
 v_mfma_f32_16x16x32_bf16 v[168:171], a[248:251], a[48:51], v[168:171]
 s_add_u32 s44, s42, 6144
 s_and_b32 s44, s44, 0x7fff
 s_add_u32 s44, s44, s43
 v_mfma_f32_16x16x32_bf16 v[168:171], a[8:11], a[80:83], v[168:171]
 buffer_load_dwordx4 a[40:43], v4, s[20:23], s44 offen offset:0 sc1
 v_mfma_f32_16x16x32_bf16 v[184:187], a[8:11], a[84:87], v[184:187]
 v_mfma_f32_16x16x32_bf16 v[184:187], a[248:251], a[52:55], v[184:187]
 v_mfma_f32_16x16x32_bf16 v[200:203], a[248:251], a[56:59], v[200:203]
 buffer_load_dwordx4 a[44:47], v5, s[20:23], s44 offen offset:0 sc1
 v_mfma_f32_16x16x32_bf16 v[200:203], a[8:11], a[88:91], v[200:203]
 v_mfma_f32_16x16x32_bf16 v[216:219], a[8:11], a[92:95], v[216:219]
 v_mfma_f32_16x16x32_bf16 v[216:219], a[248:251], a[60:63], v[216:219]
 buffer_load_dwordx4 a[208:211], v6, s[20:23], s44 offen offset:0 sc1
 v_mfma_f32_16x16x32_bf16 v[220:223], a[252:255], a[60:63], v[220:223]
 v_mfma_f32_16x16x32_bf16 v[220:223], a[12:15], a[92:95], v[220:223]
 v_mfma_f32_16x16x32_bf16 v[204:207], a[12:15], a[88:91], v[204:207]
 v_mfma_f32_16x16x32_bf16 v[204:207], a[252:255], a[56:59], v[204:207]
 v_mfma_f32_16x16x32_bf16 v[188:191], a[252:255], a[52:55], v[188:191]
 v_mfma_f32_16x16x32_bf16 v[188:191], a[12:15], a[84:87], v[188:191]
 v_mfma_f32_16x16x32_bf16 v[172:175], a[12:15], a[80:83], v[172:175]
 v_mfma_f32_16x16x32_bf16 v[172:175], a[252:255], a[48:51], v[172:175]
 s_waitcnt vmcnt(3)
 v_mfma_f32_16x16x32_bf16 v[160:163], v[96:99], a[200:203], v[160:163]
 s_add_u32 s44, s42, 6144
 s_and_b32 s44, s44, 0x7fff
 s_add_u32 s44, s44, s43
 v_mfma_f32_16x16x32_bf16 v[160:163], v[112:115], a[24:27], v[160:163]
 buffer_load_dwordx4 a[212:215], v7, s[20:23], s44 offen offset:0 sc1
 v_mfma_f32_16x16x32_bf16 v[176:179], v[112:115], a[28:31], v[176:179]
 buffer_load_dwordx4 a[216:219], v4, s[20:23], s44 offen offset:1024 sc1
 v_mfma_f32_16x16x32_bf16 v[176:179], v[96:99], a[204:207], v[176:179]
 buffer_load_dwordx4 a[220:223], v5, s[20:23], s44 offen offset:1024 sc1
 v_mfma_f32_16x16x32_bf16 v[192:195], v[96:99], a[16:19], v[192:195]
 v_mfma_f32_16x16x32_bf16 v[192:195], v[112:115], a[32:35], v[192:195]
 v_mfma_f32_16x16x32_bf16 v[208:211], v[112:115], a[36:39], v[208:211]
 v_mfma_f32_16x16x32_bf16 v[208:211], v[96:99], a[20:23], v[208:211]
 v_mfma_f32_16x16x32_bf16 v[212:215], v[100:103], a[20:23], v[212:215]
 v_mfma_f32_16x16x32_bf16 v[212:215], v[116:119], a[36:39], v[212:215]
 buffer_load_dwordx4 a[224:227], v6, s[20:23], s44 offen offset:1024 sc1
 v_mfma_f32_16x16x32_bf16 v[196:199], v[116:119], a[32:35], v[196:199]
 buffer_load_dwordx4 a[228:231], v7, s[20:23], s44 offen offset:1024 sc1
 v_mfma_f32_16x16x32_bf16 v[196:199], v[100:103], a[16:19], v[196:199]
 v_mfma_f32_16x16x32_bf16 v[180:183], v[100:103], a[204:207], v[180:183]
 v_mfma_f32_16x16x32_bf16 v[180:183], v[116:119], a[28:31], v[180:183]
 s_add_u32 s44, s42, 8192
 s_and_b32 s44, s44, 0x7fff
 s_add_u32 s44, s44, s43
 v_mfma_f32_16x16x32_bf16 v[164:167], v[116:119], a[24:27], v[164:167]
 buffer_load_dwordx4 a[232:235], v4, s[20:23], s44 offen offset:0 sc1
 v_mfma_f32_16x16x32_bf16 v[164:167], v[100:103], a[200:203], v[164:167]
 v_mfma_f32_16x16x32_bf16 v[168:171], v[104:107], a[200:203], v[168:171]
 v_mfma_f32_16x16x32_bf16 v[168:171], v[120:123], a[24:27], v[168:171]
 buffer_load_dwordx4 a[236:239], v5, s[20:23], s44 offen offset:0 sc1
 v_mfma_f32_16x16x32_bf16 v[184:187], v[120:123], a[28:31], v[184:187]
 v_mfma_f32_16x16x32_bf16 v[184:187], v[104:107], a[204:207], v[184:187]
 v_mfma_f32_16x16x32_bf16 v[200:203], v[104:107], a[16:19], v[200:203]
 buffer_load_dwordx4 a[48:51], v6, s[20:23], s44 offen offset:0 sc1
 v_mfma_f32_16x16x32_bf16 v[200:203], v[120:123], a[32:35], v[200:203]
 v_mfma_f32_16x16x32_bf16 v[216:219], v[120:123], a[36:39], v[216:219]
 v_mfma_f32_16x16x32_bf16 v[216:219], v[104:107], a[20:23], v[216:219]
 buffer_load_dwordx4 a[52:55], v7, s[20:23], s44 offen offset:0 sc1
 v_mfma_f32_16x16x32_bf16 v[220:223], v[108:111], a[20:23], v[220:223]
 v_mfma_f32_16x16x32_bf16 v[220:223], v[124:127], a[36:39], v[220:223]
 v_mfma_f32_16x16x32_bf16 v[204:207], v[124:127], a[32:35], v[204:207]
 v_mfma_f32_16x16x32_bf16 v[204:207], v[108:111], a[16:19], v[204:207]
 v_mfma_f32_16x16x32_bf16 v[188:191], v[108:111], a[204:207], v[188:191]
 v_mfma_f32_16x16x32_bf16 v[188:191], v[124:127], a[28:31], v[188:191]
 v_mfma_f32_16x16x32_bf16 v[172:175], v[124:127], a[24:27], v[172:175]
 v_mfma_f32_16x16x32_bf16 v[172:175], v[108:111], a[200:203], v[172:175]
 s_waitcnt vmcnt(4)
 v_mfma_f32_16x16x32_bf16 v[160:163], v[128:131], a[40:43], v[160:163]
 s_add_u32 s44, s42, 8192
 s_and_b32 s44, s44, 0x7fff
 s_add_u32 s44, s44, s43
 v_mfma_f32_16x16x32_bf16 v[160:163], v[144:147], a[216:219], v[160:163]
 buffer_load_dwordx4 a[56:59], v4, s[20:23], s44 offen offset:1024 sc1
 v_mfma_f32_16x16x32_bf16 v[176:179], v[144:147], a[220:223], v[176:179]
 buffer_load_dwordx4 a[60:63], v5, s[20:23], s44 offen offset:1024 sc1
 v_mfma_f32_16x16x32_bf16 v[176:179], v[128:131], a[44:47], v[176:179]
 buffer_load_dwordx4 a[80:83], v6, s[20:23], s44 offen offset:1024 sc1
 v_mfma_f32_16x16x32_bf16 v[192:195], v[128:131], a[208:211], v[192:195]
 v_mfma_f32_16x16x32_bf16 v[192:195], v[144:147], a[224:227], v[192:195]
 v_mfma_f32_16x16x32_bf16 v[208:211], v[144:147], a[228:231], v[208:211]
 v_mfma_f32_16x16x32_bf16 v[208:211], v[128:131], a[212:215], v[208:211]
 v_mfma_f32_16x16x32_bf16 v[212:215], v[132:135], a[212:215], v[212:215]
 v_mfma_f32_16x16x32_bf16 v[212:215], v[148:151], a[228:231], v[212:215]
 buffer_load_dwordx4 a[84:87], v7, s[20:23], s44 offen offset:1024 sc1
 v_mfma_f32_16x16x32_bf16 v[196:199], v[148:151], a[224:227], v[196:199]
 v_mfma_f32_16x16x32_bf16 v[196:199], v[132:135], a[208:211], v[196:199]
 s_add_u32 s44, s42, 10240
 s_and_b32 s44, s44, 0x7fff
 s_add_u32 s44, s44, s43
 v_mfma_f32_16x16x32_bf16 v[180:183], v[132:135], a[44:47], v[180:183]
 buffer_load_dwordx4 a[88:91], v4, s[20:23], s44 offen offset:0 sc1
 v_mfma_f32_16x16x32_bf16 v[180:183], v[148:151], a[220:223], v[180:183]
 v_mfma_f32_16x16x32_bf16 v[164:167], v[148:151], a[216:219], v[164:167]
 buffer_load_dwordx4 a[92:95], v5, s[20:23], s44 offen offset:0 sc1
 v_mfma_f32_16x16x32_bf16 v[164:167], v[132:135], a[40:43], v[164:167]
 v_mfma_f32_16x16x32_bf16 v[168:171], v[136:139], a[40:43], v[168:171]
 v_mfma_f32_16x16x32_bf16 v[168:171], v[152:155], a[216:219], v[168:171]
 buffer_load_dwordx4 a[240:243], v6, s[20:23], s44 offen offset:0 sc1
 v_mfma_f32_16x16x32_bf16 v[184:187], v[152:155], a[220:223], v[184:187]
 v_mfma_f32_16x16x32_bf16 v[184:187], v[136:139], a[44:47], v[184:187]
 v_mfma_f32_16x16x32_bf16 v[200:203], v[136:139], a[208:211], v[200:203]
 buffer_load_dwordx4 a[244:247], v7, s[20:23], s44 offen offset:0 sc1
 v_mfma_f32_16x16x32_bf16 v[200:203], v[152:155], a[224:227], v[200:203]
 v_mfma_f32_16x16x32_bf16 v[216:219], v[152:155], a[228:231], v[216:219]
 v_mfma_f32_16x16x32_bf16 v[216:219], v[136:139], a[212:215], v[216:219]
 buffer_load_dwordx4 a[248:251], v4, s[20:23], s44 offen offset:1024 sc1
 v_mfma_f32_16x16x32_bf16 v[220:223], v[140:143], a[212:215], v[220:223]
 v_mfma_f32_16x16x32_bf16 v[220:223], v[156:159], a[228:231], v[220:223]
 v_mfma_f32_16x16x32_bf16 v[204:207], v[156:159], a[224:227], v[204:207]
 v_mfma_f32_16x16x32_bf16 v[204:207], v[140:143], a[208:211], v[204:207]
 v_mfma_f32_16x16x32_bf16 v[188:191], v[140:143], a[44:47], v[188:191]
 v_mfma_f32_16x16x32_bf16 v[188:191], v[156:159], a[220:223], v[188:191]
 v_mfma_f32_16x16x32_bf16 v[172:175], v[156:159], a[216:219], v[172:175]
 v_mfma_f32_16x16x32_bf16 v[172:175], v[140:143], a[40:43], v[172:175]
 s_waitcnt vmcnt(5)
 v_mfma_f32_16x16x32_bf16 v[160:163], a[64:67], a[232:235], v[160:163]
 s_add_u32 s44, s42, 10240
 s_and_b32 s44, s44, 0x7fff
 s_add_u32 s44, s44, s43
 v_mfma_f32_16x16x32_bf16 v[160:163], a[176:179], a[56:59], v[160:163]
 buffer_load_dwordx4 a[252:255], v5, s[20:23], s44 offen offset:1024 sc1
 v_mfma_f32_16x16x32_bf16 v[176:179], a[176:179], a[60:63], v[176:179]
 buffer_load_dwordx4 a[0:3], v6, s[20:23], s44 offen offset:1024 sc1
 v_mfma_f32_16x16x32_bf16 v[176:179], a[64:67], a[236:239], v[176:179]
 ds_read_b128 v[16:19], v8 offset:0
 v_mfma_f32_16x16x32_bf16 v[192:195], a[64:67], a[48:51], v[192:195]
 ds_read_b128 v[20:23], v8 offset:1024
 v_mfma_f32_16x16x32_bf16 v[192:195], a[176:179], a[80:83], v[192:195]
 ds_read_b128 v[24:27], v8 offset:2048
 v_mfma_f32_16x16x32_bf16 v[208:211], a[176:179], a[84:87], v[208:211]
 ds_read_b128 v[28:31], v8 offset:3072
 v_mfma_f32_16x16x32_bf16 v[208:211], a[64:67], a[52:55], v[208:211]
 v_mfma_f32_16x16x32_bf16 v[212:215], a[68:71], a[52:55], v[212:215]
 v_mfma_f32_16x16x32_bf16 v[212:215], a[180:183], a[84:87], v[212:215]
 ds_read_b128 v[40:43], v8 offset:4096
 v_mfma_f32_16x16x32_bf16 v[196:199], a[180:183], a[80:83], v[196:199]
 buffer_load_dwordx4 a[4:7], v7, s[20:23], s44 offen offset:1024 sc1
 v_mfma_f32_16x16x32_bf16 v[196:199], a[68:71], a[48:51], v[196:199]
 s_add_u32 s44, s42, 12288
 s_and_b32 s44, s44, 0x7fff
 s_add_u32 s44, s44, s43
 v_mfma_f32_16x16x32_bf16 v[180:183], a[68:71], a[236:239], v[180:183]
 buffer_load_dwordx4 a[8:11], v4, s[20:23], s44 offen offset:0 sc1
 v_mfma_f32_16x16x32_bf16 v[180:183], a[180:183], a[60:63], v[180:183]
 buffer_load_dwordx4 a[12:15], v5, s[20:23], s44 offen offset:0 sc1
 v_mfma_f32_16x16x32_bf16 v[164:167], a[180:183], a[56:59], v[164:167]
 buffer_load_dwordx4 a[200:203], v6, s[20:23], s44 offen offset:0 sc1
 v_mfma_f32_16x16x32_bf16 v[164:167], a[68:71], a[232:235], v[164:167]
 ds_read_b128 v[44:47], v8 offset:5120
 v_mfma_f32_16x16x32_bf16 v[168:171], a[72:75], a[232:235], v[168:171]
 ds_read_b128 v[48:51], v8 offset:6144
 v_mfma_f32_16x16x32_bf16 v[168:171], v[32:35], a[56:59], v[168:171]
 buffer_load_dwordx4 a[204:207], v7, s[20:23], s44 offen offset:0 sc1
 v_mfma_f32_16x16x32_bf16 v[184:187], v[32:35], a[60:63], v[184:187]
 ds_read_b128 v[52:55], v8 offset:7168
 v_mfma_f32_16x16x32_bf16 v[184:187], a[72:75], a[236:239], v[184:187]
 v_mfma_f32_16x16x32_bf16 v[200:203], a[72:75], a[48:51], v[200:203]
 buffer_load_dwordx4 a[16:19], v4, s[20:23], s44 offen offset:1024 sc1
 v_mfma_f32_16x16x32_bf16 v[200:203], v[32:35], a[80:83], v[200:203]
 v_mfma_f32_16x16x32_bf16 v[216:219], v[32:35], a[84:87], v[216:219]
 v_mfma_f32_16x16x32_bf16 v[216:219], a[72:75], a[52:55], v[216:219]
 buffer_load_dwordx4 a[20:23], v5, s[20:23], s44 offen offset:1024 sc1
 v_mfma_f32_16x16x32_bf16 v[220:223], a[76:79], a[52:55], v[220:223]
 v_mfma_f32_16x16x32_bf16 v[220:223], v[36:39], a[84:87], v[220:223]
 v_mfma_f32_16x16x32_bf16 v[204:207], v[36:39], a[80:83], v[204:207]
 v_mfma_f32_16x16x32_bf16 v[204:207], a[76:79], a[48:51], v[204:207]
 v_mfma_f32_16x16x32_bf16 v[188:191], a[76:79], a[236:239], v[188:191]
 v_mfma_f32_16x16x32_bf16 v[188:191], v[36:39], a[60:63], v[188:191]
 v_mfma_f32_16x16x32_bf16 v[172:175], v[36:39], a[56:59], v[172:175]
 v_mfma_f32_16x16x32_bf16 v[172:175], a[76:79], a[232:235], v[172:175]
 s_waitcnt vmcnt(6)
 s_waitcnt lgkmcnt(0)
 v_mfma_f32_16x16x32_bf16 v[160:163], v[16:19], a[88:91], v[160:163]
 v_mfma_f32_16x16x32_bf16 v[160:163], v[20:23], a[248:251], v[160:163]
 s_add_u32 s44, s42, 12288
 s_and_b32 s44, s44, 0x7fff
 s_add_u32 s44, s44, s43
 v_mfma_f32_16x16x32_bf16 v[176:179], v[20:23], a[252:255], v[176:179]
 buffer_load_dwordx4 a[24:27], v6, s[20:23], s44 offen offset:1024 sc1
 v_mfma_f32_16x16x32_bf16 v[176:179], v[16:19], a[92:95], v[176:179]
 buffer_load_dwordx4 a[28:31], v7, s[20:23], s44 offen offset:1024 sc1
 v_mfma_f32_16x16x32_bf16 v[192:195], v[16:19], a[240:243], v[192:195]
 ds_read_b128 v[32:35], v9 offset:0
 v_mfma_f32_16x16x32_bf16 v[192:195], v[20:23], a[0:3], v[192:195]
 ds_read_b128 v[36:39], v9 offset:1024
 v_mfma_f32_16x16x32_bf16 v[208:211], v[20:23], a[4:7], v[208:211]
 v_mfma_f32_16x16x32_bf16 v[208:211], v[16:19], a[244:247], v[208:211]
 v_mfma_f32_16x16x32_bf16 v[212:215], v[24:27], a[244:247], v[212:215]
 ds_read_b128 v[16:19], v9 offset:2048
 v_mfma_f32_16x16x32_bf16 v[212:215], v[28:31], a[4:7], v[212:215]
 ds_read_b128 v[20:23], v9 offset:3072
 v_mfma_f32_16x16x32_bf16 v[196:199], v[28:31], a[0:3], v[196:199]
 s_add_u32 s44, s42, 14336
 s_and_b32 s44, s44, 0x7fff
 s_add_u32 s44, s44, s43
 v_mfma_f32_16x16x32_bf16 v[196:199], v[24:27], a[240:243], v[196:199]
 buffer_load_dwordx4 a[32:35], v4, s[20:23], s44 offen offset:0 sc1
 v_mfma_f32_16x16x32_bf16 v[180:183], v[24:27], a[92:95], v[180:183]
 buffer_load_dwordx4 a[36:39], v5, s[20:23], s44 offen offset:0 sc1
 v_mfma_f32_16x16x32_bf16 v[180:183], v[28:31], a[252:255], v[180:183]
 buffer_load_dwordx4 v[96:99], v6, s[20:23], s44 offen offset:0 sc1
 v_mfma_f32_16x16x32_bf16 v[164:167], v[28:31], a[248:251], v[164:167]
 buffer_load_dwordx4 v[100:103], v7, s[20:23], s44 offen offset:0 sc1
 v_mfma_f32_16x16x32_bf16 v[164:167], v[24:27], a[88:91], v[164:167]
 v_mfma_f32_16x16x32_bf16 v[168:171], v[40:43], a[88:91], v[168:171]
 ds_read_b128 v[24:27], v9 offset:4096
 v_mfma_f32_16x16x32_bf16 v[168:171], v[44:47], a[248:251], v[168:171]
 buffer_load_dwordx4 v[104:107], v4, s[20:23], s44 offen offset:1024 sc1
 v_mfma_f32_16x16x32_bf16 v[184:187], v[44:47], a[252:255], v[184:187]
 v_mfma_f32_16x16x32_bf16 v[184:187], v[40:43], a[92:95], v[184:187]
 v_mfma_f32_16x16x32_bf16 v[200:203], v[40:43], a[240:243], v[200:203]
 v_mfma_f32_16x16x32_bf16 v[200:203], v[44:47], a[0:3], v[200:203]
 buffer_load_dwordx4 v[108:111], v5, s[20:23], s44 offen offset:1024 sc1
 v_mfma_f32_16x16x32_bf16 v[216:219], v[44:47], a[4:7], v[216:219]
 ds_read_b128 v[28:31], v9 offset:5120
 v_mfma_f32_16x16x32_bf16 v[216:219], v[40:43], a[244:247], v[216:219]
 buffer_load_dwordx4 v[112:115], v6, s[20:23], s44 offen offset:1024 sc1
 v_mfma_f32_16x16x32_bf16 v[220:223], v[48:51], a[244:247], v[220:223]
 ds_read_b128 v[40:43], v9 offset:6144
 v_mfma_f32_16x16x32_bf16 v[220:223], v[52:55], a[4:7], v[220:223]
 ds_read_b128 v[44:47], v9 offset:7168
 v_mfma_f32_16x16x32_bf16 v[204:207], v[52:55], a[0:3], v[204:207]
 v_mfma_f32_16x16x32_bf16 v[204:207], v[48:51], a[240:243], v[204:207]
 v_mfma_f32_16x16x32_bf16 v[188:191], v[48:51], a[92:95], v[188:191]
 v_mfma_f32_16x16x32_bf16 v[188:191], v[52:55], a[252:255], v[188:191]
 v_mfma_f32_16x16x32_bf16 v[172:175], v[52:55], a[248:251], v[172:175]
 v_mfma_f32_16x16x32_bf16 v[172:175], v[48:51], a[88:91], v[172:175]
 s_waitcnt vmcnt(7)
 s_waitcnt lgkmcnt(4)
 v_mfma_f32_16x16x32_bf16 v[160:163], v[32:35], a[8:11], v[160:163]
 v_mfma_f32_16x16x32_bf16 v[160:163], v[36:39], a[16:19], v[160:163]
 ds_read_b128 v[48:51], v10 offset:0
 v_add_u32 v8, s38, v4
 v_mfma_f32_16x16x32_bf16 v[176:179], v[36:39], a[20:23], v[176:179]
 ds_read_b128 v[52:55], v10 offset:1024
 v_mfma_f32_16x16x32_bf16 v[176:179], v[32:35], a[12:15], v[176:179]
 v_mfma_f32_16x16x32_bf16 v[192:195], v[32:35], a[200:203], v[192:195]
 v_mfma_f32_16x16x32_bf16 v[192:195], v[36:39], a[24:27], v[192:195]
 v_mfma_f32_16x16x32_bf16 v[208:211], v[36:39], a[28:31], v[208:211]
 v_mfma_f32_16x16x32_bf16 v[208:211], v[32:35], a[204:207], v[208:211]
 v_mfma_f32_16x16x32_bf16 v[212:215], v[16:19], a[204:207], v[212:215]
 ds_read_b128 v[32:35], v10 offset:2048
 v_mfma_f32_16x16x32_bf16 v[212:215], v[20:23], a[28:31], v[212:215]
 s_add_u32 s44, s42, 14336
 s_and_b32 s44, s44, 0x7fff
 s_add_u32 s44, s44, s43
 v_mfma_f32_16x16x32_bf16 v[196:199], v[20:23], a[24:27], v[196:199]
 buffer_load_dwordx4 v[116:119], v7, s[20:23], s44 offen offset:1024 sc1
 v_mfma_f32_16x16x32_bf16 v[196:199], v[16:19], a[200:203], v[196:199]
 ds_read_b128 v[36:39], v10 offset:3072
 v_mfma_f32_16x16x32_bf16 v[180:183], v[16:19], a[12:15], v[180:183]
 v_mfma_f32_16x16x32_bf16 v[180:183], v[20:23], a[20:23], v[180:183]
 v_mfma_f32_16x16x32_bf16 v[164:167], v[20:23], a[16:19], v[164:167]
 v_mfma_f32_16x16x32_bf16 v[164:167], v[16:19], a[8:11], v[164:167]
 s_waitcnt lgkmcnt(2)
 v_mfma_f32_16x16x32_bf16 v[168:171], v[24:27], a[8:11], v[168:171]
 ds_read_b128 v[16:19], v10 offset:4096
 v_mfma_f32_16x16x32_bf16 v[168:171], v[28:31], a[16:19], v[168:171]
 ds_read_b128 v[20:23], v10 offset:5120
 v_mfma_f32_16x16x32_bf16 v[184:187], v[28:31], a[20:23], v[184:187]
 s_add_u32 s44, s42, 16384
 s_and_b32 s44, s44, 0x7fff
 s_add_u32 s44, s44, s43
 v_mfma_f32_16x16x32_bf16 v[184:187], v[24:27], a[12:15], v[184:187]
 buffer_load_dwordx4 v[120:123], v4, s[20:23], s44 offen offset:0 sc1
 v_mfma_f32_16x16x32_bf16 v[200:203], v[24:27], a[200:203], v[200:203]
 buffer_load_dwordx4 v[124:127], v5, s[20:23], s44 offen offset:0 sc1
 v_mfma_f32_16x16x32_bf16 v[200:203], v[28:31], a[24:27], v[200:203]
 buffer_load_dwordx4 a[40:43], v6, s[20:23], s44 offen offset:0 sc1
 v_mfma_f32_16x16x32_bf16 v[216:219], v[28:31], a[28:31], v[216:219]
 buffer_load_dwordx4 a[44:47], v7, s[20:23], s44 offen offset:0 sc1
 v_mfma_f32_16x16x32_bf16 v[216:219], v[24:27], a[204:207], v[216:219]
 buffer_load_dwordx4 a[208:211], v4, s[20:23], s44 offen offset:1024 sc1
 v_mfma_f32_16x16x32_bf16 v[220:223], v[40:43], a[204:207], v[220:223]
 buffer_load_dwordx4 a[212:215], v5, s[20:23], s44 offen offset:1024 sc1
 v_mfma_f32_16x16x32_bf16 v[220:223], v[44:47], a[28:31], v[220:223]
 buffer_load_dwordx4 a[216:219], v6, s[20:23], s44 offen offset:1024 sc1
 v_mfma_f32_16x16x32_bf16 v[204:207], v[44:47], a[24:27], v[204:207]
 buffer_load_dwordx4 a[220:223], v7, s[20:23], s44 offen offset:1024 sc1
 v_mfma_f32_16x16x32_bf16 v[204:207], v[40:43], a[200:203], v[204:207]
 ds_read_b128 v[24:27], v10 offset:6144
 v_mfma_f32_16x16x32_bf16 v[188:191], v[40:43], a[12:15], v[188:191]
 ds_read_b128 v[28:31], v10 offset:7168
 v_mfma_f32_16x16x32_bf16 v[188:191], v[44:47], a[20:23], v[188:191]
 v_mfma_f32_16x16x32_bf16 v[172:175], v[44:47], a[16:19], v[172:175]
 v_mfma_f32_16x16x32_bf16 v[172:175], v[40:43], a[8:11], v[172:175]
 s_waitcnt vmcnt(8)
 v_mfma_f32_16x16x32_bf16 v[160:163], v[48:51], a[32:35], v[160:163]
 v_mfma_f32_16x16x32_bf16 v[160:163], v[52:55], v[104:107], v[160:163]
 ds_read_b128 v[40:43], v8 offset:0
 v_add_u32 v9, s39, v4
 v_mfma_f32_16x16x32_bf16 v[176:179], v[52:55], v[108:111], v[176:179]
 s_mov_b32 m0, s45
 s_mov_b32 s4, 7168
 v_mfma_f32_16x16x32_bf16 v[176:179], v[48:51], a[36:39], v[176:179]
 buffer_load_dwordx4 v12, s[28:31], 0 offen offset:0 lds
 v_mfma_f32_16x16x32_bf16 v[192:195], v[48:51], v[96:99], v[192:195]
 buffer_load_dwordx4 v12, s[28:31], s4 offen offset:1024 lds
 v_mfma_f32_16x16x32_bf16 v[192:195], v[52:55], v[112:115], v[192:195]
 ds_read_b128 v[44:47], v8 offset:1024
 v_mfma_f32_16x16x32_bf16 v[208:211], v[52:55], v[116:119], v[208:211]
 v_mfma_f32_16x16x32_bf16 v[208:211], v[48:51], v[100:103], v[208:211]
 s_waitcnt lgkmcnt(2)
 v_mfma_f32_16x16x32_bf16 v[212:215], v[32:35], v[100:103], v[212:215]
 ds_read_b128 v[48:51], v8 offset:2048
 v_mfma_f32_16x16x32_bf16 v[212:215], v[36:39], v[116:119], v[212:215]
 ds_read_b128 v[52:55], v8 offset:3072
 v_mfma_f32_16x16x32_bf16 v[196:199], v[36:39], v[112:115], v[196:199]
 s_add_u32 s44, s42, 18432
 s_and_b32 s44, s44, 0x7fff
 s_add_u32 s44, s44, s43
 v_mfma_f32_16x16x32_bf16 v[196:199], v[32:35], v[96:99], v[196:199]
 buffer_load_dwordx4 a[224:227], v4, s[20:23], s44 offen offset:0 sc1
 v_mfma_f32_16x16x32_bf16 v[180:183], v[32:35], a[36:39], v[180:183]
 buffer_load_dwordx4 a[228:231], v5, s[20:23], s44 offen offset:0 sc1
 v_mfma_f32_16x16x32_bf16 v[180:183], v[36:39], v[108:111], v[180:183]
 buffer_load_dwordx4 v[128:131], v6, s[20:23], s44 offen offset:0 sc1
 v_mfma_f32_16x16x32_bf16 v[164:167], v[36:39], v[104:107], v[164:167]
 buffer_load_dwordx4 v[132:135], v7, s[20:23], s44 offen offset:0 sc1
 v_mfma_f32_16x16x32_bf16 v[164:167], v[32:35], a[32:35], v[164:167]
 buffer_load_dwordx4 v[136:139], v4, s[20:23], s44 offen offset:1024 sc1
 v_mfma_f32_16x16x32_bf16 v[168:171], v[16:19], a[32:35], v[168:171]
 buffer_load_dwordx4 v[140:143], v5, s[20:23], s44 offen offset:1024 sc1
 v_mfma_f32_16x16x32_bf16 v[168:171], v[20:23], v[104:107], v[168:171]
 buffer_load_dwordx4 v[144:147], v6, s[20:23], s44 offen offset:1024 sc1
 v_mfma_f32_16x16x32_bf16 v[184:187], v[20:23], v[108:111], v[184:187]
 ds_read_b128 v[32:35], v8 offset:4096
 v_mfma_f32_16x16x32_bf16 v[184:187], v[16:19], a[36:39], v[184:187]
 buffer_load_dwordx4 v[148:151], v7, s[20:23], s44 offen offset:1024 sc1
 v_mfma_f32_16x16x32_bf16 v[200:203], v[16:19], v[96:99], v[200:203]
 ds_read_b128 v[36:39], v8 offset:5120
 v_mfma_f32_16x16x32_bf16 v[200:203], v[20:23], v[112:115], v[200:203]
 v_mfma_f32_16x16x32_bf16 v[216:219], v[20:23], v[116:119], v[216:219]
 v_mfma_f32_16x16x32_bf16 v[216:219], v[16:19], v[100:103], v[216:219]
 s_add_u32 s44, s42, 20480
 s_and_b32 s44, s44, 0x7fff
 s_add_u32 s44, s44, s43
 v_mfma_f32_16x16x32_bf16 v[220:223], v[24:27], v[100:103], v[220:223]
 buffer_load_dwordx4 v[152:155], v4, s[20:23], s44 offen offset:0 sc1
 v_mfma_f32_16x16x32_bf16 v[220:223], v[28:31], v[116:119], v[220:223]
 ds_read_b128 v[16:19], v8 offset:6144
 v_mfma_f32_16x16x32_bf16 v[204:207], v[28:31], v[112:115], v[204:207]
 ds_read_b128 v[20:23], v8 offset:7168
 v_mfma_f32_16x16x32_bf16 v[204:207], v[24:27], v[96:99], v[204:207]
 v_mfma_f32_16x16x32_bf16 v[188:191], v[24:27], a[36:39], v[188:191]
 v_mfma_f32_16x16x32_bf16 v[188:191], v[28:31], v[108:111], v[188:191]
 v_mfma_f32_16x16x32_bf16 v[172:175], v[28:31], v[104:107], v[172:175]
 v_mfma_f32_16x16x32_bf16 v[172:175], v[24:27], a[32:35], v[172:175]
 s_waitcnt vmcnt(11)
 s_waitcnt lgkmcnt(2)
 v_mfma_f32_16x16x32_bf16 v[160:163], v[40:43], v[120:123], v[160:163]
 v_mfma_f32_16x16x32_bf16 v[160:163], v[44:47], a[208:211], v[160:163]
 s_add_u32 s44, s42, 20480
 s_and_b32 s44, s44, 0x7fff
 s_add_u32 s44, s44, s43
 v_mfma_f32_16x16x32_bf16 v[176:179], v[44:47], a[212:215], v[176:179]
 buffer_load_dwordx4 v[156:159], v5, s[20:23], s44 offen offset:0 sc1
 v_mfma_f32_16x16x32_bf16 v[176:179], v[40:43], v[124:127], v[176:179]
 buffer_load_dwordx4 a[232:235], v6, s[20:23], s44 offen offset:0 sc1
 v_mfma_f32_16x16x32_bf16 v[192:195], v[40:43], a[40:43], v[192:195]
 buffer_load_dwordx4 a[236:239], v7, s[20:23], s44 offen offset:0 sc1
 v_mfma_f32_16x16x32_bf16 v[192:195], v[44:47], a[216:219], v[192:195]
 ds_read_b128 v[24:27], v9 offset:0
 v_mfma_f32_16x16x32_bf16 v[208:211], v[44:47], a[220:223], v[208:211]
 ds_read_b128 v[28:31], v9 offset:1024
 v_mfma_f32_16x16x32_bf16 v[208:211], v[40:43], a[44:47], v[208:211]
 buffer_load_dwordx4 a[48:51], v4, s[20:23], s44 offen offset:1024 sc1
 v_mfma_f32_16x16x32_bf16 v[212:215], v[48:51], a[44:47], v[212:215]
 ds_read_b128 v[40:43], v9 offset:2048
 v_mfma_f32_16x16x32_bf16 v[212:215], v[52:55], a[220:223], v[212:215]
 buffer_load_dwordx4 a[52:55], v5, s[20:23], s44 offen offset:1024 sc1
 v_mfma_f32_16x16x32_bf16 v[196:199], v[52:55], a[216:219], v[196:199]
 ds_read_b128 v[44:47], v9 offset:3072
 v_mfma_f32_16x16x32_bf16 v[196:199], v[48:51], a[40:43], v[196:199]
 buffer_load_dwordx4 a[56:59], v6, s[20:23], s44 offen offset:1024 sc1
 v_mfma_f32_16x16x32_bf16 v[180:183], v[48:51], v[124:127], v[180:183]
 v_mfma_f32_16x16x32_bf16 v[180:183], v[52:55], a[212:215], v[180:183]
 v_mfma_f32_16x16x32_bf16 v[164:167], v[52:55], a[208:211], v[164:167]
 buffer_load_dwordx4 a[60:63], v7, s[20:23], s44 offen offset:1024 sc1
 v_mfma_f32_16x16x32_bf16 v[164:167], v[48:51], v[120:123], v[164:167]
 v_mfma_f32_16x16x32_bf16 v[168:171], v[32:35], v[120:123], v[168:171]
 ds_read_b128 v[48:51], v9 offset:4096
 v_mfma_f32_16x16x32_bf16 v[168:171], v[36:39], a[208:211], v[168:171]
 v_mfma_f32_16x16x32_bf16 v[184:187], v[36:39], a[212:215], v[184:187]
 v_mfma_f32_16x16x32_bf16 v[184:187], v[32:35], v[124:127], v[184:187]
 s_add_u32 s44, s42, 22528
 s_and_b32 s44, s44, 0x7fff
 s_add_u32 s44, s44, s43
 v_mfma_f32_16x16x32_bf16 v[200:203], v[32:35], a[40:43], v[200:203]
 v_mfma_f32_16x16x32_bf16 v[200:203], v[36:39], a[216:219], v[200:203]
 buffer_load_dwordx4 a[80:83], v4, s[20:23], s44 offen offset:0 sc1
 v_mfma_f32_16x16x32_bf16 v[216:219], v[36:39], a[220:223], v[216:219]
 ds_read_b128 v[52:55], v9 offset:5120
 v_mfma_f32_16x16x32_bf16 v[216:219], v[32:35], a[44:47], v[216:219]
 s_waitcnt lgkmcnt(2)
 v_mfma_f32_16x16x32_bf16 v[220:223], v[16:19], a[44:47], v[220:223]
 buffer_load_dwordx4 a[84:87], v5, s[20:23], s44 offen offset:0 sc1
 v_mfma_f32_16x16x32_bf16 v[220:223], v[20:23], a[220:223], v[220:223]
 ds_read_b128 v[32:35], v9 offset:6144
 v_mfma_f32_16x16x32_bf16 v[204:207], v[20:23], a[216:219], v[204:207]
 ds_read_b128 v[36:39], v9 offset:7168
 v_mfma_f32_16x16x32_bf16 v[204:207], v[16:19], a[40:43], v[204:207]
 v_mfma_f32_16x16x32_bf16 v[188:191], v[16:19], v[124:127], v[188:191]
 v_mfma_f32_16x16x32_bf16 v[188:191], v[20:23], a[212:215], v[188:191]
 v_mfma_f32_16x16x32_bf16 v[172:175], v[20:23], a[208:211], v[172:175]
 v_mfma_f32_16x16x32_bf16 v[172:175], v[16:19], v[120:123], v[172:175]
 s_waitcnt vmcnt(10)
 v_mfma_f32_16x16x32_bf16 v[160:163], v[24:27], a[224:227], v[160:163]
 s_add_u32 s44, s42, 22528
 s_and_b32 s44, s44, 0x7fff
 s_add_u32 s44, s44, s43
 v_mfma_f32_16x16x32_bf16 v[160:163], v[28:31], v[136:139], v[160:163]
 buffer_load_dwordx4 a[64:67], v6, s[20:23], s44 offen offset:0 sc1
 v_mfma_f32_16x16x32_bf16 v[176:179], v[28:31], v[140:143], v[176:179]
 buffer_load_dwordx4 a[68:71], v7, s[20:23], s44 offen offset:0 sc1
 v_mfma_f32_16x16x32_bf16 v[176:179], v[24:27], a[228:231], v[176:179]
 buffer_load_dwordx4 a[72:75], v4, s[20:23], s44 offen offset:1024 sc1
 v_mfma_f32_16x16x32_bf16 v[192:195], v[24:27], v[128:131], v[192:195]
 v_mfma_f32_16x16x32_bf16 v[192:195], v[28:31], v[144:147], v[192:195]
 v_mfma_f32_16x16x32_bf16 v[208:211], v[28:31], v[148:151], v[208:211]
 v_mfma_f32_16x16x32_bf16 v[208:211], v[24:27], v[132:135], v[208:211]
 v_mfma_f32_16x16x32_bf16 v[212:215], v[40:43], v[132:135], v[212:215]
 v_mfma_f32_16x16x32_bf16 v[212:215], v[44:47], v[148:151], v[212:215]
 buffer_load_dwordx4 a[76:79], v5, s[20:23], s44 offen offset:1024 sc1
 v_mfma_f32_16x16x32_bf16 v[196:199], v[44:47], v[144:147], v[196:199]
 buffer_load_dwordx4 a[176:179], v6, s[20:23], s44 offen offset:1024 sc1
 v_mfma_f32_16x16x32_bf16 v[196:199], v[40:43], v[128:131], v[196:199]
 buffer_load_dwordx4 a[180:183], v7, s[20:23], s44 offen offset:1024 sc1
 v_mfma_f32_16x16x32_bf16 v[180:183], v[40:43], a[228:231], v[180:183]
 v_mfma_f32_16x16x32_bf16 v[180:183], v[44:47], v[140:143], v[180:183]
 v_mfma_f32_16x16x32_bf16 v[164:167], v[44:47], v[136:139], v[164:167]
 v_mfma_f32_16x16x32_bf16 v[164:167], v[40:43], a[224:227], v[164:167]
 s_waitcnt lgkmcnt(0)
 v_mfma_f32_16x16x32_bf16 v[168:171], v[48:51], a[224:227], v[168:171]
 s_add_u32 s44, s42, 30720
 s_and_b32 s44, s44, 0x7fff
 s_add_u32 s44, s44, s43
 v_mfma_f32_16x16x32_bf16 v[168:171], v[52:55], v[136:139], v[168:171]
 buffer_load_dwordx4 a[88:91], v4, s[8:11], s44 offen offset:0 sc1
 v_mfma_f32_16x16x32_bf16 v[184:187], v[52:55], v[140:143], v[184:187]
 v_mfma_f32_16x16x32_bf16 v[184:187], v[48:51], a[228:231], v[184:187]
 v_mfma_f32_16x16x32_bf16 v[200:203], v[48:51], v[128:131], v[200:203]
 buffer_load_dwordx4 a[92:95], v5, s[8:11], s44 offen offset:0 sc1
 v_mfma_f32_16x16x32_bf16 v[200:203], v[52:55], v[144:147], v[200:203]
 v_mfma_f32_16x16x32_bf16 v[216:219], v[52:55], v[148:151], v[216:219]
 v_mfma_f32_16x16x32_bf16 v[216:219], v[48:51], v[132:135], v[216:219]
 buffer_load_dwordx4 a[240:243], v6, s[8:11], s44 offen offset:0 sc1
 v_mfma_f32_16x16x32_bf16 v[220:223], v[32:35], v[132:135], v[220:223]
 v_mfma_f32_16x16x32_bf16 v[220:223], v[36:39], v[148:151], v[220:223]
 v_mfma_f32_16x16x32_bf16 v[204:207], v[36:39], v[144:147], v[204:207]
 v_mfma_f32_16x16x32_bf16 v[204:207], v[32:35], v[128:131], v[204:207]
 v_mfma_f32_16x16x32_bf16 v[188:191], v[32:35], a[228:231], v[188:191]
 v_mfma_f32_16x16x32_bf16 v[188:191], v[36:39], v[140:143], v[188:191]
 v_mfma_f32_16x16x32_bf16 v[172:175], v[36:39], v[136:139], v[172:175]
 v_mfma_f32_16x16x32_bf16 v[172:175], v[32:35], a[224:227], v[172:175]
 s_waitcnt vmcnt(11)
 v_mfma_f32_16x16x32_bf16 v[160:163], v[64:67], v[152:155], v[160:163]
 s_add_u32 s44, s42, 30720
 s_and_b32 s44, s44, 0x7fff
 s_add_u32 s44, s44, s43
 v_mfma_f32_16x16x32_bf16 v[160:163], v[80:83], a[48:51], v[160:163]
 buffer_load_dwordx4 a[244:247], v7, s[8:11], s44 offen offset:0 sc1
 v_mfma_f32_16x16x32_bf16 v[176:179], v[80:83], a[52:55], v[176:179]
 buffer_load_dwordx4 a[248:251], v4, s[8:11], s44 offen offset:1024 sc1
 v_mfma_f32_16x16x32_bf16 v[176:179], v[64:67], v[156:159], v[176:179]
 buffer_load_dwordx4 a[252:255], v5, s[8:11], s44 offen offset:1024 sc1
 v_mfma_f32_16x16x32_bf16 v[192:195], v[64:67], a[232:235], v[192:195]
 v_mfma_f32_16x16x32_bf16 v[192:195], v[80:83], a[56:59], v[192:195]
 v_mfma_f32_16x16x32_bf16 v[208:211], v[80:83], a[60:63], v[208:211]
 v_mfma_f32_16x16x32_bf16 v[208:211], v[64:67], a[236:239], v[208:211]
 v_mfma_f32_16x16x32_bf16 v[212:215], v[68:71], a[236:239], v[212:215]
 v_mfma_f32_16x16x32_bf16 v[212:215], v[84:87], a[60:63], v[212:215]
 buffer_load_dwordx4 a[0:3], v6, s[8:11], s44 offen offset:1024 sc1
 v_mfma_f32_16x16x32_bf16 v[196:199], v[84:87], a[56:59], v[196:199]
 buffer_load_dwordx4 a[4:7], v7, s[8:11], s44 offen offset:1024 sc1
 v_mfma_f32_16x16x32_bf16 v[196:199], v[68:71], a[232:235], v[196:199]
 v_mfma_f32_16x16x32_bf16 v[180:183], v[68:71], v[156:159], v[180:183]
 v_mfma_f32_16x16x32_bf16 v[180:183], v[84:87], a[52:55], v[180:183]
 s_add_u32 s44, s42, 24576
 s_and_b32 s44, s44, 0x7fff
 s_add_u32 s44, s44, s43
 v_mfma_f32_16x16x32_bf16 v[164:167], v[84:87], a[48:51], v[164:167]
 buffer_load_dwordx4 a[8:11], v4, s[20:23], s44 offen offset:0 sc1
 v_mfma_f32_16x16x32_bf16 v[164:167], v[68:71], v[152:155], v[164:167]
 v_mfma_f32_16x16x32_bf16 v[168:171], v[72:75], v[152:155], v[168:171]
 v_mfma_f32_16x16x32_bf16 v[168:171], v[88:91], a[48:51], v[168:171]
 buffer_load_dwordx4 a[12:15], v5, s[20:23], s44 offen offset:0 sc1
 v_mfma_f32_16x16x32_bf16 v[184:187], v[88:91], a[52:55], v[184:187]
 v_mfma_f32_16x16x32_bf16 v[184:187], v[72:75], v[156:159], v[184:187]
 v_mfma_f32_16x16x32_bf16 v[200:203], v[72:75], a[232:235], v[200:203]
 buffer_load_dwordx4 a[200:203], v6, s[20:23], s44 offen offset:0 sc1
 v_mfma_f32_16x16x32_bf16 v[200:203], v[88:91], a[56:59], v[200:203]
 v_mfma_f32_16x16x32_bf16 v[216:219], v[88:91], a[60:63], v[216:219]
 v_mfma_f32_16x16x32_bf16 v[216:219], v[72:75], a[236:239], v[216:219]
 buffer_load_dwordx4 a[204:207], v7, s[20:23], s44 offen offset:0 sc1
 v_mfma_f32_16x16x32_bf16 v[220:223], v[76:79], a[236:239], v[220:223]
 v_mfma_f32_16x16x32_bf16 v[220:223], v[92:95], a[60:63], v[220:223]
 v_mfma_f32_16x16x32_bf16 v[204:207], v[92:95], a[56:59], v[204:207]
 v_mfma_f32_16x16x32_bf16 v[204:207], v[76:79], a[232:235], v[204:207]
 v_mfma_f32_16x16x32_bf16 v[188:191], v[76:79], v[156:159], v[188:191]
 v_mfma_f32_16x16x32_bf16 v[188:191], v[92:95], a[52:55], v[188:191]
 v_mfma_f32_16x16x32_bf16 v[172:175], v[92:95], a[48:51], v[172:175]
 v_mfma_f32_16x16x32_bf16 v[172:175], v[76:79], v[152:155], v[172:175]
 s_waitcnt vmcnt(12)
 v_mfma_f32_16x16x32_bf16 v[160:163], v[224:227], a[80:83], v[160:163]
 s_add_u32 s44, s42, 24576
 s_and_b32 s44, s44, 0x7fff
 s_add_u32 s44, s44, s43
 v_mfma_f32_16x16x32_bf16 v[160:163], v[240:243], a[72:75], v[160:163]
 buffer_load_dwordx4 a[16:19], v4, s[20:23], s44 offen offset:1024 sc1
 v_mfma_f32_16x16x32_bf16 v[176:179], v[240:243], a[76:79], v[176:179]
 buffer_load_dwordx4 a[20:23], v5, s[20:23], s44 offen offset:1024 sc1
 v_mfma_f32_16x16x32_bf16 v[176:179], v[224:227], a[84:87], v[176:179]
 buffer_load_dwordx4 a[24:27], v6, s[20:23], s44 offen offset:1024 sc1
 v_mfma_f32_16x16x32_bf16 v[192:195], v[224:227], a[64:67], v[192:195]
 v_mfma_f32_16x16x32_bf16 v[192:195], v[240:243], a[176:179], v[192:195]
 v_mfma_f32_16x16x32_bf16 v[208:211], v[240:243], a[180:183], v[208:211]
 v_mfma_f32_16x16x32_bf16 v[208:211], v[224:227], a[68:71], v[208:211]
 v_mfma_f32_16x16x32_bf16 v[212:215], v[228:231], a[68:71], v[212:215]
 v_mfma_f32_16x16x32_bf16 v[212:215], v[244:247], a[180:183], v[212:215]
 buffer_load_dwordx4 a[28:31], v7, s[20:23], s44 offen offset:1024 sc1
 v_mfma_f32_16x16x32_bf16 v[196:199], v[244:247], a[176:179], v[196:199]
 s_barrier
 v_and_b32 v12, 15, v0
 v_mfma_f32_16x16x32_bf16 v[196:199], v[228:231], a[64:67], v[196:199]
 s_add_u32 s44, s42, 26624
 s_and_b32 s44, s44, 0x7fff
 s_add_u32 s44, s44, s43
 v_mfma_f32_16x16x32_bf16 v[180:183], v[228:231], a[84:87], v[180:183]
 buffer_load_dwordx4 a[32:35], v4, s[20:23], s44 offen offset:0 sc1
 v_mfma_f32_16x16x32_bf16 v[180:183], v[244:247], a[76:79], v[180:183]
 v_lshlrev_b32 v12, 4, v12
 v_mfma_f32_16x16x32_bf16 v[164:167], v[244:247], a[72:75], v[164:167]
 buffer_load_dwordx4 a[36:39], v5, s[20:23], s44 offen offset:0 sc1
 v_mfma_f32_16x16x32_bf16 v[164:167], v[228:231], a[80:83], v[164:167]
 v_lshrrev_b32 v3, 4, v0
 v_mfma_f32_16x16x32_bf16 v[168:171], v[232:235], a[80:83], v[168:171]
 v_mul_u32_u24 v3, 256, v3
 v_mfma_f32_16x16x32_bf16 v[168:171], v[248:251], a[72:75], v[168:171]
 v_mfma_f32_16x16x32_bf16 v[184:187], v[248:251], a[76:79], v[184:187]
 v_mfma_f32_16x16x32_bf16 v[184:187], v[232:235], a[84:87], v[184:187]
 v_mfma_f32_16x16x32_bf16 v[200:203], v[232:235], a[64:67], v[200:203]
 buffer_load_dwordx4 v[96:99], v6, s[20:23], s44 offen offset:0 sc1
 v_mfma_f32_16x16x32_bf16 v[200:203], v[248:251], a[176:179], v[200:203]
 buffer_load_dwordx4 v[100:103], v7, s[20:23], s44 offen offset:0 sc1
 v_mfma_f32_16x16x32_bf16 v[216:219], v[248:251], a[180:183], v[216:219]
 v_add_u32 v12, v12, v3
 v_mfma_f32_16x16x32_bf16 v[216:219], v[232:235], a[68:71], v[216:219]
 s_mul_i32 s4, s3, 16384
 v_mfma_f32_16x16x32_bf16 v[220:223], v[236:239], a[68:71], v[220:223]
 v_add_u32 v12, s4, v12
 v_mfma_f32_16x16x32_bf16 v[220:223], v[252:255], a[180:183], v[220:223]
 buffer_load_dwordx4 v[104:107], v4, s[20:23], s44 offen offset:1024 sc1
 v_mfma_f32_16x16x32_bf16 v[204:207], v[252:255], a[176:179], v[204:207]
 v_mfma_f32_16x16x32_bf16 v[204:207], v[236:239], a[64:67], v[204:207]
 v_mfma_f32_16x16x32_bf16 v[188:191], v[236:239], a[84:87], v[188:191]
 v_mfma_f32_16x16x32_bf16 v[188:191], v[252:255], a[76:79], v[188:191]
 v_mfma_f32_16x16x32_bf16 v[172:175], v[252:255], a[72:75], v[172:175]
 v_mfma_f32_16x16x32_bf16 v[172:175], v[236:239], a[80:83], v[172:175]
 s_waitcnt vmcnt(5)
 v_mfma_f32_16x16x32_bf16 v[160:163], a[96:99], a[8:11], v[160:163]
 s_and_b32 s70, s2, 3
 s_lshl_b32 s70, s70, 2
 s_bfe_u32 s5, s2, 0x20003
 v_mfma_f32_16x16x32_bf16 v[160:163], a[112:115], a[16:19], v[160:163]
 s_add_u32 s44, s42, 26624
 s_and_b32 s44, s44, 0x7fff
 s_add_u32 s44, s44, s43
 v_mfma_f32_16x16x32_bf16 v[176:179], a[112:115], a[20:23], v[176:179]
 buffer_load_dwordx4 v[108:111], v5, s[20:23], s44 offen offset:1024 sc1
 v_mfma_f32_16x16x32_bf16 v[176:179], a[96:99], a[12:15], v[176:179]
 buffer_load_dwordx4 v[112:115], v6, s[20:23], s44 offen offset:1024 sc1
 v_mfma_f32_16x16x32_bf16 v[192:195], a[96:99], a[200:203], v[192:195]
 buffer_load_dwordx4 v[116:119], v7, s[20:23], s44 offen offset:1024 sc1
 v_mfma_f32_16x16x32_bf16 v[192:195], a[112:115], a[24:27], v[192:195]
 s_add_u32 s70, s70, s5
 s_lshl_b32 s70, s70, 3
 s_lshl_b32 s5, s3, 1
 v_mfma_f32_16x16x32_bf16 v[208:211], a[112:115], a[28:31], v[208:211]
 s_add_u32 s70, s70, s5
 s_lshr_b32 s74, s2, 5
 s_and_b32 s5, s2, 4
 v_mfma_f32_16x16x32_bf16 v[208:211], a[96:99], a[204:207], v[208:211]
 s_lshl_b32 s5, s5, 1
 s_add_u32 s74, s74, s5
 s_mul_i32 s6, s74, 3
 v_mfma_f32_16x16x32_bf16 v[212:215], a[100:103], a[204:207], v[212:215]
 s_add_u32 s44, s42, 28672
 s_and_b32 s44, s44, 0x7fff
 s_add_u32 s44, s44, s43
 v_mfma_f32_16x16x32_bf16 v[212:215], a[116:119], a[28:31], v[212:215]
 buffer_load_dwordx4 v[120:123], v4, s[20:23], s44 offen offset:0 sc1
 v_mfma_f32_16x16x32_bf16 v[196:199], a[116:119], a[24:27], v[196:199]
 s_lshl_b32 s5, s74, 1
 s_add_u32 s5, s5, 11
 s_min_u32 s71, s6, s5
 v_mfma_f32_16x16x32_bf16 v[196:199], a[100:103], a[200:203], v[196:199]
 buffer_load_dwordx4 v[124:127], v5, s[20:23], s44 offen offset:0 sc1
 v_mfma_f32_16x16x32_bf16 v[180:183], a[100:103], a[12:15], v[180:183]
 s_mul_i32 s73, s3, 6144
 s_mul_i32 s5, s3, 49152
 v_lshlrev_b32 v28, 4, v0
 v_mfma_f32_16x16x32_bf16 v[180:183], a[116:119], a[20:23], v[180:183]
 v_add_u32 v28, s5, v28
 v_add_u32 v29, 14336, v28
 v_mfma_f32_16x16x32_bf16 v[164:167], a[116:119], a[16:19], v[164:167]
 buffer_load_dwordx4 a[40:43], v6, s[20:23], s44 offen offset:0 sc1
 v_mfma_f32_16x16x32_bf16 v[164:167], a[100:103], a[8:11], v[164:167]
 v_add_u32 v30, 32768, v28
 s_lshl_b32 s5, s3, 6
 v_mfma_f32_16x16x32_bf16 v[168:171], a[104:107], a[8:11], v[168:171]
 v_add_u32 v53, s5, v0
 v_mfma_f32_16x16x32_bf16 v[168:171], a[120:123], a[16:19], v[168:171]
 buffer_load_dwordx4 a[44:47], v7, s[20:23], s44 offen offset:0 sc1
 v_mfma_f32_16x16x32_bf16 v[184:187], a[120:123], a[20:23], v[184:187]
 v_bfe_u32 v52, v53, 4, 1
 v_mfma_f32_16x16x32_bf16 v[184:187], a[104:107], a[12:15], v[184:187]
 v_mul_u32_u24 v52, 90112, v52
 v_mfma_f32_16x16x32_bf16 v[200:203], a[104:107], a[200:203], v[200:203]
 buffer_load_dwordx4 a[208:211], v4, s[20:23], s44 offen offset:1024 sc1
 v_mfma_f32_16x16x32_bf16 v[200:203], a[120:123], a[24:27], v[200:203]
 v_lshrrev_b32 v54, 5, v53
 v_mfma_f32_16x16x32_bf16 v[216:219], a[120:123], a[28:31], v[216:219]
 v_lshlrev_b32 v54, 6, v54
 v_mfma_f32_16x16x32_bf16 v[216:219], a[104:107], a[204:207], v[216:219]
 v_add_u32 v52, v52, v54
 v_mfma_f32_16x16x32_bf16 v[220:223], a[108:111], a[204:207], v[220:223]
 buffer_load_dwordx4 a[212:215], v5, s[20:23], s44 offen offset:1024 sc1
 v_mfma_f32_16x16x32_bf16 v[220:223], a[124:127], a[28:31], v[220:223]
 v_and_b32 v54, 15, v0
 v_lshl_add_u32 v52, v54, 2, v52
 v_mfma_f32_16x16x32_bf16 v[204:207], a[124:127], a[24:27], v[204:207]
 v_lshlrev_b32 v53, 2, v53
 v_add_u32 v53, 149504, v53
 v_mfma_f32_16x16x32_bf16 v[204:207], a[108:111], a[200:203], v[204:207]
 s_cmp_ge_u32 s74, 11
 s_cselect_b32 s6, 8, 12
 s_lshl_b32 s6, s6, 14
 s_lshl_b32 s5, s71, 16
 s_add_u32 s5, s5, 56623104
 v_mfma_f32_16x16x32_bf16 v[188:191], a[108:111], a[12:15], v[188:191]
 s_add_u32 s12, s60, s5
 s_addc_u32 s13, s61, 0
 s_mov_b32 s14, s6
 s_mov_b32 s15, 0x20000
 v_mfma_f32_16x16x32_bf16 v[188:191], a[124:127], a[20:23], v[188:191]
 s_lshl_b32 s5, s71, 7
 s_sub_u32 s6, 180224, s5
 s_add_u32 s5, s5, 59768832
 v_mfma_f32_16x16x32_bf16 v[172:175], a[124:127], a[16:19], v[172:175]
 s_add_u32 s16, s60, s5
 s_addc_u32 s17, s61, 0
 s_mov_b32 s18, s6
 s_mov_b32 s19, 0x20000
 v_mfma_f32_16x16x32_bf16 v[172:175], a[108:111], a[8:11], v[172:175]
 s_waitcnt vmcnt(6)
 v_mfma_f32_16x16x32_bf16 v[160:163], a[128:131], a[32:35], v[160:163]
 ds_read_b64 v[56:57], v15 offset:0
 v_mfma_f32_16x16x32_bf16 v[160:163], a[144:147], v[104:107], v[160:163]
 s_add_u32 s44, s42, 28672
 s_and_b32 s44, s44, 0x7fff
 s_add_u32 s44, s44, s43
 v_mfma_f32_16x16x32_bf16 v[176:179], a[144:147], v[108:111], v[176:179]
 buffer_load_dwordx4 a[216:219], v6, s[20:23], s44 offen offset:1024 sc1
 v_mfma_f32_16x16x32_bf16 v[176:179], a[128:131], a[36:39], v[176:179]
 buffer_load_dwordx4 a[220:223], v7, s[20:23], s44 offen offset:1024 sc1
 v_mfma_f32_16x16x32_bf16 v[192:195], a[128:131], v[96:99], v[192:195]
 ds_read_b64 v[58:59], v15 offset:32
 v_mfma_f32_16x16x32_bf16 v[192:195], a[144:147], v[112:115], v[192:195]
 ds_read_b64 v[60:61], v15 offset:64
 v_mfma_f32_16x16x32_bf16 v[208:211], a[144:147], v[116:119], v[208:211]
 ds_read_b64 v[62:63], v15 offset:96
 v_mfma_f32_16x16x32_bf16 v[208:211], a[128:131], v[100:103], v[208:211]
 v_mfma_f32_16x16x32_bf16 v[212:215], a[132:135], v[100:103], v[212:215]
 v_mfma_f32_16x16x32_bf16 v[212:215], a[148:151], v[116:119], v[212:215]
 v_mfma_f32_16x16x32_bf16 v[196:199], a[148:151], v[112:115], v[196:199]
 s_add_u32 s44, s42, 30720
 s_and_b32 s44, s44, 0x7fff
 s_add_u32 s44, s44, s43
 v_mfma_f32_16x16x32_bf16 v[196:199], a[132:135], v[96:99], v[196:199]
 buffer_load_dwordx4 a[224:227], v4, s[20:23], s44 offen offset:0 sc1
 v_mfma_f32_16x16x32_bf16 v[180:183], a[132:135], a[36:39], v[180:183]
 buffer_load_dwordx4 a[228:231], v5, s[20:23], s44 offen offset:0 sc1
 v_mfma_f32_16x16x32_bf16 v[180:183], a[148:151], v[108:111], v[180:183]
 buffer_load_dwordx4 v[128:131], v6, s[20:23], s44 offen offset:0 sc1
 v_mfma_f32_16x16x32_bf16 v[164:167], a[148:151], v[104:107], v[164:167]
 buffer_load_dwordx4 v[132:135], v7, s[20:23], s44 offen offset:0 sc1
 v_mfma_f32_16x16x32_bf16 v[164:167], a[132:135], a[32:35], v[164:167]
 v_mfma_f32_16x16x32_bf16 v[168:171], a[136:139], a[32:35], v[168:171]
 v_mfma_f32_16x16x32_bf16 v[168:171], a[152:155], v[104:107], v[168:171]
 v_mfma_f32_16x16x32_bf16 v[184:187], a[152:155], v[108:111], v[184:187]
 v_mfma_f32_16x16x32_bf16 v[184:187], a[136:139], a[36:39], v[184:187]
 v_mfma_f32_16x16x32_bf16 v[200:203], a[136:139], v[96:99], v[200:203]
 buffer_load_dwordx4 v[136:139], v4, s[20:23], s44 offen offset:1024 sc1
 v_mfma_f32_16x16x32_bf16 v[200:203], a[152:155], v[112:115], v[200:203]
 buffer_load_dwordx4 v[140:143], v5, s[20:23], s44 offen offset:1024 sc1
 v_mfma_f32_16x16x32_bf16 v[216:219], a[152:155], v[116:119], v[216:219]
 v_mfma_f32_16x16x32_bf16 v[216:219], a[136:139], v[100:103], v[216:219]
 buffer_load_dwordx4 v[144:147], v6, s[20:23], s44 offen offset:1024 sc1
 v_mfma_f32_16x16x32_bf16 v[220:223], a[140:143], v[100:103], v[220:223]
 v_mfma_f32_16x16x32_bf16 v[220:223], a[156:159], v[116:119], v[220:223]
 v_mfma_f32_16x16x32_bf16 v[204:207], a[156:159], v[112:115], v[204:207]
 v_mfma_f32_16x16x32_bf16 v[204:207], a[140:143], v[96:99], v[204:207]
 v_mfma_f32_16x16x32_bf16 v[188:191], a[140:143], a[36:39], v[188:191]
 v_mfma_f32_16x16x32_bf16 v[188:191], a[156:159], v[108:111], v[188:191]
 v_mfma_f32_16x16x32_bf16 v[172:175], a[156:159], v[104:107], v[172:175]
 v_mfma_f32_16x16x32_bf16 v[172:175], a[140:143], a[32:35], v[172:175]
 s_waitcnt vmcnt(7)
 v_mfma_f32_16x16x32_bf16 v[160:163], a[160:163], v[120:123], v[160:163]
 s_add_u32 s44, s42, 30720
 s_and_b32 s44, s44, 0x7fff
 s_add_u32 s44, s44, s43
 v_mfma_f32_16x16x32_bf16 v[160:163], a[184:187], a[208:211], v[160:163]
 v_mfma_f32_16x16x32_bf16 v[176:179], a[184:187], a[212:215], v[176:179]
 v_mfma_f32_16x16x32_bf16 v[176:179], a[160:163], v[124:127], v[176:179]
 v_mfma_f32_16x16x32_bf16 v[192:195], a[160:163], a[40:43], v[192:195]
 v_mfma_f32_16x16x32_bf16 v[192:195], a[184:187], a[216:219], v[192:195]
 v_mfma_f32_16x16x32_bf16 v[208:211], a[184:187], a[220:223], v[208:211]
 v_mfma_f32_16x16x32_bf16 v[208:211], a[160:163], a[44:47], v[208:211]
 v_mfma_f32_16x16x32_bf16 v[212:215], a[164:167], a[44:47], v[212:215]
 v_mfma_f32_16x16x32_bf16 v[212:215], a[188:191], a[220:223], v[212:215]
 v_mfma_f32_16x16x32_bf16 v[196:199], a[188:191], a[216:219], v[196:199]
 buffer_load_dwordx4 v[148:151], v7, s[20:23], s44 offen offset:1024 sc1
 v_mfma_f32_16x16x32_bf16 v[196:199], a[164:167], a[40:43], v[196:199]
 v_mfma_f32_16x16x32_bf16 v[180:183], a[164:167], v[124:127], v[180:183]
 v_mfma_f32_16x16x32_bf16 v[180:183], a[188:191], a[212:215], v[180:183]
 v_mfma_f32_16x16x32_bf16 v[164:167], a[188:191], a[208:211], v[164:167]
 v_mfma_f32_16x16x32_bf16 v[164:167], a[164:167], v[120:123], v[164:167]
 v_mfma_f32_16x16x32_bf16 v[168:171], a[168:171], v[120:123], v[168:171]
 v_mfma_f32_16x16x32_bf16 v[168:171], a[192:195], a[208:211], v[168:171]
 v_mfma_f32_16x16x32_bf16 v[184:187], a[192:195], a[212:215], v[184:187]
 v_mfma_f32_16x16x32_bf16 v[184:187], a[168:171], v[124:127], v[184:187]
 v_mfma_f32_16x16x32_bf16 v[200:203], a[168:171], a[40:43], v[200:203]
 v_mfma_f32_16x16x32_bf16 v[200:203], a[192:195], a[216:219], v[200:203]
 v_mfma_f32_16x16x32_bf16 v[216:219], a[192:195], a[220:223], v[216:219]
 v_mfma_f32_16x16x32_bf16 v[216:219], a[168:171], a[44:47], v[216:219]
 v_mfma_f32_16x16x32_bf16 v[220:223], a[172:175], a[44:47], v[220:223]
 v_mfma_f32_16x16x32_bf16 v[220:223], a[196:199], a[220:223], v[220:223]
 v_mfma_f32_16x16x32_bf16 v[204:207], a[196:199], a[216:219], v[204:207]
 v_mfma_f32_16x16x32_bf16 v[204:207], a[172:175], a[40:43], v[204:207]
 v_mfma_f32_16x16x32_bf16 v[188:191], a[172:175], v[124:127], v[188:191]
 v_mfma_f32_16x16x32_bf16 v[188:191], a[196:199], a[212:215], v[188:191]
 v_mfma_f32_16x16x32_bf16 v[172:175], a[196:199], a[208:211], v[172:175]
 v_mfma_f32_16x16x32_bf16 v[172:175], a[172:175], v[120:123], v[172:175]
 s_waitcnt vmcnt(0)
 v_mfma_f32_16x16x32_bf16 v[160:163], a[88:91], a[224:227], v[160:163]
 v_mfma_f32_16x16x32_bf16 v[160:163], a[248:251], v[136:139], v[160:163]
 v_mfma_f32_16x16x32_bf16 v[176:179], a[248:251], v[140:143], v[176:179]
 v_mfma_f32_16x16x32_bf16 v[176:179], a[88:91], a[228:231], v[176:179]
 v_mfma_f32_16x16x32_bf16 v[192:195], a[88:91], v[128:131], v[192:195]
 v_mfma_f32_16x16x32_bf16 v[192:195], a[248:251], v[144:147], v[192:195]
 v_mfma_f32_16x16x32_bf16 v[208:211], a[248:251], v[148:151], v[208:211]
 s_nop 2
 ds_write_b128 v12, v[160:163] offset:0
 v_mfma_f32_16x16x32_bf16 v[208:211], a[88:91], v[132:135], v[208:211]
 v_mfma_f32_16x16x32_bf16 v[212:215], a[92:95], v[132:135], v[212:215]
 ds_write_b128 v12, v[176:179] offset:4096
 v_mfma_f32_16x16x32_bf16 v[212:215], a[252:255], v[148:151], v[212:215]
 v_mfma_f32_16x16x32_bf16 v[196:199], a[252:255], v[144:147], v[196:199]
 ds_write_b128 v12, v[192:195] offset:8192
 v_mfma_f32_16x16x32_bf16 v[196:199], a[92:95], v[128:131], v[196:199]
 v_mfma_f32_16x16x32_bf16 v[180:183], a[92:95], a[228:231], v[180:183]
 s_nop 0
 ds_write_b128 v12, v[208:211] offset:12288
 v_mfma_f32_16x16x32_bf16 v[180:183], a[252:255], v[140:143], v[180:183]
 v_mfma_f32_16x16x32_bf16 v[164:167], a[252:255], v[136:139], v[164:167]
 ds_write_b128 v12, v[212:215] offset:13312
 v_mfma_f32_16x16x32_bf16 v[164:167], a[92:95], a[224:227], v[164:167]
 v_mfma_f32_16x16x32_bf16 v[168:171], a[240:243], a[224:227], v[168:171]
 ds_write_b128 v12, v[196:199] offset:9216
 v_mfma_f32_16x16x32_bf16 v[168:171], a[0:3], v[136:139], v[168:171]
 v_mfma_f32_16x16x32_bf16 v[184:187], a[0:3], v[140:143], v[184:187]
 s_nop 0
 ds_write_b128 v12, v[180:183] offset:5120
 v_mfma_f32_16x16x32_bf16 v[184:187], a[240:243], a[228:231], v[184:187]
 v_mfma_f32_16x16x32_bf16 v[200:203], a[240:243], v[128:131], v[200:203]
 ds_write_b128 v12, v[164:167] offset:1024
 v_mfma_f32_16x16x32_bf16 v[200:203], a[0:3], v[144:147], v[200:203]
 v_mfma_f32_16x16x32_bf16 v[216:219], a[0:3], v[148:151], v[216:219]
 ds_write_b128 v12, v[168:171] offset:2048
 v_mfma_f32_16x16x32_bf16 v[216:219], a[240:243], v[132:135], v[216:219]
 v_mfma_f32_16x16x32_bf16 v[220:223], a[244:247], v[132:135], v[220:223]
 s_nop 0
 ds_write_b128 v12, v[184:187] offset:6144
 v_mfma_f32_16x16x32_bf16 v[220:223], a[4:7], v[148:151], v[220:223]
 v_mfma_f32_16x16x32_bf16 v[204:207], a[4:7], v[144:147], v[204:207]
 ds_write_b128 v12, v[200:203] offset:10240
 v_mfma_f32_16x16x32_bf16 v[204:207], a[244:247], v[128:131], v[204:207]
 v_mfma_f32_16x16x32_bf16 v[188:191], a[244:247], a[228:231], v[188:191]
 ds_write_b128 v12, v[216:219] offset:14336
 v_mfma_f32_16x16x32_bf16 v[188:191], a[4:7], v[140:143], v[188:191]
 v_mfma_f32_16x16x32_bf16 v[172:175], a[4:7], v[136:139], v[172:175]
 s_nop 0
 ds_write_b128 v12, v[220:223] offset:15360
 v_mfma_f32_16x16x32_bf16 v[172:175], a[244:247], a[224:227], v[172:175]
 s_nop 0
 ds_write_b128 v12, v[204:207] offset:11264
 s_nop 1
 ds_write_b128 v12, v[188:191] offset:7168
 s_nop 2
 ds_write_b128 v12, v[172:175] offset:3072
 s_lshl_b32 s4, s3, 12
 v_add_u32 v13, s4, v4
 v_lshlrev_b32 v14, 3, v0
 s_waitcnt lgkmcnt(0)
 s_barrier
 ds_read_b128 v[64:67], v13 offset:0
 ds_read_b128 v[68:71], v13 offset:1024
 ds_read_b128 v[72:75], v13 offset:2048
 ds_read_b128 v[76:79], v13 offset:3072
 ds_read_b128 v[80:83], v13 offset:16384
 ds_read_b128 v[84:87], v13 offset:17408
 ds_read_b128 v[88:91], v13 offset:18432
 ds_read_b128 v[92:95], v13 offset:19456
 ds_read_b128 v[96:99], v13 offset:32768
 ds_read_b128 v[100:103], v13 offset:33792
 ds_read_b128 v[104:107], v13 offset:34816
 ds_read_b128 v[108:111], v13 offset:35840
 ds_read_b128 v[112:115], v13 offset:49152
 ds_read_b128 v[116:119], v13 offset:50176
 ds_read_b128 v[120:123], v13 offset:51200
 ds_read_b128 v[124:127], v13 offset:52224
 s_waitcnt lgkmcnt(8)
 v_add_f32 v64, v64, v80
 v_add_f32 v65, v65, v81
 v_add_f32 v66, v66, v82
 v_add_f32 v67, v67, v83
 v_add_f32 v68, v68, v84
 v_add_f32 v69, v69, v85
 v_add_f32 v70, v70, v86
 v_add_f32 v71, v71, v87
 v_add_f32 v72, v72, v88
 v_add_f32 v73, v73, v89
 v_add_f32 v74, v74, v90
 v_add_f32 v75, v75, v91
 v_add_f32 v76, v76, v92
 v_add_f32 v77, v77, v93
 v_add_f32 v78, v78, v94
 v_add_f32 v79, v79, v95
 s_waitcnt lgkmcnt(0)
 v_add_f32 v96, v96, v112
 v_add_f32 v97, v97, v113
 v_add_f32 v98, v98, v114
 v_add_f32 v99, v99, v115
 v_add_f32 v100, v100, v116
 v_add_f32 v101, v101, v117
 v_add_f32 v102, v102, v118
 v_add_f32 v103, v103, v119
 v_add_f32 v104, v104, v120
 v_add_f32 v105, v105, v121
 v_add_f32 v106, v106, v122
 v_add_f32 v107, v107, v123
 v_add_f32 v108, v108, v124
 v_add_f32 v109, v109, v125
 v_add_f32 v110, v110, v126
 v_add_f32 v111, v111, v127
 v_add_f32 v64, v64, v96
 v_add_f32 v65, v65, v97
 v_add_f32 v66, v66, v98
 v_add_f32 v67, v67, v99
 v_add_f32 v68, v68, v100
 v_add_f32 v69, v69, v101
 v_add_f32 v70, v70, v102
 v_add_f32 v71, v71, v103
 v_add_f32 v72, v72, v104
 v_add_f32 v73, v73, v105
 v_add_f32 v74, v74, v106
 v_add_f32 v75, v75, v107
 v_add_f32 v76, v76, v108
 v_add_f32 v77, v77, v109
 v_add_f32 v78, v78, v110
 v_add_f32 v79, v79, v111
 v_cvt_pk_bf16_f32 v224, v64, v65
 v_lshlrev_b32 v80, 16, v56
 v_and_b32 v81, 0xffff0000, v56
 v_lshlrev_b32 v64, 16, v224
 v_and_b32 v65, 0xffff0000, v224
 v_add_f32 v80, v80, v64
 v_add_f32 v81, v81, v65
 v_cvt_pk_bf16_f32 v224, v80, v81
 v_cvt_pk_bf16_f32 v225, v66, v67
 v_lshlrev_b32 v82, 16, v57
 v_and_b32 v83, 0xffff0000, v57
 v_lshlrev_b32 v66, 16, v225
 v_and_b32 v67, 0xffff0000, v225
 v_add_f32 v82, v82, v66
 v_add_f32 v83, v83, v67
 v_cvt_pk_bf16_f32 v225, v82, v83
 v_cvt_pk_bf16_f32 v226, v68, v69
 v_lshlrev_b32 v84, 16, v58
 v_and_b32 v85, 0xffff0000, v58
 v_lshlrev_b32 v68, 16, v226
 v_and_b32 v69, 0xffff0000, v226
 v_add_f32 v84, v84, v68
 v_add_f32 v85, v85, v69
 v_cvt_pk_bf16_f32 v226, v84, v85
 v_cvt_pk_bf16_f32 v227, v70, v71
 v_lshlrev_b32 v86, 16, v59
 v_and_b32 v87, 0xffff0000, v59
 v_lshlrev_b32 v70, 16, v227
 v_and_b32 v71, 0xffff0000, v227
 v_add_f32 v86, v86, v70
 v_add_f32 v87, v87, v71
 v_cvt_pk_bf16_f32 v227, v86, v87
 v_cvt_pk_bf16_f32 v228, v72, v73
 v_lshlrev_b32 v88, 16, v60
 v_and_b32 v89, 0xffff0000, v60
 v_lshlrev_b32 v72, 16, v228
 v_and_b32 v73, 0xffff0000, v228
 v_add_f32 v88, v88, v72
 v_add_f32 v89, v89, v73
 v_cvt_pk_bf16_f32 v228, v88, v89
 v_cvt_pk_bf16_f32 v229, v74, v75
 v_lshlrev_b32 v90, 16, v61
 v_and_b32 v91, 0xffff0000, v61
 v_lshlrev_b32 v74, 16, v229
 v_and_b32 v75, 0xffff0000, v229
 v_add_f32 v90, v90, v74
 v_add_f32 v91, v91, v75
 v_cvt_pk_bf16_f32 v229, v90, v91
 v_cvt_pk_bf16_f32 v230, v76, v77
 v_lshlrev_b32 v92, 16, v62
 v_and_b32 v93, 0xffff0000, v62
 v_lshlrev_b32 v76, 16, v230
 v_and_b32 v77, 0xffff0000, v230
 v_add_f32 v92, v92, v76
 v_add_f32 v93, v93, v77
 v_cvt_pk_bf16_f32 v230, v92, v93
 v_cvt_pk_bf16_f32 v231, v78, v79
 v_lshlrev_b32 v94, 16, v63
 v_and_b32 v95, 0xffff0000, v63
 v_lshlrev_b32 v78, 16, v231
 v_and_b32 v79, 0xffff0000, v231
 v_add_f32 v94, v94, v78
 v_add_f32 v95, v95, v79
 v_cvt_pk_bf16_f32 v231, v94, v95
 buffer_store_dwordx4 v[224:227], v4, s[24:27], 0 offen offset:0 sc1
 buffer_store_dwordx4 v[228:231], v4, s[24:27], 0 offen offset:1024 sc1
 v_lshlrev_b32 v80, 16, v224
 v_and_b32 v81, 0xffff0000, v224
 v_lshlrev_b32 v82, 16, v225
 v_and_b32 v83, 0xffff0000, v225
 v_lshlrev_b32 v84, 16, v226
 v_and_b32 v85, 0xffff0000, v226
 v_lshlrev_b32 v86, 16, v227
 v_and_b32 v87, 0xffff0000, v227
 v_lshlrev_b32 v88, 16, v228
 v_and_b32 v89, 0xffff0000, v228
 v_lshlrev_b32 v90, 16, v229
 v_and_b32 v91, 0xffff0000, v229
 v_lshlrev_b32 v92, 16, v230
 v_and_b32 v93, 0xffff0000, v230
 v_lshlrev_b32 v94, 16, v231
 v_and_b32 v95, 0xffff0000, v231
 v_add_f32 v32, v80, v81
 v_add_f32 v32, v32, v82
 v_add_f32 v32, v32, v83
 v_add_f32 v32, v32, v84
 v_add_f32 v32, v32, v85
 v_add_f32 v32, v32, v86
 v_add_f32 v32, v32, v87
 v_add_f32 v32, v32, v88
 v_add_f32 v32, v32, v89
 v_add_f32 v32, v32, v90
 v_add_f32 v32, v32, v91
 v_add_f32 v32, v32, v92
 v_add_f32 v32, v32, v93
 v_add_f32 v32, v32, v94
 v_add_f32 v32, v32, v95
 v_mov_b32 v3, v32
 s_nop 1
 v_permlane16_swap_b32 v32, v3
 v_add_f32 v32, v32, v3
 v_mov_b32 v3, v32
 s_nop 1
 v_permlane32_swap_b32 v32, v3
 v_add_f32 v32, v32, v3
 v_mul_f32 v32, 0x3c800000, v32
 v_sub_f32 v3, v80, v32
 v_mul_f32 v33, v3, v3
 v_sub_f32 v3, v81, v32
 v_fmac_f32 v33, v3, v3
 v_sub_f32 v3, v82, v32
 v_fmac_f32 v33, v3, v3
 v_sub_f32 v3, v83, v32
 v_fmac_f32 v33, v3, v3
 v_sub_f32 v3, v84, v32
 v_fmac_f32 v33, v3, v3
 v_sub_f32 v3, v85, v32
 v_fmac_f32 v33, v3, v3
 v_sub_f32 v3, v86, v32
 v_fmac_f32 v33, v3, v3
 v_sub_f32 v3, v87, v32
 v_fmac_f32 v33, v3, v3
 v_sub_f32 v3, v88, v32
 v_fmac_f32 v33, v3, v3
 v_sub_f32 v3, v89, v32
 v_fmac_f32 v33, v3, v3
 v_sub_f32 v3, v90, v32
 v_fmac_f32 v33, v3, v3
 v_sub_f32 v3, v91, v32
 v_fmac_f32 v33, v3, v3
 v_sub_f32 v3, v92, v32
 v_fmac_f32 v33, v3, v3
 v_sub_f32 v3, v93, v32
 v_fmac_f32 v33, v3, v3
 v_sub_f32 v3, v94, v32
 v_fmac_f32 v33, v3, v3
 v_sub_f32 v3, v95, v32
 v_fmac_f32 v33, v3, v3
 v_mov_b32 v3, v33
 s_nop 1
 v_permlane16_swap_b32 v33, v3
 v_add_f32 v33, v33, v3
 v_mov_b32 v3, v33
 s_nop 1
 v_permlane32_swap_b32 v33, v3
 v_add_f32 v33, v33, v3
 buffer_store_dwordx2 v[32:33], v14, s[88:91], 0 offen sc1
sequential_preLN__compressed_kv_cla__glu_gated_swiglu__prompt_kernel_cG:
 s_add_u32 m0, s73, 73728
 s_mov_b32 s72, 0
 buffer_load_dwordx4 v28, s[12:15], s72 offen offset:0 sc1 lds
 buffer_load_dwordx4 v28, s[12:15], s72 offen offset:1024 sc1 lds
 buffer_load_dwordx4 v29, s[12:15], s72 offen offset:2048 sc1 lds
 buffer_load_dwordx4 v29, s[12:15], s72 offen offset:3072 sc1 lds
 s_add_u32 m0, s73, 77824
 s_nop 0
 buffer_load_dwordx4 v30, s[12:15], s72 offen offset:0 sc1 lds
 buffer_load_dwordx4 v30, s[12:15], s72 offen offset:1024 sc1 lds
 s_add_u32 m0, s73, 98304
 s_mov_b32 s72, 2048
 buffer_load_dwordx4 v28, s[12:15], s72 offen offset:0 sc1 lds
 buffer_load_dwordx4 v28, s[12:15], s72 offen offset:1024 sc1 lds
 buffer_load_dwordx4 v29, s[12:15], s72 offen offset:2048 sc1 lds
 buffer_load_dwordx4 v29, s[12:15], s72 offen offset:3072 sc1 lds
 s_add_u32 m0, s73, 102400
 s_nop 0
 buffer_load_dwordx4 v30, s[12:15], s72 offen offset:0 sc1 lds
 buffer_load_dwordx4 v30, s[12:15], s72 offen offset:1024 sc1 lds
 s_waitcnt vmcnt(12)
 s_barrier
 s_cmp_eq_u32 s3, 0
 s_cbranch_scc0 L_pub_257
 s_mul_i32 s4, s2, 128
 s_add_u32 s4, s4, 98304
 v_lshl_add_u32 v2, v0, 2, s4
 v_mov_b32 v3, s100
 s_mov_b64 exec, 0xffffffff
 buffer_store_dword v3, v2, s[96:99], 0 offen sc1
 s_mov_b64 exec, -1
L_pub_257:
 s_mul_i32 s4, s41, 176128
 s_add_u32 s4, s4, 60817408
 s_add_u32 s32, s60, s4
 s_addc_u32 s33, s61, 0
 s_mov_b32 s34, 176128
 s_mov_b32 s35, 0x20000
 s_mul_i32 s4, s40, 176128
 s_add_u32 s4, s4, 66060288
 s_add_u32 s28, s60, s4
 s_addc_u32 s29, s61, 0
 s_mov_b32 s30, 176128
 s_mov_b32 s31, 0x20000
 s_lshl_b32 s5, s40, 2
 s_add_u32 s5, s5, s3
 s_lshl_b32 s5, s5, 14
 s_lshl_b32 s4, s41, 7
 s_add_u32 s4, s4, s5
 s_add_u32 s84, s56, s4
 s_addc_u32 s85, s57, 0
 s_mov_b32 s86, 15488
 s_mov_b32 s87, 0x20000
 s_mul_i32 s42, s3, 11264
 s_add_u32 s43, s42, 8192
 s_cmp_eq_u32 s3, 3
 s_cselect_b32 s43, 0x7000000, s43
 v_lshlrev_b32 v24, 4, v0
 v_add_u32 v25, 44032, v24
 v_add_u32 v26, 88064, v24
 v_add_u32 v27, 132096, v24
 v_lshlrev_b32 v2, 4, v0
 v_mov_b32 v7, v2
 v_add_u32 v8, 16384, v2
 v_mov_b32 v9, v2
 s_lshr_b32 s5, s70, 2
 s_lshr_b32 s4, s5, 2
 s_and_b32 s5, s5, 3
 s_lshl_b32 s5, s5, 3
 s_add_u32 s4, s4, s5
 s_lshl_b32 s4, s4, 7
 s_add_u32 s4, s4, 98304
 v_and_b32 v22, 7, v0
 v_lshlrev_b32 v22, 12, v22
 v_add_u32 v22, s4, v22
 s_lshl_b32 s4, s70, 14
 s_add_u32 s4, s4, 62914560
 s_add_u32 s8, s60, s4
 s_addc_u32 s9, s61, 0
 s_mov_b32 s10, 32768
 s_mov_b32 s11, 0x20000
 s_lshl_b32 s4, s70, 10
 s_add_u32 s4, s4, 65011712
 s_add_u32 s20, s60, s4
 s_addc_u32 s21, s61, 0
 s_mov_b32 s22, 2048
 s_mov_b32 s23, 0x20000
 s_mul_i32 s4, s70, 44032
 s_lshl_b32 s5, s71, 10
 s_add_u32 s4, s4, s5
 s_add_u32 s4, s4, 66060288
 s_add_u32 s24, s60, s4
 s_addc_u32 s25, s61, 0
 s_mov_b32 s26, 47104
 s_mov_b32 s27, 0x20000
 s_cmp_ge_u32 s74, 11
 s_cbranch_scc1 L_two_258
 s_mov_b32 s5, 0
 buffer_load_dword v36, v52, s[16:19], s5 offen sc1
 s_add_u32 s5, s5, 5632
 buffer_load_dword v37, v52, s[16:19], s5 offen sc1
 s_add_u32 s5, s5, 5632
 buffer_load_dword v38, v52, s[16:19], s5 offen sc1
 s_add_u32 s5, s5, 5632
 buffer_load_dword v39, v52, s[16:19], s5 offen sc1
 s_add_u32 s5, s5, 5632
 buffer_load_dword v40, v52, s[16:19], s5 offen sc1
 s_add_u32 s5, s5, 5632
 buffer_load_dword v41, v52, s[16:19], s5 offen sc1
 s_add_u32 s5, s5, 5632
 buffer_load_dword v42, v52, s[16:19], s5 offen sc1
 s_add_u32 s5, s5, 5632
 buffer_load_dword v43, v52, s[16:19], s5 offen sc1
 s_add_u32 s5, s5, 5632
 buffer_load_dword v44, v52, s[16:19], s5 offen sc1
 s_add_u32 s5, s5, 5632
 buffer_load_dword v45, v52, s[16:19], s5 offen sc1
 s_add_u32 s5, s5, 5632
 buffer_load_dword v46, v52, s[16:19], s5 offen sc1
 s_add_u32 s5, s5, 5632
 buffer_load_dword v47, v52, s[16:19], s5 offen sc1
 s_add_u32 s5, s5, 5632
 buffer_load_dword v48, v52, s[16:19], s5 offen sc1
 s_add_u32 s5, s5, 5632
 buffer_load_dword v49, v52, s[16:19], s5 offen sc1
 s_add_u32 s5, s5, 5632
 buffer_load_dword v50, v52, s[16:19], s5 offen sc1
 s_add_u32 s5, s5, 5632
 buffer_load_dword v51, v52, s[16:19], s5 offen sc1
 s_add_u32 m0, s73, 122880
 s_mov_b32 s72, 4096
 buffer_load_dwordx4 v28, s[12:15], s72 offen offset:0 sc1 lds
 buffer_load_dwordx4 v28, s[12:15], s72 offen offset:1024 sc1 lds
 buffer_load_dwordx4 v29, s[12:15], s72 offen offset:2048 sc1 lds
 buffer_load_dwordx4 v29, s[12:15], s72 offen offset:3072 sc1 lds
 s_add_u32 m0, s73, 126976
 s_nop 0
 buffer_load_dwordx4 v30, s[12:15], s72 offen offset:0 sc1 lds
 buffer_load_dwordx4 v30, s[12:15], s72 offen offset:1024 sc1 lds
 s_add_u32 m0, s73, 0
 s_mov_b32 s72, 6144
 buffer_load_dwordx4 v28, s[12:15], s72 offen offset:0 sc1 lds
 buffer_load_dwordx4 v28, s[12:15], s72 offen offset:1024 sc1 lds
 buffer_load_dwordx4 v29, s[12:15], s72 offen offset:2048 sc1 lds
 buffer_load_dwordx4 v29, s[12:15], s72 offen offset:3072 sc1 lds
 s_add_u32 m0, s73, 4096
 s_nop 0
 buffer_load_dwordx4 v30, s[12:15], s72 offen offset:0 sc1 lds
 buffer_load_dwordx4 v30, s[12:15], s72 offen offset:1024 sc1 lds
 v_and_b32 v20, 15, v0
 v_lshlrev_b32 v20, 3, v20
 v_lshrrev_b32 v3, 4, v0
 v_lshl_add_u32 v20, v3, 8, v20
 v_lshlrev_b32 v21, 4, v3
 v_add_u32 v21, 149504, v21
 v_add_u32 v10, 49152, v2
 v_add_u32 v11, 98304, v2
 s_waitcnt vmcnt(12)
 v_add_f32 v36, v36, v37
 v_add_f32 v36, v36, v38
 v_add_f32 v36, v36, v39
 v_add_f32 v36, v36, v40
 v_add_f32 v36, v36, v41
 v_add_f32 v36, v36, v42
 v_add_f32 v36, v36, v43
 v_add_f32 v36, v36, v44
 v_add_f32 v36, v36, v45
 v_add_f32 v36, v36, v46
 v_add_f32 v36, v36, v47
 v_add_f32 v36, v36, v48
 v_add_f32 v36, v36, v49
 v_add_f32 v36, v36, v50
 v_add_f32 v36, v36, v51
 ds_write_b32 v53, v36
 s_waitcnt lgkmcnt(0)
 s_mov_b32 s101, 0x40000
L_spin_260:
 buffer_load_dword v23, v22, s[96:99], 0 offen sc1
 s_waitcnt vmcnt(0)
 v_cmp_ne_u32 vcc, s100, v23
 s_nop 0
 s_cbranch_vccz L_ok_261
 s_sleep 1
 s_sub_u32 s101, s101, 1
 s_cmp_lg_u32 s101, 0
 s_cbranch_scc1 L_spin_260
L_ok_261:
 s_mov_b32 s5, 0
 buffer_load_dwordx4 a[0:3], v7, s[8:11], s5 offen offset:0 sc1
 buffer_load_dwordx4 a[4:7], v7, s[8:11], s5 offen offset:1024 sc1
 buffer_load_dwordx4 a[8:11], v8, s[8:11], s5 offen offset:0 sc1
 buffer_load_dwordx4 a[12:15], v8, s[8:11], s5 offen offset:1024 sc1
 buffer_load_dwordx2 v[160:161], v20, s[20:23], 0 offen offset:0 sc1
 buffer_load_dwordx2 v[162:163], v20, s[20:23], 0 offen offset:128 sc1
 buffer_load_dwordx2 v[164:165], v20, s[20:23], 0 offen offset:1024 sc1
 buffer_load_dwordx2 v[166:167], v20, s[20:23], 0 offen offset:1152 sc1
 s_mov_b32 s5, 2048
 buffer_load_dwordx4 a[16:19], v7, s[8:11], s5 offen offset:0 sc1
 buffer_load_dwordx4 a[20:23], v7, s[8:11], s5 offen offset:1024 sc1
 buffer_load_dwordx4 a[24:27], v8, s[8:11], s5 offen offset:0 sc1
 buffer_load_dwordx4 a[28:31], v8, s[8:11], s5 offen offset:1024 sc1
 s_mov_b32 s5, 4096
 buffer_load_dwordx4 a[32:35], v7, s[8:11], s5 offen offset:0 sc1
 buffer_load_dwordx4 a[36:39], v7, s[8:11], s5 offen offset:1024 sc1
 buffer_load_dwordx4 a[40:43], v8, s[8:11], s5 offen offset:0 sc1
 buffer_load_dwordx4 a[44:47], v8, s[8:11], s5 offen offset:1024 sc1
 s_barrier
 ds_read_b128 v[32:35], v10 offset:24576
 ds_read_b128 v[36:39], v10 offset:25600
 ds_read_b128 v[40:43], v10 offset:26624
 ds_read_b128 v[44:47], v10 offset:27648
 ds_read_b128 v[48:51], v10 offset:28672
 ds_read_b128 v[52:55], v10 offset:29696
 s_waitcnt vmcnt(12)
 s_waitcnt lgkmcnt(4)
 v_mfma_f32_16x16x32_bf16 v[64:67], v[32:35], a[0:3], 0
 ds_read_b128 v[56:59], v10 offset:30720
 v_mfma_f32_16x16x32_bf16 v[64:67], v[36:39], a[4:7], v[64:67]
 s_mov_b32 s5, 6144
 ds_read_b128 v[60:63], v10 offset:31744
 v_mfma_f32_16x16x32_bf16 v[68:71], v[36:39], a[12:15], 0
 buffer_load_dwordx4 a[48:51], v7, s[8:11], s5 offen offset:0 sc1
 v_mfma_f32_16x16x32_bf16 v[68:71], v[32:35], a[8:11], v[68:71]
 s_waitcnt lgkmcnt(4)
 s_add_u32 m0, s73, 24576
 s_mov_b32 s72, 8192
 v_mfma_f32_16x16x32_bf16 v[76:79], v[40:43], a[8:11], 0
 buffer_load_dwordx4 a[52:55], v7, s[8:11], s5 offen offset:1024 sc1
 v_mfma_f32_16x16x32_bf16 v[76:79], v[44:47], a[12:15], v[76:79]
 buffer_load_dwordx4 v28, s[12:15], s72 offen offset:0 sc1 lds
 v_mfma_f32_16x16x32_bf16 v[72:75], v[44:47], a[4:7], 0
 ds_read_b128 v[32:35], v10 offset:32768
 v_mfma_f32_16x16x32_bf16 v[72:75], v[40:43], a[0:3], v[72:75]
 s_waitcnt lgkmcnt(3)
 ds_read_b128 v[36:39], v10 offset:33792
 v_mfma_f32_16x16x32_bf16 v[80:83], v[48:51], a[0:3], 0
 buffer_load_dwordx4 a[56:59], v8, s[8:11], s5 offen offset:0 sc1
 v_mfma_f32_16x16x32_bf16 v[80:83], v[52:55], a[4:7], v[80:83]
 buffer_load_dwordx4 v28, s[12:15], s72 offen offset:1024 sc1 lds
 v_mfma_f32_16x16x32_bf16 v[84:87], v[52:55], a[12:15], 0
 ds_read_b128 v[40:43], v10 offset:34816
 v_mfma_f32_16x16x32_bf16 v[84:87], v[48:51], a[8:11], v[84:87]
 s_waitcnt lgkmcnt(3)
 ds_read_b128 v[44:47], v10 offset:35840
 v_mfma_f32_16x16x32_bf16 v[92:95], v[56:59], a[8:11], 0
 buffer_load_dwordx4 a[60:63], v8, s[8:11], s5 offen offset:1024 sc1
 v_mfma_f32_16x16x32_bf16 v[92:95], v[60:63], a[12:15], v[92:95]
 buffer_load_dwordx4 v29, s[12:15], s72 offen offset:2048 sc1 lds
 v_mfma_f32_16x16x32_bf16 v[88:91], v[60:63], a[4:7], 0
 ds_read_b128 v[48:51], v10 offset:36864
 v_mfma_f32_16x16x32_bf16 v[88:91], v[56:59], a[0:3], v[88:91]
 s_waitcnt lgkmcnt(3)
 ds_read_b128 v[52:55], v10 offset:37888
 v_mfma_f32_16x16x32_bf16 v[96:99], v[32:35], a[0:3], 0
 buffer_load_dwordx4 v29, s[12:15], s72 offen offset:3072 sc1 lds
 v_mfma_f32_16x16x32_bf16 v[96:99], v[36:39], a[4:7], v[96:99]
 s_mov_b32 s5, 8192
 ds_read_b128 v[56:59], v10 offset:38912
 v_mfma_f32_16x16x32_bf16 v[100:103], v[36:39], a[12:15], 0
 buffer_load_dwordx4 a[64:67], v7, s[8:11], s5 offen offset:0 sc1
 v_mfma_f32_16x16x32_bf16 v[100:103], v[32:35], a[8:11], v[100:103]
 s_waitcnt lgkmcnt(3)
 ds_read_b128 v[60:63], v10 offset:39936
 v_mfma_f32_16x16x32_bf16 v[108:111], v[40:43], a[8:11], 0
 buffer_load_dwordx4 a[68:71], v7, s[8:11], s5 offen offset:1024 sc1
 v_mfma_f32_16x16x32_bf16 v[108:111], v[44:47], a[12:15], v[108:111]
 s_add_u32 m0, s73, 28672
 ds_read_b128 v[32:35], v10 offset:40960
 v_mfma_f32_16x16x32_bf16 v[104:107], v[44:47], a[4:7], 0
 buffer_load_dwordx4 v30, s[12:15], s72 offen offset:0 sc1 lds
 v_mfma_f32_16x16x32_bf16 v[104:107], v[40:43], a[0:3], v[104:107]
 s_waitcnt lgkmcnt(3)
 ds_read_b128 v[36:39], v10 offset:41984
 v_mfma_f32_16x16x32_bf16 v[112:115], v[48:51], a[0:3], 0
 buffer_load_dwordx4 a[72:75], v8, s[8:11], s5 offen offset:0 sc1
 v_mfma_f32_16x16x32_bf16 v[112:115], v[52:55], a[4:7], v[112:115]
 ds_read_b128 v[40:43], v10 offset:43008
 v_mfma_f32_16x16x32_bf16 v[116:119], v[52:55], a[12:15], 0
 buffer_load_dwordx4 a[76:79], v8, s[8:11], s5 offen offset:1024 sc1
 v_mfma_f32_16x16x32_bf16 v[116:119], v[48:51], a[8:11], v[116:119]
 s_waitcnt lgkmcnt(3)
 ds_read_b128 v[44:47], v10 offset:44032
 v_mfma_f32_16x16x32_bf16 v[124:127], v[56:59], a[8:11], 0
 buffer_load_dwordx4 v30, s[12:15], s72 offen offset:1024 sc1 lds
 v_mfma_f32_16x16x32_bf16 v[124:127], v[60:63], a[12:15], v[124:127]
 ds_read_b128 v[48:51], v10 offset:45056
 v_mfma_f32_16x16x32_bf16 v[120:123], v[60:63], a[4:7], 0
 ds_read_b128 v[52:55], v10 offset:46080
 v_mfma_f32_16x16x32_bf16 v[120:123], v[56:59], a[0:3], v[120:123]
 s_waitcnt lgkmcnt(4)
 v_mfma_f32_16x16x32_bf16 v[128:131], v[32:35], a[0:3], 0
 ds_read_b128 v[56:59], v10 offset:47104
 v_mfma_f32_16x16x32_bf16 v[128:131], v[36:39], a[4:7], v[128:131]
 ds_read_b128 v[60:63], v10 offset:48128
 v_mfma_f32_16x16x32_bf16 v[132:135], v[36:39], a[12:15], 0
 v_mfma_f32_16x16x32_bf16 v[132:135], v[32:35], a[8:11], v[132:135]
 s_waitcnt lgkmcnt(4)
 v_mfma_f32_16x16x32_bf16 v[140:143], v[40:43], a[8:11], 0
 ds_read_b128 v[32:35], v11 offset:0
 v_mfma_f32_16x16x32_bf16 v[140:143], v[44:47], a[12:15], v[140:143]
 ds_read_b128 v[36:39], v11 offset:1024
 v_mfma_f32_16x16x32_bf16 v[136:139], v[44:47], a[4:7], 0
 v_mfma_f32_16x16x32_bf16 v[136:139], v[40:43], a[0:3], v[136:139]
 s_waitcnt lgkmcnt(4)
 v_mfma_f32_16x16x32_bf16 v[144:147], v[48:51], a[0:3], 0
 ds_read_b128 v[40:43], v11 offset:2048
 v_mfma_f32_16x16x32_bf16 v[144:147], v[52:55], a[4:7], v[144:147]
 ds_read_b128 v[44:47], v11 offset:3072
 v_mfma_f32_16x16x32_bf16 v[148:151], v[52:55], a[12:15], 0
 v_mfma_f32_16x16x32_bf16 v[148:151], v[48:51], a[8:11], v[148:151]
 s_waitcnt lgkmcnt(4)
 v_mfma_f32_16x16x32_bf16 v[156:159], v[56:59], a[8:11], 0
 ds_read_b128 v[48:51], v11 offset:4096
 v_mfma_f32_16x16x32_bf16 v[156:159], v[60:63], a[12:15], v[156:159]
 ds_read_b128 v[52:55], v11 offset:5120
 v_mfma_f32_16x16x32_bf16 v[152:155], v[60:63], a[4:7], 0
 v_mfma_f32_16x16x32_bf16 v[152:155], v[56:59], a[0:3], v[152:155]
 s_waitcnt vmcnt(18)
 s_waitcnt lgkmcnt(4)
 v_mfma_f32_16x16x32_bf16 v[64:67], v[32:35], a[16:19], v[64:67]
 ds_read_b128 v[56:59], v11 offset:6144
 v_mfma_f32_16x16x32_bf16 v[64:67], v[36:39], a[20:23], v[64:67]
 s_mov_b32 s5, 10240
 v_add_f32 v12, v160, v162
 s_add_u32 m0, s73, 49152
 v_mfma_f32_16x16x32_bf16 v[68:71], v[36:39], a[28:31], v[68:71]
 buffer_load_dwordx4 a[80:83], v7, s[8:11], s5 offen offset:0 sc1
 v_mfma_f32_16x16x32_bf16 v[68:71], v[32:35], a[24:27], v[68:71]
 s_waitcnt lgkmcnt(3)
 ds_read_b128 v[60:63], v11 offset:7168
 v_mfma_f32_16x16x32_bf16 v[76:79], v[40:43], a[24:27], v[76:79]
 buffer_load_dwordx4 a[84:87], v7, s[8:11], s5 offen offset:1024 sc1
 v_mfma_f32_16x16x32_bf16 v[76:79], v[44:47], a[28:31], v[76:79]
 s_mov_b32 s72, 10240
 ds_read_b128 v[32:35], v11 offset:8192
 v_mfma_f32_16x16x32_bf16 v[72:75], v[44:47], a[20:23], v[72:75]
 buffer_load_dwordx4 v28, s[12:15], s72 offen offset:0 sc1 lds
 v_mfma_f32_16x16x32_bf16 v[72:75], v[40:43], a[16:19], v[72:75]
 s_waitcnt lgkmcnt(3)
 ds_read_b128 v[36:39], v11 offset:9216
 v_mfma_f32_16x16x32_bf16 v[80:83], v[48:51], a[16:19], v[80:83]
 buffer_load_dwordx4 a[88:91], v8, s[8:11], s5 offen offset:0 sc1
 v_mfma_f32_16x16x32_bf16 v[80:83], v[52:55], a[20:23], v[80:83]
 buffer_load_dwordx4 a[92:95], v8, s[8:11], s5 offen offset:1024 sc1
 v_mfma_f32_16x16x32_bf16 v[84:87], v[52:55], a[28:31], v[84:87]
 ds_read_b128 v[40:43], v11 offset:10240
 v_mov_b32 v3, v12
 v_mfma_f32_16x16x32_bf16 v[84:87], v[48:51], a[24:27], v[84:87]
 s_waitcnt lgkmcnt(3)
 ds_read_b128 v[44:47], v11 offset:11264
 v_mfma_f32_16x16x32_bf16 v[92:95], v[56:59], a[24:27], v[92:95]
 ds_read_b128 v[48:51], v11 offset:12288
 v_permlane16_swap_b32 v12, v3
 v_mfma_f32_16x16x32_bf16 v[92:95], v[60:63], a[28:31], v[92:95]
 buffer_load_dwordx4 v28, s[12:15], s72 offen offset:1024 sc1 lds
 v_mfma_f32_16x16x32_bf16 v[88:91], v[60:63], a[20:23], v[88:91]
 ds_read_b128 v[52:55], v11 offset:13312
 v_add_f32 v12, v12, v3
 v_mfma_f32_16x16x32_bf16 v[88:91], v[56:59], a[16:19], v[88:91]
 s_waitcnt lgkmcnt(4)
 v_mov_b32 v3, v12
 s_mov_b32 s5, 12288
 v_mfma_f32_16x16x32_bf16 v[96:99], v[32:35], a[16:19], v[96:99]
 buffer_load_dwordx4 v29, s[12:15], s72 offen offset:2048 sc1 lds
 v_mfma_f32_16x16x32_bf16 v[96:99], v[36:39], a[20:23], v[96:99]
 buffer_load_dwordx4 v29, s[12:15], s72 offen offset:3072 sc1 lds
 v_mfma_f32_16x16x32_bf16 v[100:103], v[36:39], a[28:31], v[100:103]
 ds_read_b128 v[56:59], v11 offset:14336
 v_permlane32_swap_b32 v12, v3
 v_mfma_f32_16x16x32_bf16 v[100:103], v[32:35], a[24:27], v[100:103]
 s_waitcnt lgkmcnt(3)
 ds_read_b128 v[60:63], v11 offset:15360
 v_mfma_f32_16x16x32_bf16 v[108:111], v[40:43], a[24:27], v[108:111]
 buffer_load_dwordx4 a[96:99], v7, s[8:11], s5 offen offset:0 sc1
 v_mfma_f32_16x16x32_bf16 v[108:111], v[44:47], a[28:31], v[108:111]
 buffer_load_dwordx4 a[100:103], v7, s[8:11], s5 offen offset:1024 sc1
 v_mfma_f32_16x16x32_bf16 v[104:107], v[44:47], a[20:23], v[104:107]
 ds_read_b128 v[32:35], v11 offset:16384
 v_add_f32 v12, v12, v3
 v_mfma_f32_16x16x32_bf16 v[104:107], v[40:43], a[16:19], v[104:107]
 s_waitcnt lgkmcnt(3)
 ds_read_b128 v[36:39], v11 offset:17408
 v_mfma_f32_16x16x32_bf16 v[112:115], v[48:51], a[16:19], v[112:115]
 buffer_load_dwordx4 a[104:107], v8, s[8:11], s5 offen offset:0 sc1
 v_mfma_f32_16x16x32_bf16 v[112:115], v[52:55], a[20:23], v[112:115]
 ds_read_b128 v[40:43], v11 offset:18432
 v_mul_f32 v12, 0x3e000000, v12
 v_mfma_f32_16x16x32_bf16 v[116:119], v[52:55], a[28:31], v[116:119]
 buffer_load_dwordx4 a[108:111], v8, s[8:11], s5 offen offset:1024 sc1
 v_mfma_f32_16x16x32_bf16 v[116:119], v[48:51], a[24:27], v[116:119]
 s_waitcnt lgkmcnt(3)
 ds_read_b128 v[44:47], v11 offset:19456
 v_mfma_f32_16x16x32_bf16 v[124:127], v[56:59], a[24:27], v[124:127]
 s_add_u32 m0, s73, 53248
 ds_read_b128 v[48:51], v11 offset:20480
 v_mfma_f32_16x16x32_bf16 v[124:127], v[60:63], a[28:31], v[124:127]
 buffer_load_dwordx4 v30, s[12:15], s72 offen offset:0 sc1 lds
 v_mfma_f32_16x16x32_bf16 v[120:123], v[60:63], a[20:23], v[120:123]
 ds_read_b128 v[52:55], v11 offset:21504
 v_sub_f32 v160, v160, v12
 v_mfma_f32_16x16x32_bf16 v[120:123], v[56:59], a[16:19], v[120:123]
 s_waitcnt lgkmcnt(4)
 v_sub_f32 v162, v162, v12
 v_mul_f32 v160, v160, v160
 v_mfma_f32_16x16x32_bf16 v[128:131], v[32:35], a[16:19], v[128:131]
 buffer_load_dwordx4 v30, s[12:15], s72 offen offset:1024 sc1 lds
 v_mfma_f32_16x16x32_bf16 v[128:131], v[36:39], a[20:23], v[128:131]
 ds_read_b128 v[56:59], v11 offset:22528
 v_fmac_f32 v160, v162, v162
 v_mfma_f32_16x16x32_bf16 v[132:135], v[36:39], a[28:31], v[132:135]
 ds_read_b128 v[60:63], v11 offset:23552
 v_add_f32 v14, v161, v163
 v_mfma_f32_16x16x32_bf16 v[132:135], v[32:35], a[24:27], v[132:135]
 s_waitcnt lgkmcnt(4)
 v_fmac_f32 v14, 0x42800000, v160
 s_barrier
 v_mfma_f32_16x16x32_bf16 v[140:143], v[40:43], a[24:27], v[140:143]
 s_add_u32 m0, s73, 73728
 ds_read_b128 v[32:35], v11 offset:24576
 v_mfma_f32_16x16x32_bf16 v[140:143], v[44:47], a[28:31], v[140:143]
 s_mov_b32 s72, 12288
 buffer_load_dwordx4 v28, s[12:15], s72 offen offset:0 sc1 lds
 v_mfma_f32_16x16x32_bf16 v[136:139], v[44:47], a[20:23], v[136:139]
 buffer_load_dwordx4 v28, s[12:15], s72 offen offset:1024 sc1 lds
 v_mfma_f32_16x16x32_bf16 v[136:139], v[40:43], a[16:19], v[136:139]
 s_waitcnt lgkmcnt(3)
 ds_read_b128 v[36:39], v11 offset:25600
 v_mfma_f32_16x16x32_bf16 v[144:147], v[48:51], a[16:19], v[144:147]
 buffer_load_dwordx4 v29, s[12:15], s72 offen offset:2048 sc1 lds
 v_mfma_f32_16x16x32_bf16 v[144:147], v[52:55], a[20:23], v[144:147]
 buffer_load_dwordx4 v29, s[12:15], s72 offen offset:3072 sc1 lds
 v_mfma_f32_16x16x32_bf16 v[148:151], v[52:55], a[28:31], v[148:151]
 s_add_u32 m0, s73, 77824
 ds_read_b128 v[40:43], v11 offset:26624
 v_mfma_f32_16x16x32_bf16 v[148:151], v[48:51], a[24:27], v[148:151]
 s_waitcnt lgkmcnt(3)
 ds_read_b128 v[44:47], v11 offset:27648
 v_mfma_f32_16x16x32_bf16 v[156:159], v[56:59], a[24:27], v[156:159]
 buffer_load_dwordx4 v30, s[12:15], s72 offen offset:0 sc1 lds
 v_mfma_f32_16x16x32_bf16 v[156:159], v[60:63], a[28:31], v[156:159]
 buffer_load_dwordx4 v30, s[12:15], s72 offen offset:1024 sc1 lds
 v_mfma_f32_16x16x32_bf16 v[152:155], v[60:63], a[20:23], v[152:155]
 ds_read_b128 v[48:51], v11 offset:28672
 v_mov_b32 v3, v14
 v_mfma_f32_16x16x32_bf16 v[152:155], v[56:59], a[16:19], v[152:155]
 ds_read_b128 v[52:55], v11 offset:29696
 v_permlane16_swap_b32 v14, v3
 v_add_f32 v14, v14, v3
 v_mov_b32 v3, v14
 s_nop 1
 v_permlane32_swap_b32 v14, v3
 v_add_f32 v14, v14, v3
 v_mul_f32 v14, 0x3b000000, v14
 v_cvt_pk_bf16_f32 v12, v12, v14
 v_and_b32 v14, 0xffff0000, v12
 v_lshlrev_b32 v12, 16, v12
 v_xor_b32 v12, 0x80000000, v12
 v_add_f32 v14, 0x3727c5ac, v14
 v_cvt_pk_bf16_f32 v14, v14, v14
 v_lshlrev_b32 v14, 16, v14
 v_sqrt_f32 v14, v14
 s_nop 0
 v_cvt_pk_bf16_f32 v14, v14, v14
 v_lshlrev_b32 v14, 16, v14
 v_mul_f32 v16, v14, v14
 v_rcp_f32 v14, v14
 s_waitcnt vmcnt(34)
 s_waitcnt lgkmcnt(4)
 v_mfma_f32_16x16x32_bf16 v[64:67], v[32:35], a[32:35], v[64:67]
 v_mul_f32 v18, 0xbfb8aa3b, v14
 v_add_f32 v13, v164, v166
 v_mfma_f32_16x16x32_bf16 v[64:67], v[36:39], a[36:39], v[64:67]
 ds_read_b128 v[56:59], v11 offset:30720
 v_mov_b32 v3, v13
 v_mfma_f32_16x16x32_bf16 v[68:71], v[36:39], a[44:47], v[68:71]
 s_mov_b32 s5, 14336
 v_permlane16_swap_b32 v13, v3
 v_add_f32 v13, v13, v3
 v_mfma_f32_16x16x32_bf16 v[68:71], v[32:35], a[40:43], v[68:71]
 s_waitcnt lgkmcnt(3)
 ds_read_b128 v[60:63], v11 offset:31744
 v_mfma_f32_16x16x32_bf16 v[76:79], v[40:43], a[40:43], v[76:79]
 v_mov_b32 v3, v13
 s_nop 1
 v_permlane32_swap_b32 v13, v3
 v_mfma_f32_16x16x32_bf16 v[76:79], v[44:47], a[44:47], v[76:79]
 buffer_load_dwordx4 a[112:115], v7, s[8:11], s5 offen offset:0 sc1
 v_mfma_f32_16x16x32_bf16 v[72:75], v[44:47], a[36:39], v[72:75]
 ds_read_b128 v[32:35], v11 offset:32768
 v_mfma_f32_16x16x32_bf16 v[72:75], v[40:43], a[32:35], v[72:75]
 s_waitcnt lgkmcnt(3)
 ds_read_b128 v[36:39], v11 offset:33792
 v_mfma_f32_16x16x32_bf16 v[80:83], v[48:51], a[32:35], v[80:83]
 ds_read_b128 v[40:43], v11 offset:34816
 v_mfma_f32_16x16x32_bf16 v[80:83], v[52:55], a[36:39], v[80:83]
 buffer_load_dwordx4 a[116:119], v7, s[8:11], s5 offen offset:1024 sc1
 v_mfma_f32_16x16x32_bf16 v[84:87], v[52:55], a[44:47], v[84:87]
 ds_read_b128 v[44:47], v11 offset:35840
 v_mfma_f32_16x16x32_bf16 v[84:87], v[48:51], a[40:43], v[84:87]
 s_waitcnt lgkmcnt(4)
 v_mfma_f32_16x16x32_bf16 v[92:95], v[56:59], a[40:43], v[92:95]
 ds_read_b128 v[48:51], v11 offset:36864
 v_add_f32 v13, v13, v3
 v_mfma_f32_16x16x32_bf16 v[92:95], v[60:63], a[44:47], v[92:95]
 ds_read_b128 v[52:55], v11 offset:37888
 v_mul_f32 v13, 0x3e000000, v13
 v_mfma_f32_16x16x32_bf16 v[88:91], v[60:63], a[36:39], v[88:91]
 v_sub_f32 v164, v164, v13
 v_mfma_f32_16x16x32_bf16 v[88:91], v[56:59], a[32:35], v[88:91]
 s_waitcnt lgkmcnt(4)
 v_sub_f32 v166, v166, v13
 v_mfma_f32_16x16x32_bf16 v[96:99], v[32:35], a[32:35], v[96:99]
 buffer_load_dwordx4 a[120:123], v8, s[8:11], s5 offen offset:0 sc1
 v_mfma_f32_16x16x32_bf16 v[96:99], v[36:39], a[36:39], v[96:99]
 ds_read_b128 v[56:59], v11 offset:38912
 v_mul_f32 v164, v164, v164
 v_mfma_f32_16x16x32_bf16 v[100:103], v[36:39], a[44:47], v[100:103]
 ds_read_b128 v[60:63], v11 offset:39936
 v_fmac_f32 v164, v166, v166
 v_mfma_f32_16x16x32_bf16 v[100:103], v[32:35], a[40:43], v[100:103]
 s_waitcnt lgkmcnt(4)
 v_add_f32 v15, v165, v167
 v_mfma_f32_16x16x32_bf16 v[108:111], v[40:43], a[40:43], v[108:111]
 ds_read_b128 v[32:35], v11 offset:40960
 v_fmac_f32 v15, 0x42800000, v164
 v_mfma_f32_16x16x32_bf16 v[108:111], v[44:47], a[44:47], v[108:111]
 ds_read_b128 v[36:39], v11 offset:41984
 v_mov_b32 v3, v15
 v_mfma_f32_16x16x32_bf16 v[104:107], v[44:47], a[36:39], v[104:107]
 s_nop 0
 v_permlane16_swap_b32 v15, v3
 v_mfma_f32_16x16x32_bf16 v[104:107], v[40:43], a[32:35], v[104:107]
 s_waitcnt lgkmcnt(4)
 v_add_f32 v15, v15, v3
 v_mov_b32 v3, v15
 v_mfma_f32_16x16x32_bf16 v[112:115], v[48:51], a[32:35], v[112:115]
 buffer_load_dwordx4 a[124:127], v8, s[8:11], s5 offen offset:1024 sc1
 v_mfma_f32_16x16x32_bf16 v[112:115], v[52:55], a[36:39], v[112:115]
 ds_read_b128 v[40:43], v11 offset:43008
 v_permlane32_swap_b32 v15, v3
 v_mfma_f32_16x16x32_bf16 v[116:119], v[52:55], a[44:47], v[116:119]
 ds_read_b128 v[44:47], v11 offset:44032
 v_add_f32 v15, v15, v3
 v_mfma_f32_16x16x32_bf16 v[116:119], v[48:51], a[40:43], v[116:119]
 s_waitcnt lgkmcnt(4)
 v_mul_f32 v15, 0x3b000000, v15
 v_cvt_pk_bf16_f32 v13, v13, v15
 v_mfma_f32_16x16x32_bf16 v[124:127], v[56:59], a[40:43], v[124:127]
 ds_read_b128 v[48:51], v11 offset:45056
 v_and_b32 v15, 0xffff0000, v13
 v_mfma_f32_16x16x32_bf16 v[124:127], v[60:63], a[44:47], v[124:127]
 ds_read_b128 v[52:55], v11 offset:46080
 v_lshlrev_b32 v13, 16, v13
 v_mfma_f32_16x16x32_bf16 v[120:123], v[60:63], a[36:39], v[120:123]
 v_xor_b32 v13, 0x80000000, v13
 v_add_f32 v15, 0x3727c5ac, v15
 v_mfma_f32_16x16x32_bf16 v[120:123], v[56:59], a[32:35], v[120:123]
 s_waitcnt lgkmcnt(4)
 v_cvt_pk_bf16_f32 v15, v15, v15
 v_mfma_f32_16x16x32_bf16 v[128:131], v[32:35], a[32:35], v[128:131]
 ds_read_b128 v[56:59], v11 offset:47104
 v_lshlrev_b32 v15, 16, v15
 v_mfma_f32_16x16x32_bf16 v[128:131], v[36:39], a[36:39], v[128:131]
 v_sqrt_f32 v15, v15
 v_mfma_f32_16x16x32_bf16 v[132:135], v[36:39], a[44:47], v[132:135]
 ds_read_b128 v[60:63], v11 offset:48128
 v_mfma_f32_16x16x32_bf16 v[132:135], v[32:35], a[40:43], v[132:135]
 s_waitcnt lgkmcnt(4)
 v_cvt_pk_bf16_f32 v15, v15, v15
 s_barrier
 v_mfma_f32_16x16x32_bf16 v[140:143], v[40:43], a[40:43], v[140:143]
 s_add_u32 m0, s73, 98304
 ds_read_b128 v[32:35], v9 offset:0
 v_mfma_f32_16x16x32_bf16 v[140:143], v[44:47], a[44:47], v[140:143]
 s_mov_b32 s72, 14336
 ds_read_b128 v[36:39], v9 offset:1024
 v_mfma_f32_16x16x32_bf16 v[136:139], v[44:47], a[36:39], v[136:139]
 buffer_load_dwordx4 v28, s[12:15], s72 offen offset:0 sc1 lds
 v_mfma_f32_16x16x32_bf16 v[136:139], v[40:43], a[32:35], v[136:139]
 s_waitcnt lgkmcnt(4)
 v_lshlrev_b32 v15, 16, v15
 v_mul_f32 v17, v15, v15
 v_mfma_f32_16x16x32_bf16 v[144:147], v[48:51], a[32:35], v[144:147]
 buffer_load_dwordx4 v28, s[12:15], s72 offen offset:1024 sc1 lds
 v_mfma_f32_16x16x32_bf16 v[144:147], v[52:55], a[36:39], v[144:147]
 buffer_load_dwordx4 v29, s[12:15], s72 offen offset:2048 sc1 lds
 v_mfma_f32_16x16x32_bf16 v[148:151], v[52:55], a[44:47], v[148:151]
 ds_read_b128 v[40:43], v9 offset:2048
 v_rcp_f32 v15, v15
 v_mfma_f32_16x16x32_bf16 v[148:151], v[48:51], a[40:43], v[148:151]
 s_waitcnt lgkmcnt(3)
 ds_read_b128 v[44:47], v9 offset:3072
 v_mfma_f32_16x16x32_bf16 v[156:159], v[56:59], a[40:43], v[156:159]
 buffer_load_dwordx4 v29, s[12:15], s72 offen offset:3072 sc1 lds
 v_mfma_f32_16x16x32_bf16 v[156:159], v[60:63], a[44:47], v[156:159]
 s_add_u32 m0, s73, 102400
 ds_read_b128 v[48:51], v9 offset:4096
 v_mfma_f32_16x16x32_bf16 v[152:155], v[60:63], a[36:39], v[152:155]
 buffer_load_dwordx4 v30, s[12:15], s72 offen offset:0 sc1 lds
 v_mfma_f32_16x16x32_bf16 v[152:155], v[56:59], a[32:35], v[152:155]
 buffer_load_dwordx4 v30, s[12:15], s72 offen offset:1024 sc1 lds
 ds_read_b128 v[52:55], v9 offset:5120
 v_mul_f32 v19, 0xbfb8aa3b, v15
 s_waitcnt vmcnt(38)
 s_waitcnt lgkmcnt(4)
 v_mfma_f32_16x16x32_bf16 v[64:67], v[32:35], a[48:51], v[64:67]
 ds_read_b128 v[176:179], v21 offset:0
 v_mfma_f32_16x16x32_bf16 v[64:67], v[36:39], a[52:55], v[64:67]
 ds_read_b128 v[180:183], v21 offset:64
 v_mfma_f32_16x16x32_bf16 v[68:71], v[36:39], a[60:63], v[68:71]
 ds_read_b128 v[56:59], v9 offset:6144
 v_mfma_f32_16x16x32_bf16 v[68:71], v[32:35], a[56:59], v[68:71]
 s_waitcnt lgkmcnt(5)
 ds_read_b128 v[60:63], v9 offset:7168
 v_mfma_f32_16x16x32_bf16 v[76:79], v[40:43], a[56:59], v[76:79]
 ds_read_b128 v[184:187], v21 offset:128
 v_mfma_f32_16x16x32_bf16 v[76:79], v[44:47], a[60:63], v[76:79]
 ds_read_b128 v[32:35], v9 offset:8192
 v_mfma_f32_16x16x32_bf16 v[72:75], v[44:47], a[52:55], v[72:75]
 ds_read_b128 v[36:39], v9 offset:9216
 v_mfma_f32_16x16x32_bf16 v[72:75], v[40:43], a[48:51], v[72:75]
 s_waitcnt lgkmcnt(7)
 v_mfma_f32_16x16x32_bf16 v[80:83], v[48:51], a[48:51], v[80:83]
 ds_read_b128 v[188:191], v21 offset:192
 v_mfma_f32_16x16x32_bf16 v[80:83], v[52:55], a[52:55], v[80:83]
 ds_read_b128 v[40:43], v9 offset:10240
 v_mfma_f32_16x16x32_bf16 v[84:87], v[52:55], a[60:63], v[84:87]
 ds_read_b128 v[44:47], v9 offset:11264
 v_mfma_f32_16x16x32_bf16 v[84:87], v[48:51], a[56:59], v[84:87]
 s_waitcnt lgkmcnt(6)
 v_mfma_f32_16x16x32_bf16 v[92:95], v[56:59], a[56:59], v[92:95]
 ds_read_b128 v[192:195], v21 offset:256
 v_mfma_f32_16x16x32_bf16 v[92:95], v[60:63], a[60:63], v[92:95]
 ds_read_b128 v[48:51], v9 offset:12288
 v_mfma_f32_16x16x32_bf16 v[88:91], v[60:63], a[52:55], v[88:91]
 ds_read_b128 v[52:55], v9 offset:13312
 v_mfma_f32_16x16x32_bf16 v[88:91], v[56:59], a[48:51], v[88:91]
 s_waitcnt lgkmcnt(6)
 v_mfma_f32_16x16x32_bf16 v[96:99], v[32:35], a[48:51], v[96:99]
 ds_read_b128 v[196:199], v21 offset:320
 v_mfma_f32_16x16x32_bf16 v[96:99], v[36:39], a[52:55], v[96:99]
 ds_read_b128 v[56:59], v9 offset:14336
 v_mfma_f32_16x16x32_bf16 v[100:103], v[36:39], a[60:63], v[100:103]
 ds_read_b128 v[60:63], v9 offset:15360
 v_mfma_f32_16x16x32_bf16 v[100:103], v[32:35], a[56:59], v[100:103]
 s_waitcnt lgkmcnt(6)
 v_mfma_f32_16x16x32_bf16 v[108:111], v[40:43], a[56:59], v[108:111]
 ds_read_b128 v[200:203], v21 offset:384
 v_mfma_f32_16x16x32_bf16 v[108:111], v[44:47], a[60:63], v[108:111]
 ds_read_b128 v[32:35], v9 offset:16384
 v_mfma_f32_16x16x32_bf16 v[104:107], v[44:47], a[52:55], v[104:107]
 ds_read_b128 v[36:39], v9 offset:17408
 v_mfma_f32_16x16x32_bf16 v[104:107], v[40:43], a[48:51], v[104:107]
 s_waitcnt lgkmcnt(6)
 v_mfma_f32_16x16x32_bf16 v[112:115], v[48:51], a[48:51], v[112:115]
 ds_read_b128 v[204:207], v21 offset:448
 v_mfma_f32_16x16x32_bf16 v[112:115], v[52:55], a[52:55], v[112:115]
 ds_read_b128 v[40:43], v9 offset:18432
 v_mfma_f32_16x16x32_bf16 v[116:119], v[52:55], a[60:63], v[116:119]
 ds_read_b128 v[44:47], v9 offset:19456
 v_mfma_f32_16x16x32_bf16 v[116:119], v[48:51], a[56:59], v[116:119]
 s_waitcnt lgkmcnt(6)
 v_mfma_f32_16x16x32_bf16 v[124:127], v[56:59], a[56:59], v[124:127]
 ds_read_b128 v[208:211], v21 offset:512
 v_mfma_f32_16x16x32_bf16 v[124:127], v[60:63], a[60:63], v[124:127]
 ds_read_b128 v[48:51], v9 offset:20480
 v_mfma_f32_16x16x32_bf16 v[120:123], v[60:63], a[52:55], v[120:123]
 ds_read_b128 v[52:55], v9 offset:21504
 v_mfma_f32_16x16x32_bf16 v[120:123], v[56:59], a[48:51], v[120:123]
 s_waitcnt lgkmcnt(6)
 v_mfma_f32_16x16x32_bf16 v[128:131], v[32:35], a[48:51], v[128:131]
 ds_read_b128 v[212:215], v21 offset:576
 v_mfma_f32_16x16x32_bf16 v[128:131], v[36:39], a[52:55], v[128:131]
 ds_read_b128 v[56:59], v9 offset:22528
 v_mfma_f32_16x16x32_bf16 v[132:135], v[36:39], a[60:63], v[132:135]
 ds_read_b128 v[60:63], v9 offset:23552
 v_mfma_f32_16x16x32_bf16 v[132:135], v[32:35], a[56:59], v[132:135]
 s_waitcnt lgkmcnt(6)
 s_waitcnt vmcnt(30)
 s_barrier
 v_mfma_f32_16x16x32_bf16 v[140:143], v[40:43], a[56:59], v[140:143]
 ds_read_b128 v[216:219], v21 offset:640
 v_mfma_f32_16x16x32_bf16 v[140:143], v[44:47], a[60:63], v[140:143]
 ds_read_b128 v[32:35], v9 offset:24576
 v_mfma_f32_16x16x32_bf16 v[136:139], v[44:47], a[52:55], v[136:139]
 ds_read_b128 v[36:39], v9 offset:25600
 v_mfma_f32_16x16x32_bf16 v[136:139], v[40:43], a[48:51], v[136:139]
 s_waitcnt lgkmcnt(6)
 v_mfma_f32_16x16x32_bf16 v[144:147], v[48:51], a[48:51], v[144:147]
 ds_read_b128 v[220:223], v21 offset:704
 v_mfma_f32_16x16x32_bf16 v[144:147], v[52:55], a[52:55], v[144:147]
 ds_read_b128 v[40:43], v9 offset:26624
 v_mfma_f32_16x16x32_bf16 v[148:151], v[52:55], a[60:63], v[148:151]
 ds_read_b128 v[44:47], v9 offset:27648
 v_mfma_f32_16x16x32_bf16 v[148:151], v[48:51], a[56:59], v[148:151]
 s_waitcnt lgkmcnt(6)
 v_mfma_f32_16x16x32_bf16 v[156:159], v[56:59], a[56:59], v[156:159]
 ds_read_b128 v[48:51], v9 offset:28672
 v_mfma_f32_16x16x32_bf16 v[156:159], v[60:63], a[60:63], v[156:159]
 ds_read_b128 v[52:55], v9 offset:29696
 v_mfma_f32_16x16x32_bf16 v[152:155], v[60:63], a[52:55], v[152:155]
 v_mfma_f32_16x16x32_bf16 v[152:155], v[56:59], a[48:51], v[152:155]
 s_waitcnt lgkmcnt(5)
 v_mfma_f32_16x16x32_bf16 v[64:67], v[32:35], a[64:67], v[64:67]
 ds_read_b128 v[56:59], v9 offset:30720
 v_mfma_f32_16x16x32_bf16 v[64:67], v[36:39], a[68:71], v[64:67]
 ds_read_b128 v[60:63], v9 offset:31744
 v_mfma_f32_16x16x32_bf16 v[68:71], v[36:39], a[76:79], v[68:71]
 v_mfma_f32_16x16x32_bf16 v[68:71], v[32:35], a[72:75], v[68:71]
 s_waitcnt lgkmcnt(4)
 v_mfma_f32_16x16x32_bf16 v[76:79], v[40:43], a[72:75], v[76:79]
 ds_read_b128 v[32:35], v9 offset:32768
 v_mfma_f32_16x16x32_bf16 v[76:79], v[44:47], a[76:79], v[76:79]
 ds_read_b128 v[36:39], v9 offset:33792
 v_mfma_f32_16x16x32_bf16 v[72:75], v[44:47], a[68:71], v[72:75]
 v_mfma_f32_16x16x32_bf16 v[72:75], v[40:43], a[64:67], v[72:75]
 s_waitcnt lgkmcnt(4)
 v_mfma_f32_16x16x32_bf16 v[80:83], v[48:51], a[64:67], v[80:83]
 v_fmac_f32 v64, v176, v12
 v_fmac_f32 v65, v177, v12
 v_mfma_f32_16x16x32_bf16 v[80:83], v[52:55], a[68:71], v[80:83]
 ds_read_b128 v[40:43], v9 offset:34816
 v_fmac_f32 v66, v178, v12
 v_mfma_f32_16x16x32_bf16 v[84:87], v[52:55], a[76:79], v[84:87]
 ds_read_b128 v[44:47], v9 offset:35840
 v_fmac_f32 v67, v179, v12
 v_mfma_f32_16x16x32_bf16 v[84:87], v[48:51], a[72:75], v[84:87]
 s_waitcnt lgkmcnt(4)
 v_fmac_f32 v68, v176, v13
 v_fmac_f32 v69, v177, v13
 v_mfma_f32_16x16x32_bf16 v[92:95], v[56:59], a[72:75], v[92:95]
 ds_read_b128 v[48:51], v9 offset:36864
 v_fmac_f32 v70, v178, v13
 v_mfma_f32_16x16x32_bf16 v[92:95], v[60:63], a[76:79], v[92:95]
 ds_read_b128 v[52:55], v9 offset:37888
 v_fmac_f32 v71, v179, v13
 v_mfma_f32_16x16x32_bf16 v[88:91], v[60:63], a[68:71], v[88:91]
 v_fmac_f32 v72, v180, v12
 v_fmac_f32 v73, v181, v12
 v_mfma_f32_16x16x32_bf16 v[88:91], v[56:59], a[64:67], v[88:91]
 s_waitcnt lgkmcnt(4)
 v_fmac_f32 v74, v182, v12
 v_fmac_f32 v75, v183, v12
 v_mfma_f32_16x16x32_bf16 v[96:99], v[32:35], a[64:67], v[96:99]
 ds_read_b128 v[56:59], v9 offset:38912
 v_fmac_f32 v76, v180, v13
 v_mfma_f32_16x16x32_bf16 v[96:99], v[36:39], a[68:71], v[96:99]
 ds_read_b128 v[60:63], v9 offset:39936
 v_fmac_f32 v77, v181, v13
 v_mfma_f32_16x16x32_bf16 v[100:103], v[36:39], a[76:79], v[100:103]
 v_fmac_f32 v78, v182, v13
 v_mfma_f32_16x16x32_bf16 v[100:103], v[32:35], a[72:75], v[100:103]
 s_waitcnt lgkmcnt(4)
 v_fmac_f32 v79, v183, v13
 v_mfma_f32_16x16x32_bf16 v[108:111], v[40:43], a[72:75], v[108:111]
 v_fmac_f32 v80, v184, v12
 v_mfma_f32_16x16x32_bf16 v[108:111], v[44:47], a[76:79], v[108:111]
 ds_read_b128 v[32:35], v9 offset:40960
 v_fmac_f32 v81, v185, v12
 v_mfma_f32_16x16x32_bf16 v[104:107], v[44:47], a[68:71], v[104:107]
 ds_read_b128 v[36:39], v9 offset:41984
 v_fmac_f32 v82, v186, v12
 v_mfma_f32_16x16x32_bf16 v[104:107], v[40:43], a[64:67], v[104:107]
 s_waitcnt lgkmcnt(4)
 v_fmac_f32 v83, v187, v12
 v_fmac_f32 v84, v184, v13
 v_mfma_f32_16x16x32_bf16 v[112:115], v[48:51], a[64:67], v[112:115]
 ds_read_b128 v[40:43], v9 offset:43008
 v_fmac_f32 v85, v185, v13
 v_mfma_f32_16x16x32_bf16 v[112:115], v[52:55], a[68:71], v[112:115]
 v_fmac_f32 v86, v186, v13
 v_fmac_f32 v87, v187, v13
 v_mfma_f32_16x16x32_bf16 v[116:119], v[52:55], a[76:79], v[116:119]
 ds_read_b128 v[44:47], v9 offset:44032
 v_mfma_f32_16x16x32_bf16 v[116:119], v[48:51], a[72:75], v[116:119]
 s_waitcnt lgkmcnt(4)
 v_fmac_f32 v88, v188, v12
 v_fmac_f32 v89, v189, v12
 v_mfma_f32_16x16x32_bf16 v[124:127], v[56:59], a[72:75], v[124:127]
 ds_read_b128 v[48:51], v9 offset:45056
 v_fmac_f32 v90, v190, v12
 v_mfma_f32_16x16x32_bf16 v[124:127], v[60:63], a[76:79], v[124:127]
 ds_read_b128 v[52:55], v9 offset:46080
 v_fmac_f32 v91, v191, v12
 v_mfma_f32_16x16x32_bf16 v[120:123], v[60:63], a[68:71], v[120:123]
 v_fmac_f32 v92, v188, v13
 v_fmac_f32 v93, v189, v13
 v_mfma_f32_16x16x32_bf16 v[120:123], v[56:59], a[64:67], v[120:123]
 s_waitcnt lgkmcnt(4)
 v_fmac_f32 v94, v190, v13
 v_fmac_f32 v95, v191, v13
 v_mfma_f32_16x16x32_bf16 v[128:131], v[32:35], a[64:67], v[128:131]
 v_fmac_f32 v96, v192, v12
 v_fmac_f32 v97, v193, v12
 v_mfma_f32_16x16x32_bf16 v[128:131], v[36:39], a[68:71], v[128:131]
 ds_read_b128 v[56:59], v9 offset:47104
 v_fmac_f32 v98, v194, v12
 v_mfma_f32_16x16x32_bf16 v[132:135], v[36:39], a[76:79], v[132:135]
 ds_read_b128 v[60:63], v9 offset:48128
 v_fmac_f32 v99, v195, v12
 v_mfma_f32_16x16x32_bf16 v[132:135], v[32:35], a[72:75], v[132:135]
 s_waitcnt lgkmcnt(4)
 v_fmac_f32 v100, v192, v13
 s_waitcnt vmcnt(16)
 s_barrier
 v_mfma_f32_16x16x32_bf16 v[140:143], v[40:43], a[72:75], v[140:143]
 ds_read_b128 v[32:35], v10 offset:0
 v_fmac_f32 v101, v193, v13
 v_mfma_f32_16x16x32_bf16 v[140:143], v[44:47], a[76:79], v[140:143]
 v_fmac_f32 v102, v194, v13
 v_fmac_f32 v103, v195, v13
 v_mfma_f32_16x16x32_bf16 v[136:139], v[44:47], a[68:71], v[136:139]
 ds_read_b128 v[36:39], v10 offset:1024
 v_mfma_f32_16x16x32_bf16 v[136:139], v[40:43], a[64:67], v[136:139]
 s_waitcnt lgkmcnt(4)
 v_fmac_f32 v104, v196, v12
 v_fmac_f32 v105, v197, v12
 v_mfma_f32_16x16x32_bf16 v[144:147], v[48:51], a[64:67], v[144:147]
 ds_read_b128 v[40:43], v10 offset:2048
 v_fmac_f32 v106, v198, v12
 v_mfma_f32_16x16x32_bf16 v[144:147], v[52:55], a[68:71], v[144:147]
 ds_read_b128 v[44:47], v10 offset:3072
 v_fmac_f32 v107, v199, v12
 v_mfma_f32_16x16x32_bf16 v[148:151], v[52:55], a[76:79], v[148:151]
 v_fmac_f32 v108, v196, v13
 v_fmac_f32 v109, v197, v13
 v_mfma_f32_16x16x32_bf16 v[148:151], v[48:51], a[72:75], v[148:151]
 s_waitcnt lgkmcnt(4)
 v_fmac_f32 v110, v198, v13
 v_fmac_f32 v111, v199, v13
 v_mfma_f32_16x16x32_bf16 v[156:159], v[56:59], a[72:75], v[156:159]
 ds_read_b128 v[48:51], v10 offset:4096
 v_mfma_f32_16x16x32_bf16 v[156:159], v[60:63], a[76:79], v[156:159]
 ds_read_b128 v[52:55], v10 offset:5120
 v_mfma_f32_16x16x32_bf16 v[152:155], v[60:63], a[68:71], v[152:155]
 v_mfma_f32_16x16x32_bf16 v[152:155], v[56:59], a[64:67], v[152:155]
 s_waitcnt lgkmcnt(4)
 v_mfma_f32_16x16x32_bf16 v[64:67], v[32:35], a[80:83], v[64:67]
 v_fmac_f32 v112, v200, v12
 v_fmac_f32 v113, v201, v12
 v_fmac_f32 v114, v202, v12
 v_mfma_f32_16x16x32_bf16 v[64:67], v[36:39], a[84:87], v[64:67]
 ds_read_b128 v[56:59], v10 offset:6144
 v_fmac_f32 v115, v203, v12
 v_fmac_f32 v116, v200, v13
 v_mfma_f32_16x16x32_bf16 v[68:71], v[36:39], a[92:95], v[68:71]
 ds_read_b128 v[60:63], v10 offset:7168
 v_fmac_f32 v117, v201, v13
 v_mfma_f32_16x16x32_bf16 v[68:71], v[32:35], a[88:91], v[68:71]
 s_waitcnt lgkmcnt(4)
 v_fmac_f32 v118, v202, v13
 v_fmac_f32 v119, v203, v13
 v_mfma_f32_16x16x32_bf16 v[76:79], v[40:43], a[88:91], v[76:79]
 v_fmac_f32 v120, v204, v12
 v_fmac_f32 v121, v205, v12
 v_mfma_f32_16x16x32_bf16 v[76:79], v[44:47], a[92:95], v[76:79]
 ds_read_b128 v[32:35], v10 offset:8192
 v_fmac_f32 v122, v206, v12
 v_mfma_f32_16x16x32_bf16 v[72:75], v[44:47], a[84:87], v[72:75]
 ds_read_b128 v[36:39], v10 offset:9216
 v_fmac_f32 v123, v207, v12
 v_mfma_f32_16x16x32_bf16 v[72:75], v[40:43], a[80:83], v[72:75]
 s_waitcnt lgkmcnt(4)
 v_fmac_f32 v124, v204, v13
 v_fmac_f32 v125, v205, v13
 v_fmac_f32 v126, v206, v13
 v_fmac_f32 v127, v207, v13
 v_mfma_f32_16x16x32_bf16 v[80:83], v[48:51], a[80:83], v[80:83]
 v_fmac_f32 v128, v208, v12
 v_fmac_f32 v129, v209, v12
 v_mfma_f32_16x16x32_bf16 v[80:83], v[52:55], a[84:87], v[80:83]
 ds_read_b128 v[40:43], v10 offset:10240
 v_fmac_f32 v130, v210, v12
 v_mfma_f32_16x16x32_bf16 v[84:87], v[52:55], a[92:95], v[84:87]
 ds_read_b128 v[44:47], v10 offset:11264
 v_fmac_f32 v131, v211, v12
 v_fmac_f32 v132, v208, v13
 v_mfma_f32_16x16x32_bf16 v[84:87], v[48:51], a[88:91], v[84:87]
 s_waitcnt lgkmcnt(4)
 v_fmac_f32 v133, v209, v13
 v_fmac_f32 v134, v210, v13
 v_fmac_f32 v135, v211, v13
 v_mfma_f32_16x16x32_bf16 v[92:95], v[56:59], a[88:91], v[92:95]
 v_fmac_f32 v136, v212, v12
 v_fmac_f32 v137, v213, v12
 v_fmac_f32 v138, v214, v12
 v_mfma_f32_16x16x32_bf16 v[92:95], v[60:63], a[92:95], v[92:95]
 ds_read_b128 v[48:51], v10 offset:12288
 v_fmac_f32 v139, v215, v12
 v_mfma_f32_16x16x32_bf16 v[88:91], v[60:63], a[84:87], v[88:91]
 ds_read_b128 v[52:55], v10 offset:13312
 v_fmac_f32 v140, v212, v13
 v_mfma_f32_16x16x32_bf16 v[88:91], v[56:59], a[80:83], v[88:91]
 s_waitcnt lgkmcnt(4)
 v_fmac_f32 v141, v213, v13
 v_fmac_f32 v142, v214, v13
 v_fmac_f32 v143, v215, v13
 v_mfma_f32_16x16x32_bf16 v[96:99], v[32:35], a[80:83], v[96:99]
 v_fmac_f32 v144, v216, v12
 v_fmac_f32 v145, v217, v12
 v_fmac_f32 v146, v218, v12
 v_mfma_f32_16x16x32_bf16 v[96:99], v[36:39], a[84:87], v[96:99]
 ds_read_b128 v[56:59], v10 offset:14336
 v_fmac_f32 v147, v219, v12
 v_mfma_f32_16x16x32_bf16 v[100:103], v[36:39], a[92:95], v[100:103]
 ds_read_b128 v[60:63], v10 offset:15360
 v_fmac_f32 v148, v216, v13
 v_mfma_f32_16x16x32_bf16 v[100:103], v[32:35], a[88:91], v[100:103]
 s_waitcnt lgkmcnt(4)
 v_fmac_f32 v149, v217, v13
 v_fmac_f32 v150, v218, v13
 v_fmac_f32 v151, v219, v13
 v_mfma_f32_16x16x32_bf16 v[108:111], v[40:43], a[88:91], v[108:111]
 v_fmac_f32 v152, v220, v12
 v_fmac_f32 v153, v221, v12
 v_fmac_f32 v154, v222, v12
 v_mfma_f32_16x16x32_bf16 v[108:111], v[44:47], a[92:95], v[108:111]
 ds_read_b128 v[32:35], v10 offset:16384
 v_fmac_f32 v155, v223, v12
 v_mfma_f32_16x16x32_bf16 v[104:107], v[44:47], a[84:87], v[104:107]
 ds_read_b128 v[36:39], v10 offset:17408
 v_fmac_f32 v156, v220, v13
 v_mfma_f32_16x16x32_bf16 v[104:107], v[40:43], a[80:83], v[104:107]
 s_waitcnt lgkmcnt(4)
 v_fmac_f32 v157, v221, v13
 v_fmac_f32 v158, v222, v13
 v_fmac_f32 v159, v223, v13
 v_mfma_f32_16x16x32_bf16 v[112:115], v[48:51], a[80:83], v[112:115]
 ds_read_b128 v[40:43], v10 offset:18432
 v_mfma_f32_16x16x32_bf16 v[112:115], v[52:55], a[84:87], v[112:115]
 ds_read_b128 v[44:47], v10 offset:19456
 v_mfma_f32_16x16x32_bf16 v[116:119], v[52:55], a[92:95], v[116:119]
 v_mfma_f32_16x16x32_bf16 v[116:119], v[48:51], a[88:91], v[116:119]
 s_waitcnt lgkmcnt(4)
 v_mfma_f32_16x16x32_bf16 v[124:127], v[56:59], a[88:91], v[124:127]
 ds_read_b128 v[48:51], v10 offset:20480
 v_mfma_f32_16x16x32_bf16 v[124:127], v[60:63], a[92:95], v[124:127]
 ds_read_b128 v[52:55], v10 offset:21504
 v_mfma_f32_16x16x32_bf16 v[120:123], v[60:63], a[84:87], v[120:123]
 v_mfma_f32_16x16x32_bf16 v[120:123], v[56:59], a[80:83], v[120:123]
 s_waitcnt lgkmcnt(4)
 v_mfma_f32_16x16x32_bf16 v[128:131], v[32:35], a[80:83], v[128:131]
 ds_read_b128 v[56:59], v10 offset:22528
 v_mfma_f32_16x16x32_bf16 v[128:131], v[36:39], a[84:87], v[128:131]
 ds_read_b128 v[60:63], v10 offset:23552
 v_mfma_f32_16x16x32_bf16 v[132:135], v[36:39], a[92:95], v[132:135]
 v_mfma_f32_16x16x32_bf16 v[132:135], v[32:35], a[88:91], v[132:135]
 s_waitcnt lgkmcnt(4)
 s_waitcnt vmcnt(0)
 s_barrier
 v_mfma_f32_16x16x32_bf16 v[140:143], v[40:43], a[88:91], v[140:143]
 ds_read_b128 v[32:35], v10 offset:24576
 v_mfma_f32_16x16x32_bf16 v[140:143], v[44:47], a[92:95], v[140:143]
 ds_read_b128 v[36:39], v10 offset:25600
 v_mfma_f32_16x16x32_bf16 v[136:139], v[44:47], a[84:87], v[136:139]
 v_mfma_f32_16x16x32_bf16 v[136:139], v[40:43], a[80:83], v[136:139]
 s_waitcnt lgkmcnt(4)
 v_mfma_f32_16x16x32_bf16 v[144:147], v[48:51], a[80:83], v[144:147]
 ds_read_b128 v[40:43], v11 offset:0
 v_mfma_f32_16x16x32_bf16 v[144:147], v[52:55], a[84:87], v[144:147]
 ds_read_b128 v[44:47], v11 offset:1024
 v_mfma_f32_16x16x32_bf16 v[148:151], v[52:55], a[92:95], v[148:151]
 v_mfma_f32_16x16x32_bf16 v[148:151], v[48:51], a[88:91], v[148:151]
 s_waitcnt lgkmcnt(4)
 v_mfma_f32_16x16x32_bf16 v[156:159], v[56:59], a[88:91], v[156:159]
 v_mfma_f32_16x16x32_bf16 v[156:159], v[60:63], a[92:95], v[156:159]
 v_mfma_f32_16x16x32_bf16 v[152:155], v[60:63], a[84:87], v[152:155]
 v_mfma_f32_16x16x32_bf16 v[152:155], v[56:59], a[80:83], v[152:155]
 s_mov_b32 s5, 44032
 s_waitcnt lgkmcnt(2)
 v_mfma_f32_16x16x32_bf16 v[64:67], v[32:35], a[96:99], v[64:67]
 ds_read_b128 v[48:51], v10 offset:26624
 v_mfma_f32_16x16x32_bf16 v[64:67], v[36:39], a[100:103], v[64:67]
 s_waitcnt lgkmcnt(1)
 ds_read_b128 v[52:55], v10 offset:27648
 v_mfma_f32_16x16x32_bf16 v[64:67], v[40:43], a[112:115], v[64:67]
 s_add_u32 s44, s42, 0
 ds_read_b128 v[56:59], v11 offset:2048
 v_mfma_f32_16x16x32_bf16 v[64:67], v[44:47], a[116:119], v[64:67]
 buffer_load_dwordx4 a[128:131], v24, s[32:35], s44 offen offset:0 sc1
 v_mfma_f32_16x16x32_bf16 v[68:71], v[44:47], a[124:127], v[68:71]
 ds_read_b128 v[60:63], v11 offset:3072
 v_mfma_f32_16x16x32_bf16 v[68:71], v[40:43], a[120:123], v[68:71]
 buffer_load_dwordx4 a[132:135], v25, s[32:35], s44 offen offset:0 sc1
 v_mfma_f32_16x16x32_bf16 v[68:71], v[36:39], a[108:111], v[68:71]
 buffer_load_dwordx4 a[136:139], v26, s[32:35], s44 offen offset:0 sc1
 v_mfma_f32_16x16x32_bf16 v[68:71], v[32:35], a[104:107], v[68:71]
 s_waitcnt lgkmcnt(2)
 v_mfma_f32_16x16x32_bf16 v[76:79], v[48:51], a[104:107], v[76:79]
 ds_read_b128 v[32:35], v10 offset:28672
 v_mfma_f32_16x16x32_bf16 v[76:79], v[52:55], a[108:111], v[76:79]
 s_waitcnt lgkmcnt(1)
 ds_read_b128 v[36:39], v10 offset:29696
 v_mfma_f32_16x16x32_bf16 v[76:79], v[56:59], a[120:123], v[76:79]
 buffer_load_dwordx4 a[140:143], v27, s[32:35], s44 offen offset:0 sc1
 v_mfma_f32_16x16x32_bf16 v[76:79], v[60:63], a[124:127], v[76:79]
 ds_read_b128 v[40:43], v11 offset:4096
 v_mfma_f32_16x16x32_bf16 v[72:75], v[60:63], a[116:119], v[72:75]
 ds_read_b128 v[44:47], v11 offset:5120
 v_mfma_f32_16x16x32_bf16 v[72:75], v[56:59], a[112:115], v[72:75]
 buffer_load_dwordx4 a[144:147], v24, s[32:35], s44 offen offset:1024 sc1
 v_mfma_f32_16x16x32_bf16 v[72:75], v[52:55], a[100:103], v[72:75]
 v_mfma_f32_16x16x32_bf16 v[72:75], v[48:51], a[96:99], v[72:75]
 s_waitcnt lgkmcnt(2)
 v_mfma_f32_16x16x32_bf16 v[80:83], v[32:35], a[96:99], v[80:83]
 buffer_load_dwordx4 a[148:151], v25, s[32:35], s44 offen offset:1024 sc1
 v_mfma_f32_16x16x32_bf16 v[80:83], v[36:39], a[100:103], v[80:83]
 s_waitcnt lgkmcnt(0)
 ds_read_b128 v[48:51], v10 offset:30720
 v_mfma_f32_16x16x32_bf16 v[80:83], v[40:43], a[112:115], v[80:83]
 ds_read_b128 v[52:55], v10 offset:31744
 v_mfma_f32_16x16x32_bf16 v[80:83], v[44:47], a[116:119], v[80:83]
 ds_read_b128 v[56:59], v11 offset:6144
 v_mfma_f32_16x16x32_bf16 v[84:87], v[44:47], a[124:127], v[84:87]
 ds_read_b128 v[60:63], v11 offset:7168
 v_mfma_f32_16x16x32_bf16 v[84:87], v[40:43], a[120:123], v[84:87]
 buffer_load_dwordx4 a[152:155], v26, s[32:35], s44 offen offset:1024 sc1
 v_mfma_f32_16x16x32_bf16 v[84:87], v[36:39], a[108:111], v[84:87]
 buffer_load_dwordx4 a[156:159], v27, s[32:35], s44 offen offset:1024 sc1
 v_mfma_f32_16x16x32_bf16 v[84:87], v[32:35], a[104:107], v[84:87]
 s_waitcnt lgkmcnt(2)
 v_mfma_f32_16x16x32_bf16 v[92:95], v[48:51], a[104:107], v[92:95]
 ds_read_b128 v[32:35], v10 offset:32768
 v_mfma_f32_16x16x32_bf16 v[92:95], v[52:55], a[108:111], v[92:95]
 s_waitcnt lgkmcnt(1)
 ds_read_b128 v[36:39], v10 offset:33792
 v_mfma_f32_16x16x32_bf16 v[92:95], v[56:59], a[120:123], v[92:95]
 ds_read_b128 v[40:43], v11 offset:8192
 v_mfma_f32_16x16x32_bf16 v[92:95], v[60:63], a[124:127], v[92:95]
 ds_read_b128 v[44:47], v11 offset:9216
 v_mfma_f32_16x16x32_bf16 v[88:91], v[60:63], a[116:119], v[88:91]
 v_mfma_f32_16x16x32_bf16 v[88:91], v[56:59], a[112:115], v[88:91]
 v_mfma_f32_16x16x32_bf16 v[88:91], v[52:55], a[100:103], v[88:91]
 v_mfma_f32_16x16x32_bf16 v[88:91], v[48:51], a[96:99], v[88:91]
 s_waitcnt lgkmcnt(2)
 v_mfma_f32_16x16x32_bf16 v[96:99], v[32:35], a[96:99], v[96:99]
 ds_read_b128 v[48:51], v10 offset:34816
 v_mfma_f32_16x16x32_bf16 v[96:99], v[36:39], a[100:103], v[96:99]
 s_waitcnt lgkmcnt(1)
 ds_read_b128 v[52:55], v10 offset:35840
 v_mfma_f32_16x16x32_bf16 v[96:99], v[40:43], a[112:115], v[96:99]
 s_add_u32 s44, s42, 0
 ds_read_b128 v[56:59], v11 offset:10240
 v_mfma_f32_16x16x32_bf16 v[96:99], v[44:47], a[116:119], v[96:99]
 buffer_load_dwordx4 a[160:163], v24, s[32:35], s44 offen offset:2048 sc1
 v_mfma_f32_16x16x32_bf16 v[100:103], v[44:47], a[124:127], v[100:103]
 ds_read_b128 v[60:63], v11 offset:11264
 v_mul_f32 v160, v64, v18
 v_mfma_f32_16x16x32_bf16 v[100:103], v[40:43], a[120:123], v[100:103]
 buffer_load_dwordx4 a[164:167], v25, s[32:35], s44 offen offset:2048 sc1
 v_mfma_f32_16x16x32_bf16 v[100:103], v[36:39], a[108:111], v[100:103]
 buffer_load_dwordx4 a[168:171], v26, s[32:35], s44 offen offset:2048 sc1
 v_mfma_f32_16x16x32_bf16 v[100:103], v[32:35], a[104:107], v[100:103]
 s_waitcnt lgkmcnt(2)
 v_mul_f32 v161, v65, v18
 v_mul_f32 v162, v66, v18
 v_mfma_f32_16x16x32_bf16 v[108:111], v[48:51], a[104:107], v[108:111]
 ds_read_b128 v[32:35], v10 offset:36864
 v_mul_f32 v163, v67, v18
 v_mfma_f32_16x16x32_bf16 v[108:111], v[52:55], a[108:111], v[108:111]
 s_waitcnt lgkmcnt(1)
 v_mul_f32 v164, v80, v18
 v_mul_f32 v165, v81, v18
 v_mfma_f32_16x16x32_bf16 v[108:111], v[56:59], a[120:123], v[108:111]
 ds_read_b128 v[36:39], v10 offset:37888
 v_mul_f32 v166, v82, v18
 v_mfma_f32_16x16x32_bf16 v[108:111], v[60:63], a[124:127], v[108:111]
 ds_read_b128 v[40:43], v11 offset:12288
 v_mul_f32 v167, v83, v18
 v_mfma_f32_16x16x32_bf16 v[104:107], v[60:63], a[116:119], v[104:107]
 ds_read_b128 v[44:47], v11 offset:13312
 v_exp_f32 v160, v160
 v_mfma_f32_16x16x32_bf16 v[104:107], v[56:59], a[112:115], v[104:107]
 buffer_load_dwordx4 a[172:175], v27, s[32:35], s44 offen offset:2048 sc1
 v_mfma_f32_16x16x32_bf16 v[104:107], v[52:55], a[100:103], v[104:107]
 buffer_load_dwordx4 a[176:179], v24, s[32:35], s44 offen offset:3072 sc1
 v_mfma_f32_16x16x32_bf16 v[104:107], v[48:51], a[96:99], v[104:107]
 s_waitcnt lgkmcnt(2)
 v_mul_f32 v64, v64, v72
 v_exp_f32 v161, v161
 v_mfma_f32_16x16x32_bf16 v[112:115], v[32:35], a[96:99], v[112:115]
 ds_read_b128 v[48:51], v10 offset:38912
 v_mul_f32 v65, v65, v73
 v_mfma_f32_16x16x32_bf16 v[112:115], v[36:39], a[100:103], v[112:115]
 s_waitcnt lgkmcnt(1)
 v_exp_f32 v162, v162
 v_mfma_f32_16x16x32_bf16 v[112:115], v[40:43], a[112:115], v[112:115]
 buffer_load_dwordx4 a[180:183], v25, s[32:35], s44 offen offset:3072 sc1
 v_mfma_f32_16x16x32_bf16 v[112:115], v[44:47], a[116:119], v[112:115]
 ds_read_b128 v[52:55], v10 offset:39936
 v_mul_f32 v66, v66, v74
 v_mfma_f32_16x16x32_bf16 v[116:119], v[44:47], a[124:127], v[116:119]
 ds_read_b128 v[56:59], v11 offset:14336
 ds_read_b128 v[60:63], v11 offset:15360
 v_mfma_f32_16x16x32_bf16 v[116:119], v[40:43], a[120:123], v[116:119]
 buffer_load_dwordx4 a[184:187], v26, s[32:35], s44 offen offset:3072 sc1
 v_mfma_f32_16x16x32_bf16 v[116:119], v[36:39], a[108:111], v[116:119]
 buffer_load_dwordx4 a[188:191], v27, s[32:35], s44 offen offset:3072 sc1
 v_mfma_f32_16x16x32_bf16 v[116:119], v[32:35], a[104:107], v[116:119]
 s_waitcnt lgkmcnt(2)
 v_exp_f32 v163, v163
 v_mfma_f32_16x16x32_bf16 v[124:127], v[48:51], a[104:107], v[124:127]
 ds_read_b128 v[32:35], v10 offset:40960
 v_mul_f32 v67, v67, v75
 v_mfma_f32_16x16x32_bf16 v[124:127], v[52:55], a[108:111], v[124:127]
 s_waitcnt lgkmcnt(1)
 v_exp_f32 v164, v164
 v_mfma_f32_16x16x32_bf16 v[124:127], v[56:59], a[120:123], v[124:127]
 ds_read_b128 v[36:39], v10 offset:41984
 v_mul_f32 v80, v80, v88
 v_mfma_f32_16x16x32_bf16 v[124:127], v[60:63], a[124:127], v[124:127]
 ds_read_b128 v[40:43], v11 offset:16384
 v_exp_f32 v165, v165
 v_mfma_f32_16x16x32_bf16 v[120:123], v[60:63], a[116:119], v[120:123]
 ds_read_b128 v[44:47], v11 offset:17408
 v_mul_f32 v81, v81, v89
 v_mfma_f32_16x16x32_bf16 v[120:123], v[56:59], a[112:115], v[120:123]
 v_exp_f32 v166, v166
 v_mfma_f32_16x16x32_bf16 v[120:123], v[52:55], a[100:103], v[120:123]
 v_mul_f32 v82, v82, v90
 v_exp_f32 v167, v167
 v_mfma_f32_16x16x32_bf16 v[120:123], v[48:51], a[96:99], v[120:123]
 v_mul_f32 v83, v83, v91
 v_fma_f32 v160, v160, v16, v16
 v_fma_f32 v161, v161, v16, v16
 v_fma_f32 v162, v162, v16, v16
 v_fma_f32 v163, v163, v16, v16
 v_fma_f32 v164, v164, v16, v16
 v_fma_f32 v165, v165, v16, v16
 v_fma_f32 v166, v166, v16, v16
 v_fma_f32 v167, v167, v16, v16
 v_rcp_f32 v160, v160
 v_rcp_f32 v161, v161
 v_rcp_f32 v162, v162
 v_rcp_f32 v163, v163
 v_rcp_f32 v164, v164
 v_rcp_f32 v165, v165
 v_rcp_f32 v166, v166
 v_rcp_f32 v167, v167
 v_mul_f32 v64, v64, v160
 v_mul_f32 v65, v65, v161
 v_mul_f32 v66, v66, v162
 v_mul_f32 v67, v67, v163
 v_mul_f32 v80, v80, v164
 v_mul_f32 v81, v81, v165
 v_mul_f32 v82, v82, v166
 v_mul_f32 v83, v83, v167
 v_cvt_pk_bf16_f32 v168, v64, v65
 v_cvt_pk_bf16_f32 v169, v66, v67
 v_cvt_pk_bf16_f32 v170, v80, v81
 v_cvt_pk_bf16_f32 v171, v82, v83
 buffer_store_dwordx4 v[168:171], v2, s[24:27], 0 offen offset:0 sc1
 v_mul_f32 v176, v68, v19
 v_mul_f32 v177, v69, v19
 v_mul_f32 v178, v70, v19
 v_mul_f32 v179, v71, v19
 v_mul_f32 v180, v84, v19
 v_mul_f32 v181, v85, v19
 v_mul_f32 v182, v86, v19
 v_mul_f32 v183, v87, v19
 v_exp_f32 v176, v176
 v_mul_f32 v68, v68, v76
 v_exp_f32 v177, v177
 v_mul_f32 v69, v69, v77
 v_exp_f32 v178, v178
 v_mul_f32 v70, v70, v78
 v_exp_f32 v179, v179
 v_mul_f32 v71, v71, v79
 v_exp_f32 v180, v180
 v_mul_f32 v84, v84, v92
 v_exp_f32 v181, v181
 v_mul_f32 v85, v85, v93
 v_exp_f32 v182, v182
 v_mul_f32 v86, v86, v94
 v_exp_f32 v183, v183
 v_mul_f32 v87, v87, v95
 v_fma_f32 v176, v176, v17, v17
 v_fma_f32 v177, v177, v17, v17
 v_fma_f32 v178, v178, v17, v17
 v_fma_f32 v179, v179, v17, v17
 v_fma_f32 v180, v180, v17, v17
 v_fma_f32 v181, v181, v17, v17
 v_fma_f32 v182, v182, v17, v17
 v_fma_f32 v183, v183, v17, v17
 v_rcp_f32 v176, v176
 v_rcp_f32 v177, v177
 v_rcp_f32 v178, v178
 v_rcp_f32 v179, v179
 v_rcp_f32 v180, v180
 v_rcp_f32 v181, v181
 v_rcp_f32 v182, v182
 v_rcp_f32 v183, v183
 v_mul_f32 v68, v68, v176
 v_mul_f32 v69, v69, v177
 v_mul_f32 v70, v70, v178
 v_mul_f32 v71, v71, v179
 v_mul_f32 v84, v84, v180
 v_mul_f32 v85, v85, v181
 v_mul_f32 v86, v86, v182
 v_mul_f32 v87, v87, v183
 v_cvt_pk_bf16_f32 v184, v68, v69
 v_cvt_pk_bf16_f32 v185, v70, v71
 v_cvt_pk_bf16_f32 v186, v84, v85
 v_cvt_pk_bf16_f32 v187, v86, v87
 buffer_store_dwordx4 v[184:187], v2, s[24:27], s5 offen offset:0 sc1
 s_waitcnt lgkmcnt(2)
 v_mfma_f32_16x16x32_bf16 v[128:131], v[32:35], a[96:99], v[128:131]
 ds_read_b128 v[48:51], v10 offset:43008
 v_mfma_f32_16x16x32_bf16 v[128:131], v[36:39], a[100:103], v[128:131]
 s_waitcnt lgkmcnt(1)
 ds_read_b128 v[52:55], v10 offset:44032
 v_mfma_f32_16x16x32_bf16 v[128:131], v[40:43], a[112:115], v[128:131]
 ds_read_b128 v[56:59], v11 offset:18432
 v_mfma_f32_16x16x32_bf16 v[128:131], v[44:47], a[116:119], v[128:131]
 ds_read_b128 v[60:63], v11 offset:19456
 v_mfma_f32_16x16x32_bf16 v[132:135], v[44:47], a[124:127], v[132:135]
 v_mul_f32 v160, v96, v18
 v_mul_f32 v161, v97, v18
 v_mfma_f32_16x16x32_bf16 v[132:135], v[40:43], a[120:123], v[132:135]
 v_mul_f32 v162, v98, v18
 v_mul_f32 v163, v99, v18
 v_mfma_f32_16x16x32_bf16 v[132:135], v[36:39], a[108:111], v[132:135]
 v_mul_f32 v164, v112, v18
 v_mul_f32 v165, v113, v18
 v_mul_f32 v166, v114, v18
 v_mfma_f32_16x16x32_bf16 v[132:135], v[32:35], a[104:107], v[132:135]
 s_waitcnt lgkmcnt(2)
 v_mul_f32 v167, v115, v18
 v_exp_f32 v160, v160
 v_mfma_f32_16x16x32_bf16 v[140:143], v[48:51], a[104:107], v[140:143]
 ds_read_b128 v[32:35], v10 offset:45056
 v_mul_f32 v96, v96, v104
 v_exp_f32 v161, v161
 v_mfma_f32_16x16x32_bf16 v[140:143], v[52:55], a[108:111], v[140:143]
 s_waitcnt lgkmcnt(1)
 v_mul_f32 v97, v97, v105
 v_exp_f32 v162, v162
 v_mfma_f32_16x16x32_bf16 v[140:143], v[56:59], a[120:123], v[140:143]
 ds_read_b128 v[36:39], v10 offset:46080
 v_mul_f32 v98, v98, v106
 v_mfma_f32_16x16x32_bf16 v[140:143], v[60:63], a[124:127], v[140:143]
 ds_read_b128 v[40:43], v11 offset:20480
 v_exp_f32 v163, v163
 v_mfma_f32_16x16x32_bf16 v[136:139], v[60:63], a[116:119], v[136:139]
 ds_read_b128 v[44:47], v11 offset:21504
 v_mul_f32 v99, v99, v107
 v_mfma_f32_16x16x32_bf16 v[136:139], v[56:59], a[112:115], v[136:139]
 v_exp_f32 v164, v164
 v_mfma_f32_16x16x32_bf16 v[136:139], v[52:55], a[100:103], v[136:139]
 v_mul_f32 v112, v112, v120
 v_exp_f32 v165, v165
 v_mfma_f32_16x16x32_bf16 v[136:139], v[48:51], a[96:99], v[136:139]
 s_waitcnt lgkmcnt(2)
 v_mul_f32 v113, v113, v121
 v_exp_f32 v166, v166
 v_mfma_f32_16x16x32_bf16 v[144:147], v[32:35], a[96:99], v[144:147]
 ds_read_b128 v[48:51], v10 offset:47104
 v_mul_f32 v114, v114, v122
 v_mfma_f32_16x16x32_bf16 v[144:147], v[36:39], a[100:103], v[144:147]
 s_waitcnt lgkmcnt(1)
 v_exp_f32 v167, v167
 v_mul_f32 v115, v115, v123
 v_mfma_f32_16x16x32_bf16 v[144:147], v[40:43], a[112:115], v[144:147]
 ds_read_b128 v[52:55], v10 offset:48128
 v_fma_f32 v160, v160, v16, v16
 v_mfma_f32_16x16x32_bf16 v[144:147], v[44:47], a[116:119], v[144:147]
 ds_read_b128 v[56:59], v11 offset:22528
 v_fma_f32 v161, v161, v16, v16
 v_fma_f32 v162, v162, v16, v16
 v_mfma_f32_16x16x32_bf16 v[148:151], v[44:47], a[124:127], v[148:151]
 ds_read_b128 v[60:63], v11 offset:23552
 v_fma_f32 v163, v163, v16, v16
 v_fma_f32 v164, v164, v16, v16
 v_mfma_f32_16x16x32_bf16 v[148:151], v[40:43], a[120:123], v[148:151]
 v_fma_f32 v165, v165, v16, v16
 v_fma_f32 v166, v166, v16, v16
 v_fma_f32 v167, v167, v16, v16
 v_mfma_f32_16x16x32_bf16 v[148:151], v[36:39], a[108:111], v[148:151]
 v_rcp_f32 v160, v160
 v_rcp_f32 v161, v161
 v_mfma_f32_16x16x32_bf16 v[148:151], v[32:35], a[104:107], v[148:151]
 s_waitcnt lgkmcnt(2)
 v_rcp_f32 v162, v162
 v_rcp_f32 v163, v163
 v_mfma_f32_16x16x32_bf16 v[156:159], v[48:51], a[104:107], v[156:159]
 v_rcp_f32 v164, v164
 v_rcp_f32 v165, v165
 v_mfma_f32_16x16x32_bf16 v[156:159], v[52:55], a[108:111], v[156:159]
 s_waitcnt lgkmcnt(0)
 v_rcp_f32 v166, v166
 v_rcp_f32 v167, v167
 v_mfma_f32_16x16x32_bf16 v[156:159], v[56:59], a[120:123], v[156:159]
 v_mul_f32 v96, v96, v160
 v_mul_f32 v97, v97, v161
 v_mfma_f32_16x16x32_bf16 v[156:159], v[60:63], a[124:127], v[156:159]
 v_mul_f32 v98, v98, v162
 v_mul_f32 v99, v99, v163
 v_mfma_f32_16x16x32_bf16 v[152:155], v[60:63], a[116:119], v[152:155]
 v_mul_f32 v112, v112, v164
 v_mul_f32 v113, v113, v165
 v_mfma_f32_16x16x32_bf16 v[152:155], v[56:59], a[112:115], v[152:155]
 v_mul_f32 v114, v114, v166
 v_mul_f32 v115, v115, v167
 v_cvt_pk_bf16_f32 v168, v96, v97
 v_mfma_f32_16x16x32_bf16 v[152:155], v[52:55], a[100:103], v[152:155]
 v_cvt_pk_bf16_f32 v169, v98, v99
 v_cvt_pk_bf16_f32 v170, v112, v113
 v_cvt_pk_bf16_f32 v171, v114, v115
 v_mfma_f32_16x16x32_bf16 v[152:155], v[48:51], a[96:99], v[152:155]
 buffer_store_dwordx4 v[168:171], v2, s[24:27], 0 offen offset:1024 sc1
 v_mul_f32 v176, v100, v19
 v_mul_f32 v177, v101, v19
 v_mul_f32 v178, v102, v19
 v_mul_f32 v179, v103, v19
 v_mul_f32 v180, v116, v19
 v_mul_f32 v181, v117, v19
 v_mul_f32 v182, v118, v19
 v_mul_f32 v183, v119, v19
 v_exp_f32 v176, v176
 v_mul_f32 v100, v100, v108
 v_exp_f32 v177, v177
 v_mul_f32 v101, v101, v109
 v_exp_f32 v178, v178
 v_mul_f32 v102, v102, v110
 v_exp_f32 v179, v179
 v_mul_f32 v103, v103, v111
 v_exp_f32 v180, v180
 v_mul_f32 v116, v116, v124
 v_exp_f32 v181, v181
 v_mul_f32 v117, v117, v125
 v_exp_f32 v182, v182
 v_mul_f32 v118, v118, v126
 v_exp_f32 v183, v183
 v_mul_f32 v119, v119, v127
 v_fma_f32 v176, v176, v17, v17
 v_fma_f32 v177, v177, v17, v17
 v_fma_f32 v178, v178, v17, v17
 v_fma_f32 v179, v179, v17, v17
 v_fma_f32 v180, v180, v17, v17
 v_fma_f32 v181, v181, v17, v17
 v_fma_f32 v182, v182, v17, v17
 v_fma_f32 v183, v183, v17, v17
 v_rcp_f32 v176, v176
 v_rcp_f32 v177, v177
 v_rcp_f32 v178, v178
 v_rcp_f32 v179, v179
 v_rcp_f32 v180, v180
 v_rcp_f32 v181, v181
 v_rcp_f32 v182, v182
 v_rcp_f32 v183, v183
 v_mul_f32 v100, v100, v176
 v_mul_f32 v101, v101, v177
 v_mul_f32 v102, v102, v178
 v_mul_f32 v103, v103, v179
 v_mul_f32 v116, v116, v180
 v_mul_f32 v117, v117, v181
 v_mul_f32 v118, v118, v182
 v_mul_f32 v119, v119, v183
 v_cvt_pk_bf16_f32 v184, v100, v101
 v_cvt_pk_bf16_f32 v185, v102, v103
 v_cvt_pk_bf16_f32 v186, v116, v117
 v_cvt_pk_bf16_f32 v187, v118, v119
 buffer_store_dwordx4 v[184:187], v2, s[24:27], s5 offen offset:1024 sc1
 v_mul_f32 v160, v128, v18
 v_mul_f32 v161, v129, v18
 v_mul_f32 v162, v130, v18
 v_mul_f32 v163, v131, v18
 v_mul_f32 v164, v144, v18
 v_mul_f32 v165, v145, v18
 v_mul_f32 v166, v146, v18
 v_mul_f32 v167, v147, v18
 v_exp_f32 v160, v160
 v_mul_f32 v128, v128, v136
 v_exp_f32 v161, v161
 v_mul_f32 v129, v129, v137
 v_exp_f32 v162, v162
 v_mul_f32 v130, v130, v138
 v_exp_f32 v163, v163
 v_mul_f32 v131, v131, v139
 v_exp_f32 v164, v164
 v_mul_f32 v144, v144, v152
 v_exp_f32 v165, v165
 v_mul_f32 v145, v145, v153
 v_exp_f32 v166, v166
 v_mul_f32 v146, v146, v154
 v_exp_f32 v167, v167
 v_mul_f32 v147, v147, v155
 v_fma_f32 v160, v160, v16, v16
 v_fma_f32 v161, v161, v16, v16
 v_fma_f32 v162, v162, v16, v16
 v_fma_f32 v163, v163, v16, v16
 v_fma_f32 v164, v164, v16, v16
 v_fma_f32 v165, v165, v16, v16
 v_fma_f32 v166, v166, v16, v16
 v_fma_f32 v167, v167, v16, v16
 v_rcp_f32 v160, v160
 v_rcp_f32 v161, v161
 v_rcp_f32 v162, v162
 v_rcp_f32 v163, v163
 v_rcp_f32 v164, v164
 v_rcp_f32 v165, v165
 v_rcp_f32 v166, v166
 v_rcp_f32 v167, v167
 v_mul_f32 v128, v128, v160
 v_mul_f32 v129, v129, v161
 v_mul_f32 v130, v130, v162
 v_mul_f32 v131, v131, v163
 v_mul_f32 v144, v144, v164
 v_mul_f32 v145, v145, v165
 v_mul_f32 v146, v146, v166
 v_mul_f32 v147, v147, v167
 v_cvt_pk_bf16_f32 v168, v128, v129
 v_cvt_pk_bf16_f32 v169, v130, v131
 v_cvt_pk_bf16_f32 v170, v144, v145
 v_cvt_pk_bf16_f32 v171, v146, v147
 buffer_store_dwordx4 v[168:171], v2, s[24:27], 0 offen offset:2048 sc1
 v_mul_f32 v176, v132, v19
 v_mul_f32 v177, v133, v19
 v_mul_f32 v178, v134, v19
 v_mul_f32 v179, v135, v19
 v_mul_f32 v180, v148, v19
 v_mul_f32 v181, v149, v19
 v_mul_f32 v182, v150, v19
 v_mul_f32 v183, v151, v19
 v_exp_f32 v176, v176
 v_mul_f32 v132, v132, v140
 v_exp_f32 v177, v177
 v_mul_f32 v133, v133, v141
 v_exp_f32 v178, v178
 v_mul_f32 v134, v134, v142
 v_exp_f32 v179, v179
 v_mul_f32 v135, v135, v143
 v_exp_f32 v180, v180
 v_mul_f32 v148, v148, v156
 v_exp_f32 v181, v181
 v_mul_f32 v149, v149, v157
 v_exp_f32 v182, v182
 v_mul_f32 v150, v150, v158
 v_exp_f32 v183, v183
 v_mul_f32 v151, v151, v159
 v_fma_f32 v176, v176, v17, v17
 v_fma_f32 v177, v177, v17, v17
 v_fma_f32 v178, v178, v17, v17
 v_fma_f32 v179, v179, v17, v17
 v_fma_f32 v180, v180, v17, v17
 v_fma_f32 v181, v181, v17, v17
 v_fma_f32 v182, v182, v17, v17
 v_fma_f32 v183, v183, v17, v17
 v_rcp_f32 v176, v176
 v_rcp_f32 v177, v177
 v_rcp_f32 v178, v178
 v_rcp_f32 v179, v179
 v_rcp_f32 v180, v180
 v_rcp_f32 v181, v181
 v_rcp_f32 v182, v182
 v_rcp_f32 v183, v183
 v_mul_f32 v132, v132, v176
 v_mul_f32 v133, v133, v177
 v_mul_f32 v134, v134, v178
 v_mul_f32 v135, v135, v179
 v_mul_f32 v148, v148, v180
 v_mul_f32 v149, v149, v181
 v_mul_f32 v150, v150, v182
 v_mul_f32 v151, v151, v183
 v_cvt_pk_bf16_f32 v184, v132, v133
 v_cvt_pk_bf16_f32 v185, v134, v135
 v_cvt_pk_bf16_f32 v186, v148, v149
 v_cvt_pk_bf16_f32 v187, v150, v151
 buffer_store_dwordx4 v[184:187], v2, s[24:27], s5 offen offset:2048 sc1
 s_branch L_gj_259
L_two_258:
 s_mov_b32 s5, 0
 buffer_load_dword v36, v52, s[16:19], s5 offen sc1
 s_add_u32 s5, s5, 5632
 buffer_load_dword v37, v52, s[16:19], s5 offen sc1
 s_add_u32 s5, s5, 5632
 buffer_load_dword v38, v52, s[16:19], s5 offen sc1
 s_add_u32 s5, s5, 5632
 buffer_load_dword v39, v52, s[16:19], s5 offen sc1
 s_add_u32 s5, s5, 5632
 buffer_load_dword v40, v52, s[16:19], s5 offen sc1
 s_add_u32 s5, s5, 5632
 buffer_load_dword v41, v52, s[16:19], s5 offen sc1
 s_add_u32 s5, s5, 5632
 buffer_load_dword v42, v52, s[16:19], s5 offen sc1
 s_add_u32 s5, s5, 5632
 buffer_load_dword v43, v52, s[16:19], s5 offen sc1
 s_add_u32 s5, s5, 5632
 buffer_load_dword v44, v52, s[16:19], s5 offen sc1
 s_add_u32 s5, s5, 5632
 buffer_load_dword v45, v52, s[16:19], s5 offen sc1
 s_add_u32 s5, s5, 5632
 buffer_load_dword v46, v52, s[16:19], s5 offen sc1
 s_add_u32 s5, s5, 5632
 buffer_load_dword v47, v52, s[16:19], s5 offen sc1
 s_add_u32 s5, s5, 5632
 buffer_load_dword v48, v52, s[16:19], s5 offen sc1
 s_add_u32 s5, s5, 5632
 buffer_load_dword v49, v52, s[16:19], s5 offen sc1
 s_add_u32 s5, s5, 5632
 buffer_load_dword v50, v52, s[16:19], s5 offen sc1
 s_add_u32 s5, s5, 5632
 buffer_load_dword v51, v52, s[16:19], s5 offen sc1
 s_add_u32 m0, s73, 122880
 s_mov_b32 s72, 4096
 buffer_load_dwordx4 v28, s[12:15], s72 offen offset:0 sc1 lds
 buffer_load_dwordx4 v28, s[12:15], s72 offen offset:1024 sc1 lds
 buffer_load_dwordx4 v29, s[12:15], s72 offen offset:2048 sc1 lds
 buffer_load_dwordx4 v29, s[12:15], s72 offen offset:3072 sc1 lds
 s_add_u32 m0, s73, 126976
 s_nop 0
 buffer_load_dwordx4 v30, s[12:15], s72 offen offset:0 sc1 lds
 buffer_load_dwordx4 v30, s[12:15], s72 offen offset:1024 sc1 lds
 s_add_u32 m0, s73, 0
 s_mov_b32 s72, 6144
 buffer_load_dwordx4 v28, s[12:15], s72 offen offset:0 sc1 lds
 buffer_load_dwordx4 v28, s[12:15], s72 offen offset:1024 sc1 lds
 buffer_load_dwordx4 v29, s[12:15], s72 offen offset:2048 sc1 lds
 buffer_load_dwordx4 v29, s[12:15], s72 offen offset:3072 sc1 lds
 s_add_u32 m0, s73, 4096
 s_nop 0
 buffer_load_dwordx4 v30, s[12:15], s72 offen offset:0 sc1 lds
 buffer_load_dwordx4 v30, s[12:15], s72 offen offset:1024 sc1 lds
 v_and_b32 v20, 15, v0
 v_lshlrev_b32 v20, 3, v20
 v_lshrrev_b32 v3, 4, v0
 v_lshl_add_u32 v20, v3, 8, v20
 v_lshlrev_b32 v21, 4, v3
 v_add_u32 v21, 149504, v21
 v_add_u32 v10, 49152, v2
 v_add_u32 v11, 98304, v2
 s_waitcnt vmcnt(12)
 v_add_f32 v36, v36, v37
 v_add_f32 v36, v36, v38
 v_add_f32 v36, v36, v39
 v_add_f32 v36, v36, v40
 v_add_f32 v36, v36, v41
 v_add_f32 v36, v36, v42
 v_add_f32 v36, v36, v43
 v_add_f32 v36, v36, v44
 v_add_f32 v36, v36, v45
 v_add_f32 v36, v36, v46
 v_add_f32 v36, v36, v47
 v_add_f32 v36, v36, v48
 v_add_f32 v36, v36, v49
 v_add_f32 v36, v36, v50
 v_add_f32 v36, v36, v51
 ds_write_b32 v53, v36
 s_waitcnt lgkmcnt(0)
 s_mov_b32 s101, 0x40000
L_spin_262:
 buffer_load_dword v23, v22, s[96:99], 0 offen sc1
 s_waitcnt vmcnt(0)
 v_cmp_ne_u32 vcc, s100, v23
 s_nop 0
 s_cbranch_vccz L_ok_263
 s_sleep 1
 s_sub_u32 s101, s101, 1
 s_cmp_lg_u32 s101, 0
 s_cbranch_scc1 L_spin_262
L_ok_263:
 s_mov_b32 s5, 0
 buffer_load_dwordx4 a[0:3], v7, s[8:11], s5 offen offset:0 sc1
 buffer_load_dwordx4 a[4:7], v7, s[8:11], s5 offen offset:1024 sc1
 buffer_load_dwordx4 a[8:11], v8, s[8:11], s5 offen offset:0 sc1
 buffer_load_dwordx4 a[12:15], v8, s[8:11], s5 offen offset:1024 sc1
 buffer_load_dwordx2 v[160:161], v20, s[20:23], 0 offen offset:0 sc1
 buffer_load_dwordx2 v[162:163], v20, s[20:23], 0 offen offset:128 sc1
 buffer_load_dwordx2 v[164:165], v20, s[20:23], 0 offen offset:1024 sc1
 buffer_load_dwordx2 v[166:167], v20, s[20:23], 0 offen offset:1152 sc1
 s_mov_b32 s5, 2048
 buffer_load_dwordx4 a[16:19], v7, s[8:11], s5 offen offset:0 sc1
 buffer_load_dwordx4 a[20:23], v7, s[8:11], s5 offen offset:1024 sc1
 buffer_load_dwordx4 a[24:27], v8, s[8:11], s5 offen offset:0 sc1
 buffer_load_dwordx4 a[28:31], v8, s[8:11], s5 offen offset:1024 sc1
 s_mov_b32 s5, 4096
 buffer_load_dwordx4 a[32:35], v7, s[8:11], s5 offen offset:0 sc1
 buffer_load_dwordx4 a[36:39], v7, s[8:11], s5 offen offset:1024 sc1
 buffer_load_dwordx4 a[40:43], v8, s[8:11], s5 offen offset:0 sc1
 buffer_load_dwordx4 a[44:47], v8, s[8:11], s5 offen offset:1024 sc1
 s_barrier
 ds_read_b128 v[32:35], v10 offset:24576
 ds_read_b128 v[36:39], v10 offset:25600
 ds_read_b128 v[40:43], v10 offset:26624
 ds_read_b128 v[44:47], v10 offset:27648
 ds_read_b128 v[48:51], v10 offset:28672
 ds_read_b128 v[52:55], v10 offset:29696
 s_waitcnt vmcnt(12)
 s_waitcnt lgkmcnt(4)
 v_mfma_f32_16x16x32_bf16 v[64:67], v[32:35], a[0:3], 0
 ds_read_b128 v[56:59], v10 offset:30720
 v_mfma_f32_16x16x32_bf16 v[64:67], v[36:39], a[4:7], v[64:67]
 s_mov_b32 s5, 6144
 buffer_load_dwordx4 a[48:51], v7, s[8:11], s5 offen offset:0 sc1
 v_mfma_f32_16x16x32_bf16 v[68:71], v[36:39], a[12:15], 0
 buffer_load_dwordx4 a[52:55], v7, s[8:11], s5 offen offset:1024 sc1
 v_mfma_f32_16x16x32_bf16 v[68:71], v[32:35], a[8:11], v[68:71]
 s_waitcnt lgkmcnt(3)
 ds_read_b128 v[60:63], v10 offset:31744
 v_mfma_f32_16x16x32_bf16 v[76:79], v[40:43], a[8:11], 0
 buffer_load_dwordx4 a[56:59], v8, s[8:11], s5 offen offset:0 sc1
 v_mfma_f32_16x16x32_bf16 v[76:79], v[44:47], a[12:15], v[76:79]
 s_add_u32 m0, s73, 24576
 ds_read_b128 v[32:35], v10 offset:32768
 v_mfma_f32_16x16x32_bf16 v[72:75], v[44:47], a[4:7], 0
 buffer_load_dwordx4 a[60:63], v8, s[8:11], s5 offen offset:1024 sc1
 v_mfma_f32_16x16x32_bf16 v[72:75], v[40:43], a[0:3], v[72:75]
 s_waitcnt lgkmcnt(3)
 ds_read_b128 v[36:39], v10 offset:33792
 v_mfma_f32_16x16x32_bf16 v[80:83], v[48:51], a[0:3], 0
 s_mov_b32 s72, 8192
 ds_read_b128 v[40:43], v10 offset:34816
 v_mfma_f32_16x16x32_bf16 v[80:83], v[52:55], a[4:7], v[80:83]
 buffer_load_dwordx4 v28, s[12:15], s72 offen offset:0 sc1 lds
 v_mfma_f32_16x16x32_bf16 v[84:87], v[52:55], a[12:15], 0
 buffer_load_dwordx4 v28, s[12:15], s72 offen offset:1024 sc1 lds
 v_mfma_f32_16x16x32_bf16 v[84:87], v[48:51], a[8:11], v[84:87]
 s_waitcnt lgkmcnt(3)
 ds_read_b128 v[44:47], v10 offset:35840
 v_mfma_f32_16x16x32_bf16 v[92:95], v[56:59], a[8:11], 0
 buffer_load_dwordx4 v29, s[12:15], s72 offen offset:2048 sc1 lds
 v_mfma_f32_16x16x32_bf16 v[92:95], v[60:63], a[12:15], v[92:95]
 buffer_load_dwordx4 v29, s[12:15], s72 offen offset:3072 sc1 lds
 v_mfma_f32_16x16x32_bf16 v[88:91], v[60:63], a[4:7], 0
 s_mov_b32 s5, 8192
 ds_read_b128 v[48:51], v10 offset:36864
 v_mfma_f32_16x16x32_bf16 v[88:91], v[56:59], a[0:3], v[88:91]
 s_waitcnt lgkmcnt(3)
 ds_read_b128 v[52:55], v10 offset:37888
 v_mfma_f32_16x16x32_bf16 v[96:99], v[32:35], a[0:3], 0
 buffer_load_dwordx4 a[64:67], v7, s[8:11], s5 offen offset:0 sc1
 v_mfma_f32_16x16x32_bf16 v[96:99], v[36:39], a[4:7], v[96:99]
 buffer_load_dwordx4 a[68:71], v7, s[8:11], s5 offen offset:1024 sc1
 v_mfma_f32_16x16x32_bf16 v[100:103], v[36:39], a[12:15], 0
 s_add_u32 m0, s73, 28672
 ds_read_b128 v[56:59], v10 offset:38912
 buffer_load_dwordx4 a[72:75], v8, s[8:11], s5 offen offset:0 sc1
 buffer_load_dwordx4 a[76:79], v8, s[8:11], s5 offen offset:1024 sc1
 buffer_load_dwordx4 v30, s[12:15], s72 offen offset:0 sc1 lds
 buffer_load_dwordx4 v30, s[12:15], s72 offen offset:1024 sc1 lds
 v_mfma_f32_16x16x32_bf16 v[100:103], v[32:35], a[8:11], v[100:103]
 s_waitcnt lgkmcnt(3)
 ds_read_b128 v[60:63], v10 offset:39936
 v_mfma_f32_16x16x32_bf16 v[108:111], v[40:43], a[8:11], 0
 ds_read_b128 v[32:35], v11 offset:0
 v_mfma_f32_16x16x32_bf16 v[108:111], v[44:47], a[12:15], v[108:111]
 ds_read_b128 v[36:39], v11 offset:1024
 v_mfma_f32_16x16x32_bf16 v[104:107], v[44:47], a[4:7], 0
 v_mfma_f32_16x16x32_bf16 v[104:107], v[40:43], a[0:3], v[104:107]
 s_waitcnt lgkmcnt(4)
 v_mfma_f32_16x16x32_bf16 v[112:115], v[48:51], a[0:3], 0
 ds_read_b128 v[40:43], v11 offset:2048
 v_mfma_f32_16x16x32_bf16 v[112:115], v[52:55], a[4:7], v[112:115]
 ds_read_b128 v[44:47], v11 offset:3072
 v_mfma_f32_16x16x32_bf16 v[116:119], v[52:55], a[12:15], 0
 v_mfma_f32_16x16x32_bf16 v[116:119], v[48:51], a[8:11], v[116:119]
 s_waitcnt lgkmcnt(4)
 v_mfma_f32_16x16x32_bf16 v[124:127], v[56:59], a[8:11], 0
 ds_read_b128 v[48:51], v11 offset:4096
 v_mfma_f32_16x16x32_bf16 v[124:127], v[60:63], a[12:15], v[124:127]
 ds_read_b128 v[52:55], v11 offset:5120
 v_mfma_f32_16x16x32_bf16 v[120:123], v[60:63], a[4:7], 0
 v_mfma_f32_16x16x32_bf16 v[120:123], v[56:59], a[0:3], v[120:123]
 s_waitcnt vmcnt(18)
 s_waitcnt lgkmcnt(4)
 v_mfma_f32_16x16x32_bf16 v[64:67], v[32:35], a[16:19], v[64:67]
 ds_read_b128 v[56:59], v11 offset:6144
 v_mfma_f32_16x16x32_bf16 v[64:67], v[36:39], a[20:23], v[64:67]
 s_mov_b32 s5, 10240
 buffer_load_dwordx4 a[80:83], v7, s[8:11], s5 offen offset:0 sc1
 v_mfma_f32_16x16x32_bf16 v[68:71], v[36:39], a[28:31], v[68:71]
 buffer_load_dwordx4 a[84:87], v7, s[8:11], s5 offen offset:1024 sc1
 v_mfma_f32_16x16x32_bf16 v[68:71], v[32:35], a[24:27], v[68:71]
 s_waitcnt lgkmcnt(3)
 ds_read_b128 v[60:63], v11 offset:7168
 v_mfma_f32_16x16x32_bf16 v[76:79], v[40:43], a[24:27], v[76:79]
 buffer_load_dwordx4 a[88:91], v8, s[8:11], s5 offen offset:0 sc1
 v_mfma_f32_16x16x32_bf16 v[76:79], v[44:47], a[28:31], v[76:79]
 buffer_load_dwordx4 a[92:95], v8, s[8:11], s5 offen offset:1024 sc1
 v_mfma_f32_16x16x32_bf16 v[72:75], v[44:47], a[20:23], v[72:75]
 ds_read_b128 v[32:35], v11 offset:8192
 v_add_f32 v12, v160, v162
 v_mfma_f32_16x16x32_bf16 v[72:75], v[40:43], a[16:19], v[72:75]
 s_waitcnt lgkmcnt(3)
 ds_read_b128 v[36:39], v11 offset:9216
 v_mfma_f32_16x16x32_bf16 v[80:83], v[48:51], a[16:19], v[80:83]
 s_mov_b32 s5, 12288
 ds_read_b128 v[40:43], v11 offset:10240
 v_mfma_f32_16x16x32_bf16 v[80:83], v[52:55], a[20:23], v[80:83]
 buffer_load_dwordx4 a[96:99], v7, s[8:11], s5 offen offset:0 sc1
 v_mfma_f32_16x16x32_bf16 v[84:87], v[52:55], a[28:31], v[84:87]
 buffer_load_dwordx4 a[100:103], v7, s[8:11], s5 offen offset:1024 sc1
 v_mfma_f32_16x16x32_bf16 v[84:87], v[48:51], a[24:27], v[84:87]
 s_waitcnt lgkmcnt(3)
 ds_read_b128 v[44:47], v11 offset:11264
 v_mfma_f32_16x16x32_bf16 v[92:95], v[56:59], a[24:27], v[92:95]
 buffer_load_dwordx4 a[104:107], v8, s[8:11], s5 offen offset:0 sc1
 v_mfma_f32_16x16x32_bf16 v[92:95], v[60:63], a[28:31], v[92:95]
 buffer_load_dwordx4 a[108:111], v8, s[8:11], s5 offen offset:1024 sc1
 v_mfma_f32_16x16x32_bf16 v[88:91], v[60:63], a[20:23], v[88:91]
 s_add_u32 m0, s73, 49152
 ds_read_b128 v[48:51], v11 offset:12288
 v_mfma_f32_16x16x32_bf16 v[88:91], v[56:59], a[16:19], v[88:91]
 s_waitcnt lgkmcnt(3)
 ds_read_b128 v[52:55], v11 offset:13312
 v_mfma_f32_16x16x32_bf16 v[96:99], v[32:35], a[16:19], v[96:99]
 s_mov_b32 s72, 10240
 buffer_load_dwordx4 v28, s[12:15], s72 offen offset:0 sc1 lds
 v_mfma_f32_16x16x32_bf16 v[96:99], v[36:39], a[20:23], v[96:99]
 buffer_load_dwordx4 v28, s[12:15], s72 offen offset:1024 sc1 lds
 v_mfma_f32_16x16x32_bf16 v[100:103], v[36:39], a[28:31], v[100:103]
 buffer_load_dwordx4 v29, s[12:15], s72 offen offset:2048 sc1 lds
 buffer_load_dwordx4 v29, s[12:15], s72 offen offset:3072 sc1 lds
 s_add_u32 m0, s73, 53248
 s_nop 0
 buffer_load_dwordx4 v30, s[12:15], s72 offen offset:0 sc1 lds
 buffer_load_dwordx4 v30, s[12:15], s72 offen offset:1024 sc1 lds
 v_mfma_f32_16x16x32_bf16 v[100:103], v[32:35], a[24:27], v[100:103]
 s_waitcnt lgkmcnt(2)
 ds_read_b128 v[56:59], v11 offset:14336
 s_barrier
 ds_read_b128 v[60:63], v11 offset:15360
 v_mfma_f32_16x16x32_bf16 v[108:111], v[40:43], a[24:27], v[108:111]
 s_add_u32 m0, s73, 73728
 v_mov_b32 v3, v12
 s_mov_b32 s72, 12288
 v_mfma_f32_16x16x32_bf16 v[108:111], v[44:47], a[28:31], v[108:111]
 buffer_load_dwordx4 v28, s[12:15], s72 offen offset:0 sc1 lds
 v_mfma_f32_16x16x32_bf16 v[104:107], v[44:47], a[20:23], v[104:107]
 ds_read_b128 v[32:35], v11 offset:24576
 v_permlane16_swap_b32 v12, v3
 v_mfma_f32_16x16x32_bf16 v[104:107], v[40:43], a[16:19], v[104:107]
 s_waitcnt lgkmcnt(3)
 ds_read_b128 v[36:39], v11 offset:25600
 v_mfma_f32_16x16x32_bf16 v[112:115], v[48:51], a[16:19], v[112:115]
 ds_read_b128 v[40:43], v11 offset:26624
 v_add_f32 v12, v12, v3
 v_mfma_f32_16x16x32_bf16 v[112:115], v[52:55], a[20:23], v[112:115]
 buffer_load_dwordx4 v28, s[12:15], s72 offen offset:1024 sc1 lds
 v_mfma_f32_16x16x32_bf16 v[116:119], v[52:55], a[28:31], v[116:119]
 buffer_load_dwordx4 v29, s[12:15], s72 offen offset:2048 sc1 lds
 v_mfma_f32_16x16x32_bf16 v[116:119], v[48:51], a[24:27], v[116:119]
 s_waitcnt lgkmcnt(3)
 ds_read_b128 v[44:47], v11 offset:27648
 v_mfma_f32_16x16x32_bf16 v[124:127], v[56:59], a[24:27], v[124:127]
 buffer_load_dwordx4 v29, s[12:15], s72 offen offset:3072 sc1 lds
 v_mfma_f32_16x16x32_bf16 v[124:127], v[60:63], a[28:31], v[124:127]
 s_add_u32 m0, s73, 77824
 ds_read_b128 v[48:51], v11 offset:28672
 v_mfma_f32_16x16x32_bf16 v[120:123], v[60:63], a[20:23], v[120:123]
 buffer_load_dwordx4 v30, s[12:15], s72 offen offset:0 sc1 lds
 v_mfma_f32_16x16x32_bf16 v[120:123], v[56:59], a[16:19], v[120:123]
 buffer_load_dwordx4 v30, s[12:15], s72 offen offset:1024 sc1 lds
 ds_read_b128 v[52:55], v11 offset:29696
 v_mov_b32 v3, v12
 s_nop 1
 v_permlane32_swap_b32 v12, v3
 v_add_f32 v12, v12, v3
 v_mul_f32 v12, 0x3e000000, v12
 v_sub_f32 v160, v160, v12
 v_sub_f32 v162, v162, v12
 v_mul_f32 v160, v160, v160
 v_fmac_f32 v160, v162, v162
 v_add_f32 v14, v161, v163
 v_fmac_f32 v14, 0x42800000, v160
 v_mov_b32 v3, v14
 s_nop 1
 v_permlane16_swap_b32 v14, v3
 v_add_f32 v14, v14, v3
 v_mov_b32 v3, v14
 s_nop 1
 v_permlane32_swap_b32 v14, v3
 v_add_f32 v14, v14, v3
 v_mul_f32 v14, 0x3b000000, v14
 v_cvt_pk_bf16_f32 v12, v12, v14
 v_and_b32 v14, 0xffff0000, v12
 v_lshlrev_b32 v12, 16, v12
 v_xor_b32 v12, 0x80000000, v12
 v_add_f32 v14, 0x3727c5ac, v14
 v_cvt_pk_bf16_f32 v14, v14, v14
 v_lshlrev_b32 v14, 16, v14
 v_sqrt_f32 v14, v14
 s_nop 0
 v_cvt_pk_bf16_f32 v14, v14, v14
 v_lshlrev_b32 v14, 16, v14
 v_mul_f32 v16, v14, v14
 v_rcp_f32 v14, v14
 s_waitcnt vmcnt(34)
 s_waitcnt lgkmcnt(4)
 v_mfma_f32_16x16x32_bf16 v[64:67], v[32:35], a[32:35], v[64:67]
 ds_read_b128 v[56:59], v11 offset:30720
 v_mul_f32 v18, 0xbfb8aa3b, v14
 v_mfma_f32_16x16x32_bf16 v[64:67], v[36:39], a[36:39], v[64:67]
 s_mov_b32 s5, 14336
 v_add_f32 v13, v164, v166
 v_mov_b32 v3, v13
 v_mfma_f32_16x16x32_bf16 v[68:71], v[36:39], a[44:47], v[68:71]
 ds_read_b128 v[60:63], v11 offset:31744
 v_permlane16_swap_b32 v13, v3
 v_mfma_f32_16x16x32_bf16 v[68:71], v[32:35], a[40:43], v[68:71]
 s_waitcnt lgkmcnt(4)
 v_add_f32 v13, v13, v3
 v_mov_b32 v3, v13
 v_mfma_f32_16x16x32_bf16 v[76:79], v[40:43], a[40:43], v[76:79]
 ds_read_b128 v[32:35], v11 offset:32768
 v_permlane32_swap_b32 v13, v3
 v_mfma_f32_16x16x32_bf16 v[76:79], v[44:47], a[44:47], v[76:79]
 ds_read_b128 v[36:39], v11 offset:33792
 v_add_f32 v13, v13, v3
 v_mfma_f32_16x16x32_bf16 v[72:75], v[44:47], a[36:39], v[72:75]
 buffer_load_dwordx4 a[112:115], v7, s[8:11], s5 offen offset:0 sc1
 v_mfma_f32_16x16x32_bf16 v[72:75], v[40:43], a[32:35], v[72:75]
 s_waitcnt lgkmcnt(4)
 v_mul_f32 v13, 0x3e000000, v13
 v_sub_f32 v164, v164, v13
 v_mfma_f32_16x16x32_bf16 v[80:83], v[48:51], a[32:35], v[80:83]
 buffer_load_dwordx4 a[116:119], v7, s[8:11], s5 offen offset:1024 sc1
 v_mfma_f32_16x16x32_bf16 v[80:83], v[52:55], a[36:39], v[80:83]
 ds_read_b128 v[40:43], v11 offset:34816
 v_sub_f32 v166, v166, v13
 v_mfma_f32_16x16x32_bf16 v[84:87], v[52:55], a[44:47], v[84:87]
 ds_read_b128 v[44:47], v11 offset:35840
 v_mul_f32 v164, v164, v164
 v_mfma_f32_16x16x32_bf16 v[84:87], v[48:51], a[40:43], v[84:87]
 s_waitcnt lgkmcnt(4)
 v_fmac_f32 v164, v166, v166
 v_add_f32 v15, v165, v167
 v_mfma_f32_16x16x32_bf16 v[92:95], v[56:59], a[40:43], v[92:95]
 buffer_load_dwordx4 a[120:123], v8, s[8:11], s5 offen offset:0 sc1
 v_mfma_f32_16x16x32_bf16 v[92:95], v[60:63], a[44:47], v[92:95]
 ds_read_b128 v[48:51], v11 offset:36864
 v_fmac_f32 v15, 0x42800000, v164
 v_mfma_f32_16x16x32_bf16 v[88:91], v[60:63], a[36:39], v[88:91]
 ds_read_b128 v[52:55], v11 offset:37888
 v_mov_b32 v3, v15
 v_mfma_f32_16x16x32_bf16 v[88:91], v[56:59], a[32:35], v[88:91]
 s_waitcnt lgkmcnt(4)
 v_permlane16_swap_b32 v15, v3
 v_add_f32 v15, v15, v3
 v_mfma_f32_16x16x32_bf16 v[96:99], v[32:35], a[32:35], v[96:99]
 buffer_load_dwordx4 a[124:127], v8, s[8:11], s5 offen offset:1024 sc1
 v_mfma_f32_16x16x32_bf16 v[96:99], v[36:39], a[36:39], v[96:99]
 ds_read_b128 v[56:59], v11 offset:38912
 v_mov_b32 v3, v15
 v_mfma_f32_16x16x32_bf16 v[100:103], v[36:39], a[44:47], v[100:103]
 ds_read_b128 v[60:63], v11 offset:39936
 v_permlane32_swap_b32 v15, v3
 v_mfma_f32_16x16x32_bf16 v[100:103], v[32:35], a[40:43], v[100:103]
 s_waitcnt lgkmcnt(4)
 v_add_f32 v15, v15, v3
 s_barrier
 v_mfma_f32_16x16x32_bf16 v[108:111], v[40:43], a[40:43], v[108:111]
 s_add_u32 m0, s73, 98304
 v_mul_f32 v15, 0x3b000000, v15
 s_mov_b32 s72, 14336
 v_mfma_f32_16x16x32_bf16 v[108:111], v[44:47], a[44:47], v[108:111]
 buffer_load_dwordx4 v28, s[12:15], s72 offen offset:0 sc1 lds
 v_mfma_f32_16x16x32_bf16 v[104:107], v[44:47], a[36:39], v[104:107]
 ds_read_b128 v[32:35], v9 offset:0
 v_cvt_pk_bf16_f32 v13, v13, v15
 v_mfma_f32_16x16x32_bf16 v[104:107], v[40:43], a[32:35], v[104:107]
 s_waitcnt lgkmcnt(3)
 ds_read_b128 v[36:39], v9 offset:1024
 v_mfma_f32_16x16x32_bf16 v[112:115], v[48:51], a[32:35], v[112:115]
 buffer_load_dwordx4 v28, s[12:15], s72 offen offset:1024 sc1 lds
 v_mfma_f32_16x16x32_bf16 v[112:115], v[52:55], a[36:39], v[112:115]
 buffer_load_dwordx4 v29, s[12:15], s72 offen offset:2048 sc1 lds
 v_mfma_f32_16x16x32_bf16 v[116:119], v[52:55], a[44:47], v[116:119]
 ds_read_b128 v[40:43], v9 offset:2048
 v_and_b32 v15, 0xffff0000, v13
 v_mfma_f32_16x16x32_bf16 v[116:119], v[48:51], a[40:43], v[116:119]
 s_waitcnt lgkmcnt(3)
 ds_read_b128 v[44:47], v9 offset:3072
 v_mfma_f32_16x16x32_bf16 v[124:127], v[56:59], a[40:43], v[124:127]
 buffer_load_dwordx4 v29, s[12:15], s72 offen offset:3072 sc1 lds
 v_mfma_f32_16x16x32_bf16 v[124:127], v[60:63], a[44:47], v[124:127]
 s_add_u32 m0, s73, 102400
 s_nop 0
 buffer_load_dwordx4 v30, s[12:15], s72 offen offset:0 sc1 lds
 v_mfma_f32_16x16x32_bf16 v[120:123], v[60:63], a[36:39], v[120:123]
 ds_read_b128 v[48:51], v9 offset:4096
 v_lshlrev_b32 v13, 16, v13
 v_xor_b32 v13, 0x80000000, v13
 v_mfma_f32_16x16x32_bf16 v[120:123], v[56:59], a[32:35], v[120:123]
 buffer_load_dwordx4 v30, s[12:15], s72 offen offset:1024 sc1 lds
 ds_read_b128 v[52:55], v9 offset:5120
 v_add_f32 v15, 0x3727c5ac, v15
 v_cvt_pk_bf16_f32 v15, v15, v15
 v_lshlrev_b32 v15, 16, v15
 v_sqrt_f32 v15, v15
 s_nop 0
 v_cvt_pk_bf16_f32 v15, v15, v15
 v_lshlrev_b32 v15, 16, v15
 v_mul_f32 v17, v15, v15
 v_rcp_f32 v15, v15
 s_nop 0
 v_mul_f32 v19, 0xbfb8aa3b, v15
 s_waitcnt vmcnt(40)
 s_waitcnt lgkmcnt(4)
 v_mfma_f32_16x16x32_bf16 v[64:67], v[32:35], a[48:51], v[64:67]
 ds_read_b128 v[176:179], v21 offset:0
 v_mfma_f32_16x16x32_bf16 v[64:67], v[36:39], a[52:55], v[64:67]
 ds_read_b128 v[180:183], v21 offset:64
 v_mfma_f32_16x16x32_bf16 v[68:71], v[36:39], a[60:63], v[68:71]
 ds_read_b128 v[56:59], v9 offset:6144
 v_mfma_f32_16x16x32_bf16 v[68:71], v[32:35], a[56:59], v[68:71]
 s_waitcnt lgkmcnt(5)
 ds_read_b128 v[60:63], v9 offset:7168
 v_mfma_f32_16x16x32_bf16 v[76:79], v[40:43], a[56:59], v[76:79]
 ds_read_b128 v[184:187], v21 offset:128
 v_mfma_f32_16x16x32_bf16 v[76:79], v[44:47], a[60:63], v[76:79]
 ds_read_b128 v[32:35], v9 offset:8192
 v_mfma_f32_16x16x32_bf16 v[72:75], v[44:47], a[52:55], v[72:75]
 ds_read_b128 v[36:39], v9 offset:9216
 v_mfma_f32_16x16x32_bf16 v[72:75], v[40:43], a[48:51], v[72:75]
 s_waitcnt lgkmcnt(7)
 v_mfma_f32_16x16x32_bf16 v[80:83], v[48:51], a[48:51], v[80:83]
 ds_read_b128 v[188:191], v21 offset:192
 v_mfma_f32_16x16x32_bf16 v[80:83], v[52:55], a[52:55], v[80:83]
 ds_read_b128 v[40:43], v9 offset:10240
 v_mfma_f32_16x16x32_bf16 v[84:87], v[52:55], a[60:63], v[84:87]
 ds_read_b128 v[44:47], v9 offset:11264
 v_mfma_f32_16x16x32_bf16 v[84:87], v[48:51], a[56:59], v[84:87]
 s_waitcnt lgkmcnt(6)
 v_mfma_f32_16x16x32_bf16 v[92:95], v[56:59], a[56:59], v[92:95]
 ds_read_b128 v[192:195], v21 offset:256
 v_mfma_f32_16x16x32_bf16 v[92:95], v[60:63], a[60:63], v[92:95]
 ds_read_b128 v[48:51], v9 offset:12288
 v_mfma_f32_16x16x32_bf16 v[88:91], v[60:63], a[52:55], v[88:91]
 ds_read_b128 v[52:55], v9 offset:13312
 v_mfma_f32_16x16x32_bf16 v[88:91], v[56:59], a[48:51], v[88:91]
 s_waitcnt lgkmcnt(6)
 v_mfma_f32_16x16x32_bf16 v[96:99], v[32:35], a[48:51], v[96:99]
 ds_read_b128 v[196:199], v21 offset:320
 v_mfma_f32_16x16x32_bf16 v[96:99], v[36:39], a[52:55], v[96:99]
 ds_read_b128 v[56:59], v9 offset:14336
 v_mfma_f32_16x16x32_bf16 v[100:103], v[36:39], a[60:63], v[100:103]
 ds_read_b128 v[60:63], v9 offset:15360
 v_mfma_f32_16x16x32_bf16 v[100:103], v[32:35], a[56:59], v[100:103]
 s_waitcnt lgkmcnt(6)
 s_waitcnt vmcnt(30)
 s_barrier
 v_mfma_f32_16x16x32_bf16 v[108:111], v[40:43], a[56:59], v[108:111]
 ds_read_b128 v[200:203], v21 offset:384
 v_mfma_f32_16x16x32_bf16 v[108:111], v[44:47], a[60:63], v[108:111]
 ds_read_b128 v[32:35], v9 offset:24576
 v_mfma_f32_16x16x32_bf16 v[104:107], v[44:47], a[52:55], v[104:107]
 ds_read_b128 v[36:39], v9 offset:25600
 v_mfma_f32_16x16x32_bf16 v[104:107], v[40:43], a[48:51], v[104:107]
 s_waitcnt lgkmcnt(6)
 v_mfma_f32_16x16x32_bf16 v[112:115], v[48:51], a[48:51], v[112:115]
 ds_read_b128 v[204:207], v21 offset:448
 v_mfma_f32_16x16x32_bf16 v[112:115], v[52:55], a[52:55], v[112:115]
 ds_read_b128 v[40:43], v9 offset:26624
 v_mfma_f32_16x16x32_bf16 v[116:119], v[52:55], a[60:63], v[116:119]
 ds_read_b128 v[44:47], v9 offset:27648
 v_mfma_f32_16x16x32_bf16 v[116:119], v[48:51], a[56:59], v[116:119]
 s_waitcnt lgkmcnt(6)
 v_mfma_f32_16x16x32_bf16 v[124:127], v[56:59], a[56:59], v[124:127]
 ds_read_b128 v[48:51], v9 offset:28672
 v_mfma_f32_16x16x32_bf16 v[124:127], v[60:63], a[60:63], v[124:127]
 ds_read_b128 v[52:55], v9 offset:29696
 v_mfma_f32_16x16x32_bf16 v[120:123], v[60:63], a[52:55], v[120:123]
 v_mfma_f32_16x16x32_bf16 v[120:123], v[56:59], a[48:51], v[120:123]
 s_waitcnt lgkmcnt(5)
 v_mfma_f32_16x16x32_bf16 v[64:67], v[32:35], a[64:67], v[64:67]
 ds_read_b128 v[56:59], v9 offset:30720
 v_mfma_f32_16x16x32_bf16 v[64:67], v[36:39], a[68:71], v[64:67]
 ds_read_b128 v[60:63], v9 offset:31744
 v_mfma_f32_16x16x32_bf16 v[68:71], v[36:39], a[76:79], v[68:71]
 v_mfma_f32_16x16x32_bf16 v[68:71], v[32:35], a[72:75], v[68:71]
 s_waitcnt lgkmcnt(4)
 v_mfma_f32_16x16x32_bf16 v[76:79], v[40:43], a[72:75], v[76:79]
 ds_read_b128 v[32:35], v9 offset:32768
 v_mfma_f32_16x16x32_bf16 v[76:79], v[44:47], a[76:79], v[76:79]
 ds_read_b128 v[36:39], v9 offset:33792
 v_mfma_f32_16x16x32_bf16 v[72:75], v[44:47], a[68:71], v[72:75]
 v_mfma_f32_16x16x32_bf16 v[72:75], v[40:43], a[64:67], v[72:75]
 s_waitcnt lgkmcnt(4)
 v_mfma_f32_16x16x32_bf16 v[80:83], v[48:51], a[64:67], v[80:83]
 v_fmac_f32 v64, v176, v12
 v_fmac_f32 v65, v177, v12
 v_mfma_f32_16x16x32_bf16 v[80:83], v[52:55], a[68:71], v[80:83]
 ds_read_b128 v[40:43], v9 offset:34816
 v_fmac_f32 v66, v178, v12
 v_mfma_f32_16x16x32_bf16 v[84:87], v[52:55], a[76:79], v[84:87]
 ds_read_b128 v[44:47], v9 offset:35840
 v_fmac_f32 v67, v179, v12
 v_mfma_f32_16x16x32_bf16 v[84:87], v[48:51], a[72:75], v[84:87]
 s_waitcnt lgkmcnt(4)
 v_fmac_f32 v68, v176, v13
 v_fmac_f32 v69, v177, v13
 v_mfma_f32_16x16x32_bf16 v[92:95], v[56:59], a[72:75], v[92:95]
 ds_read_b128 v[48:51], v9 offset:36864
 v_fmac_f32 v70, v178, v13
 v_mfma_f32_16x16x32_bf16 v[92:95], v[60:63], a[76:79], v[92:95]
 ds_read_b128 v[52:55], v9 offset:37888
 v_fmac_f32 v71, v179, v13
 v_mfma_f32_16x16x32_bf16 v[88:91], v[60:63], a[68:71], v[88:91]
 v_fmac_f32 v72, v180, v12
 v_fmac_f32 v73, v181, v12
 v_mfma_f32_16x16x32_bf16 v[88:91], v[56:59], a[64:67], v[88:91]
 s_waitcnt lgkmcnt(4)
 v_fmac_f32 v74, v182, v12
 v_fmac_f32 v75, v183, v12
 v_mfma_f32_16x16x32_bf16 v[96:99], v[32:35], a[64:67], v[96:99]
 ds_read_b128 v[56:59], v9 offset:38912
 v_fmac_f32 v76, v180, v13
 v_mfma_f32_16x16x32_bf16 v[96:99], v[36:39], a[68:71], v[96:99]
 ds_read_b128 v[60:63], v9 offset:39936
 v_fmac_f32 v77, v181, v13
 v_mfma_f32_16x16x32_bf16 v[100:103], v[36:39], a[76:79], v[100:103]
 v_fmac_f32 v78, v182, v13
 v_mfma_f32_16x16x32_bf16 v[100:103], v[32:35], a[72:75], v[100:103]
 s_waitcnt lgkmcnt(4)
 v_fmac_f32 v79, v183, v13
 s_waitcnt vmcnt(16)
 s_barrier
 v_mfma_f32_16x16x32_bf16 v[108:111], v[40:43], a[72:75], v[108:111]
 ds_read_b128 v[32:35], v10 offset:0
 v_mfma_f32_16x16x32_bf16 v[108:111], v[44:47], a[76:79], v[108:111]
 ds_read_b128 v[36:39], v10 offset:1024
 v_fmac_f32 v80, v184, v12
 v_mfma_f32_16x16x32_bf16 v[104:107], v[44:47], a[68:71], v[104:107]
 v_fmac_f32 v81, v185, v12
 v_fmac_f32 v82, v186, v12
 v_mfma_f32_16x16x32_bf16 v[104:107], v[40:43], a[64:67], v[104:107]
 s_waitcnt lgkmcnt(4)
 v_fmac_f32 v83, v187, v12
 v_fmac_f32 v84, v184, v13
 v_mfma_f32_16x16x32_bf16 v[112:115], v[48:51], a[64:67], v[112:115]
 ds_read_b128 v[40:43], v10 offset:2048
 v_fmac_f32 v85, v185, v13
 v_mfma_f32_16x16x32_bf16 v[112:115], v[52:55], a[68:71], v[112:115]
 v_fmac_f32 v86, v186, v13
 v_fmac_f32 v87, v187, v13
 v_mfma_f32_16x16x32_bf16 v[116:119], v[52:55], a[76:79], v[116:119]
 ds_read_b128 v[44:47], v10 offset:3072
 v_mfma_f32_16x16x32_bf16 v[116:119], v[48:51], a[72:75], v[116:119]
 s_waitcnt lgkmcnt(4)
 v_fmac_f32 v88, v188, v12
 v_fmac_f32 v89, v189, v12
 v_mfma_f32_16x16x32_bf16 v[124:127], v[56:59], a[72:75], v[124:127]
 ds_read_b128 v[48:51], v10 offset:4096
 v_fmac_f32 v90, v190, v12
 v_mfma_f32_16x16x32_bf16 v[124:127], v[60:63], a[76:79], v[124:127]
 ds_read_b128 v[52:55], v10 offset:5120
 v_fmac_f32 v91, v191, v12
 v_mfma_f32_16x16x32_bf16 v[120:123], v[60:63], a[68:71], v[120:123]
 v_fmac_f32 v92, v188, v13
 v_fmac_f32 v93, v189, v13
 v_mfma_f32_16x16x32_bf16 v[120:123], v[56:59], a[64:67], v[120:123]
 v_fmac_f32 v94, v190, v13
 v_fmac_f32 v95, v191, v13
 s_waitcnt lgkmcnt(4)
 v_mfma_f32_16x16x32_bf16 v[64:67], v[32:35], a[80:83], v[64:67]
 v_fmac_f32 v96, v192, v12
 v_fmac_f32 v97, v193, v12
 v_fmac_f32 v98, v194, v12
 v_mfma_f32_16x16x32_bf16 v[64:67], v[36:39], a[84:87], v[64:67]
 ds_read_b128 v[56:59], v10 offset:6144
 v_fmac_f32 v99, v195, v12
 v_fmac_f32 v100, v192, v13
 v_mfma_f32_16x16x32_bf16 v[68:71], v[36:39], a[92:95], v[68:71]
 ds_read_b128 v[60:63], v10 offset:7168
 v_fmac_f32 v101, v193, v13
 v_mfma_f32_16x16x32_bf16 v[68:71], v[32:35], a[88:91], v[68:71]
 s_waitcnt lgkmcnt(4)
 v_fmac_f32 v102, v194, v13
 v_fmac_f32 v103, v195, v13
 v_mfma_f32_16x16x32_bf16 v[76:79], v[40:43], a[88:91], v[76:79]
 v_fmac_f32 v104, v196, v12
 v_fmac_f32 v105, v197, v12
 v_mfma_f32_16x16x32_bf16 v[76:79], v[44:47], a[92:95], v[76:79]
 ds_read_b128 v[32:35], v10 offset:8192
 v_fmac_f32 v106, v198, v12
 v_mfma_f32_16x16x32_bf16 v[72:75], v[44:47], a[84:87], v[72:75]
 ds_read_b128 v[36:39], v10 offset:9216
 v_fmac_f32 v107, v199, v12
 v_mfma_f32_16x16x32_bf16 v[72:75], v[40:43], a[80:83], v[72:75]
 s_waitcnt lgkmcnt(4)
 v_fmac_f32 v108, v196, v13
 v_fmac_f32 v109, v197, v13
 v_fmac_f32 v110, v198, v13
 v_fmac_f32 v111, v199, v13
 v_mfma_f32_16x16x32_bf16 v[80:83], v[48:51], a[80:83], v[80:83]
 v_fmac_f32 v112, v200, v12
 v_fmac_f32 v113, v201, v12
 v_mfma_f32_16x16x32_bf16 v[80:83], v[52:55], a[84:87], v[80:83]
 ds_read_b128 v[40:43], v10 offset:10240
 v_fmac_f32 v114, v202, v12
 v_mfma_f32_16x16x32_bf16 v[84:87], v[52:55], a[92:95], v[84:87]
 ds_read_b128 v[44:47], v10 offset:11264
 v_fmac_f32 v115, v203, v12
 v_fmac_f32 v116, v200, v13
 v_mfma_f32_16x16x32_bf16 v[84:87], v[48:51], a[88:91], v[84:87]
 s_waitcnt lgkmcnt(4)
 v_fmac_f32 v117, v201, v13
 v_fmac_f32 v118, v202, v13
 v_fmac_f32 v119, v203, v13
 v_mfma_f32_16x16x32_bf16 v[92:95], v[56:59], a[88:91], v[92:95]
 v_fmac_f32 v120, v204, v12
 v_fmac_f32 v121, v205, v12
 v_fmac_f32 v122, v206, v12
 v_mfma_f32_16x16x32_bf16 v[92:95], v[60:63], a[92:95], v[92:95]
 ds_read_b128 v[48:51], v10 offset:12288
 v_fmac_f32 v123, v207, v12
 v_mfma_f32_16x16x32_bf16 v[88:91], v[60:63], a[84:87], v[88:91]
 ds_read_b128 v[52:55], v10 offset:13312
 v_fmac_f32 v124, v204, v13
 v_mfma_f32_16x16x32_bf16 v[88:91], v[56:59], a[80:83], v[88:91]
 s_waitcnt lgkmcnt(4)
 v_fmac_f32 v125, v205, v13
 v_fmac_f32 v126, v206, v13
 v_fmac_f32 v127, v207, v13
 v_mfma_f32_16x16x32_bf16 v[96:99], v[32:35], a[80:83], v[96:99]
 ds_read_b128 v[56:59], v10 offset:14336
 v_mfma_f32_16x16x32_bf16 v[96:99], v[36:39], a[84:87], v[96:99]
 ds_read_b128 v[60:63], v10 offset:15360
 v_mfma_f32_16x16x32_bf16 v[100:103], v[36:39], a[92:95], v[100:103]
 v_mfma_f32_16x16x32_bf16 v[100:103], v[32:35], a[88:91], v[100:103]
 s_waitcnt lgkmcnt(4)
 s_waitcnt vmcnt(0)
 s_barrier
 v_mfma_f32_16x16x32_bf16 v[108:111], v[40:43], a[88:91], v[108:111]
 ds_read_b128 v[32:35], v10 offset:24576
 v_mfma_f32_16x16x32_bf16 v[108:111], v[44:47], a[92:95], v[108:111]
 ds_read_b128 v[36:39], v10 offset:25600
 v_mfma_f32_16x16x32_bf16 v[104:107], v[44:47], a[84:87], v[104:107]
 v_mfma_f32_16x16x32_bf16 v[104:107], v[40:43], a[80:83], v[104:107]
 s_waitcnt lgkmcnt(4)
 v_mfma_f32_16x16x32_bf16 v[112:115], v[48:51], a[80:83], v[112:115]
 ds_read_b128 v[40:43], v11 offset:0
 v_mfma_f32_16x16x32_bf16 v[112:115], v[52:55], a[84:87], v[112:115]
 ds_read_b128 v[44:47], v11 offset:1024
 v_mfma_f32_16x16x32_bf16 v[116:119], v[52:55], a[92:95], v[116:119]
 v_mfma_f32_16x16x32_bf16 v[116:119], v[48:51], a[88:91], v[116:119]
 s_waitcnt lgkmcnt(4)
 v_mfma_f32_16x16x32_bf16 v[124:127], v[56:59], a[88:91], v[124:127]
 v_mfma_f32_16x16x32_bf16 v[124:127], v[60:63], a[92:95], v[124:127]
 v_mfma_f32_16x16x32_bf16 v[120:123], v[60:63], a[84:87], v[120:123]
 v_mfma_f32_16x16x32_bf16 v[120:123], v[56:59], a[80:83], v[120:123]
 s_mov_b32 s5, 44032
 s_waitcnt lgkmcnt(2)
 v_mfma_f32_16x16x32_bf16 v[64:67], v[32:35], a[96:99], v[64:67]
 ds_read_b128 v[48:51], v10 offset:26624
 v_mfma_f32_16x16x32_bf16 v[64:67], v[36:39], a[100:103], v[64:67]
 s_waitcnt lgkmcnt(1)
 ds_read_b128 v[52:55], v10 offset:27648
 v_mfma_f32_16x16x32_bf16 v[64:67], v[40:43], a[112:115], v[64:67]
 s_add_u32 s44, s42, 0
 ds_read_b128 v[56:59], v11 offset:2048
 v_mfma_f32_16x16x32_bf16 v[64:67], v[44:47], a[116:119], v[64:67]
 buffer_load_dwordx4 a[128:131], v24, s[32:35], s44 offen offset:0 sc1
 v_mfma_f32_16x16x32_bf16 v[68:71], v[44:47], a[124:127], v[68:71]
 ds_read_b128 v[60:63], v11 offset:3072
 v_mfma_f32_16x16x32_bf16 v[68:71], v[40:43], a[120:123], v[68:71]
 buffer_load_dwordx4 a[132:135], v25, s[32:35], s44 offen offset:0 sc1
 v_mfma_f32_16x16x32_bf16 v[68:71], v[36:39], a[108:111], v[68:71]
 buffer_load_dwordx4 a[136:139], v26, s[32:35], s44 offen offset:0 sc1
 v_mfma_f32_16x16x32_bf16 v[68:71], v[32:35], a[104:107], v[68:71]
 s_waitcnt lgkmcnt(2)
 v_mfma_f32_16x16x32_bf16 v[76:79], v[48:51], a[104:107], v[76:79]
 ds_read_b128 v[32:35], v10 offset:28672
 v_mfma_f32_16x16x32_bf16 v[76:79], v[52:55], a[108:111], v[76:79]
 s_waitcnt lgkmcnt(1)
 ds_read_b128 v[36:39], v10 offset:29696
 v_mfma_f32_16x16x32_bf16 v[76:79], v[56:59], a[120:123], v[76:79]
 buffer_load_dwordx4 a[140:143], v27, s[32:35], s44 offen offset:0 sc1
 v_mfma_f32_16x16x32_bf16 v[76:79], v[60:63], a[124:127], v[76:79]
 ds_read_b128 v[40:43], v11 offset:4096
 v_mfma_f32_16x16x32_bf16 v[72:75], v[60:63], a[116:119], v[72:75]
 ds_read_b128 v[44:47], v11 offset:5120
 v_mfma_f32_16x16x32_bf16 v[72:75], v[56:59], a[112:115], v[72:75]
 buffer_load_dwordx4 a[144:147], v24, s[32:35], s44 offen offset:1024 sc1
 v_mfma_f32_16x16x32_bf16 v[72:75], v[52:55], a[100:103], v[72:75]
 v_mfma_f32_16x16x32_bf16 v[72:75], v[48:51], a[96:99], v[72:75]
 s_waitcnt lgkmcnt(2)
 v_mfma_f32_16x16x32_bf16 v[80:83], v[32:35], a[96:99], v[80:83]
 buffer_load_dwordx4 a[148:151], v25, s[32:35], s44 offen offset:1024 sc1
 v_mfma_f32_16x16x32_bf16 v[80:83], v[36:39], a[100:103], v[80:83]
 s_waitcnt lgkmcnt(0)
 ds_read_b128 v[48:51], v10 offset:30720
 v_mfma_f32_16x16x32_bf16 v[80:83], v[40:43], a[112:115], v[80:83]
 ds_read_b128 v[52:55], v10 offset:31744
 v_mfma_f32_16x16x32_bf16 v[80:83], v[44:47], a[116:119], v[80:83]
 ds_read_b128 v[56:59], v11 offset:6144
 v_mfma_f32_16x16x32_bf16 v[84:87], v[44:47], a[124:127], v[84:87]
 ds_read_b128 v[60:63], v11 offset:7168
 v_mfma_f32_16x16x32_bf16 v[84:87], v[40:43], a[120:123], v[84:87]
 buffer_load_dwordx4 a[152:155], v26, s[32:35], s44 offen offset:1024 sc1
 v_mfma_f32_16x16x32_bf16 v[84:87], v[36:39], a[108:111], v[84:87]
 buffer_load_dwordx4 a[156:159], v27, s[32:35], s44 offen offset:1024 sc1
 v_mfma_f32_16x16x32_bf16 v[84:87], v[32:35], a[104:107], v[84:87]
 s_waitcnt lgkmcnt(2)
 v_mfma_f32_16x16x32_bf16 v[92:95], v[48:51], a[104:107], v[92:95]
 ds_read_b128 v[32:35], v10 offset:32768
 v_mfma_f32_16x16x32_bf16 v[92:95], v[52:55], a[108:111], v[92:95]
 s_waitcnt lgkmcnt(1)
 ds_read_b128 v[36:39], v10 offset:33792
 v_mfma_f32_16x16x32_bf16 v[92:95], v[56:59], a[120:123], v[92:95]
 ds_read_b128 v[40:43], v11 offset:8192
 v_mfma_f32_16x16x32_bf16 v[92:95], v[60:63], a[124:127], v[92:95]
 ds_read_b128 v[44:47], v11 offset:9216
 v_mfma_f32_16x16x32_bf16 v[88:91], v[60:63], a[116:119], v[88:91]
 v_mfma_f32_16x16x32_bf16 v[88:91], v[56:59], a[112:115], v[88:91]
 v_mfma_f32_16x16x32_bf16 v[88:91], v[52:55], a[100:103], v[88:91]
 v_mfma_f32_16x16x32_bf16 v[88:91], v[48:51], a[96:99], v[88:91]
 s_waitcnt lgkmcnt(2)
 v_mfma_f32_16x16x32_bf16 v[96:99], v[32:35], a[96:99], v[96:99]
 ds_read_b128 v[48:51], v10 offset:34816
 v_mfma_f32_16x16x32_bf16 v[96:99], v[36:39], a[100:103], v[96:99]
 s_waitcnt lgkmcnt(1)
 ds_read_b128 v[52:55], v10 offset:35840
 v_mfma_f32_16x16x32_bf16 v[96:99], v[40:43], a[112:115], v[96:99]
 s_add_u32 s44, s42, 0
 ds_read_b128 v[56:59], v11 offset:10240
 v_mfma_f32_16x16x32_bf16 v[96:99], v[44:47], a[116:119], v[96:99]
 buffer_load_dwordx4 a[160:163], v24, s[32:35], s44 offen offset:2048 sc1
 v_mfma_f32_16x16x32_bf16 v[100:103], v[44:47], a[124:127], v[100:103]
 ds_read_b128 v[60:63], v11 offset:11264
 v_mul_f32 v160, v64, v18
 v_mfma_f32_16x16x32_bf16 v[100:103], v[40:43], a[120:123], v[100:103]
 buffer_load_dwordx4 a[164:167], v25, s[32:35], s44 offen offset:2048 sc1
 v_mfma_f32_16x16x32_bf16 v[100:103], v[36:39], a[108:111], v[100:103]
 buffer_load_dwordx4 a[168:171], v26, s[32:35], s44 offen offset:2048 sc1
 v_mfma_f32_16x16x32_bf16 v[100:103], v[32:35], a[104:107], v[100:103]
 s_waitcnt lgkmcnt(2)
 v_mul_f32 v161, v65, v18
 v_mul_f32 v162, v66, v18
 v_mfma_f32_16x16x32_bf16 v[108:111], v[48:51], a[104:107], v[108:111]
 ds_read_b128 v[32:35], v10 offset:36864
 v_mul_f32 v163, v67, v18
 v_mfma_f32_16x16x32_bf16 v[108:111], v[52:55], a[108:111], v[108:111]
 s_waitcnt lgkmcnt(1)
 v_mul_f32 v164, v80, v18
 v_mul_f32 v165, v81, v18
 v_mfma_f32_16x16x32_bf16 v[108:111], v[56:59], a[120:123], v[108:111]
 ds_read_b128 v[36:39], v10 offset:37888
 v_mul_f32 v166, v82, v18
 v_mfma_f32_16x16x32_bf16 v[108:111], v[60:63], a[124:127], v[108:111]
 ds_read_b128 v[40:43], v11 offset:12288
 v_mul_f32 v167, v83, v18
 v_mfma_f32_16x16x32_bf16 v[104:107], v[60:63], a[116:119], v[104:107]
 ds_read_b128 v[44:47], v11 offset:13312
 v_exp_f32 v160, v160
 v_mfma_f32_16x16x32_bf16 v[104:107], v[56:59], a[112:115], v[104:107]
 buffer_load_dwordx4 a[172:175], v27, s[32:35], s44 offen offset:2048 sc1
 v_mfma_f32_16x16x32_bf16 v[104:107], v[52:55], a[100:103], v[104:107]
 buffer_load_dwordx4 a[176:179], v24, s[32:35], s44 offen offset:3072 sc1
 v_mfma_f32_16x16x32_bf16 v[104:107], v[48:51], a[96:99], v[104:107]
 s_waitcnt lgkmcnt(2)
 v_mul_f32 v64, v64, v72
 v_exp_f32 v161, v161
 v_mfma_f32_16x16x32_bf16 v[112:115], v[32:35], a[96:99], v[112:115]
 ds_read_b128 v[48:51], v10 offset:38912
 v_mul_f32 v65, v65, v73
 v_mfma_f32_16x16x32_bf16 v[112:115], v[36:39], a[100:103], v[112:115]
 s_waitcnt lgkmcnt(1)
 v_exp_f32 v162, v162
 v_mfma_f32_16x16x32_bf16 v[112:115], v[40:43], a[112:115], v[112:115]
 buffer_load_dwordx4 a[180:183], v25, s[32:35], s44 offen offset:3072 sc1
 v_mfma_f32_16x16x32_bf16 v[112:115], v[44:47], a[116:119], v[112:115]
 ds_read_b128 v[52:55], v10 offset:39936
 v_mul_f32 v66, v66, v74
 v_mfma_f32_16x16x32_bf16 v[116:119], v[44:47], a[124:127], v[116:119]
 ds_read_b128 v[56:59], v11 offset:14336
 ds_read_b128 v[60:63], v11 offset:15360
 v_mfma_f32_16x16x32_bf16 v[116:119], v[40:43], a[120:123], v[116:119]
 buffer_load_dwordx4 a[184:187], v26, s[32:35], s44 offen offset:3072 sc1
 v_mfma_f32_16x16x32_bf16 v[116:119], v[36:39], a[108:111], v[116:119]
 v_exp_f32 v163, v163
 v_mul_f32 v67, v67, v75
 v_mfma_f32_16x16x32_bf16 v[116:119], v[32:35], a[104:107], v[116:119]
 s_waitcnt lgkmcnt(2)
 v_exp_f32 v164, v164
 v_mul_f32 v80, v80, v88
 v_mfma_f32_16x16x32_bf16 v[124:127], v[48:51], a[104:107], v[124:127]
 v_exp_f32 v165, v165
 v_mul_f32 v81, v81, v89
 v_mfma_f32_16x16x32_bf16 v[124:127], v[52:55], a[108:111], v[124:127]
 s_waitcnt lgkmcnt(0)
 v_exp_f32 v166, v166
 v_mul_f32 v82, v82, v90
 v_mfma_f32_16x16x32_bf16 v[124:127], v[56:59], a[120:123], v[124:127]
 buffer_load_dwordx4 a[188:191], v27, s[32:35], s44 offen offset:3072 sc1
 v_mfma_f32_16x16x32_bf16 v[124:127], v[60:63], a[124:127], v[124:127]
 v_exp_f32 v167, v167
 v_mfma_f32_16x16x32_bf16 v[120:123], v[60:63], a[116:119], v[120:123]
 v_mul_f32 v83, v83, v91
 v_fma_f32 v160, v160, v16, v16
 v_mfma_f32_16x16x32_bf16 v[120:123], v[56:59], a[112:115], v[120:123]
 v_fma_f32 v161, v161, v16, v16
 v_fma_f32 v162, v162, v16, v16
 v_mfma_f32_16x16x32_bf16 v[120:123], v[52:55], a[100:103], v[120:123]
 v_fma_f32 v163, v163, v16, v16
 v_fma_f32 v164, v164, v16, v16
 v_mfma_f32_16x16x32_bf16 v[120:123], v[48:51], a[96:99], v[120:123]
 v_fma_f32 v165, v165, v16, v16
 v_fma_f32 v166, v166, v16, v16
 v_fma_f32 v167, v167, v16, v16
 v_rcp_f32 v160, v160
 v_rcp_f32 v161, v161
 v_rcp_f32 v162, v162
 v_rcp_f32 v163, v163
 v_rcp_f32 v164, v164
 v_rcp_f32 v165, v165
 v_rcp_f32 v166, v166
 v_rcp_f32 v167, v167
 v_mul_f32 v64, v64, v160
 v_mul_f32 v65, v65, v161
 v_mul_f32 v66, v66, v162
 v_mul_f32 v67, v67, v163
 v_mul_f32 v80, v80, v164
 v_mul_f32 v81, v81, v165
 v_mul_f32 v82, v82, v166
 v_mul_f32 v83, v83, v167
 v_cvt_pk_bf16_f32 v168, v64, v65
 v_cvt_pk_bf16_f32 v169, v66, v67
 v_cvt_pk_bf16_f32 v170, v80, v81
 v_cvt_pk_bf16_f32 v171, v82, v83
 buffer_store_dwordx4 v[168:171], v2, s[24:27], 0 offen offset:0 sc1
 v_mul_f32 v176, v68, v19
 v_mul_f32 v177, v69, v19
 v_mul_f32 v178, v70, v19
 v_mul_f32 v179, v71, v19
 v_mul_f32 v180, v84, v19
 v_mul_f32 v181, v85, v19
 v_mul_f32 v182, v86, v19
 v_mul_f32 v183, v87, v19
 v_exp_f32 v176, v176
 v_mul_f32 v68, v68, v76
 v_exp_f32 v177, v177
 v_mul_f32 v69, v69, v77
 v_exp_f32 v178, v178
 v_mul_f32 v70, v70, v78
 v_exp_f32 v179, v179
 v_mul_f32 v71, v71, v79
 v_exp_f32 v180, v180
 v_mul_f32 v84, v84, v92
 v_exp_f32 v181, v181
 v_mul_f32 v85, v85, v93
 v_exp_f32 v182, v182
 v_mul_f32 v86, v86, v94
 v_exp_f32 v183, v183
 v_mul_f32 v87, v87, v95
 v_fma_f32 v176, v176, v17, v17
 v_fma_f32 v177, v177, v17, v17
 v_fma_f32 v178, v178, v17, v17
 v_fma_f32 v179, v179, v17, v17
 v_fma_f32 v180, v180, v17, v17
 v_fma_f32 v181, v181, v17, v17
 v_fma_f32 v182, v182, v17, v17
 v_fma_f32 v183, v183, v17, v17
 v_rcp_f32 v176, v176
 v_rcp_f32 v177, v177
 v_rcp_f32 v178, v178
 v_rcp_f32 v179, v179
 v_rcp_f32 v180, v180
 v_rcp_f32 v181, v181
 v_rcp_f32 v182, v182
 v_rcp_f32 v183, v183
 v_mul_f32 v68, v68, v176
 v_mul_f32 v69, v69, v177
 v_mul_f32 v70, v70, v178
 v_mul_f32 v71, v71, v179
 v_mul_f32 v84, v84, v180
 v_mul_f32 v85, v85, v181
 v_mul_f32 v86, v86, v182
 v_mul_f32 v87, v87, v183
 v_cvt_pk_bf16_f32 v184, v68, v69
 v_cvt_pk_bf16_f32 v185, v70, v71
 v_cvt_pk_bf16_f32 v186, v84, v85
 v_cvt_pk_bf16_f32 v187, v86, v87
 buffer_store_dwordx4 v[184:187], v2, s[24:27], s5 offen offset:0 sc1
 v_mul_f32 v160, v96, v18
 v_mul_f32 v161, v97, v18
 v_mul_f32 v162, v98, v18
 v_mul_f32 v163, v99, v18
 v_mul_f32 v164, v112, v18
 v_mul_f32 v165, v113, v18
 v_mul_f32 v166, v114, v18
 v_mul_f32 v167, v115, v18
 v_exp_f32 v160, v160
 v_mul_f32 v96, v96, v104
 v_exp_f32 v161, v161
 v_mul_f32 v97, v97, v105
 v_exp_f32 v162, v162
 v_mul_f32 v98, v98, v106
 v_exp_f32 v163, v163
 v_mul_f32 v99, v99, v107
 v_exp_f32 v164, v164
 v_mul_f32 v112, v112, v120
 v_exp_f32 v165, v165
 v_mul_f32 v113, v113, v121
 v_exp_f32 v166, v166
 v_mul_f32 v114, v114, v122
 v_exp_f32 v167, v167
 v_mul_f32 v115, v115, v123
 v_fma_f32 v160, v160, v16, v16
 v_fma_f32 v161, v161, v16, v16
 v_fma_f32 v162, v162, v16, v16
 v_fma_f32 v163, v163, v16, v16
 v_fma_f32 v164, v164, v16, v16
 v_fma_f32 v165, v165, v16, v16
 v_fma_f32 v166, v166, v16, v16
 v_fma_f32 v167, v167, v16, v16
 v_rcp_f32 v160, v160
 v_rcp_f32 v161, v161
 v_rcp_f32 v162, v162
 v_rcp_f32 v163, v163
 v_rcp_f32 v164, v164
 v_rcp_f32 v165, v165
 v_rcp_f32 v166, v166
 v_rcp_f32 v167, v167
 v_mul_f32 v96, v96, v160
 v_mul_f32 v97, v97, v161
 v_mul_f32 v98, v98, v162
 v_mul_f32 v99, v99, v163
 v_mul_f32 v112, v112, v164
 v_mul_f32 v113, v113, v165
 v_mul_f32 v114, v114, v166
 v_mul_f32 v115, v115, v167
 v_cvt_pk_bf16_f32 v168, v96, v97
 v_cvt_pk_bf16_f32 v169, v98, v99
 v_cvt_pk_bf16_f32 v170, v112, v113
 v_cvt_pk_bf16_f32 v171, v114, v115
 buffer_store_dwordx4 v[168:171], v2, s[24:27], 0 offen offset:1024 sc1
 v_mul_f32 v176, v100, v19
 v_mul_f32 v177, v101, v19
 v_mul_f32 v178, v102, v19
 v_mul_f32 v179, v103, v19
 v_mul_f32 v180, v116, v19
 v_mul_f32 v181, v117, v19
 v_mul_f32 v182, v118, v19
 v_mul_f32 v183, v119, v19
 v_exp_f32 v176, v176
 v_mul_f32 v100, v100, v108
 v_exp_f32 v177, v177
 v_mul_f32 v101, v101, v109
 v_exp_f32 v178, v178
 v_mul_f32 v102, v102, v110
 v_exp_f32 v179, v179
 v_mul_f32 v103, v103, v111
 v_exp_f32 v180, v180
 v_mul_f32 v116, v116, v124
 v_exp_f32 v181, v181
 v_mul_f32 v117, v117, v125
 v_exp_f32 v182, v182
 v_mul_f32 v118, v118, v126
 v_exp_f32 v183, v183
 v_mul_f32 v119, v119, v127
 v_fma_f32 v176, v176, v17, v17
 v_fma_f32 v177, v177, v17, v17
 v_fma_f32 v178, v178, v17, v17
 v_fma_f32 v179, v179, v17, v17
 v_fma_f32 v180, v180, v17, v17
 v_fma_f32 v181, v181, v17, v17
 v_fma_f32 v182, v182, v17, v17
 v_fma_f32 v183, v183, v17, v17
 v_rcp_f32 v176, v176
 v_rcp_f32 v177, v177
 v_rcp_f32 v178, v178
 v_rcp_f32 v179, v179
 v_rcp_f32 v180, v180
 v_rcp_f32 v181, v181
 v_rcp_f32 v182, v182
 v_rcp_f32 v183, v183
 v_mul_f32 v100, v100, v176
 v_mul_f32 v101, v101, v177
 v_mul_f32 v102, v102, v178
 v_mul_f32 v103, v103, v179
 v_mul_f32 v116, v116, v180
 v_mul_f32 v117, v117, v181
 v_mul_f32 v118, v118, v182
 v_mul_f32 v119, v119, v183
 v_cvt_pk_bf16_f32 v184, v100, v101
 v_cvt_pk_bf16_f32 v185, v102, v103
 v_cvt_pk_bf16_f32 v186, v116, v117
 v_cvt_pk_bf16_f32 v187, v118, v119
 buffer_store_dwordx4 v[184:187], v2, s[24:27], s5 offen offset:1024 sc1
L_gj_259:
 s_add_u32 s44, s42, 4096
 buffer_load_dwordx4 a[192:195], v24, s[32:35], s44 offen offset:0 sc1
 buffer_load_dwordx4 a[196:199], v25, s[32:35], s44 offen offset:0 sc1
 buffer_load_dwordx4 a[200:203], v26, s[32:35], s44 offen offset:0 sc1
 buffer_load_dwordx4 a[204:207], v27, s[32:35], s44 offen offset:0 sc1
 buffer_load_dwordx4 a[208:211], v24, s[32:35], s44 offen offset:1024 sc1
 buffer_load_dwordx4 a[212:215], v25, s[32:35], s44 offen offset:1024 sc1
 buffer_load_dwordx4 a[216:219], v26, s[32:35], s44 offen offset:1024 sc1
 buffer_load_dwordx4 a[220:223], v27, s[32:35], s44 offen offset:1024 sc1
 buffer_load_dwordx4 a[224:227], v24, s[32:35], s44 offen offset:2048 sc1
 buffer_load_dwordx4 a[228:231], v25, s[32:35], s44 offen offset:2048 sc1
 buffer_load_dwordx4 a[232:235], v26, s[32:35], s44 offen offset:2048 sc1
 buffer_load_dwordx4 a[236:239], v27, s[32:35], s44 offen offset:2048 sc1
 s_waitcnt vmcnt(12)
 s_barrier
 s_cmp_eq_u32 s3, 0
 s_cbranch_scc0 L_pub_264
 s_mul_i32 s4, s2, 128
 s_add_u32 s4, s4, 131072
 v_lshl_add_u32 v2, v0, 2, s4
 v_mov_b32 v3, s100
 s_mov_b64 exec, 0xffffffff
 buffer_store_dword v3, v2, s[96:99], 0 offen sc1
 s_mov_b64 exec, -1
L_pub_264:
 v_lshrrev_b32 v12, 2, v0
 v_and_b32 v13, 1, v0
 v_bfe_u32 v14, v0, 1, 1
 v_lshlrev_b32 v15, 4, v12
 v_mul_u32_u24 v13, 640, v13
 v_mul_u32_u24 v14, 1344, v14
 v_add3_u32 v15, v15, v13, v14
 s_mul_i32 s4, s3, 5376
 v_add_u32 v15, s4, v15
 v_and_b32 v13, 3, v0
 v_lshlrev_b32 v13, 4, v13
 v_lshl_add_u32 v14, v12, 10, v13
 s_lshr_b32 s4, s40, 3
 s_bfe_u32 s5, s40, 0x20001
 s_lshl_b32 s5, s5, 3
 s_add_u32 s4, s4, s5
 s_lshl_b32 s4, s4, 7
 s_add_u32 s4, s4, 131072
 v_and_b32 v12, 7, v0
 v_lshlrev_b32 v12, 12, v12
 v_and_b32 v13, 8, v0
 v_lshl_add_u32 v12, v13, 6, v12
 v_add_u32 v12, s4, v12
 s_add_u32 s44, s42, 4096
 buffer_load_dwordx4 a[240:243], v24, s[32:35], s44 offen offset:3072 sc1
 buffer_load_dwordx4 a[244:247], v25, s[32:35], s44 offen offset:3072 sc1
 buffer_load_dwordx4 a[248:251], v26, s[32:35], s44 offen offset:3072 sc1
 buffer_load_dwordx4 a[252:255], v27, s[32:35], s44 offen offset:3072 sc1
 s_add_u32 s44, s42, 8192
 buffer_load_dwordx4 a[0:3], v24, s[32:35], s44 offen offset:0 sc1
 buffer_load_dwordx4 a[4:7], v25, s[32:35], s44 offen offset:0 sc1
 buffer_load_dwordx4 a[8:11], v26, s[32:35], s44 offen offset:0 sc1
 buffer_load_dwordx4 a[12:15], v27, s[32:35], s44 offen offset:0 sc1
 buffer_load_dwordx4 a[16:19], v24, s[32:35], s44 offen offset:1024 sc1
 buffer_load_dwordx4 a[20:23], v25, s[32:35], s44 offen offset:1024 sc1
 buffer_load_dwordx4 a[24:27], v26, s[32:35], s44 offen offset:1024 sc1
 buffer_load_dwordx4 a[28:31], v27, s[32:35], s44 offen offset:1024 sc1
 buffer_load_dwordx4 a[32:35], v24, s[32:35], s43 offen offset:2048 sc1
 buffer_load_dwordx4 a[36:39], v25, s[32:35], s43 offen offset:2048 sc1
 buffer_load_dwordx4 a[40:43], v26, s[32:35], s43 offen offset:2048 sc1
 buffer_load_dwordx4 a[44:47], v27, s[32:35], s43 offen offset:2048 sc1
 v_and_b32 v11, 15, v0
 v_lshlrev_b32 v11, 4, v11
 v_lshrrev_b32 v3, 4, v0
 v_mul_u32_u24 v3, 320, v3
 v_add_u32 v11, v11, v3
 s_mul_i32 s4, s3, 21504
 v_add_u32 v11, s4, v11
 s_mul_i32 s4, s3, 16128
 s_sub_u32 s4, 86016, s4
 v_add_u32 v10, s4, v11
 v_lshlrev_b32 v16, 16, v224
 v_and_b32 v17, 0xffff0000, v224
 v_lshlrev_b32 v18, 16, v225
 v_and_b32 v19, 0xffff0000, v225
 ds_write_b128 v10, v[16:19] offset:0
 v_lshlrev_b32 v20, 16, v226
 v_and_b32 v21, 0xffff0000, v226
 v_lshlrev_b32 v22, 16, v227
 v_and_b32 v23, 0xffff0000, v227
 ds_write_b128 v10, v[20:23] offset:1344
 s_waitcnt lgkmcnt(0)
 v_lshlrev_b32 v16, 16, v228
 v_and_b32 v17, 0xffff0000, v228
 v_lshlrev_b32 v18, 16, v229
 v_and_b32 v19, 0xffff0000, v229
 ds_write_b128 v10, v[16:19] offset:2688
 v_lshlrev_b32 v20, 16, v230
 v_and_b32 v21, 0xffff0000, v230
 v_lshlrev_b32 v22, 16, v231
 v_and_b32 v23, 0xffff0000, v231
 ds_write_b128 v10, v[20:23] offset:4032
 s_waitcnt lgkmcnt(0)
 s_mov_b32 s101, 0x40000
L_spin_265:
 buffer_load_dword v13, v12, s[96:99], 0 offen sc1
 s_waitcnt vmcnt(0)
 v_cmp_ne_u32 vcc, s100, v13
 s_nop 0
 s_cbranch_vccz L_ok_266
 s_sleep 1
 s_sub_u32 s101, s101, 1
 s_cmp_lg_u32 s101, 0
 s_cbranch_scc1 L_spin_265
L_ok_266:
 s_add_u32 s44, s42, 0
 buffer_load_dwordx4 v[32:35], v24, s[28:31], s44 offen offset:0 sc1
 buffer_load_dwordx4 v[36:39], v25, s[28:31], s44 offen offset:0 sc1
 buffer_load_dwordx4 v[40:43], v26, s[28:31], s44 offen offset:0 sc1
 buffer_load_dwordx4 v[44:47], v27, s[28:31], s44 offen offset:0 sc1
 buffer_load_dwordx4 v[48:51], v24, s[28:31], s44 offen offset:1024 sc1
 buffer_load_dwordx4 v[52:55], v25, s[28:31], s44 offen offset:1024 sc1
 buffer_load_dwordx4 v[56:59], v26, s[28:31], s44 offen offset:1024 sc1
 buffer_load_dwordx4 v[60:63], v27, s[28:31], s44 offen offset:1024 sc1
 buffer_load_dwordx4 v[64:67], v24, s[28:31], s44 offen offset:2048 sc1
 buffer_load_dwordx4 v[68:71], v25, s[28:31], s44 offen offset:2048 sc1
 buffer_load_dwordx4 v[72:75], v26, s[28:31], s44 offen offset:2048 sc1
 buffer_load_dwordx4 v[76:79], v27, s[28:31], s44 offen offset:2048 sc1
 s_waitcnt vmcnt(8)
 v_mfma_f32_16x16x32_bf16 v[128:131], a[128:131], v[32:35], 0
 v_add_u32 v13, 43008, v15
 v_mfma_f32_16x16x32_bf16 v[144:147], a[128:131], v[36:39], 0
 s_add_u32 s44, s42, 0
 v_mfma_f32_16x16x32_bf16 v[160:163], a[128:131], v[40:43], 0
 buffer_load_dwordx4 v[80:83], v24, s[28:31], s44 offen offset:3072 sc1
 v_mfma_f32_16x16x32_bf16 v[176:179], a[128:131], v[44:47], 0
 buffer_load_dwordx4 v[84:87], v25, s[28:31], s44 offen offset:3072 sc1
 v_mfma_f32_16x16x32_bf16 v[180:183], a[132:135], v[44:47], 0
 buffer_load_dwordx4 v[88:91], v26, s[28:31], s44 offen offset:3072 sc1
 v_mfma_f32_16x16x32_bf16 v[164:167], a[132:135], v[40:43], 0
 v_mfma_f32_16x16x32_bf16 v[148:151], a[132:135], v[36:39], 0
 v_mfma_f32_16x16x32_bf16 v[132:135], a[132:135], v[32:35], 0
 buffer_load_dwordx4 v[92:95], v27, s[28:31], s44 offen offset:3072 sc1
 v_mfma_f32_16x16x32_bf16 v[136:139], a[136:139], v[32:35], 0
 v_mfma_f32_16x16x32_bf16 v[152:155], a[136:139], v[36:39], 0
 v_mfma_f32_16x16x32_bf16 v[168:171], a[136:139], v[40:43], 0
 v_add_u32 v12, 86016, v15
 v_mfma_f32_16x16x32_bf16 v[184:187], a[136:139], v[44:47], 0
 v_mfma_f32_16x16x32_bf16 v[188:191], a[140:143], v[44:47], 0
 v_mfma_f32_16x16x32_bf16 v[172:175], a[140:143], v[40:43], 0
 v_mfma_f32_16x16x32_bf16 v[156:159], a[140:143], v[36:39], 0
 v_mfma_f32_16x16x32_bf16 v[140:143], a[140:143], v[32:35], 0
 s_waitcnt vmcnt(4)
 v_mfma_f32_16x16x32_bf16 v[128:131], a[144:147], v[48:51], v[128:131]
 s_add_u32 s44, s42, 4096
 v_mfma_f32_16x16x32_bf16 v[128:131], a[160:163], v[64:67], v[128:131]
 buffer_load_dwordx4 v[96:99], v24, s[28:31], s44 offen offset:0 sc1
 v_mfma_f32_16x16x32_bf16 v[144:147], a[160:163], v[68:71], v[144:147]
 buffer_load_dwordx4 v[100:103], v25, s[28:31], s44 offen offset:0 sc1
 v_mfma_f32_16x16x32_bf16 v[144:147], a[144:147], v[52:55], v[144:147]
 buffer_load_dwordx4 v[104:107], v26, s[28:31], s44 offen offset:0 sc1
 v_mfma_f32_16x16x32_bf16 v[160:163], a[144:147], v[56:59], v[160:163]
 buffer_load_dwordx4 v[108:111], v27, s[28:31], s44 offen offset:0 sc1
 v_mfma_f32_16x16x32_bf16 v[160:163], a[160:163], v[72:75], v[160:163]
 v_mfma_f32_16x16x32_bf16 v[176:179], a[160:163], v[76:79], v[176:179]
 buffer_load_dwordx4 v[112:115], v24, s[28:31], s44 offen offset:1024 sc1
 v_mfma_f32_16x16x32_bf16 v[176:179], a[144:147], v[60:63], v[176:179]
 v_mfma_f32_16x16x32_bf16 v[180:183], a[148:151], v[60:63], v[180:183]
 v_mfma_f32_16x16x32_bf16 v[180:183], a[164:167], v[76:79], v[180:183]
 buffer_load_dwordx4 v[116:119], v25, s[28:31], s44 offen offset:1024 sc1
 v_mfma_f32_16x16x32_bf16 v[164:167], a[164:167], v[72:75], v[164:167]
 v_mfma_f32_16x16x32_bf16 v[164:167], a[148:151], v[56:59], v[164:167]
 buffer_load_dwordx4 v[120:123], v26, s[28:31], s44 offen offset:1024 sc1
 v_mfma_f32_16x16x32_bf16 v[148:151], a[148:151], v[52:55], v[148:151]
 v_mfma_f32_16x16x32_bf16 v[148:151], a[164:167], v[68:71], v[148:151]
 v_mfma_f32_16x16x32_bf16 v[132:135], a[164:167], v[64:67], v[132:135]
 buffer_load_dwordx4 v[124:127], v27, s[28:31], s44 offen offset:1024 sc1
 v_mfma_f32_16x16x32_bf16 v[132:135], a[148:151], v[48:51], v[132:135]
 v_mfma_f32_16x16x32_bf16 v[136:139], a[152:155], v[48:51], v[136:139]
 buffer_load_dwordx4 a[48:51], v24, s[28:31], s44 offen offset:2048 sc1
 v_mfma_f32_16x16x32_bf16 v[136:139], a[168:171], v[64:67], v[136:139]
 v_mfma_f32_16x16x32_bf16 v[152:155], a[168:171], v[68:71], v[152:155]
 buffer_load_dwordx4 a[52:55], v25, s[28:31], s44 offen offset:2048 sc1
 v_mfma_f32_16x16x32_bf16 v[152:155], a[152:155], v[52:55], v[152:155]
 v_mfma_f32_16x16x32_bf16 v[168:171], a[152:155], v[56:59], v[168:171]
 v_mfma_f32_16x16x32_bf16 v[168:171], a[168:171], v[72:75], v[168:171]
 buffer_load_dwordx4 a[56:59], v26, s[28:31], s44 offen offset:2048 sc1
 v_mfma_f32_16x16x32_bf16 v[184:187], a[168:171], v[76:79], v[184:187]
 v_mfma_f32_16x16x32_bf16 v[184:187], a[152:155], v[60:63], v[184:187]
 buffer_load_dwordx4 a[60:63], v27, s[28:31], s44 offen offset:2048 sc1
 v_mfma_f32_16x16x32_bf16 v[188:191], a[156:159], v[60:63], v[188:191]
 v_mfma_f32_16x16x32_bf16 v[188:191], a[172:175], v[76:79], v[188:191]
 v_mfma_f32_16x16x32_bf16 v[172:175], a[172:175], v[72:75], v[172:175]
 v_mfma_f32_16x16x32_bf16 v[172:175], a[156:159], v[56:59], v[172:175]
 v_mfma_f32_16x16x32_bf16 v[156:159], a[156:159], v[52:55], v[156:159]
 v_mfma_f32_16x16x32_bf16 v[156:159], a[172:175], v[68:71], v[156:159]
 v_mfma_f32_16x16x32_bf16 v[140:143], a[172:175], v[64:67], v[140:143]
 v_mfma_f32_16x16x32_bf16 v[140:143], a[156:159], v[48:51], v[140:143]
 s_waitcnt vmcnt(8)
 v_mfma_f32_16x16x32_bf16 v[128:131], a[176:179], v[80:83], v[128:131]
 s_add_u32 s44, s42, 4096
 v_mfma_f32_16x16x32_bf16 v[128:131], a[192:195], v[96:99], v[128:131]
 buffer_load_dwordx4 a[64:67], v24, s[28:31], s44 offen offset:3072 sc1
 v_mfma_f32_16x16x32_bf16 v[144:147], a[192:195], v[100:103], v[144:147]
 buffer_load_dwordx4 a[68:71], v25, s[28:31], s44 offen offset:3072 sc1
 v_mfma_f32_16x16x32_bf16 v[144:147], a[176:179], v[84:87], v[144:147]
 v_mfma_f32_16x16x32_bf16 v[160:163], a[176:179], v[88:91], v[160:163]
 v_mfma_f32_16x16x32_bf16 v[160:163], a[192:195], v[104:107], v[160:163]
 v_mfma_f32_16x16x32_bf16 v[176:179], a[192:195], v[108:111], v[176:179]
 v_mfma_f32_16x16x32_bf16 v[176:179], a[176:179], v[92:95], v[176:179]
 v_mfma_f32_16x16x32_bf16 v[180:183], a[180:183], v[92:95], v[180:183]
 v_mfma_f32_16x16x32_bf16 v[180:183], a[196:199], v[108:111], v[180:183]
 v_mfma_f32_16x16x32_bf16 v[164:167], a[196:199], v[104:107], v[164:167]
 v_mfma_f32_16x16x32_bf16 v[164:167], a[180:183], v[88:91], v[164:167]
 v_mfma_f32_16x16x32_bf16 v[148:151], a[180:183], v[84:87], v[148:151]
 v_mfma_f32_16x16x32_bf16 v[148:151], a[196:199], v[100:103], v[148:151]
 v_mfma_f32_16x16x32_bf16 v[132:135], a[196:199], v[96:99], v[132:135]
 v_mfma_f32_16x16x32_bf16 v[132:135], a[180:183], v[80:83], v[132:135]
 v_mfma_f32_16x16x32_bf16 v[136:139], a[184:187], v[80:83], v[136:139]
 buffer_load_dwordx4 a[72:75], v26, s[28:31], s44 offen offset:3072 sc1
 v_mfma_f32_16x16x32_bf16 v[136:139], a[200:203], v[96:99], v[136:139]
 buffer_load_dwordx4 a[76:79], v27, s[28:31], s44 offen offset:3072 sc1
 v_mfma_f32_16x16x32_bf16 v[152:155], a[200:203], v[100:103], v[152:155]
 s_add_u32 s44, s42, 8192
 v_mfma_f32_16x16x32_bf16 v[152:155], a[184:187], v[84:87], v[152:155]
 buffer_load_dwordx4 a[80:83], v24, s[28:31], s44 offen offset:0 sc1
 v_mfma_f32_16x16x32_bf16 v[168:171], a[184:187], v[88:91], v[168:171]
 buffer_load_dwordx4 a[84:87], v25, s[28:31], s44 offen offset:0 sc1
 v_mfma_f32_16x16x32_bf16 v[168:171], a[200:203], v[104:107], v[168:171]
 buffer_load_dwordx4 a[88:91], v26, s[28:31], s44 offen offset:0 sc1
 v_mfma_f32_16x16x32_bf16 v[184:187], a[200:203], v[108:111], v[184:187]
 buffer_load_dwordx4 a[92:95], v27, s[28:31], s44 offen offset:0 sc1
 v_mfma_f32_16x16x32_bf16 v[184:187], a[184:187], v[92:95], v[184:187]
 v_mfma_f32_16x16x32_bf16 v[188:191], a[188:191], v[92:95], v[188:191]
 v_mfma_f32_16x16x32_bf16 v[188:191], a[204:207], v[108:111], v[188:191]
 v_mfma_f32_16x16x32_bf16 v[172:175], a[204:207], v[104:107], v[172:175]
 v_mfma_f32_16x16x32_bf16 v[172:175], a[188:191], v[88:91], v[172:175]
 v_mfma_f32_16x16x32_bf16 v[156:159], a[188:191], v[84:87], v[156:159]
 v_mfma_f32_16x16x32_bf16 v[156:159], a[204:207], v[100:103], v[156:159]
 v_mfma_f32_16x16x32_bf16 v[140:143], a[204:207], v[96:99], v[140:143]
 v_mfma_f32_16x16x32_bf16 v[140:143], a[188:191], v[80:83], v[140:143]
 s_waitcnt vmcnt(8)
 v_mfma_f32_16x16x32_bf16 v[128:131], a[208:211], v[112:115], v[128:131]
 s_add_u32 s44, s42, 8192
 v_mfma_f32_16x16x32_bf16 v[128:131], a[224:227], a[48:51], v[128:131]
 buffer_load_dwordx4 a[96:99], v24, s[28:31], s44 offen offset:1024 sc1
 v_mfma_f32_16x16x32_bf16 v[144:147], a[224:227], a[52:55], v[144:147]
 buffer_load_dwordx4 a[100:103], v25, s[28:31], s44 offen offset:1024 sc1
 v_mfma_f32_16x16x32_bf16 v[144:147], a[208:211], v[116:119], v[144:147]
 v_mfma_f32_16x16x32_bf16 v[160:163], a[208:211], v[120:123], v[160:163]
 v_mfma_f32_16x16x32_bf16 v[160:163], a[224:227], a[56:59], v[160:163]
 buffer_load_dwordx4 a[104:107], v26, s[28:31], s44 offen offset:1024 sc1
 v_mfma_f32_16x16x32_bf16 v[176:179], a[224:227], a[60:63], v[176:179]
 v_mfma_f32_16x16x32_bf16 v[176:179], a[208:211], v[124:127], v[176:179]
 v_mfma_f32_16x16x32_bf16 v[180:183], a[212:215], v[124:127], v[180:183]
 buffer_load_dwordx4 a[108:111], v27, s[28:31], s44 offen offset:1024 sc1
 v_mfma_f32_16x16x32_bf16 v[180:183], a[228:231], a[60:63], v[180:183]
 v_mfma_f32_16x16x32_bf16 v[164:167], a[228:231], a[56:59], v[164:167]
 v_mfma_f32_16x16x32_bf16 v[164:167], a[212:215], v[120:123], v[164:167]
 v_mfma_f32_16x16x32_bf16 v[148:151], a[212:215], v[116:119], v[148:151]
 buffer_load_dwordx4 a[112:115], v24, s[28:31], s44 offen offset:2048 sc1
 v_mfma_f32_16x16x32_bf16 v[148:151], a[228:231], a[52:55], v[148:151]
 v_mfma_f32_16x16x32_bf16 v[132:135], a[228:231], a[48:51], v[132:135]
 v_mfma_f32_16x16x32_bf16 v[132:135], a[212:215], v[112:115], v[132:135]
 v_mfma_f32_16x16x32_bf16 v[136:139], a[216:219], v[112:115], v[136:139]
 v_mfma_f32_16x16x32_bf16 v[136:139], a[232:235], a[48:51], v[136:139]
 v_mfma_f32_16x16x32_bf16 v[152:155], a[232:235], a[52:55], v[152:155]
 buffer_load_dwordx4 a[116:119], v25, s[28:31], s44 offen offset:2048 sc1
 v_mfma_f32_16x16x32_bf16 v[152:155], a[216:219], v[116:119], v[152:155]
 buffer_load_dwordx4 a[120:123], v26, s[28:31], s44 offen offset:2048 sc1
 v_mfma_f32_16x16x32_bf16 v[168:171], a[216:219], v[120:123], v[168:171]
 v_mfma_f32_16x16x32_bf16 v[168:171], a[232:235], a[56:59], v[168:171]
 v_mfma_f32_16x16x32_bf16 v[184:187], a[232:235], a[60:63], v[184:187]
 buffer_load_dwordx4 a[124:127], v27, s[28:31], s44 offen offset:2048 sc1
 v_mfma_f32_16x16x32_bf16 v[184:187], a[216:219], v[124:127], v[184:187]
 v_mfma_f32_16x16x32_bf16 v[188:191], a[220:223], v[124:127], v[188:191]
 v_mfma_f32_16x16x32_bf16 v[188:191], a[236:239], a[60:63], v[188:191]
 v_mfma_f32_16x16x32_bf16 v[172:175], a[236:239], a[56:59], v[172:175]
 v_mfma_f32_16x16x32_bf16 v[172:175], a[220:223], v[120:123], v[172:175]
 v_mfma_f32_16x16x32_bf16 v[156:159], a[220:223], v[116:119], v[156:159]
 v_mfma_f32_16x16x32_bf16 v[156:159], a[236:239], a[52:55], v[156:159]
 v_mfma_f32_16x16x32_bf16 v[140:143], a[236:239], a[48:51], v[140:143]
 v_mfma_f32_16x16x32_bf16 v[140:143], a[220:223], v[112:115], v[140:143]
 s_waitcnt vmcnt(8)
 v_mfma_f32_16x16x32_bf16 v[128:131], a[240:243], a[64:67], v[128:131]
 v_mfma_f32_16x16x32_bf16 v[128:131], a[0:3], a[80:83], v[128:131]
 v_mfma_f32_16x16x32_bf16 v[144:147], a[0:3], a[84:87], v[144:147]
 v_mfma_f32_16x16x32_bf16 v[144:147], a[240:243], a[68:71], v[144:147]
 v_mfma_f32_16x16x32_bf16 v[160:163], a[240:243], a[72:75], v[160:163]
 v_mfma_f32_16x16x32_bf16 v[160:163], a[0:3], a[88:91], v[160:163]
 v_mfma_f32_16x16x32_bf16 v[176:179], a[0:3], a[92:95], v[176:179]
 v_mfma_f32_16x16x32_bf16 v[176:179], a[240:243], a[76:79], v[176:179]
 v_mfma_f32_16x16x32_bf16 v[180:183], a[244:247], a[76:79], v[180:183]
 v_mfma_f32_16x16x32_bf16 v[180:183], a[4:7], a[92:95], v[180:183]
 v_mfma_f32_16x16x32_bf16 v[164:167], a[4:7], a[88:91], v[164:167]
 v_mfma_f32_16x16x32_bf16 v[164:167], a[244:247], a[72:75], v[164:167]
 v_mfma_f32_16x16x32_bf16 v[148:151], a[244:247], a[68:71], v[148:151]
 v_mfma_f32_16x16x32_bf16 v[148:151], a[4:7], a[84:87], v[148:151]
 v_mfma_f32_16x16x32_bf16 v[132:135], a[4:7], a[80:83], v[132:135]
 v_mfma_f32_16x16x32_bf16 v[132:135], a[244:247], a[64:67], v[132:135]
 v_mfma_f32_16x16x32_bf16 v[136:139], a[248:251], a[64:67], v[136:139]
 v_mfma_f32_16x16x32_bf16 v[136:139], a[8:11], a[80:83], v[136:139]
 v_mfma_f32_16x16x32_bf16 v[152:155], a[8:11], a[84:87], v[152:155]
 v_mfma_f32_16x16x32_bf16 v[152:155], a[248:251], a[68:71], v[152:155]
 v_mfma_f32_16x16x32_bf16 v[168:171], a[248:251], a[72:75], v[168:171]
 v_mfma_f32_16x16x32_bf16 v[168:171], a[8:11], a[88:91], v[168:171]
 v_mfma_f32_16x16x32_bf16 v[184:187], a[8:11], a[92:95], v[184:187]
 v_mfma_f32_16x16x32_bf16 v[184:187], a[248:251], a[76:79], v[184:187]
 v_mfma_f32_16x16x32_bf16 v[188:191], a[252:255], a[76:79], v[188:191]
 v_mfma_f32_16x16x32_bf16 v[188:191], a[12:15], a[92:95], v[188:191]
 v_mfma_f32_16x16x32_bf16 v[172:175], a[12:15], a[88:91], v[172:175]
 v_mfma_f32_16x16x32_bf16 v[172:175], a[252:255], a[72:75], v[172:175]
 v_mfma_f32_16x16x32_bf16 v[156:159], a[252:255], a[68:71], v[156:159]
 v_mfma_f32_16x16x32_bf16 v[156:159], a[12:15], a[84:87], v[156:159]
 v_mfma_f32_16x16x32_bf16 v[140:143], a[12:15], a[80:83], v[140:143]
 v_mfma_f32_16x16x32_bf16 v[140:143], a[252:255], a[64:67], v[140:143]
 s_waitcnt vmcnt(0)
 v_mfma_f32_16x16x32_bf16 v[128:131], a[16:19], a[96:99], v[128:131]
 v_mfma_f32_16x16x32_bf16 v[128:131], a[32:35], a[112:115], v[128:131]
 v_mfma_f32_16x16x32_bf16 v[144:147], a[32:35], a[116:119], v[144:147]
 v_mfma_f32_16x16x32_bf16 v[144:147], a[16:19], a[100:103], v[144:147]
 v_mfma_f32_16x16x32_bf16 v[160:163], a[16:19], a[104:107], v[160:163]
 v_mfma_f32_16x16x32_bf16 v[160:163], a[32:35], a[120:123], v[160:163]
 v_mfma_f32_16x16x32_bf16 v[176:179], a[32:35], a[124:127], v[176:179]
 s_nop 2
 ds_write_b128 v11, v[128:131] offset:0
 v_mfma_f32_16x16x32_bf16 v[176:179], a[16:19], a[108:111], v[176:179]
 v_mfma_f32_16x16x32_bf16 v[180:183], a[20:23], a[108:111], v[180:183]
 ds_write_b128 v11, v[144:147] offset:5376
 v_mfma_f32_16x16x32_bf16 v[180:183], a[36:39], a[124:127], v[180:183]
 v_mfma_f32_16x16x32_bf16 v[164:167], a[36:39], a[120:123], v[164:167]
 ds_write_b128 v11, v[160:163] offset:10752
 v_mfma_f32_16x16x32_bf16 v[164:167], a[20:23], a[104:107], v[164:167]
 v_mfma_f32_16x16x32_bf16 v[148:151], a[20:23], a[100:103], v[148:151]
 s_nop 0
 ds_write_b128 v11, v[176:179] offset:16128
 v_mfma_f32_16x16x32_bf16 v[148:151], a[36:39], a[116:119], v[148:151]
 v_mfma_f32_16x16x32_bf16 v[132:135], a[36:39], a[112:115], v[132:135]
 ds_write_b128 v11, v[180:183] offset:17472
 v_mfma_f32_16x16x32_bf16 v[132:135], a[20:23], a[96:99], v[132:135]
 v_mfma_f32_16x16x32_bf16 v[136:139], a[24:27], a[96:99], v[136:139]
 ds_write_b128 v11, v[164:167] offset:12096
 v_mfma_f32_16x16x32_bf16 v[136:139], a[40:43], a[112:115], v[136:139]
 v_mfma_f32_16x16x32_bf16 v[152:155], a[40:43], a[116:119], v[152:155]
 s_nop 0
 ds_write_b128 v11, v[148:151] offset:6720
 v_mfma_f32_16x16x32_bf16 v[152:155], a[24:27], a[100:103], v[152:155]
 v_mfma_f32_16x16x32_bf16 v[168:171], a[24:27], a[104:107], v[168:171]
 ds_write_b128 v11, v[132:135] offset:1344
 v_mfma_f32_16x16x32_bf16 v[168:171], a[40:43], a[120:123], v[168:171]
 v_mfma_f32_16x16x32_bf16 v[184:187], a[40:43], a[124:127], v[184:187]
 ds_write_b128 v11, v[136:139] offset:2688
 v_mfma_f32_16x16x32_bf16 v[184:187], a[24:27], a[108:111], v[184:187]
 v_mfma_f32_16x16x32_bf16 v[188:191], a[28:31], a[108:111], v[188:191]
 s_nop 0
 ds_write_b128 v11, v[152:155] offset:8064
 v_mfma_f32_16x16x32_bf16 v[188:191], a[44:47], a[124:127], v[188:191]
 v_mfma_f32_16x16x32_bf16 v[172:175], a[44:47], a[120:123], v[172:175]
 ds_write_b128 v11, v[168:171] offset:13440
 v_mfma_f32_16x16x32_bf16 v[172:175], a[28:31], a[104:107], v[172:175]
 v_mfma_f32_16x16x32_bf16 v[156:159], a[28:31], a[100:103], v[156:159]
 ds_write_b128 v11, v[184:187] offset:18816
 v_mfma_f32_16x16x32_bf16 v[156:159], a[44:47], a[116:119], v[156:159]
 v_mfma_f32_16x16x32_bf16 v[140:143], a[44:47], a[112:115], v[140:143]
 s_nop 0
 ds_write_b128 v11, v[188:191] offset:20160
 v_mfma_f32_16x16x32_bf16 v[140:143], a[28:31], a[96:99], v[140:143]
 s_nop 0
 ds_write_b128 v11, v[172:175] offset:14784
 s_nop 1
 ds_write_b128 v11, v[156:159] offset:9408
 s_nop 2
 ds_write_b128 v11, v[140:143] offset:4032
 s_waitcnt lgkmcnt(0)
 s_barrier
 ds_read_b128 v[192:195], v15 offset:0
 ds_read_b128 v[196:199], v15 offset:320
 ds_read_b128 v[200:203], v15 offset:2688
 ds_read_b128 v[204:207], v15 offset:3008
 ds_read_b128 v[208:211], v15 offset:21504
 ds_read_b128 v[212:215], v15 offset:21824
 ds_read_b128 v[216:219], v15 offset:24192
 ds_read_b128 v[220:223], v15 offset:24512
 ds_read_b128 v[224:227], v13 offset:0
 ds_read_b128 v[228:231], v13 offset:320
 ds_read_b128 v[232:235], v13 offset:2688
 ds_read_b128 v[236:239], v13 offset:3008
 ds_read_b128 v[240:243], v13 offset:21504
 ds_read_b128 v[244:247], v13 offset:21824
 ds_read_b128 v[248:251], v13 offset:24192
 ds_read_b128 v[252:255], v13 offset:24512
 ds_read_b128 v[64:67], v12 offset:0
 ds_read_b128 v[68:71], v12 offset:320
 ds_read_b128 v[72:75], v12 offset:2688
 ds_read_b128 v[76:79], v12 offset:3008
 s_waitcnt lgkmcnt(12)
 v_add_f32 v192, v192, v208
 v_add_f32 v193, v193, v209
 v_add_f32 v194, v194, v210
 v_add_f32 v195, v195, v211
 v_add_f32 v196, v196, v212
 v_add_f32 v197, v197, v213
 v_add_f32 v198, v198, v214
 v_add_f32 v199, v199, v215
 v_add_f32 v200, v200, v216
 v_add_f32 v201, v201, v217
 v_add_f32 v202, v202, v218
 v_add_f32 v203, v203, v219
 v_add_f32 v204, v204, v220
 v_add_f32 v205, v205, v221
 v_add_f32 v206, v206, v222
 v_add_f32 v207, v207, v223
 s_waitcnt lgkmcnt(4)
 v_add_f32 v224, v224, v240
 v_add_f32 v225, v225, v241
 v_add_f32 v226, v226, v242
 v_add_f32 v227, v227, v243
 v_add_f32 v228, v228, v244
 v_add_f32 v229, v229, v245
 v_add_f32 v230, v230, v246
 v_add_f32 v231, v231, v247
 v_add_f32 v232, v232, v248
 v_add_f32 v233, v233, v249
 v_add_f32 v234, v234, v250
 v_add_f32 v235, v235, v251
 v_add_f32 v236, v236, v252
 v_add_f32 v237, v237, v253
 v_add_f32 v238, v238, v254
 v_add_f32 v239, v239, v255
 v_add_f32 v192, v192, v224
 v_add_f32 v193, v193, v225
 v_add_f32 v194, v194, v226
 v_add_f32 v195, v195, v227
 v_add_f32 v196, v196, v228
 v_add_f32 v197, v197, v229
 v_add_f32 v198, v198, v230
 v_add_f32 v199, v199, v231
 v_add_f32 v200, v200, v232
 v_add_f32 v201, v201, v233
 v_add_f32 v202, v202, v234
 v_add_f32 v203, v203, v235
 v_add_f32 v204, v204, v236
 v_add_f32 v205, v205, v237
 v_add_f32 v206, v206, v238
 v_add_f32 v207, v207, v239
 s_waitcnt lgkmcnt(0)
 v_cvt_pk_bf16_f32 v32, v192, v193
 v_lshlrev_b32 v192, 16, v32
 v_and_b32 v193, 0xffff0000, v32
 v_add_f32 v64, v64, v192
 v_add_f32 v65, v65, v193
 v_cvt_pk_bf16_f32 v32, v64, v65
 v_cvt_pk_bf16_f32 v33, v194, v195
 v_lshlrev_b32 v194, 16, v33
 v_and_b32 v195, 0xffff0000, v33
 v_add_f32 v66, v66, v194
 v_add_f32 v67, v67, v195
 v_cvt_pk_bf16_f32 v33, v66, v67
 v_cvt_pk_bf16_f32 v34, v196, v197
 v_lshlrev_b32 v196, 16, v34
 v_and_b32 v197, 0xffff0000, v34
 v_add_f32 v68, v68, v196
 v_add_f32 v69, v69, v197
 v_cvt_pk_bf16_f32 v34, v68, v69
 v_cvt_pk_bf16_f32 v35, v198, v199
 v_lshlrev_b32 v198, 16, v35
 v_and_b32 v199, 0xffff0000, v35
 v_add_f32 v70, v70, v198
 v_add_f32 v71, v71, v199
 v_cvt_pk_bf16_f32 v35, v70, v71
 buffer_store_dwordx4 v[32:35], v14, s[84:87], 0 offen offset:0
 v_cvt_pk_bf16_f32 v36, v200, v201
 v_lshlrev_b32 v200, 16, v36
 v_and_b32 v201, 0xffff0000, v36
 v_add_f32 v72, v72, v200
 v_add_f32 v73, v73, v201
 v_cvt_pk_bf16_f32 v36, v72, v73
 v_cvt_pk_bf16_f32 v37, v202, v203
 v_lshlrev_b32 v202, 16, v37
 v_and_b32 v203, 0xffff0000, v37
 v_add_f32 v74, v74, v202
 v_add_f32 v75, v75, v203
 v_cvt_pk_bf16_f32 v37, v74, v75
 v_cvt_pk_bf16_f32 v38, v204, v205
 v_lshlrev_b32 v204, 16, v38
 v_and_b32 v205, 0xffff0000, v38
 v_add_f32 v76, v76, v204
 v_add_f32 v77, v77, v205
 v_cvt_pk_bf16_f32 v38, v76, v77
 v_cvt_pk_bf16_f32 v39, v206, v207
 v_lshlrev_b32 v206, 16, v39
 v_and_b32 v207, 0xffff0000, v39
 v_add_f32 v78, v78, v206
 v_add_f32 v79, v79, v207
 v_cvt_pk_bf16_f32 v39, v78, v79
 buffer_store_dwordx4 v[36:39], v14, s[84:87], 0 offen offset:64
 s_or_b32 s4, s2, s3
 s_cmp_eq_u32 s4, 0
 s_cbranch_scc0 L_ep_267
 v_mov_b32 v2, 196608
 v_mov_b32 v3, s100
 s_mov_b64 exec, 1
 buffer_store_dword v3, v2, s[96:99], 0 offen sc1
 s_mov_b64 exec, -1
L_ep_267:
 s_endpgm
L_so_25:
 s_call_b64 s[62:63], sequential_preLN__compressed_kv_cla__glu_gated_swiglu__prompt_kernel_slow21
 s_branch L_sb_26
L_so_27:
 s_call_b64 s[62:63], sequential_preLN__compressed_kv_cla__glu_gated_swiglu__prompt_kernel_slow00
 s_branch L_sb_28
L_so_29:
 s_call_b64 s[62:63], sequential_preLN__compressed_kv_cla__glu_gated_swiglu__prompt_kernel_slow11
 s_branch L_sb_30
L_so_31:
 s_call_b64 s[62:63], sequential_preLN__compressed_kv_cla__glu_gated_swiglu__prompt_kernel_slow30
 s_branch L_sb_32
L_so_40:
 s_call_b64 s[62:63], sequential_preLN__compressed_kv_cla__glu_gated_swiglu__prompt_kernel_slow21
 s_branch L_sb_41
L_so_42:
 s_call_b64 s[62:63], sequential_preLN__compressed_kv_cla__glu_gated_swiglu__prompt_kernel_slow00
 s_branch L_sb_43
L_so_44:
 s_call_b64 s[62:63], sequential_preLN__compressed_kv_cla__glu_gated_swiglu__prompt_kernel_slow11
 s_branch L_sb_45
L_so_46:
 s_call_b64 s[62:63], sequential_preLN__compressed_kv_cla__glu_gated_swiglu__prompt_kernel_slow30
 s_branch L_sb_47
L_so_50:
 s_call_b64 s[62:63], sequential_preLN__compressed_kv_cla__glu_gated_swiglu__prompt_kernel_slow21
 s_branch L_sb_51
L_so_52:
 s_call_b64 s[62:63], sequential_preLN__compressed_kv_cla__glu_gated_swiglu__prompt_kernel_slow10
 s_branch L_sb_53
L_so_54:
 s_call_b64 s[62:63], sequential_preLN__compressed_kv_cla__glu_gated_swiglu__prompt_kernel_slow31
 s_branch L_sb_55
L_so_58:
 s_call_b64 s[62:63], sequential_preLN__compressed_kv_cla__glu_gated_swiglu__prompt_kernel_slow21
 s_branch L_sb_59
L_so_60:
 s_call_b64 s[62:63], sequential_preLN__compressed_kv_cla__glu_gated_swiglu__prompt_kernel_slow00
 s_branch L_sb_61
L_so_62:
 s_call_b64 s[62:63], sequential_preLN__compressed_kv_cla__glu_gated_swiglu__prompt_kernel_slow11
 s_branch L_sb_63
L_so_64:
 s_call_b64 s[62:63], sequential_preLN__compressed_kv_cla__glu_gated_swiglu__prompt_kernel_slow30
 s_branch L_sb_65
L_so_68:
 s_call_b64 s[62:63], sequential_preLN__compressed_kv_cla__glu_gated_swiglu__prompt_kernel_slow21
 s_branch L_sb_69
L_so_70:
 s_call_b64 s[62:63], sequential_preLN__compressed_kv_cla__glu_gated_swiglu__prompt_kernel_slow10
 s_branch L_sb_71
L_so_72:
 s_call_b64 s[62:63], sequential_preLN__compressed_kv_cla__glu_gated_swiglu__prompt_kernel_slow31
 s_branch L_sb_73
L_so_76:
 s_call_b64 s[62:63], sequential_preLN__compressed_kv_cla__glu_gated_swiglu__prompt_kernel_slow21
 s_branch L_sb_77
L_so_78:
 s_call_b64 s[62:63], sequential_preLN__compressed_kv_cla__glu_gated_swiglu__prompt_kernel_slow00
 s_branch L_sb_79
L_so_80:
 s_call_b64 s[62:63], sequential_preLN__compressed_kv_cla__glu_gated_swiglu__prompt_kernel_slow11
 s_branch L_sb_81
L_so_82:
 s_call_b64 s[62:63], sequential_preLN__compressed_kv_cla__glu_gated_swiglu__prompt_kernel_slow30
 s_branch L_sb_83
L_so_86:
 s_call_b64 s[62:63], sequential_preLN__compressed_kv_cla__glu_gated_swiglu__prompt_kernel_slow21
 s_branch L_sb_87
L_so_88:
 s_call_b64 s[62:63], sequential_preLN__compressed_kv_cla__glu_gated_swiglu__prompt_kernel_slow10
 s_branch L_sb_89
L_so_90:
 s_call_b64 s[62:63], sequential_preLN__compressed_kv_cla__glu_gated_swiglu__prompt_kernel_slow31
 s_branch L_sb_91
L_so_94:
 s_call_b64 s[62:63], sequential_preLN__compressed_kv_cla__glu_gated_swiglu__prompt_kernel_slow21
 s_branch L_sb_95
L_so_96:
 s_call_b64 s[62:63], sequential_preLN__compressed_kv_cla__glu_gated_swiglu__prompt_kernel_slow00
 s_branch L_sb_97
L_so_98:
 s_call_b64 s[62:63], sequential_preLN__compressed_kv_cla__glu_gated_swiglu__prompt_kernel_slow11
 s_branch L_sb_99
L_so_100:
 s_call_b64 s[62:63], sequential_preLN__compressed_kv_cla__glu_gated_swiglu__prompt_kernel_slow30
 s_branch L_sb_101
L_so_104:
 s_call_b64 s[62:63], sequential_preLN__compressed_kv_cla__glu_gated_swiglu__prompt_kernel_slow21
 s_branch L_sb_105
L_so_106:
 s_call_b64 s[62:63], sequential_preLN__compressed_kv_cla__glu_gated_swiglu__prompt_kernel_slow10
 s_branch L_sb_107
L_so_108:
 s_call_b64 s[62:63], sequential_preLN__compressed_kv_cla__glu_gated_swiglu__prompt_kernel_slow31
 s_branch L_sb_109
L_so_115:
 s_call_b64 s[62:63], sequential_preLN__compressed_kv_cla__glu_gated_swiglu__prompt_kernel_slow20
 s_branch L_sb_116
L_so_117:
 s_call_b64 s[62:63], sequential_preLN__compressed_kv_cla__glu_gated_swiglu__prompt_kernel_slow31
 s_branch L_sb_118
L_so_121:
 s_call_b64 s[62:63], sequential_preLN__compressed_kv_cla__glu_gated_swiglu__prompt_kernel_slow20
 s_branch L_sb_122
L_so_123:
 s_call_b64 s[62:63], sequential_preLN__compressed_kv_cla__glu_gated_swiglu__prompt_kernel_slow31
 s_branch L_sb_124
L_so_127:
 s_call_b64 s[62:63], sequential_preLN__compressed_kv_cla__glu_gated_swiglu__prompt_kernel_slow20
 s_branch L_sb_128
L_so_129:
 s_call_b64 s[62:63], sequential_preLN__compressed_kv_cla__glu_gated_swiglu__prompt_kernel_slow31
 s_branch L_sb_130
L_so_133:
 s_call_b64 s[62:63], sequential_preLN__compressed_kv_cla__glu_gated_swiglu__prompt_kernel_slow20
 s_branch L_sb_134
L_so_135:
 s_call_b64 s[62:63], sequential_preLN__compressed_kv_cla__glu_gated_swiglu__prompt_kernel_slow31
 s_branch L_sb_136
L_so_139:
 s_call_b64 s[62:63], sequential_preLN__compressed_kv_cla__glu_gated_swiglu__prompt_kernel_slow20
 s_branch L_sb_140
L_so_141:
 s_call_b64 s[62:63], sequential_preLN__compressed_kv_cla__glu_gated_swiglu__prompt_kernel_slow31
 s_branch L_sb_142
L_so_150:
 s_call_b64 s[62:63], sequential_preLN__compressed_kv_cla__glu_gated_swiglu__prompt_kernel_slow20
 s_branch L_sb_151
L_so_152:
 s_call_b64 s[62:63], sequential_preLN__compressed_kv_cla__glu_gated_swiglu__prompt_kernel_slow31
 s_branch L_sb_153
L_so_156:
 s_call_b64 s[62:63], sequential_preLN__compressed_kv_cla__glu_gated_swiglu__prompt_kernel_slow20
 s_branch L_sb_157
L_so_160:
 s_call_b64 s[62:63], sequential_preLN__compressed_kv_cla__glu_gated_swiglu__prompt_kernel_slow31
 s_branch L_sb_161
L_so_162:
 s_call_b64 s[62:63], sequential_preLN__compressed_kv_cla__glu_gated_swiglu__prompt_kernel_slow20
 s_branch L_sb_163
L_so_164:
 s_call_b64 s[62:63], sequential_preLN__compressed_kv_cla__glu_gated_swiglu__prompt_kernel_slow31
 s_branch L_sb_165
L_so_168:
 s_call_b64 s[62:63], sequential_preLN__compressed_kv_cla__glu_gated_swiglu__prompt_kernel_slow20
 s_branch L_sb_169
L_so_172:
 s_call_b64 s[62:63], sequential_preLN__compressed_kv_cla__glu_gated_swiglu__prompt_kernel_slow31
 s_branch L_sb_173
L_so_174:
 s_call_b64 s[62:63], sequential_preLN__compressed_kv_cla__glu_gated_swiglu__prompt_kernel_slow20
 s_branch L_sb_175
L_so_176:
 s_call_b64 s[62:63], sequential_preLN__compressed_kv_cla__glu_gated_swiglu__prompt_kernel_slow31
 s_branch L_sb_177
L_so_180:
 s_call_b64 s[62:63], sequential_preLN__compressed_kv_cla__glu_gated_swiglu__prompt_kernel_slow20
 s_branch L_sb_181
L_so_184:
 s_call_b64 s[62:63], sequential_preLN__compressed_kv_cla__glu_gated_swiglu__prompt_kernel_slow31
 s_branch L_sb_185
L_so_186:
 s_call_b64 s[62:63], sequential_preLN__compressed_kv_cla__glu_gated_swiglu__prompt_kernel_slow20
 s_branch L_sb_187
L_so_188:
 s_call_b64 s[62:63], sequential_preLN__compressed_kv_cla__glu_gated_swiglu__prompt_kernel_slow31
 s_branch L_sb_189
L_so_192:
 s_call_b64 s[62:63], sequential_preLN__compressed_kv_cla__glu_gated_swiglu__prompt_kernel_slow20
 s_branch L_sb_193
L_so_196:
 s_call_b64 s[62:63], sequential_preLN__compressed_kv_cla__glu_gated_swiglu__prompt_kernel_slow31
 s_branch L_sb_197
L_so_204:
 s_call_b64 s[62:63], sequential_preLN__compressed_kv_cla__glu_gated_swiglu__prompt_kernel_slow20
 s_branch L_sb_205
L_so_206:
 s_call_b64 s[62:63], sequential_preLN__compressed_kv_cla__glu_gated_swiglu__prompt_kernel_slow31
 s_branch L_sb_207
L_so_210:
 s_call_b64 s[62:63], sequential_preLN__compressed_kv_cla__glu_gated_swiglu__prompt_kernel_slow20
 s_branch L_sb_211
L_so_214:
 s_call_b64 s[62:63], sequential_preLN__compressed_kv_cla__glu_gated_swiglu__prompt_kernel_slow31
 s_branch L_sb_215
L_so_216:
 s_call_b64 s[62:63], sequential_preLN__compressed_kv_cla__glu_gated_swiglu__prompt_kernel_slow20
 s_branch L_sb_217
L_so_218:
 s_call_b64 s[62:63], sequential_preLN__compressed_kv_cla__glu_gated_swiglu__prompt_kernel_slow31
 s_branch L_sb_219
L_so_222:
 s_call_b64 s[62:63], sequential_preLN__compressed_kv_cla__glu_gated_swiglu__prompt_kernel_slow20
 s_branch L_sb_223
L_so_226:
 s_call_b64 s[62:63], sequential_preLN__compressed_kv_cla__glu_gated_swiglu__prompt_kernel_slow31
 s_branch L_sb_227
L_so_228:
 s_call_b64 s[62:63], sequential_preLN__compressed_kv_cla__glu_gated_swiglu__prompt_kernel_slow20
 s_branch L_sb_229
L_so_230:
 s_call_b64 s[62:63], sequential_preLN__compressed_kv_cla__glu_gated_swiglu__prompt_kernel_slow31
 s_branch L_sb_231
L_so_234:
 s_call_b64 s[62:63], sequential_preLN__compressed_kv_cla__glu_gated_swiglu__prompt_kernel_slow20
 s_branch L_sb_235
L_so_238:
 s_call_b64 s[62:63], sequential_preLN__compressed_kv_cla__glu_gated_swiglu__prompt_kernel_slow31
 s_branch L_sb_239
L_so_240:
 s_call_b64 s[62:63], sequential_preLN__compressed_kv_cla__glu_gated_swiglu__prompt_kernel_slow20
 s_branch L_sb_241
L_so_242:
 s_call_b64 s[62:63], sequential_preLN__compressed_kv_cla__glu_gated_swiglu__prompt_kernel_slow31
 s_branch L_sb_243
L_so_246:
 s_call_b64 s[62:63], sequential_preLN__compressed_kv_cla__glu_gated_swiglu__prompt_kernel_slow20
 s_branch L_sb_247
L_so_250:
 s_call_b64 s[62:63], sequential_preLN__compressed_kv_cla__glu_gated_swiglu__prompt_kernel_slow31
 s_branch L_sb_251
L_fo_33:
 s_call_b64 s[62:63], sequential_preLN__compressed_kv_cla__glu_gated_swiglu__prompt_kernel_evt
 s_branch L_fb_34
L_fo_48:
 s_call_b64 s[62:63], sequential_preLN__compressed_kv_cla__glu_gated_swiglu__prompt_kernel_evt
 s_branch L_fb_49
L_fo_56:
 s_call_b64 s[62:63], sequential_preLN__compressed_kv_cla__glu_gated_swiglu__prompt_kernel_evt
 s_branch L_fb_57
L_fo_66:
 s_call_b64 s[62:63], sequential_preLN__compressed_kv_cla__glu_gated_swiglu__prompt_kernel_evt
 s_branch L_fb_67
L_fo_74:
 s_call_b64 s[62:63], sequential_preLN__compressed_kv_cla__glu_gated_swiglu__prompt_kernel_evt
 s_branch L_fb_75
L_fo_84:
 s_call_b64 s[62:63], sequential_preLN__compressed_kv_cla__glu_gated_swiglu__prompt_kernel_evt
 s_branch L_fb_85
L_fo_92:
 s_call_b64 s[62:63], sequential_preLN__compressed_kv_cla__glu_gated_swiglu__prompt_kernel_evt
 s_branch L_fb_93
L_fo_102:
 s_call_b64 s[62:63], sequential_preLN__compressed_kv_cla__glu_gated_swiglu__prompt_kernel_evt
 s_branch L_fb_103
L_fo_110:
 s_call_b64 s[62:63], sequential_preLN__compressed_kv_cla__glu_gated_swiglu__prompt_kernel_evt
 s_branch L_fb_111
L_fo_119:
 s_call_b64 s[62:63], sequential_preLN__compressed_kv_cla__glu_gated_swiglu__prompt_kernel_evt
 s_branch L_fb_120
L_fo_125:
 s_call_b64 s[62:63], sequential_preLN__compressed_kv_cla__glu_gated_swiglu__prompt_kernel_evt
 s_branch L_fb_126
L_fo_131:
 s_call_b64 s[62:63], sequential_preLN__compressed_kv_cla__glu_gated_swiglu__prompt_kernel_evt
 s_branch L_fb_132
L_fo_137:
 s_call_b64 s[62:63], sequential_preLN__compressed_kv_cla__glu_gated_swiglu__prompt_kernel_evt
 s_branch L_fb_138
L_fo_143:
 s_call_b64 s[62:63], sequential_preLN__compressed_kv_cla__glu_gated_swiglu__prompt_kernel_evt
 s_branch L_fb_144
L_fo_154:
 s_call_b64 s[62:63], sequential_preLN__compressed_kv_cla__glu_gated_swiglu__prompt_kernel_evt
 s_branch L_fb_155
L_fo_158:
 s_call_b64 s[62:63], sequential_preLN__compressed_kv_cla__glu_gated_swiglu__prompt_kernel_evt
 s_branch L_fb_159
L_fo_166:
 s_call_b64 s[62:63], sequential_preLN__compressed_kv_cla__glu_gated_swiglu__prompt_kernel_evt
 s_branch L_fb_167
L_fo_170:
 s_call_b64 s[62:63], sequential_preLN__compressed_kv_cla__glu_gated_swiglu__prompt_kernel_evt
 s_branch L_fb_171
L_fo_178:
 s_call_b64 s[62:63], sequential_preLN__compressed_kv_cla__glu_gated_swiglu__prompt_kernel_evt
 s_branch L_fb_179
L_fo_182:
 s_call_b64 s[62:63], sequential_preLN__compressed_kv_cla__glu_gated_swiglu__prompt_kernel_evt
 s_branch L_fb_183
L_fo_190:
 s_call_b64 s[62:63], sequential_preLN__compressed_kv_cla__glu_gated_swiglu__prompt_kernel_evt
 s_branch L_fb_191
L_fo_194:
 s_call_b64 s[62:63], sequential_preLN__compressed_kv_cla__glu_gated_swiglu__prompt_kernel_evt
 s_branch L_fb_195
L_fo_208:
 s_call_b64 s[62:63], sequential_preLN__compressed_kv_cla__glu_gated_swiglu__prompt_kernel_evt
 s_branch L_fb_209
L_fo_212:
 s_call_b64 s[62:63], sequential_preLN__compressed_kv_cla__glu_gated_swiglu__prompt_kernel_evt
 s_branch L_fb_213
L_fo_220:
 s_call_b64 s[62:63], sequential_preLN__compressed_kv_cla__glu_gated_swiglu__prompt_kernel_evt
 s_branch L_fb_221
L_fo_224:
 s_call_b64 s[62:63], sequential_preLN__compressed_kv_cla__glu_gated_swiglu__prompt_kernel_evt
 s_branch L_fb_225
L_fo_232:
 s_call_b64 s[62:63], sequential_preLN__compressed_kv_cla__glu_gated_swiglu__prompt_kernel_evt
 s_branch L_fb_233
L_fo_236:
 s_call_b64 s[62:63], sequential_preLN__compressed_kv_cla__glu_gated_swiglu__prompt_kernel_evt
 s_branch L_fb_237
L_fo_244:
 s_call_b64 s[62:63], sequential_preLN__compressed_kv_cla__glu_gated_swiglu__prompt_kernel_evt
 s_branch L_fb_245
L_fo_248:
 s_call_b64 s[62:63], sequential_preLN__compressed_kv_cla__glu_gated_swiglu__prompt_kernel_evt
 s_branch L_fb_249
sequential_preLN__compressed_kv_cla__glu_gated_swiglu__prompt_kernel_evt:
 s_add_u32 s59, s59, 1
 s_cmp_eq_u32 s59, 1
 s_cbranch_scc0 L_e2_268
 s_waitcnt lgkmcnt(0)
 ds_read_b64_tr_b16 v[224:225], v6 offset:0
 ds_read_b64_tr_b16 v[226:227], v6 offset:2048
 ds_read_b64_tr_b16 v[228:229], v6 offset:32
 ds_read_b64_tr_b16 v[230:231], v6 offset:2080
 ds_read_b64_tr_b16 v[232:233], v6 offset:64
 ds_read_b64_tr_b16 v[234:235], v6 offset:2112
 ds_read_b64_tr_b16 v[236:237], v6 offset:96
 ds_read_b64_tr_b16 v[238:239], v6 offset:2144
 ds_read_b64_tr_b16 v[240:241], v6 offset:4096
 ds_read_b64_tr_b16 v[242:243], v6 offset:6144
 ds_read_b64_tr_b16 v[244:245], v6 offset:4128
 ds_read_b64_tr_b16 v[246:247], v6 offset:6176
 ds_read_b64_tr_b16 v[248:249], v6 offset:4160
 ds_read_b64_tr_b16 v[250:251], v6 offset:6208
 ds_read_b64_tr_b16 v[252:253], v6 offset:4192
 ds_read_b64_tr_b16 v[254:255], v6 offset:6240
 v_mov_b32 v8, 0x3f803f80
 v_mov_b32 v9, 0x3f803f80
 v_mov_b32 v10, 0x3f803f80
 v_mov_b32 v11, 0x3f803f80
 s_mov_b32 s42, 0
 s_waitcnt lgkmcnt(14)
 buffer_store_dwordx4 v[224:227], v12, s[24:27], s42 offen sc1
 s_add_u32 s42, s42, 131072
 s_waitcnt lgkmcnt(12)
 buffer_store_dwordx4 v[228:231], v12, s[24:27], s42 offen sc1
 s_add_u32 s42, s42, 131072
 s_waitcnt lgkmcnt(10)
 buffer_store_dwordx4 v[232:235], v12, s[24:27], s42 offen sc1
 s_add_u32 s42, s42, 131072
 s_waitcnt lgkmcnt(8)
 buffer_store_dwordx4 v[236:239], v12, s[24:27], s42 offen sc1
 s_mov_b32 s42, 0
 s_waitcnt lgkmcnt(6)
 buffer_store_dwordx4 v[240:243], v12, s[28:31], s42 offen sc1
 v_mfma_f32_16x16x32_bf16 v[224:227], v[240:243], v[8:11], 0
 s_add_u32 s42, s42, s41
 s_waitcnt lgkmcnt(4)
 buffer_store_dwordx4 v[244:247], v12, s[28:31], s42 offen sc1
 v_mfma_f32_16x16x32_bf16 v[228:231], v[244:247], v[8:11], 0
 s_add_u32 s42, s42, s41
 s_waitcnt lgkmcnt(2)
 buffer_store_dwordx4 v[248:251], v12, s[28:31], s42 offen sc1
 v_mfma_f32_16x16x32_bf16 v[232:235], v[248:251], v[8:11], 0
 s_add_u32 s42, s42, s41
 s_waitcnt lgkmcnt(0)
 buffer_store_dwordx4 v[252:255], v12, s[28:31], s42 offen sc1
 v_mfma_f32_16x16x32_bf16 v[236:239], v[252:255], v[8:11], 0
 v_and_b32 v2, 15, v0
 v_cmp_eq_u32 vcc, 1, v2
 s_nop 1
 v_cndmask_b32 v224, v224, v228, vcc
 v_cndmask_b32 v225, v225, v229, vcc
 v_cndmask_b32 v226, v226, v230, vcc
 v_cndmask_b32 v227, v227, v231, vcc
 v_cmp_eq_u32 vcc, 2, v2
 s_nop 1
 v_cndmask_b32 v224, v224, v232, vcc
 v_cndmask_b32 v225, v225, v233, vcc
 v_cndmask_b32 v226, v226, v234, vcc
 v_cndmask_b32 v227, v227, v235, vcc
 v_cmp_eq_u32 vcc, 3, v2
 s_nop 1
 v_cndmask_b32 v224, v224, v236, vcc
 v_cndmask_b32 v225, v225, v237, vcc
 v_cndmask_b32 v226, v226, v238, vcc
 v_cndmask_b32 v227, v227, v239, vcc
 buffer_store_dwordx4 v[224:227], v7, s[88:91], 0 offen sc1
 s_mov_b32 s68, 3
 s_branch L_er_271
L_e2_268:
 s_cmp_eq_u32 s59, 2
 s_cbranch_scc0 L_e3_269
 s_cmp_eq_u32 s3, 0
 s_cbranch_scc0 L_pub_272
 s_mul_i32 s4, s2, 128
 s_add_u32 s4, s4, 163840
 v_lshl_add_u32 v252, v0, 2, s4
 v_mov_b32 v253, s100
 s_mov_b64 exec, 0xffffffff
 buffer_store_dword v253, v252, s[96:99], 0 offen sc1
 s_mov_b64 exec, -1
L_pub_272:
 s_lshl_b32 s4, s71, 1
 s_sub_u32 s4, 12, s4
 s_max_i32 s68, s4, 2
 s_branch L_er_271
L_e3_269:
 s_cmp_eq_u32 s59, 3
 s_cbranch_scc0 L_e4_270
 buffer_load_dword v248, v15, s[96:99], 0 offen sc1
 s_mov_b32 s68, 2
 s_getpc_b64 s[6:7]
L_cw_273:
 s_sub_u32 s6, s6, L_cw_273 - sequential_preLN__compressed_kv_cla__glu_gated_swiglu__prompt_kernel_cB
 s_subb_u32 s7, s7, 0
 s_lshr_b32 s4, s2, 3
 s_lshl_b32 s4, s4, 2
 s_add_u32 s4, s4, s3
 s_lshl_b32 s4, s4, 7
 v_lshlrev_b32 v252, 14, v0
 v_add_u32 v252, s4, v252
 v_cmp_gt_u32 vcc, sequential_preLN__compressed_kv_cla__glu_gated_swiglu__prompt_kernel_cend - sequential_preLN__compressed_kv_cla__glu_gated_swiglu__prompt_kernel_cB, v252
 s_and_saveexec_b64 s[92:93], vcc
 s_cbranch_execz L_cs_274
 global_load_dword a255, v252, s[6:7]
L_cs_274:
 s_mov_b64 exec, s[92:93]
 s_branch L_er_271
L_e4_270:
 s_mov_b32 s68, 64
 s_and_b32 s40, s2, 7
 s_lshl_b32 s40, s40, 2
 s_bfe_u32 s5, s2, 0x20003
 s_add_u32 s40, s40, s5
 s_lshr_b32 s41, s2, 5
 s_lshl_b32 s42, s41, 12
 s_lshl_b32 s43, s3, 15
 s_lshl_b32 s5, s41, 19
 s_add_u32 s5, s5, 52428800
 s_add_u32 s8, s60, s5
 s_addc_u32 s9, s61, 0
 s_mov_b32 s10, 524288
 s_mov_b32 s11, 0x20000
 s_lshl_b32 s5, s40, 19
 s_add_u32 s5, s5, 35651584
 s_add_u32 s20, s60, s5
 s_addc_u32 s21, s61, 0
 s_mov_b32 s22, 524288
 s_mov_b32 s23, 0x20000
 v_lshlrev_b32 v4, 4, v0
 v_add_u32 v5, 131072, v4
 v_add_u32 v6, 262144, v4
 v_add_u32 v7, 393216, v4
 s_lshr_b32 s5, s40, 1
 s_sub_u32 s6, 15, s5
 s_min_u32 s5, s5, s6
 s_lshl_b32 s5, s5, 5
 s_lshl_b32 s6, s3, 1
 s_add_u32 s5, s5, s6
 s_lshl_b32 s5, s5, 7
 s_add_u32 s5, s5, 65536
 v_bfe_u32 v11, v0, 2, 1
 v_and_b32 v2, 3, v0
 v_lshl_add_u32 v11, v2, 3, v11
 v_lshlrev_b32 v11, 7, v11
 v_add_u32 v11, s5, v11
 s_lshl_b32 s5, s40, 2
 s_add_u32 s5, s5, s3
 s_lshl_b32 s5, s5, 14
 s_lshl_b32 s6, s41, 7
 s_add_u32 s6, s6, s5
 s_add_u32 s28, s36, s6
 s_addc_u32 s29, s37, 0
 s_mov_b32 s30, 15488
 s_mov_b32 s31, 0x20000
 s_lshl_b32 s45, s3, 13
 s_add_u32 s45, s45, 131072
 v_add_u32 v8, s45, v4
 v_cmp_ne_u32 vcc, s100, v248
 s_nop 0
 s_cbranch_vccz L_er_271
 s_mov_b32 s101, 0x40000
L_spin_275:
 buffer_load_dword v248, v15, s[96:99], 0 offen sc1
 s_waitcnt vmcnt(0)
 v_cmp_ne_u32 vcc, s100, v248
 s_nop 0
 s_cbranch_vccz L_ok_276
 s_sleep 1
 s_sub_u32 s101, s101, 1
 s_cmp_lg_u32 s101, 0
 s_cbranch_scc1 L_spin_275
L_ok_276:
L_er_271:
 s_setpc_b64 s[62:63]
sequential_preLN__compressed_kv_cla__glu_gated_swiglu__prompt_kernel_slow00:
 v_max3_f32 v225, v64, v65, v66
 v_max3_f32 v225, v225, v67, v68
 v_max3_f32 v225, v225, v69, v70
 v_max3_f32 v225, v225, v71, v72
 v_max3_f32 v225, v225, v73, v74
 v_max3_f32 v225, v225, v75, v76
 v_max3_f32 v225, v225, v77, v78
 v_max_f32 v225, v225, v79
 v_mov_b32 v226, v225
 s_nop 1
 v_permlane16_swap_b32 v225, v226
 v_max_f32 v225, v225, v226
 v_mov_b32 v226, v225
 s_nop 1
 v_permlane32_swap_b32 v225, v226
 v_max_f32 v225, v225, v226
 v_add_f32 v225, 0x42cc0000, v225
 v_max_f32 v225, 0, v225
 v_sub_f32 v227, 0, v225
 v_exp_f32 v227, v227
 v_accvgpr_read_b32 v226, a176
 v_mul_f32 v226, v226, v227
 v_accvgpr_write_b32 a176, v226
 v_mul_f32 v96, v96, v227
 v_mul_f32 v97, v97, v227
 v_mul_f32 v98, v98, v227
 v_mul_f32 v99, v99, v227
 v_mul_f32 v100, v100, v227
 v_mul_f32 v101, v101, v227
 v_mul_f32 v102, v102, v227
 v_mul_f32 v103, v103, v227
 v_mul_f32 v104, v104, v227
 v_mul_f32 v105, v105, v227
 v_mul_f32 v106, v106, v227
 v_mul_f32 v107, v107, v227
 v_mul_f32 v108, v108, v227
 v_mul_f32 v109, v109, v227
 v_mul_f32 v110, v110, v227
 v_mul_f32 v111, v111, v227
 v_mul_f32 v112, v112, v227
 v_mul_f32 v113, v113, v227
 v_mul_f32 v114, v114, v227
 v_mul_f32 v115, v115, v227
 v_mul_f32 v116, v116, v227
 v_mul_f32 v117, v117, v227
 v_mul_f32 v118, v118, v227
 v_mul_f32 v119, v119, v227
 v_mul_f32 v120, v120, v227
 v_mul_f32 v121, v121, v227
 v_mul_f32 v122, v122, v227
 v_mul_f32 v123, v123, v227
 v_mul_f32 v124, v124, v227
 v_mul_f32 v125, v125, v227
 v_mul_f32 v126, v126, v227
 v_mul_f32 v127, v127, v227
 v_sub_f32 v32, v32, v225
 v_sub_f32 v33, v33, v225
 v_sub_f32 v34, v34, v225
 v_sub_f32 v35, v35, v225
 v_sub_f32 v228, v64, v225
 v_sub_f32 v229, v65, v225
 v_sub_f32 v230, v66, v225
 v_sub_f32 v231, v67, v225
 v_sub_f32 v232, v68, v225
 v_sub_f32 v233, v69, v225
 v_sub_f32 v234, v70, v225
 v_sub_f32 v235, v71, v225
 v_sub_f32 v236, v72, v225
 v_sub_f32 v237, v73, v225
 v_sub_f32 v238, v74, v225
 v_sub_f32 v239, v75, v225
 v_sub_f32 v240, v76, v225
 v_sub_f32 v241, v77, v225
 v_sub_f32 v242, v78, v225
 v_sub_f32 v243, v79, v225
 v_exp_f32 v228, v228
 v_exp_f32 v229, v229
 v_exp_f32 v230, v230
 v_exp_f32 v231, v231
 v_exp_f32 v232, v232
 v_exp_f32 v233, v233
 v_exp_f32 v234, v234
 v_exp_f32 v235, v235
 v_exp_f32 v236, v236
 v_exp_f32 v237, v237
 v_exp_f32 v238, v238
 v_exp_f32 v239, v239
 v_exp_f32 v240, v240
 v_exp_f32 v241, v241
 v_exp_f32 v242, v242
 v_exp_f32 v243, v243
 v_cvt_pk_bf16_f32 v48, v228, v229
 v_cvt_pk_bf16_f32 v49, v230, v231
 v_cvt_pk_bf16_f32 v50, v232, v233
 v_cvt_pk_bf16_f32 v51, v234, v235
 v_cvt_pk_bf16_f32 v52, v236, v237
 v_cvt_pk_bf16_f32 v53, v238, v239
 v_cvt_pk_bf16_f32 v54, v240, v241
 v_cvt_pk_bf16_f32 v55, v242, v243
 s_nop 1
 s_setpc_b64 s[62:63]
sequential_preLN__compressed_kv_cla__glu_gated_swiglu__prompt_kernel_slow10:
 v_max3_f32 v225, v64, v65, v66
 v_max3_f32 v225, v225, v67, v68
 v_max3_f32 v225, v225, v69, v70
 v_max3_f32 v225, v225, v71, v72
 v_max3_f32 v225, v225, v73, v74
 v_max3_f32 v225, v225, v75, v76
 v_max3_f32 v225, v225, v77, v78
 v_max_f32 v225, v225, v79
 v_mov_b32 v226, v225
 s_nop 1
 v_permlane16_swap_b32 v225, v226
 v_max_f32 v225, v225, v226
 v_mov_b32 v226, v225
 s_nop 1
 v_permlane32_swap_b32 v225, v226
 v_max_f32 v225, v225, v226
 v_add_f32 v225, 0x42cc0000, v225
 v_max_f32 v225, 0, v225
 v_sub_f32 v227, 0, v225
 v_exp_f32 v227, v227
 v_accvgpr_read_b32 v226, a180
 v_mul_f32 v226, v226, v227
 v_accvgpr_write_b32 a180, v226
 v_mul_f32 v128, v128, v227
 v_mul_f32 v129, v129, v227
 v_mul_f32 v130, v130, v227
 v_mul_f32 v131, v131, v227
 v_mul_f32 v132, v132, v227
 v_mul_f32 v133, v133, v227
 v_mul_f32 v134, v134, v227
 v_mul_f32 v135, v135, v227
 v_mul_f32 v136, v136, v227
 v_mul_f32 v137, v137, v227
 v_mul_f32 v138, v138, v227
 v_mul_f32 v139, v139, v227
 v_mul_f32 v140, v140, v227
 v_mul_f32 v141, v141, v227
 v_mul_f32 v142, v142, v227
 v_mul_f32 v143, v143, v227
 v_mul_f32 v144, v144, v227
 v_mul_f32 v145, v145, v227
 v_mul_f32 v146, v146, v227
 v_mul_f32 v147, v147, v227
 v_mul_f32 v148, v148, v227
 v_mul_f32 v149, v149, v227
 v_mul_f32 v150, v150, v227
 v_mul_f32 v151, v151, v227
 v_mul_f32 v152, v152, v227
 v_mul_f32 v153, v153, v227
 v_mul_f32 v154, v154, v227
 v_mul_f32 v155, v155, v227
 v_mul_f32 v156, v156, v227
 v_mul_f32 v157, v157, v227
 v_mul_f32 v158, v158, v227
 v_mul_f32 v159, v159, v227
 v_sub_f32 v36, v36, v225
 v_sub_f32 v37, v37, v225
 v_sub_f32 v38, v38, v225
 v_sub_f32 v39, v39, v225
 v_sub_f32 v228, v64, v225
 v_sub_f32 v229, v65, v225
 v_sub_f32 v230, v66, v225
 v_sub_f32 v231, v67, v225
 v_sub_f32 v232, v68, v225
 v_sub_f32 v233, v69, v225
 v_sub_f32 v234, v70, v225
 v_sub_f32 v235, v71, v225
 v_sub_f32 v236, v72, v225
 v_sub_f32 v237, v73, v225
 v_sub_f32 v238, v74, v225
 v_sub_f32 v239, v75, v225
 v_sub_f32 v240, v76, v225
 v_sub_f32 v241, v77, v225
 v_sub_f32 v242, v78, v225
 v_sub_f32 v243, v79, v225
 v_exp_f32 v228, v228
 v_exp_f32 v229, v229
 v_exp_f32 v230, v230
 v_exp_f32 v231, v231
 v_exp_f32 v232, v232
 v_exp_f32 v233, v233
 v_exp_f32 v234, v234
 v_exp_f32 v235, v235
 v_exp_f32 v236, v236
 v_exp_f32 v237, v237
 v_exp_f32 v238, v238
 v_exp_f32 v239, v239
 v_exp_f32 v240, v240
 v_exp_f32 v241, v241
 v_exp_f32 v242, v242
 v_exp_f32 v243, v243
 v_cvt_pk_bf16_f32 v48, v228, v229
 v_cvt_pk_bf16_f32 v49, v230, v231
 v_cvt_pk_bf16_f32 v50, v232, v233
 v_cvt_pk_bf16_f32 v51, v234, v235
 v_cvt_pk_bf16_f32 v52, v236, v237
 v_cvt_pk_bf16_f32 v53, v238, v239
 v_cvt_pk_bf16_f32 v54, v240, v241
 v_cvt_pk_bf16_f32 v55, v242, v243
 s_nop 1
 s_setpc_b64 s[62:63]
sequential_preLN__compressed_kv_cla__glu_gated_swiglu__prompt_kernel_slow11:
 v_max3_f32 v225, v80, v81, v82
 v_max3_f32 v225, v225, v83, v84
 v_max3_f32 v225, v225, v85, v86
 v_max3_f32 v225, v225, v87, v88
 v_max3_f32 v225, v225, v89, v90
 v_max3_f32 v225, v225, v91, v92
 v_max3_f32 v225, v225, v93, v94
 v_max_f32 v225, v225, v95
 v_mov_b32 v226, v225
 s_nop 1
 v_permlane16_swap_b32 v225, v226
 v_max_f32 v225, v225, v226
 v_mov_b32 v226, v225
 s_nop 1
 v_permlane32_swap_b32 v225, v226
 v_max_f32 v225, v225, v226
 v_add_f32 v225, 0x42cc0000, v225
 v_max_f32 v225, 0, v225
 v_sub_f32 v227, 0, v225
 v_exp_f32 v227, v227
 v_accvgpr_read_b32 v226, a180
 v_mul_f32 v226, v226, v227
 v_accvgpr_write_b32 a180, v226
 v_mul_f32 v128, v128, v227
 v_mul_f32 v129, v129, v227
 v_mul_f32 v130, v130, v227
 v_mul_f32 v131, v131, v227
 v_mul_f32 v132, v132, v227
 v_mul_f32 v133, v133, v227
 v_mul_f32 v134, v134, v227
 v_mul_f32 v135, v135, v227
 v_mul_f32 v136, v136, v227
 v_mul_f32 v137, v137, v227
 v_mul_f32 v138, v138, v227
 v_mul_f32 v139, v139, v227
 v_mul_f32 v140, v140, v227
 v_mul_f32 v141, v141, v227
 v_mul_f32 v142, v142, v227
 v_mul_f32 v143, v143, v227
 v_mul_f32 v144, v144, v227
 v_mul_f32 v145, v145, v227
 v_mul_f32 v146, v146, v227
 v_mul_f32 v147, v147, v227
 v_mul_f32 v148, v148, v227
 v_mul_f32 v149, v149, v227
 v_mul_f32 v150, v150, v227
 v_mul_f32 v151, v151, v227
 v_mul_f32 v152, v152, v227
 v_mul_f32 v153, v153, v227
 v_mul_f32 v154, v154, v227
 v_mul_f32 v155, v155, v227
 v_mul_f32 v156, v156, v227
 v_mul_f32 v157, v157, v227
 v_mul_f32 v158, v158, v227
 v_mul_f32 v159, v159, v227
 v_sub_f32 v36, v36, v225
 v_sub_f32 v37, v37, v225
 v_sub_f32 v38, v38, v225
 v_sub_f32 v39, v39, v225
 v_sub_f32 v228, v80, v225
 v_sub_f32 v229, v81, v225
 v_sub_f32 v230, v82, v225
 v_sub_f32 v231, v83, v225
 v_sub_f32 v232, v84, v225
 v_sub_f32 v233, v85, v225
 v_sub_f32 v234, v86, v225
 v_sub_f32 v235, v87, v225
 v_sub_f32 v236, v88, v225
 v_sub_f32 v237, v89, v225
 v_sub_f32 v238, v90, v225
 v_sub_f32 v239, v91, v225
 v_sub_f32 v240, v92, v225
 v_sub_f32 v241, v93, v225
 v_sub_f32 v242, v94, v225
 v_sub_f32 v243, v95, v225
 v_exp_f32 v228, v228
 v_exp_f32 v229, v229
 v_exp_f32 v230, v230
 v_exp_f32 v231, v231
 v_exp_f32 v232, v232
 v_exp_f32 v233, v233
 v_exp_f32 v234, v234
 v_exp_f32 v235, v235
 v_exp_f32 v236, v236
 v_exp_f32 v237, v237
 v_exp_f32 v238, v238
 v_exp_f32 v239, v239
 v_exp_f32 v240, v240
 v_exp_f32 v241, v241
 v_exp_f32 v242, v242
 v_exp_f32 v243, v243
 v_cvt_pk_bf16_f32 v56, v228, v229
 v_cvt_pk_bf16_f32 v57, v230, v231
 v_cvt_pk_bf16_f32 v58, v232, v233
 v_cvt_pk_bf16_f32 v59, v234, v235
 v_cvt_pk_bf16_f32 v60, v236, v237
 v_cvt_pk_bf16_f32 v61, v238, v239
 v_cvt_pk_bf16_f32 v62, v240, v241
 v_cvt_pk_bf16_f32 v63, v242, v243
 s_nop 1
 s_setpc_b64 s[62:63]
sequential_preLN__compressed_kv_cla__glu_gated_swiglu__prompt_kernel_slow20:
 v_max3_f32 v225, v64, v65, v66
 v_max3_f32 v225, v225, v67, v68
 v_max3_f32 v225, v225, v69, v70
 v_max3_f32 v225, v225, v71, v72
 v_max3_f32 v225, v225, v73, v74
 v_max3_f32 v225, v225, v75, v76
 v_max3_f32 v225, v225, v77, v78
 v_max_f32 v225, v225, v79
 v_mov_b32 v226, v225
 s_nop 1
 v_permlane16_swap_b32 v225, v226
 v_max_f32 v225, v225, v226
 v_mov_b32 v226, v225
 s_nop 1
 v_permlane32_swap_b32 v225, v226
 v_max_f32 v225, v225, v226
 v_add_f32 v225, 0x42cc0000, v225
 v_max_f32 v225, 0, v225
 v_sub_f32 v227, 0, v225
 v_exp_f32 v227, v227
 v_accvgpr_read_b32 v226, a184
 v_mul_f32 v226, v226, v227
 v_accvgpr_write_b32 a184, v226
 v_mul_f32 v160, v160, v227
 v_mul_f32 v161, v161, v227
 v_mul_f32 v162, v162, v227
 v_mul_f32 v163, v163, v227
 v_mul_f32 v164, v164, v227
 v_mul_f32 v165, v165, v227
 v_mul_f32 v166, v166, v227
 v_mul_f32 v167, v167, v227
 v_mul_f32 v168, v168, v227
 v_mul_f32 v169, v169, v227
 v_mul_f32 v170, v170, v227
 v_mul_f32 v171, v171, v227
 v_mul_f32 v172, v172, v227
 v_mul_f32 v173, v173, v227
 v_mul_f32 v174, v174, v227
 v_mul_f32 v175, v175, v227
 v_mul_f32 v176, v176, v227
 v_mul_f32 v177, v177, v227
 v_mul_f32 v178, v178, v227
 v_mul_f32 v179, v179, v227
 v_mul_f32 v180, v180, v227
 v_mul_f32 v181, v181, v227
 v_mul_f32 v182, v182, v227
 v_mul_f32 v183, v183, v227
 v_mul_f32 v184, v184, v227
 v_mul_f32 v185, v185, v227
 v_mul_f32 v186, v186, v227
 v_mul_f32 v187, v187, v227
 v_mul_f32 v188, v188, v227
 v_mul_f32 v189, v189, v227
 v_mul_f32 v190, v190, v227
 v_mul_f32 v191, v191, v227
 v_sub_f32 v40, v40, v225
 v_sub_f32 v41, v41, v225
 v_sub_f32 v42, v42, v225
 v_sub_f32 v43, v43, v225
 v_sub_f32 v228, v64, v225
 v_sub_f32 v229, v65, v225
 v_sub_f32 v230, v66, v225
 v_sub_f32 v231, v67, v225
 v_sub_f32 v232, v68, v225
 v_sub_f32 v233, v69, v225
 v_sub_f32 v234, v70, v225
 v_sub_f32 v235, v71, v225
 v_sub_f32 v236, v72, v225
 v_sub_f32 v237, v73, v225
 v_sub_f32 v238, v74, v225
 v_sub_f32 v239, v75, v225
 v_sub_f32 v240, v76, v225
 v_sub_f32 v241, v77, v225
 v_sub_f32 v242, v78, v225
 v_sub_f32 v243, v79, v225
 v_exp_f32 v228, v228
 v_exp_f32 v229, v229
 v_exp_f32 v230, v230
 v_exp_f32 v231, v231
 v_exp_f32 v232, v232
 v_exp_f32 v233, v233
 v_exp_f32 v234, v234
 v_exp_f32 v235, v235
 v_exp_f32 v236, v236
 v_exp_f32 v237, v237
 v_exp_f32 v238, v238
 v_exp_f32 v239, v239
 v_exp_f32 v240, v240
 v_exp_f32 v241, v241
 v_exp_f32 v242, v242
 v_exp_f32 v243, v243
 v_cvt_pk_bf16_f32 v48, v228, v229
 v_cvt_pk_bf16_f32 v49, v230, v231
 v_cvt_pk_bf16_f32 v50, v232, v233
 v_cvt_pk_bf16_f32 v51, v234, v235
 v_cvt_pk_bf16_f32 v52, v236, v237
 v_cvt_pk_bf16_f32 v53, v238, v239
 v_cvt_pk_bf16_f32 v54, v240, v241
 v_cvt_pk_bf16_f32 v55, v242, v243
 s_nop 1
 s_setpc_b64 s[62:63]
sequential_preLN__compressed_kv_cla__glu_gated_swiglu__prompt_kernel_slow21:
 v_max3_f32 v225, v80, v81, v82
 v_max3_f32 v225, v225, v83, v84
 v_max3_f32 v225, v225, v85, v86
 v_max3_f32 v225, v225, v87, v88
 v_max3_f32 v225, v225, v89, v90
 v_max3_f32 v225, v225, v91, v92
 v_max3_f32 v225, v225, v93, v94
 v_max_f32 v225, v225, v95
 v_mov_b32 v226, v225
 s_nop 1
 v_permlane16_swap_b32 v225, v226
 v_max_f32 v225, v225, v226
 v_mov_b32 v226, v225
 s_nop 1
 v_permlane32_swap_b32 v225, v226
 v_max_f32 v225, v225, v226
 v_add_f32 v225, 0x42cc0000, v225
 v_max_f32 v225, 0, v225
 v_sub_f32 v227, 0, v225
 v_exp_f32 v227, v227
 v_accvgpr_read_b32 v226, a184
 v_mul_f32 v226, v226, v227
 v_accvgpr_write_b32 a184, v226
 v_mul_f32 v160, v160, v227
 v_mul_f32 v161, v161, v227
 v_mul_f32 v162, v162, v227
 v_mul_f32 v163, v163, v227
 v_mul_f32 v164, v164, v227
 v_mul_f32 v165, v165, v227
 v_mul_f32 v166, v166, v227
 v_mul_f32 v167, v167, v227
 v_mul_f32 v168, v168, v227
 v_mul_f32 v169, v169, v227
 v_mul_f32 v170, v170, v227
 v_mul_f32 v171, v171, v227
 v_mul_f32 v172, v172, v227
 v_mul_f32 v173, v173, v227
 v_mul_f32 v174, v174, v227
 v_mul_f32 v175, v175, v227
 v_mul_f32 v176, v176, v227
 v_mul_f32 v177, v177, v227
 v_mul_f32 v178, v178, v227
 v_mul_f32 v179, v179, v227
 v_mul_f32 v180, v180, v227
 v_mul_f32 v181, v181, v227
 v_mul_f32 v182, v182, v227
 v_mul_f32 v183, v183, v227
 v_mul_f32 v184, v184, v227
 v_mul_f32 v185, v185, v227
 v_mul_f32 v186, v186, v227
 v_mul_f32 v187, v187, v227
 v_mul_f32 v188, v188, v227
 v_mul_f32 v189, v189, v227
 v_mul_f32 v190, v190, v227
 v_mul_f32 v191, v191, v227
 v_sub_f32 v40, v40, v225
 v_sub_f32 v41, v41, v225
 v_sub_f32 v42, v42, v225
 v_sub_f32 v43, v43, v225
 v_sub_f32 v228, v80, v225
 v_sub_f32 v229, v81, v225
 v_sub_f32 v230, v82, v225
 v_sub_f32 v231, v83, v225
 v_sub_f32 v232, v84, v225
 v_sub_f32 v233, v85, v225
 v_sub_f32 v234, v86, v225
 v_sub_f32 v235, v87, v225
 v_sub_f32 v236, v88, v225
 v_sub_f32 v237, v89, v225
 v_sub_f32 v238, v90, v225
 v_sub_f32 v239, v91, v225
 v_sub_f32 v240, v92, v225
 v_sub_f32 v241, v93, v225
 v_sub_f32 v242, v94, v225
 v_sub_f32 v243, v95, v225
 v_exp_f32 v228, v228
 v_exp_f32 v229, v229
 v_exp_f32 v230, v230
 v_exp_f32 v231, v231
 v_exp_f32 v232, v232
 v_exp_f32 v233, v233
 v_exp_f32 v234, v234
 v_exp_f32 v235, v235
 v_exp_f32 v236, v236
 v_exp_f32 v237, v237
 v_exp_f32 v238, v238
 v_exp_f32 v239, v239
 v_exp_f32 v240, v240
 v_exp_f32 v241, v241
 v_exp_f32 v242, v242
 v_exp_f32 v243, v243
 v_cvt_pk_bf16_f32 v56, v228, v229
 v_cvt_pk_bf16_f32 v57, v230, v231
 v_cvt_pk_bf16_f32 v58, v232, v233
 v_cvt_pk_bf16_f32 v59, v234, v235
 v_cvt_pk_bf16_f32 v60, v236, v237
 v_cvt_pk_bf16_f32 v61, v238, v239
 v_cvt_pk_bf16_f32 v62, v240, v241
 v_cvt_pk_bf16_f32 v63, v242, v243
 s_nop 1
 s_setpc_b64 s[62:63]
sequential_preLN__compressed_kv_cla__glu_gated_swiglu__prompt_kernel_slow30:
 v_max3_f32 v225, v64, v65, v66
 v_max3_f32 v225, v225, v67, v68
 v_max3_f32 v225, v225, v69, v70
 v_max3_f32 v225, v225, v71, v72
 v_max3_f32 v225, v225, v73, v74
 v_max3_f32 v225, v225, v75, v76
 v_max3_f32 v225, v225, v77, v78
 v_max_f32 v225, v225, v79
 v_mov_b32 v226, v225
 s_nop 1
 v_permlane16_swap_b32 v225, v226
 v_max_f32 v225, v225, v226
 v_mov_b32 v226, v225
 s_nop 1
 v_permlane32_swap_b32 v225, v226
 v_max_f32 v225, v225, v226
 v_add_f32 v225, 0x42cc0000, v225
 v_max_f32 v225, 0, v225
 v_sub_f32 v227, 0, v225
 v_exp_f32 v227, v227
 v_accvgpr_read_b32 v226, a188
 v_mul_f32 v226, v226, v227
 v_accvgpr_write_b32 a188, v226
 v_mul_f32 v192, v192, v227
 v_mul_f32 v193, v193, v227
 v_mul_f32 v194, v194, v227
 v_mul_f32 v195, v195, v227
 v_mul_f32 v196, v196, v227
 v_mul_f32 v197, v197, v227
 v_mul_f32 v198, v198, v227
 v_mul_f32 v199, v199, v227
 v_mul_f32 v200, v200, v227
 v_mul_f32 v201, v201, v227
 v_mul_f32 v202, v202, v227
 v_mul_f32 v203, v203, v227
 v_mul_f32 v204, v204, v227
 v_mul_f32 v205, v205, v227
 v_mul_f32 v206, v206, v227
 v_mul_f32 v207, v207, v227
 v_mul_f32 v208, v208, v227
 v_mul_f32 v209, v209, v227
 v_mul_f32 v210, v210, v227
 v_mul_f32 v211, v211, v227
 v_mul_f32 v212, v212, v227
 v_mul_f32 v213, v213, v227
 v_mul_f32 v214, v214, v227
 v_mul_f32 v215, v215, v227
 v_mul_f32 v216, v216, v227
 v_mul_f32 v217, v217, v227
 v_mul_f32 v218, v218, v227
 v_mul_f32 v219, v219, v227
 v_mul_f32 v220, v220, v227
 v_mul_f32 v221, v221, v227
 v_mul_f32 v222, v222, v227
 v_mul_f32 v223, v223, v227
 v_sub_f32 v44, v44, v225
 v_sub_f32 v45, v45, v225
 v_sub_f32 v46, v46, v225
 v_sub_f32 v47, v47, v225
 v_sub_f32 v228, v64, v225
 v_sub_f32 v229, v65, v225
 v_sub_f32 v230, v66, v225
 v_sub_f32 v231, v67, v225
 v_sub_f32 v232, v68, v225
 v_sub_f32 v233, v69, v225
 v_sub_f32 v234, v70, v225
 v_sub_f32 v235, v71, v225
 v_sub_f32 v236, v72, v225
 v_sub_f32 v237, v73, v225
 v_sub_f32 v238, v74, v225
 v_sub_f32 v239, v75, v225
 v_sub_f32 v240, v76, v225
 v_sub_f32 v241, v77, v225
 v_sub_f32 v242, v78, v225
 v_sub_f32 v243, v79, v225
 v_exp_f32 v228, v228
 v_exp_f32 v229, v229
 v_exp_f32 v230, v230
 v_exp_f32 v231, v231
 v_exp_f32 v232, v232
 v_exp_f32 v233, v233
 v_exp_f32 v234, v234
 v_exp_f32 v235, v235
 v_exp_f32 v236, v236
 v_exp_f32 v237, v237
 v_exp_f32 v238, v238
 v_exp_f32 v239, v239
 v_exp_f32 v240, v240
 v_exp_f32 v241, v241
 v_exp_f32 v242, v242
 v_exp_f32 v243, v243
 v_cvt_pk_bf16_f32 v48, v228, v229
 v_cvt_pk_bf16_f32 v49, v230, v231
 v_cvt_pk_bf16_f32 v50, v232, v233
 v_cvt_pk_bf16_f32 v51, v234, v235
 v_cvt_pk_bf16_f32 v52, v236, v237
 v_cvt_pk_bf16_f32 v53, v238, v239
 v_cvt_pk_bf16_f32 v54, v240, v241
 v_cvt_pk_bf16_f32 v55, v242, v243
 s_nop 1
 s_setpc_b64 s[62:63]
sequential_preLN__compressed_kv_cla__glu_gated_swiglu__prompt_kernel_slow31:
 v_max3_f32 v225, v80, v81, v82
 v_max3_f32 v225, v225, v83, v84
 v_max3_f32 v225, v225, v85, v86
 v_max3_f32 v225, v225, v87, v88
 v_max3_f32 v225, v225, v89, v90
 v_max3_f32 v225, v225, v91, v92
 v_max3_f32 v225, v225, v93, v94
 v_max_f32 v225, v225, v95
 v_mov_b32 v226, v225
 s_nop 1
 v_permlane16_swap_b32 v225, v226
 v_max_f32 v225, v225, v226
 v_mov_b32 v226, v225
 s_nop 1
 v_permlane32_swap_b32 v225, v226
 v_max_f32 v225, v225, v226
 v_add_f32 v225, 0x42cc0000, v225
 v_max_f32 v225, 0, v225
 v_sub_f32 v227, 0, v225
 v_exp_f32 v227, v227
 v_accvgpr_read_b32 v226, a188
 v_mul_f32 v226, v226, v227
 v_accvgpr_write_b32 a188, v226
 v_mul_f32 v192, v192, v227
 v_mul_f32 v193, v193, v227
 v_mul_f32 v194, v194, v227
 v_mul_f32 v195, v195, v227
 v_mul_f32 v196, v196, v227
 v_mul_f32 v197, v197, v227
 v_mul_f32 v198, v198, v227
 v_mul_f32 v199, v199, v227
 v_mul_f32 v200, v200, v227
 v_mul_f32 v201, v201, v227
 v_mul_f32 v202, v202, v227
 v_mul_f32 v203, v203, v227
 v_mul_f32 v204, v204, v227
 v_mul_f32 v205, v205, v227
 v_mul_f32 v206, v206, v227
 v_mul_f32 v207, v207, v227
 v_mul_f32 v208, v208, v227
 v_mul_f32 v209, v209, v227
 v_mul_f32 v210, v210, v227
 v_mul_f32 v211, v211, v227
 v_mul_f32 v212, v212, v227
 v_mul_f32 v213, v213, v227
 v_mul_f32 v214, v214, v227
 v_mul_f32 v215, v215, v227
 v_mul_f32 v216, v216, v227
 v_mul_f32 v217, v217, v227
 v_mul_f32 v218, v218, v227
 v_mul_f32 v219, v219, v227
 v_mul_f32 v220, v220, v227
 v_mul_f32 v221, v221, v227
 v_mul_f32 v222, v222, v227
 v_mul_f32 v223, v223, v227
 v_sub_f32 v44, v44, v225
 v_sub_f32 v45, v45, v225
 v_sub_f32 v46, v46, v225
 v_sub_f32 v47, v47, v225
 v_sub_f32 v228, v80, v225
 v_sub_f32 v229, v81, v225
 v_sub_f32 v230, v82, v225
 v_sub_f32 v231, v83, v225
 v_sub_f32 v232, v84, v225
 v_sub_f32 v233, v85, v225
 v_sub_f32 v234, v86, v225
 v_sub_f32 v235, v87, v225
 v_sub_f32 v236, v88, v225
 v_sub_f32 v237, v89, v225
 v_sub_f32 v238, v90, v225
 v_sub_f32 v239, v91, v225
 v_sub_f32 v240, v92, v225
 v_sub_f32 v241, v93, v225
 v_sub_f32 v242, v94, v225
 v_sub_f32 v243, v95, v225
 v_exp_f32 v228, v228
 v_exp_f32 v229, v229
 v_exp_f32 v230, v230
 v_exp_f32 v231, v231
 v_exp_f32 v232, v232
 v_exp_f32 v233, v233
 v_exp_f32 v234, v234
 v_exp_f32 v235, v235
 v_exp_f32 v236, v236
 v_exp_f32 v237, v237
 v_exp_f32 v238, v238
 v_exp_f32 v239, v239
 v_exp_f32 v240, v240
 v_exp_f32 v241, v241
 v_exp_f32 v242, v242
 v_exp_f32 v243, v243
 v_cvt_pk_bf16_f32 v56, v228, v229
 v_cvt_pk_bf16_f32 v57, v230, v231
 v_cvt_pk_bf16_f32 v58, v232, v233
 v_cvt_pk_bf16_f32 v59, v234, v235
 v_cvt_pk_bf16_f32 v60, v236, v237
 v_cvt_pk_bf16_f32 v61, v238, v239
 v_cvt_pk_bf16_f32 v62, v240, v241
 v_cvt_pk_bf16_f32 v63, v242, v243
 s_nop 1
 s_setpc_b64 s[62:63]
L_po_3:
 s_mov_b32 s101, 0x40000
L_spin_291:
 buffer_load_dword v16, v18, s[96:99], 0 offen sc1
 s_waitcnt vmcnt(0)
 v_cmp_ne_u32 vcc, s100, v16
 s_nop 0
 s_cbranch_vccz L_ok_292
 s_sleep 1
 s_sub_u32 s101, s101, 1
 s_cmp_lg_u32 s101, 0
 s_cbranch_scc1 L_spin_291
L_ok_292:
 s_branch L_pb_4
L_po_5:
 s_mov_b32 s101, 0x40000
L_spin_293:
 buffer_load_dword v16, v19, s[96:99], 0 offen sc1
 s_waitcnt vmcnt(0)
 v_cmp_ne_u32 vcc, s100, v16
 s_nop 0
 s_cbranch_vccz L_ok_294
 s_sleep 1
 s_sub_u32 s101, s101, 1
 s_cmp_lg_u32 s101, 0
 s_cbranch_scc1 L_spin_293
L_ok_294:
 s_branch L_pb_6
sequential_preLN__compressed_kv_cla__glu_gated_swiglu__prompt_kernel_cend:
 s_endpgm
.section .rodata,"a"
.p2align 6
.amdhsa_kernel sequential_preLN__compressed_kv_cla__glu_gated_swiglu__prompt_kernel
  .amdhsa_next_free_vgpr 512
  .amdhsa_next_free_sgpr 102
  .amdhsa_accum_offset 256
  .amdhsa_group_segment_fixed_size 0
  .amdhsa_kernarg_size 104
  .amdhsa_user_sgpr_count 2
  .amdhsa_user_sgpr_kernarg_segment_ptr 1
  .amdhsa_system_sgpr_workgroup_id_x 1
.end_amdhsa_kernel
```
